```python
import torch

def _softmax(x, axis=-1):
    return torch.softmax(x, dim=axis)

def _gelu(x):
    return torch.nn.functional.gelu(x, approximate='tanh')

def _silu(x):
    return torch.nn.functional.silu(x)

def _sigmoid(x):
    return torch.sigmoid(x)

def _layernorm(x, axis=-1, eps=1e-05):
    m = x.mean(dim=axis, keepdim=True)
    v = x.var(dim=axis, keepdim=True, unbiased=False)
    return (x - m) / torch.sqrt(v + eps)

def _scatter_add(tgt, idx, src, axis=0):
    return tgt.clone().index_add_(axis, idx, src)

def _segment_sum(src, seg, n):
    out = torch.zeros((n,) + src.shape[1:], dtype=src.dtype)
    return out.index_add_(0, seg, src)

def _pad(x, pw):
    flat = tuple((v for pair in reversed(pw) for v in pair))
    return torch.nn.functional.pad(x, flat)
kernel_name = 'concat_heads__memory_aug_recurrent_mem_tr__mha_block__prompt'

def setup_inputs():

    _w = lambda a: (lambda t: t.to(torch.bfloat16) if t.is_floating_point() else t)(torch.as_tensor(a))

    def _A_setup():
        B, S, Dm = (1, 2048, 640)
        H, Dh = (32, 192)
        M, seg = (8, 32)
        seg = min(seg, S)
        S = S // seg * seg
        return {'x': _w((lambda *s: torch.randn(*s, dtype=torch.bfloat16) * 0.05)(B, S, Dm)), 'mem0': _w((lambda *s: torch.randn(*s, dtype=torch.bfloat16) * 0.8)(B, M, Dm)), 'Wq': _w((lambda *s: torch.randn(*s, dtype=torch.bfloat16) * 1.6)(Dm, H, Dh) * Dm ** (-0.5)), 'Wk': _w((lambda *s: torch.randn(*s, dtype=torch.bfloat16) * 1.6)(Dm, H, Dh) * Dm ** (-0.5)), 'Wv': _w((lambda *s: torch.randn(*s, dtype=torch.bfloat16) * 0.8)(Dm, H, Dh) * Dm ** (-0.5)), 'Wo': _w((lambda *s: torch.randn(*s, dtype=torch.bfloat16) * 0.8)(H, Dh, Dm) * (H * Dh) ** (-0.5)), 'seg_len': seg}
    _A_in = _A_setup()

    def _B_setup():
        B, S, D, H = (1, 2048, 640, 32)
        return {'x': _w((lambda *s: torch.randn(*s, dtype=torch.bfloat16) * 0.2)(B, S, D)), 'wqkv': _w((lambda *s: torch.randn(*s, dtype=torch.bfloat16) * 0.2)(D, 3 * D)), 'wo': _w((lambda *s: torch.randn(*s, dtype=torch.bfloat16) * 0.05)(D, D))}
    _B_in = _B_setup()
    return {'A_x': _A_in['x'], 'A_mem0': _A_in['mem0'], 'A_Wq': _A_in['Wq'], 'A_Wk': _A_in['Wk'], 'A_Wv': _A_in['Wv'], 'A_Wo': _A_in['Wo'], 'A_seg_len': _A_in['seg_len'], 'B_x': _B_in['x'], 'B_wqkv': _B_in['wqkv'], 'B_wo': _B_in['wo']}

def reference(A_x, A_mem0, A_Wq, A_Wk, A_Wv, A_Wo, A_seg_len, B_x, B_wqkv, B_wo):

    def _A_ref(x, mem0, Wq, Wk, Wv, Wo, seg_len):
        B, S, Dm = x.shape
        H, Dh = (Wq.shape[1], Wq.shape[2])
        M = mem0.shape[1]
        scale = Dh ** (-0.5)
        n_seg = S // seg_len
        L = M + seg_len
        idx = torch.arange(L)
        mask = (idx[:, None] < M) | (idx[:, None] >= idx[None, :])
        mem = mem0
        outs = []
        for s in range(n_seg):
            xs = x[:, s * seg_len:(s + 1) * seg_len, :].clone()
            h = torch.concatenate([mem, xs], axis=1)
            q = torch.einsum('btd,dhe->bhte', h, Wq)
            k = torch.einsum('btd,dhe->bhte', h, Wk)
            v = torch.einsum('btd,dhe->bhte', h, Wv)
            scores = torch.einsum('bhqe,bhke->bhqk', q, k) * scale
            scores = torch.where(mask[None, None], scores, -1000000000.0)
            p = _softmax(scores, axis=-1)
            o = torch.einsum('bhqk,bhke->bhqe', p, v)
            o = torch.einsum('bhte,hed->btd', o, Wo)
            mem = o[:, :M, :].clone()
            outs.append(o[:, M:, :])
        return torch.concatenate(outs, axis=1)

    def _B_ref(x, wqkv, wo):
        B, S, D = x.shape
        H = 32
        Dh = D // H
        qkv = (lambda x, *d: x.permute(*d))((x @ wqkv).reshape(B, S, 3, H, Dh), 2, 0, 3, 1, 4)
        q, k, v = (qkv[0], qkv[1], qkv[2])
        scores = torch.einsum('bhqd,bhkd->bhqk', q, k) * Dh ** (-0.5)
        p = _softmax(scores, axis=-1)
        o = torch.einsum('bhqk,bhkd->bhqd', p, v)
        return (lambda x, *d: x.permute(*d))(o, 0, 2, 1, 3).reshape(B, S, D) @ wo
    a = _A_ref(A_x, A_mem0, A_Wq, A_Wk, A_Wv, A_Wo, A_seg_len)
    b = _B_ref(B_x, B_wqkv, B_wo)
    return torch.concatenate([a, b], axis=-1)
```

```asm
; @launch kernel=concat_heads__memory_aug_recurrent_mem_tr__mha_block__prompt_kernel grid=(256,1,1) block=(256,1,1) lds=163840
.amdgcn_target "amdgcn-amd-amdhsa--gfx950"
.text
  .globl concat_heads__memory_aug_recurrent_mem_tr__mha_block__prompt_kernel
.p2align 8
  .type concat_heads__memory_aug_recurrent_mem_tr__mha_block__prompt_kernel,@function
concat_heads__memory_aug_recurrent_mem_tr__mha_block__prompt_kernel:
  s_cmp_ge_u32 s2, 256
  s_cbranch_scc0 L1_GO
  s_endpgm
L1_GO:
  s_load_dwordx2 s[4:5], s[0:1], 96
  s_mov_b32 s6, 0x10000000
  s_mov_b32 s7, 0x00020000
  s_load_dwordx2 s[12:13], s[0:1], 88
  s_mov_b32 s14, 0x100
  s_mov_b32 s15, 0x00020000
  v_and_b32 v1, 63, v0
  v_lshrrev_b32 v2, 6, v0
  s_nop 0
  v_readfirstlane_b32 s16, v2
  s_waitcnt lgkmcnt(0)
  v_mov_b32 v40, -1
  v_mov_b32 v41, -1
  v_mov_b32 v42, -1
  v_mov_b32 v43, -1
  v_lshlrev_b32 v44, 4, v0
  s_mul_i32 s34, s2, 5120
  buffer_store_dwordx4 v[40:43], v44, s[4:7], s34 offen sc1
  s_add_u32 s34, s34, 4096
  v_cmp_gt_u32 vcc, 64, v0
  s_and_saveexec_b64 s[36:37], vcc
  buffer_store_dwordx4 v[40:43], v44, s[4:7], s34 offen sc1
  s_mov_b64 exec, s[36:37]
  s_cmp_lt_u32 s2, 3
  s_cbranch_scc0 L1_NZ
  v_mov_b32 v46, 0
  v_mov_b32 v47, 0
  v_mov_b32 v48, 0
  v_mov_b32 v49, 0
  s_lshl_b32 s34, s2, 12
  s_add_u32 s34, s34, 1835008
  buffer_store_dwordx4 v[46:49], v44, s[4:7], s34 offen sc1
L1_NZ:
  s_waitcnt vmcnt(0)
  s_barrier
  s_cmp_eq_u32 s16, 0
  s_cbranch_scc0 RO_wait
  s_getreg_b32 s57, hwreg(HW_REG_XCC_ID, 0, 4)
  s_min_u32 s57, s57, 7
  s_lshl_b32 s58, s57, 2
  v_mov_b32 v2, s58
  v_mov_b32 v3, 1
  v_mov_b32 v7, 0
  s_mov_b64 exec, 1
  buffer_atomic_add v3, v2, s[12:15], 0 offen sc0 sc1
  s_mov_b32 s59, 0
RO_spin:
  buffer_load_dwordx4 v[8:11], v7, s[12:15], 0 offen sc0 sc1
  buffer_load_dwordx4 v[12:15], v7, s[12:15], 0 offen offset:16 sc0 sc1
  s_waitcnt vmcnt(0)
  v_readfirstlane_b32 s60, v8
  v_readfirstlane_b32 s61, v9
  v_readfirstlane_b32 s62, v10
  v_readfirstlane_b32 s63, v11
  v_readfirstlane_b32 s64, v12
  v_readfirstlane_b32 s65, v13
  v_readfirstlane_b32 s66, v14
  v_readfirstlane_b32 s67, v15
  s_add_u32 s58, s60, s61
  s_add_u32 s58, s58, s62
  s_add_u32 s58, s58, s63
  s_add_u32 s58, s58, s64
  s_add_u32 s58, s58, s65
  s_add_u32 s58, s58, s66
  s_add_u32 s58, s58, s67
  s_add_u32 s59, s59, 1
  s_cmp_ge_u32 s58, 256
  s_cbranch_scc1 RO_go
  s_cmp_lt_u32 s59, 400000
  s_cbranch_scc1 RO_spin
RO_go:
  s_mov_b64 exec, -1
  v_readfirstlane_b32 s56, v3
  s_cmp_gt_u32 s57, 0
  s_cselect_b32 s58, s60, 0
  s_add_u32 s56, s56, s58
  s_cmp_gt_u32 s57, 1
  s_cselect_b32 s58, s61, 0
  s_add_u32 s56, s56, s58
  s_cmp_gt_u32 s57, 2
  s_cselect_b32 s58, s62, 0
  s_add_u32 s56, s56, s58
  s_cmp_gt_u32 s57, 3
  s_cselect_b32 s58, s63, 0
  s_add_u32 s56, s56, s58
  s_cmp_gt_u32 s57, 4
  s_cselect_b32 s58, s64, 0
  s_add_u32 s56, s56, s58
  s_cmp_gt_u32 s57, 5
  s_cselect_b32 s58, s65, 0
  s_add_u32 s56, s56, s58
  s_cmp_gt_u32 s57, 6
  s_cselect_b32 s58, s66, 0
  s_add_u32 s56, s56, s58
  s_xor_b32 s60, s60, 32
  s_xor_b32 s61, s61, 32
  s_xor_b32 s62, s62, 32
  s_xor_b32 s63, s63, 32
  s_or_b32 s60, s60, s61
  s_or_b32 s62, s62, s63
  s_or_b32 s60, s60, s62
  s_cmp_lt_u32 s56, 128
  s_cselect_b32 s58, 0x8000, 0
  s_and_b32 s56, s56, 127
  s_or_b32 s56, s56, s58
  s_cmp_eq_u32 s60, 0
  s_cselect_b32 s58, 0x10000, 0
  s_or_b32 s56, s56, s58
RO_bc:
  v_mov_b32 v2, s56
  v_mov_b32 v3, 0
  ds_write_b32 v3, v2
  s_waitcnt lgkmcnt(0)
RO_wait:
  s_barrier
  v_mov_b32 v3, 0
  ds_read_b32 v2, v3
  s_waitcnt lgkmcnt(0)
  v_readfirstlane_b32 s56, v2
  s_barrier
  s_and_b32 s57, s56, 0x8000
  s_cmp_eq_u32 s57, 0
  s_cbranch_scc1 L1_OTHER
  s_and_b32 s18, s56, 31
  s_bfe_u32 s17, s56, 0x20005
  s_bfe_u32 s68, s56, 0x10010
  s_lshr_b32 s35, s18, 2
  s_lshl_b32 s57, s17, 3
  s_add_u32 s35, s35, s57
  s_and_b32 s36, s18, 3
  s_mov_b32 s21, 0
  s_load_dwordx2 s[90:91], s[0:1], 8
  v_mov_b32 v176, 0
  v_mov_b32 v177, 0
  v_mov_b32 v178, 0
  v_mov_b32 v179, 0
  v_mov_b32 v240, 0
  s_load_dwordx2 s[60:61], s[0:1], 16
  s_load_dwordx2 s[62:63], s[0:1], 24
  s_load_dwordx2 s[64:65], s[0:1], 32
  s_load_dwordx2 s[66:67], s[0:1], 40
  s_mov_b32 s10, 7864320
  s_mov_b32 s11, 0x00020000
  v_mul_u32_u24 v30, 43691, v1
  v_lshrrev_b32 v30, 18, v30
  v_mul_u32_u24 v31, 6, v30
  v_sub_u32 v31, v1, v31
  v_mul_u32_u24 v30, 12288, v30
  v_lshlrev_b32 v31, 4, v31
  v_add_u32 v32, v30, v31
  s_mul_i32 s33, s35, 384
  s_mul_i32 s34, s36, 96
  s_add_u32 s56, s33, s34
  s_waitcnt lgkmcnt(0)
  s_mov_b32 s8, s60
  s_mov_b32 s9, s61
  s_mul_i32 s57, s16, 1966080
  s_add_u32 s57, s57, s56
  s_mul_i32 s58, s16, 15360
  s_add_u32 s58, s58, 0
  s_mov_b32 exec_hi, 0x0fffffff
  s_mov_b32 m0, s58
  s_add_u32 s58, s58, 960
  buffer_load_dwordx4 v32, s[8:11], s57 offen lds
  s_add_u32 s57, s57, 122880
  s_mov_b32 m0, s58
  s_add_u32 s58, s58, 960
  buffer_load_dwordx4 v32, s[8:11], s57 offen lds
  s_add_u32 s57, s57, 122880
  s_mov_b32 m0, s58
  s_add_u32 s58, s58, 960
  buffer_load_dwordx4 v32, s[8:11], s57 offen lds
  s_add_u32 s57, s57, 122880
  s_mov_b32 m0, s58
  s_add_u32 s58, s58, 960
  buffer_load_dwordx4 v32, s[8:11], s57 offen lds
  s_add_u32 s57, s57, 122880
  s_mov_b32 m0, s58
  s_add_u32 s58, s58, 960
  buffer_load_dwordx4 v32, s[8:11], s57 offen lds
  s_add_u32 s57, s57, 122880
  s_mov_b32 m0, s58
  s_add_u32 s58, s58, 960
  buffer_load_dwordx4 v32, s[8:11], s57 offen lds
  s_add_u32 s57, s57, 122880
  s_mov_b32 m0, s58
  s_add_u32 s58, s58, 960
  buffer_load_dwordx4 v32, s[8:11], s57 offen lds
  s_add_u32 s57, s57, 122880
  s_mov_b32 m0, s58
  s_add_u32 s58, s58, 960
  buffer_load_dwordx4 v32, s[8:11], s57 offen lds
  s_add_u32 s57, s57, 122880
  s_mov_b32 m0, s58
  s_add_u32 s58, s58, 960
  buffer_load_dwordx4 v32, s[8:11], s57 offen lds
  s_add_u32 s57, s57, 122880
  s_mov_b32 m0, s58
  s_add_u32 s58, s58, 960
  buffer_load_dwordx4 v32, s[8:11], s57 offen lds
  s_add_u32 s57, s57, 122880
  s_mov_b32 m0, s58
  s_add_u32 s58, s58, 960
  buffer_load_dwordx4 v32, s[8:11], s57 offen lds
  s_add_u32 s57, s57, 122880
  s_mov_b32 m0, s58
  s_add_u32 s58, s58, 960
  buffer_load_dwordx4 v32, s[8:11], s57 offen lds
  s_add_u32 s57, s57, 122880
  s_mov_b32 m0, s58
  s_add_u32 s58, s58, 960
  buffer_load_dwordx4 v32, s[8:11], s57 offen lds
  s_add_u32 s57, s57, 122880
  s_mov_b32 m0, s58
  s_add_u32 s58, s58, 960
  buffer_load_dwordx4 v32, s[8:11], s57 offen lds
  s_add_u32 s57, s57, 122880
  s_mov_b32 m0, s58
  s_add_u32 s58, s58, 960
  buffer_load_dwordx4 v32, s[8:11], s57 offen lds
  s_add_u32 s57, s57, 122880
  s_mov_b32 m0, s58
  s_add_u32 s58, s58, 960
  buffer_load_dwordx4 v32, s[8:11], s57 offen lds
  s_add_u32 s57, s57, 122880
  s_mov_b64 exec, -1
  s_mov_b32 s8, s62
  s_mov_b32 s9, s63
  s_mul_i32 s57, s16, 1966080
  s_add_u32 s57, s57, s56
  s_mul_i32 s58, s16, 15360
  s_add_u32 s58, s58, 61440
  s_mov_b32 exec_hi, 0x0fffffff
  s_mov_b32 m0, s58
  s_add_u32 s58, s58, 960
  buffer_load_dwordx4 v32, s[8:11], s57 offen lds
  s_add_u32 s57, s57, 122880
  s_mov_b32 m0, s58
  s_add_u32 s58, s58, 960
  buffer_load_dwordx4 v32, s[8:11], s57 offen lds
  s_add_u32 s57, s57, 122880
  s_mov_b32 m0, s58
  s_add_u32 s58, s58, 960
  buffer_load_dwordx4 v32, s[8:11], s57 offen lds
  s_add_u32 s57, s57, 122880
  s_mov_b32 m0, s58
  s_add_u32 s58, s58, 960
  buffer_load_dwordx4 v32, s[8:11], s57 offen lds
  s_add_u32 s57, s57, 122880
  s_mov_b32 m0, s58
  s_add_u32 s58, s58, 960
  buffer_load_dwordx4 v32, s[8:11], s57 offen lds
  s_add_u32 s57, s57, 122880
  s_mov_b32 m0, s58
  s_add_u32 s58, s58, 960
  buffer_load_dwordx4 v32, s[8:11], s57 offen lds
  s_add_u32 s57, s57, 122880
  s_mov_b32 m0, s58
  s_add_u32 s58, s58, 960
  buffer_load_dwordx4 v32, s[8:11], s57 offen lds
  s_add_u32 s57, s57, 122880
  s_mov_b32 m0, s58
  s_add_u32 s58, s58, 960
  buffer_load_dwordx4 v32, s[8:11], s57 offen lds
  s_add_u32 s57, s57, 122880
  s_mov_b32 m0, s58
  s_add_u32 s58, s58, 960
  buffer_load_dwordx4 v32, s[8:11], s57 offen lds
  s_add_u32 s57, s57, 122880
  s_mov_b32 m0, s58
  s_add_u32 s58, s58, 960
  buffer_load_dwordx4 v32, s[8:11], s57 offen lds
  s_add_u32 s57, s57, 122880
  s_mov_b32 m0, s58
  s_add_u32 s58, s58, 960
  buffer_load_dwordx4 v32, s[8:11], s57 offen lds
  s_add_u32 s57, s57, 122880
  s_mov_b32 m0, s58
  s_add_u32 s58, s58, 960
  buffer_load_dwordx4 v32, s[8:11], s57 offen lds
  s_add_u32 s57, s57, 122880
  s_mov_b32 m0, s58
  s_add_u32 s58, s58, 960
  buffer_load_dwordx4 v32, s[8:11], s57 offen lds
  s_add_u32 s57, s57, 122880
  s_mov_b32 m0, s58
  s_add_u32 s58, s58, 960
  buffer_load_dwordx4 v32, s[8:11], s57 offen lds
  s_add_u32 s57, s57, 122880
  s_mov_b32 m0, s58
  s_add_u32 s58, s58, 960
  buffer_load_dwordx4 v32, s[8:11], s57 offen lds
  s_add_u32 s57, s57, 122880
  s_mov_b32 m0, s58
  s_add_u32 s58, s58, 960
  buffer_load_dwordx4 v32, s[8:11], s57 offen lds
  s_add_u32 s57, s57, 122880
  s_mov_b64 exec, -1
  v_bfe_u32 v30, v1, 2, 2
  v_and_b32 v31, 1, v30
  v_lshrrev_b32 v30, 1, v30
  v_lshlrev_b32 v30, 3, v30
  v_add_u32 v30, v30, v31
  v_bfe_u32 v31, v1, 5, 1
  v_lshlrev_b32 v31, 4, v31
  v_add_u32 v30, v30, v31
  v_bfe_u32 v31, v1, 4, 1
  v_lshlrev_b32 v31, 2, v31
  v_add_u32 v30, v30, v31
  v_mul_u32_u24 v30, 96, v30
  v_and_b32 v31, 3, v1
  v_lshlrev_b32 v31, 3, v31
  v_add_u32 v33, v30, v31
  s_and_b32 s57, s16, 1
  s_mul_i32 s57, s57, 30720
  s_lshr_b32 s58, s16, 1
  s_mul_i32 s58, s58, 61440
  s_add_u32 s57, s57, s58
  v_add_u32 v34, s57, v33
  s_waitcnt vmcnt(0)
  s_barrier
  ds_read_b64_tr_b16 a[0:1], v34 offset:0
  ds_read_b64_tr_b16 a[2:3], v34 offset:192
  ds_read_b64_tr_b16 a[4:5], v34 offset:3072
  ds_read_b64_tr_b16 a[6:7], v34 offset:3264
  ds_read_b64_tr_b16 a[8:9], v34 offset:32
  ds_read_b64_tr_b16 a[10:11], v34 offset:224
  ds_read_b64_tr_b16 a[12:13], v34 offset:3104
  ds_read_b64_tr_b16 a[14:15], v34 offset:3296
  ds_read_b64_tr_b16 a[16:17], v34 offset:64
  ds_read_b64_tr_b16 a[18:19], v34 offset:256
  ds_read_b64_tr_b16 a[20:21], v34 offset:3136
  ds_read_b64_tr_b16 a[22:23], v34 offset:3328
  s_waitcnt lgkmcnt(0)
  ds_read_b64_tr_b16 a[24:25], v34 offset:6144
  ds_read_b64_tr_b16 a[26:27], v34 offset:6336
  ds_read_b64_tr_b16 a[28:29], v34 offset:9216
  ds_read_b64_tr_b16 a[30:31], v34 offset:9408
  ds_read_b64_tr_b16 a[32:33], v34 offset:6176
  ds_read_b64_tr_b16 a[34:35], v34 offset:6368
  ds_read_b64_tr_b16 a[36:37], v34 offset:9248
  ds_read_b64_tr_b16 a[38:39], v34 offset:9440
  ds_read_b64_tr_b16 a[40:41], v34 offset:6208
  ds_read_b64_tr_b16 a[42:43], v34 offset:6400
  ds_read_b64_tr_b16 a[44:45], v34 offset:9280
  ds_read_b64_tr_b16 a[46:47], v34 offset:9472
  s_waitcnt lgkmcnt(0)
  ds_read_b64_tr_b16 a[48:49], v34 offset:12288
  ds_read_b64_tr_b16 a[50:51], v34 offset:12480
  ds_read_b64_tr_b16 a[52:53], v34 offset:15360
  ds_read_b64_tr_b16 a[54:55], v34 offset:15552
  ds_read_b64_tr_b16 a[56:57], v34 offset:12320
  ds_read_b64_tr_b16 a[58:59], v34 offset:12512
  ds_read_b64_tr_b16 a[60:61], v34 offset:15392
  ds_read_b64_tr_b16 a[62:63], v34 offset:15584
  ds_read_b64_tr_b16 a[64:65], v34 offset:12352
  ds_read_b64_tr_b16 a[66:67], v34 offset:12544
  ds_read_b64_tr_b16 a[68:69], v34 offset:15424
  ds_read_b64_tr_b16 a[70:71], v34 offset:15616
  s_waitcnt lgkmcnt(0)
  ds_read_b64_tr_b16 a[72:73], v34 offset:18432
  ds_read_b64_tr_b16 a[74:75], v34 offset:18624
  ds_read_b64_tr_b16 a[76:77], v34 offset:21504
  ds_read_b64_tr_b16 a[78:79], v34 offset:21696
  ds_read_b64_tr_b16 a[80:81], v34 offset:18464
  ds_read_b64_tr_b16 a[82:83], v34 offset:18656
  ds_read_b64_tr_b16 a[84:85], v34 offset:21536
  ds_read_b64_tr_b16 a[86:87], v34 offset:21728
  ds_read_b64_tr_b16 a[88:89], v34 offset:18496
  ds_read_b64_tr_b16 a[90:91], v34 offset:18688
  ds_read_b64_tr_b16 a[92:93], v34 offset:21568
  ds_read_b64_tr_b16 a[94:95], v34 offset:21760
  s_waitcnt lgkmcnt(0)
  ds_read_b64_tr_b16 a[96:97], v34 offset:24576
  ds_read_b64_tr_b16 a[98:99], v34 offset:24768
  ds_read_b64_tr_b16 a[100:101], v34 offset:27648
  ds_read_b64_tr_b16 a[102:103], v34 offset:27840
  ds_read_b64_tr_b16 a[104:105], v34 offset:24608
  ds_read_b64_tr_b16 a[106:107], v34 offset:24800
  ds_read_b64_tr_b16 a[108:109], v34 offset:27680
  ds_read_b64_tr_b16 a[110:111], v34 offset:27872
  ds_read_b64_tr_b16 a[112:113], v34 offset:24640
  ds_read_b64_tr_b16 a[114:115], v34 offset:24832
  ds_read_b64_tr_b16 a[116:117], v34 offset:27712
  ds_read_b64_tr_b16 a[118:119], v34 offset:27904
  s_waitcnt lgkmcnt(0)
  s_barrier
  s_mov_b32 s8, s64
  s_mov_b32 s9, s65
  s_mul_i32 s57, s16, 1966080
  s_add_u32 s57, s57, s56
  s_mul_i32 s58, s16, 15360
  s_add_u32 s58, s58, 0
  s_mov_b32 exec_hi, 0x0fffffff
  s_mov_b32 m0, s58
  s_add_u32 s58, s58, 960
  buffer_load_dwordx4 v32, s[8:11], s57 offen lds
  s_add_u32 s57, s57, 122880
  s_mov_b32 m0, s58
  s_add_u32 s58, s58, 960
  buffer_load_dwordx4 v32, s[8:11], s57 offen lds
  s_add_u32 s57, s57, 122880
  s_mov_b32 m0, s58
  s_add_u32 s58, s58, 960
  buffer_load_dwordx4 v32, s[8:11], s57 offen lds
  s_add_u32 s57, s57, 122880
  s_mov_b32 m0, s58
  s_add_u32 s58, s58, 960
  buffer_load_dwordx4 v32, s[8:11], s57 offen lds
  s_add_u32 s57, s57, 122880
  s_mov_b32 m0, s58
  s_add_u32 s58, s58, 960
  buffer_load_dwordx4 v32, s[8:11], s57 offen lds
  s_add_u32 s57, s57, 122880
  s_mov_b32 m0, s58
  s_add_u32 s58, s58, 960
  buffer_load_dwordx4 v32, s[8:11], s57 offen lds
  s_add_u32 s57, s57, 122880
  s_mov_b32 m0, s58
  s_add_u32 s58, s58, 960
  buffer_load_dwordx4 v32, s[8:11], s57 offen lds
  s_add_u32 s57, s57, 122880
  s_mov_b32 m0, s58
  s_add_u32 s58, s58, 960
  buffer_load_dwordx4 v32, s[8:11], s57 offen lds
  s_add_u32 s57, s57, 122880
  s_mov_b32 m0, s58
  s_add_u32 s58, s58, 960
  buffer_load_dwordx4 v32, s[8:11], s57 offen lds
  s_add_u32 s57, s57, 122880
  s_mov_b32 m0, s58
  s_add_u32 s58, s58, 960
  buffer_load_dwordx4 v32, s[8:11], s57 offen lds
  s_add_u32 s57, s57, 122880
  s_mov_b32 m0, s58
  s_add_u32 s58, s58, 960
  buffer_load_dwordx4 v32, s[8:11], s57 offen lds
  s_add_u32 s57, s57, 122880
  s_mov_b32 m0, s58
  s_add_u32 s58, s58, 960
  buffer_load_dwordx4 v32, s[8:11], s57 offen lds
  s_add_u32 s57, s57, 122880
  s_mov_b32 m0, s58
  s_add_u32 s58, s58, 960
  buffer_load_dwordx4 v32, s[8:11], s57 offen lds
  s_add_u32 s57, s57, 122880
  s_mov_b32 m0, s58
  s_add_u32 s58, s58, 960
  buffer_load_dwordx4 v32, s[8:11], s57 offen lds
  s_add_u32 s57, s57, 122880
  s_mov_b32 m0, s58
  s_add_u32 s58, s58, 960
  buffer_load_dwordx4 v32, s[8:11], s57 offen lds
  s_add_u32 s57, s57, 122880
  s_mov_b32 m0, s58
  s_add_u32 s58, s58, 960
  buffer_load_dwordx4 v32, s[8:11], s57 offen lds
  s_add_u32 s57, s57, 122880
  s_mov_b64 exec, -1
  s_mov_b32 s8, s66
  s_mov_b32 s9, s67
  s_mov_b32 s10, 7864320
  v_lshrrev_b32 v30, 2, v1
  v_mul_u32_u24 v30, 1280, v30
  v_and_b32 v31, 3, v1
  v_lshlrev_b32 v31, 4, v31
  v_add_u32 v32, v30, v31
  s_mul_i32 s57, s17, 1966080
  s_mul_i32 s58, s16, 491520
  s_add_u32 s57, s57, s58
  s_min_u32 s58, s18, 19
  s_lshl_b32 s58, s58, 6
  s_add_u32 s57, s57, s58
  s_mul_i32 s58, s16, 24576
  s_add_u32 s58, s58, 61440
  s_mov_b32 m0, s58
  s_add_u32 s58, s58, 1024
  buffer_load_dwordx4 v32, s[8:11], s57 offen lds
  s_add_u32 s57, s57, 20480
  s_mov_b32 m0, s58
  s_add_u32 s58, s58, 1024
  buffer_load_dwordx4 v32, s[8:11], s57 offen lds
  s_add_u32 s57, s57, 20480
  s_mov_b32 m0, s58
  s_add_u32 s58, s58, 1024
  buffer_load_dwordx4 v32, s[8:11], s57 offen lds
  s_add_u32 s57, s57, 20480
  s_mov_b32 m0, s58
  s_add_u32 s58, s58, 1024
  buffer_load_dwordx4 v32, s[8:11], s57 offen lds
  s_add_u32 s57, s57, 20480
  s_mov_b32 m0, s58
  s_add_u32 s58, s58, 1024
  buffer_load_dwordx4 v32, s[8:11], s57 offen lds
  s_add_u32 s57, s57, 20480
  s_mov_b32 m0, s58
  s_add_u32 s58, s58, 1024
  buffer_load_dwordx4 v32, s[8:11], s57 offen lds
  s_add_u32 s57, s57, 20480
  s_mov_b32 m0, s58
  s_add_u32 s58, s58, 1024
  buffer_load_dwordx4 v32, s[8:11], s57 offen lds
  s_add_u32 s57, s57, 20480
  s_mov_b32 m0, s58
  s_add_u32 s58, s58, 1024
  buffer_load_dwordx4 v32, s[8:11], s57 offen lds
  s_add_u32 s57, s57, 20480
  s_mov_b32 m0, s58
  s_add_u32 s58, s58, 1024
  buffer_load_dwordx4 v32, s[8:11], s57 offen lds
  s_add_u32 s57, s57, 20480
  s_mov_b32 m0, s58
  s_add_u32 s58, s58, 1024
  buffer_load_dwordx4 v32, s[8:11], s57 offen lds
  s_add_u32 s57, s57, 20480
  s_mov_b32 m0, s58
  s_add_u32 s58, s58, 1024
  buffer_load_dwordx4 v32, s[8:11], s57 offen lds
  s_add_u32 s57, s57, 20480
  s_mov_b32 m0, s58
  s_add_u32 s58, s58, 1024
  buffer_load_dwordx4 v32, s[8:11], s57 offen lds
  s_add_u32 s57, s57, 20480
  s_mov_b32 m0, s58
  s_add_u32 s58, s58, 1024
  buffer_load_dwordx4 v32, s[8:11], s57 offen lds
  s_add_u32 s57, s57, 20480
  s_mov_b32 m0, s58
  s_add_u32 s58, s58, 1024
  buffer_load_dwordx4 v32, s[8:11], s57 offen lds
  s_add_u32 s57, s57, 20480
  s_mov_b32 m0, s58
  s_add_u32 s58, s58, 1024
  buffer_load_dwordx4 v32, s[8:11], s57 offen lds
  s_add_u32 s57, s57, 20480
  s_mov_b32 m0, s58
  s_add_u32 s58, s58, 1024
  buffer_load_dwordx4 v32, s[8:11], s57 offen lds
  s_add_u32 s57, s57, 20480
  s_mov_b32 m0, s58
  s_add_u32 s58, s58, 1024
  buffer_load_dwordx4 v32, s[8:11], s57 offen lds
  s_add_u32 s57, s57, 20480
  s_mov_b32 m0, s58
  s_add_u32 s58, s58, 1024
  buffer_load_dwordx4 v32, s[8:11], s57 offen lds
  s_add_u32 s57, s57, 20480
  s_mov_b32 m0, s58
  s_add_u32 s58, s58, 1024
  buffer_load_dwordx4 v32, s[8:11], s57 offen lds
  s_add_u32 s57, s57, 20480
  s_mov_b32 m0, s58
  s_add_u32 s58, s58, 1024
  buffer_load_dwordx4 v32, s[8:11], s57 offen lds
  s_add_u32 s57, s57, 20480
  s_mov_b32 m0, s58
  s_add_u32 s58, s58, 1024
  buffer_load_dwordx4 v32, s[8:11], s57 offen lds
  s_add_u32 s57, s57, 20480
  s_mov_b32 m0, s58
  s_add_u32 s58, s58, 1024
  buffer_load_dwordx4 v32, s[8:11], s57 offen lds
  s_add_u32 s57, s57, 20480
  s_mov_b32 m0, s58
  s_add_u32 s58, s58, 1024
  buffer_load_dwordx4 v32, s[8:11], s57 offen lds
  s_add_u32 s57, s57, 20480
  s_mov_b32 m0, s58
  s_add_u32 s58, s58, 1024
  buffer_load_dwordx4 v32, s[8:11], s57 offen lds
  s_add_u32 s57, s57, 20480
  v_bfe_u32 v30, v1, 2, 2
  v_and_b32 v31, 1, v30
  v_lshrrev_b32 v30, 1, v30
  v_lshlrev_b32 v30, 3, v30
  v_add_u32 v30, v30, v31
  v_bfe_u32 v31, v1, 5, 1
  v_lshlrev_b32 v31, 4, v31
  v_add_u32 v30, v30, v31
  v_bfe_u32 v31, v1, 4, 1
  v_lshlrev_b32 v31, 2, v31
  v_add_u32 v30, v30, v31
  v_mul_u32_u24 v30, 64, v30
  v_and_b32 v31, 3, v1
  v_lshlrev_b32 v31, 3, v31
  v_add_u32 v35, v30, v31
  s_mul_i32 s57, s16, 24576
  s_add_u32 s57, s57, 61440
  v_add_u32 v35, s57, v35
  s_and_b32 s57, s16, 1
  s_mul_i32 s57, s57, 30720
  v_add_u32 v34, s57, v33
  s_waitcnt vmcnt(0)
  s_barrier
  ds_read_b64_tr_b16 a[120:121], v35 offset:0
  ds_read_b64_tr_b16 a[122:123], v35 offset:128
  ds_read_b64_tr_b16 a[124:125], v35 offset:2048
  ds_read_b64_tr_b16 a[126:127], v35 offset:2176
  ds_read_b64_tr_b16 a[128:129], v35 offset:32
  ds_read_b64_tr_b16 a[130:131], v35 offset:160
  ds_read_b64_tr_b16 a[132:133], v35 offset:2080
  ds_read_b64_tr_b16 a[134:135], v35 offset:2208
  s_waitcnt lgkmcnt(0)
  ds_read_b64_tr_b16 a[136:137], v35 offset:4096
  ds_read_b64_tr_b16 a[138:139], v35 offset:4224
  ds_read_b64_tr_b16 a[140:141], v35 offset:6144
  ds_read_b64_tr_b16 a[142:143], v35 offset:6272
  ds_read_b64_tr_b16 a[144:145], v35 offset:4128
  ds_read_b64_tr_b16 a[146:147], v35 offset:4256
  ds_read_b64_tr_b16 a[148:149], v35 offset:6176
  ds_read_b64_tr_b16 a[150:151], v35 offset:6304
  s_waitcnt lgkmcnt(0)
  ds_read_b64_tr_b16 a[152:153], v35 offset:8192
  ds_read_b64_tr_b16 a[154:155], v35 offset:8320
  ds_read_b64_tr_b16 a[156:157], v35 offset:10240
  ds_read_b64_tr_b16 a[158:159], v35 offset:10368
  ds_read_b64_tr_b16 a[160:161], v35 offset:8224
  ds_read_b64_tr_b16 a[162:163], v35 offset:8352
  ds_read_b64_tr_b16 a[164:165], v35 offset:10272
  ds_read_b64_tr_b16 a[166:167], v35 offset:10400
  s_waitcnt lgkmcnt(0)
  ds_read_b64_tr_b16 a[168:169], v35 offset:12288
  ds_read_b64_tr_b16 a[170:171], v35 offset:12416
  ds_read_b64_tr_b16 a[172:173], v35 offset:14336
  ds_read_b64_tr_b16 a[174:175], v35 offset:14464
  ds_read_b64_tr_b16 a[176:177], v35 offset:12320
  ds_read_b64_tr_b16 a[178:179], v35 offset:12448
  ds_read_b64_tr_b16 a[180:181], v35 offset:14368
  ds_read_b64_tr_b16 a[182:183], v35 offset:14496
  s_waitcnt lgkmcnt(0)
  ds_read_b64_tr_b16 a[184:185], v35 offset:16384
  ds_read_b64_tr_b16 a[186:187], v35 offset:16512
  ds_read_b64_tr_b16 a[188:189], v35 offset:18432
  ds_read_b64_tr_b16 a[190:191], v35 offset:18560
  ds_read_b64_tr_b16 a[192:193], v35 offset:16416
  ds_read_b64_tr_b16 a[194:195], v35 offset:16544
  ds_read_b64_tr_b16 a[196:197], v35 offset:18464
  ds_read_b64_tr_b16 a[198:199], v35 offset:18592
  s_waitcnt lgkmcnt(0)
  ds_read_b64_tr_b16 a[200:201], v35 offset:20480
  ds_read_b64_tr_b16 a[202:203], v35 offset:20608
  ds_read_b64_tr_b16 a[204:205], v35 offset:22528
  ds_read_b64_tr_b16 a[206:207], v35 offset:22656
  ds_read_b64_tr_b16 a[208:209], v35 offset:20512
  ds_read_b64_tr_b16 a[210:211], v35 offset:20640
  ds_read_b64_tr_b16 a[212:213], v35 offset:22560
  ds_read_b64_tr_b16 a[214:215], v35 offset:22688
  s_waitcnt lgkmcnt(0)
  s_cmp_lt_u32 s16, 2
  s_cbranch_scc1 NOV_1
  ds_read_b64_tr_b16 a[216:217], v34 offset:0
  ds_read_b64_tr_b16 a[218:219], v34 offset:192
  ds_read_b64_tr_b16 a[220:221], v34 offset:3072
  ds_read_b64_tr_b16 a[222:223], v34 offset:3264
  ds_read_b64_tr_b16 a[224:225], v34 offset:32
  ds_read_b64_tr_b16 a[226:227], v34 offset:224
  ds_read_b64_tr_b16 a[228:229], v34 offset:3104
  ds_read_b64_tr_b16 a[230:231], v34 offset:3296
  ds_read_b64_tr_b16 a[232:233], v34 offset:64
  ds_read_b64_tr_b16 a[234:235], v34 offset:256
  ds_read_b64_tr_b16 a[236:237], v34 offset:3136
  ds_read_b64_tr_b16 a[238:239], v34 offset:3328
  s_waitcnt lgkmcnt(0)
  ds_read_b64_tr_b16 a[240:241], v34 offset:6144
  ds_read_b64_tr_b16 a[242:243], v34 offset:6336
  ds_read_b64_tr_b16 a[244:245], v34 offset:9216
  ds_read_b64_tr_b16 a[246:247], v34 offset:9408
  ds_read_b64_tr_b16 a[248:249], v34 offset:6176
  ds_read_b64_tr_b16 a[250:251], v34 offset:6368
  ds_read_b64_tr_b16 a[252:253], v34 offset:9248
  ds_read_b64_tr_b16 a[254:255], v34 offset:9440
  ds_read_b64_tr_b16 v[176:177], v34 offset:6208
  ds_read_b64_tr_b16 v[178:179], v34 offset:6400
  ds_read_b64_tr_b16 v[180:181], v34 offset:9280
  ds_read_b64_tr_b16 v[182:183], v34 offset:9472
  s_waitcnt lgkmcnt(0)
  ds_read_b64_tr_b16 v[184:185], v34 offset:12288
  ds_read_b64_tr_b16 v[186:187], v34 offset:12480
  ds_read_b64_tr_b16 v[188:189], v34 offset:15360
  ds_read_b64_tr_b16 v[190:191], v34 offset:15552
  ds_read_b64_tr_b16 v[192:193], v34 offset:12320
  ds_read_b64_tr_b16 v[194:195], v34 offset:12512
  ds_read_b64_tr_b16 v[196:197], v34 offset:15392
  ds_read_b64_tr_b16 v[198:199], v34 offset:15584
  ds_read_b64_tr_b16 v[200:201], v34 offset:12352
  ds_read_b64_tr_b16 v[202:203], v34 offset:12544
  ds_read_b64_tr_b16 v[204:205], v34 offset:15424
  ds_read_b64_tr_b16 v[206:207], v34 offset:15616
  s_waitcnt lgkmcnt(0)
  ds_read_b64_tr_b16 v[208:209], v34 offset:18432
  ds_read_b64_tr_b16 v[210:211], v34 offset:18624
  ds_read_b64_tr_b16 v[212:213], v34 offset:21504
  ds_read_b64_tr_b16 v[214:215], v34 offset:21696
  ds_read_b64_tr_b16 v[216:217], v34 offset:18464
  ds_read_b64_tr_b16 v[218:219], v34 offset:18656
  ds_read_b64_tr_b16 v[220:221], v34 offset:21536
  ds_read_b64_tr_b16 v[222:223], v34 offset:21728
  ds_read_b64_tr_b16 v[224:225], v34 offset:18496
  ds_read_b64_tr_b16 v[226:227], v34 offset:18688
  ds_read_b64_tr_b16 v[228:229], v34 offset:21568
  ds_read_b64_tr_b16 v[230:231], v34 offset:21760
  s_waitcnt lgkmcnt(0)
  ds_read_b64_tr_b16 v[232:233], v34 offset:24576
  ds_read_b64_tr_b16 v[234:235], v34 offset:24768
  ds_read_b64_tr_b16 v[236:237], v34 offset:27648
  ds_read_b64_tr_b16 v[238:239], v34 offset:27840
  ds_read_b64_tr_b16 v[240:241], v34 offset:24608
  ds_read_b64_tr_b16 v[242:243], v34 offset:24800
  ds_read_b64_tr_b16 v[244:245], v34 offset:27680
  ds_read_b64_tr_b16 v[246:247], v34 offset:27872
  ds_read_b64_tr_b16 v[248:249], v34 offset:24640
  ds_read_b64_tr_b16 v[250:251], v34 offset:24832
  ds_read_b64_tr_b16 v[252:253], v34 offset:27712
  ds_read_b64_tr_b16 v[254:255], v34 offset:27904
  s_waitcnt lgkmcnt(0)
NOV_1:
  s_barrier
  v_lshlrev_b32 v2, 4, v1
  v_lshlrev_b32 v18, 3, v1
  v_mul_u32_u24 v19, 12, v1
  v_and_b32 v30, 15, v1
  v_lshrrev_b32 v31, 4, v1
  v_mov_b32 v3, 0x44444444
  v_mov_b32 v32, 0xeeeeeeee
  v_cmp_gt_u32 vcc, 8, v30
  s_mov_b64 s[42:43], vcc
  v_cndmask_b32 v3, v32, v3, vcc
  s_not_b64 s[48:49], vcc
  v_cmp_gt_u32 vcc, 32, v1
  s_mov_b64 s[40:41], vcc
  s_mov_b64 s[52:53], vcc
  s_not_b64 s[46:47], vcc
  s_and_b64 s[50:51], s[48:49], vcc
  s_mov_b64 s[44:45], s[42:43]
  v_mov_b32 v170, -1
  v_mov_b32 v171, -1
  v_mov_b32 v172, -1
  v_mov_b32 v173, -1
  s_and_b32 s57, s16, 1
  s_mul_i32 s58, s57, 5120
  v_add_u32 v4, s58, v2
  v_add_u32 v174, 0x1000, v4
  s_mul_i32 s58, s16, 6144
  v_add_u32 v7, s58, v2
  v_add_u32 v175, 0x1000, v7
  v_and_b32 v34, 1, v31
  v_lshlrev_b32 v32, 2, v34
  v_lshrrev_b32 v36, 1, v31
  v_add_u32 v32, v32, v36
  v_mul_u32_u24 v35, 144, v32
  s_lshr_b32 s58, s16, 1
  s_lshl_b32 s58, s58, 3
  v_add_u32 v32, s58, v32
  v_mul_u32_u24 v32, 208, v32
  v_lshlrev_b32 v33, 2, v30
  s_and_b32 s58, s16, 1
  s_mul_i32 s58, s58, 3328
  s_add_u32 s58, s58, 0
  v_add3_u32 v5, v32, v33, s58
  s_mul_i32 s58, s16, 1152
  s_add_u32 s58, s58, 16384
  v_add3_u32 v6, v35, v33, s58
  v_mul_u32_u24 v32, 208, v30
  v_lshrrev_b32 v33, 1, v31
  v_lshlrev_b32 v33, 6, v33
  v_and_b32 v34, 1, v31
  v_lshlrev_b32 v35, 4, v34
  v_add3_u32 v8, v32, v33, v35
  v_lshlrev_b32 v32, 7, v31
  v_lshlrev_b32 v33, 4, v30
  v_add_u32 v9, v32, v33
  v_and_b32 v36, 7, v1
  v_bfe_u32 v37, v1, 3, 1
  v_lshlrev_b32 v32, 9, v37
  v_lshlrev_b32 v33, 7, v31
  v_lshlrev_b32 v35, 4, v36
  v_add3_u32 v10, v32, v33, v35
  v_mul_u32_u24 v32, 3072, v37
  v_lshlrev_b32 v33, 7, v34
  v_add3_u32 v32, v32, v33, v35
  v_add_u32 v11, 1280, v32
  s_mul_i32 s57, s36, 768
  v_lshrrev_b32 v32, 1, v31
  v_lshlrev_b32 v32, 8, v32
  v_lshlrev_b32 v33, 7, v34
  v_add3_u32 v32, v32, v33, v35
  v_add_u32 v12, s57, v32
  v_add3_u32 v32, v33, v35, s57
  v_add_u32 v13, 512, v32
  v_lshlrev_b32 v32, 8, v34
  v_lshlrev_b32 v33, 4, v30
  v_add_u32 v32, v32, v33
  s_and_b32 s58, s16, 1
  s_mul_i32 s58, s58, 1536
  v_lshrrev_b32 v33, 1, v31
  v_lshlrev_b32 v33, 3, v33
  v_add_u32 v33, s58, v33
  s_lshr_b32 s58, s16, 1
  v_mul_lo_u32 v33, v33, s58
  v_add_u32 v32, v32, v33
  v_lshlrev_b32 v33, 4, v30
  v_add_u32 v14, 8192, v32
  v_lshlrev_b32 v32, 3, v34
  v_add3_u32 v15, v32, v33, s57
  v_lshrrev_b32 v32, 1, v31
  v_lshlrev_b32 v32, 7, v32
  v_lshlrev_b32 v33, 3, v34
  v_add3_u32 v32, v32, v33, v35
  s_mul_i32 s57, s18, 768
  v_add_u32 v16, s57, v32
  v_bfe_u32 v32, v1, 1, 3
  v_mul_u32_u24 v32, 144, v32
  v_lshlrev_b32 v33, 5, v31
  v_and_b32 v34, 1, v1
  v_lshlrev_b32 v34, 4, v34
  v_add3_u32 v32, v32, v33, v34
  v_add_u32 v17, 16384, v32
  s_cmp_ge_u32 s16, 2
  s_cbranch_scc1 WEC_2
  v_add_u32 v179, 3072, v10
  v_lshlrev_b32 v240, 9, v1
  v_lshrrev_b32 v32, 3, v30
  v_lshlrev_b32 v32, 4, v32
  v_bfe_u32 v33, v30, 2, 1
  v_lshlrev_b32 v33, 2, v33
  v_and_b32 v34, 3, v30
  v_add3_u32 v32, v32, v33, v34
  v_lshlrev_b32 v32, 4, v32
  v_and_b32 v33, 1, v31
  v_lshlrev_b32 v33, 9, v33
  v_add_u32 v32, v32, v33
  s_mul_i32 s57, s36, 3072
  s_add_u32 s58, s57, 2048
  v_add_u32 v177, s58, v32
  v_lshrrev_b32 v34, 1, v31
  v_lshlrev_b32 v34, 10, v34
  v_add3_u32 v176, v32, v34, s57
  v_lshlrev_b32 v32, 4, v30
  v_add3_u32 v178, v32, v33, v34
WEC_2:
  s_mov_b32 s8, s90
  s_mov_b32 s9, s91
  s_mov_b32 s10, 10240
  s_mov_b32 s11, 0x00020000
  s_cmp_eq_u32 s68, 1
  s_cbranch_scc0 CH_SLOW
  s_lshl_b32 s59, s17, 5
  s_add_u32 s59, s59, s18
  s_mul_i32 s22, s59, 1536
  s_mul_i32 s34, s36, 1536
  s_sub_u32 s23, s22, s34
  s_xor_b32 s24, s22, 262144
  s_mul_i32 s59, s17, 24576
  s_add_u32 s25, s59, 524288
  s_mul_i32 s33, s18, 768
  s_add_u32 s26, s25, s33
  s_xor_b32 s26, s26, 131072
  s_mul_i32 s59, s17, 10240
  s_add_u32 s30, s59, 786432
  s_lshl_b32 s59, s18, 12
  s_add_u32 s27, s59, 1048576
  s_lshl_b32 s31, s17, 10
  s_add_u32 s27, s27, s31
  s_add_u32 s28, s59, 1048576
  s_mov_b32 s29, 0
  s_mul_i32 s32, s35, 3072
  s_mov_b32 s38, 24576
  s_mov_b32 s37, 31744
  s_mov_b32 s20, 0
  s_cmp_eq_u32 s16, 1
  s_cbranch_scc0 CH_3_pf
  s_mov_b32 s57, 1835008
  s_mov_b32 s58, 96
  v_mov_b32 v135, 0
CH_3_k0l:
  buffer_load_dword v134, v135, s[4:7], s57 offen sc1
  s_add_u32 s21, s21, 1
  s_waitcnt vmcnt(0)
  v_cmp_gt_u32 vcc, s58, v134
  s_cbranch_vccz CH_3_k0d
  s_sleep 2
  s_cmp_lt_u32 s21, 400000
  s_cbranch_scc1 CH_3_k0l
CH_3_k0d:
  s_mov_b32 s33, 0
  s_lshl_b32 s33, s33, 5
  s_add_u32 s33, s33, s35
  s_mul_i32 s33, s33, 12288
  s_add_u32 s57, s33, 27262976
  s_add_u32 s58, s57, 128
  s_mov_b32 m0, s38
  s_add_u32 s33, s33, 52428800
  buffer_load_dwordx4 v176, s[4:7], s57 offen lds
  s_add_u32 m0, s38, 1024
  s_nop 0
  buffer_load_dwordx4 v177, s[4:7], s57 offen lds
  s_add_u32 m0, s38, 2048
  s_nop 0
  buffer_load_dwordx4 v176, s[4:7], s58 offen lds
  s_add_u32 m0, s38, 3072
  s_nop 0
  buffer_load_dwordx4 v177, s[4:7], s58 offen lds
  s_mul_i32 s57, s36, 48
  s_add_u32 s57, s57, 0
  s_lshr_b32 s58, s57, 5
  s_lshl_b32 s58, s58, 11
  s_and_b32 s57, s57, 31
  s_lshl_b32 s57, s57, 4
  s_add_u32 s57, s57, s58
  s_add_u32 s57, s57, s33
  s_add_u32 m0, s38, 4096
  s_nop 0
  buffer_load_dwordx4 v178, s[4:7], s57 offen lds
  s_mul_i32 s57, s36, 48
  s_add_u32 s57, s57, 16
  s_lshr_b32 s58, s57, 5
  s_lshl_b32 s58, s58, 11
  s_and_b32 s57, s57, 31
  s_lshl_b32 s57, s57, 4
  s_add_u32 s57, s57, s58
  s_add_u32 s57, s57, s33
  s_add_u32 m0, s38, 5120
  s_nop 0
  buffer_load_dwordx4 v178, s[4:7], s57 offen lds
  s_mul_i32 s57, s36, 48
  s_add_u32 s57, s57, 32
  s_lshr_b32 s58, s57, 5
  s_lshl_b32 s58, s58, 11
  s_and_b32 s57, s57, 31
  s_lshl_b32 s57, s57, 4
  s_add_u32 s57, s57, s58
  s_add_u32 s57, s57, s33
  s_add_u32 m0, s38, 6144
  s_nop 0
  buffer_load_dwordx4 v178, s[4:7], s57 offen lds
  s_mov_b32 s38, 31744
  s_mov_b32 s33, 1
  s_lshl_b32 s33, s33, 5
  s_add_u32 s33, s33, s35
  s_mul_i32 s33, s33, 12288
  s_add_u32 s57, s33, 27262976
  s_add_u32 s58, s57, 128
  s_mov_b32 m0, s38
  s_add_u32 s33, s33, 52428800
  buffer_load_dwordx4 v176, s[4:7], s57 offen lds
  s_add_u32 m0, s38, 1024
  s_nop 0
  buffer_load_dwordx4 v177, s[4:7], s57 offen lds
  s_add_u32 m0, s38, 2048
  s_nop 0
  buffer_load_dwordx4 v176, s[4:7], s58 offen lds
  s_add_u32 m0, s38, 3072
  s_nop 0
  buffer_load_dwordx4 v177, s[4:7], s58 offen lds
  s_mul_i32 s57, s36, 48
  s_add_u32 s57, s57, 0
  s_lshr_b32 s58, s57, 5
  s_lshl_b32 s58, s58, 11
  s_and_b32 s57, s57, 31
  s_lshl_b32 s57, s57, 4
  s_add_u32 s57, s57, s58
  s_add_u32 s57, s57, s33
  s_add_u32 m0, s38, 4096
  s_nop 0
  buffer_load_dwordx4 v178, s[4:7], s57 offen lds
  s_mul_i32 s57, s36, 48
  s_add_u32 s57, s57, 16
  s_lshr_b32 s58, s57, 5
  s_lshl_b32 s58, s58, 11
  s_and_b32 s57, s57, 31
  s_lshl_b32 s57, s57, 4
  s_add_u32 s57, s57, s58
  s_add_u32 s57, s57, s33
  s_add_u32 m0, s38, 5120
  s_nop 0
  buffer_load_dwordx4 v178, s[4:7], s57 offen lds
  s_mul_i32 s57, s36, 48
  s_add_u32 s57, s57, 32
  s_lshr_b32 s58, s57, 5
  s_lshl_b32 s58, s58, 11
  s_and_b32 s57, s57, 31
  s_lshl_b32 s57, s57, 4
  s_add_u32 s57, s57, s58
  s_add_u32 s57, s57, s33
  s_add_u32 m0, s38, 6144
  s_nop 0
  buffer_load_dwordx4 v178, s[4:7], s57 offen lds
  s_mov_b32 s38, 24576
  s_waitcnt vmcnt(0) lgkmcnt(0)
CH_3_pf:
  s_barrier
  s_cmp_eq_u32 s16, 0
  s_cbranch_scc0 CH_3_nk0
  s_mov_b32 s57, 24576
  v_add_u32 v104, s57, v2
  ds_read_b128 v[136:139], v104 offset:0
  ds_read_b128 v[140:143], v104 offset:1024
  ds_read_b128 v[144:147], v104 offset:2048
  ds_read_b128 v[148:151], v104 offset:3072
  ds_read_b128 v[152:155], v104 offset:4096
  ds_read_b128 v[156:159], v104 offset:5120
  ds_read_b128 v[160:163], v104 offset:6144
CH_3_nk0:
  v_mov_b32 v40, 0
  v_mov_b32 v41, 0
  v_mov_b32 v42, 0
  v_mov_b32 v43, 0
  v_mov_b32 v44, 0
  v_mov_b32 v45, 0
  v_mov_b32 v46, 0
  v_mov_b32 v47, 0
  v_mov_b32 v48, 0
  v_mov_b32 v49, 0
  v_mov_b32 v50, 0
  v_mov_b32 v51, 0
  v_mov_b32 v52, 0
  v_mov_b32 v53, 0
  v_mov_b32 v54, 0
  v_mov_b32 v55, 0
  v_mov_b32 v56, 0
  v_mov_b32 v57, 0
  v_mov_b32 v58, 0
  v_mov_b32 v59, 0
  v_mov_b32 v60, 0
  v_mov_b32 v61, 0
  v_mov_b32 v62, 0
  v_mov_b32 v63, 0
  v_and_b32 v105, 7, v1
  v_mul_u32_u24 v105, 1280, v105
  v_lshrrev_b32 v106, 3, v1
  v_lshlrev_b32 v106, 4, v106
  s_and_b32 s57, s16, 1
  s_mul_i32 s57, s57, 640
  v_add3_u32 v105, v105, v106, s57
  buffer_load_dwordx4 v[20:23], v105, s[8:11], 0 offen offset:0
  buffer_load_dwordx4 v[24:27], v105, s[8:11], 0 offen offset:128
  buffer_load_dwordx4 v[28:31], v105, s[8:11], 0 offen offset:256
  buffer_load_dwordx4 v[32:35], v105, s[8:11], 0 offen offset:384
  buffer_load_dwordx4 v[36:39], v105, s[8:11], 0 offen offset:512
  s_xor_b32 s30, s30, 65536
  s_waitcnt vmcnt(0) lgkmcnt(0)
  v_smfmac_f32_16x16x64_bf16 v[40:43], v[20:23], a[0:7], v3
  v_smfmac_f32_16x16x64_bf16 v[44:47], v[20:23], a[8:15], v3
  v_smfmac_f32_16x16x64_bf16 v[48:51], v[20:23], a[16:23], v3
  v_smfmac_f32_16x16x64_bf16 v[40:43], v[24:27], a[24:31], v3
  v_smfmac_f32_16x16x64_bf16 v[44:47], v[24:27], a[32:39], v3
  v_smfmac_f32_16x16x64_bf16 v[48:51], v[24:27], a[40:47], v3
  v_smfmac_f32_16x16x64_bf16 v[40:43], v[28:31], a[48:55], v3
  v_smfmac_f32_16x16x64_bf16 v[44:47], v[28:31], a[56:63], v3
  v_smfmac_f32_16x16x64_bf16 v[48:51], v[28:31], a[64:71], v3
  v_smfmac_f32_16x16x64_bf16 v[40:43], v[32:35], a[72:79], v3
  v_smfmac_f32_16x16x64_bf16 v[44:47], v[32:35], a[80:87], v3
  v_smfmac_f32_16x16x64_bf16 v[48:51], v[32:35], a[88:95], v3
  v_smfmac_f32_16x16x64_bf16 v[40:43], v[36:39], a[96:103], v3
  v_smfmac_f32_16x16x64_bf16 v[44:47], v[36:39], a[104:111], v3
  v_smfmac_f32_16x16x64_bf16 v[48:51], v[36:39], a[112:119], v3
  s_branch CH_3_qd
CH_3_loop:
  s_mov_b32 s59, s30
  buffer_load_dwordx4 v[20:23], v4, s[4:7], s59 offen offset:0 sc1
  buffer_load_dwordx4 v[24:27], v4, s[4:7], s59 offen offset:1024 sc1
  buffer_load_dwordx4 v[28:31], v4, s[4:7], s59 offen offset:2048 sc1
  buffer_load_dwordx4 v[32:35], v4, s[4:7], s59 offen offset:3072 sc1
  buffer_load_dwordx4 v[36:39], v174, s[4:7], s59 offen sc1
  s_xor_b32 s30, s30, 65536
  s_add_u32 s20, s20, 1
  s_xor_b32 s22, s22, 262144
  s_xor_b32 s23, s23, 262144
  s_xor_b32 s24, s24, 262144
  s_xor_b32 s25, s25, 131072
  s_xor_b32 s26, s26, 131072
  s_xor_b32 s29, s29, 81920
  s_add_u32 s32, s32, 98304
  s_xor_b32 s37, s37, 0x1c00
  s_xor_b32 s38, s38, 0x1c00
CH_3D_L0:
  s_waitcnt vmcnt(4)
  v_max_u32 v135, v20, v22
  v_cmp_eq_u32 vcc, -1, v135
  s_cbranch_vccnz CH_3D_R0
CH_3D_S0:
  v_smfmac_f32_16x16x64_bf16 v[40:43], v[20:23], a[0:7], v3
  v_smfmac_f32_16x16x64_bf16 v[44:47], v[20:23], a[8:15], v3
  v_smfmac_f32_16x16x64_bf16 v[48:51], v[20:23], a[16:23], v3
CH_3D_L1:
  s_waitcnt vmcnt(3)
  v_max_u32 v135, v24, v26
  v_cmp_eq_u32 vcc, -1, v135
  s_cbranch_vccnz CH_3D_R1
CH_3D_S1:
  v_smfmac_f32_16x16x64_bf16 v[40:43], v[24:27], a[24:31], v3
  v_smfmac_f32_16x16x64_bf16 v[44:47], v[24:27], a[32:39], v3
  v_smfmac_f32_16x16x64_bf16 v[48:51], v[24:27], a[40:47], v3
CH_3D_L2:
  s_waitcnt vmcnt(2)
  v_max_u32 v135, v28, v30
  v_cmp_eq_u32 vcc, -1, v135
  s_cbranch_vccnz CH_3D_R2
CH_3D_S2:
  v_smfmac_f32_16x16x64_bf16 v[40:43], v[28:31], a[48:55], v3
  v_smfmac_f32_16x16x64_bf16 v[44:47], v[28:31], a[56:63], v3
  v_smfmac_f32_16x16x64_bf16 v[48:51], v[28:31], a[64:71], v3
CH_3D_L3:
  s_waitcnt vmcnt(1)
  v_max_u32 v135, v32, v34
  v_cmp_eq_u32 vcc, -1, v135
  s_cbranch_vccnz CH_3D_R3
CH_3D_S3:
  v_smfmac_f32_16x16x64_bf16 v[40:43], v[32:35], a[72:79], v3
  v_smfmac_f32_16x16x64_bf16 v[44:47], v[32:35], a[80:87], v3
  v_smfmac_f32_16x16x64_bf16 v[48:51], v[32:35], a[88:95], v3
CH_3D_L4:
  s_waitcnt vmcnt(0)
  v_max_u32 v135, v36, v38
  v_cmp_eq_u32 vcc, -1, v135
  s_cbranch_vccnz CH_3D_R4
CH_3D_S4:
  v_smfmac_f32_16x16x64_bf16 v[40:43], v[36:39], a[96:103], v3
  v_smfmac_f32_16x16x64_bf16 v[44:47], v[36:39], a[104:111], v3
  v_smfmac_f32_16x16x64_bf16 v[48:51], v[36:39], a[112:119], v3
CH_3_qd:
  s_nop 5
  v_permlane32_swap_b32 v40, v41
  v_permlane32_swap_b32 v42, v43
  v_add_f32 v40, v40, v41
  v_add_f32 v42, v42, v43
  ds_write_b32 v5, v40 offset:0
  ds_write_b32 v5, v42 offset:416
  v_permlane32_swap_b32 v44, v45
  v_permlane32_swap_b32 v46, v47
  v_add_f32 v44, v44, v45
  v_add_f32 v46, v46, v47
  ds_write_b32 v5, v44 offset:64
  ds_write_b32 v5, v46 offset:480
  v_permlane32_swap_b32 v48, v49
  v_permlane32_swap_b32 v50, v51
  v_add_f32 v48, v48, v49
  v_add_f32 v50, v50, v51
  ds_write_b32 v5, v48 offset:128
  ds_write_b32 v5, v50 offset:544
  s_waitcnt lgkmcnt(0)
  s_barrier
  s_cmp_eq_u32 s16, 0
  s_cbranch_scc1 CH_3_w0a
  s_cmp_eq_u32 s16, 1
  s_cbranch_scc1 CH_3_w1a
  v_smfmac_f32_16x16x64_bf16 v[52:55], v[20:23], a[216:223], v3
  v_smfmac_f32_16x16x64_bf16 v[56:59], v[20:23], a[224:231], v3
  v_smfmac_f32_16x16x64_bf16 v[60:63], v[20:23], a[232:239], v3
  v_smfmac_f32_16x16x64_bf16 v[52:55], v[24:27], a[240:247], v3
  v_smfmac_f32_16x16x64_bf16 v[56:59], v[24:27], a[248:255], v3
  v_smfmac_f32_16x16x64_bf16 v[60:63], v[24:27], v[176:183], v3
  v_smfmac_f32_16x16x64_bf16 v[52:55], v[28:31], v[184:191], v3
  v_smfmac_f32_16x16x64_bf16 v[56:59], v[28:31], v[192:199], v3
  v_smfmac_f32_16x16x64_bf16 v[60:63], v[28:31], v[200:207], v3
  v_smfmac_f32_16x16x64_bf16 v[52:55], v[32:35], v[208:215], v3
  v_smfmac_f32_16x16x64_bf16 v[56:59], v[32:35], v[216:223], v3
  v_smfmac_f32_16x16x64_bf16 v[60:63], v[32:35], v[224:231], v3
  v_smfmac_f32_16x16x64_bf16 v[52:55], v[36:39], v[232:239], v3
  v_smfmac_f32_16x16x64_bf16 v[56:59], v[36:39], v[240:247], v3
  v_smfmac_f32_16x16x64_bf16 v[60:63], v[36:39], v[248:255], v3
  s_nop 5
  v_permlane32_swap_b32 v52, v54
  v_permlane32_swap_b32 v53, v55
  v_add_f32 v52, v52, v54
  v_add_f32 v53, v53, v55
  ds_write_b64 v14, v[52:53] offset:0
  v_permlane32_swap_b32 v56, v58
  v_permlane32_swap_b32 v57, v59
  v_add_f32 v56, v56, v58
  v_add_f32 v57, v57, v59
  ds_write_b64 v14, v[56:57] offset:512
  v_permlane32_swap_b32 v60, v62
  v_permlane32_swap_b32 v61, v63
  v_add_f32 v60, v60, v62
  v_add_f32 v61, v61, v63
  ds_write_b64 v14, v[60:61] offset:1024
  v_mov_b32 v52, 0
  v_mov_b32 v53, 0
  v_mov_b32 v54, 0
  v_mov_b32 v55, 0
  v_mov_b32 v56, 0
  v_mov_b32 v57, 0
  v_mov_b32 v58, 0
  v_mov_b32 v59, 0
  v_mov_b32 v60, 0
  v_mov_b32 v61, 0
  v_mov_b32 v62, 0
  v_mov_b32 v63, 0
  s_waitcnt lgkmcnt(0)
  s_branch CH_3_b2
CH_3_w1a:
  buffer_store_dwordx4 v[170:173], v2, s[4:7], s24 offen
  buffer_store_dwordx2 v[170:171], v18, s[4:7], s24 offen offset:1024
  buffer_store_dwordx3 v[170:172], v19, s[4:7], s26 offen
  ds_read_b128 v[104:107], v8 offset:0
  ds_read_b128 v[108:111], v8 offset:3328
  ds_read_b128 v[112:115], v8 offset:32
  ds_read_b128 v[116:119], v8 offset:3360
  ds_read_b128 v[120:123], v8 offset:128
  ds_read_b128 v[124:127], v8 offset:3456
  ds_read_b128 v[128:131], v8 offset:160
  ds_read_b128 v[132:135], v8 offset:3488
  s_waitcnt lgkmcnt(6)
  v_add_f32 v104, v104, v108
  v_add_f32 v105, v105, v109
  v_add_f32 v106, v106, v110
  v_add_f32 v107, v107, v111
  v_cvt_pk_bf16_f32 v96, v104, v105
  v_cvt_pk_bf16_f32 v97, v106, v107
  s_waitcnt lgkmcnt(4)
  v_add_f32 v112, v112, v116
  v_add_f32 v113, v113, v117
  v_add_f32 v114, v114, v118
  v_add_f32 v115, v115, v119
  v_cvt_pk_bf16_f32 v98, v112, v113
  v_cvt_pk_bf16_f32 v99, v114, v115
  s_waitcnt lgkmcnt(2)
  v_add_f32 v120, v120, v124
  v_add_f32 v121, v121, v125
  v_add_f32 v122, v122, v126
  v_add_f32 v123, v123, v127
  v_cvt_pk_bf16_f32 v100, v120, v121
  v_cvt_pk_bf16_f32 v101, v122, v123
  s_waitcnt lgkmcnt(0)
  v_add_f32 v128, v128, v132
  v_add_f32 v129, v129, v133
  v_add_f32 v130, v130, v134
  v_add_f32 v131, v131, v135
  v_cvt_pk_bf16_f32 v102, v128, v129
  v_cvt_pk_bf16_f32 v103, v130, v131
  v_cndmask_b32 v100, 0, v100, s[40:41]
  v_cndmask_b32 v101, 0, v101, s[40:41]
  v_cndmask_b32 v102, 0, v102, s[40:41]
  v_cndmask_b32 v103, 0, v103, s[40:41]
  s_waitcnt vmcnt(0)
  s_branch CH_3_b2
CH_3_w0a:
  ds_read_b128 v[104:107], v8 offset:0
  ds_read_b128 v[108:111], v8 offset:3328
  ds_read_b128 v[112:115], v8 offset:32
  ds_read_b128 v[116:119], v8 offset:3360
  ds_read_b128 v[120:123], v8 offset:128
  ds_read_b128 v[124:127], v8 offset:3456
  ds_read_b128 v[128:131], v8 offset:160
  ds_read_b128 v[132:135], v8 offset:3488
  s_waitcnt lgkmcnt(6)
  v_add_f32 v104, v104, v108
  v_add_f32 v105, v105, v109
  v_add_f32 v106, v106, v110
  v_add_f32 v107, v107, v111
  v_cvt_pk_bf16_f32 v96, v104, v105
  v_cvt_pk_bf16_f32 v97, v106, v107
  s_waitcnt lgkmcnt(4)
  v_add_f32 v112, v112, v116
  v_add_f32 v113, v113, v117
  v_add_f32 v114, v114, v118
  v_add_f32 v115, v115, v119
  v_cvt_pk_bf16_f32 v98, v112, v113
  v_cvt_pk_bf16_f32 v99, v114, v115
  s_waitcnt lgkmcnt(2)
  v_add_f32 v120, v120, v124
  v_add_f32 v121, v121, v125
  v_add_f32 v122, v122, v126
  v_add_f32 v123, v123, v127
  v_cvt_pk_bf16_f32 v100, v120, v121
  v_cvt_pk_bf16_f32 v101, v122, v123
  s_waitcnt lgkmcnt(0)
  v_add_f32 v128, v128, v132
  v_add_f32 v129, v129, v133
  v_add_f32 v130, v130, v134
  v_add_f32 v131, v131, v135
  v_cvt_pk_bf16_f32 v102, v128, v129
  v_cvt_pk_bf16_f32 v103, v130, v131
  v_cndmask_b32 v100, 0, v100, s[40:41]
  v_cndmask_b32 v101, 0, v101, s[40:41]
  v_cndmask_b32 v102, 0, v102, s[40:41]
  v_cndmask_b32 v103, 0, v103, s[40:41]
  v_mfma_f32_16x16x32_bf16 v[108:111], v[136:139], v[96:99], 0
  v_mfma_f32_16x16x32_bf16 v[112:115], v[144:147], v[96:99], 0
  v_mfma_f32_16x16x32_bf16 v[104:107], v[96:99], v[96:99], 0
  v_mfma_f32_16x16x32_bf16 v[108:111], v[140:143], v[100:103], v[108:111]
  v_mfma_f32_16x16x32_bf16 v[112:115], v[148:151], v[100:103], v[112:115]
  v_mfma_f32_16x16x32_bf16 v[104:107], v[100:103], v[100:103], v[104:107]
  s_mov_b64 exec, s[42:43]
  s_nop 3
  buffer_store_dwordx4 v[108:111], v9, s[4:7], s22 offen
  s_nop 0
  buffer_store_dwordx4 v[112:115], v9, s[4:7], s22 offen offset:512
  s_nop 1
  buffer_store_dwordx4 v[104:107], v9, s[4:7], s22 offen offset:1024
  s_mov_b64 exec, -1
CH_3_b2:
  s_barrier
  s_cmp_eq_u32 s20, 63
  s_cbranch_scc1 CH_3_last
  s_cmp_eq_u32 s16, 0
  s_cbranch_scc1 CH_3_w0b
  s_cmp_eq_u32 s16, 1
  s_cbranch_scc0 CH_3_b3
  ds_read_b128 v[104:107], v14 offset:0
  ds_read_b128 v[108:111], v14 offset:1536
  ds_read_b128 v[112:115], v14 offset:512
  ds_read_b128 v[116:119], v14 offset:2048
  ds_read_b128 v[120:123], v14 offset:1024
  ds_read_b128 v[124:127], v14 offset:2560
  s_waitcnt lgkmcnt(4)
  v_add_f32 v104, v104, v108
  v_add_f32 v105, v105, v109
  v_add_f32 v106, v106, v110
  v_add_f32 v107, v107, v111
  v_cvt_pk_bf16_f32 v164, v104, v105
  v_cvt_pk_bf16_f32 v165, v106, v107
  s_waitcnt lgkmcnt(2)
  v_add_f32 v112, v112, v116
  v_add_f32 v113, v113, v117
  v_add_f32 v114, v114, v118
  v_add_f32 v115, v115, v119
  v_cvt_pk_bf16_f32 v166, v112, v113
  v_cvt_pk_bf16_f32 v167, v114, v115
  s_waitcnt lgkmcnt(0)
  v_add_f32 v120, v120, v124
  v_add_f32 v121, v121, v125
  v_add_f32 v122, v122, v126
  v_add_f32 v123, v123, v127
  v_cvt_pk_bf16_f32 v168, v120, v121
  v_cvt_pk_bf16_f32 v169, v122, v123
  s_branch CH_3_b3
CH_3_w0b:
  buffer_load_dwordx4 v[104:107], v10, s[4:7], s23 offen offset:0 sc1
  buffer_load_dwordx4 v[108:111], v10, s[4:7], s23 offen offset:1536 sc1
  buffer_load_dwordx4 v[112:115], v179, s[4:7], s23 offen offset:0 sc1
  buffer_load_dwordx4 v[116:119], v179, s[4:7], s23 offen offset:1536 sc1
  buffer_load_dwordx4 v[120:123], v11, s[4:7], s23 offen offset:0 sc1
  buffer_load_dwordx4 v[124:127], v11, s[4:7], s23 offen offset:1536 sc1
  ds_read_b128 v[64:67], v14 offset:0
  ds_read_b128 v[68:71], v14 offset:1536
  ds_read_b128 v[72:75], v14 offset:512
  ds_read_b128 v[76:79], v14 offset:2048
  ds_read_b128 v[80:83], v14 offset:1024
  ds_read_b128 v[84:87], v14 offset:2560
  s_waitcnt lgkmcnt(4)
  v_add_f32 v64, v64, v68
  v_add_f32 v65, v65, v69
  v_add_f32 v66, v66, v70
  v_add_f32 v67, v67, v71
  v_cvt_pk_bf16_f32 v164, v64, v65
  v_cvt_pk_bf16_f32 v165, v66, v67
  s_waitcnt lgkmcnt(2)
  v_add_f32 v72, v72, v76
  v_add_f32 v73, v73, v77
  v_add_f32 v74, v74, v78
  v_add_f32 v75, v75, v79
  v_cvt_pk_bf16_f32 v166, v72, v73
  v_cvt_pk_bf16_f32 v167, v74, v75
  s_waitcnt lgkmcnt(0)
  v_add_f32 v80, v80, v84
  v_add_f32 v81, v81, v85
  v_add_f32 v82, v82, v86
  v_add_f32 v83, v83, v87
  v_cvt_pk_bf16_f32 v168, v80, v81
  v_cvt_pk_bf16_f32 v169, v82, v83
CH_3_apl:
  s_waitcnt vmcnt(0)
  v_max3_u32 v128, v104, v108, v112
  v_max3_u32 v128, v128, v116, v120
  v_max_u32 v128, v128, v124
  v_cmp_eq_u32 vcc, -1, v128
  s_cbranch_vccnz CH_3_apr
CH_3_apd:
  v_add_f32 v120, v120, v124
  v_add_f32 v121, v121, v125
  v_add_f32 v122, v122, v126
  v_add_f32 v123, v123, v127
  v_add_f32 v104, v104, v108
  v_add_f32 v105, v105, v109
  v_add_f32 v106, v106, v110
  v_add_f32 v107, v107, v111
  v_add_f32_dpp v124, v120, v120 row_ror:8 row_mask:0xf bank_mask:0xf
  v_add_f32_dpp v125, v121, v121 row_ror:8 row_mask:0xf bank_mask:0xf
  v_add_f32_dpp v126, v122, v122 row_ror:8 row_mask:0xf bank_mask:0xf
  v_add_f32_dpp v127, v123, v123 row_ror:8 row_mask:0xf bank_mask:0xf
  v_add_f32 v112, v112, v116
  v_add_f32 v113, v113, v117
  v_add_f32 v114, v114, v118
  v_add_f32 v115, v115, v119
  v_add_f32 v104, v104, v112
  v_add_f32 v105, v105, v113
  v_add_f32 v106, v106, v114
  v_add_f32 v107, v107, v115
  v_max3_f32 v128, v124, v125, v126
  v_max3_f32 v128, v128, v127, v104
  v_max3_f32 v128, v128, v105, v106
  v_max_f32 v128, v128, v107
  s_mov_b32 s57, 0x3dd53b95
  s_nop 0
  v_max_f32_dpp v128, v128, v128 row_ror:8 row_mask:0xf bank_mask:0xf
  v_mov_b32 v129, v128
  s_nop 1
  v_permlane16_swap_b32 v128, v129
  v_max_f32 v128, v128, v129
  v_mov_b32 v129, v128
  s_nop 1
  v_permlane32_swap_b32 v128, v129
  v_max_f32 v128, v128, v129
  v_mul_f32 v128, s57, v128
  v_fma_f32 v104, v104, s57, -v128
  v_fma_f32 v105, v105, s57, -v128
  v_fma_f32 v106, v106, s57, -v128
  v_fma_f32 v107, v107, s57, -v128
  v_fma_f32 v124, v124, s57, -v128
  v_fma_f32 v125, v125, s57, -v128
  v_fma_f32 v126, v126, s57, -v128
  v_fma_f32 v127, v127, s57, -v128
  v_exp_f32 v104, v104
  v_exp_f32 v105, v105
  v_exp_f32 v106, v106
  v_exp_f32 v107, v107
  v_exp_f32 v124, v124
  v_exp_f32 v125, v125
  v_exp_f32 v126, v126
  v_exp_f32 v127, v127
  v_mov_b32 v116, 0x3f803f80
  v_mov_b32 v117, 0x3f803f80
  v_cvt_pk_bf16_f32 v134, v104, v105
  v_cvt_pk_bf16_f32 v135, v106, v107
  v_cvt_pk_bf16_f32 v130, v124, v125
  v_cvt_pk_bf16_f32 v131, v126, v127
  v_mov_b32 v132, v134
  v_mov_b32 v133, v135
  v_mov_b32 v118, 0x3f803f80
  v_mov_b32_dpp v132, v134 row_ror:8 row_mask:0xf bank_mask:0xc
  v_mov_b32_dpp v133, v135 row_ror:8 row_mask:0xf bank_mask:0xc
  v_cndmask_b32 v130, 0, v130, s[46:47]
  v_cndmask_b32 v131, 0, v131, s[46:47]
  v_mov_b32_dpp v134, v134 row_ror:8 row_mask:0xf bank_mask:0x3
  v_mov_b32_dpp v135, v135 row_ror:8 row_mask:0xf bank_mask:0x3
  v_mov_b32 v119, 0x3f803f80
  s_nop 1
  v_mfma_f32_16x16x32_bf16 v[120:123], v[116:119], v[132:135], 0
  v_mfma_f32_16x16x32_bf16 v[96:99], v[152:155], v[132:135], 0
  v_mfma_f32_16x16x32_bf16 v[100:103], v[156:159], v[132:135], 0
  v_mfma_f32_16x16x16_bf16 v[120:123], v[116:117], v[130:131], v[120:123]
  v_mfma_f32_16x16x32_bf16 v[104:107], v[160:163], v[132:135], 0
  v_mfma_f32_16x16x16_bf16 v[96:99], v[164:165], v[130:131], v[96:99]
  v_mfma_f32_16x16x16_bf16 v[100:103], v[166:167], v[130:131], v[100:103]
  s_nop 1
  v_rcp_f32 v120, v120
  v_mfma_f32_16x16x16_bf16 v[104:107], v[168:169], v[130:131], v[104:107]
  s_nop 1
  s_mov_b64 exec, s[44:45]
  v_mul_f32 v96, v96, v120
  v_mul_f32 v97, v97, v120
  v_mul_f32 v98, v98, v120
  v_mul_f32 v99, v99, v120
  v_cvt_pk_bf16_f32 v108, v96, v97
  v_cvt_pk_bf16_f32 v109, v98, v99
  buffer_store_dwordx2 v[108:109], v16, s[4:7], s25 offen offset:0
  s_nop 0
  v_mul_f32 v100, v100, v120
  v_mul_f32 v101, v101, v120
  v_mul_f32 v102, v102, v120
  v_mul_f32 v103, v103, v120
  v_cvt_pk_bf16_f32 v110, v100, v101
  v_cvt_pk_bf16_f32 v111, v102, v103
  buffer_store_dwordx2 v[110:111], v16, s[4:7], s25 offen offset:256
  s_nop 0
  v_mul_f32 v104, v104, v120
  v_mul_f32 v105, v105, v120
  v_mul_f32 v106, v106, v120
  v_mul_f32 v107, v107, v120
  v_cvt_pk_bf16_f32 v112, v104, v105
  v_cvt_pk_bf16_f32 v113, v106, v107
  buffer_store_dwordx2 v[112:113], v16, s[4:7], s25 offen offset:512
  s_mov_b64 exec, -1
CH_3_b3:
  s_barrier
  s_cmp_ge_u32 s18, 20
  s_cbranch_scc1 CH_3_nb
  buffer_load_dwordx4 v[64:67], v7, s[4:7], s25 offen offset:0 sc1
  buffer_load_dwordx4 v[68:71], v7, s[4:7], s25 offen offset:1024 sc1
  buffer_load_dwordx4 v[72:75], v7, s[4:7], s25 offen offset:2048 sc1
  buffer_load_dwordx4 v[76:79], v7, s[4:7], s25 offen offset:3072 sc1
  buffer_load_dwordx4 v[80:83], v175, s[4:7], s25 offen offset:0 sc1
  buffer_load_dwordx4 v[84:87], v175, s[4:7], s25 offen offset:1024 sc1
  v_mov_b32 v88, 0
  v_mov_b32 v89, 0
  v_mov_b32 v90, 0
  v_mov_b32 v91, 0
  v_mov_b32 v92, 0
  v_mov_b32 v93, 0
  v_mov_b32 v94, 0
  v_mov_b32 v95, 0
CH_3B_L0:
  s_waitcnt vmcnt(5)
  v_max_u32 v135, v64, v66
  v_cmp_eq_u32 vcc, -1, v135
  s_cbranch_vccnz CH_3B_R0
CH_3B_S0:
  v_smfmac_f32_16x16x64_bf16 v[88:91], v[64:67], a[120:127], v3
  v_smfmac_f32_16x16x64_bf16 v[92:95], v[64:67], a[128:135], v3
CH_3B_L1:
  s_waitcnt vmcnt(4)
  v_max_u32 v135, v68, v70
  v_cmp_eq_u32 vcc, -1, v135
  s_cbranch_vccnz CH_3B_R1
CH_3B_S1:
  v_smfmac_f32_16x16x64_bf16 v[88:91], v[68:71], a[136:143], v3
  v_smfmac_f32_16x16x64_bf16 v[92:95], v[68:71], a[144:151], v3
CH_3B_L2:
  s_waitcnt vmcnt(3)
  v_max_u32 v135, v72, v74
  v_cmp_eq_u32 vcc, -1, v135
  s_cbranch_vccnz CH_3B_R2
CH_3B_S2:
  v_smfmac_f32_16x16x64_bf16 v[88:91], v[72:75], a[152:159], v3
  v_smfmac_f32_16x16x64_bf16 v[92:95], v[72:75], a[160:167], v3
CH_3B_L3:
  s_waitcnt vmcnt(2)
  v_max_u32 v135, v76, v78
  v_cmp_eq_u32 vcc, -1, v135
  s_cbranch_vccnz CH_3B_R3
CH_3B_S3:
  v_smfmac_f32_16x16x64_bf16 v[88:91], v[76:79], a[168:175], v3
  v_smfmac_f32_16x16x64_bf16 v[92:95], v[76:79], a[176:183], v3
CH_3B_L4:
  s_waitcnt vmcnt(1)
  v_max_u32 v135, v80, v82
  v_cmp_eq_u32 vcc, -1, v135
  s_cbranch_vccnz CH_3B_R4
CH_3B_S4:
  v_smfmac_f32_16x16x64_bf16 v[88:91], v[80:83], a[184:191], v3
  v_smfmac_f32_16x16x64_bf16 v[92:95], v[80:83], a[192:199], v3
CH_3B_L5:
  s_waitcnt vmcnt(0)
  v_max_u32 v135, v84, v86
  v_cmp_eq_u32 vcc, -1, v135
  s_cbranch_vccnz CH_3B_R5
CH_3B_S5:
  v_smfmac_f32_16x16x64_bf16 v[88:91], v[84:87], a[200:207], v3
  v_smfmac_f32_16x16x64_bf16 v[92:95], v[84:87], a[208:215], v3
  s_nop 6
  v_permlane32_swap_b32 v88, v89
  v_permlane32_swap_b32 v90, v91
  v_add_f32 v88, v88, v89
  v_add_f32 v90, v90, v91
  ds_write_b32 v6, v88 offset:0
  ds_write_b32 v6, v90 offset:288
  v_permlane32_swap_b32 v92, v93
  v_permlane32_swap_b32 v94, v95
  v_add_f32 v92, v92, v93
  v_add_f32 v94, v94, v95
  ds_write_b32 v6, v92 offset:64
  ds_write_b32 v6, v94 offset:352
  s_waitcnt lgkmcnt(0)
  s_branch CH_3_b4
CH_3_nb:
  s_waitcnt vmcnt(0)
CH_3_b4:
  s_barrier
  s_cmp_eq_u32 s16, 0
  s_cbranch_scc1 CH_3_w0c
  v_mov_b32 v40, 0
  v_mov_b32 v41, 0
  v_mov_b32 v42, 0
  v_mov_b32 v43, 0
  v_mov_b32 v44, 0
  v_mov_b32 v45, 0
  v_mov_b32 v46, 0
  v_mov_b32 v47, 0
  v_mov_b32 v48, 0
  v_mov_b32 v49, 0
  v_mov_b32 v50, 0
  v_mov_b32 v51, 0
  s_cmp_eq_u32 s16, 1
  s_cbranch_scc0 CH_3_b5
  s_lshl_b32 s57, s17, 5
  s_add_u32 s57, s57, s18
  s_lshl_b32 s57, s57, 2
  s_add_u32 s57, s57, 1843200
  v_mov_b32 v134, s20
  v_mov_b32 v135, 0
  s_mov_b64 exec, 1
  buffer_store_dword v134, v135, s[4:7], s57 offen sc1
  s_mov_b64 exec, -1
  s_add_u32 s57, s32, 102760448
  s_mov_b64 exec, s[48:49]
  buffer_store_dwordx4 v[96:99], v12, s[4:7], s57 offen sc1
  s_mov_b64 exec, s[50:51]
  buffer_store_dwordx4 v[100:103], v13, s[4:7], s57 offen sc1
  s_mov_b64 exec, -1
  s_add_u32 s57, s32, 109051904
  s_mov_b64 exec, s[52:53]
  buffer_store_dwordx2 v[164:165], v15, s[4:7], s57 offen offset:0 sc1
  buffer_store_dwordx2 v[166:167], v15, s[4:7], s57 offen offset:256 sc1
  buffer_store_dwordx2 v[168:169], v15, s[4:7], s57 offen offset:512 sc1
  s_mov_b64 exec, -1
  s_add_u32 s59, s20, 2
  s_cmp_ge_u32 s59, 64
  s_cbranch_scc1 CH_3_npf
  s_and_b32 s57, s59, 7
  s_cmp_eq_u32 s57, 0
  s_cbranch_scc0 CH_3_kg
  s_lshl_b32 s57, s59, 3
  s_add_u32 s57, s57, 1835008
  s_mov_b32 s58, 96
  v_mov_b32 v135, 0
CH_3_kl:
  buffer_load_dword v134, v135, s[4:7], s57 offen sc1
  s_add_u32 s21, s21, 1
  s_waitcnt vmcnt(0)
  v_cmp_gt_u32 vcc, s58, v134
  s_cbranch_vccz CH_3_kd
  s_sleep 2
  s_cmp_lt_u32 s21, 400000
  s_cbranch_scc1 CH_3_kl
CH_3_kd:
CH_3_kg:
  s_mov_b32 s33, s59
  s_lshl_b32 s33, s33, 5
  s_add_u32 s33, s33, s35
  s_mul_i32 s33, s33, 12288
  s_add_u32 s57, s33, 27262976
  s_add_u32 s58, s57, 128
  s_mov_b32 m0, s38
  s_add_u32 s33, s33, 52428800
  buffer_load_dwordx4 v176, s[4:7], s57 offen lds
  s_add_u32 m0, s38, 1024
  s_nop 0
  buffer_load_dwordx4 v177, s[4:7], s57 offen lds
  s_add_u32 m0, s38, 2048
  s_nop 0
  buffer_load_dwordx4 v176, s[4:7], s58 offen lds
  s_add_u32 m0, s38, 3072
  s_nop 0
  buffer_load_dwordx4 v177, s[4:7], s58 offen lds
  s_mul_i32 s57, s36, 48
  s_add_u32 s57, s57, 0
  s_lshr_b32 s58, s57, 5
  s_lshl_b32 s58, s58, 11
  s_and_b32 s57, s57, 31
  s_lshl_b32 s57, s57, 4
  s_add_u32 s57, s57, s58
  s_add_u32 s57, s57, s33
  s_add_u32 m0, s38, 4096
  s_nop 0
  buffer_load_dwordx4 v178, s[4:7], s57 offen lds
  s_mul_i32 s57, s36, 48
  s_add_u32 s57, s57, 16
  s_lshr_b32 s58, s57, 5
  s_lshl_b32 s58, s58, 11
  s_and_b32 s57, s57, 31
  s_lshl_b32 s57, s57, 4
  s_add_u32 s57, s57, s58
  s_add_u32 s57, s57, s33
  s_add_u32 m0, s38, 5120
  s_nop 0
  buffer_load_dwordx4 v178, s[4:7], s57 offen lds
  s_mul_i32 s57, s36, 48
  s_add_u32 s57, s57, 32
  s_lshr_b32 s58, s57, 5
  s_lshl_b32 s58, s58, 11
  s_and_b32 s57, s57, 31
  s_lshl_b32 s57, s57, 4
  s_add_u32 s57, s57, s58
  s_add_u32 s57, s57, s33
  s_add_u32 m0, s38, 6144
  s_nop 0
  buffer_load_dwordx4 v178, s[4:7], s57 offen lds
CH_3_npf:
  s_cmp_ge_u32 s18, 20
  s_cbranch_scc1 CH_3_b5
  s_lshl_b32 s57, s18, 9
  s_xor_b32 s58, s30, 65536
  s_add_u32 s58, s58, s57
  buffer_store_dwordx2 v[170:171], v18, s[4:7], s58 offen
  s_branch CH_3_b5
CH_3_w0c:
  s_cmp_ge_u32 s18, 20
  s_cbranch_scc1 CH_3_w0h
  ds_read_b128 v[108:111], v17 offset:0
  ds_read_b128 v[112:115], v17 offset:1152
  ds_read_b128 v[116:119], v17 offset:2304
  ds_read_b128 v[120:123], v17 offset:3456
  s_bfe_u32 s19, s20, 0x10001
  s_add_u32 s57, s27, s29
  s_add_u32 s59, s28, s29
  s_waitcnt lgkmcnt(2)
  v_add_f32 v108, v108, v112
  v_add_f32 v109, v109, v113
  v_add_f32 v110, v110, v114
  v_add_f32 v111, v111, v115
  s_waitcnt lgkmcnt(0)
  v_add_f32 v116, v116, v120
  v_add_f32 v117, v117, v121
  v_add_f32 v118, v118, v122
  v_add_f32 v119, v119, v123
  v_add_f32 v108, v108, v116
  v_add_f32 v109, v109, v117
  v_add_f32 v110, v110, v118
  v_add_f32 v111, v111, v119
  v_and_or_b32 v108, v108, -2, s19
  buffer_store_dwordx4 v[108:111], v2, s[4:7], s57 offen sc1
  s_xor_b32 s60, s31, 1024
  s_add_u32 s60, s60, s59
  s_xor_b32 s61, s31, 2048
  s_add_u32 s61, s61, s59
  s_xor_b32 s62, s31, 3072
  s_add_u32 s62, s62, s59
  s_lshl_b32 s59, s18, 9
  s_add_u32 s59, s59, s30
  v_mov_b32 v40, 0
  v_mov_b32 v41, 0
  v_mov_b32 v42, 0
  v_mov_b32 v43, 0
  v_mov_b32 v44, 0
  v_mov_b32 v45, 0
  v_mov_b32 v46, 0
  v_mov_b32 v47, 0
  v_mov_b32 v48, 0
  v_mov_b32 v49, 0
  v_mov_b32 v50, 0
  v_mov_b32 v51, 0
  v_add_u32 v104, s37, v2
  ds_read_b128 v[136:139], v104 offset:0
  s_waitcnt lgkmcnt(0)
  ds_read_b128 v[140:143], v104 offset:1024
  s_waitcnt lgkmcnt(0)
  ds_read_b128 v[144:147], v104 offset:2048
  s_waitcnt lgkmcnt(0)
  ds_read_b128 v[148:151], v104 offset:3072
  s_waitcnt lgkmcnt(0)
  ds_read_b128 v[152:155], v104 offset:4096
  s_waitcnt lgkmcnt(0)
  ds_read_b128 v[156:159], v104 offset:5120
  s_waitcnt lgkmcnt(0)
  buffer_load_dwordx4 v[180:183], v2, s[4:7], s60 offen sc1
  buffer_load_dwordx4 v[184:187], v2, s[4:7], s61 offen sc1
  buffer_load_dwordx4 v[188:191], v2, s[4:7], s62 offen sc1
  ds_read_b128 v[160:163], v104 offset:6144
  s_waitcnt lgkmcnt(0)
  ds_read_b32 v105, v104
  s_waitcnt lgkmcnt(0)
  buffer_load_dwordx4 v[192:195], v2, s[4:7], s60 offen sc1
  buffer_load_dwordx4 v[196:199], v2, s[4:7], s61 offen sc1
  buffer_load_dwordx4 v[200:203], v2, s[4:7], s62 offen sc1
  ds_read_b32 v105, v104
  s_waitcnt lgkmcnt(0)
  ds_read_b32 v105, v104
  s_waitcnt lgkmcnt(0)
  buffer_load_dwordx4 v[204:207], v2, s[4:7], s60 offen sc1
  buffer_load_dwordx4 v[208:211], v2, s[4:7], s61 offen sc1
  buffer_load_dwordx4 v[212:215], v2, s[4:7], s62 offen sc1
  ds_read_b32 v105, v104
  s_waitcnt lgkmcnt(0)
  ds_read_b32 v105, v104
  s_waitcnt lgkmcnt(0)
  buffer_load_dwordx4 v[216:219], v2, s[4:7], s60 offen sc1
  buffer_load_dwordx4 v[220:223], v2, s[4:7], s61 offen sc1
  buffer_load_dwordx4 v[224:227], v2, s[4:7], s62 offen sc1
  ds_read_b32 v105, v104
  s_waitcnt lgkmcnt(0)
  ds_read_b32 v105, v104
  s_waitcnt lgkmcnt(0)
  buffer_load_dwordx4 v[228:231], v2, s[4:7], s60 offen sc1
  buffer_load_dwordx4 v[232:235], v2, s[4:7], s61 offen sc1
  buffer_load_dwordx4 v[236:239], v2, s[4:7], s62 offen sc1
CH_3_cl:
  s_waitcnt vmcnt(12)
  v_bitop3_b32 v112, v180, v184, s19 bitop3:0x7e
  v_xor_b32 v113, s19, v188
  v_bitop3_b32 v112, v112, v113, 1 bitop3:0xa8
  v_cmp_eq_u32 vcc, 1, v112
  s_cbranch_vccz CH_3_ok0
  s_add_u32 s21, s21, 1
  buffer_load_dwordx4 v[180:183], v2, s[4:7], s60 offen sc1
  buffer_load_dwordx4 v[184:187], v2, s[4:7], s61 offen sc1
  buffer_load_dwordx4 v[188:191], v2, s[4:7], s62 offen sc1
  s_waitcnt vmcnt(12)
  v_bitop3_b32 v112, v192, v196, s19 bitop3:0x7e
  v_xor_b32 v113, s19, v200
  v_bitop3_b32 v112, v112, v113, 1 bitop3:0xa8
  v_cmp_eq_u32 vcc, 1, v112
  s_cbranch_vccz CH_3_ok1
  s_add_u32 s21, s21, 1
  buffer_load_dwordx4 v[192:195], v2, s[4:7], s60 offen sc1
  buffer_load_dwordx4 v[196:199], v2, s[4:7], s61 offen sc1
  buffer_load_dwordx4 v[200:203], v2, s[4:7], s62 offen sc1
  s_waitcnt vmcnt(12)
  v_bitop3_b32 v112, v204, v208, s19 bitop3:0x7e
  v_xor_b32 v113, s19, v212
  v_bitop3_b32 v112, v112, v113, 1 bitop3:0xa8
  v_cmp_eq_u32 vcc, 1, v112
  s_cbranch_vccz CH_3_ok2
  s_add_u32 s21, s21, 1
  buffer_load_dwordx4 v[204:207], v2, s[4:7], s60 offen sc1
  buffer_load_dwordx4 v[208:211], v2, s[4:7], s61 offen sc1
  buffer_load_dwordx4 v[212:215], v2, s[4:7], s62 offen sc1
  s_waitcnt vmcnt(12)
  v_bitop3_b32 v112, v216, v220, s19 bitop3:0x7e
  v_xor_b32 v113, s19, v224
  v_bitop3_b32 v112, v112, v113, 1 bitop3:0xa8
  v_cmp_eq_u32 vcc, 1, v112
  s_cbranch_vccz CH_3_ok3
  s_add_u32 s21, s21, 1
  buffer_load_dwordx4 v[216:219], v2, s[4:7], s60 offen sc1
  buffer_load_dwordx4 v[220:223], v2, s[4:7], s61 offen sc1
  buffer_load_dwordx4 v[224:227], v2, s[4:7], s62 offen sc1
  s_waitcnt vmcnt(12)
  v_bitop3_b32 v112, v228, v232, s19 bitop3:0x7e
  v_xor_b32 v113, s19, v236
  v_bitop3_b32 v112, v112, v113, 1 bitop3:0xa8
  v_cmp_eq_u32 vcc, 1, v112
  s_cbranch_vccz CH_3_ok4
  s_add_u32 s21, s21, 1
  s_cmp_lt_u32 s21, 400000
  s_cbranch_scc0 CH_3_ok4
  buffer_load_dwordx4 v[228:231], v2, s[4:7], s60 offen sc1
  buffer_load_dwordx4 v[232:235], v2, s[4:7], s61 offen sc1
  buffer_load_dwordx4 v[236:239], v2, s[4:7], s62 offen sc1
  s_branch CH_3_cl
CH_3_ok0:
  v_add_f32 v108, v108, v180
  v_add_f32 v109, v109, v181
  v_add_f32 v110, v110, v182
  v_add_f32 v111, v111, v183
  v_add_f32 v112, v184, v188
  v_add_f32 v113, v185, v189
  v_add_f32 v114, v186, v190
  v_add_f32 v115, v187, v191
  v_add_f32 v108, v108, v112
  v_add_f32 v109, v109, v113
  v_add_f32 v110, v110, v114
  v_add_f32 v111, v111, v115
  v_cvt_pk_bf16_f32 v104, v108, v109
  v_cvt_pk_bf16_f32 v105, v110, v111
  buffer_store_dwordx2 v[104:105], v18, s[4:7], s59 offen
  s_branch CH_3_probe
CH_3_ok1:
  v_add_f32 v108, v108, v192
  v_add_f32 v109, v109, v193
  v_add_f32 v110, v110, v194
  v_add_f32 v111, v111, v195
  v_add_f32 v112, v196, v200
  v_add_f32 v113, v197, v201
  v_add_f32 v114, v198, v202
  v_add_f32 v115, v199, v203
  v_add_f32 v108, v108, v112
  v_add_f32 v109, v109, v113
  v_add_f32 v110, v110, v114
  v_add_f32 v111, v111, v115
  v_cvt_pk_bf16_f32 v104, v108, v109
  v_cvt_pk_bf16_f32 v105, v110, v111
  buffer_store_dwordx2 v[104:105], v18, s[4:7], s59 offen
  s_branch CH_3_probe
CH_3_ok2:
  v_add_f32 v108, v108, v204
  v_add_f32 v109, v109, v205
  v_add_f32 v110, v110, v206
  v_add_f32 v111, v111, v207
  v_add_f32 v112, v208, v212
  v_add_f32 v113, v209, v213
  v_add_f32 v114, v210, v214
  v_add_f32 v115, v211, v215
  v_add_f32 v108, v108, v112
  v_add_f32 v109, v109, v113
  v_add_f32 v110, v110, v114
  v_add_f32 v111, v111, v115
  v_cvt_pk_bf16_f32 v104, v108, v109
  v_cvt_pk_bf16_f32 v105, v110, v111
  buffer_store_dwordx2 v[104:105], v18, s[4:7], s59 offen
  s_branch CH_3_probe
CH_3_ok3:
  v_add_f32 v108, v108, v216
  v_add_f32 v109, v109, v217
  v_add_f32 v110, v110, v218
  v_add_f32 v111, v111, v219
  v_add_f32 v112, v220, v224
  v_add_f32 v113, v221, v225
  v_add_f32 v114, v222, v226
  v_add_f32 v115, v223, v227
  v_add_f32 v108, v108, v112
  v_add_f32 v109, v109, v113
  v_add_f32 v110, v110, v114
  v_add_f32 v111, v111, v115
  v_cvt_pk_bf16_f32 v104, v108, v109
  v_cvt_pk_bf16_f32 v105, v110, v111
  buffer_store_dwordx2 v[104:105], v18, s[4:7], s59 offen
  s_branch CH_3_probe
CH_3_ok4:
  v_add_f32 v108, v108, v228
  v_add_f32 v109, v109, v229
  v_add_f32 v110, v110, v230
  v_add_f32 v111, v111, v231
  v_add_f32 v112, v232, v236
  v_add_f32 v113, v233, v237
  v_add_f32 v114, v234, v238
  v_add_f32 v115, v235, v239
  v_add_f32 v108, v108, v112
  v_add_f32 v109, v109, v113
  v_add_f32 v110, v110, v114
  v_add_f32 v111, v111, v115
  v_cvt_pk_bf16_f32 v104, v108, v109
  v_cvt_pk_bf16_f32 v105, v110, v111
  buffer_store_dwordx2 v[104:105], v18, s[4:7], s59 offen
  s_branch CH_3_probe
CH_3_w0h:
  v_mov_b32 v40, 0
  v_mov_b32 v41, 0
  v_mov_b32 v42, 0
  v_mov_b32 v43, 0
  v_mov_b32 v44, 0
  v_mov_b32 v45, 0
  v_mov_b32 v46, 0
  v_mov_b32 v47, 0
  v_mov_b32 v48, 0
  v_mov_b32 v49, 0
  v_mov_b32 v50, 0
  v_mov_b32 v51, 0
  v_add_u32 v104, s37, v2
  ds_read_b128 v[136:139], v104 offset:0
  ds_read_b128 v[140:143], v104 offset:1024
  ds_read_b128 v[144:147], v104 offset:2048
  ds_read_b128 v[148:151], v104 offset:3072
  ds_read_b128 v[152:155], v104 offset:4096
  ds_read_b128 v[156:159], v104 offset:5120
  ds_read_b128 v[160:163], v104 offset:6144
CH_3_probe:
  s_mov_b64 exec, 0xfffff
CH_3_prl:
  buffer_load_dword v106, v240, s[4:7], s30 offen sc1
  s_add_u32 s21, s21, 1
  s_waitcnt vmcnt(0)
  v_cmp_eq_u32 vcc, -1, v106
  s_cbranch_vccz CH_3_prd
  s_cmp_lt_u32 s21, 400000
  s_cbranch_scc1 CH_3_prl
CH_3_prd:
  s_mov_b64 exec, -1
CH_3_b5:
  s_waitcnt lgkmcnt(0)
  s_barrier
  s_branch CH_3_loop
CH_3D_R0:
  s_add_u32 s21, s21, 1
  s_cmp_lt_u32 s21, 400000
  s_cbranch_scc0 CH_3D_S0
  buffer_load_dwordx4 v[20:23], v4, s[4:7], s59 offen offset:0 sc1
  buffer_load_dwordx4 v[24:27], v4, s[4:7], s59 offen offset:1024 sc1
  buffer_load_dwordx4 v[28:31], v4, s[4:7], s59 offen offset:2048 sc1
  buffer_load_dwordx4 v[32:35], v4, s[4:7], s59 offen offset:3072 sc1
  buffer_load_dwordx4 v[36:39], v174, s[4:7], s59 offen sc1
  s_branch CH_3D_L0
CH_3D_R1:
  s_add_u32 s21, s21, 1
  s_cmp_lt_u32 s21, 400000
  s_cbranch_scc0 CH_3D_S1
  buffer_load_dwordx4 v[24:27], v4, s[4:7], s59 offen offset:1024 sc1
  buffer_load_dwordx4 v[28:31], v4, s[4:7], s59 offen offset:2048 sc1
  buffer_load_dwordx4 v[32:35], v4, s[4:7], s59 offen offset:3072 sc1
  buffer_load_dwordx4 v[36:39], v174, s[4:7], s59 offen sc1
  s_branch CH_3D_L1
CH_3D_R2:
  s_add_u32 s21, s21, 1
  s_cmp_lt_u32 s21, 400000
  s_cbranch_scc0 CH_3D_S2
  buffer_load_dwordx4 v[28:31], v4, s[4:7], s59 offen offset:2048 sc1
  buffer_load_dwordx4 v[32:35], v4, s[4:7], s59 offen offset:3072 sc1
  buffer_load_dwordx4 v[36:39], v174, s[4:7], s59 offen sc1
  s_branch CH_3D_L2
CH_3D_R3:
  s_add_u32 s21, s21, 1
  s_cmp_lt_u32 s21, 400000
  s_cbranch_scc0 CH_3D_S3
  buffer_load_dwordx4 v[32:35], v4, s[4:7], s59 offen offset:3072 sc1
  buffer_load_dwordx4 v[36:39], v174, s[4:7], s59 offen sc1
  s_branch CH_3D_L3
CH_3D_R4:
  s_add_u32 s21, s21, 1
  s_cmp_lt_u32 s21, 400000
  s_cbranch_scc0 CH_3D_S4
  buffer_load_dwordx4 v[36:39], v174, s[4:7], s59 offen sc1
  s_branch CH_3D_L4
CH_3_apr:
  s_add_u32 s21, s21, 1
  s_cmp_lt_u32 s21, 400000
  s_cbranch_scc0 CH_3_apd
  buffer_load_dwordx4 v[104:107], v10, s[4:7], s23 offen offset:0 sc1
  buffer_load_dwordx4 v[108:111], v10, s[4:7], s23 offen offset:1536 sc1
  buffer_load_dwordx4 v[112:115], v179, s[4:7], s23 offen offset:0 sc1
  buffer_load_dwordx4 v[116:119], v179, s[4:7], s23 offen offset:1536 sc1
  buffer_load_dwordx4 v[120:123], v11, s[4:7], s23 offen offset:0 sc1
  buffer_load_dwordx4 v[124:127], v11, s[4:7], s23 offen offset:1536 sc1
  s_branch CH_3_apl
CH_3B_R0:
  s_add_u32 s21, s21, 1
  s_cmp_lt_u32 s21, 400000
  s_cbranch_scc0 CH_3B_S0
  buffer_load_dwordx4 v[64:67], v7, s[4:7], s25 offen offset:0 sc1
  buffer_load_dwordx4 v[68:71], v7, s[4:7], s25 offen offset:1024 sc1
  buffer_load_dwordx4 v[72:75], v7, s[4:7], s25 offen offset:2048 sc1
  buffer_load_dwordx4 v[76:79], v7, s[4:7], s25 offen offset:3072 sc1
  buffer_load_dwordx4 v[80:83], v175, s[4:7], s25 offen offset:0 sc1
  buffer_load_dwordx4 v[84:87], v175, s[4:7], s25 offen offset:1024 sc1
  s_branch CH_3B_L0
CH_3B_R1:
  s_add_u32 s21, s21, 1
  s_cmp_lt_u32 s21, 400000
  s_cbranch_scc0 CH_3B_S1
  buffer_load_dwordx4 v[68:71], v7, s[4:7], s25 offen offset:1024 sc1
  buffer_load_dwordx4 v[72:75], v7, s[4:7], s25 offen offset:2048 sc1
  buffer_load_dwordx4 v[76:79], v7, s[4:7], s25 offen offset:3072 sc1
  buffer_load_dwordx4 v[80:83], v175, s[4:7], s25 offen offset:0 sc1
  buffer_load_dwordx4 v[84:87], v175, s[4:7], s25 offen offset:1024 sc1
  s_branch CH_3B_L1
CH_3B_R2:
  s_add_u32 s21, s21, 1
  s_cmp_lt_u32 s21, 400000
  s_cbranch_scc0 CH_3B_S2
  buffer_load_dwordx4 v[72:75], v7, s[4:7], s25 offen offset:2048 sc1
  buffer_load_dwordx4 v[76:79], v7, s[4:7], s25 offen offset:3072 sc1
  buffer_load_dwordx4 v[80:83], v175, s[4:7], s25 offen offset:0 sc1
  buffer_load_dwordx4 v[84:87], v175, s[4:7], s25 offen offset:1024 sc1
  s_branch CH_3B_L2
CH_3B_R3:
  s_add_u32 s21, s21, 1
  s_cmp_lt_u32 s21, 400000
  s_cbranch_scc0 CH_3B_S3
  buffer_load_dwordx4 v[76:79], v7, s[4:7], s25 offen offset:3072 sc1
  buffer_load_dwordx4 v[80:83], v175, s[4:7], s25 offen offset:0 sc1
  buffer_load_dwordx4 v[84:87], v175, s[4:7], s25 offen offset:1024 sc1
  s_branch CH_3B_L3
CH_3B_R4:
  s_add_u32 s21, s21, 1
  s_cmp_lt_u32 s21, 400000
  s_cbranch_scc0 CH_3B_S4
  buffer_load_dwordx4 v[80:83], v175, s[4:7], s25 offen offset:0 sc1
  buffer_load_dwordx4 v[84:87], v175, s[4:7], s25 offen offset:1024 sc1
  s_branch CH_3B_L4
CH_3B_R5:
  s_add_u32 s21, s21, 1
  s_cmp_lt_u32 s21, 400000
  s_cbranch_scc0 CH_3B_S5
  buffer_load_dwordx4 v[84:87], v175, s[4:7], s25 offen offset:1024 sc1
  s_branch CH_3B_L5
CH_3_last:
  s_cmp_eq_u32 s16, 1
  s_cbranch_scc0 CH_3_end
  s_lshl_b32 s57, s17, 5
  s_add_u32 s57, s57, s18
  s_lshl_b32 s57, s57, 2
  s_add_u32 s57, s57, 1843200
  v_mov_b32 v134, 63
  v_mov_b32 v135, 0
  s_mov_b64 exec, 1
  buffer_store_dword v134, v135, s[4:7], s57 offen sc1
  s_mov_b64 exec, -1
  s_add_u32 s57, s32, 102760448
  s_mov_b64 exec, s[48:49]
  buffer_store_dwordx4 v[96:99], v12, s[4:7], s57 offen sc1
  s_mov_b64 exec, s[50:51]
  buffer_store_dwordx4 v[100:103], v13, s[4:7], s57 offen sc1
  s_mov_b64 exec, -1
  ds_read_b128 v[104:107], v14 offset:0
  ds_read_b128 v[108:111], v14 offset:1536
  ds_read_b128 v[112:115], v14 offset:512
  ds_read_b128 v[116:119], v14 offset:2048
  ds_read_b128 v[120:123], v14 offset:1024
  ds_read_b128 v[124:127], v14 offset:2560
  s_waitcnt lgkmcnt(4)
  v_add_f32 v104, v104, v108
  v_add_f32 v105, v105, v109
  v_add_f32 v106, v106, v110
  v_add_f32 v107, v107, v111
  v_cvt_pk_bf16_f32 v164, v104, v105
  v_cvt_pk_bf16_f32 v165, v106, v107
  s_waitcnt lgkmcnt(2)
  v_add_f32 v112, v112, v116
  v_add_f32 v113, v113, v117
  v_add_f32 v114, v114, v118
  v_add_f32 v115, v115, v119
  v_cvt_pk_bf16_f32 v166, v112, v113
  v_cvt_pk_bf16_f32 v167, v114, v115
  s_waitcnt lgkmcnt(0)
  v_add_f32 v120, v120, v124
  v_add_f32 v121, v121, v125
  v_add_f32 v122, v122, v126
  v_add_f32 v123, v123, v127
  v_cvt_pk_bf16_f32 v168, v120, v121
  v_cvt_pk_bf16_f32 v169, v122, v123
  s_add_u32 s57, s32, 109051904
  s_mov_b64 exec, s[52:53]
  buffer_store_dwordx2 v[164:165], v15, s[4:7], s57 offen offset:0 sc1
  buffer_store_dwordx2 v[166:167], v15, s[4:7], s57 offen offset:256 sc1
  buffer_store_dwordx2 v[168:169], v15, s[4:7], s57 offen offset:512 sc1
  s_mov_b64 exec, -1
  s_waitcnt vmcnt(0)
  s_lshl_b32 s57, s17, 5
  s_add_u32 s57, s57, s18
  s_lshl_b32 s57, s57, 2
  s_add_u32 s57, s57, 1843200
  v_mov_b32 v134, 64
  v_mov_b32 v135, 0
  s_mov_b64 exec, 1
  buffer_store_dword v134, v135, s[4:7], s57 offen sc1
  s_mov_b64 exec, -1
CH_3_end:
  s_waitcnt vmcnt(0)
  s_branch CH_DONE
CH_SLOW:
  s_lshl_b32 s59, s17, 5
  s_add_u32 s59, s59, s18
  s_mul_i32 s22, s59, 1536
  s_mul_i32 s34, s36, 1536
  s_sub_u32 s23, s22, s34
  s_xor_b32 s24, s22, 262144
  s_mul_i32 s59, s17, 24576
  s_add_u32 s25, s59, 524288
  s_mul_i32 s33, s18, 768
  s_add_u32 s26, s25, s33
  s_xor_b32 s26, s26, 131072
  s_mul_i32 s59, s17, 10240
  s_add_u32 s30, s59, 786432
  s_lshl_b32 s59, s18, 12
  s_add_u32 s27, s59, 1048576
  s_lshl_b32 s31, s17, 10
  s_add_u32 s27, s27, s31
  s_add_u32 s28, s59, 1048576
  s_mov_b32 s29, 0
  s_mul_i32 s32, s35, 3072
  s_mov_b32 s38, 24576
  s_mov_b32 s37, 31744
  s_mov_b32 s20, 0
  s_cmp_eq_u32 s16, 1
  s_cbranch_scc0 CH_4_pf
  s_mov_b32 s57, 1835008
  s_mov_b32 s58, 96
  v_mov_b32 v135, 0
CH_4_k0l:
  buffer_load_dword v134, v135, s[4:7], s57 offen sc1
  s_add_u32 s21, s21, 1
  s_waitcnt vmcnt(0)
  v_cmp_gt_u32 vcc, s58, v134
  s_cbranch_vccz CH_4_k0d
  s_sleep 2
  s_cmp_lt_u32 s21, 400000
  s_cbranch_scc1 CH_4_k0l
CH_4_k0d:
  s_mov_b32 s33, 0
  s_lshl_b32 s33, s33, 5
  s_add_u32 s33, s33, s35
  s_mul_i32 s33, s33, 12288
  s_add_u32 s57, s33, 27262976
  s_add_u32 s58, s57, 128
  s_mov_b32 m0, s38
  s_add_u32 s33, s33, 52428800
  buffer_load_dwordx4 v176, s[4:7], s57 offen lds
  s_add_u32 m0, s38, 1024
  s_nop 0
  buffer_load_dwordx4 v177, s[4:7], s57 offen lds
  s_add_u32 m0, s38, 2048
  s_nop 0
  buffer_load_dwordx4 v176, s[4:7], s58 offen lds
  s_add_u32 m0, s38, 3072
  s_nop 0
  buffer_load_dwordx4 v177, s[4:7], s58 offen lds
  s_mul_i32 s57, s36, 48
  s_add_u32 s57, s57, 0
  s_lshr_b32 s58, s57, 5
  s_lshl_b32 s58, s58, 11
  s_and_b32 s57, s57, 31
  s_lshl_b32 s57, s57, 4
  s_add_u32 s57, s57, s58
  s_add_u32 s57, s57, s33
  s_add_u32 m0, s38, 4096
  s_nop 0
  buffer_load_dwordx4 v178, s[4:7], s57 offen lds
  s_mul_i32 s57, s36, 48
  s_add_u32 s57, s57, 16
  s_lshr_b32 s58, s57, 5
  s_lshl_b32 s58, s58, 11
  s_and_b32 s57, s57, 31
  s_lshl_b32 s57, s57, 4
  s_add_u32 s57, s57, s58
  s_add_u32 s57, s57, s33
  s_add_u32 m0, s38, 5120
  s_nop 0
  buffer_load_dwordx4 v178, s[4:7], s57 offen lds
  s_mul_i32 s57, s36, 48
  s_add_u32 s57, s57, 32
  s_lshr_b32 s58, s57, 5
  s_lshl_b32 s58, s58, 11
  s_and_b32 s57, s57, 31
  s_lshl_b32 s57, s57, 4
  s_add_u32 s57, s57, s58
  s_add_u32 s57, s57, s33
  s_add_u32 m0, s38, 6144
  s_nop 0
  buffer_load_dwordx4 v178, s[4:7], s57 offen lds
  s_mov_b32 s38, 31744
  s_mov_b32 s33, 1
  s_lshl_b32 s33, s33, 5
  s_add_u32 s33, s33, s35
  s_mul_i32 s33, s33, 12288
  s_add_u32 s57, s33, 27262976
  s_add_u32 s58, s57, 128
  s_mov_b32 m0, s38
  s_add_u32 s33, s33, 52428800
  buffer_load_dwordx4 v176, s[4:7], s57 offen lds
  s_add_u32 m0, s38, 1024
  s_nop 0
  buffer_load_dwordx4 v177, s[4:7], s57 offen lds
  s_add_u32 m0, s38, 2048
  s_nop 0
  buffer_load_dwordx4 v176, s[4:7], s58 offen lds
  s_add_u32 m0, s38, 3072
  s_nop 0
  buffer_load_dwordx4 v177, s[4:7], s58 offen lds
  s_mul_i32 s57, s36, 48
  s_add_u32 s57, s57, 0
  s_lshr_b32 s58, s57, 5
  s_lshl_b32 s58, s58, 11
  s_and_b32 s57, s57, 31
  s_lshl_b32 s57, s57, 4
  s_add_u32 s57, s57, s58
  s_add_u32 s57, s57, s33
  s_add_u32 m0, s38, 4096
  s_nop 0
  buffer_load_dwordx4 v178, s[4:7], s57 offen lds
  s_mul_i32 s57, s36, 48
  s_add_u32 s57, s57, 16
  s_lshr_b32 s58, s57, 5
  s_lshl_b32 s58, s58, 11
  s_and_b32 s57, s57, 31
  s_lshl_b32 s57, s57, 4
  s_add_u32 s57, s57, s58
  s_add_u32 s57, s57, s33
  s_add_u32 m0, s38, 5120
  s_nop 0
  buffer_load_dwordx4 v178, s[4:7], s57 offen lds
  s_mul_i32 s57, s36, 48
  s_add_u32 s57, s57, 32
  s_lshr_b32 s58, s57, 5
  s_lshl_b32 s58, s58, 11
  s_and_b32 s57, s57, 31
  s_lshl_b32 s57, s57, 4
  s_add_u32 s57, s57, s58
  s_add_u32 s57, s57, s33
  s_add_u32 m0, s38, 6144
  s_nop 0
  buffer_load_dwordx4 v178, s[4:7], s57 offen lds
  s_mov_b32 s38, 24576
  s_waitcnt vmcnt(0) lgkmcnt(0)
CH_4_pf:
  s_barrier
  s_cmp_eq_u32 s16, 0
  s_cbranch_scc0 CH_4_nk0
  s_mov_b32 s57, 24576
  v_add_u32 v104, s57, v2
  ds_read_b128 v[136:139], v104 offset:0
  ds_read_b128 v[140:143], v104 offset:1024
  ds_read_b128 v[144:147], v104 offset:2048
  ds_read_b128 v[148:151], v104 offset:3072
  ds_read_b128 v[152:155], v104 offset:4096
  ds_read_b128 v[156:159], v104 offset:5120
  ds_read_b128 v[160:163], v104 offset:6144
CH_4_nk0:
  v_mov_b32 v40, 0
  v_mov_b32 v41, 0
  v_mov_b32 v42, 0
  v_mov_b32 v43, 0
  v_mov_b32 v44, 0
  v_mov_b32 v45, 0
  v_mov_b32 v46, 0
  v_mov_b32 v47, 0
  v_mov_b32 v48, 0
  v_mov_b32 v49, 0
  v_mov_b32 v50, 0
  v_mov_b32 v51, 0
  v_mov_b32 v52, 0
  v_mov_b32 v53, 0
  v_mov_b32 v54, 0
  v_mov_b32 v55, 0
  v_mov_b32 v56, 0
  v_mov_b32 v57, 0
  v_mov_b32 v58, 0
  v_mov_b32 v59, 0
  v_mov_b32 v60, 0
  v_mov_b32 v61, 0
  v_mov_b32 v62, 0
  v_mov_b32 v63, 0
  v_and_b32 v105, 7, v1
  v_mul_u32_u24 v105, 1280, v105
  v_lshrrev_b32 v106, 3, v1
  v_lshlrev_b32 v106, 4, v106
  s_and_b32 s57, s16, 1
  s_mul_i32 s57, s57, 640
  v_add3_u32 v105, v105, v106, s57
  buffer_load_dwordx4 v[20:23], v105, s[8:11], 0 offen offset:0
  buffer_load_dwordx4 v[24:27], v105, s[8:11], 0 offen offset:128
  buffer_load_dwordx4 v[28:31], v105, s[8:11], 0 offen offset:256
  buffer_load_dwordx4 v[32:35], v105, s[8:11], 0 offen offset:384
  buffer_load_dwordx4 v[36:39], v105, s[8:11], 0 offen offset:512
  s_xor_b32 s30, s30, 65536
  s_waitcnt vmcnt(0) lgkmcnt(0)
  v_smfmac_f32_16x16x64_bf16 v[40:43], v[20:23], a[0:7], v3
  v_smfmac_f32_16x16x64_bf16 v[44:47], v[20:23], a[8:15], v3
  v_smfmac_f32_16x16x64_bf16 v[48:51], v[20:23], a[16:23], v3
  v_smfmac_f32_16x16x64_bf16 v[40:43], v[24:27], a[24:31], v3
  v_smfmac_f32_16x16x64_bf16 v[44:47], v[24:27], a[32:39], v3
  v_smfmac_f32_16x16x64_bf16 v[48:51], v[24:27], a[40:47], v3
  v_smfmac_f32_16x16x64_bf16 v[40:43], v[28:31], a[48:55], v3
  v_smfmac_f32_16x16x64_bf16 v[44:47], v[28:31], a[56:63], v3
  v_smfmac_f32_16x16x64_bf16 v[48:51], v[28:31], a[64:71], v3
  v_smfmac_f32_16x16x64_bf16 v[40:43], v[32:35], a[72:79], v3
  v_smfmac_f32_16x16x64_bf16 v[44:47], v[32:35], a[80:87], v3
  v_smfmac_f32_16x16x64_bf16 v[48:51], v[32:35], a[88:95], v3
  v_smfmac_f32_16x16x64_bf16 v[40:43], v[36:39], a[96:103], v3
  v_smfmac_f32_16x16x64_bf16 v[44:47], v[36:39], a[104:111], v3
  v_smfmac_f32_16x16x64_bf16 v[48:51], v[36:39], a[112:119], v3
  s_branch CH_4_qd
CH_4_loop:
  s_mov_b32 s59, s30
  buffer_load_dwordx4 v[20:23], v4, s[4:7], s59 offen offset:0 sc1
  buffer_load_dwordx4 v[24:27], v4, s[4:7], s59 offen offset:1024 sc1
  buffer_load_dwordx4 v[28:31], v4, s[4:7], s59 offen offset:2048 sc1
  buffer_load_dwordx4 v[32:35], v4, s[4:7], s59 offen offset:3072 sc1
  buffer_load_dwordx4 v[36:39], v174, s[4:7], s59 offen sc1
  s_xor_b32 s30, s30, 65536
  s_add_u32 s20, s20, 1
  s_xor_b32 s22, s22, 262144
  s_xor_b32 s23, s23, 262144
  s_xor_b32 s24, s24, 262144
  s_xor_b32 s25, s25, 131072
  s_xor_b32 s26, s26, 131072
  s_xor_b32 s29, s29, 81920
  s_add_u32 s32, s32, 98304
  s_xor_b32 s37, s37, 0x1c00
  s_xor_b32 s38, s38, 0x1c00
CH_4D_L0:
  s_waitcnt vmcnt(4)
  v_max_u32 v135, v20, v22
  v_cmp_eq_u32 vcc, -1, v135
  s_cbranch_vccnz CH_4D_R0
CH_4D_S0:
  v_smfmac_f32_16x16x64_bf16 v[40:43], v[20:23], a[0:7], v3
  v_smfmac_f32_16x16x64_bf16 v[44:47], v[20:23], a[8:15], v3
  v_smfmac_f32_16x16x64_bf16 v[48:51], v[20:23], a[16:23], v3
CH_4D_L1:
  s_waitcnt vmcnt(3)
  v_max_u32 v135, v24, v26
  v_cmp_eq_u32 vcc, -1, v135
  s_cbranch_vccnz CH_4D_R1
CH_4D_S1:
  v_smfmac_f32_16x16x64_bf16 v[40:43], v[24:27], a[24:31], v3
  v_smfmac_f32_16x16x64_bf16 v[44:47], v[24:27], a[32:39], v3
  v_smfmac_f32_16x16x64_bf16 v[48:51], v[24:27], a[40:47], v3
CH_4D_L2:
  s_waitcnt vmcnt(2)
  v_max_u32 v135, v28, v30
  v_cmp_eq_u32 vcc, -1, v135
  s_cbranch_vccnz CH_4D_R2
CH_4D_S2:
  v_smfmac_f32_16x16x64_bf16 v[40:43], v[28:31], a[48:55], v3
  v_smfmac_f32_16x16x64_bf16 v[44:47], v[28:31], a[56:63], v3
  v_smfmac_f32_16x16x64_bf16 v[48:51], v[28:31], a[64:71], v3
CH_4D_L3:
  s_waitcnt vmcnt(1)
  v_max_u32 v135, v32, v34
  v_cmp_eq_u32 vcc, -1, v135
  s_cbranch_vccnz CH_4D_R3
CH_4D_S3:
  v_smfmac_f32_16x16x64_bf16 v[40:43], v[32:35], a[72:79], v3
  v_smfmac_f32_16x16x64_bf16 v[44:47], v[32:35], a[80:87], v3
  v_smfmac_f32_16x16x64_bf16 v[48:51], v[32:35], a[88:95], v3
CH_4D_L4:
  s_waitcnt vmcnt(0)
  v_max_u32 v135, v36, v38
  v_cmp_eq_u32 vcc, -1, v135
  s_cbranch_vccnz CH_4D_R4
CH_4D_S4:
  v_smfmac_f32_16x16x64_bf16 v[40:43], v[36:39], a[96:103], v3
  v_smfmac_f32_16x16x64_bf16 v[44:47], v[36:39], a[104:111], v3
  v_smfmac_f32_16x16x64_bf16 v[48:51], v[36:39], a[112:119], v3
CH_4_qd:
  s_nop 5
  v_permlane32_swap_b32 v40, v41
  v_permlane32_swap_b32 v42, v43
  v_add_f32 v40, v40, v41
  v_add_f32 v42, v42, v43
  ds_write_b32 v5, v40 offset:0
  ds_write_b32 v5, v42 offset:416
  v_permlane32_swap_b32 v44, v45
  v_permlane32_swap_b32 v46, v47
  v_add_f32 v44, v44, v45
  v_add_f32 v46, v46, v47
  ds_write_b32 v5, v44 offset:64
  ds_write_b32 v5, v46 offset:480
  v_permlane32_swap_b32 v48, v49
  v_permlane32_swap_b32 v50, v51
  v_add_f32 v48, v48, v49
  v_add_f32 v50, v50, v51
  ds_write_b32 v5, v48 offset:128
  ds_write_b32 v5, v50 offset:544
  s_waitcnt lgkmcnt(0)
  s_barrier
  s_cmp_eq_u32 s16, 0
  s_cbranch_scc1 CH_4_w0a
  s_cmp_eq_u32 s16, 1
  s_cbranch_scc1 CH_4_w1a
  v_smfmac_f32_16x16x64_bf16 v[52:55], v[20:23], a[216:223], v3
  v_smfmac_f32_16x16x64_bf16 v[56:59], v[20:23], a[224:231], v3
  v_smfmac_f32_16x16x64_bf16 v[60:63], v[20:23], a[232:239], v3
  v_smfmac_f32_16x16x64_bf16 v[52:55], v[24:27], a[240:247], v3
  v_smfmac_f32_16x16x64_bf16 v[56:59], v[24:27], a[248:255], v3
  v_smfmac_f32_16x16x64_bf16 v[60:63], v[24:27], v[176:183], v3
  v_smfmac_f32_16x16x64_bf16 v[52:55], v[28:31], v[184:191], v3
  v_smfmac_f32_16x16x64_bf16 v[56:59], v[28:31], v[192:199], v3
  v_smfmac_f32_16x16x64_bf16 v[60:63], v[28:31], v[200:207], v3
  v_smfmac_f32_16x16x64_bf16 v[52:55], v[32:35], v[208:215], v3
  v_smfmac_f32_16x16x64_bf16 v[56:59], v[32:35], v[216:223], v3
  v_smfmac_f32_16x16x64_bf16 v[60:63], v[32:35], v[224:231], v3
  v_smfmac_f32_16x16x64_bf16 v[52:55], v[36:39], v[232:239], v3
  v_smfmac_f32_16x16x64_bf16 v[56:59], v[36:39], v[240:247], v3
  v_smfmac_f32_16x16x64_bf16 v[60:63], v[36:39], v[248:255], v3
  s_nop 5
  v_permlane32_swap_b32 v52, v54
  v_permlane32_swap_b32 v53, v55
  v_add_f32 v52, v52, v54
  v_add_f32 v53, v53, v55
  ds_write_b64 v14, v[52:53] offset:0
  v_permlane32_swap_b32 v56, v58
  v_permlane32_swap_b32 v57, v59
  v_add_f32 v56, v56, v58
  v_add_f32 v57, v57, v59
  ds_write_b64 v14, v[56:57] offset:512
  v_permlane32_swap_b32 v60, v62
  v_permlane32_swap_b32 v61, v63
  v_add_f32 v60, v60, v62
  v_add_f32 v61, v61, v63
  ds_write_b64 v14, v[60:61] offset:1024
  v_mov_b32 v52, 0
  v_mov_b32 v53, 0
  v_mov_b32 v54, 0
  v_mov_b32 v55, 0
  v_mov_b32 v56, 0
  v_mov_b32 v57, 0
  v_mov_b32 v58, 0
  v_mov_b32 v59, 0
  v_mov_b32 v60, 0
  v_mov_b32 v61, 0
  v_mov_b32 v62, 0
  v_mov_b32 v63, 0
  s_waitcnt lgkmcnt(0)
  s_branch CH_4_b2
CH_4_w1a:
  buffer_store_dwordx4 v[170:173], v2, s[4:7], s24 offen sc1
  buffer_store_dwordx2 v[170:171], v18, s[4:7], s24 offen offset:1024 sc1
  buffer_store_dwordx3 v[170:172], v19, s[4:7], s26 offen sc1
  ds_read_b128 v[104:107], v8 offset:0
  ds_read_b128 v[108:111], v8 offset:3328
  ds_read_b128 v[112:115], v8 offset:32
  ds_read_b128 v[116:119], v8 offset:3360
  ds_read_b128 v[120:123], v8 offset:128
  ds_read_b128 v[124:127], v8 offset:3456
  ds_read_b128 v[128:131], v8 offset:160
  ds_read_b128 v[132:135], v8 offset:3488
  s_waitcnt lgkmcnt(6)
  v_add_f32 v104, v104, v108
  v_add_f32 v105, v105, v109
  v_add_f32 v106, v106, v110
  v_add_f32 v107, v107, v111
  v_cvt_pk_bf16_f32 v96, v104, v105
  v_cvt_pk_bf16_f32 v97, v106, v107
  s_waitcnt lgkmcnt(4)
  v_add_f32 v112, v112, v116
  v_add_f32 v113, v113, v117
  v_add_f32 v114, v114, v118
  v_add_f32 v115, v115, v119
  v_cvt_pk_bf16_f32 v98, v112, v113
  v_cvt_pk_bf16_f32 v99, v114, v115
  s_waitcnt lgkmcnt(2)
  v_add_f32 v120, v120, v124
  v_add_f32 v121, v121, v125
  v_add_f32 v122, v122, v126
  v_add_f32 v123, v123, v127
  v_cvt_pk_bf16_f32 v100, v120, v121
  v_cvt_pk_bf16_f32 v101, v122, v123
  s_waitcnt lgkmcnt(0)
  v_add_f32 v128, v128, v132
  v_add_f32 v129, v129, v133
  v_add_f32 v130, v130, v134
  v_add_f32 v131, v131, v135
  v_cvt_pk_bf16_f32 v102, v128, v129
  v_cvt_pk_bf16_f32 v103, v130, v131
  v_cndmask_b32 v100, 0, v100, s[40:41]
  v_cndmask_b32 v101, 0, v101, s[40:41]
  v_cndmask_b32 v102, 0, v102, s[40:41]
  v_cndmask_b32 v103, 0, v103, s[40:41]
  s_waitcnt vmcnt(0)
  s_branch CH_4_b2
CH_4_w0a:
  ds_read_b128 v[104:107], v8 offset:0
  ds_read_b128 v[108:111], v8 offset:3328
  ds_read_b128 v[112:115], v8 offset:32
  ds_read_b128 v[116:119], v8 offset:3360
  ds_read_b128 v[120:123], v8 offset:128
  ds_read_b128 v[124:127], v8 offset:3456
  ds_read_b128 v[128:131], v8 offset:160
  ds_read_b128 v[132:135], v8 offset:3488
  s_waitcnt lgkmcnt(6)
  v_add_f32 v104, v104, v108
  v_add_f32 v105, v105, v109
  v_add_f32 v106, v106, v110
  v_add_f32 v107, v107, v111
  v_cvt_pk_bf16_f32 v96, v104, v105
  v_cvt_pk_bf16_f32 v97, v106, v107
  s_waitcnt lgkmcnt(4)
  v_add_f32 v112, v112, v116
  v_add_f32 v113, v113, v117
  v_add_f32 v114, v114, v118
  v_add_f32 v115, v115, v119
  v_cvt_pk_bf16_f32 v98, v112, v113
  v_cvt_pk_bf16_f32 v99, v114, v115
  s_waitcnt lgkmcnt(2)
  v_add_f32 v120, v120, v124
  v_add_f32 v121, v121, v125
  v_add_f32 v122, v122, v126
  v_add_f32 v123, v123, v127
  v_cvt_pk_bf16_f32 v100, v120, v121
  v_cvt_pk_bf16_f32 v101, v122, v123
  s_waitcnt lgkmcnt(0)
  v_add_f32 v128, v128, v132
  v_add_f32 v129, v129, v133
  v_add_f32 v130, v130, v134
  v_add_f32 v131, v131, v135
  v_cvt_pk_bf16_f32 v102, v128, v129
  v_cvt_pk_bf16_f32 v103, v130, v131
  v_cndmask_b32 v100, 0, v100, s[40:41]
  v_cndmask_b32 v101, 0, v101, s[40:41]
  v_cndmask_b32 v102, 0, v102, s[40:41]
  v_cndmask_b32 v103, 0, v103, s[40:41]
  v_mfma_f32_16x16x32_bf16 v[108:111], v[136:139], v[96:99], 0
  v_mfma_f32_16x16x32_bf16 v[112:115], v[144:147], v[96:99], 0
  v_mfma_f32_16x16x32_bf16 v[104:107], v[96:99], v[96:99], 0
  v_mfma_f32_16x16x32_bf16 v[108:111], v[140:143], v[100:103], v[108:111]
  v_mfma_f32_16x16x32_bf16 v[112:115], v[148:151], v[100:103], v[112:115]
  v_mfma_f32_16x16x32_bf16 v[104:107], v[100:103], v[100:103], v[104:107]
  s_mov_b64 exec, s[42:43]
  s_nop 3
  buffer_store_dwordx4 v[108:111], v9, s[4:7], s22 offen sc1
  s_nop 0
  buffer_store_dwordx4 v[112:115], v9, s[4:7], s22 offen offset:512 sc1
  s_nop 1
  buffer_store_dwordx4 v[104:107], v9, s[4:7], s22 offen offset:1024 sc1
  s_mov_b64 exec, -1
CH_4_b2:
  s_barrier
  s_cmp_eq_u32 s20, 63
  s_cbranch_scc1 CH_4_last
  s_cmp_eq_u32 s16, 0
  s_cbranch_scc1 CH_4_w0b
  s_cmp_eq_u32 s16, 1
  s_cbranch_scc0 CH_4_b3
  ds_read_b128 v[104:107], v14 offset:0
  ds_read_b128 v[108:111], v14 offset:1536
  ds_read_b128 v[112:115], v14 offset:512
  ds_read_b128 v[116:119], v14 offset:2048
  ds_read_b128 v[120:123], v14 offset:1024
  ds_read_b128 v[124:127], v14 offset:2560
  s_waitcnt lgkmcnt(4)
  v_add_f32 v104, v104, v108
  v_add_f32 v105, v105, v109
  v_add_f32 v106, v106, v110
  v_add_f32 v107, v107, v111
  v_cvt_pk_bf16_f32 v164, v104, v105
  v_cvt_pk_bf16_f32 v165, v106, v107
  s_waitcnt lgkmcnt(2)
  v_add_f32 v112, v112, v116
  v_add_f32 v113, v113, v117
  v_add_f32 v114, v114, v118
  v_add_f32 v115, v115, v119
  v_cvt_pk_bf16_f32 v166, v112, v113
  v_cvt_pk_bf16_f32 v167, v114, v115
  s_waitcnt lgkmcnt(0)
  v_add_f32 v120, v120, v124
  v_add_f32 v121, v121, v125
  v_add_f32 v122, v122, v126
  v_add_f32 v123, v123, v127
  v_cvt_pk_bf16_f32 v168, v120, v121
  v_cvt_pk_bf16_f32 v169, v122, v123
  s_branch CH_4_b3
CH_4_w0b:
  buffer_load_dwordx4 v[104:107], v10, s[4:7], s23 offen offset:0 sc1
  buffer_load_dwordx4 v[108:111], v10, s[4:7], s23 offen offset:1536 sc1
  buffer_load_dwordx4 v[112:115], v179, s[4:7], s23 offen offset:0 sc1
  buffer_load_dwordx4 v[116:119], v179, s[4:7], s23 offen offset:1536 sc1
  buffer_load_dwordx4 v[120:123], v11, s[4:7], s23 offen offset:0 sc1
  buffer_load_dwordx4 v[124:127], v11, s[4:7], s23 offen offset:1536 sc1
  ds_read_b128 v[64:67], v14 offset:0
  ds_read_b128 v[68:71], v14 offset:1536
  ds_read_b128 v[72:75], v14 offset:512
  ds_read_b128 v[76:79], v14 offset:2048
  ds_read_b128 v[80:83], v14 offset:1024
  ds_read_b128 v[84:87], v14 offset:2560
  s_waitcnt lgkmcnt(4)
  v_add_f32 v64, v64, v68
  v_add_f32 v65, v65, v69
  v_add_f32 v66, v66, v70
  v_add_f32 v67, v67, v71
  v_cvt_pk_bf16_f32 v164, v64, v65
  v_cvt_pk_bf16_f32 v165, v66, v67
  s_waitcnt lgkmcnt(2)
  v_add_f32 v72, v72, v76
  v_add_f32 v73, v73, v77
  v_add_f32 v74, v74, v78
  v_add_f32 v75, v75, v79
  v_cvt_pk_bf16_f32 v166, v72, v73
  v_cvt_pk_bf16_f32 v167, v74, v75
  s_waitcnt lgkmcnt(0)
  v_add_f32 v80, v80, v84
  v_add_f32 v81, v81, v85
  v_add_f32 v82, v82, v86
  v_add_f32 v83, v83, v87
  v_cvt_pk_bf16_f32 v168, v80, v81
  v_cvt_pk_bf16_f32 v169, v82, v83
CH_4_apl:
  s_waitcnt vmcnt(0)
  v_max3_u32 v128, v104, v108, v112
  v_max3_u32 v128, v128, v116, v120
  v_max_u32 v128, v128, v124
  v_cmp_eq_u32 vcc, -1, v128
  s_cbranch_vccnz CH_4_apr
CH_4_apd:
  v_add_f32 v120, v120, v124
  v_add_f32 v121, v121, v125
  v_add_f32 v122, v122, v126
  v_add_f32 v123, v123, v127
  v_add_f32 v104, v104, v108
  v_add_f32 v105, v105, v109
  v_add_f32 v106, v106, v110
  v_add_f32 v107, v107, v111
  v_add_f32_dpp v124, v120, v120 row_ror:8 row_mask:0xf bank_mask:0xf
  v_add_f32_dpp v125, v121, v121 row_ror:8 row_mask:0xf bank_mask:0xf
  v_add_f32_dpp v126, v122, v122 row_ror:8 row_mask:0xf bank_mask:0xf
  v_add_f32_dpp v127, v123, v123 row_ror:8 row_mask:0xf bank_mask:0xf
  v_add_f32 v112, v112, v116
  v_add_f32 v113, v113, v117
  v_add_f32 v114, v114, v118
  v_add_f32 v115, v115, v119
  v_add_f32 v104, v104, v112
  v_add_f32 v105, v105, v113
  v_add_f32 v106, v106, v114
  v_add_f32 v107, v107, v115
  v_max3_f32 v128, v124, v125, v126
  v_max3_f32 v128, v128, v127, v104
  v_max3_f32 v128, v128, v105, v106
  v_max_f32 v128, v128, v107
  s_mov_b32 s57, 0x3dd53b95
  s_nop 0
  v_max_f32_dpp v128, v128, v128 row_ror:8 row_mask:0xf bank_mask:0xf
  v_mov_b32 v129, v128
  s_nop 1
  v_permlane16_swap_b32 v128, v129
  v_max_f32 v128, v128, v129
  v_mov_b32 v129, v128
  s_nop 1
  v_permlane32_swap_b32 v128, v129
  v_max_f32 v128, v128, v129
  v_mul_f32 v128, s57, v128
  v_fma_f32 v104, v104, s57, -v128
  v_fma_f32 v105, v105, s57, -v128
  v_fma_f32 v106, v106, s57, -v128
  v_fma_f32 v107, v107, s57, -v128
  v_fma_f32 v124, v124, s57, -v128
  v_fma_f32 v125, v125, s57, -v128
  v_fma_f32 v126, v126, s57, -v128
  v_fma_f32 v127, v127, s57, -v128
  v_exp_f32 v104, v104
  v_exp_f32 v105, v105
  v_exp_f32 v106, v106
  v_exp_f32 v107, v107
  v_exp_f32 v124, v124
  v_exp_f32 v125, v125
  v_exp_f32 v126, v126
  v_exp_f32 v127, v127
  v_mov_b32 v116, 0x3f803f80
  v_mov_b32 v117, 0x3f803f80
  v_cvt_pk_bf16_f32 v134, v104, v105
  v_cvt_pk_bf16_f32 v135, v106, v107
  v_cvt_pk_bf16_f32 v130, v124, v125
  v_cvt_pk_bf16_f32 v131, v126, v127
  v_mov_b32 v132, v134
  v_mov_b32 v133, v135
  v_mov_b32 v118, 0x3f803f80
  v_mov_b32_dpp v132, v134 row_ror:8 row_mask:0xf bank_mask:0xc
  v_mov_b32_dpp v133, v135 row_ror:8 row_mask:0xf bank_mask:0xc
  v_cndmask_b32 v130, 0, v130, s[46:47]
  v_cndmask_b32 v131, 0, v131, s[46:47]
  v_mov_b32_dpp v134, v134 row_ror:8 row_mask:0xf bank_mask:0x3
  v_mov_b32_dpp v135, v135 row_ror:8 row_mask:0xf bank_mask:0x3
  v_mov_b32 v119, 0x3f803f80
  s_nop 1
  v_mfma_f32_16x16x32_bf16 v[120:123], v[116:119], v[132:135], 0
  v_mfma_f32_16x16x32_bf16 v[96:99], v[152:155], v[132:135], 0
  v_mfma_f32_16x16x32_bf16 v[100:103], v[156:159], v[132:135], 0
  v_mfma_f32_16x16x16_bf16 v[120:123], v[116:117], v[130:131], v[120:123]
  v_mfma_f32_16x16x32_bf16 v[104:107], v[160:163], v[132:135], 0
  v_mfma_f32_16x16x16_bf16 v[96:99], v[164:165], v[130:131], v[96:99]
  v_mfma_f32_16x16x16_bf16 v[100:103], v[166:167], v[130:131], v[100:103]
  s_nop 1
  v_rcp_f32 v120, v120
  v_mfma_f32_16x16x16_bf16 v[104:107], v[168:169], v[130:131], v[104:107]
  s_nop 1
  s_mov_b64 exec, s[44:45]
  v_mul_f32 v96, v96, v120
  v_mul_f32 v97, v97, v120
  v_mul_f32 v98, v98, v120
  v_mul_f32 v99, v99, v120
  v_cvt_pk_bf16_f32 v108, v96, v97
  v_cvt_pk_bf16_f32 v109, v98, v99
  buffer_store_dwordx2 v[108:109], v16, s[4:7], s25 offen offset:0 sc1
  s_nop 0
  v_mul_f32 v100, v100, v120
  v_mul_f32 v101, v101, v120
  v_mul_f32 v102, v102, v120
  v_mul_f32 v103, v103, v120
  v_cvt_pk_bf16_f32 v110, v100, v101
  v_cvt_pk_bf16_f32 v111, v102, v103
  buffer_store_dwordx2 v[110:111], v16, s[4:7], s25 offen offset:256 sc1
  s_nop 0
  v_mul_f32 v104, v104, v120
  v_mul_f32 v105, v105, v120
  v_mul_f32 v106, v106, v120
  v_mul_f32 v107, v107, v120
  v_cvt_pk_bf16_f32 v112, v104, v105
  v_cvt_pk_bf16_f32 v113, v106, v107
  buffer_store_dwordx2 v[112:113], v16, s[4:7], s25 offen offset:512 sc1
  s_mov_b64 exec, -1
CH_4_b3:
  s_barrier
  s_cmp_ge_u32 s18, 20
  s_cbranch_scc1 CH_4_nb
  buffer_load_dwordx4 v[64:67], v7, s[4:7], s25 offen offset:0 sc1
  buffer_load_dwordx4 v[68:71], v7, s[4:7], s25 offen offset:1024 sc1
  buffer_load_dwordx4 v[72:75], v7, s[4:7], s25 offen offset:2048 sc1
  buffer_load_dwordx4 v[76:79], v7, s[4:7], s25 offen offset:3072 sc1
  buffer_load_dwordx4 v[80:83], v175, s[4:7], s25 offen offset:0 sc1
  buffer_load_dwordx4 v[84:87], v175, s[4:7], s25 offen offset:1024 sc1
  v_mov_b32 v88, 0
  v_mov_b32 v89, 0
  v_mov_b32 v90, 0
  v_mov_b32 v91, 0
  v_mov_b32 v92, 0
  v_mov_b32 v93, 0
  v_mov_b32 v94, 0
  v_mov_b32 v95, 0
CH_4B_L0:
  s_waitcnt vmcnt(5)
  v_max_u32 v135, v64, v66
  v_cmp_eq_u32 vcc, -1, v135
  s_cbranch_vccnz CH_4B_R0
CH_4B_S0:
  v_smfmac_f32_16x16x64_bf16 v[88:91], v[64:67], a[120:127], v3
  v_smfmac_f32_16x16x64_bf16 v[92:95], v[64:67], a[128:135], v3
CH_4B_L1:
  s_waitcnt vmcnt(4)
  v_max_u32 v135, v68, v70
  v_cmp_eq_u32 vcc, -1, v135
  s_cbranch_vccnz CH_4B_R1
CH_4B_S1:
  v_smfmac_f32_16x16x64_bf16 v[88:91], v[68:71], a[136:143], v3
  v_smfmac_f32_16x16x64_bf16 v[92:95], v[68:71], a[144:151], v3
CH_4B_L2:
  s_waitcnt vmcnt(3)
  v_max_u32 v135, v72, v74
  v_cmp_eq_u32 vcc, -1, v135
  s_cbranch_vccnz CH_4B_R2
CH_4B_S2:
  v_smfmac_f32_16x16x64_bf16 v[88:91], v[72:75], a[152:159], v3
  v_smfmac_f32_16x16x64_bf16 v[92:95], v[72:75], a[160:167], v3
CH_4B_L3:
  s_waitcnt vmcnt(2)
  v_max_u32 v135, v76, v78
  v_cmp_eq_u32 vcc, -1, v135
  s_cbranch_vccnz CH_4B_R3
CH_4B_S3:
  v_smfmac_f32_16x16x64_bf16 v[88:91], v[76:79], a[168:175], v3
  v_smfmac_f32_16x16x64_bf16 v[92:95], v[76:79], a[176:183], v3
CH_4B_L4:
  s_waitcnt vmcnt(1)
  v_max_u32 v135, v80, v82
  v_cmp_eq_u32 vcc, -1, v135
  s_cbranch_vccnz CH_4B_R4
CH_4B_S4:
  v_smfmac_f32_16x16x64_bf16 v[88:91], v[80:83], a[184:191], v3
  v_smfmac_f32_16x16x64_bf16 v[92:95], v[80:83], a[192:199], v3
CH_4B_L5:
  s_waitcnt vmcnt(0)
  v_max_u32 v135, v84, v86
  v_cmp_eq_u32 vcc, -1, v135
  s_cbranch_vccnz CH_4B_R5
CH_4B_S5:
  v_smfmac_f32_16x16x64_bf16 v[88:91], v[84:87], a[200:207], v3
  v_smfmac_f32_16x16x64_bf16 v[92:95], v[84:87], a[208:215], v3
  s_nop 6
  v_permlane32_swap_b32 v88, v89
  v_permlane32_swap_b32 v90, v91
  v_add_f32 v88, v88, v89
  v_add_f32 v90, v90, v91
  ds_write_b32 v6, v88 offset:0
  ds_write_b32 v6, v90 offset:288
  v_permlane32_swap_b32 v92, v93
  v_permlane32_swap_b32 v94, v95
  v_add_f32 v92, v92, v93
  v_add_f32 v94, v94, v95
  ds_write_b32 v6, v92 offset:64
  ds_write_b32 v6, v94 offset:352
  s_waitcnt lgkmcnt(0)
  s_branch CH_4_b4
CH_4_nb:
  s_waitcnt vmcnt(0)
CH_4_b4:
  s_barrier
  s_cmp_eq_u32 s16, 0
  s_cbranch_scc1 CH_4_w0c
  v_mov_b32 v40, 0
  v_mov_b32 v41, 0
  v_mov_b32 v42, 0
  v_mov_b32 v43, 0
  v_mov_b32 v44, 0
  v_mov_b32 v45, 0
  v_mov_b32 v46, 0
  v_mov_b32 v47, 0
  v_mov_b32 v48, 0
  v_mov_b32 v49, 0
  v_mov_b32 v50, 0
  v_mov_b32 v51, 0
  s_cmp_eq_u32 s16, 1
  s_cbranch_scc0 CH_4_b5
  s_lshl_b32 s57, s17, 5
  s_add_u32 s57, s57, s18
  s_lshl_b32 s57, s57, 2
  s_add_u32 s57, s57, 1843200
  v_mov_b32 v134, s20
  v_mov_b32 v135, 0
  s_mov_b64 exec, 1
  buffer_store_dword v134, v135, s[4:7], s57 offen sc1
  s_mov_b64 exec, -1
  s_add_u32 s57, s32, 102760448
  s_mov_b64 exec, s[48:49]
  buffer_store_dwordx4 v[96:99], v12, s[4:7], s57 offen sc1
  s_mov_b64 exec, s[50:51]
  buffer_store_dwordx4 v[100:103], v13, s[4:7], s57 offen sc1
  s_mov_b64 exec, -1
  s_add_u32 s57, s32, 109051904
  s_mov_b64 exec, s[52:53]
  buffer_store_dwordx2 v[164:165], v15, s[4:7], s57 offen offset:0 sc1
  buffer_store_dwordx2 v[166:167], v15, s[4:7], s57 offen offset:256 sc1
  buffer_store_dwordx2 v[168:169], v15, s[4:7], s57 offen offset:512 sc1
  s_mov_b64 exec, -1
  s_add_u32 s59, s20, 2
  s_cmp_ge_u32 s59, 64
  s_cbranch_scc1 CH_4_npf
  s_and_b32 s57, s59, 7
  s_cmp_eq_u32 s57, 0
  s_cbranch_scc0 CH_4_kg
  s_lshl_b32 s57, s59, 3
  s_add_u32 s57, s57, 1835008
  s_mov_b32 s58, 96
  v_mov_b32 v135, 0
CH_4_kl:
  buffer_load_dword v134, v135, s[4:7], s57 offen sc1
  s_add_u32 s21, s21, 1
  s_waitcnt vmcnt(0)
  v_cmp_gt_u32 vcc, s58, v134
  s_cbranch_vccz CH_4_kd
  s_sleep 2
  s_cmp_lt_u32 s21, 400000
  s_cbranch_scc1 CH_4_kl
CH_4_kd:
CH_4_kg:
  s_mov_b32 s33, s59
  s_lshl_b32 s33, s33, 5
  s_add_u32 s33, s33, s35
  s_mul_i32 s33, s33, 12288
  s_add_u32 s57, s33, 27262976
  s_add_u32 s58, s57, 128
  s_mov_b32 m0, s38
  s_add_u32 s33, s33, 52428800
  buffer_load_dwordx4 v176, s[4:7], s57 offen lds
  s_add_u32 m0, s38, 1024
  s_nop 0
  buffer_load_dwordx4 v177, s[4:7], s57 offen lds
  s_add_u32 m0, s38, 2048
  s_nop 0
  buffer_load_dwordx4 v176, s[4:7], s58 offen lds
  s_add_u32 m0, s38, 3072
  s_nop 0
  buffer_load_dwordx4 v177, s[4:7], s58 offen lds
  s_mul_i32 s57, s36, 48
  s_add_u32 s57, s57, 0
  s_lshr_b32 s58, s57, 5
  s_lshl_b32 s58, s58, 11
  s_and_b32 s57, s57, 31
  s_lshl_b32 s57, s57, 4
  s_add_u32 s57, s57, s58
  s_add_u32 s57, s57, s33
  s_add_u32 m0, s38, 4096
  s_nop 0
  buffer_load_dwordx4 v178, s[4:7], s57 offen lds
  s_mul_i32 s57, s36, 48
  s_add_u32 s57, s57, 16
  s_lshr_b32 s58, s57, 5
  s_lshl_b32 s58, s58, 11
  s_and_b32 s57, s57, 31
  s_lshl_b32 s57, s57, 4
  s_add_u32 s57, s57, s58
  s_add_u32 s57, s57, s33
  s_add_u32 m0, s38, 5120
  s_nop 0
  buffer_load_dwordx4 v178, s[4:7], s57 offen lds
  s_mul_i32 s57, s36, 48
  s_add_u32 s57, s57, 32
  s_lshr_b32 s58, s57, 5
  s_lshl_b32 s58, s58, 11
  s_and_b32 s57, s57, 31
  s_lshl_b32 s57, s57, 4
  s_add_u32 s57, s57, s58
  s_add_u32 s57, s57, s33
  s_add_u32 m0, s38, 6144
  s_nop 0
  buffer_load_dwordx4 v178, s[4:7], s57 offen lds
CH_4_npf:
  s_cmp_ge_u32 s18, 20
  s_cbranch_scc1 CH_4_b5
  s_lshl_b32 s57, s18, 9
  s_xor_b32 s58, s30, 65536
  s_add_u32 s58, s58, s57
  buffer_store_dwordx2 v[170:171], v18, s[4:7], s58 offen sc1
  s_branch CH_4_b5
CH_4_w0c:
  s_cmp_ge_u32 s18, 20
  s_cbranch_scc1 CH_4_w0h
  ds_read_b128 v[108:111], v17 offset:0
  ds_read_b128 v[112:115], v17 offset:1152
  ds_read_b128 v[116:119], v17 offset:2304
  ds_read_b128 v[120:123], v17 offset:3456
  s_bfe_u32 s19, s20, 0x10001
  s_add_u32 s57, s27, s29
  s_add_u32 s59, s28, s29
  s_waitcnt lgkmcnt(2)
  v_add_f32 v108, v108, v112
  v_add_f32 v109, v109, v113
  v_add_f32 v110, v110, v114
  v_add_f32 v111, v111, v115
  s_waitcnt lgkmcnt(0)
  v_add_f32 v116, v116, v120
  v_add_f32 v117, v117, v121
  v_add_f32 v118, v118, v122
  v_add_f32 v119, v119, v123
  v_add_f32 v108, v108, v116
  v_add_f32 v109, v109, v117
  v_add_f32 v110, v110, v118
  v_add_f32 v111, v111, v119
  v_and_or_b32 v108, v108, -2, s19
  buffer_store_dwordx4 v[108:111], v2, s[4:7], s57 offen sc1
  s_xor_b32 s60, s31, 1024
  s_add_u32 s60, s60, s59
  s_xor_b32 s61, s31, 2048
  s_add_u32 s61, s61, s59
  s_xor_b32 s62, s31, 3072
  s_add_u32 s62, s62, s59
  s_lshl_b32 s59, s18, 9
  s_add_u32 s59, s59, s30
  v_mov_b32 v40, 0
  v_mov_b32 v41, 0
  v_mov_b32 v42, 0
  v_mov_b32 v43, 0
  v_mov_b32 v44, 0
  v_mov_b32 v45, 0
  v_mov_b32 v46, 0
  v_mov_b32 v47, 0
  v_mov_b32 v48, 0
  v_mov_b32 v49, 0
  v_mov_b32 v50, 0
  v_mov_b32 v51, 0
  v_add_u32 v104, s37, v2
  ds_read_b128 v[136:139], v104 offset:0
  s_waitcnt lgkmcnt(0)
  ds_read_b128 v[140:143], v104 offset:1024
  s_waitcnt lgkmcnt(0)
  ds_read_b128 v[144:147], v104 offset:2048
  s_waitcnt lgkmcnt(0)
  ds_read_b128 v[148:151], v104 offset:3072
  s_waitcnt lgkmcnt(0)
  ds_read_b128 v[152:155], v104 offset:4096
  s_waitcnt lgkmcnt(0)
  ds_read_b128 v[156:159], v104 offset:5120
  s_waitcnt lgkmcnt(0)
  buffer_load_dwordx4 v[180:183], v2, s[4:7], s60 offen sc1
  buffer_load_dwordx4 v[184:187], v2, s[4:7], s61 offen sc1
  buffer_load_dwordx4 v[188:191], v2, s[4:7], s62 offen sc1
  ds_read_b128 v[160:163], v104 offset:6144
  s_waitcnt lgkmcnt(0)
  ds_read_b32 v105, v104
  s_waitcnt lgkmcnt(0)
  buffer_load_dwordx4 v[192:195], v2, s[4:7], s60 offen sc1
  buffer_load_dwordx4 v[196:199], v2, s[4:7], s61 offen sc1
  buffer_load_dwordx4 v[200:203], v2, s[4:7], s62 offen sc1
  ds_read_b32 v105, v104
  s_waitcnt lgkmcnt(0)
  ds_read_b32 v105, v104
  s_waitcnt lgkmcnt(0)
  buffer_load_dwordx4 v[204:207], v2, s[4:7], s60 offen sc1
  buffer_load_dwordx4 v[208:211], v2, s[4:7], s61 offen sc1
  buffer_load_dwordx4 v[212:215], v2, s[4:7], s62 offen sc1
  ds_read_b32 v105, v104
  s_waitcnt lgkmcnt(0)
  ds_read_b32 v105, v104
  s_waitcnt lgkmcnt(0)
  buffer_load_dwordx4 v[216:219], v2, s[4:7], s60 offen sc1
  buffer_load_dwordx4 v[220:223], v2, s[4:7], s61 offen sc1
  buffer_load_dwordx4 v[224:227], v2, s[4:7], s62 offen sc1
  ds_read_b32 v105, v104
  s_waitcnt lgkmcnt(0)
  ds_read_b32 v105, v104
  s_waitcnt lgkmcnt(0)
  buffer_load_dwordx4 v[228:231], v2, s[4:7], s60 offen sc1
  buffer_load_dwordx4 v[232:235], v2, s[4:7], s61 offen sc1
  buffer_load_dwordx4 v[236:239], v2, s[4:7], s62 offen sc1
CH_4_cl:
  s_waitcnt vmcnt(12)
  v_bitop3_b32 v112, v180, v184, s19 bitop3:0x7e
  v_xor_b32 v113, s19, v188
  v_bitop3_b32 v112, v112, v113, 1 bitop3:0xa8
  v_cmp_eq_u32 vcc, 1, v112
  s_cbranch_vccz CH_4_ok0
  s_add_u32 s21, s21, 1
  buffer_load_dwordx4 v[180:183], v2, s[4:7], s60 offen sc1
  buffer_load_dwordx4 v[184:187], v2, s[4:7], s61 offen sc1
  buffer_load_dwordx4 v[188:191], v2, s[4:7], s62 offen sc1
  s_waitcnt vmcnt(12)
  v_bitop3_b32 v112, v192, v196, s19 bitop3:0x7e
  v_xor_b32 v113, s19, v200
  v_bitop3_b32 v112, v112, v113, 1 bitop3:0xa8
  v_cmp_eq_u32 vcc, 1, v112
  s_cbranch_vccz CH_4_ok1
  s_add_u32 s21, s21, 1
  buffer_load_dwordx4 v[192:195], v2, s[4:7], s60 offen sc1
  buffer_load_dwordx4 v[196:199], v2, s[4:7], s61 offen sc1
  buffer_load_dwordx4 v[200:203], v2, s[4:7], s62 offen sc1
  s_waitcnt vmcnt(12)
  v_bitop3_b32 v112, v204, v208, s19 bitop3:0x7e
  v_xor_b32 v113, s19, v212
  v_bitop3_b32 v112, v112, v113, 1 bitop3:0xa8
  v_cmp_eq_u32 vcc, 1, v112
  s_cbranch_vccz CH_4_ok2
  s_add_u32 s21, s21, 1
  buffer_load_dwordx4 v[204:207], v2, s[4:7], s60 offen sc1
  buffer_load_dwordx4 v[208:211], v2, s[4:7], s61 offen sc1
  buffer_load_dwordx4 v[212:215], v2, s[4:7], s62 offen sc1
  s_waitcnt vmcnt(12)
  v_bitop3_b32 v112, v216, v220, s19 bitop3:0x7e
  v_xor_b32 v113, s19, v224
  v_bitop3_b32 v112, v112, v113, 1 bitop3:0xa8
  v_cmp_eq_u32 vcc, 1, v112
  s_cbranch_vccz CH_4_ok3
  s_add_u32 s21, s21, 1
  buffer_load_dwordx4 v[216:219], v2, s[4:7], s60 offen sc1
  buffer_load_dwordx4 v[220:223], v2, s[4:7], s61 offen sc1
  buffer_load_dwordx4 v[224:227], v2, s[4:7], s62 offen sc1
  s_waitcnt vmcnt(12)
  v_bitop3_b32 v112, v228, v232, s19 bitop3:0x7e
  v_xor_b32 v113, s19, v236
  v_bitop3_b32 v112, v112, v113, 1 bitop3:0xa8
  v_cmp_eq_u32 vcc, 1, v112
  s_cbranch_vccz CH_4_ok4
  s_add_u32 s21, s21, 1
  s_cmp_lt_u32 s21, 400000
  s_cbranch_scc0 CH_4_ok4
  buffer_load_dwordx4 v[228:231], v2, s[4:7], s60 offen sc1
  buffer_load_dwordx4 v[232:235], v2, s[4:7], s61 offen sc1
  buffer_load_dwordx4 v[236:239], v2, s[4:7], s62 offen sc1
  s_branch CH_4_cl
CH_4_ok0:
  v_add_f32 v108, v108, v180
  v_add_f32 v109, v109, v181
  v_add_f32 v110, v110, v182
  v_add_f32 v111, v111, v183
  v_add_f32 v112, v184, v188
  v_add_f32 v113, v185, v189
  v_add_f32 v114, v186, v190
  v_add_f32 v115, v187, v191
  v_add_f32 v108, v108, v112
  v_add_f32 v109, v109, v113
  v_add_f32 v110, v110, v114
  v_add_f32 v111, v111, v115
  v_cvt_pk_bf16_f32 v104, v108, v109
  v_cvt_pk_bf16_f32 v105, v110, v111
  buffer_store_dwordx2 v[104:105], v18, s[4:7], s59 offen sc1
  s_branch CH_4_probe
CH_4_ok1:
  v_add_f32 v108, v108, v192
  v_add_f32 v109, v109, v193
  v_add_f32 v110, v110, v194
  v_add_f32 v111, v111, v195
  v_add_f32 v112, v196, v200
  v_add_f32 v113, v197, v201
  v_add_f32 v114, v198, v202
  v_add_f32 v115, v199, v203
  v_add_f32 v108, v108, v112
  v_add_f32 v109, v109, v113
  v_add_f32 v110, v110, v114
  v_add_f32 v111, v111, v115
  v_cvt_pk_bf16_f32 v104, v108, v109
  v_cvt_pk_bf16_f32 v105, v110, v111
  buffer_store_dwordx2 v[104:105], v18, s[4:7], s59 offen sc1
  s_branch CH_4_probe
CH_4_ok2:
  v_add_f32 v108, v108, v204
  v_add_f32 v109, v109, v205
  v_add_f32 v110, v110, v206
  v_add_f32 v111, v111, v207
  v_add_f32 v112, v208, v212
  v_add_f32 v113, v209, v213
  v_add_f32 v114, v210, v214
  v_add_f32 v115, v211, v215
  v_add_f32 v108, v108, v112
  v_add_f32 v109, v109, v113
  v_add_f32 v110, v110, v114
  v_add_f32 v111, v111, v115
  v_cvt_pk_bf16_f32 v104, v108, v109
  v_cvt_pk_bf16_f32 v105, v110, v111
  buffer_store_dwordx2 v[104:105], v18, s[4:7], s59 offen sc1
  s_branch CH_4_probe
CH_4_ok3:
  v_add_f32 v108, v108, v216
  v_add_f32 v109, v109, v217
  v_add_f32 v110, v110, v218
  v_add_f32 v111, v111, v219
  v_add_f32 v112, v220, v224
  v_add_f32 v113, v221, v225
  v_add_f32 v114, v222, v226
  v_add_f32 v115, v223, v227
  v_add_f32 v108, v108, v112
  v_add_f32 v109, v109, v113
  v_add_f32 v110, v110, v114
  v_add_f32 v111, v111, v115
  v_cvt_pk_bf16_f32 v104, v108, v109
  v_cvt_pk_bf16_f32 v105, v110, v111
  buffer_store_dwordx2 v[104:105], v18, s[4:7], s59 offen sc1
  s_branch CH_4_probe
CH_4_ok4:
  v_add_f32 v108, v108, v228
  v_add_f32 v109, v109, v229
  v_add_f32 v110, v110, v230
  v_add_f32 v111, v111, v231
  v_add_f32 v112, v232, v236
  v_add_f32 v113, v233, v237
  v_add_f32 v114, v234, v238
  v_add_f32 v115, v235, v239
  v_add_f32 v108, v108, v112
  v_add_f32 v109, v109, v113
  v_add_f32 v110, v110, v114
  v_add_f32 v111, v111, v115
  v_cvt_pk_bf16_f32 v104, v108, v109
  v_cvt_pk_bf16_f32 v105, v110, v111
  buffer_store_dwordx2 v[104:105], v18, s[4:7], s59 offen sc1
  s_branch CH_4_probe
CH_4_w0h:
  v_mov_b32 v40, 0
  v_mov_b32 v41, 0
  v_mov_b32 v42, 0
  v_mov_b32 v43, 0
  v_mov_b32 v44, 0
  v_mov_b32 v45, 0
  v_mov_b32 v46, 0
  v_mov_b32 v47, 0
  v_mov_b32 v48, 0
  v_mov_b32 v49, 0
  v_mov_b32 v50, 0
  v_mov_b32 v51, 0
  v_add_u32 v104, s37, v2
  ds_read_b128 v[136:139], v104 offset:0
  ds_read_b128 v[140:143], v104 offset:1024
  ds_read_b128 v[144:147], v104 offset:2048
  ds_read_b128 v[148:151], v104 offset:3072
  ds_read_b128 v[152:155], v104 offset:4096
  ds_read_b128 v[156:159], v104 offset:5120
  ds_read_b128 v[160:163], v104 offset:6144
CH_4_probe:
  s_mov_b64 exec, 0xfffff
CH_4_prl:
  buffer_load_dword v106, v240, s[4:7], s30 offen sc1
  s_add_u32 s21, s21, 1
  s_waitcnt vmcnt(0)
  v_cmp_eq_u32 vcc, -1, v106
  s_cbranch_vccz CH_4_prd
  s_cmp_lt_u32 s21, 400000
  s_cbranch_scc1 CH_4_prl
CH_4_prd:
  s_mov_b64 exec, -1
CH_4_b5:
  s_waitcnt lgkmcnt(0)
  s_barrier
  s_branch CH_4_loop
CH_4D_R0:
  s_add_u32 s21, s21, 1
  s_cmp_lt_u32 s21, 400000
  s_cbranch_scc0 CH_4D_S0
  buffer_load_dwordx4 v[20:23], v4, s[4:7], s59 offen offset:0 sc1
  buffer_load_dwordx4 v[24:27], v4, s[4:7], s59 offen offset:1024 sc1
  buffer_load_dwordx4 v[28:31], v4, s[4:7], s59 offen offset:2048 sc1
  buffer_load_dwordx4 v[32:35], v4, s[4:7], s59 offen offset:3072 sc1
  buffer_load_dwordx4 v[36:39], v174, s[4:7], s59 offen sc1
  s_branch CH_4D_L0
CH_4D_R1:
  s_add_u32 s21, s21, 1
  s_cmp_lt_u32 s21, 400000
  s_cbranch_scc0 CH_4D_S1
  buffer_load_dwordx4 v[24:27], v4, s[4:7], s59 offen offset:1024 sc1
  buffer_load_dwordx4 v[28:31], v4, s[4:7], s59 offen offset:2048 sc1
  buffer_load_dwordx4 v[32:35], v4, s[4:7], s59 offen offset:3072 sc1
  buffer_load_dwordx4 v[36:39], v174, s[4:7], s59 offen sc1
  s_branch CH_4D_L1
CH_4D_R2:
  s_add_u32 s21, s21, 1
  s_cmp_lt_u32 s21, 400000
  s_cbranch_scc0 CH_4D_S2
  buffer_load_dwordx4 v[28:31], v4, s[4:7], s59 offen offset:2048 sc1
  buffer_load_dwordx4 v[32:35], v4, s[4:7], s59 offen offset:3072 sc1
  buffer_load_dwordx4 v[36:39], v174, s[4:7], s59 offen sc1
  s_branch CH_4D_L2
CH_4D_R3:
  s_add_u32 s21, s21, 1
  s_cmp_lt_u32 s21, 400000
  s_cbranch_scc0 CH_4D_S3
  buffer_load_dwordx4 v[32:35], v4, s[4:7], s59 offen offset:3072 sc1
  buffer_load_dwordx4 v[36:39], v174, s[4:7], s59 offen sc1
  s_branch CH_4D_L3
CH_4D_R4:
  s_add_u32 s21, s21, 1
  s_cmp_lt_u32 s21, 400000
  s_cbranch_scc0 CH_4D_S4
  buffer_load_dwordx4 v[36:39], v174, s[4:7], s59 offen sc1
  s_branch CH_4D_L4
CH_4_apr:
  s_add_u32 s21, s21, 1
  s_cmp_lt_u32 s21, 400000
  s_cbranch_scc0 CH_4_apd
  buffer_load_dwordx4 v[104:107], v10, s[4:7], s23 offen offset:0 sc1
  buffer_load_dwordx4 v[108:111], v10, s[4:7], s23 offen offset:1536 sc1
  buffer_load_dwordx4 v[112:115], v179, s[4:7], s23 offen offset:0 sc1
  buffer_load_dwordx4 v[116:119], v179, s[4:7], s23 offen offset:1536 sc1
  buffer_load_dwordx4 v[120:123], v11, s[4:7], s23 offen offset:0 sc1
  buffer_load_dwordx4 v[124:127], v11, s[4:7], s23 offen offset:1536 sc1
  s_branch CH_4_apl
CH_4B_R0:
  s_add_u32 s21, s21, 1
  s_cmp_lt_u32 s21, 400000
  s_cbranch_scc0 CH_4B_S0
  buffer_load_dwordx4 v[64:67], v7, s[4:7], s25 offen offset:0 sc1
  buffer_load_dwordx4 v[68:71], v7, s[4:7], s25 offen offset:1024 sc1
  buffer_load_dwordx4 v[72:75], v7, s[4:7], s25 offen offset:2048 sc1
  buffer_load_dwordx4 v[76:79], v7, s[4:7], s25 offen offset:3072 sc1
  buffer_load_dwordx4 v[80:83], v175, s[4:7], s25 offen offset:0 sc1
  buffer_load_dwordx4 v[84:87], v175, s[4:7], s25 offen offset:1024 sc1
  s_branch CH_4B_L0
CH_4B_R1:
  s_add_u32 s21, s21, 1
  s_cmp_lt_u32 s21, 400000
  s_cbranch_scc0 CH_4B_S1
  buffer_load_dwordx4 v[68:71], v7, s[4:7], s25 offen offset:1024 sc1
  buffer_load_dwordx4 v[72:75], v7, s[4:7], s25 offen offset:2048 sc1
  buffer_load_dwordx4 v[76:79], v7, s[4:7], s25 offen offset:3072 sc1
  buffer_load_dwordx4 v[80:83], v175, s[4:7], s25 offen offset:0 sc1
  buffer_load_dwordx4 v[84:87], v175, s[4:7], s25 offen offset:1024 sc1
  s_branch CH_4B_L1
CH_4B_R2:
  s_add_u32 s21, s21, 1
  s_cmp_lt_u32 s21, 400000
  s_cbranch_scc0 CH_4B_S2
  buffer_load_dwordx4 v[72:75], v7, s[4:7], s25 offen offset:2048 sc1
  buffer_load_dwordx4 v[76:79], v7, s[4:7], s25 offen offset:3072 sc1
  buffer_load_dwordx4 v[80:83], v175, s[4:7], s25 offen offset:0 sc1
  buffer_load_dwordx4 v[84:87], v175, s[4:7], s25 offen offset:1024 sc1
  s_branch CH_4B_L2
CH_4B_R3:
  s_add_u32 s21, s21, 1
  s_cmp_lt_u32 s21, 400000
  s_cbranch_scc0 CH_4B_S3
  buffer_load_dwordx4 v[76:79], v7, s[4:7], s25 offen offset:3072 sc1
  buffer_load_dwordx4 v[80:83], v175, s[4:7], s25 offen offset:0 sc1
  buffer_load_dwordx4 v[84:87], v175, s[4:7], s25 offen offset:1024 sc1
  s_branch CH_4B_L3
CH_4B_R4:
  s_add_u32 s21, s21, 1
  s_cmp_lt_u32 s21, 400000
  s_cbranch_scc0 CH_4B_S4
  buffer_load_dwordx4 v[80:83], v175, s[4:7], s25 offen offset:0 sc1
  buffer_load_dwordx4 v[84:87], v175, s[4:7], s25 offen offset:1024 sc1
  s_branch CH_4B_L4
CH_4B_R5:
  s_add_u32 s21, s21, 1
  s_cmp_lt_u32 s21, 400000
  s_cbranch_scc0 CH_4B_S5
  buffer_load_dwordx4 v[84:87], v175, s[4:7], s25 offen offset:1024 sc1
  s_branch CH_4B_L5
CH_4_last:
  s_cmp_eq_u32 s16, 1
  s_cbranch_scc0 CH_4_end
  s_lshl_b32 s57, s17, 5
  s_add_u32 s57, s57, s18
  s_lshl_b32 s57, s57, 2
  s_add_u32 s57, s57, 1843200
  v_mov_b32 v134, 63
  v_mov_b32 v135, 0
  s_mov_b64 exec, 1
  buffer_store_dword v134, v135, s[4:7], s57 offen sc1
  s_mov_b64 exec, -1
  s_add_u32 s57, s32, 102760448
  s_mov_b64 exec, s[48:49]
  buffer_store_dwordx4 v[96:99], v12, s[4:7], s57 offen sc1
  s_mov_b64 exec, s[50:51]
  buffer_store_dwordx4 v[100:103], v13, s[4:7], s57 offen sc1
  s_mov_b64 exec, -1
  ds_read_b128 v[104:107], v14 offset:0
  ds_read_b128 v[108:111], v14 offset:1536
  ds_read_b128 v[112:115], v14 offset:512
  ds_read_b128 v[116:119], v14 offset:2048
  ds_read_b128 v[120:123], v14 offset:1024
  ds_read_b128 v[124:127], v14 offset:2560
  s_waitcnt lgkmcnt(4)
  v_add_f32 v104, v104, v108
  v_add_f32 v105, v105, v109
  v_add_f32 v106, v106, v110
  v_add_f32 v107, v107, v111
  v_cvt_pk_bf16_f32 v164, v104, v105
  v_cvt_pk_bf16_f32 v165, v106, v107
  s_waitcnt lgkmcnt(2)
  v_add_f32 v112, v112, v116
  v_add_f32 v113, v113, v117
  v_add_f32 v114, v114, v118
  v_add_f32 v115, v115, v119
  v_cvt_pk_bf16_f32 v166, v112, v113
  v_cvt_pk_bf16_f32 v167, v114, v115
  s_waitcnt lgkmcnt(0)
  v_add_f32 v120, v120, v124
  v_add_f32 v121, v121, v125
  v_add_f32 v122, v122, v126
  v_add_f32 v123, v123, v127
  v_cvt_pk_bf16_f32 v168, v120, v121
  v_cvt_pk_bf16_f32 v169, v122, v123
  s_add_u32 s57, s32, 109051904
  s_mov_b64 exec, s[52:53]
  buffer_store_dwordx2 v[164:165], v15, s[4:7], s57 offen offset:0 sc1
  buffer_store_dwordx2 v[166:167], v15, s[4:7], s57 offen offset:256 sc1
  buffer_store_dwordx2 v[168:169], v15, s[4:7], s57 offen offset:512 sc1
  s_mov_b64 exec, -1
  s_waitcnt vmcnt(0)
  s_lshl_b32 s57, s17, 5
  s_add_u32 s57, s57, s18
  s_lshl_b32 s57, s57, 2
  s_add_u32 s57, s57, 1843200
  v_mov_b32 v134, 64
  v_mov_b32 v135, 0
  s_mov_b64 exec, 1
  buffer_store_dword v134, v135, s[4:7], s57 offen sc1
  s_mov_b64 exec, -1
CH_4_end:
  s_waitcnt vmcnt(0)
CH_DONE:
  s_barrier
  s_lshl_b32 s56, s17, 5
L1_OTHER:
  s_mov_b32 s80, s16
  s_bfe_u32 s79, s56, 0x20005
  s_load_dwordx2 s[84:85], s[0:1], 96
  s_mov_b32 s86, 0x10000000
  s_mov_b32 s87, 0x00020000
  s_waitcnt lgkmcnt(0)
  s_lshl_b32 s97, s79, 6
  s_add_u32 s97, s97, 1838592
  s_cmp_eq_u32 s80, 0
  s_cbranch_scc0 TI_5
  v_mov_b32 v255, 1
  s_mov_b64 exec, 1
  buffer_atomic_add v255, off, s[84:87], s97 sc0 sc1
  s_mov_b64 exec, -1
TI_5:
  s_waitcnt vmcnt(0)
  v_readfirstlane_b32 s96, v255
BG_LOOP:
  s_cmp_eq_u32 s80, 0
  s_cbranch_scc0 BG_T1
  v_mov_b32 v2, 131072
  v_mov_b32 v3, s96
  ds_write_b32 v2, v3
  s_waitcnt lgkmcnt(0)
BG_T1:
  s_barrier
  v_mov_b32 v2, 131072
  ds_read_b32 v3, v2
  v_and_b32 v1, 63, v0
  s_waitcnt lgkmcnt(0)
  v_readfirstlane_b32 s81, v3
  s_mov_b32 s98, 0
  s_mov_b32 s99, 1
  s_barrier
  s_cmp_lt_u32 s81, 108
  s_cbranch_scc1 BG_R0
  s_cmp_lt_u32 s81, 124
  s_cbranch_scc1 BG_R1
  s_cmp_lt_u32 s81, 172
  s_cbranch_scc1 BG_R2
  s_cmp_lt_u32 s81, 204
  s_cbranch_scc1 BG_R3
  s_cmp_lt_u32 s81, 284
  s_cbranch_scc1 BG_R4
  s_cmp_lt_u32 s81, 300
  s_cbranch_scc1 BG_R5
  s_cmp_lt_u32 s81, 306
  s_cbranch_scc1 BG_R6
  s_cmp_lt_u32 s81, 318
  s_cbranch_scc1 BG_R7
  s_cmp_lt_u32 s81, 325
  s_cbranch_scc1 BG_R8
  s_cmp_lt_u32 s81, 337
  s_cbranch_scc1 BG_R9
  s_cmp_lt_u32 s81, 343
  s_cbranch_scc1 BG_R10
  s_cmp_lt_u32 s81, 359
  s_cbranch_scc1 BG_R11
  s_cmp_lt_u32 s81, 379
  s_cbranch_scc1 BG_R12
  s_cmp_lt_u32 s81, 387
  s_cbranch_scc1 BG_R13
  s_cmp_lt_u32 s81, 407
  s_cbranch_scc1 BG_R14
  s_cmp_lt_u32 s81, 487
  s_cbranch_scc1 BG_R15
  s_branch BG_END
BG_R0:
  s_sub_u32 s82, s81, 0
  s_mov_b32 s83, 0
  s_branch BG_KV
BG_R1:
  s_sub_u32 s82, s81, 108
  s_mov_b32 s83, 0
  s_branch BG_BQ
BG_R2:
  s_sub_u32 s82, s81, 124
  s_mov_b32 s83, 0
  s_branch BG_Q
BG_R3:
  s_sub_u32 s82, s81, 172
  s_mov_b32 s83, 0
  s_branch BG_BA
BG_R4:
  s_sub_u32 s82, s81, 204
  s_mov_b32 s83, 0
  s_branch BG_X
BG_R5:
  s_sub_u32 s82, s81, 284
  s_mov_b32 s83, 0
  s_branch BG_O5
BG_R6:
  s_sub_u32 s82, s81, 300
  s_mov_b32 s83, 0
  s_branch BG_BO
BG_R7:
  s_sub_u32 s82, s81, 306
  s_mov_b32 s83, 40
  s_branch BG_X
BG_R8:
  s_sub_u32 s82, s81, 318
  s_mov_b32 s83, 16
  s_branch BG_O5
BG_R9:
  s_sub_u32 s82, s81, 325
  s_mov_b32 s83, 46
  s_branch BG_X
BG_R10:
  s_sub_u32 s82, s81, 337
  s_mov_b32 s83, 23
  s_branch BG_OM
BG_R11:
  s_sub_u32 s82, s81, 343
  s_mov_b32 s83, 52
  s_branch BG_X
BG_R12:
  s_sub_u32 s82, s81, 359
  s_mov_b32 s83, 52
  s_branch BG_O1
BG_R13:
  s_sub_u32 s82, s81, 379
  s_mov_b32 s83, 60
  s_branch BG_X
BG_R14:
  s_sub_u32 s82, s81, 387
  s_mov_b32 s83, 56
  s_branch BG_O1
BG_R15:
  s_sub_u32 s82, s81, 407
  s_mov_b32 s83, 60
  s_branch BG_OK
BG_KV:
  s_mul_i32 s32, s82, 171
  s_lshr_b32 s32, s32, 11
  s_mul_i32 s34, s32, 12
  s_sub_u32 s33, s82, s34
  s_mul_i32 s34, s79, 12
  s_add_u32 s33, s33, s34
  s_mov_b32 s99, 2
  s_cmp_lt_u32 s32, 2
  s_cbranch_scc0 BG_KVF
  s_add_u32 s98, s32, 1
  s_mov_b32 s99, 1
  s_mov_b32 s32, 1
BG_KVF:
  s_sub_u32 s32, s32, 1
BG_KVX:
  s_lshl_b32 s90, s32, 6
  s_add_u32 s90, s90, 1835008
  s_branch BG_GEMM
BG_BQ:
  s_and_b32 s33, s82, 1
  s_lshl_b32 s34, s79, 1
  s_add_u32 s33, s33, s34
  s_add_u32 s33, s33, 72
  s_lshr_b32 s32, s82, 1
  s_mov_b32 s90, 1836032
  s_branch BG_GEMM
BG_Q:
  s_mul_i32 s32, s82, 43
  s_lshr_b32 s32, s32, 8
  s_mul_i32 s34, s32, 6
  s_sub_u32 s33, s82, s34
  s_mul_i32 s34, s79, 6
  s_add_u32 s33, s33, s34
  s_add_u32 s33, s33, 48
  s_lshl_b32 s90, s32, 6
  s_add_u32 s90, s90, 1835520
  s_branch BG_GEMM
BG_BO:
  s_and_b32 s32, s82, 1
  s_lshl_b32 s34, s79, 1
  s_add_u32 s32, s32, s34
  s_lshr_b32 s33, s82, 1
  s_add_u32 s33, s33, 80
  s_lshr_b32 s91, s32, 1
  s_lshl_b32 s91, s91, 6
  s_add_u32 s91, s91, 1836096
  s_cmp_eq_u32 s80, 0
  s_cbranch_scc0 W_6_d
  v_lshlrev_b32 v2, 2, v0
  s_mov_b32 s93, 0
  s_mov_b64 exec, 0x1
W_6_l:
  buffer_load_dword v3, v2, s[84:87], s91 offen sc1
  s_add_u32 s93, s93, 1
  s_waitcnt vmcnt(0)
  v_cmp_gt_u32 vcc, 32, v3
  s_cbranch_vccz W_6_k
  s_sleep 4
  s_cmp_lt_u32 s93, 200000
  s_cbranch_scc1 W_6_l
W_6_k:
  s_mov_b64 exec, -1
W_6_d:
  s_barrier
  s_mov_b32 s90, 0
BG_GEMM:
  s_load_dwordx2 s[40:41], s[0:1], 0
  s_load_dwordx2 s[42:43], s[0:1], 16
  s_load_dwordx2 s[44:45], s[0:1], 24
  s_load_dwordx2 s[46:47], s[0:1], 32
  s_load_dwordx2 s[48:49], s[0:1], 56
  s_load_dwordx2 s[50:51], s[0:1], 64
  s_load_dwordx2 s[12:13], s[0:1], 96
  s_mov_b32 s14, 0x10000000
  s_mov_b32 s15, 0x00020000
  s_load_dwordx2 s[16:17], s[0:1], 80
  s_mov_b32 s18, 0x500000
  s_mov_b32 s19, 0x00020000
  s_load_dwordx2 s[52:53], s[0:1], 72
  v_and_b32 v1, 63, v0
  v_lshrrev_b32 v22, 6, v0
  s_nop 0
  v_readfirstlane_b32 s26, v22
  s_and_b32 s27, s26, 1
  s_lshr_b32 s28, s26, 1
  s_lshl_b32 s24, s26, 12
  s_add_u32 s25, s24, 16384
  v_lshrrev_b32 v22, 2, v1
  s_lshl_b32 s34, s26, 6
  v_add_u32 v22, s34, v22
  v_mul_u32_u24 v22, 1280, v22
  v_lshrrev_b32 v23, 4, v1
  v_xor_b32 v23, v23, v1
  v_and_b32 v23, 3, v23
  v_lshlrev_b32 v23, 4, v23
  v_add_u32 v2, v22, v23
  v_add_u32 v3, 20480, v2
  v_add_u32 v4, 40960, v2
  v_add_u32 v5, 61440, v2
  v_and_b32 v22, 31, v1
  s_lshl_b32 s34, s28, 7
  v_add_u32 v22, s34, v22
  v_lshlrev_b32 v22, 6, v22
  v_lshrrev_b32 v23, 5, v1
  v_lshrrev_b32 v24, 2, v1
  v_and_b32 v24, 3, v24
  v_xor_b32 v23, v23, v24
  v_lshlrev_b32 v25, 4, v23
  v_add_u32 v10, v22, v25
  v_xor_b32 v23, 2, v23
  v_lshlrev_b32 v25, 4, v23
  v_add_u32 v11, v22, v25
  v_add_u32 v12, 0x10000, v10
  v_add_u32 v13, 0x10000, v11
  v_lshrrev_b32 v22, 5, v1
  v_lshlrev_b32 v22, 3, v22
  v_bfe_u32 v23, v1, 2, 2
  v_add_u32 v22, v22, v23
  v_lshlrev_b32 v22, 9, v22
  v_bfe_u32 v24, v1, 4, 1
  v_lshlrev_b32 v24, 5, v24
  v_and_b32 v25, 3, v1
  v_lshlrev_b32 v25, 3, v25
  v_add3_u32 v22, v22, v24, v25
  s_lshl_b32 s34, s27, 8
  s_add_u32 s34, s34, 16384
  v_add_u32 v22, s34, v22
  v_xor_b32 v24, 0, v23
  v_lshlrev_b32 v24, 6, v24
  v_add_u32 v14, v22, v24
  v_add_u32 v18, 0x10000, v14
  v_xor_b32 v24, 1, v23
  v_lshlrev_b32 v24, 6, v24
  v_add_u32 v15, v22, v24
  v_add_u32 v19, 0x10000, v15
  v_xor_b32 v24, 2, v23
  v_lshlrev_b32 v24, 6, v24
  v_add_u32 v16, v22, v24
  v_add_u32 v20, 0x10000, v16
  v_xor_b32 v24, 3, v23
  v_lshlrev_b32 v24, 6, v24
  v_add_u32 v17, v22, v24
  v_add_u32 v21, 0x10000, v17
  s_waitcnt lgkmcnt(0)
  s_mul_i32 s20, s32, 327680
  s_mov_b32 s6, 2621440
  s_mov_b32 s7, 0x00020000
  s_mov_b32 s11, 0x00020000
  s_cmp_ge_u32 s33, 80
  s_cbranch_scc1 BGG_BO
  s_cmp_ge_u32 s33, 72
  s_cbranch_scc1 BGG_B
  s_mov_b32 s4, s40
  s_mov_b32 s5, s41
  s_mov_b32 s10, 7864320
  s_mov_b32 s22, 12288
  s_cmp_ge_u32 s33, 48
  s_cbranch_scc1 BGG_Q
  s_cmp_ge_u32 s33, 24
  s_cbranch_scc1 BGG_V
  s_mov_b32 s8, s44
  s_mov_b32 s9, s45
  s_mov_b32 s30, 27262976
  s_mov_b32 s31, 0
  s_branch BGG_A
BGG_V:
  s_mov_b32 s8, s46
  s_mov_b32 s9, s47
  s_mov_b32 s30, 52428800
  s_mov_b32 s31, 1
  s_sub_u32 s33, s33, 24
  s_branch BGG_A
BGG_Q:
  s_mov_b32 s8, s42
  s_mov_b32 s9, s43
  s_mov_b32 s30, 2097152
  s_mov_b32 s31, 0
  s_sub_u32 s33, s33, 48
BGG_A:
  s_lshl_b32 s21, s33, 9
  s_lshl_b32 s34, s32, 3
  s_lshl_b32 s35, s28, 2
  s_add_u32 s34, s34, s35
  s_mul_i32 s34, s34, 393216
  s_add_u32 s30, s30, s34
  s_lshl_b32 s34, s33, 3
  s_lshl_b32 s35, s27, 2
  s_add_u32 s34, s34, s35
  s_lshl_b32 s34, s34, 11
  s_add_u32 s30, s30, s34
  s_branch BGG_GO
BGG_B:
  s_mov_b32 s4, s48
  s_mov_b32 s5, s49
  s_mov_b32 s8, s50
  s_mov_b32 s9, s51
  s_mov_b32 s10, 2457600
  s_mov_b32 s22, 3840
  s_sub_u32 s33, s33, 72
  s_lshl_b32 s21, s33, 9
  s_lshl_b32 s35, s33, 8
  s_lshl_b32 s34, s27, 7
  s_add_u32 s35, s35, s34
  s_cmp_ge_u32 s33, 5
  s_cbranch_scc1 BGG_BV
  s_mov_b32 s31, 2
  s_mov_b32 s30, 115343360
  s_cmp_ge_u32 s35, 640
  s_cbranch_scc0 BGG_BQ
  s_mov_b32 s30, 118489088
  s_sub_u32 s35, s35, 640
BGG_BQ:
  s_lshr_b32 s35, s35, 2
  s_lshl_b32 s34, s32, 3
  s_lshl_b32 s36, s28, 2
  s_add_u32 s34, s34, s36
  s_mul_i32 s34, s34, 1280
  s_add_u32 s30, s30, s34
  s_branch BGG_GO
BGG_BV:
  s_mov_b32 s31, 3
  s_sub_u32 s35, s35, 1280
  s_lshl_b32 s34, s32, 4
  s_lshl_b32 s36, s28, 3
  s_add_u32 s34, s34, s36
  s_mul_i32 s34, s34, 640
  s_add_u32 s30, s34, 121634816
  s_branch BGG_GO
BGG_BO:
  s_add_u32 s4, s12, 124780544
  s_addc_u32 s5, s13, 0
  s_mov_b32 s6, 2621440
  s_mov_b32 s8, s52
  s_mov_b32 s9, s53
  s_mov_b32 s10, 819200
  s_mov_b32 s22, 1280
  s_sub_u32 s33, s33, 80
  s_lshl_b32 s21, s33, 9
  s_mov_b32 s31, 4
  s_lshl_b32 s34, s32, 1
  s_add_u32 s34, s34, s28
  s_mul_i32 s30, s34, 327680
  s_lshl_b32 s35, s33, 1
  s_add_u32 s35, s35, s27
  s_lshl_b32 s34, s35, 8
  s_add_u32 s30, s30, s34
  s_add_u32 s30, s30, 1280
BGG_GO:
  s_mov_b32 s39, s35
  s_lshl_b32 s23, s22, 5
  v_lshrrev_b32 v22, 5, v1
  v_add_u32 v22, 0, v22
  v_lshlrev_b32 v23, 2, v22
  v_and_b32 v24, 31, v1
  v_xor_b32 v23, v23, v24
  v_lshlrev_b32 v23, 4, v23
  s_lshl_b32 s34, s26, 3
  v_add_u32 v22, s34, v22
  v_mul_lo_u32 v22, v22, s22
  v_add_u32 v6, v22, v23
  s_lshl_b32 s34, s22, 2
  v_add_u32 v8, s34, v6
  v_lshrrev_b32 v22, 5, v1
  v_add_u32 v22, 2, v22
  v_lshlrev_b32 v23, 2, v22
  v_and_b32 v24, 31, v1
  v_xor_b32 v23, v23, v24
  v_lshlrev_b32 v23, 4, v23
  s_lshl_b32 s34, s26, 3
  v_add_u32 v22, s34, v22
  v_mul_lo_u32 v22, v22, s22
  v_add_u32 v7, v22, v23
  s_lshl_b32 s34, s22, 2
  v_add_u32 v9, s34, v7
  s_mov_b32 s35, s39
  s_cmp_lg_u32 s98, 0
  s_cbranch_scc1 BGG_HALF
  s_and_b32 s34, s31, 1
  s_cmp_eq_u32 s34, 1
  s_cbranch_scc1 BGG_SWAP
  s_add_u32 m0, s24, 0
  s_nop 0
  buffer_load_dwordx4 v2, s[4:7], s20 offen lds
  s_add_u32 m0, s24, 1024
  s_nop 0
  buffer_load_dwordx4 v3, s[4:7], s20 offen lds
  s_add_u32 m0, s24, 2048
  s_nop 0
  buffer_load_dwordx4 v4, s[4:7], s20 offen lds
  s_add_u32 m0, s24, 3072
  s_nop 0
  buffer_load_dwordx4 v5, s[4:7], s20 offen lds
  s_add_u32 m0, s25, 0
  s_nop 0
  buffer_load_dwordx4 v6, s[8:11], s21 offen lds
  s_add_u32 m0, s25, 1024
  s_nop 0
  buffer_load_dwordx4 v7, s[8:11], s21 offen lds
  s_add_u32 m0, s25, 2048
  s_nop 0
  buffer_load_dwordx4 v8, s[8:11], s21 offen lds
  s_add_u32 m0, s25, 3072
  s_nop 0
  buffer_load_dwordx4 v9, s[8:11], s21 offen lds
  s_add_u32 s20, s20, 64
  s_add_u32 s21, s21, s23
  s_add_u32 m0, s24, 32768
  s_nop 0
  buffer_load_dwordx4 v2, s[4:7], s20 offen lds
  s_add_u32 m0, s24, 33792
  s_nop 0
  buffer_load_dwordx4 v3, s[4:7], s20 offen lds
  s_add_u32 m0, s24, 34816
  s_nop 0
  buffer_load_dwordx4 v4, s[4:7], s20 offen lds
  s_add_u32 m0, s24, 35840
  s_nop 0
  buffer_load_dwordx4 v5, s[4:7], s20 offen lds
  s_add_u32 m0, s25, 32768
  s_nop 0
  buffer_load_dwordx4 v6, s[8:11], s21 offen lds
  s_add_u32 m0, s25, 33792
  s_nop 0
  buffer_load_dwordx4 v7, s[8:11], s21 offen lds
  s_add_u32 m0, s25, 34816
  s_nop 0
  buffer_load_dwordx4 v8, s[8:11], s21 offen lds
  s_add_u32 m0, s25, 35840
  s_nop 0
  buffer_load_dwordx4 v9, s[8:11], s21 offen lds
  s_add_u32 s20, s20, 64
  s_add_u32 s21, s21, s23
  s_add_u32 m0, s24, 65536
  s_nop 0
  buffer_load_dwordx4 v2, s[4:7], s20 offen lds
  s_add_u32 m0, s24, 66560
  s_nop 0
  buffer_load_dwordx4 v3, s[4:7], s20 offen lds
  s_add_u32 m0, s24, 67584
  s_nop 0
  buffer_load_dwordx4 v4, s[4:7], s20 offen lds
  s_add_u32 m0, s24, 68608
  s_nop 0
  buffer_load_dwordx4 v5, s[4:7], s20 offen lds
  s_add_u32 m0, s25, 65536
  s_nop 0
  buffer_load_dwordx4 v6, s[8:11], s21 offen lds
  s_add_u32 m0, s25, 66560
  s_nop 0
  buffer_load_dwordx4 v7, s[8:11], s21 offen lds
  s_add_u32 m0, s25, 67584
  s_nop 0
  buffer_load_dwordx4 v8, s[8:11], s21 offen lds
  s_add_u32 m0, s25, 68608
  s_nop 0
  buffer_load_dwordx4 v9, s[8:11], s21 offen lds
  s_add_u32 s20, s20, 64
  s_add_u32 s21, s21, s23
  s_waitcnt vmcnt(16)
  s_barrier
  ds_read_b64_tr_b16 v[64:65], v14 offset:0
  ds_read_b64_tr_b16 v[66:67], v14 offset:2048
  ds_read_b128 v[80:83], v10 offset:0
  ds_read_b128 v[84:87], v10 offset:2048
  ds_read_b128 v[88:91], v10 offset:4096
  ds_read_b128 v[92:95], v10 offset:6144
  ds_read_b64_tr_b16 v[68:69], v15 offset:0
  ds_read_b64_tr_b16 v[70:71], v15 offset:2048
  ds_read_b64_tr_b16 v[72:73], v16 offset:0
  ds_read_b64_tr_b16 v[74:75], v16 offset:2048
  ds_read_b64_tr_b16 v[76:77], v17 offset:0
  ds_read_b64_tr_b16 v[78:79], v17 offset:2048
  s_waitcnt lgkmcnt(0)
  v_mfma_f32_32x32x16_bf16 a[0:15], v[64:67], v[80:83], 0
  ds_read_b64_tr_b16 v[96:97], v14 offset:8192
  v_mfma_f32_32x32x16_bf16 a[16:31], v[64:67], v[84:87], 0
  ds_read_b64_tr_b16 v[98:99], v14 offset:10240
  v_mfma_f32_32x32x16_bf16 a[32:47], v[64:67], v[88:91], 0
  ds_read_b128 v[112:115], v11 offset:0
  v_mfma_f32_32x32x16_bf16 a[48:63], v[64:67], v[92:95], 0
  ds_read_b128 v[116:119], v11 offset:2048
  s_add_u32 m0, s24, 98304
  s_nop 0
  buffer_load_dwordx4 v2, s[4:7], s20 offen lds
  v_mfma_f32_32x32x16_bf16 a[64:79], v[68:71], v[80:83], 0
  ds_read_b128 v[120:123], v11 offset:4096
  v_mfma_f32_32x32x16_bf16 a[80:95], v[68:71], v[84:87], 0
  ds_read_b128 v[124:127], v11 offset:6144
  v_mfma_f32_32x32x16_bf16 a[96:111], v[68:71], v[88:91], 0
  ds_read_b64_tr_b16 v[100:101], v15 offset:8192
  v_mfma_f32_32x32x16_bf16 a[112:127], v[68:71], v[92:95], 0
  ds_read_b64_tr_b16 v[102:103], v15 offset:10240
  s_add_u32 m0, s24, 99328
  s_nop 0
  buffer_load_dwordx4 v3, s[4:7], s20 offen lds
  v_mfma_f32_32x32x16_bf16 a[128:143], v[72:75], v[80:83], 0
  ds_read_b64_tr_b16 v[104:105], v16 offset:8192
  v_mfma_f32_32x32x16_bf16 a[144:159], v[72:75], v[84:87], 0
  ds_read_b64_tr_b16 v[106:107], v16 offset:10240
  v_mfma_f32_32x32x16_bf16 a[160:175], v[72:75], v[88:91], 0
  ds_read_b64_tr_b16 v[108:109], v17 offset:8192
  v_mfma_f32_32x32x16_bf16 a[176:191], v[72:75], v[92:95], 0
  ds_read_b64_tr_b16 v[110:111], v17 offset:10240
  s_add_u32 m0, s24, 100352
  s_nop 0
  buffer_load_dwordx4 v4, s[4:7], s20 offen lds
  v_mfma_f32_32x32x16_bf16 a[192:207], v[76:79], v[80:83], 0
  v_mfma_f32_32x32x16_bf16 a[208:223], v[76:79], v[84:87], 0
  v_mfma_f32_32x32x16_bf16 a[224:239], v[76:79], v[88:91], 0
  v_mfma_f32_32x32x16_bf16 a[240:255], v[76:79], v[92:95], 0
  s_add_u32 m0, s24, 101376
  s_nop 0
  buffer_load_dwordx4 v5, s[4:7], s20 offen lds
  s_waitcnt vmcnt(12) lgkmcnt(0)
  s_barrier
  v_mfma_f32_32x32x16_bf16 a[0:15], v[96:99], v[112:115], a[0:15]
  ds_read_b64_tr_b16 v[64:65], v14 offset:32768
  v_mfma_f32_32x32x16_bf16 a[16:31], v[96:99], v[116:119], a[16:31]
  ds_read_b64_tr_b16 v[66:67], v14 offset:34816
  v_mfma_f32_32x32x16_bf16 a[32:47], v[96:99], v[120:123], a[32:47]
  ds_read_b128 v[80:83], v10 offset:32768
  v_mfma_f32_32x32x16_bf16 a[48:63], v[96:99], v[124:127], a[48:63]
  ds_read_b128 v[84:87], v10 offset:34816
  s_add_u32 m0, s25, 98304
  s_nop 0
  buffer_load_dwordx4 v6, s[8:11], s21 offen lds
  v_mfma_f32_32x32x16_bf16 a[64:79], v[100:103], v[112:115], a[64:79]
  ds_read_b128 v[88:91], v10 offset:36864
  v_mfma_f32_32x32x16_bf16 a[80:95], v[100:103], v[116:119], a[80:95]
  ds_read_b128 v[92:95], v10 offset:38912
  v_mfma_f32_32x32x16_bf16 a[96:111], v[100:103], v[120:123], a[96:111]
  ds_read_b64_tr_b16 v[68:69], v15 offset:32768
  v_mfma_f32_32x32x16_bf16 a[112:127], v[100:103], v[124:127], a[112:127]
  ds_read_b64_tr_b16 v[70:71], v15 offset:34816
  s_add_u32 m0, s25, 99328
  s_nop 0
  buffer_load_dwordx4 v7, s[8:11], s21 offen lds
  v_mfma_f32_32x32x16_bf16 a[128:143], v[104:107], v[112:115], a[128:143]
  ds_read_b64_tr_b16 v[72:73], v16 offset:32768
  v_mfma_f32_32x32x16_bf16 a[144:159], v[104:107], v[116:119], a[144:159]
  ds_read_b64_tr_b16 v[74:75], v16 offset:34816
  v_mfma_f32_32x32x16_bf16 a[160:175], v[104:107], v[120:123], a[160:175]
  ds_read_b64_tr_b16 v[76:77], v17 offset:32768
  v_mfma_f32_32x32x16_bf16 a[176:191], v[104:107], v[124:127], a[176:191]
  ds_read_b64_tr_b16 v[78:79], v17 offset:34816
  s_add_u32 m0, s25, 100352
  s_nop 0
  buffer_load_dwordx4 v8, s[8:11], s21 offen lds
  v_mfma_f32_32x32x16_bf16 a[192:207], v[108:111], v[112:115], a[192:207]
  v_mfma_f32_32x32x16_bf16 a[208:223], v[108:111], v[116:119], a[208:223]
  v_mfma_f32_32x32x16_bf16 a[224:239], v[108:111], v[120:123], a[224:239]
  v_mfma_f32_32x32x16_bf16 a[240:255], v[108:111], v[124:127], a[240:255]
  s_add_u32 m0, s25, 101376
  s_nop 0
  buffer_load_dwordx4 v9, s[8:11], s21 offen lds
  s_add_u32 s20, s20, 64
  s_add_u32 s21, s21, s23
  s_waitcnt lgkmcnt(0)
  v_mfma_f32_32x32x16_bf16 a[0:15], v[64:67], v[80:83], a[0:15]
  ds_read_b64_tr_b16 v[96:97], v14 offset:40960
  v_mfma_f32_32x32x16_bf16 a[16:31], v[64:67], v[84:87], a[16:31]
  ds_read_b64_tr_b16 v[98:99], v14 offset:43008
  v_mfma_f32_32x32x16_bf16 a[32:47], v[64:67], v[88:91], a[32:47]
  ds_read_b128 v[112:115], v11 offset:32768
  v_mfma_f32_32x32x16_bf16 a[48:63], v[64:67], v[92:95], a[48:63]
  ds_read_b128 v[116:119], v11 offset:34816
  s_add_u32 m0, s24, 0
  s_nop 0
  buffer_load_dwordx4 v2, s[4:7], s20 offen lds
  v_mfma_f32_32x32x16_bf16 a[64:79], v[68:71], v[80:83], a[64:79]
  ds_read_b128 v[120:123], v11 offset:36864
  v_mfma_f32_32x32x16_bf16 a[80:95], v[68:71], v[84:87], a[80:95]
  ds_read_b128 v[124:127], v11 offset:38912
  v_mfma_f32_32x32x16_bf16 a[96:111], v[68:71], v[88:91], a[96:111]
  ds_read_b64_tr_b16 v[100:101], v15 offset:40960
  v_mfma_f32_32x32x16_bf16 a[112:127], v[68:71], v[92:95], a[112:127]
  ds_read_b64_tr_b16 v[102:103], v15 offset:43008
  s_add_u32 m0, s24, 1024
  s_nop 0
  buffer_load_dwordx4 v3, s[4:7], s20 offen lds
  v_mfma_f32_32x32x16_bf16 a[128:143], v[72:75], v[80:83], a[128:143]
  ds_read_b64_tr_b16 v[104:105], v16 offset:40960
  v_mfma_f32_32x32x16_bf16 a[144:159], v[72:75], v[84:87], a[144:159]
  ds_read_b64_tr_b16 v[106:107], v16 offset:43008
  v_mfma_f32_32x32x16_bf16 a[160:175], v[72:75], v[88:91], a[160:175]
  ds_read_b64_tr_b16 v[108:109], v17 offset:40960
  v_mfma_f32_32x32x16_bf16 a[176:191], v[72:75], v[92:95], a[176:191]
  ds_read_b64_tr_b16 v[110:111], v17 offset:43008
  s_add_u32 m0, s24, 2048
  s_nop 0
  buffer_load_dwordx4 v4, s[4:7], s20 offen lds
  v_mfma_f32_32x32x16_bf16 a[192:207], v[76:79], v[80:83], a[192:207]
  v_mfma_f32_32x32x16_bf16 a[208:223], v[76:79], v[84:87], a[208:223]
  v_mfma_f32_32x32x16_bf16 a[224:239], v[76:79], v[88:91], a[224:239]
  v_mfma_f32_32x32x16_bf16 a[240:255], v[76:79], v[92:95], a[240:255]
  s_add_u32 m0, s24, 3072
  s_nop 0
  buffer_load_dwordx4 v5, s[4:7], s20 offen lds
  s_waitcnt vmcnt(12) lgkmcnt(0)
  s_barrier
  v_mfma_f32_32x32x16_bf16 a[0:15], v[96:99], v[112:115], a[0:15]
  ds_read_b64_tr_b16 v[64:65], v18 offset:0
  v_mfma_f32_32x32x16_bf16 a[16:31], v[96:99], v[116:119], a[16:31]
  ds_read_b64_tr_b16 v[66:67], v18 offset:2048
  v_mfma_f32_32x32x16_bf16 a[32:47], v[96:99], v[120:123], a[32:47]
  ds_read_b128 v[80:83], v12 offset:0
  v_mfma_f32_32x32x16_bf16 a[48:63], v[96:99], v[124:127], a[48:63]
  ds_read_b128 v[84:87], v12 offset:2048
  s_add_u32 m0, s25, 0
  s_nop 0
  buffer_load_dwordx4 v6, s[8:11], s21 offen lds
  v_mfma_f32_32x32x16_bf16 a[64:79], v[100:103], v[112:115], a[64:79]
  ds_read_b128 v[88:91], v12 offset:4096
  v_mfma_f32_32x32x16_bf16 a[80:95], v[100:103], v[116:119], a[80:95]
  ds_read_b128 v[92:95], v12 offset:6144
  v_mfma_f32_32x32x16_bf16 a[96:111], v[100:103], v[120:123], a[96:111]
  ds_read_b64_tr_b16 v[68:69], v19 offset:0
  v_mfma_f32_32x32x16_bf16 a[112:127], v[100:103], v[124:127], a[112:127]
  ds_read_b64_tr_b16 v[70:71], v19 offset:2048
  s_add_u32 m0, s25, 1024
  s_nop 0
  buffer_load_dwordx4 v7, s[8:11], s21 offen lds
  v_mfma_f32_32x32x16_bf16 a[128:143], v[104:107], v[112:115], a[128:143]
  ds_read_b64_tr_b16 v[72:73], v20 offset:0
  v_mfma_f32_32x32x16_bf16 a[144:159], v[104:107], v[116:119], a[144:159]
  ds_read_b64_tr_b16 v[74:75], v20 offset:2048
  v_mfma_f32_32x32x16_bf16 a[160:175], v[104:107], v[120:123], a[160:175]
  ds_read_b64_tr_b16 v[76:77], v21 offset:0
  v_mfma_f32_32x32x16_bf16 a[176:191], v[104:107], v[124:127], a[176:191]
  ds_read_b64_tr_b16 v[78:79], v21 offset:2048
  s_add_u32 m0, s25, 2048
  s_nop 0
  buffer_load_dwordx4 v8, s[8:11], s21 offen lds
  v_mfma_f32_32x32x16_bf16 a[192:207], v[108:111], v[112:115], a[192:207]
  v_mfma_f32_32x32x16_bf16 a[208:223], v[108:111], v[116:119], a[208:223]
  v_mfma_f32_32x32x16_bf16 a[224:239], v[108:111], v[120:123], a[224:239]
  v_mfma_f32_32x32x16_bf16 a[240:255], v[108:111], v[124:127], a[240:255]
  s_add_u32 m0, s25, 3072
  s_nop 0
  buffer_load_dwordx4 v9, s[8:11], s21 offen lds
  s_add_u32 s20, s20, 64
  s_add_u32 s21, s21, s23
  s_waitcnt lgkmcnt(0)
  v_mfma_f32_32x32x16_bf16 a[0:15], v[64:67], v[80:83], a[0:15]
  ds_read_b64_tr_b16 v[96:97], v18 offset:8192
  v_mfma_f32_32x32x16_bf16 a[16:31], v[64:67], v[84:87], a[16:31]
  ds_read_b64_tr_b16 v[98:99], v18 offset:10240
  v_mfma_f32_32x32x16_bf16 a[32:47], v[64:67], v[88:91], a[32:47]
  ds_read_b128 v[112:115], v13 offset:0
  v_mfma_f32_32x32x16_bf16 a[48:63], v[64:67], v[92:95], a[48:63]
  ds_read_b128 v[116:119], v13 offset:2048
  s_add_u32 m0, s24, 32768
  s_nop 0
  buffer_load_dwordx4 v2, s[4:7], s20 offen lds
  v_mfma_f32_32x32x16_bf16 a[64:79], v[68:71], v[80:83], a[64:79]
  ds_read_b128 v[120:123], v13 offset:4096
  v_mfma_f32_32x32x16_bf16 a[80:95], v[68:71], v[84:87], a[80:95]
  ds_read_b128 v[124:127], v13 offset:6144
  v_mfma_f32_32x32x16_bf16 a[96:111], v[68:71], v[88:91], a[96:111]
  ds_read_b64_tr_b16 v[100:101], v19 offset:8192
  v_mfma_f32_32x32x16_bf16 a[112:127], v[68:71], v[92:95], a[112:127]
  ds_read_b64_tr_b16 v[102:103], v19 offset:10240
  s_add_u32 m0, s24, 33792
  s_nop 0
  buffer_load_dwordx4 v3, s[4:7], s20 offen lds
  v_mfma_f32_32x32x16_bf16 a[128:143], v[72:75], v[80:83], a[128:143]
  ds_read_b64_tr_b16 v[104:105], v20 offset:8192
  v_mfma_f32_32x32x16_bf16 a[144:159], v[72:75], v[84:87], a[144:159]
  ds_read_b64_tr_b16 v[106:107], v20 offset:10240
  v_mfma_f32_32x32x16_bf16 a[160:175], v[72:75], v[88:91], a[160:175]
  ds_read_b64_tr_b16 v[108:109], v21 offset:8192
  v_mfma_f32_32x32x16_bf16 a[176:191], v[72:75], v[92:95], a[176:191]
  ds_read_b64_tr_b16 v[110:111], v21 offset:10240
  s_add_u32 m0, s24, 34816
  s_nop 0
  buffer_load_dwordx4 v4, s[4:7], s20 offen lds
  v_mfma_f32_32x32x16_bf16 a[192:207], v[76:79], v[80:83], a[192:207]
  v_mfma_f32_32x32x16_bf16 a[208:223], v[76:79], v[84:87], a[208:223]
  v_mfma_f32_32x32x16_bf16 a[224:239], v[76:79], v[88:91], a[224:239]
  v_mfma_f32_32x32x16_bf16 a[240:255], v[76:79], v[92:95], a[240:255]
  s_add_u32 m0, s24, 35840
  s_nop 0
  buffer_load_dwordx4 v5, s[4:7], s20 offen lds
  s_waitcnt vmcnt(12) lgkmcnt(0)
  s_barrier
  v_mfma_f32_32x32x16_bf16 a[0:15], v[96:99], v[112:115], a[0:15]
  ds_read_b64_tr_b16 v[64:65], v18 offset:32768
  v_mfma_f32_32x32x16_bf16 a[16:31], v[96:99], v[116:119], a[16:31]
  ds_read_b64_tr_b16 v[66:67], v18 offset:34816
  v_mfma_f32_32x32x16_bf16 a[32:47], v[96:99], v[120:123], a[32:47]
  ds_read_b128 v[80:83], v12 offset:32768
  v_mfma_f32_32x32x16_bf16 a[48:63], v[96:99], v[124:127], a[48:63]
  ds_read_b128 v[84:87], v12 offset:34816
  s_add_u32 m0, s25, 32768
  s_nop 0
  buffer_load_dwordx4 v6, s[8:11], s21 offen lds
  v_mfma_f32_32x32x16_bf16 a[64:79], v[100:103], v[112:115], a[64:79]
  ds_read_b128 v[88:91], v12 offset:36864
  v_mfma_f32_32x32x16_bf16 a[80:95], v[100:103], v[116:119], a[80:95]
  ds_read_b128 v[92:95], v12 offset:38912
  v_mfma_f32_32x32x16_bf16 a[96:111], v[100:103], v[120:123], a[96:111]
  ds_read_b64_tr_b16 v[68:69], v19 offset:32768
  v_mfma_f32_32x32x16_bf16 a[112:127], v[100:103], v[124:127], a[112:127]
  ds_read_b64_tr_b16 v[70:71], v19 offset:34816
  s_add_u32 m0, s25, 33792
  s_nop 0
  buffer_load_dwordx4 v7, s[8:11], s21 offen lds
  v_mfma_f32_32x32x16_bf16 a[128:143], v[104:107], v[112:115], a[128:143]
  ds_read_b64_tr_b16 v[72:73], v20 offset:32768
  v_mfma_f32_32x32x16_bf16 a[144:159], v[104:107], v[116:119], a[144:159]
  ds_read_b64_tr_b16 v[74:75], v20 offset:34816
  v_mfma_f32_32x32x16_bf16 a[160:175], v[104:107], v[120:123], a[160:175]
  ds_read_b64_tr_b16 v[76:77], v21 offset:32768
  v_mfma_f32_32x32x16_bf16 a[176:191], v[104:107], v[124:127], a[176:191]
  ds_read_b64_tr_b16 v[78:79], v21 offset:34816
  s_add_u32 m0, s25, 34816
  s_nop 0
  buffer_load_dwordx4 v8, s[8:11], s21 offen lds
  v_mfma_f32_32x32x16_bf16 a[192:207], v[108:111], v[112:115], a[192:207]
  v_mfma_f32_32x32x16_bf16 a[208:223], v[108:111], v[116:119], a[208:223]
  v_mfma_f32_32x32x16_bf16 a[224:239], v[108:111], v[120:123], a[224:239]
  v_mfma_f32_32x32x16_bf16 a[240:255], v[108:111], v[124:127], a[240:255]
  s_add_u32 m0, s25, 35840
  s_nop 0
  buffer_load_dwordx4 v9, s[8:11], s21 offen lds
  s_add_u32 s20, s20, 64
  s_add_u32 s21, s21, s23
  s_waitcnt lgkmcnt(0)
  v_mfma_f32_32x32x16_bf16 a[0:15], v[64:67], v[80:83], a[0:15]
  ds_read_b64_tr_b16 v[96:97], v18 offset:40960
  v_mfma_f32_32x32x16_bf16 a[16:31], v[64:67], v[84:87], a[16:31]
  ds_read_b64_tr_b16 v[98:99], v18 offset:43008
  v_mfma_f32_32x32x16_bf16 a[32:47], v[64:67], v[88:91], a[32:47]
  ds_read_b128 v[112:115], v13 offset:32768
  v_mfma_f32_32x32x16_bf16 a[48:63], v[64:67], v[92:95], a[48:63]
  ds_read_b128 v[116:119], v13 offset:34816
  s_add_u32 m0, s24, 65536
  s_nop 0
  buffer_load_dwordx4 v2, s[4:7], s20 offen lds
  v_mfma_f32_32x32x16_bf16 a[64:79], v[68:71], v[80:83], a[64:79]
  ds_read_b128 v[120:123], v13 offset:36864
  v_mfma_f32_32x32x16_bf16 a[80:95], v[68:71], v[84:87], a[80:95]
  ds_read_b128 v[124:127], v13 offset:38912
  v_mfma_f32_32x32x16_bf16 a[96:111], v[68:71], v[88:91], a[96:111]
  ds_read_b64_tr_b16 v[100:101], v19 offset:40960
  v_mfma_f32_32x32x16_bf16 a[112:127], v[68:71], v[92:95], a[112:127]
  ds_read_b64_tr_b16 v[102:103], v19 offset:43008
  s_add_u32 m0, s24, 66560
  s_nop 0
  buffer_load_dwordx4 v3, s[4:7], s20 offen lds
  v_mfma_f32_32x32x16_bf16 a[128:143], v[72:75], v[80:83], a[128:143]
  ds_read_b64_tr_b16 v[104:105], v20 offset:40960
  v_mfma_f32_32x32x16_bf16 a[144:159], v[72:75], v[84:87], a[144:159]
  ds_read_b64_tr_b16 v[106:107], v20 offset:43008
  v_mfma_f32_32x32x16_bf16 a[160:175], v[72:75], v[88:91], a[160:175]
  ds_read_b64_tr_b16 v[108:109], v21 offset:40960
  v_mfma_f32_32x32x16_bf16 a[176:191], v[72:75], v[92:95], a[176:191]
  ds_read_b64_tr_b16 v[110:111], v21 offset:43008
  s_add_u32 m0, s24, 67584
  s_nop 0
  buffer_load_dwordx4 v4, s[4:7], s20 offen lds
  v_mfma_f32_32x32x16_bf16 a[192:207], v[76:79], v[80:83], a[192:207]
  v_mfma_f32_32x32x16_bf16 a[208:223], v[76:79], v[84:87], a[208:223]
  v_mfma_f32_32x32x16_bf16 a[224:239], v[76:79], v[88:91], a[224:239]
  v_mfma_f32_32x32x16_bf16 a[240:255], v[76:79], v[92:95], a[240:255]
  s_add_u32 m0, s24, 68608
  s_nop 0
  buffer_load_dwordx4 v5, s[4:7], s20 offen lds
  s_waitcnt vmcnt(12) lgkmcnt(0)
  s_barrier
  v_mfma_f32_32x32x16_bf16 a[0:15], v[96:99], v[112:115], a[0:15]
  ds_read_b64_tr_b16 v[64:65], v14 offset:0
  v_mfma_f32_32x32x16_bf16 a[16:31], v[96:99], v[116:119], a[16:31]
  ds_read_b64_tr_b16 v[66:67], v14 offset:2048
  v_mfma_f32_32x32x16_bf16 a[32:47], v[96:99], v[120:123], a[32:47]
  ds_read_b128 v[80:83], v10 offset:0
  v_mfma_f32_32x32x16_bf16 a[48:63], v[96:99], v[124:127], a[48:63]
  ds_read_b128 v[84:87], v10 offset:2048
  s_add_u32 m0, s25, 65536
  s_nop 0
  buffer_load_dwordx4 v6, s[8:11], s21 offen lds
  v_mfma_f32_32x32x16_bf16 a[64:79], v[100:103], v[112:115], a[64:79]
  ds_read_b128 v[88:91], v10 offset:4096
  v_mfma_f32_32x32x16_bf16 a[80:95], v[100:103], v[116:119], a[80:95]
  ds_read_b128 v[92:95], v10 offset:6144
  v_mfma_f32_32x32x16_bf16 a[96:111], v[100:103], v[120:123], a[96:111]
  ds_read_b64_tr_b16 v[68:69], v15 offset:0
  v_mfma_f32_32x32x16_bf16 a[112:127], v[100:103], v[124:127], a[112:127]
  ds_read_b64_tr_b16 v[70:71], v15 offset:2048
  s_add_u32 m0, s25, 66560
  s_nop 0
  buffer_load_dwordx4 v7, s[8:11], s21 offen lds
  v_mfma_f32_32x32x16_bf16 a[128:143], v[104:107], v[112:115], a[128:143]
  ds_read_b64_tr_b16 v[72:73], v16 offset:0
  v_mfma_f32_32x32x16_bf16 a[144:159], v[104:107], v[116:119], a[144:159]
  ds_read_b64_tr_b16 v[74:75], v16 offset:2048
  v_mfma_f32_32x32x16_bf16 a[160:175], v[104:107], v[120:123], a[160:175]
  ds_read_b64_tr_b16 v[76:77], v17 offset:0
  v_mfma_f32_32x32x16_bf16 a[176:191], v[104:107], v[124:127], a[176:191]
  ds_read_b64_tr_b16 v[78:79], v17 offset:2048
  s_add_u32 m0, s25, 67584
  s_nop 0
  buffer_load_dwordx4 v8, s[8:11], s21 offen lds
  v_mfma_f32_32x32x16_bf16 a[192:207], v[108:111], v[112:115], a[192:207]
  v_mfma_f32_32x32x16_bf16 a[208:223], v[108:111], v[116:119], a[208:223]
  v_mfma_f32_32x32x16_bf16 a[224:239], v[108:111], v[120:123], a[224:239]
  v_mfma_f32_32x32x16_bf16 a[240:255], v[108:111], v[124:127], a[240:255]
  s_add_u32 m0, s25, 68608
  s_nop 0
  buffer_load_dwordx4 v9, s[8:11], s21 offen lds
  s_add_u32 s20, s20, 64
  s_add_u32 s21, s21, s23
  s_waitcnt lgkmcnt(0)
  v_mfma_f32_32x32x16_bf16 a[0:15], v[64:67], v[80:83], a[0:15]
  ds_read_b64_tr_b16 v[96:97], v14 offset:8192
  v_mfma_f32_32x32x16_bf16 a[16:31], v[64:67], v[84:87], a[16:31]
  ds_read_b64_tr_b16 v[98:99], v14 offset:10240
  v_mfma_f32_32x32x16_bf16 a[32:47], v[64:67], v[88:91], a[32:47]
  ds_read_b128 v[112:115], v11 offset:0
  v_mfma_f32_32x32x16_bf16 a[48:63], v[64:67], v[92:95], a[48:63]
  ds_read_b128 v[116:119], v11 offset:2048
  s_add_u32 m0, s24, 98304
  s_nop 0
  buffer_load_dwordx4 v2, s[4:7], s20 offen lds
  v_mfma_f32_32x32x16_bf16 a[64:79], v[68:71], v[80:83], a[64:79]
  ds_read_b128 v[120:123], v11 offset:4096
  v_mfma_f32_32x32x16_bf16 a[80:95], v[68:71], v[84:87], a[80:95]
  ds_read_b128 v[124:127], v11 offset:6144
  v_mfma_f32_32x32x16_bf16 a[96:111], v[68:71], v[88:91], a[96:111]
  ds_read_b64_tr_b16 v[100:101], v15 offset:8192
  v_mfma_f32_32x32x16_bf16 a[112:127], v[68:71], v[92:95], a[112:127]
  ds_read_b64_tr_b16 v[102:103], v15 offset:10240
  s_add_u32 m0, s24, 99328
  s_nop 0
  buffer_load_dwordx4 v3, s[4:7], s20 offen lds
  v_mfma_f32_32x32x16_bf16 a[128:143], v[72:75], v[80:83], a[128:143]
  ds_read_b64_tr_b16 v[104:105], v16 offset:8192
  v_mfma_f32_32x32x16_bf16 a[144:159], v[72:75], v[84:87], a[144:159]
  ds_read_b64_tr_b16 v[106:107], v16 offset:10240
  v_mfma_f32_32x32x16_bf16 a[160:175], v[72:75], v[88:91], a[160:175]
  ds_read_b64_tr_b16 v[108:109], v17 offset:8192
  v_mfma_f32_32x32x16_bf16 a[176:191], v[72:75], v[92:95], a[176:191]
  ds_read_b64_tr_b16 v[110:111], v17 offset:10240
  s_add_u32 m0, s24, 100352
  s_nop 0
  buffer_load_dwordx4 v4, s[4:7], s20 offen lds
  v_mfma_f32_32x32x16_bf16 a[192:207], v[76:79], v[80:83], a[192:207]
  v_mfma_f32_32x32x16_bf16 a[208:223], v[76:79], v[84:87], a[208:223]
  v_mfma_f32_32x32x16_bf16 a[224:239], v[76:79], v[88:91], a[224:239]
  v_mfma_f32_32x32x16_bf16 a[240:255], v[76:79], v[92:95], a[240:255]
  s_add_u32 m0, s24, 101376
  s_nop 0
  buffer_load_dwordx4 v5, s[4:7], s20 offen lds
  s_waitcnt vmcnt(12) lgkmcnt(0)
  s_barrier
  v_mfma_f32_32x32x16_bf16 a[0:15], v[96:99], v[112:115], a[0:15]
  ds_read_b64_tr_b16 v[64:65], v14 offset:32768
  v_mfma_f32_32x32x16_bf16 a[16:31], v[96:99], v[116:119], a[16:31]
  ds_read_b64_tr_b16 v[66:67], v14 offset:34816
  v_mfma_f32_32x32x16_bf16 a[32:47], v[96:99], v[120:123], a[32:47]
  ds_read_b128 v[80:83], v10 offset:32768
  v_mfma_f32_32x32x16_bf16 a[48:63], v[96:99], v[124:127], a[48:63]
  ds_read_b128 v[84:87], v10 offset:34816
  s_add_u32 m0, s25, 98304
  s_nop 0
  buffer_load_dwordx4 v6, s[8:11], s21 offen lds
  v_mfma_f32_32x32x16_bf16 a[64:79], v[100:103], v[112:115], a[64:79]
  ds_read_b128 v[88:91], v10 offset:36864
  v_mfma_f32_32x32x16_bf16 a[80:95], v[100:103], v[116:119], a[80:95]
  ds_read_b128 v[92:95], v10 offset:38912
  v_mfma_f32_32x32x16_bf16 a[96:111], v[100:103], v[120:123], a[96:111]
  ds_read_b64_tr_b16 v[68:69], v15 offset:32768
  v_mfma_f32_32x32x16_bf16 a[112:127], v[100:103], v[124:127], a[112:127]
  ds_read_b64_tr_b16 v[70:71], v15 offset:34816
  s_add_u32 m0, s25, 99328
  s_nop 0
  buffer_load_dwordx4 v7, s[8:11], s21 offen lds
  v_mfma_f32_32x32x16_bf16 a[128:143], v[104:107], v[112:115], a[128:143]
  ds_read_b64_tr_b16 v[72:73], v16 offset:32768
  v_mfma_f32_32x32x16_bf16 a[144:159], v[104:107], v[116:119], a[144:159]
  ds_read_b64_tr_b16 v[74:75], v16 offset:34816
  v_mfma_f32_32x32x16_bf16 a[160:175], v[104:107], v[120:123], a[160:175]
  ds_read_b64_tr_b16 v[76:77], v17 offset:32768
  v_mfma_f32_32x32x16_bf16 a[176:191], v[104:107], v[124:127], a[176:191]
  ds_read_b64_tr_b16 v[78:79], v17 offset:34816
  s_add_u32 m0, s25, 100352
  s_nop 0
  buffer_load_dwordx4 v8, s[8:11], s21 offen lds
  v_mfma_f32_32x32x16_bf16 a[192:207], v[108:111], v[112:115], a[192:207]
  v_mfma_f32_32x32x16_bf16 a[208:223], v[108:111], v[116:119], a[208:223]
  v_mfma_f32_32x32x16_bf16 a[224:239], v[108:111], v[120:123], a[224:239]
  v_mfma_f32_32x32x16_bf16 a[240:255], v[108:111], v[124:127], a[240:255]
  s_add_u32 m0, s25, 101376
  s_nop 0
  buffer_load_dwordx4 v9, s[8:11], s21 offen lds
  s_add_u32 s20, s20, 64
  s_add_u32 s21, s21, s23
  s_waitcnt lgkmcnt(0)
  v_mfma_f32_32x32x16_bf16 a[0:15], v[64:67], v[80:83], a[0:15]
  ds_read_b64_tr_b16 v[96:97], v14 offset:40960
  v_mfma_f32_32x32x16_bf16 a[16:31], v[64:67], v[84:87], a[16:31]
  ds_read_b64_tr_b16 v[98:99], v14 offset:43008
  v_mfma_f32_32x32x16_bf16 a[32:47], v[64:67], v[88:91], a[32:47]
  ds_read_b128 v[112:115], v11 offset:32768
  v_mfma_f32_32x32x16_bf16 a[48:63], v[64:67], v[92:95], a[48:63]
  ds_read_b128 v[116:119], v11 offset:34816
  s_add_u32 m0, s24, 0
  s_nop 0
  buffer_load_dwordx4 v2, s[4:7], s20 offen lds
  v_mfma_f32_32x32x16_bf16 a[64:79], v[68:71], v[80:83], a[64:79]
  ds_read_b128 v[120:123], v11 offset:36864
  v_mfma_f32_32x32x16_bf16 a[80:95], v[68:71], v[84:87], a[80:95]
  ds_read_b128 v[124:127], v11 offset:38912
  v_mfma_f32_32x32x16_bf16 a[96:111], v[68:71], v[88:91], a[96:111]
  ds_read_b64_tr_b16 v[100:101], v15 offset:40960
  v_mfma_f32_32x32x16_bf16 a[112:127], v[68:71], v[92:95], a[112:127]
  ds_read_b64_tr_b16 v[102:103], v15 offset:43008
  s_add_u32 m0, s24, 1024
  s_nop 0
  buffer_load_dwordx4 v3, s[4:7], s20 offen lds
  v_mfma_f32_32x32x16_bf16 a[128:143], v[72:75], v[80:83], a[128:143]
  ds_read_b64_tr_b16 v[104:105], v16 offset:40960
  v_mfma_f32_32x32x16_bf16 a[144:159], v[72:75], v[84:87], a[144:159]
  ds_read_b64_tr_b16 v[106:107], v16 offset:43008
  v_mfma_f32_32x32x16_bf16 a[160:175], v[72:75], v[88:91], a[160:175]
  ds_read_b64_tr_b16 v[108:109], v17 offset:40960
  v_mfma_f32_32x32x16_bf16 a[176:191], v[72:75], v[92:95], a[176:191]
  ds_read_b64_tr_b16 v[110:111], v17 offset:43008
  s_add_u32 m0, s24, 2048
  s_nop 0
  buffer_load_dwordx4 v4, s[4:7], s20 offen lds
  v_mfma_f32_32x32x16_bf16 a[192:207], v[76:79], v[80:83], a[192:207]
  v_mfma_f32_32x32x16_bf16 a[208:223], v[76:79], v[84:87], a[208:223]
  v_mfma_f32_32x32x16_bf16 a[224:239], v[76:79], v[88:91], a[224:239]
  v_mfma_f32_32x32x16_bf16 a[240:255], v[76:79], v[92:95], a[240:255]
  s_add_u32 m0, s24, 3072
  s_nop 0
  buffer_load_dwordx4 v5, s[4:7], s20 offen lds
  s_waitcnt vmcnt(12) lgkmcnt(0)
  s_barrier
  v_mfma_f32_32x32x16_bf16 a[0:15], v[96:99], v[112:115], a[0:15]
  ds_read_b64_tr_b16 v[64:65], v18 offset:0
  v_mfma_f32_32x32x16_bf16 a[16:31], v[96:99], v[116:119], a[16:31]
  ds_read_b64_tr_b16 v[66:67], v18 offset:2048
  v_mfma_f32_32x32x16_bf16 a[32:47], v[96:99], v[120:123], a[32:47]
  ds_read_b128 v[80:83], v12 offset:0
  v_mfma_f32_32x32x16_bf16 a[48:63], v[96:99], v[124:127], a[48:63]
  ds_read_b128 v[84:87], v12 offset:2048
  s_add_u32 m0, s25, 0
  s_nop 0
  buffer_load_dwordx4 v6, s[8:11], s21 offen lds
  v_mfma_f32_32x32x16_bf16 a[64:79], v[100:103], v[112:115], a[64:79]
  ds_read_b128 v[88:91], v12 offset:4096
  v_mfma_f32_32x32x16_bf16 a[80:95], v[100:103], v[116:119], a[80:95]
  ds_read_b128 v[92:95], v12 offset:6144
  v_mfma_f32_32x32x16_bf16 a[96:111], v[100:103], v[120:123], a[96:111]
  ds_read_b64_tr_b16 v[68:69], v19 offset:0
  v_mfma_f32_32x32x16_bf16 a[112:127], v[100:103], v[124:127], a[112:127]
  ds_read_b64_tr_b16 v[70:71], v19 offset:2048
  s_add_u32 m0, s25, 1024
  s_nop 0
  buffer_load_dwordx4 v7, s[8:11], s21 offen lds
  v_mfma_f32_32x32x16_bf16 a[128:143], v[104:107], v[112:115], a[128:143]
  ds_read_b64_tr_b16 v[72:73], v20 offset:0
  v_mfma_f32_32x32x16_bf16 a[144:159], v[104:107], v[116:119], a[144:159]
  ds_read_b64_tr_b16 v[74:75], v20 offset:2048
  v_mfma_f32_32x32x16_bf16 a[160:175], v[104:107], v[120:123], a[160:175]
  ds_read_b64_tr_b16 v[76:77], v21 offset:0
  v_mfma_f32_32x32x16_bf16 a[176:191], v[104:107], v[124:127], a[176:191]
  ds_read_b64_tr_b16 v[78:79], v21 offset:2048
  s_add_u32 m0, s25, 2048
  s_nop 0
  buffer_load_dwordx4 v8, s[8:11], s21 offen lds
  v_mfma_f32_32x32x16_bf16 a[192:207], v[108:111], v[112:115], a[192:207]
  v_mfma_f32_32x32x16_bf16 a[208:223], v[108:111], v[116:119], a[208:223]
  v_mfma_f32_32x32x16_bf16 a[224:239], v[108:111], v[120:123], a[224:239]
  v_mfma_f32_32x32x16_bf16 a[240:255], v[108:111], v[124:127], a[240:255]
  s_add_u32 m0, s25, 3072
  s_nop 0
  buffer_load_dwordx4 v9, s[8:11], s21 offen lds
  s_add_u32 s20, s20, 64
  s_add_u32 s21, s21, s23
  s_waitcnt lgkmcnt(0)
  v_mfma_f32_32x32x16_bf16 a[0:15], v[64:67], v[80:83], a[0:15]
  ds_read_b64_tr_b16 v[96:97], v18 offset:8192
  v_mfma_f32_32x32x16_bf16 a[16:31], v[64:67], v[84:87], a[16:31]
  ds_read_b64_tr_b16 v[98:99], v18 offset:10240
  v_mfma_f32_32x32x16_bf16 a[32:47], v[64:67], v[88:91], a[32:47]
  ds_read_b128 v[112:115], v13 offset:0
  v_mfma_f32_32x32x16_bf16 a[48:63], v[64:67], v[92:95], a[48:63]
  ds_read_b128 v[116:119], v13 offset:2048
  s_add_u32 m0, s24, 32768
  s_nop 0
  buffer_load_dwordx4 v2, s[4:7], s20 offen lds
  v_mfma_f32_32x32x16_bf16 a[64:79], v[68:71], v[80:83], a[64:79]
  ds_read_b128 v[120:123], v13 offset:4096
  v_mfma_f32_32x32x16_bf16 a[80:95], v[68:71], v[84:87], a[80:95]
  ds_read_b128 v[124:127], v13 offset:6144
  v_mfma_f32_32x32x16_bf16 a[96:111], v[68:71], v[88:91], a[96:111]
  ds_read_b64_tr_b16 v[100:101], v19 offset:8192
  v_mfma_f32_32x32x16_bf16 a[112:127], v[68:71], v[92:95], a[112:127]
  ds_read_b64_tr_b16 v[102:103], v19 offset:10240
  s_add_u32 m0, s24, 33792
  s_nop 0
  buffer_load_dwordx4 v3, s[4:7], s20 offen lds
  v_mfma_f32_32x32x16_bf16 a[128:143], v[72:75], v[80:83], a[128:143]
  ds_read_b64_tr_b16 v[104:105], v20 offset:8192
  v_mfma_f32_32x32x16_bf16 a[144:159], v[72:75], v[84:87], a[144:159]
  ds_read_b64_tr_b16 v[106:107], v20 offset:10240
  v_mfma_f32_32x32x16_bf16 a[160:175], v[72:75], v[88:91], a[160:175]
  ds_read_b64_tr_b16 v[108:109], v21 offset:8192
  v_mfma_f32_32x32x16_bf16 a[176:191], v[72:75], v[92:95], a[176:191]
  ds_read_b64_tr_b16 v[110:111], v21 offset:10240
  s_add_u32 m0, s24, 34816
  s_nop 0
  buffer_load_dwordx4 v4, s[4:7], s20 offen lds
  v_mfma_f32_32x32x16_bf16 a[192:207], v[76:79], v[80:83], a[192:207]
  v_mfma_f32_32x32x16_bf16 a[208:223], v[76:79], v[84:87], a[208:223]
  v_mfma_f32_32x32x16_bf16 a[224:239], v[76:79], v[88:91], a[224:239]
  v_mfma_f32_32x32x16_bf16 a[240:255], v[76:79], v[92:95], a[240:255]
  s_add_u32 m0, s24, 35840
  s_nop 0
  buffer_load_dwordx4 v5, s[4:7], s20 offen lds
  s_waitcnt vmcnt(12) lgkmcnt(0)
  s_barrier
  v_mfma_f32_32x32x16_bf16 a[0:15], v[96:99], v[112:115], a[0:15]
  ds_read_b64_tr_b16 v[64:65], v18 offset:32768
  v_mfma_f32_32x32x16_bf16 a[16:31], v[96:99], v[116:119], a[16:31]
  ds_read_b64_tr_b16 v[66:67], v18 offset:34816
  v_mfma_f32_32x32x16_bf16 a[32:47], v[96:99], v[120:123], a[32:47]
  ds_read_b128 v[80:83], v12 offset:32768
  v_mfma_f32_32x32x16_bf16 a[48:63], v[96:99], v[124:127], a[48:63]
  ds_read_b128 v[84:87], v12 offset:34816
  s_add_u32 m0, s25, 32768
  s_nop 0
  buffer_load_dwordx4 v6, s[8:11], s21 offen lds
  v_mfma_f32_32x32x16_bf16 a[64:79], v[100:103], v[112:115], a[64:79]
  ds_read_b128 v[88:91], v12 offset:36864
  v_mfma_f32_32x32x16_bf16 a[80:95], v[100:103], v[116:119], a[80:95]
  ds_read_b128 v[92:95], v12 offset:38912
  v_mfma_f32_32x32x16_bf16 a[96:111], v[100:103], v[120:123], a[96:111]
  ds_read_b64_tr_b16 v[68:69], v19 offset:32768
  v_mfma_f32_32x32x16_bf16 a[112:127], v[100:103], v[124:127], a[112:127]
  ds_read_b64_tr_b16 v[70:71], v19 offset:34816
  s_add_u32 m0, s25, 33792
  s_nop 0
  buffer_load_dwordx4 v7, s[8:11], s21 offen lds
  v_mfma_f32_32x32x16_bf16 a[128:143], v[104:107], v[112:115], a[128:143]
  ds_read_b64_tr_b16 v[72:73], v20 offset:32768
  v_mfma_f32_32x32x16_bf16 a[144:159], v[104:107], v[116:119], a[144:159]
  ds_read_b64_tr_b16 v[74:75], v20 offset:34816
  v_mfma_f32_32x32x16_bf16 a[160:175], v[104:107], v[120:123], a[160:175]
  ds_read_b64_tr_b16 v[76:77], v21 offset:32768
  v_mfma_f32_32x32x16_bf16 a[176:191], v[104:107], v[124:127], a[176:191]
  ds_read_b64_tr_b16 v[78:79], v21 offset:34816
  s_add_u32 m0, s25, 34816
  s_nop 0
  buffer_load_dwordx4 v8, s[8:11], s21 offen lds
  v_mfma_f32_32x32x16_bf16 a[192:207], v[108:111], v[112:115], a[192:207]
  v_mfma_f32_32x32x16_bf16 a[208:223], v[108:111], v[116:119], a[208:223]
  v_mfma_f32_32x32x16_bf16 a[224:239], v[108:111], v[120:123], a[224:239]
  v_mfma_f32_32x32x16_bf16 a[240:255], v[108:111], v[124:127], a[240:255]
  s_add_u32 m0, s25, 35840
  s_nop 0
  buffer_load_dwordx4 v9, s[8:11], s21 offen lds
  s_add_u32 s20, s20, 64
  s_add_u32 s21, s21, s23
  s_waitcnt lgkmcnt(0)
  v_mfma_f32_32x32x16_bf16 a[0:15], v[64:67], v[80:83], a[0:15]
  ds_read_b64_tr_b16 v[96:97], v18 offset:40960
  v_mfma_f32_32x32x16_bf16 a[16:31], v[64:67], v[84:87], a[16:31]
  ds_read_b64_tr_b16 v[98:99], v18 offset:43008
  v_mfma_f32_32x32x16_bf16 a[32:47], v[64:67], v[88:91], a[32:47]
  ds_read_b128 v[112:115], v13 offset:32768
  v_mfma_f32_32x32x16_bf16 a[48:63], v[64:67], v[92:95], a[48:63]
  ds_read_b128 v[116:119], v13 offset:34816
  s_add_u32 m0, s24, 65536
  s_nop 0
  buffer_load_dwordx4 v2, s[4:7], s20 offen lds
  v_mfma_f32_32x32x16_bf16 a[64:79], v[68:71], v[80:83], a[64:79]
  ds_read_b128 v[120:123], v13 offset:36864
  v_mfma_f32_32x32x16_bf16 a[80:95], v[68:71], v[84:87], a[80:95]
  ds_read_b128 v[124:127], v13 offset:38912
  v_mfma_f32_32x32x16_bf16 a[96:111], v[68:71], v[88:91], a[96:111]
  ds_read_b64_tr_b16 v[100:101], v19 offset:40960
  v_mfma_f32_32x32x16_bf16 a[112:127], v[68:71], v[92:95], a[112:127]
  ds_read_b64_tr_b16 v[102:103], v19 offset:43008
  s_add_u32 m0, s24, 66560
  s_nop 0
  buffer_load_dwordx4 v3, s[4:7], s20 offen lds
  v_mfma_f32_32x32x16_bf16 a[128:143], v[72:75], v[80:83], a[128:143]
  ds_read_b64_tr_b16 v[104:105], v20 offset:40960
  v_mfma_f32_32x32x16_bf16 a[144:159], v[72:75], v[84:87], a[144:159]
  ds_read_b64_tr_b16 v[106:107], v20 offset:43008
  v_mfma_f32_32x32x16_bf16 a[160:175], v[72:75], v[88:91], a[160:175]
  ds_read_b64_tr_b16 v[108:109], v21 offset:40960
  v_mfma_f32_32x32x16_bf16 a[176:191], v[72:75], v[92:95], a[176:191]
  ds_read_b64_tr_b16 v[110:111], v21 offset:43008
  s_add_u32 m0, s24, 67584
  s_nop 0
  buffer_load_dwordx4 v4, s[4:7], s20 offen lds
  v_mfma_f32_32x32x16_bf16 a[192:207], v[76:79], v[80:83], a[192:207]
  v_mfma_f32_32x32x16_bf16 a[208:223], v[76:79], v[84:87], a[208:223]
  v_mfma_f32_32x32x16_bf16 a[224:239], v[76:79], v[88:91], a[224:239]
  v_mfma_f32_32x32x16_bf16 a[240:255], v[76:79], v[92:95], a[240:255]
  s_add_u32 m0, s24, 68608
  s_nop 0
  buffer_load_dwordx4 v5, s[4:7], s20 offen lds
  s_waitcnt vmcnt(12) lgkmcnt(0)
  s_barrier
  v_mfma_f32_32x32x16_bf16 a[0:15], v[96:99], v[112:115], a[0:15]
  ds_read_b64_tr_b16 v[64:65], v14 offset:0
  v_mfma_f32_32x32x16_bf16 a[16:31], v[96:99], v[116:119], a[16:31]
  ds_read_b64_tr_b16 v[66:67], v14 offset:2048
  v_mfma_f32_32x32x16_bf16 a[32:47], v[96:99], v[120:123], a[32:47]
  ds_read_b128 v[80:83], v10 offset:0
  v_mfma_f32_32x32x16_bf16 a[48:63], v[96:99], v[124:127], a[48:63]
  ds_read_b128 v[84:87], v10 offset:2048
  s_add_u32 m0, s25, 65536
  s_nop 0
  buffer_load_dwordx4 v6, s[8:11], s21 offen lds
  v_mfma_f32_32x32x16_bf16 a[64:79], v[100:103], v[112:115], a[64:79]
  ds_read_b128 v[88:91], v10 offset:4096
  v_mfma_f32_32x32x16_bf16 a[80:95], v[100:103], v[116:119], a[80:95]
  ds_read_b128 v[92:95], v10 offset:6144
  v_mfma_f32_32x32x16_bf16 a[96:111], v[100:103], v[120:123], a[96:111]
  ds_read_b64_tr_b16 v[68:69], v15 offset:0
  v_mfma_f32_32x32x16_bf16 a[112:127], v[100:103], v[124:127], a[112:127]
  ds_read_b64_tr_b16 v[70:71], v15 offset:2048
  s_add_u32 m0, s25, 66560
  s_nop 0
  buffer_load_dwordx4 v7, s[8:11], s21 offen lds
  v_mfma_f32_32x32x16_bf16 a[128:143], v[104:107], v[112:115], a[128:143]
  ds_read_b64_tr_b16 v[72:73], v16 offset:0
  v_mfma_f32_32x32x16_bf16 a[144:159], v[104:107], v[116:119], a[144:159]
  ds_read_b64_tr_b16 v[74:75], v16 offset:2048
  v_mfma_f32_32x32x16_bf16 a[160:175], v[104:107], v[120:123], a[160:175]
  ds_read_b64_tr_b16 v[76:77], v17 offset:0
  v_mfma_f32_32x32x16_bf16 a[176:191], v[104:107], v[124:127], a[176:191]
  ds_read_b64_tr_b16 v[78:79], v17 offset:2048
  s_add_u32 m0, s25, 67584
  s_nop 0
  buffer_load_dwordx4 v8, s[8:11], s21 offen lds
  v_mfma_f32_32x32x16_bf16 a[192:207], v[108:111], v[112:115], a[192:207]
  v_mfma_f32_32x32x16_bf16 a[208:223], v[108:111], v[116:119], a[208:223]
  v_mfma_f32_32x32x16_bf16 a[224:239], v[108:111], v[120:123], a[224:239]
  v_mfma_f32_32x32x16_bf16 a[240:255], v[108:111], v[124:127], a[240:255]
  s_add_u32 m0, s25, 68608
  s_nop 0
  buffer_load_dwordx4 v9, s[8:11], s21 offen lds
  s_add_u32 s20, s20, 64
  s_add_u32 s21, s21, s23
  s_waitcnt lgkmcnt(0)
  v_mfma_f32_32x32x16_bf16 a[0:15], v[64:67], v[80:83], a[0:15]
  ds_read_b64_tr_b16 v[96:97], v14 offset:8192
  v_mfma_f32_32x32x16_bf16 a[16:31], v[64:67], v[84:87], a[16:31]
  ds_read_b64_tr_b16 v[98:99], v14 offset:10240
  v_mfma_f32_32x32x16_bf16 a[32:47], v[64:67], v[88:91], a[32:47]
  ds_read_b128 v[112:115], v11 offset:0
  v_mfma_f32_32x32x16_bf16 a[48:63], v[64:67], v[92:95], a[48:63]
  ds_read_b128 v[116:119], v11 offset:2048
  s_add_u32 m0, s24, 98304
  s_nop 0
  buffer_load_dwordx4 v2, s[4:7], s20 offen lds
  v_mfma_f32_32x32x16_bf16 a[64:79], v[68:71], v[80:83], a[64:79]
  ds_read_b128 v[120:123], v11 offset:4096
  v_mfma_f32_32x32x16_bf16 a[80:95], v[68:71], v[84:87], a[80:95]
  ds_read_b128 v[124:127], v11 offset:6144
  v_mfma_f32_32x32x16_bf16 a[96:111], v[68:71], v[88:91], a[96:111]
  ds_read_b64_tr_b16 v[100:101], v15 offset:8192
  v_mfma_f32_32x32x16_bf16 a[112:127], v[68:71], v[92:95], a[112:127]
  ds_read_b64_tr_b16 v[102:103], v15 offset:10240
  s_add_u32 m0, s24, 99328
  s_nop 0
  buffer_load_dwordx4 v3, s[4:7], s20 offen lds
  v_mfma_f32_32x32x16_bf16 a[128:143], v[72:75], v[80:83], a[128:143]
  ds_read_b64_tr_b16 v[104:105], v16 offset:8192
  v_mfma_f32_32x32x16_bf16 a[144:159], v[72:75], v[84:87], a[144:159]
  ds_read_b64_tr_b16 v[106:107], v16 offset:10240
  v_mfma_f32_32x32x16_bf16 a[160:175], v[72:75], v[88:91], a[160:175]
  ds_read_b64_tr_b16 v[108:109], v17 offset:8192
  v_mfma_f32_32x32x16_bf16 a[176:191], v[72:75], v[92:95], a[176:191]
  ds_read_b64_tr_b16 v[110:111], v17 offset:10240
  s_add_u32 m0, s24, 100352
  s_nop 0
  buffer_load_dwordx4 v4, s[4:7], s20 offen lds
  v_mfma_f32_32x32x16_bf16 a[192:207], v[76:79], v[80:83], a[192:207]
  v_mfma_f32_32x32x16_bf16 a[208:223], v[76:79], v[84:87], a[208:223]
  v_mfma_f32_32x32x16_bf16 a[224:239], v[76:79], v[88:91], a[224:239]
  v_mfma_f32_32x32x16_bf16 a[240:255], v[76:79], v[92:95], a[240:255]
  s_add_u32 m0, s24, 101376
  s_nop 0
  buffer_load_dwordx4 v5, s[4:7], s20 offen lds
  s_waitcnt vmcnt(12) lgkmcnt(0)
  s_barrier
  v_mfma_f32_32x32x16_bf16 a[0:15], v[96:99], v[112:115], a[0:15]
  ds_read_b64_tr_b16 v[64:65], v14 offset:32768
  v_mfma_f32_32x32x16_bf16 a[16:31], v[96:99], v[116:119], a[16:31]
  ds_read_b64_tr_b16 v[66:67], v14 offset:34816
  v_mfma_f32_32x32x16_bf16 a[32:47], v[96:99], v[120:123], a[32:47]
  ds_read_b128 v[80:83], v10 offset:32768
  v_mfma_f32_32x32x16_bf16 a[48:63], v[96:99], v[124:127], a[48:63]
  ds_read_b128 v[84:87], v10 offset:34816
  s_add_u32 m0, s25, 98304
  s_nop 0
  buffer_load_dwordx4 v6, s[8:11], s21 offen lds
  v_mfma_f32_32x32x16_bf16 a[64:79], v[100:103], v[112:115], a[64:79]
  ds_read_b128 v[88:91], v10 offset:36864
  v_mfma_f32_32x32x16_bf16 a[80:95], v[100:103], v[116:119], a[80:95]
  ds_read_b128 v[92:95], v10 offset:38912
  v_mfma_f32_32x32x16_bf16 a[96:111], v[100:103], v[120:123], a[96:111]
  ds_read_b64_tr_b16 v[68:69], v15 offset:32768
  v_mfma_f32_32x32x16_bf16 a[112:127], v[100:103], v[124:127], a[112:127]
  ds_read_b64_tr_b16 v[70:71], v15 offset:34816
  s_add_u32 m0, s25, 99328
  s_nop 0
  buffer_load_dwordx4 v7, s[8:11], s21 offen lds
  v_mfma_f32_32x32x16_bf16 a[128:143], v[104:107], v[112:115], a[128:143]
  ds_read_b64_tr_b16 v[72:73], v16 offset:32768
  v_mfma_f32_32x32x16_bf16 a[144:159], v[104:107], v[116:119], a[144:159]
  ds_read_b64_tr_b16 v[74:75], v16 offset:34816
  v_mfma_f32_32x32x16_bf16 a[160:175], v[104:107], v[120:123], a[160:175]
  ds_read_b64_tr_b16 v[76:77], v17 offset:32768
  v_mfma_f32_32x32x16_bf16 a[176:191], v[104:107], v[124:127], a[176:191]
  ds_read_b64_tr_b16 v[78:79], v17 offset:34816
  s_add_u32 m0, s25, 100352
  s_nop 0
  buffer_load_dwordx4 v8, s[8:11], s21 offen lds
  v_mfma_f32_32x32x16_bf16 a[192:207], v[108:111], v[112:115], a[192:207]
  v_mfma_f32_32x32x16_bf16 a[208:223], v[108:111], v[116:119], a[208:223]
  v_mfma_f32_32x32x16_bf16 a[224:239], v[108:111], v[120:123], a[224:239]
  v_mfma_f32_32x32x16_bf16 a[240:255], v[108:111], v[124:127], a[240:255]
  s_add_u32 m0, s25, 101376
  s_nop 0
  buffer_load_dwordx4 v9, s[8:11], s21 offen lds
  s_add_u32 s20, s20, 64
  s_add_u32 s21, s21, s23
  s_waitcnt lgkmcnt(0)
  v_mfma_f32_32x32x16_bf16 a[0:15], v[64:67], v[80:83], a[0:15]
  ds_read_b64_tr_b16 v[96:97], v14 offset:40960
  v_mfma_f32_32x32x16_bf16 a[16:31], v[64:67], v[84:87], a[16:31]
  ds_read_b64_tr_b16 v[98:99], v14 offset:43008
  v_mfma_f32_32x32x16_bf16 a[32:47], v[64:67], v[88:91], a[32:47]
  ds_read_b128 v[112:115], v11 offset:32768
  v_mfma_f32_32x32x16_bf16 a[48:63], v[64:67], v[92:95], a[48:63]
  ds_read_b128 v[116:119], v11 offset:34816
  s_add_u32 m0, s24, 0
  s_nop 0
  buffer_load_dwordx4 v2, s[4:7], s20 offen lds
  v_mfma_f32_32x32x16_bf16 a[64:79], v[68:71], v[80:83], a[64:79]
  ds_read_b128 v[120:123], v11 offset:36864
  v_mfma_f32_32x32x16_bf16 a[80:95], v[68:71], v[84:87], a[80:95]
  ds_read_b128 v[124:127], v11 offset:38912
  v_mfma_f32_32x32x16_bf16 a[96:111], v[68:71], v[88:91], a[96:111]
  ds_read_b64_tr_b16 v[100:101], v15 offset:40960
  v_mfma_f32_32x32x16_bf16 a[112:127], v[68:71], v[92:95], a[112:127]
  ds_read_b64_tr_b16 v[102:103], v15 offset:43008
  s_add_u32 m0, s24, 1024
  s_nop 0
  buffer_load_dwordx4 v3, s[4:7], s20 offen lds
  v_mfma_f32_32x32x16_bf16 a[128:143], v[72:75], v[80:83], a[128:143]
  ds_read_b64_tr_b16 v[104:105], v16 offset:40960
  v_mfma_f32_32x32x16_bf16 a[144:159], v[72:75], v[84:87], a[144:159]
  ds_read_b64_tr_b16 v[106:107], v16 offset:43008
  v_mfma_f32_32x32x16_bf16 a[160:175], v[72:75], v[88:91], a[160:175]
  ds_read_b64_tr_b16 v[108:109], v17 offset:40960
  v_mfma_f32_32x32x16_bf16 a[176:191], v[72:75], v[92:95], a[176:191]
  ds_read_b64_tr_b16 v[110:111], v17 offset:43008
  s_add_u32 m0, s24, 2048
  s_nop 0
  buffer_load_dwordx4 v4, s[4:7], s20 offen lds
  v_mfma_f32_32x32x16_bf16 a[192:207], v[76:79], v[80:83], a[192:207]
  v_mfma_f32_32x32x16_bf16 a[208:223], v[76:79], v[84:87], a[208:223]
  v_mfma_f32_32x32x16_bf16 a[224:239], v[76:79], v[88:91], a[224:239]
  v_mfma_f32_32x32x16_bf16 a[240:255], v[76:79], v[92:95], a[240:255]
  s_add_u32 m0, s24, 3072
  s_nop 0
  buffer_load_dwordx4 v5, s[4:7], s20 offen lds
  s_waitcnt vmcnt(12) lgkmcnt(0)
  s_barrier
  v_mfma_f32_32x32x16_bf16 a[0:15], v[96:99], v[112:115], a[0:15]
  ds_read_b64_tr_b16 v[64:65], v18 offset:0
  v_mfma_f32_32x32x16_bf16 a[16:31], v[96:99], v[116:119], a[16:31]
  ds_read_b64_tr_b16 v[66:67], v18 offset:2048
  v_mfma_f32_32x32x16_bf16 a[32:47], v[96:99], v[120:123], a[32:47]
  ds_read_b128 v[80:83], v12 offset:0
  v_mfma_f32_32x32x16_bf16 a[48:63], v[96:99], v[124:127], a[48:63]
  ds_read_b128 v[84:87], v12 offset:2048
  s_add_u32 m0, s25, 0
  s_nop 0
  buffer_load_dwordx4 v6, s[8:11], s21 offen lds
  v_mfma_f32_32x32x16_bf16 a[64:79], v[100:103], v[112:115], a[64:79]
  ds_read_b128 v[88:91], v12 offset:4096
  v_mfma_f32_32x32x16_bf16 a[80:95], v[100:103], v[116:119], a[80:95]
  ds_read_b128 v[92:95], v12 offset:6144
  v_mfma_f32_32x32x16_bf16 a[96:111], v[100:103], v[120:123], a[96:111]
  ds_read_b64_tr_b16 v[68:69], v19 offset:0
  v_mfma_f32_32x32x16_bf16 a[112:127], v[100:103], v[124:127], a[112:127]
  ds_read_b64_tr_b16 v[70:71], v19 offset:2048
  s_add_u32 m0, s25, 1024
  s_nop 0
  buffer_load_dwordx4 v7, s[8:11], s21 offen lds
  v_mfma_f32_32x32x16_bf16 a[128:143], v[104:107], v[112:115], a[128:143]
  ds_read_b64_tr_b16 v[72:73], v20 offset:0
  v_mfma_f32_32x32x16_bf16 a[144:159], v[104:107], v[116:119], a[144:159]
  ds_read_b64_tr_b16 v[74:75], v20 offset:2048
  v_mfma_f32_32x32x16_bf16 a[160:175], v[104:107], v[120:123], a[160:175]
  ds_read_b64_tr_b16 v[76:77], v21 offset:0
  v_mfma_f32_32x32x16_bf16 a[176:191], v[104:107], v[124:127], a[176:191]
  ds_read_b64_tr_b16 v[78:79], v21 offset:2048
  s_add_u32 m0, s25, 2048
  s_nop 0
  buffer_load_dwordx4 v8, s[8:11], s21 offen lds
  v_mfma_f32_32x32x16_bf16 a[192:207], v[108:111], v[112:115], a[192:207]
  v_mfma_f32_32x32x16_bf16 a[208:223], v[108:111], v[116:119], a[208:223]
  v_mfma_f32_32x32x16_bf16 a[224:239], v[108:111], v[120:123], a[224:239]
  v_mfma_f32_32x32x16_bf16 a[240:255], v[108:111], v[124:127], a[240:255]
  s_add_u32 m0, s25, 3072
  s_nop 0
  buffer_load_dwordx4 v9, s[8:11], s21 offen lds
  s_add_u32 s20, s20, 64
  s_add_u32 s21, s21, s23
  s_waitcnt lgkmcnt(0)
  v_mfma_f32_32x32x16_bf16 a[0:15], v[64:67], v[80:83], a[0:15]
  ds_read_b64_tr_b16 v[96:97], v18 offset:8192
  v_mfma_f32_32x32x16_bf16 a[16:31], v[64:67], v[84:87], a[16:31]
  ds_read_b64_tr_b16 v[98:99], v18 offset:10240
  v_mfma_f32_32x32x16_bf16 a[32:47], v[64:67], v[88:91], a[32:47]
  ds_read_b128 v[112:115], v13 offset:0
  v_mfma_f32_32x32x16_bf16 a[48:63], v[64:67], v[92:95], a[48:63]
  ds_read_b128 v[116:119], v13 offset:2048
  s_add_u32 m0, s24, 32768
  s_nop 0
  buffer_load_dwordx4 v2, s[4:7], s20 offen lds
  v_mfma_f32_32x32x16_bf16 a[64:79], v[68:71], v[80:83], a[64:79]
  ds_read_b128 v[120:123], v13 offset:4096
  v_mfma_f32_32x32x16_bf16 a[80:95], v[68:71], v[84:87], a[80:95]
  ds_read_b128 v[124:127], v13 offset:6144
  v_mfma_f32_32x32x16_bf16 a[96:111], v[68:71], v[88:91], a[96:111]
  ds_read_b64_tr_b16 v[100:101], v19 offset:8192
  v_mfma_f32_32x32x16_bf16 a[112:127], v[68:71], v[92:95], a[112:127]
  ds_read_b64_tr_b16 v[102:103], v19 offset:10240
  s_add_u32 m0, s24, 33792
  s_nop 0
  buffer_load_dwordx4 v3, s[4:7], s20 offen lds
  v_mfma_f32_32x32x16_bf16 a[128:143], v[72:75], v[80:83], a[128:143]
  ds_read_b64_tr_b16 v[104:105], v20 offset:8192
  v_mfma_f32_32x32x16_bf16 a[144:159], v[72:75], v[84:87], a[144:159]
  ds_read_b64_tr_b16 v[106:107], v20 offset:10240
  v_mfma_f32_32x32x16_bf16 a[160:175], v[72:75], v[88:91], a[160:175]
  ds_read_b64_tr_b16 v[108:109], v21 offset:8192
  v_mfma_f32_32x32x16_bf16 a[176:191], v[72:75], v[92:95], a[176:191]
  ds_read_b64_tr_b16 v[110:111], v21 offset:10240
  s_add_u32 m0, s24, 34816
  s_nop 0
  buffer_load_dwordx4 v4, s[4:7], s20 offen lds
  v_mfma_f32_32x32x16_bf16 a[192:207], v[76:79], v[80:83], a[192:207]
  v_mfma_f32_32x32x16_bf16 a[208:223], v[76:79], v[84:87], a[208:223]
  v_mfma_f32_32x32x16_bf16 a[224:239], v[76:79], v[88:91], a[224:239]
  v_mfma_f32_32x32x16_bf16 a[240:255], v[76:79], v[92:95], a[240:255]
  s_add_u32 m0, s24, 35840
  s_nop 0
  buffer_load_dwordx4 v5, s[4:7], s20 offen lds
  s_waitcnt vmcnt(12) lgkmcnt(0)
  s_barrier
  v_mfma_f32_32x32x16_bf16 a[0:15], v[96:99], v[112:115], a[0:15]
  ds_read_b64_tr_b16 v[64:65], v18 offset:32768
  v_mfma_f32_32x32x16_bf16 a[16:31], v[96:99], v[116:119], a[16:31]
  ds_read_b64_tr_b16 v[66:67], v18 offset:34816
  v_mfma_f32_32x32x16_bf16 a[32:47], v[96:99], v[120:123], a[32:47]
  ds_read_b128 v[80:83], v12 offset:32768
  v_mfma_f32_32x32x16_bf16 a[48:63], v[96:99], v[124:127], a[48:63]
  ds_read_b128 v[84:87], v12 offset:34816
  s_add_u32 m0, s25, 32768
  s_nop 0
  buffer_load_dwordx4 v6, s[8:11], s21 offen lds
  v_mfma_f32_32x32x16_bf16 a[64:79], v[100:103], v[112:115], a[64:79]
  ds_read_b128 v[88:91], v12 offset:36864
  v_mfma_f32_32x32x16_bf16 a[80:95], v[100:103], v[116:119], a[80:95]
  ds_read_b128 v[92:95], v12 offset:38912
  v_mfma_f32_32x32x16_bf16 a[96:111], v[100:103], v[120:123], a[96:111]
  ds_read_b64_tr_b16 v[68:69], v19 offset:32768
  v_mfma_f32_32x32x16_bf16 a[112:127], v[100:103], v[124:127], a[112:127]
  ds_read_b64_tr_b16 v[70:71], v19 offset:34816
  s_add_u32 m0, s25, 33792
  s_nop 0
  buffer_load_dwordx4 v7, s[8:11], s21 offen lds
  v_mfma_f32_32x32x16_bf16 a[128:143], v[104:107], v[112:115], a[128:143]
  ds_read_b64_tr_b16 v[72:73], v20 offset:32768
  v_mfma_f32_32x32x16_bf16 a[144:159], v[104:107], v[116:119], a[144:159]
  ds_read_b64_tr_b16 v[74:75], v20 offset:34816
  v_mfma_f32_32x32x16_bf16 a[160:175], v[104:107], v[120:123], a[160:175]
  ds_read_b64_tr_b16 v[76:77], v21 offset:32768
  v_mfma_f32_32x32x16_bf16 a[176:191], v[104:107], v[124:127], a[176:191]
  ds_read_b64_tr_b16 v[78:79], v21 offset:34816
  s_add_u32 m0, s25, 34816
  s_nop 0
  buffer_load_dwordx4 v8, s[8:11], s21 offen lds
  v_mfma_f32_32x32x16_bf16 a[192:207], v[108:111], v[112:115], a[192:207]
  v_mfma_f32_32x32x16_bf16 a[208:223], v[108:111], v[116:119], a[208:223]
  v_mfma_f32_32x32x16_bf16 a[224:239], v[108:111], v[120:123], a[224:239]
  v_mfma_f32_32x32x16_bf16 a[240:255], v[108:111], v[124:127], a[240:255]
  s_add_u32 m0, s25, 35840
  s_nop 0
  buffer_load_dwordx4 v9, s[8:11], s21 offen lds
  s_add_u32 s20, s20, 64
  s_add_u32 s21, s21, s23
  s_waitcnt lgkmcnt(0)
  v_mfma_f32_32x32x16_bf16 a[0:15], v[64:67], v[80:83], a[0:15]
  ds_read_b64_tr_b16 v[96:97], v18 offset:40960
  v_mfma_f32_32x32x16_bf16 a[16:31], v[64:67], v[84:87], a[16:31]
  ds_read_b64_tr_b16 v[98:99], v18 offset:43008
  v_mfma_f32_32x32x16_bf16 a[32:47], v[64:67], v[88:91], a[32:47]
  ds_read_b128 v[112:115], v13 offset:32768
  v_mfma_f32_32x32x16_bf16 a[48:63], v[64:67], v[92:95], a[48:63]
  ds_read_b128 v[116:119], v13 offset:34816
  s_add_u32 m0, s24, 65536
  s_nop 0
  buffer_load_dwordx4 v2, s[4:7], s20 offen lds
  v_mfma_f32_32x32x16_bf16 a[64:79], v[68:71], v[80:83], a[64:79]
  ds_read_b128 v[120:123], v13 offset:36864
  v_mfma_f32_32x32x16_bf16 a[80:95], v[68:71], v[84:87], a[80:95]
  ds_read_b128 v[124:127], v13 offset:38912
  v_mfma_f32_32x32x16_bf16 a[96:111], v[68:71], v[88:91], a[96:111]
  ds_read_b64_tr_b16 v[100:101], v19 offset:40960
  v_mfma_f32_32x32x16_bf16 a[112:127], v[68:71], v[92:95], a[112:127]
  ds_read_b64_tr_b16 v[102:103], v19 offset:43008
  s_add_u32 m0, s24, 66560
  s_nop 0
  buffer_load_dwordx4 v3, s[4:7], s20 offen lds
  v_mfma_f32_32x32x16_bf16 a[128:143], v[72:75], v[80:83], a[128:143]
  ds_read_b64_tr_b16 v[104:105], v20 offset:40960
  v_mfma_f32_32x32x16_bf16 a[144:159], v[72:75], v[84:87], a[144:159]
  ds_read_b64_tr_b16 v[106:107], v20 offset:43008
  v_mfma_f32_32x32x16_bf16 a[160:175], v[72:75], v[88:91], a[160:175]
  ds_read_b64_tr_b16 v[108:109], v21 offset:40960
  v_mfma_f32_32x32x16_bf16 a[176:191], v[72:75], v[92:95], a[176:191]
  ds_read_b64_tr_b16 v[110:111], v21 offset:43008
  s_add_u32 m0, s24, 67584
  s_nop 0
  buffer_load_dwordx4 v4, s[4:7], s20 offen lds
  v_mfma_f32_32x32x16_bf16 a[192:207], v[76:79], v[80:83], a[192:207]
  v_mfma_f32_32x32x16_bf16 a[208:223], v[76:79], v[84:87], a[208:223]
  v_mfma_f32_32x32x16_bf16 a[224:239], v[76:79], v[88:91], a[224:239]
  v_mfma_f32_32x32x16_bf16 a[240:255], v[76:79], v[92:95], a[240:255]
  s_add_u32 m0, s24, 68608
  s_nop 0
  buffer_load_dwordx4 v5, s[4:7], s20 offen lds
  s_waitcnt vmcnt(12) lgkmcnt(0)
  s_barrier
  v_mfma_f32_32x32x16_bf16 a[0:15], v[96:99], v[112:115], a[0:15]
  ds_read_b64_tr_b16 v[64:65], v14 offset:0
  v_mfma_f32_32x32x16_bf16 a[16:31], v[96:99], v[116:119], a[16:31]
  ds_read_b64_tr_b16 v[66:67], v14 offset:2048
  v_mfma_f32_32x32x16_bf16 a[32:47], v[96:99], v[120:123], a[32:47]
  ds_read_b128 v[80:83], v10 offset:0
  v_mfma_f32_32x32x16_bf16 a[48:63], v[96:99], v[124:127], a[48:63]
  ds_read_b128 v[84:87], v10 offset:2048
  s_add_u32 m0, s25, 65536
  s_nop 0
  buffer_load_dwordx4 v6, s[8:11], s21 offen lds
  v_mfma_f32_32x32x16_bf16 a[64:79], v[100:103], v[112:115], a[64:79]
  ds_read_b128 v[88:91], v10 offset:4096
  v_mfma_f32_32x32x16_bf16 a[80:95], v[100:103], v[116:119], a[80:95]
  ds_read_b128 v[92:95], v10 offset:6144
  v_mfma_f32_32x32x16_bf16 a[96:111], v[100:103], v[120:123], a[96:111]
  ds_read_b64_tr_b16 v[68:69], v15 offset:0
  v_mfma_f32_32x32x16_bf16 a[112:127], v[100:103], v[124:127], a[112:127]
  ds_read_b64_tr_b16 v[70:71], v15 offset:2048
  s_add_u32 m0, s25, 66560
  s_nop 0
  buffer_load_dwordx4 v7, s[8:11], s21 offen lds
  v_mfma_f32_32x32x16_bf16 a[128:143], v[104:107], v[112:115], a[128:143]
  ds_read_b64_tr_b16 v[72:73], v16 offset:0
  v_mfma_f32_32x32x16_bf16 a[144:159], v[104:107], v[116:119], a[144:159]
  ds_read_b64_tr_b16 v[74:75], v16 offset:2048
  v_mfma_f32_32x32x16_bf16 a[160:175], v[104:107], v[120:123], a[160:175]
  ds_read_b64_tr_b16 v[76:77], v17 offset:0
  v_mfma_f32_32x32x16_bf16 a[176:191], v[104:107], v[124:127], a[176:191]
  ds_read_b64_tr_b16 v[78:79], v17 offset:2048
  s_add_u32 m0, s25, 67584
  s_nop 0
  buffer_load_dwordx4 v8, s[8:11], s21 offen lds
  v_mfma_f32_32x32x16_bf16 a[192:207], v[108:111], v[112:115], a[192:207]
  v_mfma_f32_32x32x16_bf16 a[208:223], v[108:111], v[116:119], a[208:223]
  v_mfma_f32_32x32x16_bf16 a[224:239], v[108:111], v[120:123], a[224:239]
  v_mfma_f32_32x32x16_bf16 a[240:255], v[108:111], v[124:127], a[240:255]
  s_add_u32 m0, s25, 68608
  s_nop 0
  buffer_load_dwordx4 v9, s[8:11], s21 offen lds
  s_add_u32 s20, s20, 64
  s_add_u32 s21, s21, s23
  s_waitcnt lgkmcnt(0)
  v_mfma_f32_32x32x16_bf16 a[0:15], v[64:67], v[80:83], a[0:15]
  ds_read_b64_tr_b16 v[96:97], v14 offset:8192
  v_mfma_f32_32x32x16_bf16 a[16:31], v[64:67], v[84:87], a[16:31]
  ds_read_b64_tr_b16 v[98:99], v14 offset:10240
  v_mfma_f32_32x32x16_bf16 a[32:47], v[64:67], v[88:91], a[32:47]
  ds_read_b128 v[112:115], v11 offset:0
  v_mfma_f32_32x32x16_bf16 a[48:63], v[64:67], v[92:95], a[48:63]
  ds_read_b128 v[116:119], v11 offset:2048
  s_add_u32 m0, s24, 98304
  s_nop 0
  buffer_load_dwordx4 v2, s[4:7], s20 offen lds
  v_mfma_f32_32x32x16_bf16 a[64:79], v[68:71], v[80:83], a[64:79]
  ds_read_b128 v[120:123], v11 offset:4096
  v_mfma_f32_32x32x16_bf16 a[80:95], v[68:71], v[84:87], a[80:95]
  ds_read_b128 v[124:127], v11 offset:6144
  v_mfma_f32_32x32x16_bf16 a[96:111], v[68:71], v[88:91], a[96:111]
  ds_read_b64_tr_b16 v[100:101], v15 offset:8192
  v_mfma_f32_32x32x16_bf16 a[112:127], v[68:71], v[92:95], a[112:127]
  ds_read_b64_tr_b16 v[102:103], v15 offset:10240
  s_add_u32 m0, s24, 99328
  s_nop 0
  buffer_load_dwordx4 v3, s[4:7], s20 offen lds
  v_mfma_f32_32x32x16_bf16 a[128:143], v[72:75], v[80:83], a[128:143]
  ds_read_b64_tr_b16 v[104:105], v16 offset:8192
  v_mfma_f32_32x32x16_bf16 a[144:159], v[72:75], v[84:87], a[144:159]
  ds_read_b64_tr_b16 v[106:107], v16 offset:10240
  v_mfma_f32_32x32x16_bf16 a[160:175], v[72:75], v[88:91], a[160:175]
  ds_read_b64_tr_b16 v[108:109], v17 offset:8192
  v_mfma_f32_32x32x16_bf16 a[176:191], v[72:75], v[92:95], a[176:191]
  ds_read_b64_tr_b16 v[110:111], v17 offset:10240
  s_add_u32 m0, s24, 100352
  s_nop 0
  buffer_load_dwordx4 v4, s[4:7], s20 offen lds
  v_mfma_f32_32x32x16_bf16 a[192:207], v[76:79], v[80:83], a[192:207]
  v_mfma_f32_32x32x16_bf16 a[208:223], v[76:79], v[84:87], a[208:223]
  v_mfma_f32_32x32x16_bf16 a[224:239], v[76:79], v[88:91], a[224:239]
  v_mfma_f32_32x32x16_bf16 a[240:255], v[76:79], v[92:95], a[240:255]
  s_add_u32 m0, s24, 101376
  s_nop 0
  buffer_load_dwordx4 v5, s[4:7], s20 offen lds
  s_waitcnt vmcnt(12) lgkmcnt(0)
  s_barrier
  v_mfma_f32_32x32x16_bf16 a[0:15], v[96:99], v[112:115], a[0:15]
  ds_read_b64_tr_b16 v[64:65], v14 offset:32768
  v_mfma_f32_32x32x16_bf16 a[16:31], v[96:99], v[116:119], a[16:31]
  ds_read_b64_tr_b16 v[66:67], v14 offset:34816
  v_mfma_f32_32x32x16_bf16 a[32:47], v[96:99], v[120:123], a[32:47]
  ds_read_b128 v[80:83], v10 offset:32768
  v_mfma_f32_32x32x16_bf16 a[48:63], v[96:99], v[124:127], a[48:63]
  ds_read_b128 v[84:87], v10 offset:34816
  s_add_u32 m0, s25, 98304
  s_nop 0
  buffer_load_dwordx4 v6, s[8:11], s21 offen lds
  v_mfma_f32_32x32x16_bf16 a[64:79], v[100:103], v[112:115], a[64:79]
  ds_read_b128 v[88:91], v10 offset:36864
  v_mfma_f32_32x32x16_bf16 a[80:95], v[100:103], v[116:119], a[80:95]
  ds_read_b128 v[92:95], v10 offset:38912
  v_mfma_f32_32x32x16_bf16 a[96:111], v[100:103], v[120:123], a[96:111]
  ds_read_b64_tr_b16 v[68:69], v15 offset:32768
  v_mfma_f32_32x32x16_bf16 a[112:127], v[100:103], v[124:127], a[112:127]
  ds_read_b64_tr_b16 v[70:71], v15 offset:34816
  s_add_u32 m0, s25, 99328
  s_nop 0
  buffer_load_dwordx4 v7, s[8:11], s21 offen lds
  v_mfma_f32_32x32x16_bf16 a[128:143], v[104:107], v[112:115], a[128:143]
  ds_read_b64_tr_b16 v[72:73], v16 offset:32768
  v_mfma_f32_32x32x16_bf16 a[144:159], v[104:107], v[116:119], a[144:159]
  ds_read_b64_tr_b16 v[74:75], v16 offset:34816
  v_mfma_f32_32x32x16_bf16 a[160:175], v[104:107], v[120:123], a[160:175]
  ds_read_b64_tr_b16 v[76:77], v17 offset:32768
  v_mfma_f32_32x32x16_bf16 a[176:191], v[104:107], v[124:127], a[176:191]
  ds_read_b64_tr_b16 v[78:79], v17 offset:34816
  s_add_u32 m0, s25, 100352
  s_nop 0
  buffer_load_dwordx4 v8, s[8:11], s21 offen lds
  v_mfma_f32_32x32x16_bf16 a[192:207], v[108:111], v[112:115], a[192:207]
  v_mfma_f32_32x32x16_bf16 a[208:223], v[108:111], v[116:119], a[208:223]
  v_mfma_f32_32x32x16_bf16 a[224:239], v[108:111], v[120:123], a[224:239]
  v_mfma_f32_32x32x16_bf16 a[240:255], v[108:111], v[124:127], a[240:255]
  s_add_u32 m0, s25, 101376
  s_nop 0
  buffer_load_dwordx4 v9, s[8:11], s21 offen lds
  s_add_u32 s20, s20, 64
  s_add_u32 s21, s21, s23
  s_waitcnt lgkmcnt(0)
  v_mfma_f32_32x32x16_bf16 a[0:15], v[64:67], v[80:83], a[0:15]
  ds_read_b64_tr_b16 v[96:97], v14 offset:40960
  v_mfma_f32_32x32x16_bf16 a[16:31], v[64:67], v[84:87], a[16:31]
  ds_read_b64_tr_b16 v[98:99], v14 offset:43008
  v_mfma_f32_32x32x16_bf16 a[32:47], v[64:67], v[88:91], a[32:47]
  ds_read_b128 v[112:115], v11 offset:32768
  v_mfma_f32_32x32x16_bf16 a[48:63], v[64:67], v[92:95], a[48:63]
  ds_read_b128 v[116:119], v11 offset:34816
  s_add_u32 m0, s24, 0
  s_nop 0
  buffer_load_dwordx4 v2, s[4:7], s20 offen lds
  v_mfma_f32_32x32x16_bf16 a[64:79], v[68:71], v[80:83], a[64:79]
  ds_read_b128 v[120:123], v11 offset:36864
  v_mfma_f32_32x32x16_bf16 a[80:95], v[68:71], v[84:87], a[80:95]
  ds_read_b128 v[124:127], v11 offset:38912
  v_mfma_f32_32x32x16_bf16 a[96:111], v[68:71], v[88:91], a[96:111]
  ds_read_b64_tr_b16 v[100:101], v15 offset:40960
  v_mfma_f32_32x32x16_bf16 a[112:127], v[68:71], v[92:95], a[112:127]
  ds_read_b64_tr_b16 v[102:103], v15 offset:43008
  s_add_u32 m0, s24, 1024
  s_nop 0
  buffer_load_dwordx4 v3, s[4:7], s20 offen lds
  v_mfma_f32_32x32x16_bf16 a[128:143], v[72:75], v[80:83], a[128:143]
  ds_read_b64_tr_b16 v[104:105], v16 offset:40960
  v_mfma_f32_32x32x16_bf16 a[144:159], v[72:75], v[84:87], a[144:159]
  ds_read_b64_tr_b16 v[106:107], v16 offset:43008
  v_mfma_f32_32x32x16_bf16 a[160:175], v[72:75], v[88:91], a[160:175]
  ds_read_b64_tr_b16 v[108:109], v17 offset:40960
  v_mfma_f32_32x32x16_bf16 a[176:191], v[72:75], v[92:95], a[176:191]
  ds_read_b64_tr_b16 v[110:111], v17 offset:43008
  s_add_u32 m0, s24, 2048
  s_nop 0
  buffer_load_dwordx4 v4, s[4:7], s20 offen lds
  v_mfma_f32_32x32x16_bf16 a[192:207], v[76:79], v[80:83], a[192:207]
  v_mfma_f32_32x32x16_bf16 a[208:223], v[76:79], v[84:87], a[208:223]
  v_mfma_f32_32x32x16_bf16 a[224:239], v[76:79], v[88:91], a[224:239]
  v_mfma_f32_32x32x16_bf16 a[240:255], v[76:79], v[92:95], a[240:255]
  s_add_u32 m0, s24, 3072
  s_nop 0
  buffer_load_dwordx4 v5, s[4:7], s20 offen lds
  s_waitcnt vmcnt(12) lgkmcnt(0)
  s_barrier
  v_mfma_f32_32x32x16_bf16 a[0:15], v[96:99], v[112:115], a[0:15]
  ds_read_b64_tr_b16 v[64:65], v18 offset:0
  v_mfma_f32_32x32x16_bf16 a[16:31], v[96:99], v[116:119], a[16:31]
  ds_read_b64_tr_b16 v[66:67], v18 offset:2048
  v_mfma_f32_32x32x16_bf16 a[32:47], v[96:99], v[120:123], a[32:47]
  ds_read_b128 v[80:83], v12 offset:0
  v_mfma_f32_32x32x16_bf16 a[48:63], v[96:99], v[124:127], a[48:63]
  ds_read_b128 v[84:87], v12 offset:2048
  s_add_u32 m0, s25, 0
  s_nop 0
  buffer_load_dwordx4 v6, s[8:11], s21 offen lds
  v_mfma_f32_32x32x16_bf16 a[64:79], v[100:103], v[112:115], a[64:79]
  ds_read_b128 v[88:91], v12 offset:4096
  v_mfma_f32_32x32x16_bf16 a[80:95], v[100:103], v[116:119], a[80:95]
  ds_read_b128 v[92:95], v12 offset:6144
  v_mfma_f32_32x32x16_bf16 a[96:111], v[100:103], v[120:123], a[96:111]
  ds_read_b64_tr_b16 v[68:69], v19 offset:0
  v_mfma_f32_32x32x16_bf16 a[112:127], v[100:103], v[124:127], a[112:127]
  ds_read_b64_tr_b16 v[70:71], v19 offset:2048
  s_add_u32 m0, s25, 1024
  s_nop 0
  buffer_load_dwordx4 v7, s[8:11], s21 offen lds
  v_mfma_f32_32x32x16_bf16 a[128:143], v[104:107], v[112:115], a[128:143]
  ds_read_b64_tr_b16 v[72:73], v20 offset:0
  v_mfma_f32_32x32x16_bf16 a[144:159], v[104:107], v[116:119], a[144:159]
  ds_read_b64_tr_b16 v[74:75], v20 offset:2048
  v_mfma_f32_32x32x16_bf16 a[160:175], v[104:107], v[120:123], a[160:175]
  ds_read_b64_tr_b16 v[76:77], v21 offset:0
  v_mfma_f32_32x32x16_bf16 a[176:191], v[104:107], v[124:127], a[176:191]
  ds_read_b64_tr_b16 v[78:79], v21 offset:2048
  s_add_u32 m0, s25, 2048
  s_nop 0
  buffer_load_dwordx4 v8, s[8:11], s21 offen lds
  v_mfma_f32_32x32x16_bf16 a[192:207], v[108:111], v[112:115], a[192:207]
  v_mfma_f32_32x32x16_bf16 a[208:223], v[108:111], v[116:119], a[208:223]
  v_mfma_f32_32x32x16_bf16 a[224:239], v[108:111], v[120:123], a[224:239]
  v_mfma_f32_32x32x16_bf16 a[240:255], v[108:111], v[124:127], a[240:255]
  s_add_u32 m0, s25, 3072
  s_nop 0
  buffer_load_dwordx4 v9, s[8:11], s21 offen lds
  s_add_u32 s20, s20, 64
  s_add_u32 s21, s21, s23
  s_waitcnt lgkmcnt(0)
  v_mfma_f32_32x32x16_bf16 a[0:15], v[64:67], v[80:83], a[0:15]
  ds_read_b64_tr_b16 v[96:97], v18 offset:8192
  v_mfma_f32_32x32x16_bf16 a[16:31], v[64:67], v[84:87], a[16:31]
  ds_read_b64_tr_b16 v[98:99], v18 offset:10240
  v_mfma_f32_32x32x16_bf16 a[32:47], v[64:67], v[88:91], a[32:47]
  ds_read_b128 v[112:115], v13 offset:0
  v_mfma_f32_32x32x16_bf16 a[48:63], v[64:67], v[92:95], a[48:63]
  ds_read_b128 v[116:119], v13 offset:2048
  s_add_u32 m0, s24, 32768
  s_nop 0
  buffer_load_dwordx4 v2, s[4:7], s20 offen lds
  v_mfma_f32_32x32x16_bf16 a[64:79], v[68:71], v[80:83], a[64:79]
  ds_read_b128 v[120:123], v13 offset:4096
  v_mfma_f32_32x32x16_bf16 a[80:95], v[68:71], v[84:87], a[80:95]
  ds_read_b128 v[124:127], v13 offset:6144
  v_mfma_f32_32x32x16_bf16 a[96:111], v[68:71], v[88:91], a[96:111]
  ds_read_b64_tr_b16 v[100:101], v19 offset:8192
  v_mfma_f32_32x32x16_bf16 a[112:127], v[68:71], v[92:95], a[112:127]
  ds_read_b64_tr_b16 v[102:103], v19 offset:10240
  s_add_u32 m0, s24, 33792
  s_nop 0
  buffer_load_dwordx4 v3, s[4:7], s20 offen lds
  v_mfma_f32_32x32x16_bf16 a[128:143], v[72:75], v[80:83], a[128:143]
  ds_read_b64_tr_b16 v[104:105], v20 offset:8192
  v_mfma_f32_32x32x16_bf16 a[144:159], v[72:75], v[84:87], a[144:159]
  ds_read_b64_tr_b16 v[106:107], v20 offset:10240
  v_mfma_f32_32x32x16_bf16 a[160:175], v[72:75], v[88:91], a[160:175]
  ds_read_b64_tr_b16 v[108:109], v21 offset:8192
  v_mfma_f32_32x32x16_bf16 a[176:191], v[72:75], v[92:95], a[176:191]
  ds_read_b64_tr_b16 v[110:111], v21 offset:10240
  s_add_u32 m0, s24, 34816
  s_nop 0
  buffer_load_dwordx4 v4, s[4:7], s20 offen lds
  v_mfma_f32_32x32x16_bf16 a[192:207], v[76:79], v[80:83], a[192:207]
  v_mfma_f32_32x32x16_bf16 a[208:223], v[76:79], v[84:87], a[208:223]
  v_mfma_f32_32x32x16_bf16 a[224:239], v[76:79], v[88:91], a[224:239]
  v_mfma_f32_32x32x16_bf16 a[240:255], v[76:79], v[92:95], a[240:255]
  s_add_u32 m0, s24, 35840
  s_nop 0
  buffer_load_dwordx4 v5, s[4:7], s20 offen lds
  s_waitcnt vmcnt(12) lgkmcnt(0)
  s_barrier
  v_mfma_f32_32x32x16_bf16 a[0:15], v[96:99], v[112:115], a[0:15]
  ds_read_b64_tr_b16 v[64:65], v18 offset:32768
  v_mfma_f32_32x32x16_bf16 a[16:31], v[96:99], v[116:119], a[16:31]
  ds_read_b64_tr_b16 v[66:67], v18 offset:34816
  v_mfma_f32_32x32x16_bf16 a[32:47], v[96:99], v[120:123], a[32:47]
  ds_read_b128 v[80:83], v12 offset:32768
  v_mfma_f32_32x32x16_bf16 a[48:63], v[96:99], v[124:127], a[48:63]
  ds_read_b128 v[84:87], v12 offset:34816
  s_add_u32 m0, s25, 32768
  s_nop 0
  buffer_load_dwordx4 v6, s[8:11], s21 offen lds
  v_mfma_f32_32x32x16_bf16 a[64:79], v[100:103], v[112:115], a[64:79]
  ds_read_b128 v[88:91], v12 offset:36864
  v_mfma_f32_32x32x16_bf16 a[80:95], v[100:103], v[116:119], a[80:95]
  ds_read_b128 v[92:95], v12 offset:38912
  v_mfma_f32_32x32x16_bf16 a[96:111], v[100:103], v[120:123], a[96:111]
  ds_read_b64_tr_b16 v[68:69], v19 offset:32768
  v_mfma_f32_32x32x16_bf16 a[112:127], v[100:103], v[124:127], a[112:127]
  ds_read_b64_tr_b16 v[70:71], v19 offset:34816
  s_add_u32 m0, s25, 33792
  s_nop 0
  buffer_load_dwordx4 v7, s[8:11], s21 offen lds
  v_mfma_f32_32x32x16_bf16 a[128:143], v[104:107], v[112:115], a[128:143]
  ds_read_b64_tr_b16 v[72:73], v20 offset:32768
  v_mfma_f32_32x32x16_bf16 a[144:159], v[104:107], v[116:119], a[144:159]
  ds_read_b64_tr_b16 v[74:75], v20 offset:34816
  v_mfma_f32_32x32x16_bf16 a[160:175], v[104:107], v[120:123], a[160:175]
  ds_read_b64_tr_b16 v[76:77], v21 offset:32768
  v_mfma_f32_32x32x16_bf16 a[176:191], v[104:107], v[124:127], a[176:191]
  ds_read_b64_tr_b16 v[78:79], v21 offset:34816
  s_add_u32 m0, s25, 34816
  s_nop 0
  buffer_load_dwordx4 v8, s[8:11], s21 offen lds
  v_mfma_f32_32x32x16_bf16 a[192:207], v[108:111], v[112:115], a[192:207]
  v_mfma_f32_32x32x16_bf16 a[208:223], v[108:111], v[116:119], a[208:223]
  v_mfma_f32_32x32x16_bf16 a[224:239], v[108:111], v[120:123], a[224:239]
  v_mfma_f32_32x32x16_bf16 a[240:255], v[108:111], v[124:127], a[240:255]
  s_add_u32 m0, s25, 35840
  s_nop 0
  buffer_load_dwordx4 v9, s[8:11], s21 offen lds
  s_add_u32 s20, s20, 64
  s_add_u32 s21, s21, s23
  s_waitcnt lgkmcnt(0)
  v_mfma_f32_32x32x16_bf16 a[0:15], v[64:67], v[80:83], a[0:15]
  ds_read_b64_tr_b16 v[96:97], v18 offset:40960
  v_mfma_f32_32x32x16_bf16 a[16:31], v[64:67], v[84:87], a[16:31]
  ds_read_b64_tr_b16 v[98:99], v18 offset:43008
  v_mfma_f32_32x32x16_bf16 a[32:47], v[64:67], v[88:91], a[32:47]
  ds_read_b128 v[112:115], v13 offset:32768
  v_mfma_f32_32x32x16_bf16 a[48:63], v[64:67], v[92:95], a[48:63]
  ds_read_b128 v[116:119], v13 offset:34816
  s_add_u32 m0, s24, 65536
  s_nop 0
  buffer_load_dwordx4 v2, s[4:7], s20 offen lds
  v_mfma_f32_32x32x16_bf16 a[64:79], v[68:71], v[80:83], a[64:79]
  ds_read_b128 v[120:123], v13 offset:36864
  v_mfma_f32_32x32x16_bf16 a[80:95], v[68:71], v[84:87], a[80:95]
  ds_read_b128 v[124:127], v13 offset:38912
  v_mfma_f32_32x32x16_bf16 a[96:111], v[68:71], v[88:91], a[96:111]
  ds_read_b64_tr_b16 v[100:101], v19 offset:40960
  v_mfma_f32_32x32x16_bf16 a[112:127], v[68:71], v[92:95], a[112:127]
  ds_read_b64_tr_b16 v[102:103], v19 offset:43008
  s_add_u32 m0, s24, 66560
  s_nop 0
  buffer_load_dwordx4 v3, s[4:7], s20 offen lds
  v_mfma_f32_32x32x16_bf16 a[128:143], v[72:75], v[80:83], a[128:143]
  ds_read_b64_tr_b16 v[104:105], v20 offset:40960
  v_mfma_f32_32x32x16_bf16 a[144:159], v[72:75], v[84:87], a[144:159]
  ds_read_b64_tr_b16 v[106:107], v20 offset:43008
  v_mfma_f32_32x32x16_bf16 a[160:175], v[72:75], v[88:91], a[160:175]
  ds_read_b64_tr_b16 v[108:109], v21 offset:40960
  v_mfma_f32_32x32x16_bf16 a[176:191], v[72:75], v[92:95], a[176:191]
  ds_read_b64_tr_b16 v[110:111], v21 offset:43008
  s_add_u32 m0, s24, 67584
  s_nop 0
  buffer_load_dwordx4 v4, s[4:7], s20 offen lds
  v_mfma_f32_32x32x16_bf16 a[192:207], v[76:79], v[80:83], a[192:207]
  v_mfma_f32_32x32x16_bf16 a[208:223], v[76:79], v[84:87], a[208:223]
  v_mfma_f32_32x32x16_bf16 a[224:239], v[76:79], v[88:91], a[224:239]
  v_mfma_f32_32x32x16_bf16 a[240:255], v[76:79], v[92:95], a[240:255]
  s_add_u32 m0, s24, 68608
  s_nop 0
  buffer_load_dwordx4 v5, s[4:7], s20 offen lds
  s_waitcnt vmcnt(12) lgkmcnt(0)
  s_barrier
  v_mfma_f32_32x32x16_bf16 a[0:15], v[96:99], v[112:115], a[0:15]
  ds_read_b64_tr_b16 v[64:65], v14 offset:0
  v_mfma_f32_32x32x16_bf16 a[16:31], v[96:99], v[116:119], a[16:31]
  ds_read_b64_tr_b16 v[66:67], v14 offset:2048
  v_mfma_f32_32x32x16_bf16 a[32:47], v[96:99], v[120:123], a[32:47]
  ds_read_b128 v[80:83], v10 offset:0
  v_mfma_f32_32x32x16_bf16 a[48:63], v[96:99], v[124:127], a[48:63]
  ds_read_b128 v[84:87], v10 offset:2048
  s_add_u32 m0, s25, 65536
  s_nop 0
  buffer_load_dwordx4 v6, s[8:11], s21 offen lds
  v_mfma_f32_32x32x16_bf16 a[64:79], v[100:103], v[112:115], a[64:79]
  ds_read_b128 v[88:91], v10 offset:4096
  v_mfma_f32_32x32x16_bf16 a[80:95], v[100:103], v[116:119], a[80:95]
  ds_read_b128 v[92:95], v10 offset:6144
  v_mfma_f32_32x32x16_bf16 a[96:111], v[100:103], v[120:123], a[96:111]
  ds_read_b64_tr_b16 v[68:69], v15 offset:0
  v_mfma_f32_32x32x16_bf16 a[112:127], v[100:103], v[124:127], a[112:127]
  ds_read_b64_tr_b16 v[70:71], v15 offset:2048
  s_add_u32 m0, s25, 66560
  s_nop 0
  buffer_load_dwordx4 v7, s[8:11], s21 offen lds
  v_mfma_f32_32x32x16_bf16 a[128:143], v[104:107], v[112:115], a[128:143]
  ds_read_b64_tr_b16 v[72:73], v16 offset:0
  v_mfma_f32_32x32x16_bf16 a[144:159], v[104:107], v[116:119], a[144:159]
  ds_read_b64_tr_b16 v[74:75], v16 offset:2048
  v_mfma_f32_32x32x16_bf16 a[160:175], v[104:107], v[120:123], a[160:175]
  ds_read_b64_tr_b16 v[76:77], v17 offset:0
  v_mfma_f32_32x32x16_bf16 a[176:191], v[104:107], v[124:127], a[176:191]
  ds_read_b64_tr_b16 v[78:79], v17 offset:2048
  s_add_u32 m0, s25, 67584
  s_nop 0
  buffer_load_dwordx4 v8, s[8:11], s21 offen lds
  v_mfma_f32_32x32x16_bf16 a[192:207], v[108:111], v[112:115], a[192:207]
  v_mfma_f32_32x32x16_bf16 a[208:223], v[108:111], v[116:119], a[208:223]
  v_mfma_f32_32x32x16_bf16 a[224:239], v[108:111], v[120:123], a[224:239]
  v_mfma_f32_32x32x16_bf16 a[240:255], v[108:111], v[124:127], a[240:255]
  s_add_u32 m0, s25, 68608
  s_nop 0
  buffer_load_dwordx4 v9, s[8:11], s21 offen lds
  s_add_u32 s20, s20, 64
  s_add_u32 s21, s21, s23
  s_waitcnt lgkmcnt(0)
  v_mfma_f32_32x32x16_bf16 a[0:15], v[64:67], v[80:83], a[0:15]
  ds_read_b64_tr_b16 v[96:97], v14 offset:8192
  v_mfma_f32_32x32x16_bf16 a[16:31], v[64:67], v[84:87], a[16:31]
  ds_read_b64_tr_b16 v[98:99], v14 offset:10240
  v_mfma_f32_32x32x16_bf16 a[32:47], v[64:67], v[88:91], a[32:47]
  ds_read_b128 v[112:115], v11 offset:0
  v_mfma_f32_32x32x16_bf16 a[48:63], v[64:67], v[92:95], a[48:63]
  ds_read_b128 v[116:119], v11 offset:2048
  s_add_u32 m0, s24, 98304
  s_nop 0
  buffer_load_dwordx4 v2, s[4:7], s20 offen lds
  v_mfma_f32_32x32x16_bf16 a[64:79], v[68:71], v[80:83], a[64:79]
  ds_read_b128 v[120:123], v11 offset:4096
  v_mfma_f32_32x32x16_bf16 a[80:95], v[68:71], v[84:87], a[80:95]
  ds_read_b128 v[124:127], v11 offset:6144
  v_mfma_f32_32x32x16_bf16 a[96:111], v[68:71], v[88:91], a[96:111]
  ds_read_b64_tr_b16 v[100:101], v15 offset:8192
  v_mfma_f32_32x32x16_bf16 a[112:127], v[68:71], v[92:95], a[112:127]
  ds_read_b64_tr_b16 v[102:103], v15 offset:10240
  s_add_u32 m0, s24, 99328
  s_nop 0
  buffer_load_dwordx4 v3, s[4:7], s20 offen lds
  v_mfma_f32_32x32x16_bf16 a[128:143], v[72:75], v[80:83], a[128:143]
  ds_read_b64_tr_b16 v[104:105], v16 offset:8192
  v_mfma_f32_32x32x16_bf16 a[144:159], v[72:75], v[84:87], a[144:159]
  ds_read_b64_tr_b16 v[106:107], v16 offset:10240
  v_mfma_f32_32x32x16_bf16 a[160:175], v[72:75], v[88:91], a[160:175]
  ds_read_b64_tr_b16 v[108:109], v17 offset:8192
  v_mfma_f32_32x32x16_bf16 a[176:191], v[72:75], v[92:95], a[176:191]
  ds_read_b64_tr_b16 v[110:111], v17 offset:10240
  s_add_u32 m0, s24, 100352
  s_nop 0
  buffer_load_dwordx4 v4, s[4:7], s20 offen lds
  v_mfma_f32_32x32x16_bf16 a[192:207], v[76:79], v[80:83], a[192:207]
  v_mfma_f32_32x32x16_bf16 a[208:223], v[76:79], v[84:87], a[208:223]
  v_mfma_f32_32x32x16_bf16 a[224:239], v[76:79], v[88:91], a[224:239]
  v_mfma_f32_32x32x16_bf16 a[240:255], v[76:79], v[92:95], a[240:255]
  s_add_u32 m0, s24, 101376
  s_nop 0
  buffer_load_dwordx4 v5, s[4:7], s20 offen lds
  s_waitcnt vmcnt(12) lgkmcnt(0)
  s_barrier
  v_mfma_f32_32x32x16_bf16 a[0:15], v[96:99], v[112:115], a[0:15]
  ds_read_b64_tr_b16 v[64:65], v14 offset:32768
  v_mfma_f32_32x32x16_bf16 a[16:31], v[96:99], v[116:119], a[16:31]
  ds_read_b64_tr_b16 v[66:67], v14 offset:34816
  v_mfma_f32_32x32x16_bf16 a[32:47], v[96:99], v[120:123], a[32:47]
  ds_read_b128 v[80:83], v10 offset:32768
  v_mfma_f32_32x32x16_bf16 a[48:63], v[96:99], v[124:127], a[48:63]
  ds_read_b128 v[84:87], v10 offset:34816
  s_add_u32 m0, s25, 98304
  s_nop 0
  buffer_load_dwordx4 v6, s[8:11], s21 offen lds
  v_mfma_f32_32x32x16_bf16 a[64:79], v[100:103], v[112:115], a[64:79]
  ds_read_b128 v[88:91], v10 offset:36864
  v_mfma_f32_32x32x16_bf16 a[80:95], v[100:103], v[116:119], a[80:95]
  ds_read_b128 v[92:95], v10 offset:38912
  v_mfma_f32_32x32x16_bf16 a[96:111], v[100:103], v[120:123], a[96:111]
  ds_read_b64_tr_b16 v[68:69], v15 offset:32768
  v_mfma_f32_32x32x16_bf16 a[112:127], v[100:103], v[124:127], a[112:127]
  ds_read_b64_tr_b16 v[70:71], v15 offset:34816
  s_add_u32 m0, s25, 99328
  s_nop 0
  buffer_load_dwordx4 v7, s[8:11], s21 offen lds
  v_mfma_f32_32x32x16_bf16 a[128:143], v[104:107], v[112:115], a[128:143]
  ds_read_b64_tr_b16 v[72:73], v16 offset:32768
  v_mfma_f32_32x32x16_bf16 a[144:159], v[104:107], v[116:119], a[144:159]
  ds_read_b64_tr_b16 v[74:75], v16 offset:34816
  v_mfma_f32_32x32x16_bf16 a[160:175], v[104:107], v[120:123], a[160:175]
  ds_read_b64_tr_b16 v[76:77], v17 offset:32768
  v_mfma_f32_32x32x16_bf16 a[176:191], v[104:107], v[124:127], a[176:191]
  ds_read_b64_tr_b16 v[78:79], v17 offset:34816
  s_add_u32 m0, s25, 100352
  s_nop 0
  buffer_load_dwordx4 v8, s[8:11], s21 offen lds
  v_mfma_f32_32x32x16_bf16 a[192:207], v[108:111], v[112:115], a[192:207]
  v_mfma_f32_32x32x16_bf16 a[208:223], v[108:111], v[116:119], a[208:223]
  v_mfma_f32_32x32x16_bf16 a[224:239], v[108:111], v[120:123], a[224:239]
  v_mfma_f32_32x32x16_bf16 a[240:255], v[108:111], v[124:127], a[240:255]
  s_add_u32 m0, s25, 101376
  s_nop 0
  buffer_load_dwordx4 v9, s[8:11], s21 offen lds
  s_add_u32 s20, s20, 64
  s_add_u32 s21, s21, s23
  s_waitcnt lgkmcnt(0)
  v_mfma_f32_32x32x16_bf16 a[0:15], v[64:67], v[80:83], a[0:15]
  ds_read_b64_tr_b16 v[96:97], v14 offset:40960
  v_mfma_f32_32x32x16_bf16 a[16:31], v[64:67], v[84:87], a[16:31]
  ds_read_b64_tr_b16 v[98:99], v14 offset:43008
  v_mfma_f32_32x32x16_bf16 a[32:47], v[64:67], v[88:91], a[32:47]
  ds_read_b128 v[112:115], v11 offset:32768
  v_mfma_f32_32x32x16_bf16 a[48:63], v[64:67], v[92:95], a[48:63]
  ds_read_b128 v[116:119], v11 offset:34816
  v_mfma_f32_32x32x16_bf16 a[64:79], v[68:71], v[80:83], a[64:79]
  ds_read_b128 v[120:123], v11 offset:36864
  v_mfma_f32_32x32x16_bf16 a[80:95], v[68:71], v[84:87], a[80:95]
  ds_read_b128 v[124:127], v11 offset:38912
  v_mfma_f32_32x32x16_bf16 a[96:111], v[68:71], v[88:91], a[96:111]
  ds_read_b64_tr_b16 v[100:101], v15 offset:40960
  v_mfma_f32_32x32x16_bf16 a[112:127], v[68:71], v[92:95], a[112:127]
  ds_read_b64_tr_b16 v[102:103], v15 offset:43008
  v_mfma_f32_32x32x16_bf16 a[128:143], v[72:75], v[80:83], a[128:143]
  ds_read_b64_tr_b16 v[104:105], v16 offset:40960
  v_mfma_f32_32x32x16_bf16 a[144:159], v[72:75], v[84:87], a[144:159]
  ds_read_b64_tr_b16 v[106:107], v16 offset:43008
  v_mfma_f32_32x32x16_bf16 a[160:175], v[72:75], v[88:91], a[160:175]
  ds_read_b64_tr_b16 v[108:109], v17 offset:40960
  v_mfma_f32_32x32x16_bf16 a[176:191], v[72:75], v[92:95], a[176:191]
  ds_read_b64_tr_b16 v[110:111], v17 offset:43008
  v_mfma_f32_32x32x16_bf16 a[192:207], v[76:79], v[80:83], a[192:207]
  v_mfma_f32_32x32x16_bf16 a[208:223], v[76:79], v[84:87], a[208:223]
  v_mfma_f32_32x32x16_bf16 a[224:239], v[76:79], v[88:91], a[224:239]
  v_mfma_f32_32x32x16_bf16 a[240:255], v[76:79], v[92:95], a[240:255]
  s_waitcnt vmcnt(8) lgkmcnt(0)
  s_barrier
  v_mfma_f32_32x32x16_bf16 a[0:15], v[96:99], v[112:115], a[0:15]
  ds_read_b64_tr_b16 v[64:65], v18 offset:0
  v_mfma_f32_32x32x16_bf16 a[16:31], v[96:99], v[116:119], a[16:31]
  ds_read_b64_tr_b16 v[66:67], v18 offset:2048
  v_mfma_f32_32x32x16_bf16 a[32:47], v[96:99], v[120:123], a[32:47]
  ds_read_b128 v[80:83], v12 offset:0
  v_mfma_f32_32x32x16_bf16 a[48:63], v[96:99], v[124:127], a[48:63]
  ds_read_b128 v[84:87], v12 offset:2048
  v_mfma_f32_32x32x16_bf16 a[64:79], v[100:103], v[112:115], a[64:79]
  ds_read_b128 v[88:91], v12 offset:4096
  v_mfma_f32_32x32x16_bf16 a[80:95], v[100:103], v[116:119], a[80:95]
  ds_read_b128 v[92:95], v12 offset:6144
  v_mfma_f32_32x32x16_bf16 a[96:111], v[100:103], v[120:123], a[96:111]
  ds_read_b64_tr_b16 v[68:69], v19 offset:0
  v_mfma_f32_32x32x16_bf16 a[112:127], v[100:103], v[124:127], a[112:127]
  ds_read_b64_tr_b16 v[70:71], v19 offset:2048
  v_mfma_f32_32x32x16_bf16 a[128:143], v[104:107], v[112:115], a[128:143]
  ds_read_b64_tr_b16 v[72:73], v20 offset:0
  v_mfma_f32_32x32x16_bf16 a[144:159], v[104:107], v[116:119], a[144:159]
  ds_read_b64_tr_b16 v[74:75], v20 offset:2048
  v_mfma_f32_32x32x16_bf16 a[160:175], v[104:107], v[120:123], a[160:175]
  ds_read_b64_tr_b16 v[76:77], v21 offset:0
  v_mfma_f32_32x32x16_bf16 a[176:191], v[104:107], v[124:127], a[176:191]
  ds_read_b64_tr_b16 v[78:79], v21 offset:2048
  v_mfma_f32_32x32x16_bf16 a[192:207], v[108:111], v[112:115], a[192:207]
  v_mfma_f32_32x32x16_bf16 a[208:223], v[108:111], v[116:119], a[208:223]
  v_mfma_f32_32x32x16_bf16 a[224:239], v[108:111], v[120:123], a[224:239]
  v_mfma_f32_32x32x16_bf16 a[240:255], v[108:111], v[124:127], a[240:255]
  s_waitcnt lgkmcnt(0)
  v_mfma_f32_32x32x16_bf16 a[0:15], v[64:67], v[80:83], a[0:15]
  ds_read_b64_tr_b16 v[96:97], v18 offset:8192
  v_mfma_f32_32x32x16_bf16 a[16:31], v[64:67], v[84:87], a[16:31]
  ds_read_b64_tr_b16 v[98:99], v18 offset:10240
  v_mfma_f32_32x32x16_bf16 a[32:47], v[64:67], v[88:91], a[32:47]
  ds_read_b128 v[112:115], v13 offset:0
  v_mfma_f32_32x32x16_bf16 a[48:63], v[64:67], v[92:95], a[48:63]
  ds_read_b128 v[116:119], v13 offset:2048
  v_mfma_f32_32x32x16_bf16 a[64:79], v[68:71], v[80:83], a[64:79]
  ds_read_b128 v[120:123], v13 offset:4096
  v_mfma_f32_32x32x16_bf16 a[80:95], v[68:71], v[84:87], a[80:95]
  ds_read_b128 v[124:127], v13 offset:6144
  v_mfma_f32_32x32x16_bf16 a[96:111], v[68:71], v[88:91], a[96:111]
  ds_read_b64_tr_b16 v[100:101], v19 offset:8192
  v_mfma_f32_32x32x16_bf16 a[112:127], v[68:71], v[92:95], a[112:127]
  ds_read_b64_tr_b16 v[102:103], v19 offset:10240
  v_mfma_f32_32x32x16_bf16 a[128:143], v[72:75], v[80:83], a[128:143]
  ds_read_b64_tr_b16 v[104:105], v20 offset:8192
  v_mfma_f32_32x32x16_bf16 a[144:159], v[72:75], v[84:87], a[144:159]
  ds_read_b64_tr_b16 v[106:107], v20 offset:10240
  v_mfma_f32_32x32x16_bf16 a[160:175], v[72:75], v[88:91], a[160:175]
  ds_read_b64_tr_b16 v[108:109], v21 offset:8192
  v_mfma_f32_32x32x16_bf16 a[176:191], v[72:75], v[92:95], a[176:191]
  ds_read_b64_tr_b16 v[110:111], v21 offset:10240
  v_mfma_f32_32x32x16_bf16 a[192:207], v[76:79], v[80:83], a[192:207]
  v_mfma_f32_32x32x16_bf16 a[208:223], v[76:79], v[84:87], a[208:223]
  v_mfma_f32_32x32x16_bf16 a[224:239], v[76:79], v[88:91], a[224:239]
  v_mfma_f32_32x32x16_bf16 a[240:255], v[76:79], v[92:95], a[240:255]
  s_waitcnt vmcnt(0) lgkmcnt(0)
  s_barrier
  v_mfma_f32_32x32x16_bf16 a[0:15], v[96:99], v[112:115], a[0:15]
  ds_read_b64_tr_b16 v[64:65], v18 offset:32768
  v_mfma_f32_32x32x16_bf16 a[16:31], v[96:99], v[116:119], a[16:31]
  ds_read_b64_tr_b16 v[66:67], v18 offset:34816
  v_mfma_f32_32x32x16_bf16 a[32:47], v[96:99], v[120:123], a[32:47]
  ds_read_b128 v[80:83], v12 offset:32768
  v_mfma_f32_32x32x16_bf16 a[48:63], v[96:99], v[124:127], a[48:63]
  ds_read_b128 v[84:87], v12 offset:34816
  v_mfma_f32_32x32x16_bf16 a[64:79], v[100:103], v[112:115], a[64:79]
  ds_read_b128 v[88:91], v12 offset:36864
  v_mfma_f32_32x32x16_bf16 a[80:95], v[100:103], v[116:119], a[80:95]
  ds_read_b128 v[92:95], v12 offset:38912
  v_mfma_f32_32x32x16_bf16 a[96:111], v[100:103], v[120:123], a[96:111]
  ds_read_b64_tr_b16 v[68:69], v19 offset:32768
  v_mfma_f32_32x32x16_bf16 a[112:127], v[100:103], v[124:127], a[112:127]
  ds_read_b64_tr_b16 v[70:71], v19 offset:34816
  v_mfma_f32_32x32x16_bf16 a[128:143], v[104:107], v[112:115], a[128:143]
  ds_read_b64_tr_b16 v[72:73], v20 offset:32768
  v_mfma_f32_32x32x16_bf16 a[144:159], v[104:107], v[116:119], a[144:159]
  ds_read_b64_tr_b16 v[74:75], v20 offset:34816
  v_mfma_f32_32x32x16_bf16 a[160:175], v[104:107], v[120:123], a[160:175]
  ds_read_b64_tr_b16 v[76:77], v21 offset:32768
  v_mfma_f32_32x32x16_bf16 a[176:191], v[104:107], v[124:127], a[176:191]
  ds_read_b64_tr_b16 v[78:79], v21 offset:34816
  v_mfma_f32_32x32x16_bf16 a[192:207], v[108:111], v[112:115], a[192:207]
  v_mfma_f32_32x32x16_bf16 a[208:223], v[108:111], v[116:119], a[208:223]
  v_mfma_f32_32x32x16_bf16 a[224:239], v[108:111], v[120:123], a[224:239]
  v_mfma_f32_32x32x16_bf16 a[240:255], v[108:111], v[124:127], a[240:255]
  s_waitcnt lgkmcnt(0)
  v_mfma_f32_32x32x16_bf16 a[0:15], v[64:67], v[80:83], a[0:15]
  ds_read_b64_tr_b16 v[96:97], v18 offset:40960
  v_mfma_f32_32x32x16_bf16 a[16:31], v[64:67], v[84:87], a[16:31]
  ds_read_b64_tr_b16 v[98:99], v18 offset:43008
  v_mfma_f32_32x32x16_bf16 a[32:47], v[64:67], v[88:91], a[32:47]
  ds_read_b128 v[112:115], v13 offset:32768
  v_mfma_f32_32x32x16_bf16 a[48:63], v[64:67], v[92:95], a[48:63]
  ds_read_b128 v[116:119], v13 offset:34816
  v_mfma_f32_32x32x16_bf16 a[64:79], v[68:71], v[80:83], a[64:79]
  ds_read_b128 v[120:123], v13 offset:36864
  v_mfma_f32_32x32x16_bf16 a[80:95], v[68:71], v[84:87], a[80:95]
  ds_read_b128 v[124:127], v13 offset:38912
  v_mfma_f32_32x32x16_bf16 a[96:111], v[68:71], v[88:91], a[96:111]
  ds_read_b64_tr_b16 v[100:101], v19 offset:40960
  v_mfma_f32_32x32x16_bf16 a[112:127], v[68:71], v[92:95], a[112:127]
  ds_read_b64_tr_b16 v[102:103], v19 offset:43008
  v_mfma_f32_32x32x16_bf16 a[128:143], v[72:75], v[80:83], a[128:143]
  ds_read_b64_tr_b16 v[104:105], v20 offset:40960
  v_mfma_f32_32x32x16_bf16 a[144:159], v[72:75], v[84:87], a[144:159]
  ds_read_b64_tr_b16 v[106:107], v20 offset:43008
  v_mfma_f32_32x32x16_bf16 a[160:175], v[72:75], v[88:91], a[160:175]
  ds_read_b64_tr_b16 v[108:109], v21 offset:40960
  v_mfma_f32_32x32x16_bf16 a[176:191], v[72:75], v[92:95], a[176:191]
  ds_read_b64_tr_b16 v[110:111], v21 offset:43008
  v_mfma_f32_32x32x16_bf16 a[192:207], v[76:79], v[80:83], a[192:207]
  v_mfma_f32_32x32x16_bf16 a[208:223], v[76:79], v[84:87], a[208:223]
  v_mfma_f32_32x32x16_bf16 a[224:239], v[76:79], v[88:91], a[224:239]
  v_mfma_f32_32x32x16_bf16 a[240:255], v[76:79], v[92:95], a[240:255]
  s_waitcnt lgkmcnt(0)
  v_mfma_f32_32x32x16_bf16 a[0:15], v[96:99], v[112:115], a[0:15]
  v_mfma_f32_32x32x16_bf16 a[16:31], v[96:99], v[116:119], a[16:31]
  v_mfma_f32_32x32x16_bf16 a[32:47], v[96:99], v[120:123], a[32:47]
  v_mfma_f32_32x32x16_bf16 a[48:63], v[96:99], v[124:127], a[48:63]
  v_mfma_f32_32x32x16_bf16 a[64:79], v[100:103], v[112:115], a[64:79]
  v_mfma_f32_32x32x16_bf16 a[80:95], v[100:103], v[116:119], a[80:95]
  v_mfma_f32_32x32x16_bf16 a[96:111], v[100:103], v[120:123], a[96:111]
  v_mfma_f32_32x32x16_bf16 a[112:127], v[100:103], v[124:127], a[112:127]
  v_mfma_f32_32x32x16_bf16 a[128:143], v[104:107], v[112:115], a[128:143]
  v_mfma_f32_32x32x16_bf16 a[144:159], v[104:107], v[116:119], a[144:159]
  v_mfma_f32_32x32x16_bf16 a[160:175], v[104:107], v[120:123], a[160:175]
  v_mfma_f32_32x32x16_bf16 a[176:191], v[104:107], v[124:127], a[176:191]
  v_mfma_f32_32x32x16_bf16 a[192:207], v[108:111], v[112:115], a[192:207]
  v_mfma_f32_32x32x16_bf16 a[208:223], v[108:111], v[116:119], a[208:223]
  v_mfma_f32_32x32x16_bf16 a[224:239], v[108:111], v[120:123], a[224:239]
  v_mfma_f32_32x32x16_bf16 a[240:255], v[108:111], v[124:127], a[240:255]
  s_cmp_eq_u32 s31, 4
  s_cbranch_scc1 BGG_ENAT
  s_cmp_eq_u32 s31, 0
  s_cbranch_scc0 BGG_EQKB
BGG_EFRAG:
  s_nop 7
  s_nop 7
  v_lshlrev_b32 v22, 4, v1
  v_accvgpr_read_b32 v40, a0
  v_accvgpr_read_b32 v41, a1
  v_accvgpr_read_b32 v42, a2
  v_accvgpr_read_b32 v43, a3
  v_accvgpr_read_b32 v44, a4
  v_accvgpr_read_b32 v45, a5
  v_accvgpr_read_b32 v46, a6
  v_accvgpr_read_b32 v47, a7
  v_accvgpr_read_b32 v48, a8
  v_accvgpr_read_b32 v49, a9
  v_accvgpr_read_b32 v50, a10
  v_accvgpr_read_b32 v51, a11
  v_accvgpr_read_b32 v52, a12
  v_accvgpr_read_b32 v53, a13
  v_accvgpr_read_b32 v54, a14
  v_accvgpr_read_b32 v55, a15
  v_cvt_pk_bf16_f32 v128, v40, v41
  v_cvt_pk_bf16_f32 v129, v42, v43
  v_cvt_pk_bf16_f32 v130, v44, v45
  v_cvt_pk_bf16_f32 v131, v46, v47
  v_cvt_pk_bf16_f32 v132, v48, v49
  v_cvt_pk_bf16_f32 v133, v50, v51
  v_cvt_pk_bf16_f32 v134, v52, v53
  v_cvt_pk_bf16_f32 v135, v54, v55
  s_add_u32 s34, s30, 0
  buffer_store_dwordx4 v[128:131], v22, s[12:15], s34 offen sc1
  buffer_store_dwordx4 v[132:135], v22, s[12:15], s34 offen offset:1024 sc1
  v_accvgpr_read_b32 v40, a16
  v_accvgpr_read_b32 v41, a17
  v_accvgpr_read_b32 v42, a18
  v_accvgpr_read_b32 v43, a19
  v_accvgpr_read_b32 v44, a20
  v_accvgpr_read_b32 v45, a21
  v_accvgpr_read_b32 v46, a22
  v_accvgpr_read_b32 v47, a23
  v_accvgpr_read_b32 v48, a24
  v_accvgpr_read_b32 v49, a25
  v_accvgpr_read_b32 v50, a26
  v_accvgpr_read_b32 v51, a27
  v_accvgpr_read_b32 v52, a28
  v_accvgpr_read_b32 v53, a29
  v_accvgpr_read_b32 v54, a30
  v_accvgpr_read_b32 v55, a31
  v_cvt_pk_bf16_f32 v136, v40, v41
  v_cvt_pk_bf16_f32 v137, v42, v43
  v_cvt_pk_bf16_f32 v138, v44, v45
  v_cvt_pk_bf16_f32 v139, v46, v47
  v_cvt_pk_bf16_f32 v140, v48, v49
  v_cvt_pk_bf16_f32 v141, v50, v51
  v_cvt_pk_bf16_f32 v142, v52, v53
  v_cvt_pk_bf16_f32 v143, v54, v55
  s_add_u32 s34, s30, 393216
  buffer_store_dwordx4 v[136:139], v22, s[12:15], s34 offen sc1
  buffer_store_dwordx4 v[140:143], v22, s[12:15], s34 offen offset:1024 sc1
  v_accvgpr_read_b32 v40, a32
  v_accvgpr_read_b32 v41, a33
  v_accvgpr_read_b32 v42, a34
  v_accvgpr_read_b32 v43, a35
  v_accvgpr_read_b32 v44, a36
  v_accvgpr_read_b32 v45, a37
  v_accvgpr_read_b32 v46, a38
  v_accvgpr_read_b32 v47, a39
  v_accvgpr_read_b32 v48, a40
  v_accvgpr_read_b32 v49, a41
  v_accvgpr_read_b32 v50, a42
  v_accvgpr_read_b32 v51, a43
  v_accvgpr_read_b32 v52, a44
  v_accvgpr_read_b32 v53, a45
  v_accvgpr_read_b32 v54, a46
  v_accvgpr_read_b32 v55, a47
  v_cvt_pk_bf16_f32 v144, v40, v41
  v_cvt_pk_bf16_f32 v145, v42, v43
  v_cvt_pk_bf16_f32 v146, v44, v45
  v_cvt_pk_bf16_f32 v147, v46, v47
  v_cvt_pk_bf16_f32 v148, v48, v49
  v_cvt_pk_bf16_f32 v149, v50, v51
  v_cvt_pk_bf16_f32 v150, v52, v53
  v_cvt_pk_bf16_f32 v151, v54, v55
  s_add_u32 s34, s30, 786432
  buffer_store_dwordx4 v[144:147], v22, s[12:15], s34 offen sc1
  buffer_store_dwordx4 v[148:151], v22, s[12:15], s34 offen offset:1024 sc1
  v_accvgpr_read_b32 v40, a48
  v_accvgpr_read_b32 v41, a49
  v_accvgpr_read_b32 v42, a50
  v_accvgpr_read_b32 v43, a51
  v_accvgpr_read_b32 v44, a52
  v_accvgpr_read_b32 v45, a53
  v_accvgpr_read_b32 v46, a54
  v_accvgpr_read_b32 v47, a55
  v_accvgpr_read_b32 v48, a56
  v_accvgpr_read_b32 v49, a57
  v_accvgpr_read_b32 v50, a58
  v_accvgpr_read_b32 v51, a59
  v_accvgpr_read_b32 v52, a60
  v_accvgpr_read_b32 v53, a61
  v_accvgpr_read_b32 v54, a62
  v_accvgpr_read_b32 v55, a63
  v_cvt_pk_bf16_f32 v152, v40, v41
  v_cvt_pk_bf16_f32 v153, v42, v43
  v_cvt_pk_bf16_f32 v154, v44, v45
  v_cvt_pk_bf16_f32 v155, v46, v47
  v_cvt_pk_bf16_f32 v156, v48, v49
  v_cvt_pk_bf16_f32 v157, v50, v51
  v_cvt_pk_bf16_f32 v158, v52, v53
  v_cvt_pk_bf16_f32 v159, v54, v55
  s_add_u32 s34, s30, 1179648
  buffer_store_dwordx4 v[152:155], v22, s[12:15], s34 offen sc1
  buffer_store_dwordx4 v[156:159], v22, s[12:15], s34 offen offset:1024 sc1
  v_accvgpr_read_b32 v40, a64
  v_accvgpr_read_b32 v41, a65
  v_accvgpr_read_b32 v42, a66
  v_accvgpr_read_b32 v43, a67
  v_accvgpr_read_b32 v44, a68
  v_accvgpr_read_b32 v45, a69
  v_accvgpr_read_b32 v46, a70
  v_accvgpr_read_b32 v47, a71
  v_accvgpr_read_b32 v48, a72
  v_accvgpr_read_b32 v49, a73
  v_accvgpr_read_b32 v50, a74
  v_accvgpr_read_b32 v51, a75
  v_accvgpr_read_b32 v52, a76
  v_accvgpr_read_b32 v53, a77
  v_accvgpr_read_b32 v54, a78
  v_accvgpr_read_b32 v55, a79
  v_cvt_pk_bf16_f32 v128, v40, v41
  v_cvt_pk_bf16_f32 v129, v42, v43
  v_cvt_pk_bf16_f32 v130, v44, v45
  v_cvt_pk_bf16_f32 v131, v46, v47
  v_cvt_pk_bf16_f32 v132, v48, v49
  v_cvt_pk_bf16_f32 v133, v50, v51
  v_cvt_pk_bf16_f32 v134, v52, v53
  v_cvt_pk_bf16_f32 v135, v54, v55
  s_add_u32 s34, s30, 2048
  buffer_store_dwordx4 v[128:131], v22, s[12:15], s34 offen sc1
  buffer_store_dwordx4 v[132:135], v22, s[12:15], s34 offen offset:1024 sc1
  v_accvgpr_read_b32 v40, a80
  v_accvgpr_read_b32 v41, a81
  v_accvgpr_read_b32 v42, a82
  v_accvgpr_read_b32 v43, a83
  v_accvgpr_read_b32 v44, a84
  v_accvgpr_read_b32 v45, a85
  v_accvgpr_read_b32 v46, a86
  v_accvgpr_read_b32 v47, a87
  v_accvgpr_read_b32 v48, a88
  v_accvgpr_read_b32 v49, a89
  v_accvgpr_read_b32 v50, a90
  v_accvgpr_read_b32 v51, a91
  v_accvgpr_read_b32 v52, a92
  v_accvgpr_read_b32 v53, a93
  v_accvgpr_read_b32 v54, a94
  v_accvgpr_read_b32 v55, a95
  v_cvt_pk_bf16_f32 v136, v40, v41
  v_cvt_pk_bf16_f32 v137, v42, v43
  v_cvt_pk_bf16_f32 v138, v44, v45
  v_cvt_pk_bf16_f32 v139, v46, v47
  v_cvt_pk_bf16_f32 v140, v48, v49
  v_cvt_pk_bf16_f32 v141, v50, v51
  v_cvt_pk_bf16_f32 v142, v52, v53
  v_cvt_pk_bf16_f32 v143, v54, v55
  s_add_u32 s34, s30, 395264
  buffer_store_dwordx4 v[136:139], v22, s[12:15], s34 offen sc1
  buffer_store_dwordx4 v[140:143], v22, s[12:15], s34 offen offset:1024 sc1
  v_accvgpr_read_b32 v40, a96
  v_accvgpr_read_b32 v41, a97
  v_accvgpr_read_b32 v42, a98
  v_accvgpr_read_b32 v43, a99
  v_accvgpr_read_b32 v44, a100
  v_accvgpr_read_b32 v45, a101
  v_accvgpr_read_b32 v46, a102
  v_accvgpr_read_b32 v47, a103
  v_accvgpr_read_b32 v48, a104
  v_accvgpr_read_b32 v49, a105
  v_accvgpr_read_b32 v50, a106
  v_accvgpr_read_b32 v51, a107
  v_accvgpr_read_b32 v52, a108
  v_accvgpr_read_b32 v53, a109
  v_accvgpr_read_b32 v54, a110
  v_accvgpr_read_b32 v55, a111
  v_cvt_pk_bf16_f32 v144, v40, v41
  v_cvt_pk_bf16_f32 v145, v42, v43
  v_cvt_pk_bf16_f32 v146, v44, v45
  v_cvt_pk_bf16_f32 v147, v46, v47
  v_cvt_pk_bf16_f32 v148, v48, v49
  v_cvt_pk_bf16_f32 v149, v50, v51
  v_cvt_pk_bf16_f32 v150, v52, v53
  v_cvt_pk_bf16_f32 v151, v54, v55
  s_add_u32 s34, s30, 788480
  buffer_store_dwordx4 v[144:147], v22, s[12:15], s34 offen sc1
  buffer_store_dwordx4 v[148:151], v22, s[12:15], s34 offen offset:1024 sc1
  v_accvgpr_read_b32 v40, a112
  v_accvgpr_read_b32 v41, a113
  v_accvgpr_read_b32 v42, a114
  v_accvgpr_read_b32 v43, a115
  v_accvgpr_read_b32 v44, a116
  v_accvgpr_read_b32 v45, a117
  v_accvgpr_read_b32 v46, a118
  v_accvgpr_read_b32 v47, a119
  v_accvgpr_read_b32 v48, a120
  v_accvgpr_read_b32 v49, a121
  v_accvgpr_read_b32 v50, a122
  v_accvgpr_read_b32 v51, a123
  v_accvgpr_read_b32 v52, a124
  v_accvgpr_read_b32 v53, a125
  v_accvgpr_read_b32 v54, a126
  v_accvgpr_read_b32 v55, a127
  v_cvt_pk_bf16_f32 v152, v40, v41
  v_cvt_pk_bf16_f32 v153, v42, v43
  v_cvt_pk_bf16_f32 v154, v44, v45
  v_cvt_pk_bf16_f32 v155, v46, v47
  v_cvt_pk_bf16_f32 v156, v48, v49
  v_cvt_pk_bf16_f32 v157, v50, v51
  v_cvt_pk_bf16_f32 v158, v52, v53
  v_cvt_pk_bf16_f32 v159, v54, v55
  s_add_u32 s34, s30, 1181696
  buffer_store_dwordx4 v[152:155], v22, s[12:15], s34 offen sc1
  buffer_store_dwordx4 v[156:159], v22, s[12:15], s34 offen offset:1024 sc1
  v_accvgpr_read_b32 v40, a128
  v_accvgpr_read_b32 v41, a129
  v_accvgpr_read_b32 v42, a130
  v_accvgpr_read_b32 v43, a131
  v_accvgpr_read_b32 v44, a132
  v_accvgpr_read_b32 v45, a133
  v_accvgpr_read_b32 v46, a134
  v_accvgpr_read_b32 v47, a135
  v_accvgpr_read_b32 v48, a136
  v_accvgpr_read_b32 v49, a137
  v_accvgpr_read_b32 v50, a138
  v_accvgpr_read_b32 v51, a139
  v_accvgpr_read_b32 v52, a140
  v_accvgpr_read_b32 v53, a141
  v_accvgpr_read_b32 v54, a142
  v_accvgpr_read_b32 v55, a143
  v_cvt_pk_bf16_f32 v128, v40, v41
  v_cvt_pk_bf16_f32 v129, v42, v43
  v_cvt_pk_bf16_f32 v130, v44, v45
  v_cvt_pk_bf16_f32 v131, v46, v47
  v_cvt_pk_bf16_f32 v132, v48, v49
  v_cvt_pk_bf16_f32 v133, v50, v51
  v_cvt_pk_bf16_f32 v134, v52, v53
  v_cvt_pk_bf16_f32 v135, v54, v55
  s_add_u32 s34, s30, 4096
  buffer_store_dwordx4 v[128:131], v22, s[12:15], s34 offen sc1
  buffer_store_dwordx4 v[132:135], v22, s[12:15], s34 offen offset:1024 sc1
  v_accvgpr_read_b32 v40, a144
  v_accvgpr_read_b32 v41, a145
  v_accvgpr_read_b32 v42, a146
  v_accvgpr_read_b32 v43, a147
  v_accvgpr_read_b32 v44, a148
  v_accvgpr_read_b32 v45, a149
  v_accvgpr_read_b32 v46, a150
  v_accvgpr_read_b32 v47, a151
  v_accvgpr_read_b32 v48, a152
  v_accvgpr_read_b32 v49, a153
  v_accvgpr_read_b32 v50, a154
  v_accvgpr_read_b32 v51, a155
  v_accvgpr_read_b32 v52, a156
  v_accvgpr_read_b32 v53, a157
  v_accvgpr_read_b32 v54, a158
  v_accvgpr_read_b32 v55, a159
  v_cvt_pk_bf16_f32 v136, v40, v41
  v_cvt_pk_bf16_f32 v137, v42, v43
  v_cvt_pk_bf16_f32 v138, v44, v45
  v_cvt_pk_bf16_f32 v139, v46, v47
  v_cvt_pk_bf16_f32 v140, v48, v49
  v_cvt_pk_bf16_f32 v141, v50, v51
  v_cvt_pk_bf16_f32 v142, v52, v53
  v_cvt_pk_bf16_f32 v143, v54, v55
  s_add_u32 s34, s30, 397312
  buffer_store_dwordx4 v[136:139], v22, s[12:15], s34 offen sc1
  buffer_store_dwordx4 v[140:143], v22, s[12:15], s34 offen offset:1024 sc1
  v_accvgpr_read_b32 v40, a160
  v_accvgpr_read_b32 v41, a161
  v_accvgpr_read_b32 v42, a162
  v_accvgpr_read_b32 v43, a163
  v_accvgpr_read_b32 v44, a164
  v_accvgpr_read_b32 v45, a165
  v_accvgpr_read_b32 v46, a166
  v_accvgpr_read_b32 v47, a167
  v_accvgpr_read_b32 v48, a168
  v_accvgpr_read_b32 v49, a169
  v_accvgpr_read_b32 v50, a170
  v_accvgpr_read_b32 v51, a171
  v_accvgpr_read_b32 v52, a172
  v_accvgpr_read_b32 v53, a173
  v_accvgpr_read_b32 v54, a174
  v_accvgpr_read_b32 v55, a175
  v_cvt_pk_bf16_f32 v144, v40, v41
  v_cvt_pk_bf16_f32 v145, v42, v43
  v_cvt_pk_bf16_f32 v146, v44, v45
  v_cvt_pk_bf16_f32 v147, v46, v47
  v_cvt_pk_bf16_f32 v148, v48, v49
  v_cvt_pk_bf16_f32 v149, v50, v51
  v_cvt_pk_bf16_f32 v150, v52, v53
  v_cvt_pk_bf16_f32 v151, v54, v55
  s_add_u32 s34, s30, 790528
  buffer_store_dwordx4 v[144:147], v22, s[12:15], s34 offen sc1
  buffer_store_dwordx4 v[148:151], v22, s[12:15], s34 offen offset:1024 sc1
  v_accvgpr_read_b32 v40, a176
  v_accvgpr_read_b32 v41, a177
  v_accvgpr_read_b32 v42, a178
  v_accvgpr_read_b32 v43, a179
  v_accvgpr_read_b32 v44, a180
  v_accvgpr_read_b32 v45, a181
  v_accvgpr_read_b32 v46, a182
  v_accvgpr_read_b32 v47, a183
  v_accvgpr_read_b32 v48, a184
  v_accvgpr_read_b32 v49, a185
  v_accvgpr_read_b32 v50, a186
  v_accvgpr_read_b32 v51, a187
  v_accvgpr_read_b32 v52, a188
  v_accvgpr_read_b32 v53, a189
  v_accvgpr_read_b32 v54, a190
  v_accvgpr_read_b32 v55, a191
  v_cvt_pk_bf16_f32 v152, v40, v41
  v_cvt_pk_bf16_f32 v153, v42, v43
  v_cvt_pk_bf16_f32 v154, v44, v45
  v_cvt_pk_bf16_f32 v155, v46, v47
  v_cvt_pk_bf16_f32 v156, v48, v49
  v_cvt_pk_bf16_f32 v157, v50, v51
  v_cvt_pk_bf16_f32 v158, v52, v53
  v_cvt_pk_bf16_f32 v159, v54, v55
  s_add_u32 s34, s30, 1183744
  buffer_store_dwordx4 v[152:155], v22, s[12:15], s34 offen sc1
  buffer_store_dwordx4 v[156:159], v22, s[12:15], s34 offen offset:1024 sc1
  v_accvgpr_read_b32 v40, a192
  v_accvgpr_read_b32 v41, a193
  v_accvgpr_read_b32 v42, a194
  v_accvgpr_read_b32 v43, a195
  v_accvgpr_read_b32 v44, a196
  v_accvgpr_read_b32 v45, a197
  v_accvgpr_read_b32 v46, a198
  v_accvgpr_read_b32 v47, a199
  v_accvgpr_read_b32 v48, a200
  v_accvgpr_read_b32 v49, a201
  v_accvgpr_read_b32 v50, a202
  v_accvgpr_read_b32 v51, a203
  v_accvgpr_read_b32 v52, a204
  v_accvgpr_read_b32 v53, a205
  v_accvgpr_read_b32 v54, a206
  v_accvgpr_read_b32 v55, a207
  v_cvt_pk_bf16_f32 v128, v40, v41
  v_cvt_pk_bf16_f32 v129, v42, v43
  v_cvt_pk_bf16_f32 v130, v44, v45
  v_cvt_pk_bf16_f32 v131, v46, v47
  v_cvt_pk_bf16_f32 v132, v48, v49
  v_cvt_pk_bf16_f32 v133, v50, v51
  v_cvt_pk_bf16_f32 v134, v52, v53
  v_cvt_pk_bf16_f32 v135, v54, v55
  s_add_u32 s34, s30, 6144
  buffer_store_dwordx4 v[128:131], v22, s[12:15], s34 offen sc1
  buffer_store_dwordx4 v[132:135], v22, s[12:15], s34 offen offset:1024 sc1
  v_accvgpr_read_b32 v40, a208
  v_accvgpr_read_b32 v41, a209
  v_accvgpr_read_b32 v42, a210
  v_accvgpr_read_b32 v43, a211
  v_accvgpr_read_b32 v44, a212
  v_accvgpr_read_b32 v45, a213
  v_accvgpr_read_b32 v46, a214
  v_accvgpr_read_b32 v47, a215
  v_accvgpr_read_b32 v48, a216
  v_accvgpr_read_b32 v49, a217
  v_accvgpr_read_b32 v50, a218
  v_accvgpr_read_b32 v51, a219
  v_accvgpr_read_b32 v52, a220
  v_accvgpr_read_b32 v53, a221
  v_accvgpr_read_b32 v54, a222
  v_accvgpr_read_b32 v55, a223
  v_cvt_pk_bf16_f32 v136, v40, v41
  v_cvt_pk_bf16_f32 v137, v42, v43
  v_cvt_pk_bf16_f32 v138, v44, v45
  v_cvt_pk_bf16_f32 v139, v46, v47
  v_cvt_pk_bf16_f32 v140, v48, v49
  v_cvt_pk_bf16_f32 v141, v50, v51
  v_cvt_pk_bf16_f32 v142, v52, v53
  v_cvt_pk_bf16_f32 v143, v54, v55
  s_add_u32 s34, s30, 399360
  buffer_store_dwordx4 v[136:139], v22, s[12:15], s34 offen sc1
  buffer_store_dwordx4 v[140:143], v22, s[12:15], s34 offen offset:1024 sc1
  v_accvgpr_read_b32 v40, a224
  v_accvgpr_read_b32 v41, a225
  v_accvgpr_read_b32 v42, a226
  v_accvgpr_read_b32 v43, a227
  v_accvgpr_read_b32 v44, a228
  v_accvgpr_read_b32 v45, a229
  v_accvgpr_read_b32 v46, a230
  v_accvgpr_read_b32 v47, a231
  v_accvgpr_read_b32 v48, a232
  v_accvgpr_read_b32 v49, a233
  v_accvgpr_read_b32 v50, a234
  v_accvgpr_read_b32 v51, a235
  v_accvgpr_read_b32 v52, a236
  v_accvgpr_read_b32 v53, a237
  v_accvgpr_read_b32 v54, a238
  v_accvgpr_read_b32 v55, a239
  v_cvt_pk_bf16_f32 v144, v40, v41
  v_cvt_pk_bf16_f32 v145, v42, v43
  v_cvt_pk_bf16_f32 v146, v44, v45
  v_cvt_pk_bf16_f32 v147, v46, v47
  v_cvt_pk_bf16_f32 v148, v48, v49
  v_cvt_pk_bf16_f32 v149, v50, v51
  v_cvt_pk_bf16_f32 v150, v52, v53
  v_cvt_pk_bf16_f32 v151, v54, v55
  s_add_u32 s34, s30, 792576
  buffer_store_dwordx4 v[144:147], v22, s[12:15], s34 offen sc1
  buffer_store_dwordx4 v[148:151], v22, s[12:15], s34 offen offset:1024 sc1
  v_accvgpr_read_b32 v40, a240
  v_accvgpr_read_b32 v41, a241
  v_accvgpr_read_b32 v42, a242
  v_accvgpr_read_b32 v43, a243
  v_accvgpr_read_b32 v44, a244
  v_accvgpr_read_b32 v45, a245
  v_accvgpr_read_b32 v46, a246
  v_accvgpr_read_b32 v47, a247
  v_accvgpr_read_b32 v48, a248
  v_accvgpr_read_b32 v49, a249
  v_accvgpr_read_b32 v50, a250
  v_accvgpr_read_b32 v51, a251
  v_accvgpr_read_b32 v52, a252
  v_accvgpr_read_b32 v53, a253
  v_accvgpr_read_b32 v54, a254
  v_accvgpr_read_b32 v55, a255
  v_cvt_pk_bf16_f32 v152, v40, v41
  v_cvt_pk_bf16_f32 v153, v42, v43
  v_cvt_pk_bf16_f32 v154, v44, v45
  v_cvt_pk_bf16_f32 v155, v46, v47
  v_cvt_pk_bf16_f32 v156, v48, v49
  v_cvt_pk_bf16_f32 v157, v50, v51
  v_cvt_pk_bf16_f32 v158, v52, v53
  v_cvt_pk_bf16_f32 v159, v54, v55
  s_add_u32 s34, s30, 1185792
  buffer_store_dwordx4 v[152:155], v22, s[12:15], s34 offen sc1
  buffer_store_dwordx4 v[156:159], v22, s[12:15], s34 offen offset:1024 sc1
  s_branch BGG_NEXT
BGG_EQKB:
  s_nop 7
  s_nop 7
  v_lshrrev_b32 v22, 5, v1
  v_and_b32 v23, 31, v1
  v_lshlrev_b32 v24, 4, v23
  v_lshlrev_b32 v25, 3, v23
  v_add_u32 v25, 1024, v25
  s_mov_b32 s36, 52429
  s_mov_b32 s37, 81920
  s_add_u32 s34, s35, 0
  v_add_u32 v26, s34, v22
  v_mul_u32_u24 v27, s36, v26
  v_lshrrev_b32 v27, 18, v27
  v_mul_u32_u24 v28, 5, v27
  v_sub_u32 v28, v26, v28
  v_lshrrev_b32 v29, 1, v28
  v_lshlrev_b32 v29, 9, v29
  v_and_b32 v30, 1, v28
  v_lshlrev_b32 v30, 3, v30
  v_add3_u32 v29, v29, v30, v24
  v_cmp_eq_u32 vcc, 4, v28
  v_cndmask_b32 v29, v29, v25, vcc
  v_mul_u32_u24 v27, s37, v27
  v_add_u32 v32, v29, v27
  s_add_u32 s34, s35, 2
  v_add_u32 v26, s34, v22
  v_mul_u32_u24 v27, s36, v26
  v_lshrrev_b32 v27, 18, v27
  v_mul_u32_u24 v28, 5, v27
  v_sub_u32 v28, v26, v28
  v_lshrrev_b32 v29, 1, v28
  v_lshlrev_b32 v29, 9, v29
  v_and_b32 v30, 1, v28
  v_lshlrev_b32 v30, 3, v30
  v_add3_u32 v29, v29, v30, v24
  v_cmp_eq_u32 vcc, 4, v28
  v_cndmask_b32 v29, v29, v25, vcc
  v_mul_u32_u24 v27, s37, v27
  v_add_u32 v33, v29, v27
  s_add_u32 s34, s35, 4
  v_add_u32 v26, s34, v22
  v_mul_u32_u24 v27, s36, v26
  v_lshrrev_b32 v27, 18, v27
  v_mul_u32_u24 v28, 5, v27
  v_sub_u32 v28, v26, v28
  v_lshrrev_b32 v29, 1, v28
  v_lshlrev_b32 v29, 9, v29
  v_and_b32 v30, 1, v28
  v_lshlrev_b32 v30, 3, v30
  v_add3_u32 v29, v29, v30, v24
  v_cmp_eq_u32 vcc, 4, v28
  v_cndmask_b32 v29, v29, v25, vcc
  v_mul_u32_u24 v27, s37, v27
  v_add_u32 v34, v29, v27
  s_add_u32 s34, s35, 6
  v_add_u32 v26, s34, v22
  v_mul_u32_u24 v27, s36, v26
  v_lshrrev_b32 v27, 18, v27
  v_mul_u32_u24 v28, 5, v27
  v_sub_u32 v28, v26, v28
  v_lshrrev_b32 v29, 1, v28
  v_lshlrev_b32 v29, 9, v29
  v_and_b32 v30, 1, v28
  v_lshlrev_b32 v30, 3, v30
  v_add3_u32 v29, v29, v30, v24
  v_cmp_eq_u32 vcc, 4, v28
  v_cndmask_b32 v29, v29, v25, vcc
  v_mul_u32_u24 v27, s37, v27
  v_add_u32 v35, v29, v27
  v_accvgpr_read_b32 v40, a0
  v_accvgpr_read_b32 v41, a1
  v_accvgpr_read_b32 v42, a2
  v_accvgpr_read_b32 v43, a3
  v_accvgpr_read_b32 v44, a4
  v_accvgpr_read_b32 v45, a5
  v_accvgpr_read_b32 v46, a6
  v_accvgpr_read_b32 v47, a7
  v_accvgpr_read_b32 v48, a8
  v_accvgpr_read_b32 v49, a9
  v_accvgpr_read_b32 v50, a10
  v_accvgpr_read_b32 v51, a11
  v_accvgpr_read_b32 v52, a12
  v_accvgpr_read_b32 v53, a13
  v_accvgpr_read_b32 v54, a14
  v_accvgpr_read_b32 v55, a15
  v_cvt_pk_bf16_f32 v128, v40, v41
  v_cvt_pk_bf16_f32 v129, v42, v43
  v_cvt_pk_bf16_f32 v130, v44, v45
  v_cvt_pk_bf16_f32 v131, v46, v47
  v_cvt_pk_bf16_f32 v132, v48, v49
  v_cvt_pk_bf16_f32 v133, v50, v51
  v_cvt_pk_bf16_f32 v134, v52, v53
  v_cvt_pk_bf16_f32 v135, v54, v55
  s_add_u32 s34, s30, 0
  buffer_store_dwordx2 v[128:129], v32, s[12:15], s34 offen sc1
  buffer_store_dwordx2 v[130:131], v33, s[12:15], s34 offen sc1
  buffer_store_dwordx2 v[132:133], v34, s[12:15], s34 offen sc1
  buffer_store_dwordx2 v[134:135], v35, s[12:15], s34 offen sc1
  v_accvgpr_read_b32 v40, a16
  v_accvgpr_read_b32 v41, a17
  v_accvgpr_read_b32 v42, a18
  v_accvgpr_read_b32 v43, a19
  v_accvgpr_read_b32 v44, a20
  v_accvgpr_read_b32 v45, a21
  v_accvgpr_read_b32 v46, a22
  v_accvgpr_read_b32 v47, a23
  v_accvgpr_read_b32 v48, a24
  v_accvgpr_read_b32 v49, a25
  v_accvgpr_read_b32 v50, a26
  v_accvgpr_read_b32 v51, a27
  v_accvgpr_read_b32 v52, a28
  v_accvgpr_read_b32 v53, a29
  v_accvgpr_read_b32 v54, a30
  v_accvgpr_read_b32 v55, a31
  v_cvt_pk_bf16_f32 v136, v40, v41
  v_cvt_pk_bf16_f32 v137, v42, v43
  v_cvt_pk_bf16_f32 v138, v44, v45
  v_cvt_pk_bf16_f32 v139, v46, v47
  v_cvt_pk_bf16_f32 v140, v48, v49
  v_cvt_pk_bf16_f32 v141, v50, v51
  v_cvt_pk_bf16_f32 v142, v52, v53
  v_cvt_pk_bf16_f32 v143, v54, v55
  s_add_u32 s34, s30, 1280
  buffer_store_dwordx2 v[136:137], v32, s[12:15], s34 offen sc1
  buffer_store_dwordx2 v[138:139], v33, s[12:15], s34 offen sc1
  buffer_store_dwordx2 v[140:141], v34, s[12:15], s34 offen sc1
  buffer_store_dwordx2 v[142:143], v35, s[12:15], s34 offen sc1
  v_accvgpr_read_b32 v40, a32
  v_accvgpr_read_b32 v41, a33
  v_accvgpr_read_b32 v42, a34
  v_accvgpr_read_b32 v43, a35
  v_accvgpr_read_b32 v44, a36
  v_accvgpr_read_b32 v45, a37
  v_accvgpr_read_b32 v46, a38
  v_accvgpr_read_b32 v47, a39
  v_accvgpr_read_b32 v48, a40
  v_accvgpr_read_b32 v49, a41
  v_accvgpr_read_b32 v50, a42
  v_accvgpr_read_b32 v51, a43
  v_accvgpr_read_b32 v52, a44
  v_accvgpr_read_b32 v53, a45
  v_accvgpr_read_b32 v54, a46
  v_accvgpr_read_b32 v55, a47
  v_cvt_pk_bf16_f32 v144, v40, v41
  v_cvt_pk_bf16_f32 v145, v42, v43
  v_cvt_pk_bf16_f32 v146, v44, v45
  v_cvt_pk_bf16_f32 v147, v46, v47
  v_cvt_pk_bf16_f32 v148, v48, v49
  v_cvt_pk_bf16_f32 v149, v50, v51
  v_cvt_pk_bf16_f32 v150, v52, v53
  v_cvt_pk_bf16_f32 v151, v54, v55
  s_add_u32 s34, s30, 2560
  buffer_store_dwordx2 v[144:145], v32, s[12:15], s34 offen sc1
  buffer_store_dwordx2 v[146:147], v33, s[12:15], s34 offen sc1
  buffer_store_dwordx2 v[148:149], v34, s[12:15], s34 offen sc1
  buffer_store_dwordx2 v[150:151], v35, s[12:15], s34 offen sc1
  v_accvgpr_read_b32 v40, a48
  v_accvgpr_read_b32 v41, a49
  v_accvgpr_read_b32 v42, a50
  v_accvgpr_read_b32 v43, a51
  v_accvgpr_read_b32 v44, a52
  v_accvgpr_read_b32 v45, a53
  v_accvgpr_read_b32 v46, a54
  v_accvgpr_read_b32 v47, a55
  v_accvgpr_read_b32 v48, a56
  v_accvgpr_read_b32 v49, a57
  v_accvgpr_read_b32 v50, a58
  v_accvgpr_read_b32 v51, a59
  v_accvgpr_read_b32 v52, a60
  v_accvgpr_read_b32 v53, a61
  v_accvgpr_read_b32 v54, a62
  v_accvgpr_read_b32 v55, a63
  v_cvt_pk_bf16_f32 v152, v40, v41
  v_cvt_pk_bf16_f32 v153, v42, v43
  v_cvt_pk_bf16_f32 v154, v44, v45
  v_cvt_pk_bf16_f32 v155, v46, v47
  v_cvt_pk_bf16_f32 v156, v48, v49
  v_cvt_pk_bf16_f32 v157, v50, v51
  v_cvt_pk_bf16_f32 v158, v52, v53
  v_cvt_pk_bf16_f32 v159, v54, v55
  s_add_u32 s34, s30, 3840
  buffer_store_dwordx2 v[152:153], v32, s[12:15], s34 offen sc1
  buffer_store_dwordx2 v[154:155], v33, s[12:15], s34 offen sc1
  buffer_store_dwordx2 v[156:157], v34, s[12:15], s34 offen sc1
  buffer_store_dwordx2 v[158:159], v35, s[12:15], s34 offen sc1
  s_add_u32 s34, s35, 8
  v_add_u32 v26, s34, v22
  v_mul_u32_u24 v27, s36, v26
  v_lshrrev_b32 v27, 18, v27
  v_mul_u32_u24 v28, 5, v27
  v_sub_u32 v28, v26, v28
  v_lshrrev_b32 v29, 1, v28
  v_lshlrev_b32 v29, 9, v29
  v_and_b32 v30, 1, v28
  v_lshlrev_b32 v30, 3, v30
  v_add3_u32 v29, v29, v30, v24
  v_cmp_eq_u32 vcc, 4, v28
  v_cndmask_b32 v29, v29, v25, vcc
  v_mul_u32_u24 v27, s37, v27
  v_add_u32 v32, v29, v27
  s_add_u32 s34, s35, 10
  v_add_u32 v26, s34, v22
  v_mul_u32_u24 v27, s36, v26
  v_lshrrev_b32 v27, 18, v27
  v_mul_u32_u24 v28, 5, v27
  v_sub_u32 v28, v26, v28
  v_lshrrev_b32 v29, 1, v28
  v_lshlrev_b32 v29, 9, v29
  v_and_b32 v30, 1, v28
  v_lshlrev_b32 v30, 3, v30
  v_add3_u32 v29, v29, v30, v24
  v_cmp_eq_u32 vcc, 4, v28
  v_cndmask_b32 v29, v29, v25, vcc
  v_mul_u32_u24 v27, s37, v27
  v_add_u32 v33, v29, v27
  s_add_u32 s34, s35, 12
  v_add_u32 v26, s34, v22
  v_mul_u32_u24 v27, s36, v26
  v_lshrrev_b32 v27, 18, v27
  v_mul_u32_u24 v28, 5, v27
  v_sub_u32 v28, v26, v28
  v_lshrrev_b32 v29, 1, v28
  v_lshlrev_b32 v29, 9, v29
  v_and_b32 v30, 1, v28
  v_lshlrev_b32 v30, 3, v30
  v_add3_u32 v29, v29, v30, v24
  v_cmp_eq_u32 vcc, 4, v28
  v_cndmask_b32 v29, v29, v25, vcc
  v_mul_u32_u24 v27, s37, v27
  v_add_u32 v34, v29, v27
  s_add_u32 s34, s35, 14
  v_add_u32 v26, s34, v22
  v_mul_u32_u24 v27, s36, v26
  v_lshrrev_b32 v27, 18, v27
  v_mul_u32_u24 v28, 5, v27
  v_sub_u32 v28, v26, v28
  v_lshrrev_b32 v29, 1, v28
  v_lshlrev_b32 v29, 9, v29
  v_and_b32 v30, 1, v28
  v_lshlrev_b32 v30, 3, v30
  v_add3_u32 v29, v29, v30, v24
  v_cmp_eq_u32 vcc, 4, v28
  v_cndmask_b32 v29, v29, v25, vcc
  v_mul_u32_u24 v27, s37, v27
  v_add_u32 v35, v29, v27
  v_accvgpr_read_b32 v40, a64
  v_accvgpr_read_b32 v41, a65
  v_accvgpr_read_b32 v42, a66
  v_accvgpr_read_b32 v43, a67
  v_accvgpr_read_b32 v44, a68
  v_accvgpr_read_b32 v45, a69
  v_accvgpr_read_b32 v46, a70
  v_accvgpr_read_b32 v47, a71
  v_accvgpr_read_b32 v48, a72
  v_accvgpr_read_b32 v49, a73
  v_accvgpr_read_b32 v50, a74
  v_accvgpr_read_b32 v51, a75
  v_accvgpr_read_b32 v52, a76
  v_accvgpr_read_b32 v53, a77
  v_accvgpr_read_b32 v54, a78
  v_accvgpr_read_b32 v55, a79
  v_cvt_pk_bf16_f32 v128, v40, v41
  v_cvt_pk_bf16_f32 v129, v42, v43
  v_cvt_pk_bf16_f32 v130, v44, v45
  v_cvt_pk_bf16_f32 v131, v46, v47
  v_cvt_pk_bf16_f32 v132, v48, v49
  v_cvt_pk_bf16_f32 v133, v50, v51
  v_cvt_pk_bf16_f32 v134, v52, v53
  v_cvt_pk_bf16_f32 v135, v54, v55
  s_add_u32 s34, s30, 0
  buffer_store_dwordx2 v[128:129], v32, s[12:15], s34 offen sc1
  buffer_store_dwordx2 v[130:131], v33, s[12:15], s34 offen sc1
  buffer_store_dwordx2 v[132:133], v34, s[12:15], s34 offen sc1
  buffer_store_dwordx2 v[134:135], v35, s[12:15], s34 offen sc1
  v_accvgpr_read_b32 v40, a80
  v_accvgpr_read_b32 v41, a81
  v_accvgpr_read_b32 v42, a82
  v_accvgpr_read_b32 v43, a83
  v_accvgpr_read_b32 v44, a84
  v_accvgpr_read_b32 v45, a85
  v_accvgpr_read_b32 v46, a86
  v_accvgpr_read_b32 v47, a87
  v_accvgpr_read_b32 v48, a88
  v_accvgpr_read_b32 v49, a89
  v_accvgpr_read_b32 v50, a90
  v_accvgpr_read_b32 v51, a91
  v_accvgpr_read_b32 v52, a92
  v_accvgpr_read_b32 v53, a93
  v_accvgpr_read_b32 v54, a94
  v_accvgpr_read_b32 v55, a95
  v_cvt_pk_bf16_f32 v136, v40, v41
  v_cvt_pk_bf16_f32 v137, v42, v43
  v_cvt_pk_bf16_f32 v138, v44, v45
  v_cvt_pk_bf16_f32 v139, v46, v47
  v_cvt_pk_bf16_f32 v140, v48, v49
  v_cvt_pk_bf16_f32 v141, v50, v51
  v_cvt_pk_bf16_f32 v142, v52, v53
  v_cvt_pk_bf16_f32 v143, v54, v55
  s_add_u32 s34, s30, 1280
  buffer_store_dwordx2 v[136:137], v32, s[12:15], s34 offen sc1
  buffer_store_dwordx2 v[138:139], v33, s[12:15], s34 offen sc1
  buffer_store_dwordx2 v[140:141], v34, s[12:15], s34 offen sc1
  buffer_store_dwordx2 v[142:143], v35, s[12:15], s34 offen sc1
  v_accvgpr_read_b32 v40, a96
  v_accvgpr_read_b32 v41, a97
  v_accvgpr_read_b32 v42, a98
  v_accvgpr_read_b32 v43, a99
  v_accvgpr_read_b32 v44, a100
  v_accvgpr_read_b32 v45, a101
  v_accvgpr_read_b32 v46, a102
  v_accvgpr_read_b32 v47, a103
  v_accvgpr_read_b32 v48, a104
  v_accvgpr_read_b32 v49, a105
  v_accvgpr_read_b32 v50, a106
  v_accvgpr_read_b32 v51, a107
  v_accvgpr_read_b32 v52, a108
  v_accvgpr_read_b32 v53, a109
  v_accvgpr_read_b32 v54, a110
  v_accvgpr_read_b32 v55, a111
  v_cvt_pk_bf16_f32 v144, v40, v41
  v_cvt_pk_bf16_f32 v145, v42, v43
  v_cvt_pk_bf16_f32 v146, v44, v45
  v_cvt_pk_bf16_f32 v147, v46, v47
  v_cvt_pk_bf16_f32 v148, v48, v49
  v_cvt_pk_bf16_f32 v149, v50, v51
  v_cvt_pk_bf16_f32 v150, v52, v53
  v_cvt_pk_bf16_f32 v151, v54, v55
  s_add_u32 s34, s30, 2560
  buffer_store_dwordx2 v[144:145], v32, s[12:15], s34 offen sc1
  buffer_store_dwordx2 v[146:147], v33, s[12:15], s34 offen sc1
  buffer_store_dwordx2 v[148:149], v34, s[12:15], s34 offen sc1
  buffer_store_dwordx2 v[150:151], v35, s[12:15], s34 offen sc1
  v_accvgpr_read_b32 v40, a112
  v_accvgpr_read_b32 v41, a113
  v_accvgpr_read_b32 v42, a114
  v_accvgpr_read_b32 v43, a115
  v_accvgpr_read_b32 v44, a116
  v_accvgpr_read_b32 v45, a117
  v_accvgpr_read_b32 v46, a118
  v_accvgpr_read_b32 v47, a119
  v_accvgpr_read_b32 v48, a120
  v_accvgpr_read_b32 v49, a121
  v_accvgpr_read_b32 v50, a122
  v_accvgpr_read_b32 v51, a123
  v_accvgpr_read_b32 v52, a124
  v_accvgpr_read_b32 v53, a125
  v_accvgpr_read_b32 v54, a126
  v_accvgpr_read_b32 v55, a127
  v_cvt_pk_bf16_f32 v152, v40, v41
  v_cvt_pk_bf16_f32 v153, v42, v43
  v_cvt_pk_bf16_f32 v154, v44, v45
  v_cvt_pk_bf16_f32 v155, v46, v47
  v_cvt_pk_bf16_f32 v156, v48, v49
  v_cvt_pk_bf16_f32 v157, v50, v51
  v_cvt_pk_bf16_f32 v158, v52, v53
  v_cvt_pk_bf16_f32 v159, v54, v55
  s_add_u32 s34, s30, 3840
  buffer_store_dwordx2 v[152:153], v32, s[12:15], s34 offen sc1
  buffer_store_dwordx2 v[154:155], v33, s[12:15], s34 offen sc1
  buffer_store_dwordx2 v[156:157], v34, s[12:15], s34 offen sc1
  buffer_store_dwordx2 v[158:159], v35, s[12:15], s34 offen sc1
  s_add_u32 s34, s35, 16
  v_add_u32 v26, s34, v22
  v_mul_u32_u24 v27, s36, v26
  v_lshrrev_b32 v27, 18, v27
  v_mul_u32_u24 v28, 5, v27
  v_sub_u32 v28, v26, v28
  v_lshrrev_b32 v29, 1, v28
  v_lshlrev_b32 v29, 9, v29
  v_and_b32 v30, 1, v28
  v_lshlrev_b32 v30, 3, v30
  v_add3_u32 v29, v29, v30, v24
  v_cmp_eq_u32 vcc, 4, v28
  v_cndmask_b32 v29, v29, v25, vcc
  v_mul_u32_u24 v27, s37, v27
  v_add_u32 v32, v29, v27
  s_add_u32 s34, s35, 18
  v_add_u32 v26, s34, v22
  v_mul_u32_u24 v27, s36, v26
  v_lshrrev_b32 v27, 18, v27
  v_mul_u32_u24 v28, 5, v27
  v_sub_u32 v28, v26, v28
  v_lshrrev_b32 v29, 1, v28
  v_lshlrev_b32 v29, 9, v29
  v_and_b32 v30, 1, v28
  v_lshlrev_b32 v30, 3, v30
  v_add3_u32 v29, v29, v30, v24
  v_cmp_eq_u32 vcc, 4, v28
  v_cndmask_b32 v29, v29, v25, vcc
  v_mul_u32_u24 v27, s37, v27
  v_add_u32 v33, v29, v27
  s_add_u32 s34, s35, 20
  v_add_u32 v26, s34, v22
  v_mul_u32_u24 v27, s36, v26
  v_lshrrev_b32 v27, 18, v27
  v_mul_u32_u24 v28, 5, v27
  v_sub_u32 v28, v26, v28
  v_lshrrev_b32 v29, 1, v28
  v_lshlrev_b32 v29, 9, v29
  v_and_b32 v30, 1, v28
  v_lshlrev_b32 v30, 3, v30
  v_add3_u32 v29, v29, v30, v24
  v_cmp_eq_u32 vcc, 4, v28
  v_cndmask_b32 v29, v29, v25, vcc
  v_mul_u32_u24 v27, s37, v27
  v_add_u32 v34, v29, v27
  s_add_u32 s34, s35, 22
  v_add_u32 v26, s34, v22
  v_mul_u32_u24 v27, s36, v26
  v_lshrrev_b32 v27, 18, v27
  v_mul_u32_u24 v28, 5, v27
  v_sub_u32 v28, v26, v28
  v_lshrrev_b32 v29, 1, v28
  v_lshlrev_b32 v29, 9, v29
  v_and_b32 v30, 1, v28
  v_lshlrev_b32 v30, 3, v30
  v_add3_u32 v29, v29, v30, v24
  v_cmp_eq_u32 vcc, 4, v28
  v_cndmask_b32 v29, v29, v25, vcc
  v_mul_u32_u24 v27, s37, v27
  v_add_u32 v35, v29, v27
  v_accvgpr_read_b32 v40, a128
  v_accvgpr_read_b32 v41, a129
  v_accvgpr_read_b32 v42, a130
  v_accvgpr_read_b32 v43, a131
  v_accvgpr_read_b32 v44, a132
  v_accvgpr_read_b32 v45, a133
  v_accvgpr_read_b32 v46, a134
  v_accvgpr_read_b32 v47, a135
  v_accvgpr_read_b32 v48, a136
  v_accvgpr_read_b32 v49, a137
  v_accvgpr_read_b32 v50, a138
  v_accvgpr_read_b32 v51, a139
  v_accvgpr_read_b32 v52, a140
  v_accvgpr_read_b32 v53, a141
  v_accvgpr_read_b32 v54, a142
  v_accvgpr_read_b32 v55, a143
  v_cvt_pk_bf16_f32 v128, v40, v41
  v_cvt_pk_bf16_f32 v129, v42, v43
  v_cvt_pk_bf16_f32 v130, v44, v45
  v_cvt_pk_bf16_f32 v131, v46, v47
  v_cvt_pk_bf16_f32 v132, v48, v49
  v_cvt_pk_bf16_f32 v133, v50, v51
  v_cvt_pk_bf16_f32 v134, v52, v53
  v_cvt_pk_bf16_f32 v135, v54, v55
  s_add_u32 s34, s30, 0
  buffer_store_dwordx2 v[128:129], v32, s[12:15], s34 offen sc1
  buffer_store_dwordx2 v[130:131], v33, s[12:15], s34 offen sc1
  buffer_store_dwordx2 v[132:133], v34, s[12:15], s34 offen sc1
  buffer_store_dwordx2 v[134:135], v35, s[12:15], s34 offen sc1
  v_accvgpr_read_b32 v40, a144
  v_accvgpr_read_b32 v41, a145
  v_accvgpr_read_b32 v42, a146
  v_accvgpr_read_b32 v43, a147
  v_accvgpr_read_b32 v44, a148
  v_accvgpr_read_b32 v45, a149
  v_accvgpr_read_b32 v46, a150
  v_accvgpr_read_b32 v47, a151
  v_accvgpr_read_b32 v48, a152
  v_accvgpr_read_b32 v49, a153
  v_accvgpr_read_b32 v50, a154
  v_accvgpr_read_b32 v51, a155
  v_accvgpr_read_b32 v52, a156
  v_accvgpr_read_b32 v53, a157
  v_accvgpr_read_b32 v54, a158
  v_accvgpr_read_b32 v55, a159
  v_cvt_pk_bf16_f32 v136, v40, v41
  v_cvt_pk_bf16_f32 v137, v42, v43
  v_cvt_pk_bf16_f32 v138, v44, v45
  v_cvt_pk_bf16_f32 v139, v46, v47
  v_cvt_pk_bf16_f32 v140, v48, v49
  v_cvt_pk_bf16_f32 v141, v50, v51
  v_cvt_pk_bf16_f32 v142, v52, v53
  v_cvt_pk_bf16_f32 v143, v54, v55
  s_add_u32 s34, s30, 1280
  buffer_store_dwordx2 v[136:137], v32, s[12:15], s34 offen sc1
  buffer_store_dwordx2 v[138:139], v33, s[12:15], s34 offen sc1
  buffer_store_dwordx2 v[140:141], v34, s[12:15], s34 offen sc1
  buffer_store_dwordx2 v[142:143], v35, s[12:15], s34 offen sc1
  v_accvgpr_read_b32 v40, a160
  v_accvgpr_read_b32 v41, a161
  v_accvgpr_read_b32 v42, a162
  v_accvgpr_read_b32 v43, a163
  v_accvgpr_read_b32 v44, a164
  v_accvgpr_read_b32 v45, a165
  v_accvgpr_read_b32 v46, a166
  v_accvgpr_read_b32 v47, a167
  v_accvgpr_read_b32 v48, a168
  v_accvgpr_read_b32 v49, a169
  v_accvgpr_read_b32 v50, a170
  v_accvgpr_read_b32 v51, a171
  v_accvgpr_read_b32 v52, a172
  v_accvgpr_read_b32 v53, a173
  v_accvgpr_read_b32 v54, a174
  v_accvgpr_read_b32 v55, a175
  v_cvt_pk_bf16_f32 v144, v40, v41
  v_cvt_pk_bf16_f32 v145, v42, v43
  v_cvt_pk_bf16_f32 v146, v44, v45
  v_cvt_pk_bf16_f32 v147, v46, v47
  v_cvt_pk_bf16_f32 v148, v48, v49
  v_cvt_pk_bf16_f32 v149, v50, v51
  v_cvt_pk_bf16_f32 v150, v52, v53
  v_cvt_pk_bf16_f32 v151, v54, v55
  s_add_u32 s34, s30, 2560
  buffer_store_dwordx2 v[144:145], v32, s[12:15], s34 offen sc1
  buffer_store_dwordx2 v[146:147], v33, s[12:15], s34 offen sc1
  buffer_store_dwordx2 v[148:149], v34, s[12:15], s34 offen sc1
  buffer_store_dwordx2 v[150:151], v35, s[12:15], s34 offen sc1
  v_accvgpr_read_b32 v40, a176
  v_accvgpr_read_b32 v41, a177
  v_accvgpr_read_b32 v42, a178
  v_accvgpr_read_b32 v43, a179
  v_accvgpr_read_b32 v44, a180
  v_accvgpr_read_b32 v45, a181
  v_accvgpr_read_b32 v46, a182
  v_accvgpr_read_b32 v47, a183
  v_accvgpr_read_b32 v48, a184
  v_accvgpr_read_b32 v49, a185
  v_accvgpr_read_b32 v50, a186
  v_accvgpr_read_b32 v51, a187
  v_accvgpr_read_b32 v52, a188
  v_accvgpr_read_b32 v53, a189
  v_accvgpr_read_b32 v54, a190
  v_accvgpr_read_b32 v55, a191
  v_cvt_pk_bf16_f32 v152, v40, v41
  v_cvt_pk_bf16_f32 v153, v42, v43
  v_cvt_pk_bf16_f32 v154, v44, v45
  v_cvt_pk_bf16_f32 v155, v46, v47
  v_cvt_pk_bf16_f32 v156, v48, v49
  v_cvt_pk_bf16_f32 v157, v50, v51
  v_cvt_pk_bf16_f32 v158, v52, v53
  v_cvt_pk_bf16_f32 v159, v54, v55
  s_add_u32 s34, s30, 3840
  buffer_store_dwordx2 v[152:153], v32, s[12:15], s34 offen sc1
  buffer_store_dwordx2 v[154:155], v33, s[12:15], s34 offen sc1
  buffer_store_dwordx2 v[156:157], v34, s[12:15], s34 offen sc1
  buffer_store_dwordx2 v[158:159], v35, s[12:15], s34 offen sc1
  s_add_u32 s34, s35, 24
  v_add_u32 v26, s34, v22
  v_mul_u32_u24 v27, s36, v26
  v_lshrrev_b32 v27, 18, v27
  v_mul_u32_u24 v28, 5, v27
  v_sub_u32 v28, v26, v28
  v_lshrrev_b32 v29, 1, v28
  v_lshlrev_b32 v29, 9, v29
  v_and_b32 v30, 1, v28
  v_lshlrev_b32 v30, 3, v30
  v_add3_u32 v29, v29, v30, v24
  v_cmp_eq_u32 vcc, 4, v28
  v_cndmask_b32 v29, v29, v25, vcc
  v_mul_u32_u24 v27, s37, v27
  v_add_u32 v32, v29, v27
  s_add_u32 s34, s35, 26
  v_add_u32 v26, s34, v22
  v_mul_u32_u24 v27, s36, v26
  v_lshrrev_b32 v27, 18, v27
  v_mul_u32_u24 v28, 5, v27
  v_sub_u32 v28, v26, v28
  v_lshrrev_b32 v29, 1, v28
  v_lshlrev_b32 v29, 9, v29
  v_and_b32 v30, 1, v28
  v_lshlrev_b32 v30, 3, v30
  v_add3_u32 v29, v29, v30, v24
  v_cmp_eq_u32 vcc, 4, v28
  v_cndmask_b32 v29, v29, v25, vcc
  v_mul_u32_u24 v27, s37, v27
  v_add_u32 v33, v29, v27
  s_add_u32 s34, s35, 28
  v_add_u32 v26, s34, v22
  v_mul_u32_u24 v27, s36, v26
  v_lshrrev_b32 v27, 18, v27
  v_mul_u32_u24 v28, 5, v27
  v_sub_u32 v28, v26, v28
  v_lshrrev_b32 v29, 1, v28
  v_lshlrev_b32 v29, 9, v29
  v_and_b32 v30, 1, v28
  v_lshlrev_b32 v30, 3, v30
  v_add3_u32 v29, v29, v30, v24
  v_cmp_eq_u32 vcc, 4, v28
  v_cndmask_b32 v29, v29, v25, vcc
  v_mul_u32_u24 v27, s37, v27
  v_add_u32 v34, v29, v27
  s_add_u32 s34, s35, 30
  v_add_u32 v26, s34, v22
  v_mul_u32_u24 v27, s36, v26
  v_lshrrev_b32 v27, 18, v27
  v_mul_u32_u24 v28, 5, v27
  v_sub_u32 v28, v26, v28
  v_lshrrev_b32 v29, 1, v28
  v_lshlrev_b32 v29, 9, v29
  v_and_b32 v30, 1, v28
  v_lshlrev_b32 v30, 3, v30
  v_add3_u32 v29, v29, v30, v24
  v_cmp_eq_u32 vcc, 4, v28
  v_cndmask_b32 v29, v29, v25, vcc
  v_mul_u32_u24 v27, s37, v27
  v_add_u32 v35, v29, v27
  v_accvgpr_read_b32 v40, a192
  v_accvgpr_read_b32 v41, a193
  v_accvgpr_read_b32 v42, a194
  v_accvgpr_read_b32 v43, a195
  v_accvgpr_read_b32 v44, a196
  v_accvgpr_read_b32 v45, a197
  v_accvgpr_read_b32 v46, a198
  v_accvgpr_read_b32 v47, a199
  v_accvgpr_read_b32 v48, a200
  v_accvgpr_read_b32 v49, a201
  v_accvgpr_read_b32 v50, a202
  v_accvgpr_read_b32 v51, a203
  v_accvgpr_read_b32 v52, a204
  v_accvgpr_read_b32 v53, a205
  v_accvgpr_read_b32 v54, a206
  v_accvgpr_read_b32 v55, a207
  v_cvt_pk_bf16_f32 v128, v40, v41
  v_cvt_pk_bf16_f32 v129, v42, v43
  v_cvt_pk_bf16_f32 v130, v44, v45
  v_cvt_pk_bf16_f32 v131, v46, v47
  v_cvt_pk_bf16_f32 v132, v48, v49
  v_cvt_pk_bf16_f32 v133, v50, v51
  v_cvt_pk_bf16_f32 v134, v52, v53
  v_cvt_pk_bf16_f32 v135, v54, v55
  s_add_u32 s34, s30, 0
  buffer_store_dwordx2 v[128:129], v32, s[12:15], s34 offen sc1
  buffer_store_dwordx2 v[130:131], v33, s[12:15], s34 offen sc1
  buffer_store_dwordx2 v[132:133], v34, s[12:15], s34 offen sc1
  buffer_store_dwordx2 v[134:135], v35, s[12:15], s34 offen sc1
  v_accvgpr_read_b32 v40, a208
  v_accvgpr_read_b32 v41, a209
  v_accvgpr_read_b32 v42, a210
  v_accvgpr_read_b32 v43, a211
  v_accvgpr_read_b32 v44, a212
  v_accvgpr_read_b32 v45, a213
  v_accvgpr_read_b32 v46, a214
  v_accvgpr_read_b32 v47, a215
  v_accvgpr_read_b32 v48, a216
  v_accvgpr_read_b32 v49, a217
  v_accvgpr_read_b32 v50, a218
  v_accvgpr_read_b32 v51, a219
  v_accvgpr_read_b32 v52, a220
  v_accvgpr_read_b32 v53, a221
  v_accvgpr_read_b32 v54, a222
  v_accvgpr_read_b32 v55, a223
  v_cvt_pk_bf16_f32 v136, v40, v41
  v_cvt_pk_bf16_f32 v137, v42, v43
  v_cvt_pk_bf16_f32 v138, v44, v45
  v_cvt_pk_bf16_f32 v139, v46, v47
  v_cvt_pk_bf16_f32 v140, v48, v49
  v_cvt_pk_bf16_f32 v141, v50, v51
  v_cvt_pk_bf16_f32 v142, v52, v53
  v_cvt_pk_bf16_f32 v143, v54, v55
  s_add_u32 s34, s30, 1280
  buffer_store_dwordx2 v[136:137], v32, s[12:15], s34 offen sc1
  buffer_store_dwordx2 v[138:139], v33, s[12:15], s34 offen sc1
  buffer_store_dwordx2 v[140:141], v34, s[12:15], s34 offen sc1
  buffer_store_dwordx2 v[142:143], v35, s[12:15], s34 offen sc1
  v_accvgpr_read_b32 v40, a224
  v_accvgpr_read_b32 v41, a225
  v_accvgpr_read_b32 v42, a226
  v_accvgpr_read_b32 v43, a227
  v_accvgpr_read_b32 v44, a228
  v_accvgpr_read_b32 v45, a229
  v_accvgpr_read_b32 v46, a230
  v_accvgpr_read_b32 v47, a231
  v_accvgpr_read_b32 v48, a232
  v_accvgpr_read_b32 v49, a233
  v_accvgpr_read_b32 v50, a234
  v_accvgpr_read_b32 v51, a235
  v_accvgpr_read_b32 v52, a236
  v_accvgpr_read_b32 v53, a237
  v_accvgpr_read_b32 v54, a238
  v_accvgpr_read_b32 v55, a239
  v_cvt_pk_bf16_f32 v144, v40, v41
  v_cvt_pk_bf16_f32 v145, v42, v43
  v_cvt_pk_bf16_f32 v146, v44, v45
  v_cvt_pk_bf16_f32 v147, v46, v47
  v_cvt_pk_bf16_f32 v148, v48, v49
  v_cvt_pk_bf16_f32 v149, v50, v51
  v_cvt_pk_bf16_f32 v150, v52, v53
  v_cvt_pk_bf16_f32 v151, v54, v55
  s_add_u32 s34, s30, 2560
  buffer_store_dwordx2 v[144:145], v32, s[12:15], s34 offen sc1
  buffer_store_dwordx2 v[146:147], v33, s[12:15], s34 offen sc1
  buffer_store_dwordx2 v[148:149], v34, s[12:15], s34 offen sc1
  buffer_store_dwordx2 v[150:151], v35, s[12:15], s34 offen sc1
  v_accvgpr_read_b32 v40, a240
  v_accvgpr_read_b32 v41, a241
  v_accvgpr_read_b32 v42, a242
  v_accvgpr_read_b32 v43, a243
  v_accvgpr_read_b32 v44, a244
  v_accvgpr_read_b32 v45, a245
  v_accvgpr_read_b32 v46, a246
  v_accvgpr_read_b32 v47, a247
  v_accvgpr_read_b32 v48, a248
  v_accvgpr_read_b32 v49, a249
  v_accvgpr_read_b32 v50, a250
  v_accvgpr_read_b32 v51, a251
  v_accvgpr_read_b32 v52, a252
  v_accvgpr_read_b32 v53, a253
  v_accvgpr_read_b32 v54, a254
  v_accvgpr_read_b32 v55, a255
  v_cvt_pk_bf16_f32 v152, v40, v41
  v_cvt_pk_bf16_f32 v153, v42, v43
  v_cvt_pk_bf16_f32 v154, v44, v45
  v_cvt_pk_bf16_f32 v155, v46, v47
  v_cvt_pk_bf16_f32 v156, v48, v49
  v_cvt_pk_bf16_f32 v157, v50, v51
  v_cvt_pk_bf16_f32 v158, v52, v53
  v_cvt_pk_bf16_f32 v159, v54, v55
  s_add_u32 s34, s30, 3840
  buffer_store_dwordx2 v[152:153], v32, s[12:15], s34 offen sc1
  buffer_store_dwordx2 v[154:155], v33, s[12:15], s34 offen sc1
  buffer_store_dwordx2 v[156:157], v34, s[12:15], s34 offen sc1
  buffer_store_dwordx2 v[158:159], v35, s[12:15], s34 offen sc1
  s_branch BGG_NEXT
BGG_ENAT:
  s_cmp_ge_u32 s35, 5
  s_cbranch_scc1 BGG_NEXT
  s_nop 7
  s_nop 7
  v_and_b32 v22, 31, v1
  v_mul_u32_u24 v22, 2560, v22
  v_lshrrev_b32 v23, 5, v1
  v_lshlrev_b32 v23, 4, v23
  v_add_u32 v22, v22, v23
  v_accvgpr_read_b32 v40, a0
  v_accvgpr_read_b32 v41, a1
  v_accvgpr_read_b32 v42, a2
  v_accvgpr_read_b32 v43, a3
  v_accvgpr_read_b32 v44, a4
  v_accvgpr_read_b32 v45, a5
  v_accvgpr_read_b32 v46, a6
  v_accvgpr_read_b32 v47, a7
  v_accvgpr_read_b32 v48, a8
  v_accvgpr_read_b32 v49, a9
  v_accvgpr_read_b32 v50, a10
  v_accvgpr_read_b32 v51, a11
  v_accvgpr_read_b32 v52, a12
  v_accvgpr_read_b32 v53, a13
  v_accvgpr_read_b32 v54, a14
  v_accvgpr_read_b32 v55, a15
  v_cvt_pk_bf16_f32 v128, v40, v41
  v_cvt_pk_bf16_f32 v129, v42, v43
  v_cvt_pk_bf16_f32 v130, v44, v45
  v_cvt_pk_bf16_f32 v131, v46, v47
  v_cvt_pk_bf16_f32 v132, v48, v49
  v_cvt_pk_bf16_f32 v133, v50, v51
  v_cvt_pk_bf16_f32 v134, v52, v53
  v_cvt_pk_bf16_f32 v135, v54, v55
  s_add_u32 s34, s30, 0
  s_nop 0
  v_permlane32_swap_b32 v128, v130
  v_permlane32_swap_b32 v129, v131
  v_permlane32_swap_b32 v132, v134
  v_permlane32_swap_b32 v133, v135
  buffer_store_dwordx4 v[128:131], v22, s[16:19], s34 offen offset:0
  buffer_store_dwordx4 v[132:135], v22, s[16:19], s34 offen offset:32
  v_accvgpr_read_b32 v40, a16
  v_accvgpr_read_b32 v41, a17
  v_accvgpr_read_b32 v42, a18
  v_accvgpr_read_b32 v43, a19
  v_accvgpr_read_b32 v44, a20
  v_accvgpr_read_b32 v45, a21
  v_accvgpr_read_b32 v46, a22
  v_accvgpr_read_b32 v47, a23
  v_accvgpr_read_b32 v48, a24
  v_accvgpr_read_b32 v49, a25
  v_accvgpr_read_b32 v50, a26
  v_accvgpr_read_b32 v51, a27
  v_accvgpr_read_b32 v52, a28
  v_accvgpr_read_b32 v53, a29
  v_accvgpr_read_b32 v54, a30
  v_accvgpr_read_b32 v55, a31
  v_cvt_pk_bf16_f32 v136, v40, v41
  v_cvt_pk_bf16_f32 v137, v42, v43
  v_cvt_pk_bf16_f32 v138, v44, v45
  v_cvt_pk_bf16_f32 v139, v46, v47
  v_cvt_pk_bf16_f32 v140, v48, v49
  v_cvt_pk_bf16_f32 v141, v50, v51
  v_cvt_pk_bf16_f32 v142, v52, v53
  v_cvt_pk_bf16_f32 v143, v54, v55
  s_add_u32 s34, s30, 81920
  s_nop 0
  v_permlane32_swap_b32 v136, v138
  v_permlane32_swap_b32 v137, v139
  v_permlane32_swap_b32 v140, v142
  v_permlane32_swap_b32 v141, v143
  buffer_store_dwordx4 v[136:139], v22, s[16:19], s34 offen offset:0
  buffer_store_dwordx4 v[140:143], v22, s[16:19], s34 offen offset:32
  v_accvgpr_read_b32 v40, a32
  v_accvgpr_read_b32 v41, a33
  v_accvgpr_read_b32 v42, a34
  v_accvgpr_read_b32 v43, a35
  v_accvgpr_read_b32 v44, a36
  v_accvgpr_read_b32 v45, a37
  v_accvgpr_read_b32 v46, a38
  v_accvgpr_read_b32 v47, a39
  v_accvgpr_read_b32 v48, a40
  v_accvgpr_read_b32 v49, a41
  v_accvgpr_read_b32 v50, a42
  v_accvgpr_read_b32 v51, a43
  v_accvgpr_read_b32 v52, a44
  v_accvgpr_read_b32 v53, a45
  v_accvgpr_read_b32 v54, a46
  v_accvgpr_read_b32 v55, a47
  v_cvt_pk_bf16_f32 v144, v40, v41
  v_cvt_pk_bf16_f32 v145, v42, v43
  v_cvt_pk_bf16_f32 v146, v44, v45
  v_cvt_pk_bf16_f32 v147, v46, v47
  v_cvt_pk_bf16_f32 v148, v48, v49
  v_cvt_pk_bf16_f32 v149, v50, v51
  v_cvt_pk_bf16_f32 v150, v52, v53
  v_cvt_pk_bf16_f32 v151, v54, v55
  s_add_u32 s34, s30, 163840
  s_nop 0
  v_permlane32_swap_b32 v144, v146
  v_permlane32_swap_b32 v145, v147
  v_permlane32_swap_b32 v148, v150
  v_permlane32_swap_b32 v149, v151
  buffer_store_dwordx4 v[144:147], v22, s[16:19], s34 offen offset:0
  buffer_store_dwordx4 v[148:151], v22, s[16:19], s34 offen offset:32
  v_accvgpr_read_b32 v40, a48
  v_accvgpr_read_b32 v41, a49
  v_accvgpr_read_b32 v42, a50
  v_accvgpr_read_b32 v43, a51
  v_accvgpr_read_b32 v44, a52
  v_accvgpr_read_b32 v45, a53
  v_accvgpr_read_b32 v46, a54
  v_accvgpr_read_b32 v47, a55
  v_accvgpr_read_b32 v48, a56
  v_accvgpr_read_b32 v49, a57
  v_accvgpr_read_b32 v50, a58
  v_accvgpr_read_b32 v51, a59
  v_accvgpr_read_b32 v52, a60
  v_accvgpr_read_b32 v53, a61
  v_accvgpr_read_b32 v54, a62
  v_accvgpr_read_b32 v55, a63
  v_cvt_pk_bf16_f32 v152, v40, v41
  v_cvt_pk_bf16_f32 v153, v42, v43
  v_cvt_pk_bf16_f32 v154, v44, v45
  v_cvt_pk_bf16_f32 v155, v46, v47
  v_cvt_pk_bf16_f32 v156, v48, v49
  v_cvt_pk_bf16_f32 v157, v50, v51
  v_cvt_pk_bf16_f32 v158, v52, v53
  v_cvt_pk_bf16_f32 v159, v54, v55
  s_add_u32 s34, s30, 245760
  s_nop 0
  v_permlane32_swap_b32 v152, v154
  v_permlane32_swap_b32 v153, v155
  v_permlane32_swap_b32 v156, v158
  v_permlane32_swap_b32 v157, v159
  buffer_store_dwordx4 v[152:155], v22, s[16:19], s34 offen offset:0
  buffer_store_dwordx4 v[156:159], v22, s[16:19], s34 offen offset:32
  v_accvgpr_read_b32 v40, a64
  v_accvgpr_read_b32 v41, a65
  v_accvgpr_read_b32 v42, a66
  v_accvgpr_read_b32 v43, a67
  v_accvgpr_read_b32 v44, a68
  v_accvgpr_read_b32 v45, a69
  v_accvgpr_read_b32 v46, a70
  v_accvgpr_read_b32 v47, a71
  v_accvgpr_read_b32 v48, a72
  v_accvgpr_read_b32 v49, a73
  v_accvgpr_read_b32 v50, a74
  v_accvgpr_read_b32 v51, a75
  v_accvgpr_read_b32 v52, a76
  v_accvgpr_read_b32 v53, a77
  v_accvgpr_read_b32 v54, a78
  v_accvgpr_read_b32 v55, a79
  v_cvt_pk_bf16_f32 v128, v40, v41
  v_cvt_pk_bf16_f32 v129, v42, v43
  v_cvt_pk_bf16_f32 v130, v44, v45
  v_cvt_pk_bf16_f32 v131, v46, v47
  v_cvt_pk_bf16_f32 v132, v48, v49
  v_cvt_pk_bf16_f32 v133, v50, v51
  v_cvt_pk_bf16_f32 v134, v52, v53
  v_cvt_pk_bf16_f32 v135, v54, v55
  s_add_u32 s34, s30, 64
  s_nop 0
  v_permlane32_swap_b32 v128, v130
  v_permlane32_swap_b32 v129, v131
  v_permlane32_swap_b32 v132, v134
  v_permlane32_swap_b32 v133, v135
  buffer_store_dwordx4 v[128:131], v22, s[16:19], s34 offen offset:0
  buffer_store_dwordx4 v[132:135], v22, s[16:19], s34 offen offset:32
  v_accvgpr_read_b32 v40, a80
  v_accvgpr_read_b32 v41, a81
  v_accvgpr_read_b32 v42, a82
  v_accvgpr_read_b32 v43, a83
  v_accvgpr_read_b32 v44, a84
  v_accvgpr_read_b32 v45, a85
  v_accvgpr_read_b32 v46, a86
  v_accvgpr_read_b32 v47, a87
  v_accvgpr_read_b32 v48, a88
  v_accvgpr_read_b32 v49, a89
  v_accvgpr_read_b32 v50, a90
  v_accvgpr_read_b32 v51, a91
  v_accvgpr_read_b32 v52, a92
  v_accvgpr_read_b32 v53, a93
  v_accvgpr_read_b32 v54, a94
  v_accvgpr_read_b32 v55, a95
  v_cvt_pk_bf16_f32 v136, v40, v41
  v_cvt_pk_bf16_f32 v137, v42, v43
  v_cvt_pk_bf16_f32 v138, v44, v45
  v_cvt_pk_bf16_f32 v139, v46, v47
  v_cvt_pk_bf16_f32 v140, v48, v49
  v_cvt_pk_bf16_f32 v141, v50, v51
  v_cvt_pk_bf16_f32 v142, v52, v53
  v_cvt_pk_bf16_f32 v143, v54, v55
  s_add_u32 s34, s30, 81984
  s_nop 0
  v_permlane32_swap_b32 v136, v138
  v_permlane32_swap_b32 v137, v139
  v_permlane32_swap_b32 v140, v142
  v_permlane32_swap_b32 v141, v143
  buffer_store_dwordx4 v[136:139], v22, s[16:19], s34 offen offset:0
  buffer_store_dwordx4 v[140:143], v22, s[16:19], s34 offen offset:32
  v_accvgpr_read_b32 v40, a96
  v_accvgpr_read_b32 v41, a97
  v_accvgpr_read_b32 v42, a98
  v_accvgpr_read_b32 v43, a99
  v_accvgpr_read_b32 v44, a100
  v_accvgpr_read_b32 v45, a101
  v_accvgpr_read_b32 v46, a102
  v_accvgpr_read_b32 v47, a103
  v_accvgpr_read_b32 v48, a104
  v_accvgpr_read_b32 v49, a105
  v_accvgpr_read_b32 v50, a106
  v_accvgpr_read_b32 v51, a107
  v_accvgpr_read_b32 v52, a108
  v_accvgpr_read_b32 v53, a109
  v_accvgpr_read_b32 v54, a110
  v_accvgpr_read_b32 v55, a111
  v_cvt_pk_bf16_f32 v144, v40, v41
  v_cvt_pk_bf16_f32 v145, v42, v43
  v_cvt_pk_bf16_f32 v146, v44, v45
  v_cvt_pk_bf16_f32 v147, v46, v47
  v_cvt_pk_bf16_f32 v148, v48, v49
  v_cvt_pk_bf16_f32 v149, v50, v51
  v_cvt_pk_bf16_f32 v150, v52, v53
  v_cvt_pk_bf16_f32 v151, v54, v55
  s_add_u32 s34, s30, 163904
  s_nop 0
  v_permlane32_swap_b32 v144, v146
  v_permlane32_swap_b32 v145, v147
  v_permlane32_swap_b32 v148, v150
  v_permlane32_swap_b32 v149, v151
  buffer_store_dwordx4 v[144:147], v22, s[16:19], s34 offen offset:0
  buffer_store_dwordx4 v[148:151], v22, s[16:19], s34 offen offset:32
  v_accvgpr_read_b32 v40, a112
  v_accvgpr_read_b32 v41, a113
  v_accvgpr_read_b32 v42, a114
  v_accvgpr_read_b32 v43, a115
  v_accvgpr_read_b32 v44, a116
  v_accvgpr_read_b32 v45, a117
  v_accvgpr_read_b32 v46, a118
  v_accvgpr_read_b32 v47, a119
  v_accvgpr_read_b32 v48, a120
  v_accvgpr_read_b32 v49, a121
  v_accvgpr_read_b32 v50, a122
  v_accvgpr_read_b32 v51, a123
  v_accvgpr_read_b32 v52, a124
  v_accvgpr_read_b32 v53, a125
  v_accvgpr_read_b32 v54, a126
  v_accvgpr_read_b32 v55, a127
  v_cvt_pk_bf16_f32 v152, v40, v41
  v_cvt_pk_bf16_f32 v153, v42, v43
  v_cvt_pk_bf16_f32 v154, v44, v45
  v_cvt_pk_bf16_f32 v155, v46, v47
  v_cvt_pk_bf16_f32 v156, v48, v49
  v_cvt_pk_bf16_f32 v157, v50, v51
  v_cvt_pk_bf16_f32 v158, v52, v53
  v_cvt_pk_bf16_f32 v159, v54, v55
  s_add_u32 s34, s30, 245824
  s_nop 0
  v_permlane32_swap_b32 v152, v154
  v_permlane32_swap_b32 v153, v155
  v_permlane32_swap_b32 v156, v158
  v_permlane32_swap_b32 v157, v159
  buffer_store_dwordx4 v[152:155], v22, s[16:19], s34 offen offset:0
  buffer_store_dwordx4 v[156:159], v22, s[16:19], s34 offen offset:32
  v_accvgpr_read_b32 v40, a128
  v_accvgpr_read_b32 v41, a129
  v_accvgpr_read_b32 v42, a130
  v_accvgpr_read_b32 v43, a131
  v_accvgpr_read_b32 v44, a132
  v_accvgpr_read_b32 v45, a133
  v_accvgpr_read_b32 v46, a134
  v_accvgpr_read_b32 v47, a135
  v_accvgpr_read_b32 v48, a136
  v_accvgpr_read_b32 v49, a137
  v_accvgpr_read_b32 v50, a138
  v_accvgpr_read_b32 v51, a139
  v_accvgpr_read_b32 v52, a140
  v_accvgpr_read_b32 v53, a141
  v_accvgpr_read_b32 v54, a142
  v_accvgpr_read_b32 v55, a143
  v_cvt_pk_bf16_f32 v128, v40, v41
  v_cvt_pk_bf16_f32 v129, v42, v43
  v_cvt_pk_bf16_f32 v130, v44, v45
  v_cvt_pk_bf16_f32 v131, v46, v47
  v_cvt_pk_bf16_f32 v132, v48, v49
  v_cvt_pk_bf16_f32 v133, v50, v51
  v_cvt_pk_bf16_f32 v134, v52, v53
  v_cvt_pk_bf16_f32 v135, v54, v55
  s_add_u32 s34, s30, 128
  s_nop 0
  v_permlane32_swap_b32 v128, v130
  v_permlane32_swap_b32 v129, v131
  v_permlane32_swap_b32 v132, v134
  v_permlane32_swap_b32 v133, v135
  buffer_store_dwordx4 v[128:131], v22, s[16:19], s34 offen offset:0
  buffer_store_dwordx4 v[132:135], v22, s[16:19], s34 offen offset:32
  v_accvgpr_read_b32 v40, a144
  v_accvgpr_read_b32 v41, a145
  v_accvgpr_read_b32 v42, a146
  v_accvgpr_read_b32 v43, a147
  v_accvgpr_read_b32 v44, a148
  v_accvgpr_read_b32 v45, a149
  v_accvgpr_read_b32 v46, a150
  v_accvgpr_read_b32 v47, a151
  v_accvgpr_read_b32 v48, a152
  v_accvgpr_read_b32 v49, a153
  v_accvgpr_read_b32 v50, a154
  v_accvgpr_read_b32 v51, a155
  v_accvgpr_read_b32 v52, a156
  v_accvgpr_read_b32 v53, a157
  v_accvgpr_read_b32 v54, a158
  v_accvgpr_read_b32 v55, a159
  v_cvt_pk_bf16_f32 v136, v40, v41
  v_cvt_pk_bf16_f32 v137, v42, v43
  v_cvt_pk_bf16_f32 v138, v44, v45
  v_cvt_pk_bf16_f32 v139, v46, v47
  v_cvt_pk_bf16_f32 v140, v48, v49
  v_cvt_pk_bf16_f32 v141, v50, v51
  v_cvt_pk_bf16_f32 v142, v52, v53
  v_cvt_pk_bf16_f32 v143, v54, v55
  s_add_u32 s34, s30, 82048
  s_nop 0
  v_permlane32_swap_b32 v136, v138
  v_permlane32_swap_b32 v137, v139
  v_permlane32_swap_b32 v140, v142
  v_permlane32_swap_b32 v141, v143
  buffer_store_dwordx4 v[136:139], v22, s[16:19], s34 offen offset:0
  buffer_store_dwordx4 v[140:143], v22, s[16:19], s34 offen offset:32
  v_accvgpr_read_b32 v40, a160
  v_accvgpr_read_b32 v41, a161
  v_accvgpr_read_b32 v42, a162
  v_accvgpr_read_b32 v43, a163
  v_accvgpr_read_b32 v44, a164
  v_accvgpr_read_b32 v45, a165
  v_accvgpr_read_b32 v46, a166
  v_accvgpr_read_b32 v47, a167
  v_accvgpr_read_b32 v48, a168
  v_accvgpr_read_b32 v49, a169
  v_accvgpr_read_b32 v50, a170
  v_accvgpr_read_b32 v51, a171
  v_accvgpr_read_b32 v52, a172
  v_accvgpr_read_b32 v53, a173
  v_accvgpr_read_b32 v54, a174
  v_accvgpr_read_b32 v55, a175
  v_cvt_pk_bf16_f32 v144, v40, v41
  v_cvt_pk_bf16_f32 v145, v42, v43
  v_cvt_pk_bf16_f32 v146, v44, v45
  v_cvt_pk_bf16_f32 v147, v46, v47
  v_cvt_pk_bf16_f32 v148, v48, v49
  v_cvt_pk_bf16_f32 v149, v50, v51
  v_cvt_pk_bf16_f32 v150, v52, v53
  v_cvt_pk_bf16_f32 v151, v54, v55
  s_add_u32 s34, s30, 163968
  s_nop 0
  v_permlane32_swap_b32 v144, v146
  v_permlane32_swap_b32 v145, v147
  v_permlane32_swap_b32 v148, v150
  v_permlane32_swap_b32 v149, v151
  buffer_store_dwordx4 v[144:147], v22, s[16:19], s34 offen offset:0
  buffer_store_dwordx4 v[148:151], v22, s[16:19], s34 offen offset:32
  v_accvgpr_read_b32 v40, a176
  v_accvgpr_read_b32 v41, a177
  v_accvgpr_read_b32 v42, a178
  v_accvgpr_read_b32 v43, a179
  v_accvgpr_read_b32 v44, a180
  v_accvgpr_read_b32 v45, a181
  v_accvgpr_read_b32 v46, a182
  v_accvgpr_read_b32 v47, a183
  v_accvgpr_read_b32 v48, a184
  v_accvgpr_read_b32 v49, a185
  v_accvgpr_read_b32 v50, a186
  v_accvgpr_read_b32 v51, a187
  v_accvgpr_read_b32 v52, a188
  v_accvgpr_read_b32 v53, a189
  v_accvgpr_read_b32 v54, a190
  v_accvgpr_read_b32 v55, a191
  v_cvt_pk_bf16_f32 v152, v40, v41
  v_cvt_pk_bf16_f32 v153, v42, v43
  v_cvt_pk_bf16_f32 v154, v44, v45
  v_cvt_pk_bf16_f32 v155, v46, v47
  v_cvt_pk_bf16_f32 v156, v48, v49
  v_cvt_pk_bf16_f32 v157, v50, v51
  v_cvt_pk_bf16_f32 v158, v52, v53
  v_cvt_pk_bf16_f32 v159, v54, v55
  s_add_u32 s34, s30, 245888
  s_nop 0
  v_permlane32_swap_b32 v152, v154
  v_permlane32_swap_b32 v153, v155
  v_permlane32_swap_b32 v156, v158
  v_permlane32_swap_b32 v157, v159
  buffer_store_dwordx4 v[152:155], v22, s[16:19], s34 offen offset:0
  buffer_store_dwordx4 v[156:159], v22, s[16:19], s34 offen offset:32
  v_accvgpr_read_b32 v40, a192
  v_accvgpr_read_b32 v41, a193
  v_accvgpr_read_b32 v42, a194
  v_accvgpr_read_b32 v43, a195
  v_accvgpr_read_b32 v44, a196
  v_accvgpr_read_b32 v45, a197
  v_accvgpr_read_b32 v46, a198
  v_accvgpr_read_b32 v47, a199
  v_accvgpr_read_b32 v48, a200
  v_accvgpr_read_b32 v49, a201
  v_accvgpr_read_b32 v50, a202
  v_accvgpr_read_b32 v51, a203
  v_accvgpr_read_b32 v52, a204
  v_accvgpr_read_b32 v53, a205
  v_accvgpr_read_b32 v54, a206
  v_accvgpr_read_b32 v55, a207
  v_cvt_pk_bf16_f32 v128, v40, v41
  v_cvt_pk_bf16_f32 v129, v42, v43
  v_cvt_pk_bf16_f32 v130, v44, v45
  v_cvt_pk_bf16_f32 v131, v46, v47
  v_cvt_pk_bf16_f32 v132, v48, v49
  v_cvt_pk_bf16_f32 v133, v50, v51
  v_cvt_pk_bf16_f32 v134, v52, v53
  v_cvt_pk_bf16_f32 v135, v54, v55
  s_add_u32 s34, s30, 192
  s_nop 0
  v_permlane32_swap_b32 v128, v130
  v_permlane32_swap_b32 v129, v131
  v_permlane32_swap_b32 v132, v134
  v_permlane32_swap_b32 v133, v135
  buffer_store_dwordx4 v[128:131], v22, s[16:19], s34 offen offset:0
  buffer_store_dwordx4 v[132:135], v22, s[16:19], s34 offen offset:32
  v_accvgpr_read_b32 v40, a208
  v_accvgpr_read_b32 v41, a209
  v_accvgpr_read_b32 v42, a210
  v_accvgpr_read_b32 v43, a211
  v_accvgpr_read_b32 v44, a212
  v_accvgpr_read_b32 v45, a213
  v_accvgpr_read_b32 v46, a214
  v_accvgpr_read_b32 v47, a215
  v_accvgpr_read_b32 v48, a216
  v_accvgpr_read_b32 v49, a217
  v_accvgpr_read_b32 v50, a218
  v_accvgpr_read_b32 v51, a219
  v_accvgpr_read_b32 v52, a220
  v_accvgpr_read_b32 v53, a221
  v_accvgpr_read_b32 v54, a222
  v_accvgpr_read_b32 v55, a223
  v_cvt_pk_bf16_f32 v136, v40, v41
  v_cvt_pk_bf16_f32 v137, v42, v43
  v_cvt_pk_bf16_f32 v138, v44, v45
  v_cvt_pk_bf16_f32 v139, v46, v47
  v_cvt_pk_bf16_f32 v140, v48, v49
  v_cvt_pk_bf16_f32 v141, v50, v51
  v_cvt_pk_bf16_f32 v142, v52, v53
  v_cvt_pk_bf16_f32 v143, v54, v55
  s_add_u32 s34, s30, 82112
  s_nop 0
  v_permlane32_swap_b32 v136, v138
  v_permlane32_swap_b32 v137, v139
  v_permlane32_swap_b32 v140, v142
  v_permlane32_swap_b32 v141, v143
  buffer_store_dwordx4 v[136:139], v22, s[16:19], s34 offen offset:0
  buffer_store_dwordx4 v[140:143], v22, s[16:19], s34 offen offset:32
  v_accvgpr_read_b32 v40, a224
  v_accvgpr_read_b32 v41, a225
  v_accvgpr_read_b32 v42, a226
  v_accvgpr_read_b32 v43, a227
  v_accvgpr_read_b32 v44, a228
  v_accvgpr_read_b32 v45, a229
  v_accvgpr_read_b32 v46, a230
  v_accvgpr_read_b32 v47, a231
  v_accvgpr_read_b32 v48, a232
  v_accvgpr_read_b32 v49, a233
  v_accvgpr_read_b32 v50, a234
  v_accvgpr_read_b32 v51, a235
  v_accvgpr_read_b32 v52, a236
  v_accvgpr_read_b32 v53, a237
  v_accvgpr_read_b32 v54, a238
  v_accvgpr_read_b32 v55, a239
  v_cvt_pk_bf16_f32 v144, v40, v41
  v_cvt_pk_bf16_f32 v145, v42, v43
  v_cvt_pk_bf16_f32 v146, v44, v45
  v_cvt_pk_bf16_f32 v147, v46, v47
  v_cvt_pk_bf16_f32 v148, v48, v49
  v_cvt_pk_bf16_f32 v149, v50, v51
  v_cvt_pk_bf16_f32 v150, v52, v53
  v_cvt_pk_bf16_f32 v151, v54, v55
  s_add_u32 s34, s30, 164032
  s_nop 0
  v_permlane32_swap_b32 v144, v146
  v_permlane32_swap_b32 v145, v147
  v_permlane32_swap_b32 v148, v150
  v_permlane32_swap_b32 v149, v151
  buffer_store_dwordx4 v[144:147], v22, s[16:19], s34 offen offset:0
  buffer_store_dwordx4 v[148:151], v22, s[16:19], s34 offen offset:32
  v_accvgpr_read_b32 v40, a240
  v_accvgpr_read_b32 v41, a241
  v_accvgpr_read_b32 v42, a242
  v_accvgpr_read_b32 v43, a243
  v_accvgpr_read_b32 v44, a244
  v_accvgpr_read_b32 v45, a245
  v_accvgpr_read_b32 v46, a246
  v_accvgpr_read_b32 v47, a247
  v_accvgpr_read_b32 v48, a248
  v_accvgpr_read_b32 v49, a249
  v_accvgpr_read_b32 v50, a250
  v_accvgpr_read_b32 v51, a251
  v_accvgpr_read_b32 v52, a252
  v_accvgpr_read_b32 v53, a253
  v_accvgpr_read_b32 v54, a254
  v_accvgpr_read_b32 v55, a255
  v_cvt_pk_bf16_f32 v152, v40, v41
  v_cvt_pk_bf16_f32 v153, v42, v43
  v_cvt_pk_bf16_f32 v154, v44, v45
  v_cvt_pk_bf16_f32 v155, v46, v47
  v_cvt_pk_bf16_f32 v156, v48, v49
  v_cvt_pk_bf16_f32 v157, v50, v51
  v_cvt_pk_bf16_f32 v158, v52, v53
  v_cvt_pk_bf16_f32 v159, v54, v55
  s_add_u32 s34, s30, 245952
  s_nop 0
  v_permlane32_swap_b32 v152, v154
  v_permlane32_swap_b32 v153, v155
  v_permlane32_swap_b32 v156, v158
  v_permlane32_swap_b32 v157, v159
  buffer_store_dwordx4 v[152:155], v22, s[16:19], s34 offen offset:0
  buffer_store_dwordx4 v[156:159], v22, s[16:19], s34 offen offset:32
  s_branch BGG_NEXT
BGG_SWAP:
  s_add_u32 m0, s24, 0
  s_nop 0
  buffer_load_dwordx4 v2, s[4:7], s20 offen lds
  s_add_u32 m0, s24, 1024
  s_nop 0
  buffer_load_dwordx4 v3, s[4:7], s20 offen lds
  s_add_u32 m0, s24, 2048
  s_nop 0
  buffer_load_dwordx4 v4, s[4:7], s20 offen lds
  s_add_u32 m0, s24, 3072
  s_nop 0
  buffer_load_dwordx4 v5, s[4:7], s20 offen lds
  s_add_u32 m0, s25, 0
  s_nop 0
  buffer_load_dwordx4 v6, s[8:11], s21 offen lds
  s_add_u32 m0, s25, 1024
  s_nop 0
  buffer_load_dwordx4 v7, s[8:11], s21 offen lds
  s_add_u32 m0, s25, 2048
  s_nop 0
  buffer_load_dwordx4 v8, s[8:11], s21 offen lds
  s_add_u32 m0, s25, 3072
  s_nop 0
  buffer_load_dwordx4 v9, s[8:11], s21 offen lds
  s_add_u32 s20, s20, 64
  s_add_u32 s21, s21, s23
  s_add_u32 m0, s24, 32768
  s_nop 0
  buffer_load_dwordx4 v2, s[4:7], s20 offen lds
  s_add_u32 m0, s24, 33792
  s_nop 0
  buffer_load_dwordx4 v3, s[4:7], s20 offen lds
  s_add_u32 m0, s24, 34816
  s_nop 0
  buffer_load_dwordx4 v4, s[4:7], s20 offen lds
  s_add_u32 m0, s24, 35840
  s_nop 0
  buffer_load_dwordx4 v5, s[4:7], s20 offen lds
  s_add_u32 m0, s25, 32768
  s_nop 0
  buffer_load_dwordx4 v6, s[8:11], s21 offen lds
  s_add_u32 m0, s25, 33792
  s_nop 0
  buffer_load_dwordx4 v7, s[8:11], s21 offen lds
  s_add_u32 m0, s25, 34816
  s_nop 0
  buffer_load_dwordx4 v8, s[8:11], s21 offen lds
  s_add_u32 m0, s25, 35840
  s_nop 0
  buffer_load_dwordx4 v9, s[8:11], s21 offen lds
  s_add_u32 s20, s20, 64
  s_add_u32 s21, s21, s23
  s_add_u32 m0, s24, 65536
  s_nop 0
  buffer_load_dwordx4 v2, s[4:7], s20 offen lds
  s_add_u32 m0, s24, 66560
  s_nop 0
  buffer_load_dwordx4 v3, s[4:7], s20 offen lds
  s_add_u32 m0, s24, 67584
  s_nop 0
  buffer_load_dwordx4 v4, s[4:7], s20 offen lds
  s_add_u32 m0, s24, 68608
  s_nop 0
  buffer_load_dwordx4 v5, s[4:7], s20 offen lds
  s_add_u32 m0, s25, 65536
  s_nop 0
  buffer_load_dwordx4 v6, s[8:11], s21 offen lds
  s_add_u32 m0, s25, 66560
  s_nop 0
  buffer_load_dwordx4 v7, s[8:11], s21 offen lds
  s_add_u32 m0, s25, 67584
  s_nop 0
  buffer_load_dwordx4 v8, s[8:11], s21 offen lds
  s_add_u32 m0, s25, 68608
  s_nop 0
  buffer_load_dwordx4 v9, s[8:11], s21 offen lds
  s_add_u32 s20, s20, 64
  s_add_u32 s21, s21, s23
  s_waitcnt vmcnt(16)
  s_barrier
  ds_read_b64_tr_b16 v[64:65], v14 offset:0
  ds_read_b64_tr_b16 v[66:67], v14 offset:2048
  ds_read_b128 v[80:83], v10 offset:0
  ds_read_b128 v[84:87], v10 offset:2048
  ds_read_b128 v[88:91], v10 offset:4096
  ds_read_b128 v[92:95], v10 offset:6144
  ds_read_b64_tr_b16 v[68:69], v15 offset:0
  ds_read_b64_tr_b16 v[70:71], v15 offset:2048
  ds_read_b64_tr_b16 v[72:73], v16 offset:0
  ds_read_b64_tr_b16 v[74:75], v16 offset:2048
  ds_read_b64_tr_b16 v[76:77], v17 offset:0
  ds_read_b64_tr_b16 v[78:79], v17 offset:2048
  s_waitcnt lgkmcnt(0)
  v_mfma_f32_32x32x16_bf16 a[0:15], v[80:83], v[64:67], 0
  ds_read_b64_tr_b16 v[96:97], v14 offset:8192
  v_mfma_f32_32x32x16_bf16 a[16:31], v[84:87], v[64:67], 0
  ds_read_b64_tr_b16 v[98:99], v14 offset:10240
  v_mfma_f32_32x32x16_bf16 a[32:47], v[88:91], v[64:67], 0
  ds_read_b128 v[112:115], v11 offset:0
  v_mfma_f32_32x32x16_bf16 a[48:63], v[92:95], v[64:67], 0
  ds_read_b128 v[116:119], v11 offset:2048
  s_add_u32 m0, s24, 98304
  s_nop 0
  buffer_load_dwordx4 v2, s[4:7], s20 offen lds
  v_mfma_f32_32x32x16_bf16 a[64:79], v[80:83], v[68:71], 0
  ds_read_b128 v[120:123], v11 offset:4096
  v_mfma_f32_32x32x16_bf16 a[80:95], v[84:87], v[68:71], 0
  ds_read_b128 v[124:127], v11 offset:6144
  v_mfma_f32_32x32x16_bf16 a[96:111], v[88:91], v[68:71], 0
  ds_read_b64_tr_b16 v[100:101], v15 offset:8192
  v_mfma_f32_32x32x16_bf16 a[112:127], v[92:95], v[68:71], 0
  ds_read_b64_tr_b16 v[102:103], v15 offset:10240
  s_add_u32 m0, s24, 99328
  s_nop 0
  buffer_load_dwordx4 v3, s[4:7], s20 offen lds
  v_mfma_f32_32x32x16_bf16 a[128:143], v[80:83], v[72:75], 0
  ds_read_b64_tr_b16 v[104:105], v16 offset:8192
  v_mfma_f32_32x32x16_bf16 a[144:159], v[84:87], v[72:75], 0
  ds_read_b64_tr_b16 v[106:107], v16 offset:10240
  v_mfma_f32_32x32x16_bf16 a[160:175], v[88:91], v[72:75], 0
  ds_read_b64_tr_b16 v[108:109], v17 offset:8192
  v_mfma_f32_32x32x16_bf16 a[176:191], v[92:95], v[72:75], 0
  ds_read_b64_tr_b16 v[110:111], v17 offset:10240
  s_add_u32 m0, s24, 100352
  s_nop 0
  buffer_load_dwordx4 v4, s[4:7], s20 offen lds
  v_mfma_f32_32x32x16_bf16 a[192:207], v[80:83], v[76:79], 0
  v_mfma_f32_32x32x16_bf16 a[208:223], v[84:87], v[76:79], 0
  v_mfma_f32_32x32x16_bf16 a[224:239], v[88:91], v[76:79], 0
  v_mfma_f32_32x32x16_bf16 a[240:255], v[92:95], v[76:79], 0
  s_add_u32 m0, s24, 101376
  s_nop 0
  buffer_load_dwordx4 v5, s[4:7], s20 offen lds
  s_waitcnt vmcnt(12) lgkmcnt(0)
  s_barrier
  v_mfma_f32_32x32x16_bf16 a[0:15], v[112:115], v[96:99], a[0:15]
  ds_read_b64_tr_b16 v[64:65], v14 offset:32768
  v_mfma_f32_32x32x16_bf16 a[16:31], v[116:119], v[96:99], a[16:31]
  ds_read_b64_tr_b16 v[66:67], v14 offset:34816
  v_mfma_f32_32x32x16_bf16 a[32:47], v[120:123], v[96:99], a[32:47]
  ds_read_b128 v[80:83], v10 offset:32768
  v_mfma_f32_32x32x16_bf16 a[48:63], v[124:127], v[96:99], a[48:63]
  ds_read_b128 v[84:87], v10 offset:34816
  s_add_u32 m0, s25, 98304
  s_nop 0
  buffer_load_dwordx4 v6, s[8:11], s21 offen lds
  v_mfma_f32_32x32x16_bf16 a[64:79], v[112:115], v[100:103], a[64:79]
  ds_read_b128 v[88:91], v10 offset:36864
  v_mfma_f32_32x32x16_bf16 a[80:95], v[116:119], v[100:103], a[80:95]
  ds_read_b128 v[92:95], v10 offset:38912
  v_mfma_f32_32x32x16_bf16 a[96:111], v[120:123], v[100:103], a[96:111]
  ds_read_b64_tr_b16 v[68:69], v15 offset:32768
  v_mfma_f32_32x32x16_bf16 a[112:127], v[124:127], v[100:103], a[112:127]
  ds_read_b64_tr_b16 v[70:71], v15 offset:34816
  s_add_u32 m0, s25, 99328
  s_nop 0
  buffer_load_dwordx4 v7, s[8:11], s21 offen lds
  v_mfma_f32_32x32x16_bf16 a[128:143], v[112:115], v[104:107], a[128:143]
  ds_read_b64_tr_b16 v[72:73], v16 offset:32768
  v_mfma_f32_32x32x16_bf16 a[144:159], v[116:119], v[104:107], a[144:159]
  ds_read_b64_tr_b16 v[74:75], v16 offset:34816
  v_mfma_f32_32x32x16_bf16 a[160:175], v[120:123], v[104:107], a[160:175]
  ds_read_b64_tr_b16 v[76:77], v17 offset:32768
  v_mfma_f32_32x32x16_bf16 a[176:191], v[124:127], v[104:107], a[176:191]
  ds_read_b64_tr_b16 v[78:79], v17 offset:34816
  s_add_u32 m0, s25, 100352
  s_nop 0
  buffer_load_dwordx4 v8, s[8:11], s21 offen lds
  v_mfma_f32_32x32x16_bf16 a[192:207], v[112:115], v[108:111], a[192:207]
  v_mfma_f32_32x32x16_bf16 a[208:223], v[116:119], v[108:111], a[208:223]
  v_mfma_f32_32x32x16_bf16 a[224:239], v[120:123], v[108:111], a[224:239]
  v_mfma_f32_32x32x16_bf16 a[240:255], v[124:127], v[108:111], a[240:255]
  s_add_u32 m0, s25, 101376
  s_nop 0
  buffer_load_dwordx4 v9, s[8:11], s21 offen lds
  s_add_u32 s20, s20, 64
  s_add_u32 s21, s21, s23
  s_waitcnt lgkmcnt(0)
  v_mfma_f32_32x32x16_bf16 a[0:15], v[80:83], v[64:67], a[0:15]
  ds_read_b64_tr_b16 v[96:97], v14 offset:40960
  v_mfma_f32_32x32x16_bf16 a[16:31], v[84:87], v[64:67], a[16:31]
  ds_read_b64_tr_b16 v[98:99], v14 offset:43008
  v_mfma_f32_32x32x16_bf16 a[32:47], v[88:91], v[64:67], a[32:47]
  ds_read_b128 v[112:115], v11 offset:32768
  v_mfma_f32_32x32x16_bf16 a[48:63], v[92:95], v[64:67], a[48:63]
  ds_read_b128 v[116:119], v11 offset:34816
  s_add_u32 m0, s24, 0
  s_nop 0
  buffer_load_dwordx4 v2, s[4:7], s20 offen lds
  v_mfma_f32_32x32x16_bf16 a[64:79], v[80:83], v[68:71], a[64:79]
  ds_read_b128 v[120:123], v11 offset:36864
  v_mfma_f32_32x32x16_bf16 a[80:95], v[84:87], v[68:71], a[80:95]
  ds_read_b128 v[124:127], v11 offset:38912
  v_mfma_f32_32x32x16_bf16 a[96:111], v[88:91], v[68:71], a[96:111]
  ds_read_b64_tr_b16 v[100:101], v15 offset:40960
  v_mfma_f32_32x32x16_bf16 a[112:127], v[92:95], v[68:71], a[112:127]
  ds_read_b64_tr_b16 v[102:103], v15 offset:43008
  s_add_u32 m0, s24, 1024
  s_nop 0
  buffer_load_dwordx4 v3, s[4:7], s20 offen lds
  v_mfma_f32_32x32x16_bf16 a[128:143], v[80:83], v[72:75], a[128:143]
  ds_read_b64_tr_b16 v[104:105], v16 offset:40960
  v_mfma_f32_32x32x16_bf16 a[144:159], v[84:87], v[72:75], a[144:159]
  ds_read_b64_tr_b16 v[106:107], v16 offset:43008
  v_mfma_f32_32x32x16_bf16 a[160:175], v[88:91], v[72:75], a[160:175]
  ds_read_b64_tr_b16 v[108:109], v17 offset:40960
  v_mfma_f32_32x32x16_bf16 a[176:191], v[92:95], v[72:75], a[176:191]
  ds_read_b64_tr_b16 v[110:111], v17 offset:43008
  s_add_u32 m0, s24, 2048
  s_nop 0
  buffer_load_dwordx4 v4, s[4:7], s20 offen lds
  v_mfma_f32_32x32x16_bf16 a[192:207], v[80:83], v[76:79], a[192:207]
  v_mfma_f32_32x32x16_bf16 a[208:223], v[84:87], v[76:79], a[208:223]
  v_mfma_f32_32x32x16_bf16 a[224:239], v[88:91], v[76:79], a[224:239]
  v_mfma_f32_32x32x16_bf16 a[240:255], v[92:95], v[76:79], a[240:255]
  s_add_u32 m0, s24, 3072
  s_nop 0
  buffer_load_dwordx4 v5, s[4:7], s20 offen lds
  s_waitcnt vmcnt(12) lgkmcnt(0)
  s_barrier
  v_mfma_f32_32x32x16_bf16 a[0:15], v[112:115], v[96:99], a[0:15]
  ds_read_b64_tr_b16 v[64:65], v18 offset:0
  v_mfma_f32_32x32x16_bf16 a[16:31], v[116:119], v[96:99], a[16:31]
  ds_read_b64_tr_b16 v[66:67], v18 offset:2048
  v_mfma_f32_32x32x16_bf16 a[32:47], v[120:123], v[96:99], a[32:47]
  ds_read_b128 v[80:83], v12 offset:0
  v_mfma_f32_32x32x16_bf16 a[48:63], v[124:127], v[96:99], a[48:63]
  ds_read_b128 v[84:87], v12 offset:2048
  s_add_u32 m0, s25, 0
  s_nop 0
  buffer_load_dwordx4 v6, s[8:11], s21 offen lds
  v_mfma_f32_32x32x16_bf16 a[64:79], v[112:115], v[100:103], a[64:79]
  ds_read_b128 v[88:91], v12 offset:4096
  v_mfma_f32_32x32x16_bf16 a[80:95], v[116:119], v[100:103], a[80:95]
  ds_read_b128 v[92:95], v12 offset:6144
  v_mfma_f32_32x32x16_bf16 a[96:111], v[120:123], v[100:103], a[96:111]
  ds_read_b64_tr_b16 v[68:69], v19 offset:0
  v_mfma_f32_32x32x16_bf16 a[112:127], v[124:127], v[100:103], a[112:127]
  ds_read_b64_tr_b16 v[70:71], v19 offset:2048
  s_add_u32 m0, s25, 1024
  s_nop 0
  buffer_load_dwordx4 v7, s[8:11], s21 offen lds
  v_mfma_f32_32x32x16_bf16 a[128:143], v[112:115], v[104:107], a[128:143]
  ds_read_b64_tr_b16 v[72:73], v20 offset:0
  v_mfma_f32_32x32x16_bf16 a[144:159], v[116:119], v[104:107], a[144:159]
  ds_read_b64_tr_b16 v[74:75], v20 offset:2048
  v_mfma_f32_32x32x16_bf16 a[160:175], v[120:123], v[104:107], a[160:175]
  ds_read_b64_tr_b16 v[76:77], v21 offset:0
  v_mfma_f32_32x32x16_bf16 a[176:191], v[124:127], v[104:107], a[176:191]
  ds_read_b64_tr_b16 v[78:79], v21 offset:2048
  s_add_u32 m0, s25, 2048
  s_nop 0
  buffer_load_dwordx4 v8, s[8:11], s21 offen lds
  v_mfma_f32_32x32x16_bf16 a[192:207], v[112:115], v[108:111], a[192:207]
  v_mfma_f32_32x32x16_bf16 a[208:223], v[116:119], v[108:111], a[208:223]
  v_mfma_f32_32x32x16_bf16 a[224:239], v[120:123], v[108:111], a[224:239]
  v_mfma_f32_32x32x16_bf16 a[240:255], v[124:127], v[108:111], a[240:255]
  s_add_u32 m0, s25, 3072
  s_nop 0
  buffer_load_dwordx4 v9, s[8:11], s21 offen lds
  s_add_u32 s20, s20, 64
  s_add_u32 s21, s21, s23
  s_waitcnt lgkmcnt(0)
  v_mfma_f32_32x32x16_bf16 a[0:15], v[80:83], v[64:67], a[0:15]
  ds_read_b64_tr_b16 v[96:97], v18 offset:8192
  v_mfma_f32_32x32x16_bf16 a[16:31], v[84:87], v[64:67], a[16:31]
  ds_read_b64_tr_b16 v[98:99], v18 offset:10240
  v_mfma_f32_32x32x16_bf16 a[32:47], v[88:91], v[64:67], a[32:47]
  ds_read_b128 v[112:115], v13 offset:0
  v_mfma_f32_32x32x16_bf16 a[48:63], v[92:95], v[64:67], a[48:63]
  ds_read_b128 v[116:119], v13 offset:2048
  s_add_u32 m0, s24, 32768
  s_nop 0
  buffer_load_dwordx4 v2, s[4:7], s20 offen lds
  v_mfma_f32_32x32x16_bf16 a[64:79], v[80:83], v[68:71], a[64:79]
  ds_read_b128 v[120:123], v13 offset:4096
  v_mfma_f32_32x32x16_bf16 a[80:95], v[84:87], v[68:71], a[80:95]
  ds_read_b128 v[124:127], v13 offset:6144
  v_mfma_f32_32x32x16_bf16 a[96:111], v[88:91], v[68:71], a[96:111]
  ds_read_b64_tr_b16 v[100:101], v19 offset:8192
  v_mfma_f32_32x32x16_bf16 a[112:127], v[92:95], v[68:71], a[112:127]
  ds_read_b64_tr_b16 v[102:103], v19 offset:10240
  s_add_u32 m0, s24, 33792
  s_nop 0
  buffer_load_dwordx4 v3, s[4:7], s20 offen lds
  v_mfma_f32_32x32x16_bf16 a[128:143], v[80:83], v[72:75], a[128:143]
  ds_read_b64_tr_b16 v[104:105], v20 offset:8192
  v_mfma_f32_32x32x16_bf16 a[144:159], v[84:87], v[72:75], a[144:159]
  ds_read_b64_tr_b16 v[106:107], v20 offset:10240
  v_mfma_f32_32x32x16_bf16 a[160:175], v[88:91], v[72:75], a[160:175]
  ds_read_b64_tr_b16 v[108:109], v21 offset:8192
  v_mfma_f32_32x32x16_bf16 a[176:191], v[92:95], v[72:75], a[176:191]
  ds_read_b64_tr_b16 v[110:111], v21 offset:10240
  s_add_u32 m0, s24, 34816
  s_nop 0
  buffer_load_dwordx4 v4, s[4:7], s20 offen lds
  v_mfma_f32_32x32x16_bf16 a[192:207], v[80:83], v[76:79], a[192:207]
  v_mfma_f32_32x32x16_bf16 a[208:223], v[84:87], v[76:79], a[208:223]
  v_mfma_f32_32x32x16_bf16 a[224:239], v[88:91], v[76:79], a[224:239]
  v_mfma_f32_32x32x16_bf16 a[240:255], v[92:95], v[76:79], a[240:255]
  s_add_u32 m0, s24, 35840
  s_nop 0
  buffer_load_dwordx4 v5, s[4:7], s20 offen lds
  s_waitcnt vmcnt(12) lgkmcnt(0)
  s_barrier
  v_mfma_f32_32x32x16_bf16 a[0:15], v[112:115], v[96:99], a[0:15]
  ds_read_b64_tr_b16 v[64:65], v18 offset:32768
  v_mfma_f32_32x32x16_bf16 a[16:31], v[116:119], v[96:99], a[16:31]
  ds_read_b64_tr_b16 v[66:67], v18 offset:34816
  v_mfma_f32_32x32x16_bf16 a[32:47], v[120:123], v[96:99], a[32:47]
  ds_read_b128 v[80:83], v12 offset:32768
  v_mfma_f32_32x32x16_bf16 a[48:63], v[124:127], v[96:99], a[48:63]
  ds_read_b128 v[84:87], v12 offset:34816
  s_add_u32 m0, s25, 32768
  s_nop 0
  buffer_load_dwordx4 v6, s[8:11], s21 offen lds
  v_mfma_f32_32x32x16_bf16 a[64:79], v[112:115], v[100:103], a[64:79]
  ds_read_b128 v[88:91], v12 offset:36864
  v_mfma_f32_32x32x16_bf16 a[80:95], v[116:119], v[100:103], a[80:95]
  ds_read_b128 v[92:95], v12 offset:38912
  v_mfma_f32_32x32x16_bf16 a[96:111], v[120:123], v[100:103], a[96:111]
  ds_read_b64_tr_b16 v[68:69], v19 offset:32768
  v_mfma_f32_32x32x16_bf16 a[112:127], v[124:127], v[100:103], a[112:127]
  ds_read_b64_tr_b16 v[70:71], v19 offset:34816
  s_add_u32 m0, s25, 33792
  s_nop 0
  buffer_load_dwordx4 v7, s[8:11], s21 offen lds
  v_mfma_f32_32x32x16_bf16 a[128:143], v[112:115], v[104:107], a[128:143]
  ds_read_b64_tr_b16 v[72:73], v20 offset:32768
  v_mfma_f32_32x32x16_bf16 a[144:159], v[116:119], v[104:107], a[144:159]
  ds_read_b64_tr_b16 v[74:75], v20 offset:34816
  v_mfma_f32_32x32x16_bf16 a[160:175], v[120:123], v[104:107], a[160:175]
  ds_read_b64_tr_b16 v[76:77], v21 offset:32768
  v_mfma_f32_32x32x16_bf16 a[176:191], v[124:127], v[104:107], a[176:191]
  ds_read_b64_tr_b16 v[78:79], v21 offset:34816
  s_add_u32 m0, s25, 34816
  s_nop 0
  buffer_load_dwordx4 v8, s[8:11], s21 offen lds
  v_mfma_f32_32x32x16_bf16 a[192:207], v[112:115], v[108:111], a[192:207]
  v_mfma_f32_32x32x16_bf16 a[208:223], v[116:119], v[108:111], a[208:223]
  v_mfma_f32_32x32x16_bf16 a[224:239], v[120:123], v[108:111], a[224:239]
  v_mfma_f32_32x32x16_bf16 a[240:255], v[124:127], v[108:111], a[240:255]
  s_add_u32 m0, s25, 35840
  s_nop 0
  buffer_load_dwordx4 v9, s[8:11], s21 offen lds
  s_add_u32 s20, s20, 64
  s_add_u32 s21, s21, s23
  s_waitcnt lgkmcnt(0)
  v_mfma_f32_32x32x16_bf16 a[0:15], v[80:83], v[64:67], a[0:15]
  ds_read_b64_tr_b16 v[96:97], v18 offset:40960
  v_mfma_f32_32x32x16_bf16 a[16:31], v[84:87], v[64:67], a[16:31]
  ds_read_b64_tr_b16 v[98:99], v18 offset:43008
  v_mfma_f32_32x32x16_bf16 a[32:47], v[88:91], v[64:67], a[32:47]
  ds_read_b128 v[112:115], v13 offset:32768
  v_mfma_f32_32x32x16_bf16 a[48:63], v[92:95], v[64:67], a[48:63]
  ds_read_b128 v[116:119], v13 offset:34816
  s_add_u32 m0, s24, 65536
  s_nop 0
  buffer_load_dwordx4 v2, s[4:7], s20 offen lds
  v_mfma_f32_32x32x16_bf16 a[64:79], v[80:83], v[68:71], a[64:79]
  ds_read_b128 v[120:123], v13 offset:36864
  v_mfma_f32_32x32x16_bf16 a[80:95], v[84:87], v[68:71], a[80:95]
  ds_read_b128 v[124:127], v13 offset:38912
  v_mfma_f32_32x32x16_bf16 a[96:111], v[88:91], v[68:71], a[96:111]
  ds_read_b64_tr_b16 v[100:101], v19 offset:40960
  v_mfma_f32_32x32x16_bf16 a[112:127], v[92:95], v[68:71], a[112:127]
  ds_read_b64_tr_b16 v[102:103], v19 offset:43008
  s_add_u32 m0, s24, 66560
  s_nop 0
  buffer_load_dwordx4 v3, s[4:7], s20 offen lds
  v_mfma_f32_32x32x16_bf16 a[128:143], v[80:83], v[72:75], a[128:143]
  ds_read_b64_tr_b16 v[104:105], v20 offset:40960
  v_mfma_f32_32x32x16_bf16 a[144:159], v[84:87], v[72:75], a[144:159]
  ds_read_b64_tr_b16 v[106:107], v20 offset:43008
  v_mfma_f32_32x32x16_bf16 a[160:175], v[88:91], v[72:75], a[160:175]
  ds_read_b64_tr_b16 v[108:109], v21 offset:40960
  v_mfma_f32_32x32x16_bf16 a[176:191], v[92:95], v[72:75], a[176:191]
  ds_read_b64_tr_b16 v[110:111], v21 offset:43008
  s_add_u32 m0, s24, 67584
  s_nop 0
  buffer_load_dwordx4 v4, s[4:7], s20 offen lds
  v_mfma_f32_32x32x16_bf16 a[192:207], v[80:83], v[76:79], a[192:207]
  v_mfma_f32_32x32x16_bf16 a[208:223], v[84:87], v[76:79], a[208:223]
  v_mfma_f32_32x32x16_bf16 a[224:239], v[88:91], v[76:79], a[224:239]
  v_mfma_f32_32x32x16_bf16 a[240:255], v[92:95], v[76:79], a[240:255]
  s_add_u32 m0, s24, 68608
  s_nop 0
  buffer_load_dwordx4 v5, s[4:7], s20 offen lds
  s_waitcnt vmcnt(12) lgkmcnt(0)
  s_barrier
  v_mfma_f32_32x32x16_bf16 a[0:15], v[112:115], v[96:99], a[0:15]
  ds_read_b64_tr_b16 v[64:65], v14 offset:0
  v_mfma_f32_32x32x16_bf16 a[16:31], v[116:119], v[96:99], a[16:31]
  ds_read_b64_tr_b16 v[66:67], v14 offset:2048
  v_mfma_f32_32x32x16_bf16 a[32:47], v[120:123], v[96:99], a[32:47]
  ds_read_b128 v[80:83], v10 offset:0
  v_mfma_f32_32x32x16_bf16 a[48:63], v[124:127], v[96:99], a[48:63]
  ds_read_b128 v[84:87], v10 offset:2048
  s_add_u32 m0, s25, 65536
  s_nop 0
  buffer_load_dwordx4 v6, s[8:11], s21 offen lds
  v_mfma_f32_32x32x16_bf16 a[64:79], v[112:115], v[100:103], a[64:79]
  ds_read_b128 v[88:91], v10 offset:4096
  v_mfma_f32_32x32x16_bf16 a[80:95], v[116:119], v[100:103], a[80:95]
  ds_read_b128 v[92:95], v10 offset:6144
  v_mfma_f32_32x32x16_bf16 a[96:111], v[120:123], v[100:103], a[96:111]
  ds_read_b64_tr_b16 v[68:69], v15 offset:0
  v_mfma_f32_32x32x16_bf16 a[112:127], v[124:127], v[100:103], a[112:127]
  ds_read_b64_tr_b16 v[70:71], v15 offset:2048
  s_add_u32 m0, s25, 66560
  s_nop 0
  buffer_load_dwordx4 v7, s[8:11], s21 offen lds
  v_mfma_f32_32x32x16_bf16 a[128:143], v[112:115], v[104:107], a[128:143]
  ds_read_b64_tr_b16 v[72:73], v16 offset:0
  v_mfma_f32_32x32x16_bf16 a[144:159], v[116:119], v[104:107], a[144:159]
  ds_read_b64_tr_b16 v[74:75], v16 offset:2048
  v_mfma_f32_32x32x16_bf16 a[160:175], v[120:123], v[104:107], a[160:175]
  ds_read_b64_tr_b16 v[76:77], v17 offset:0
  v_mfma_f32_32x32x16_bf16 a[176:191], v[124:127], v[104:107], a[176:191]
  ds_read_b64_tr_b16 v[78:79], v17 offset:2048
  s_add_u32 m0, s25, 67584
  s_nop 0
  buffer_load_dwordx4 v8, s[8:11], s21 offen lds
  v_mfma_f32_32x32x16_bf16 a[192:207], v[112:115], v[108:111], a[192:207]
  v_mfma_f32_32x32x16_bf16 a[208:223], v[116:119], v[108:111], a[208:223]
  v_mfma_f32_32x32x16_bf16 a[224:239], v[120:123], v[108:111], a[224:239]
  v_mfma_f32_32x32x16_bf16 a[240:255], v[124:127], v[108:111], a[240:255]
  s_add_u32 m0, s25, 68608
  s_nop 0
  buffer_load_dwordx4 v9, s[8:11], s21 offen lds
  s_add_u32 s20, s20, 64
  s_add_u32 s21, s21, s23
  s_waitcnt lgkmcnt(0)
  v_mfma_f32_32x32x16_bf16 a[0:15], v[80:83], v[64:67], a[0:15]
  ds_read_b64_tr_b16 v[96:97], v14 offset:8192
  v_mfma_f32_32x32x16_bf16 a[16:31], v[84:87], v[64:67], a[16:31]
  ds_read_b64_tr_b16 v[98:99], v14 offset:10240
  v_mfma_f32_32x32x16_bf16 a[32:47], v[88:91], v[64:67], a[32:47]
  ds_read_b128 v[112:115], v11 offset:0
  v_mfma_f32_32x32x16_bf16 a[48:63], v[92:95], v[64:67], a[48:63]
  ds_read_b128 v[116:119], v11 offset:2048
  s_add_u32 m0, s24, 98304
  s_nop 0
  buffer_load_dwordx4 v2, s[4:7], s20 offen lds
  v_mfma_f32_32x32x16_bf16 a[64:79], v[80:83], v[68:71], a[64:79]
  ds_read_b128 v[120:123], v11 offset:4096
  v_mfma_f32_32x32x16_bf16 a[80:95], v[84:87], v[68:71], a[80:95]
  ds_read_b128 v[124:127], v11 offset:6144
  v_mfma_f32_32x32x16_bf16 a[96:111], v[88:91], v[68:71], a[96:111]
  ds_read_b64_tr_b16 v[100:101], v15 offset:8192
  v_mfma_f32_32x32x16_bf16 a[112:127], v[92:95], v[68:71], a[112:127]
  ds_read_b64_tr_b16 v[102:103], v15 offset:10240
  s_add_u32 m0, s24, 99328
  s_nop 0
  buffer_load_dwordx4 v3, s[4:7], s20 offen lds
  v_mfma_f32_32x32x16_bf16 a[128:143], v[80:83], v[72:75], a[128:143]
  ds_read_b64_tr_b16 v[104:105], v16 offset:8192
  v_mfma_f32_32x32x16_bf16 a[144:159], v[84:87], v[72:75], a[144:159]
  ds_read_b64_tr_b16 v[106:107], v16 offset:10240
  v_mfma_f32_32x32x16_bf16 a[160:175], v[88:91], v[72:75], a[160:175]
  ds_read_b64_tr_b16 v[108:109], v17 offset:8192
  v_mfma_f32_32x32x16_bf16 a[176:191], v[92:95], v[72:75], a[176:191]
  ds_read_b64_tr_b16 v[110:111], v17 offset:10240
  s_add_u32 m0, s24, 100352
  s_nop 0
  buffer_load_dwordx4 v4, s[4:7], s20 offen lds
  v_mfma_f32_32x32x16_bf16 a[192:207], v[80:83], v[76:79], a[192:207]
  v_mfma_f32_32x32x16_bf16 a[208:223], v[84:87], v[76:79], a[208:223]
  v_mfma_f32_32x32x16_bf16 a[224:239], v[88:91], v[76:79], a[224:239]
  v_mfma_f32_32x32x16_bf16 a[240:255], v[92:95], v[76:79], a[240:255]
  s_add_u32 m0, s24, 101376
  s_nop 0
  buffer_load_dwordx4 v5, s[4:7], s20 offen lds
  s_waitcnt vmcnt(12) lgkmcnt(0)
  s_barrier
  v_mfma_f32_32x32x16_bf16 a[0:15], v[112:115], v[96:99], a[0:15]
  ds_read_b64_tr_b16 v[64:65], v14 offset:32768
  v_mfma_f32_32x32x16_bf16 a[16:31], v[116:119], v[96:99], a[16:31]
  ds_read_b64_tr_b16 v[66:67], v14 offset:34816
  v_mfma_f32_32x32x16_bf16 a[32:47], v[120:123], v[96:99], a[32:47]
  ds_read_b128 v[80:83], v10 offset:32768
  v_mfma_f32_32x32x16_bf16 a[48:63], v[124:127], v[96:99], a[48:63]
  ds_read_b128 v[84:87], v10 offset:34816
  s_add_u32 m0, s25, 98304
  s_nop 0
  buffer_load_dwordx4 v6, s[8:11], s21 offen lds
  v_mfma_f32_32x32x16_bf16 a[64:79], v[112:115], v[100:103], a[64:79]
  ds_read_b128 v[88:91], v10 offset:36864
  v_mfma_f32_32x32x16_bf16 a[80:95], v[116:119], v[100:103], a[80:95]
  ds_read_b128 v[92:95], v10 offset:38912
  v_mfma_f32_32x32x16_bf16 a[96:111], v[120:123], v[100:103], a[96:111]
  ds_read_b64_tr_b16 v[68:69], v15 offset:32768
  v_mfma_f32_32x32x16_bf16 a[112:127], v[124:127], v[100:103], a[112:127]
  ds_read_b64_tr_b16 v[70:71], v15 offset:34816
  s_add_u32 m0, s25, 99328
  s_nop 0
  buffer_load_dwordx4 v7, s[8:11], s21 offen lds
  v_mfma_f32_32x32x16_bf16 a[128:143], v[112:115], v[104:107], a[128:143]
  ds_read_b64_tr_b16 v[72:73], v16 offset:32768
  v_mfma_f32_32x32x16_bf16 a[144:159], v[116:119], v[104:107], a[144:159]
  ds_read_b64_tr_b16 v[74:75], v16 offset:34816
  v_mfma_f32_32x32x16_bf16 a[160:175], v[120:123], v[104:107], a[160:175]
  ds_read_b64_tr_b16 v[76:77], v17 offset:32768
  v_mfma_f32_32x32x16_bf16 a[176:191], v[124:127], v[104:107], a[176:191]
  ds_read_b64_tr_b16 v[78:79], v17 offset:34816
  s_add_u32 m0, s25, 100352
  s_nop 0
  buffer_load_dwordx4 v8, s[8:11], s21 offen lds
  v_mfma_f32_32x32x16_bf16 a[192:207], v[112:115], v[108:111], a[192:207]
  v_mfma_f32_32x32x16_bf16 a[208:223], v[116:119], v[108:111], a[208:223]
  v_mfma_f32_32x32x16_bf16 a[224:239], v[120:123], v[108:111], a[224:239]
  v_mfma_f32_32x32x16_bf16 a[240:255], v[124:127], v[108:111], a[240:255]
  s_add_u32 m0, s25, 101376
  s_nop 0
  buffer_load_dwordx4 v9, s[8:11], s21 offen lds
  s_add_u32 s20, s20, 64
  s_add_u32 s21, s21, s23
  s_waitcnt lgkmcnt(0)
  v_mfma_f32_32x32x16_bf16 a[0:15], v[80:83], v[64:67], a[0:15]
  ds_read_b64_tr_b16 v[96:97], v14 offset:40960
  v_mfma_f32_32x32x16_bf16 a[16:31], v[84:87], v[64:67], a[16:31]
  ds_read_b64_tr_b16 v[98:99], v14 offset:43008
  v_mfma_f32_32x32x16_bf16 a[32:47], v[88:91], v[64:67], a[32:47]
  ds_read_b128 v[112:115], v11 offset:32768
  v_mfma_f32_32x32x16_bf16 a[48:63], v[92:95], v[64:67], a[48:63]
  ds_read_b128 v[116:119], v11 offset:34816
  s_add_u32 m0, s24, 0
  s_nop 0
  buffer_load_dwordx4 v2, s[4:7], s20 offen lds
  v_mfma_f32_32x32x16_bf16 a[64:79], v[80:83], v[68:71], a[64:79]
  ds_read_b128 v[120:123], v11 offset:36864
  v_mfma_f32_32x32x16_bf16 a[80:95], v[84:87], v[68:71], a[80:95]
  ds_read_b128 v[124:127], v11 offset:38912
  v_mfma_f32_32x32x16_bf16 a[96:111], v[88:91], v[68:71], a[96:111]
  ds_read_b64_tr_b16 v[100:101], v15 offset:40960
  v_mfma_f32_32x32x16_bf16 a[112:127], v[92:95], v[68:71], a[112:127]
  ds_read_b64_tr_b16 v[102:103], v15 offset:43008
  s_add_u32 m0, s24, 1024
  s_nop 0
  buffer_load_dwordx4 v3, s[4:7], s20 offen lds
  v_mfma_f32_32x32x16_bf16 a[128:143], v[80:83], v[72:75], a[128:143]
  ds_read_b64_tr_b16 v[104:105], v16 offset:40960
  v_mfma_f32_32x32x16_bf16 a[144:159], v[84:87], v[72:75], a[144:159]
  ds_read_b64_tr_b16 v[106:107], v16 offset:43008
  v_mfma_f32_32x32x16_bf16 a[160:175], v[88:91], v[72:75], a[160:175]
  ds_read_b64_tr_b16 v[108:109], v17 offset:40960
  v_mfma_f32_32x32x16_bf16 a[176:191], v[92:95], v[72:75], a[176:191]
  ds_read_b64_tr_b16 v[110:111], v17 offset:43008
  s_add_u32 m0, s24, 2048
  s_nop 0
  buffer_load_dwordx4 v4, s[4:7], s20 offen lds
  v_mfma_f32_32x32x16_bf16 a[192:207], v[80:83], v[76:79], a[192:207]
  v_mfma_f32_32x32x16_bf16 a[208:223], v[84:87], v[76:79], a[208:223]
  v_mfma_f32_32x32x16_bf16 a[224:239], v[88:91], v[76:79], a[224:239]
  v_mfma_f32_32x32x16_bf16 a[240:255], v[92:95], v[76:79], a[240:255]
  s_add_u32 m0, s24, 3072
  s_nop 0
  buffer_load_dwordx4 v5, s[4:7], s20 offen lds
  s_waitcnt vmcnt(12) lgkmcnt(0)
  s_barrier
  v_mfma_f32_32x32x16_bf16 a[0:15], v[112:115], v[96:99], a[0:15]
  ds_read_b64_tr_b16 v[64:65], v18 offset:0
  v_mfma_f32_32x32x16_bf16 a[16:31], v[116:119], v[96:99], a[16:31]
  ds_read_b64_tr_b16 v[66:67], v18 offset:2048
  v_mfma_f32_32x32x16_bf16 a[32:47], v[120:123], v[96:99], a[32:47]
  ds_read_b128 v[80:83], v12 offset:0
  v_mfma_f32_32x32x16_bf16 a[48:63], v[124:127], v[96:99], a[48:63]
  ds_read_b128 v[84:87], v12 offset:2048
  s_add_u32 m0, s25, 0
  s_nop 0
  buffer_load_dwordx4 v6, s[8:11], s21 offen lds
  v_mfma_f32_32x32x16_bf16 a[64:79], v[112:115], v[100:103], a[64:79]
  ds_read_b128 v[88:91], v12 offset:4096
  v_mfma_f32_32x32x16_bf16 a[80:95], v[116:119], v[100:103], a[80:95]
  ds_read_b128 v[92:95], v12 offset:6144
  v_mfma_f32_32x32x16_bf16 a[96:111], v[120:123], v[100:103], a[96:111]
  ds_read_b64_tr_b16 v[68:69], v19 offset:0
  v_mfma_f32_32x32x16_bf16 a[112:127], v[124:127], v[100:103], a[112:127]
  ds_read_b64_tr_b16 v[70:71], v19 offset:2048
  s_add_u32 m0, s25, 1024
  s_nop 0
  buffer_load_dwordx4 v7, s[8:11], s21 offen lds
  v_mfma_f32_32x32x16_bf16 a[128:143], v[112:115], v[104:107], a[128:143]
  ds_read_b64_tr_b16 v[72:73], v20 offset:0
  v_mfma_f32_32x32x16_bf16 a[144:159], v[116:119], v[104:107], a[144:159]
  ds_read_b64_tr_b16 v[74:75], v20 offset:2048
  v_mfma_f32_32x32x16_bf16 a[160:175], v[120:123], v[104:107], a[160:175]
  ds_read_b64_tr_b16 v[76:77], v21 offset:0
  v_mfma_f32_32x32x16_bf16 a[176:191], v[124:127], v[104:107], a[176:191]
  ds_read_b64_tr_b16 v[78:79], v21 offset:2048
  s_add_u32 m0, s25, 2048
  s_nop 0
  buffer_load_dwordx4 v8, s[8:11], s21 offen lds
  v_mfma_f32_32x32x16_bf16 a[192:207], v[112:115], v[108:111], a[192:207]
  v_mfma_f32_32x32x16_bf16 a[208:223], v[116:119], v[108:111], a[208:223]
  v_mfma_f32_32x32x16_bf16 a[224:239], v[120:123], v[108:111], a[224:239]
  v_mfma_f32_32x32x16_bf16 a[240:255], v[124:127], v[108:111], a[240:255]
  s_add_u32 m0, s25, 3072
  s_nop 0
  buffer_load_dwordx4 v9, s[8:11], s21 offen lds
  s_add_u32 s20, s20, 64
  s_add_u32 s21, s21, s23
  s_waitcnt lgkmcnt(0)
  v_mfma_f32_32x32x16_bf16 a[0:15], v[80:83], v[64:67], a[0:15]
  ds_read_b64_tr_b16 v[96:97], v18 offset:8192
  v_mfma_f32_32x32x16_bf16 a[16:31], v[84:87], v[64:67], a[16:31]
  ds_read_b64_tr_b16 v[98:99], v18 offset:10240
  v_mfma_f32_32x32x16_bf16 a[32:47], v[88:91], v[64:67], a[32:47]
  ds_read_b128 v[112:115], v13 offset:0
  v_mfma_f32_32x32x16_bf16 a[48:63], v[92:95], v[64:67], a[48:63]
  ds_read_b128 v[116:119], v13 offset:2048
  s_add_u32 m0, s24, 32768
  s_nop 0
  buffer_load_dwordx4 v2, s[4:7], s20 offen lds
  v_mfma_f32_32x32x16_bf16 a[64:79], v[80:83], v[68:71], a[64:79]
  ds_read_b128 v[120:123], v13 offset:4096
  v_mfma_f32_32x32x16_bf16 a[80:95], v[84:87], v[68:71], a[80:95]
  ds_read_b128 v[124:127], v13 offset:6144
  v_mfma_f32_32x32x16_bf16 a[96:111], v[88:91], v[68:71], a[96:111]
  ds_read_b64_tr_b16 v[100:101], v19 offset:8192
  v_mfma_f32_32x32x16_bf16 a[112:127], v[92:95], v[68:71], a[112:127]
  ds_read_b64_tr_b16 v[102:103], v19 offset:10240
  s_add_u32 m0, s24, 33792
  s_nop 0
  buffer_load_dwordx4 v3, s[4:7], s20 offen lds
  v_mfma_f32_32x32x16_bf16 a[128:143], v[80:83], v[72:75], a[128:143]
  ds_read_b64_tr_b16 v[104:105], v20 offset:8192
  v_mfma_f32_32x32x16_bf16 a[144:159], v[84:87], v[72:75], a[144:159]
  ds_read_b64_tr_b16 v[106:107], v20 offset:10240
  v_mfma_f32_32x32x16_bf16 a[160:175], v[88:91], v[72:75], a[160:175]
  ds_read_b64_tr_b16 v[108:109], v21 offset:8192
  v_mfma_f32_32x32x16_bf16 a[176:191], v[92:95], v[72:75], a[176:191]
  ds_read_b64_tr_b16 v[110:111], v21 offset:10240
  s_add_u32 m0, s24, 34816
  s_nop 0
  buffer_load_dwordx4 v4, s[4:7], s20 offen lds
  v_mfma_f32_32x32x16_bf16 a[192:207], v[80:83], v[76:79], a[192:207]
  v_mfma_f32_32x32x16_bf16 a[208:223], v[84:87], v[76:79], a[208:223]
  v_mfma_f32_32x32x16_bf16 a[224:239], v[88:91], v[76:79], a[224:239]
  v_mfma_f32_32x32x16_bf16 a[240:255], v[92:95], v[76:79], a[240:255]
  s_add_u32 m0, s24, 35840
  s_nop 0
  buffer_load_dwordx4 v5, s[4:7], s20 offen lds
  s_waitcnt vmcnt(12) lgkmcnt(0)
  s_barrier
  v_mfma_f32_32x32x16_bf16 a[0:15], v[112:115], v[96:99], a[0:15]
  ds_read_b64_tr_b16 v[64:65], v18 offset:32768
  v_mfma_f32_32x32x16_bf16 a[16:31], v[116:119], v[96:99], a[16:31]
  ds_read_b64_tr_b16 v[66:67], v18 offset:34816
  v_mfma_f32_32x32x16_bf16 a[32:47], v[120:123], v[96:99], a[32:47]
  ds_read_b128 v[80:83], v12 offset:32768
  v_mfma_f32_32x32x16_bf16 a[48:63], v[124:127], v[96:99], a[48:63]
  ds_read_b128 v[84:87], v12 offset:34816
  s_add_u32 m0, s25, 32768
  s_nop 0
  buffer_load_dwordx4 v6, s[8:11], s21 offen lds
  v_mfma_f32_32x32x16_bf16 a[64:79], v[112:115], v[100:103], a[64:79]
  ds_read_b128 v[88:91], v12 offset:36864
  v_mfma_f32_32x32x16_bf16 a[80:95], v[116:119], v[100:103], a[80:95]
  ds_read_b128 v[92:95], v12 offset:38912
  v_mfma_f32_32x32x16_bf16 a[96:111], v[120:123], v[100:103], a[96:111]
  ds_read_b64_tr_b16 v[68:69], v19 offset:32768
  v_mfma_f32_32x32x16_bf16 a[112:127], v[124:127], v[100:103], a[112:127]
  ds_read_b64_tr_b16 v[70:71], v19 offset:34816
  s_add_u32 m0, s25, 33792
  s_nop 0
  buffer_load_dwordx4 v7, s[8:11], s21 offen lds
  v_mfma_f32_32x32x16_bf16 a[128:143], v[112:115], v[104:107], a[128:143]
  ds_read_b64_tr_b16 v[72:73], v20 offset:32768
  v_mfma_f32_32x32x16_bf16 a[144:159], v[116:119], v[104:107], a[144:159]
  ds_read_b64_tr_b16 v[74:75], v20 offset:34816
  v_mfma_f32_32x32x16_bf16 a[160:175], v[120:123], v[104:107], a[160:175]
  ds_read_b64_tr_b16 v[76:77], v21 offset:32768
  v_mfma_f32_32x32x16_bf16 a[176:191], v[124:127], v[104:107], a[176:191]
  ds_read_b64_tr_b16 v[78:79], v21 offset:34816
  s_add_u32 m0, s25, 34816
  s_nop 0
  buffer_load_dwordx4 v8, s[8:11], s21 offen lds
  v_mfma_f32_32x32x16_bf16 a[192:207], v[112:115], v[108:111], a[192:207]
  v_mfma_f32_32x32x16_bf16 a[208:223], v[116:119], v[108:111], a[208:223]
  v_mfma_f32_32x32x16_bf16 a[224:239], v[120:123], v[108:111], a[224:239]
  v_mfma_f32_32x32x16_bf16 a[240:255], v[124:127], v[108:111], a[240:255]
  s_add_u32 m0, s25, 35840
  s_nop 0
  buffer_load_dwordx4 v9, s[8:11], s21 offen lds
  s_add_u32 s20, s20, 64
  s_add_u32 s21, s21, s23
  s_waitcnt lgkmcnt(0)
  v_mfma_f32_32x32x16_bf16 a[0:15], v[80:83], v[64:67], a[0:15]
  ds_read_b64_tr_b16 v[96:97], v18 offset:40960
  v_mfma_f32_32x32x16_bf16 a[16:31], v[84:87], v[64:67], a[16:31]
  ds_read_b64_tr_b16 v[98:99], v18 offset:43008
  v_mfma_f32_32x32x16_bf16 a[32:47], v[88:91], v[64:67], a[32:47]
  ds_read_b128 v[112:115], v13 offset:32768
  v_mfma_f32_32x32x16_bf16 a[48:63], v[92:95], v[64:67], a[48:63]
  ds_read_b128 v[116:119], v13 offset:34816
  s_add_u32 m0, s24, 65536
  s_nop 0
  buffer_load_dwordx4 v2, s[4:7], s20 offen lds
  v_mfma_f32_32x32x16_bf16 a[64:79], v[80:83], v[68:71], a[64:79]
  ds_read_b128 v[120:123], v13 offset:36864
  v_mfma_f32_32x32x16_bf16 a[80:95], v[84:87], v[68:71], a[80:95]
  ds_read_b128 v[124:127], v13 offset:38912
  v_mfma_f32_32x32x16_bf16 a[96:111], v[88:91], v[68:71], a[96:111]
  ds_read_b64_tr_b16 v[100:101], v19 offset:40960
  v_mfma_f32_32x32x16_bf16 a[112:127], v[92:95], v[68:71], a[112:127]
  ds_read_b64_tr_b16 v[102:103], v19 offset:43008
  s_add_u32 m0, s24, 66560
  s_nop 0
  buffer_load_dwordx4 v3, s[4:7], s20 offen lds
  v_mfma_f32_32x32x16_bf16 a[128:143], v[80:83], v[72:75], a[128:143]
  ds_read_b64_tr_b16 v[104:105], v20 offset:40960
  v_mfma_f32_32x32x16_bf16 a[144:159], v[84:87], v[72:75], a[144:159]
  ds_read_b64_tr_b16 v[106:107], v20 offset:43008
  v_mfma_f32_32x32x16_bf16 a[160:175], v[88:91], v[72:75], a[160:175]
  ds_read_b64_tr_b16 v[108:109], v21 offset:40960
  v_mfma_f32_32x32x16_bf16 a[176:191], v[92:95], v[72:75], a[176:191]
  ds_read_b64_tr_b16 v[110:111], v21 offset:43008
  s_add_u32 m0, s24, 67584
  s_nop 0
  buffer_load_dwordx4 v4, s[4:7], s20 offen lds
  v_mfma_f32_32x32x16_bf16 a[192:207], v[80:83], v[76:79], a[192:207]
  v_mfma_f32_32x32x16_bf16 a[208:223], v[84:87], v[76:79], a[208:223]
  v_mfma_f32_32x32x16_bf16 a[224:239], v[88:91], v[76:79], a[224:239]
  v_mfma_f32_32x32x16_bf16 a[240:255], v[92:95], v[76:79], a[240:255]
  s_add_u32 m0, s24, 68608
  s_nop 0
  buffer_load_dwordx4 v5, s[4:7], s20 offen lds
  s_waitcnt vmcnt(12) lgkmcnt(0)
  s_barrier
  v_mfma_f32_32x32x16_bf16 a[0:15], v[112:115], v[96:99], a[0:15]
  ds_read_b64_tr_b16 v[64:65], v14 offset:0
  v_mfma_f32_32x32x16_bf16 a[16:31], v[116:119], v[96:99], a[16:31]
  ds_read_b64_tr_b16 v[66:67], v14 offset:2048
  v_mfma_f32_32x32x16_bf16 a[32:47], v[120:123], v[96:99], a[32:47]
  ds_read_b128 v[80:83], v10 offset:0
  v_mfma_f32_32x32x16_bf16 a[48:63], v[124:127], v[96:99], a[48:63]
  ds_read_b128 v[84:87], v10 offset:2048
  s_add_u32 m0, s25, 65536
  s_nop 0
  buffer_load_dwordx4 v6, s[8:11], s21 offen lds
  v_mfma_f32_32x32x16_bf16 a[64:79], v[112:115], v[100:103], a[64:79]
  ds_read_b128 v[88:91], v10 offset:4096
  v_mfma_f32_32x32x16_bf16 a[80:95], v[116:119], v[100:103], a[80:95]
  ds_read_b128 v[92:95], v10 offset:6144
  v_mfma_f32_32x32x16_bf16 a[96:111], v[120:123], v[100:103], a[96:111]
  ds_read_b64_tr_b16 v[68:69], v15 offset:0
  v_mfma_f32_32x32x16_bf16 a[112:127], v[124:127], v[100:103], a[112:127]
  ds_read_b64_tr_b16 v[70:71], v15 offset:2048
  s_add_u32 m0, s25, 66560
  s_nop 0
  buffer_load_dwordx4 v7, s[8:11], s21 offen lds
  v_mfma_f32_32x32x16_bf16 a[128:143], v[112:115], v[104:107], a[128:143]
  ds_read_b64_tr_b16 v[72:73], v16 offset:0
  v_mfma_f32_32x32x16_bf16 a[144:159], v[116:119], v[104:107], a[144:159]
  ds_read_b64_tr_b16 v[74:75], v16 offset:2048
  v_mfma_f32_32x32x16_bf16 a[160:175], v[120:123], v[104:107], a[160:175]
  ds_read_b64_tr_b16 v[76:77], v17 offset:0
  v_mfma_f32_32x32x16_bf16 a[176:191], v[124:127], v[104:107], a[176:191]
  ds_read_b64_tr_b16 v[78:79], v17 offset:2048
  s_add_u32 m0, s25, 67584
  s_nop 0
  buffer_load_dwordx4 v8, s[8:11], s21 offen lds
  v_mfma_f32_32x32x16_bf16 a[192:207], v[112:115], v[108:111], a[192:207]
  v_mfma_f32_32x32x16_bf16 a[208:223], v[116:119], v[108:111], a[208:223]
  v_mfma_f32_32x32x16_bf16 a[224:239], v[120:123], v[108:111], a[224:239]
  v_mfma_f32_32x32x16_bf16 a[240:255], v[124:127], v[108:111], a[240:255]
  s_add_u32 m0, s25, 68608
  s_nop 0
  buffer_load_dwordx4 v9, s[8:11], s21 offen lds
  s_add_u32 s20, s20, 64
  s_add_u32 s21, s21, s23
  s_waitcnt lgkmcnt(0)
  v_mfma_f32_32x32x16_bf16 a[0:15], v[80:83], v[64:67], a[0:15]
  ds_read_b64_tr_b16 v[96:97], v14 offset:8192
  v_mfma_f32_32x32x16_bf16 a[16:31], v[84:87], v[64:67], a[16:31]
  ds_read_b64_tr_b16 v[98:99], v14 offset:10240
  v_mfma_f32_32x32x16_bf16 a[32:47], v[88:91], v[64:67], a[32:47]
  ds_read_b128 v[112:115], v11 offset:0
  v_mfma_f32_32x32x16_bf16 a[48:63], v[92:95], v[64:67], a[48:63]
  ds_read_b128 v[116:119], v11 offset:2048
  s_add_u32 m0, s24, 98304
  s_nop 0
  buffer_load_dwordx4 v2, s[4:7], s20 offen lds
  v_mfma_f32_32x32x16_bf16 a[64:79], v[80:83], v[68:71], a[64:79]
  ds_read_b128 v[120:123], v11 offset:4096
  v_mfma_f32_32x32x16_bf16 a[80:95], v[84:87], v[68:71], a[80:95]
  ds_read_b128 v[124:127], v11 offset:6144
  v_mfma_f32_32x32x16_bf16 a[96:111], v[88:91], v[68:71], a[96:111]
  ds_read_b64_tr_b16 v[100:101], v15 offset:8192
  v_mfma_f32_32x32x16_bf16 a[112:127], v[92:95], v[68:71], a[112:127]
  ds_read_b64_tr_b16 v[102:103], v15 offset:10240
  s_add_u32 m0, s24, 99328
  s_nop 0
  buffer_load_dwordx4 v3, s[4:7], s20 offen lds
  v_mfma_f32_32x32x16_bf16 a[128:143], v[80:83], v[72:75], a[128:143]
  ds_read_b64_tr_b16 v[104:105], v16 offset:8192
  v_mfma_f32_32x32x16_bf16 a[144:159], v[84:87], v[72:75], a[144:159]
  ds_read_b64_tr_b16 v[106:107], v16 offset:10240
  v_mfma_f32_32x32x16_bf16 a[160:175], v[88:91], v[72:75], a[160:175]
  ds_read_b64_tr_b16 v[108:109], v17 offset:8192
  v_mfma_f32_32x32x16_bf16 a[176:191], v[92:95], v[72:75], a[176:191]
  ds_read_b64_tr_b16 v[110:111], v17 offset:10240
  s_add_u32 m0, s24, 100352
  s_nop 0
  buffer_load_dwordx4 v4, s[4:7], s20 offen lds
  v_mfma_f32_32x32x16_bf16 a[192:207], v[80:83], v[76:79], a[192:207]
  v_mfma_f32_32x32x16_bf16 a[208:223], v[84:87], v[76:79], a[208:223]
  v_mfma_f32_32x32x16_bf16 a[224:239], v[88:91], v[76:79], a[224:239]
  v_mfma_f32_32x32x16_bf16 a[240:255], v[92:95], v[76:79], a[240:255]
  s_add_u32 m0, s24, 101376
  s_nop 0
  buffer_load_dwordx4 v5, s[4:7], s20 offen lds
  s_waitcnt vmcnt(12) lgkmcnt(0)
  s_barrier
  v_mfma_f32_32x32x16_bf16 a[0:15], v[112:115], v[96:99], a[0:15]
  ds_read_b64_tr_b16 v[64:65], v14 offset:32768
  v_mfma_f32_32x32x16_bf16 a[16:31], v[116:119], v[96:99], a[16:31]
  ds_read_b64_tr_b16 v[66:67], v14 offset:34816
  v_mfma_f32_32x32x16_bf16 a[32:47], v[120:123], v[96:99], a[32:47]
  ds_read_b128 v[80:83], v10 offset:32768
  v_mfma_f32_32x32x16_bf16 a[48:63], v[124:127], v[96:99], a[48:63]
  ds_read_b128 v[84:87], v10 offset:34816
  s_add_u32 m0, s25, 98304
  s_nop 0
  buffer_load_dwordx4 v6, s[8:11], s21 offen lds
  v_mfma_f32_32x32x16_bf16 a[64:79], v[112:115], v[100:103], a[64:79]
  ds_read_b128 v[88:91], v10 offset:36864
  v_mfma_f32_32x32x16_bf16 a[80:95], v[116:119], v[100:103], a[80:95]
  ds_read_b128 v[92:95], v10 offset:38912
  v_mfma_f32_32x32x16_bf16 a[96:111], v[120:123], v[100:103], a[96:111]
  ds_read_b64_tr_b16 v[68:69], v15 offset:32768
  v_mfma_f32_32x32x16_bf16 a[112:127], v[124:127], v[100:103], a[112:127]
  ds_read_b64_tr_b16 v[70:71], v15 offset:34816
  s_add_u32 m0, s25, 99328
  s_nop 0
  buffer_load_dwordx4 v7, s[8:11], s21 offen lds
  v_mfma_f32_32x32x16_bf16 a[128:143], v[112:115], v[104:107], a[128:143]
  ds_read_b64_tr_b16 v[72:73], v16 offset:32768
  v_mfma_f32_32x32x16_bf16 a[144:159], v[116:119], v[104:107], a[144:159]
  ds_read_b64_tr_b16 v[74:75], v16 offset:34816
  v_mfma_f32_32x32x16_bf16 a[160:175], v[120:123], v[104:107], a[160:175]
  ds_read_b64_tr_b16 v[76:77], v17 offset:32768
  v_mfma_f32_32x32x16_bf16 a[176:191], v[124:127], v[104:107], a[176:191]
  ds_read_b64_tr_b16 v[78:79], v17 offset:34816
  s_add_u32 m0, s25, 100352
  s_nop 0
  buffer_load_dwordx4 v8, s[8:11], s21 offen lds
  v_mfma_f32_32x32x16_bf16 a[192:207], v[112:115], v[108:111], a[192:207]
  v_mfma_f32_32x32x16_bf16 a[208:223], v[116:119], v[108:111], a[208:223]
  v_mfma_f32_32x32x16_bf16 a[224:239], v[120:123], v[108:111], a[224:239]
  v_mfma_f32_32x32x16_bf16 a[240:255], v[124:127], v[108:111], a[240:255]
  s_add_u32 m0, s25, 101376
  s_nop 0
  buffer_load_dwordx4 v9, s[8:11], s21 offen lds
  s_add_u32 s20, s20, 64
  s_add_u32 s21, s21, s23
  s_waitcnt lgkmcnt(0)
  v_mfma_f32_32x32x16_bf16 a[0:15], v[80:83], v[64:67], a[0:15]
  ds_read_b64_tr_b16 v[96:97], v14 offset:40960
  v_mfma_f32_32x32x16_bf16 a[16:31], v[84:87], v[64:67], a[16:31]
  ds_read_b64_tr_b16 v[98:99], v14 offset:43008
  v_mfma_f32_32x32x16_bf16 a[32:47], v[88:91], v[64:67], a[32:47]
  ds_read_b128 v[112:115], v11 offset:32768
  v_mfma_f32_32x32x16_bf16 a[48:63], v[92:95], v[64:67], a[48:63]
  ds_read_b128 v[116:119], v11 offset:34816
  s_add_u32 m0, s24, 0
  s_nop 0
  buffer_load_dwordx4 v2, s[4:7], s20 offen lds
  v_mfma_f32_32x32x16_bf16 a[64:79], v[80:83], v[68:71], a[64:79]
  ds_read_b128 v[120:123], v11 offset:36864
  v_mfma_f32_32x32x16_bf16 a[80:95], v[84:87], v[68:71], a[80:95]
  ds_read_b128 v[124:127], v11 offset:38912
  v_mfma_f32_32x32x16_bf16 a[96:111], v[88:91], v[68:71], a[96:111]
  ds_read_b64_tr_b16 v[100:101], v15 offset:40960
  v_mfma_f32_32x32x16_bf16 a[112:127], v[92:95], v[68:71], a[112:127]
  ds_read_b64_tr_b16 v[102:103], v15 offset:43008
  s_add_u32 m0, s24, 1024
  s_nop 0
  buffer_load_dwordx4 v3, s[4:7], s20 offen lds
  v_mfma_f32_32x32x16_bf16 a[128:143], v[80:83], v[72:75], a[128:143]
  ds_read_b64_tr_b16 v[104:105], v16 offset:40960
  v_mfma_f32_32x32x16_bf16 a[144:159], v[84:87], v[72:75], a[144:159]
  ds_read_b64_tr_b16 v[106:107], v16 offset:43008
  v_mfma_f32_32x32x16_bf16 a[160:175], v[88:91], v[72:75], a[160:175]
  ds_read_b64_tr_b16 v[108:109], v17 offset:40960
  v_mfma_f32_32x32x16_bf16 a[176:191], v[92:95], v[72:75], a[176:191]
  ds_read_b64_tr_b16 v[110:111], v17 offset:43008
  s_add_u32 m0, s24, 2048
  s_nop 0
  buffer_load_dwordx4 v4, s[4:7], s20 offen lds
  v_mfma_f32_32x32x16_bf16 a[192:207], v[80:83], v[76:79], a[192:207]
  v_mfma_f32_32x32x16_bf16 a[208:223], v[84:87], v[76:79], a[208:223]
  v_mfma_f32_32x32x16_bf16 a[224:239], v[88:91], v[76:79], a[224:239]
  v_mfma_f32_32x32x16_bf16 a[240:255], v[92:95], v[76:79], a[240:255]
  s_add_u32 m0, s24, 3072
  s_nop 0
  buffer_load_dwordx4 v5, s[4:7], s20 offen lds
  s_waitcnt vmcnt(12) lgkmcnt(0)
  s_barrier
  v_mfma_f32_32x32x16_bf16 a[0:15], v[112:115], v[96:99], a[0:15]
  ds_read_b64_tr_b16 v[64:65], v18 offset:0
  v_mfma_f32_32x32x16_bf16 a[16:31], v[116:119], v[96:99], a[16:31]
  ds_read_b64_tr_b16 v[66:67], v18 offset:2048
  v_mfma_f32_32x32x16_bf16 a[32:47], v[120:123], v[96:99], a[32:47]
  ds_read_b128 v[80:83], v12 offset:0
  v_mfma_f32_32x32x16_bf16 a[48:63], v[124:127], v[96:99], a[48:63]
  ds_read_b128 v[84:87], v12 offset:2048
  s_add_u32 m0, s25, 0
  s_nop 0
  buffer_load_dwordx4 v6, s[8:11], s21 offen lds
  v_mfma_f32_32x32x16_bf16 a[64:79], v[112:115], v[100:103], a[64:79]
  ds_read_b128 v[88:91], v12 offset:4096
  v_mfma_f32_32x32x16_bf16 a[80:95], v[116:119], v[100:103], a[80:95]
  ds_read_b128 v[92:95], v12 offset:6144
  v_mfma_f32_32x32x16_bf16 a[96:111], v[120:123], v[100:103], a[96:111]
  ds_read_b64_tr_b16 v[68:69], v19 offset:0
  v_mfma_f32_32x32x16_bf16 a[112:127], v[124:127], v[100:103], a[112:127]
  ds_read_b64_tr_b16 v[70:71], v19 offset:2048
  s_add_u32 m0, s25, 1024
  s_nop 0
  buffer_load_dwordx4 v7, s[8:11], s21 offen lds
  v_mfma_f32_32x32x16_bf16 a[128:143], v[112:115], v[104:107], a[128:143]
  ds_read_b64_tr_b16 v[72:73], v20 offset:0
  v_mfma_f32_32x32x16_bf16 a[144:159], v[116:119], v[104:107], a[144:159]
  ds_read_b64_tr_b16 v[74:75], v20 offset:2048
  v_mfma_f32_32x32x16_bf16 a[160:175], v[120:123], v[104:107], a[160:175]
  ds_read_b64_tr_b16 v[76:77], v21 offset:0
  v_mfma_f32_32x32x16_bf16 a[176:191], v[124:127], v[104:107], a[176:191]
  ds_read_b64_tr_b16 v[78:79], v21 offset:2048
  s_add_u32 m0, s25, 2048
  s_nop 0
  buffer_load_dwordx4 v8, s[8:11], s21 offen lds
  v_mfma_f32_32x32x16_bf16 a[192:207], v[112:115], v[108:111], a[192:207]
  v_mfma_f32_32x32x16_bf16 a[208:223], v[116:119], v[108:111], a[208:223]
  v_mfma_f32_32x32x16_bf16 a[224:239], v[120:123], v[108:111], a[224:239]
  v_mfma_f32_32x32x16_bf16 a[240:255], v[124:127], v[108:111], a[240:255]
  s_add_u32 m0, s25, 3072
  s_nop 0
  buffer_load_dwordx4 v9, s[8:11], s21 offen lds
  s_add_u32 s20, s20, 64
  s_add_u32 s21, s21, s23
  s_waitcnt lgkmcnt(0)
  v_mfma_f32_32x32x16_bf16 a[0:15], v[80:83], v[64:67], a[0:15]
  ds_read_b64_tr_b16 v[96:97], v18 offset:8192
  v_mfma_f32_32x32x16_bf16 a[16:31], v[84:87], v[64:67], a[16:31]
  ds_read_b64_tr_b16 v[98:99], v18 offset:10240
  v_mfma_f32_32x32x16_bf16 a[32:47], v[88:91], v[64:67], a[32:47]
  ds_read_b128 v[112:115], v13 offset:0
  v_mfma_f32_32x32x16_bf16 a[48:63], v[92:95], v[64:67], a[48:63]
  ds_read_b128 v[116:119], v13 offset:2048
  s_add_u32 m0, s24, 32768
  s_nop 0
  buffer_load_dwordx4 v2, s[4:7], s20 offen lds
  v_mfma_f32_32x32x16_bf16 a[64:79], v[80:83], v[68:71], a[64:79]
  ds_read_b128 v[120:123], v13 offset:4096
  v_mfma_f32_32x32x16_bf16 a[80:95], v[84:87], v[68:71], a[80:95]
  ds_read_b128 v[124:127], v13 offset:6144
  v_mfma_f32_32x32x16_bf16 a[96:111], v[88:91], v[68:71], a[96:111]
  ds_read_b64_tr_b16 v[100:101], v19 offset:8192
  v_mfma_f32_32x32x16_bf16 a[112:127], v[92:95], v[68:71], a[112:127]
  ds_read_b64_tr_b16 v[102:103], v19 offset:10240
  s_add_u32 m0, s24, 33792
  s_nop 0
  buffer_load_dwordx4 v3, s[4:7], s20 offen lds
  v_mfma_f32_32x32x16_bf16 a[128:143], v[80:83], v[72:75], a[128:143]
  ds_read_b64_tr_b16 v[104:105], v20 offset:8192
  v_mfma_f32_32x32x16_bf16 a[144:159], v[84:87], v[72:75], a[144:159]
  ds_read_b64_tr_b16 v[106:107], v20 offset:10240
  v_mfma_f32_32x32x16_bf16 a[160:175], v[88:91], v[72:75], a[160:175]
  ds_read_b64_tr_b16 v[108:109], v21 offset:8192
  v_mfma_f32_32x32x16_bf16 a[176:191], v[92:95], v[72:75], a[176:191]
  ds_read_b64_tr_b16 v[110:111], v21 offset:10240
  s_add_u32 m0, s24, 34816
  s_nop 0
  buffer_load_dwordx4 v4, s[4:7], s20 offen lds
  v_mfma_f32_32x32x16_bf16 a[192:207], v[80:83], v[76:79], a[192:207]
  v_mfma_f32_32x32x16_bf16 a[208:223], v[84:87], v[76:79], a[208:223]
  v_mfma_f32_32x32x16_bf16 a[224:239], v[88:91], v[76:79], a[224:239]
  v_mfma_f32_32x32x16_bf16 a[240:255], v[92:95], v[76:79], a[240:255]
  s_add_u32 m0, s24, 35840
  s_nop 0
  buffer_load_dwordx4 v5, s[4:7], s20 offen lds
  s_waitcnt vmcnt(12) lgkmcnt(0)
  s_barrier
  v_mfma_f32_32x32x16_bf16 a[0:15], v[112:115], v[96:99], a[0:15]
  ds_read_b64_tr_b16 v[64:65], v18 offset:32768
  v_mfma_f32_32x32x16_bf16 a[16:31], v[116:119], v[96:99], a[16:31]
  ds_read_b64_tr_b16 v[66:67], v18 offset:34816
  v_mfma_f32_32x32x16_bf16 a[32:47], v[120:123], v[96:99], a[32:47]
  ds_read_b128 v[80:83], v12 offset:32768
  v_mfma_f32_32x32x16_bf16 a[48:63], v[124:127], v[96:99], a[48:63]
  ds_read_b128 v[84:87], v12 offset:34816
  s_add_u32 m0, s25, 32768
  s_nop 0
  buffer_load_dwordx4 v6, s[8:11], s21 offen lds
  v_mfma_f32_32x32x16_bf16 a[64:79], v[112:115], v[100:103], a[64:79]
  ds_read_b128 v[88:91], v12 offset:36864
  v_mfma_f32_32x32x16_bf16 a[80:95], v[116:119], v[100:103], a[80:95]
  ds_read_b128 v[92:95], v12 offset:38912
  v_mfma_f32_32x32x16_bf16 a[96:111], v[120:123], v[100:103], a[96:111]
  ds_read_b64_tr_b16 v[68:69], v19 offset:32768
  v_mfma_f32_32x32x16_bf16 a[112:127], v[124:127], v[100:103], a[112:127]
  ds_read_b64_tr_b16 v[70:71], v19 offset:34816
  s_add_u32 m0, s25, 33792
  s_nop 0
  buffer_load_dwordx4 v7, s[8:11], s21 offen lds
  v_mfma_f32_32x32x16_bf16 a[128:143], v[112:115], v[104:107], a[128:143]
  ds_read_b64_tr_b16 v[72:73], v20 offset:32768
  v_mfma_f32_32x32x16_bf16 a[144:159], v[116:119], v[104:107], a[144:159]
  ds_read_b64_tr_b16 v[74:75], v20 offset:34816
  v_mfma_f32_32x32x16_bf16 a[160:175], v[120:123], v[104:107], a[160:175]
  ds_read_b64_tr_b16 v[76:77], v21 offset:32768
  v_mfma_f32_32x32x16_bf16 a[176:191], v[124:127], v[104:107], a[176:191]
  ds_read_b64_tr_b16 v[78:79], v21 offset:34816
  s_add_u32 m0, s25, 34816
  s_nop 0
  buffer_load_dwordx4 v8, s[8:11], s21 offen lds
  v_mfma_f32_32x32x16_bf16 a[192:207], v[112:115], v[108:111], a[192:207]
  v_mfma_f32_32x32x16_bf16 a[208:223], v[116:119], v[108:111], a[208:223]
  v_mfma_f32_32x32x16_bf16 a[224:239], v[120:123], v[108:111], a[224:239]
  v_mfma_f32_32x32x16_bf16 a[240:255], v[124:127], v[108:111], a[240:255]
  s_add_u32 m0, s25, 35840
  s_nop 0
  buffer_load_dwordx4 v9, s[8:11], s21 offen lds
  s_add_u32 s20, s20, 64
  s_add_u32 s21, s21, s23
  s_waitcnt lgkmcnt(0)
  v_mfma_f32_32x32x16_bf16 a[0:15], v[80:83], v[64:67], a[0:15]
  ds_read_b64_tr_b16 v[96:97], v18 offset:40960
  v_mfma_f32_32x32x16_bf16 a[16:31], v[84:87], v[64:67], a[16:31]
  ds_read_b64_tr_b16 v[98:99], v18 offset:43008
  v_mfma_f32_32x32x16_bf16 a[32:47], v[88:91], v[64:67], a[32:47]
  ds_read_b128 v[112:115], v13 offset:32768
  v_mfma_f32_32x32x16_bf16 a[48:63], v[92:95], v[64:67], a[48:63]
  ds_read_b128 v[116:119], v13 offset:34816
  s_add_u32 m0, s24, 65536
  s_nop 0
  buffer_load_dwordx4 v2, s[4:7], s20 offen lds
  v_mfma_f32_32x32x16_bf16 a[64:79], v[80:83], v[68:71], a[64:79]
  ds_read_b128 v[120:123], v13 offset:36864
  v_mfma_f32_32x32x16_bf16 a[80:95], v[84:87], v[68:71], a[80:95]
  ds_read_b128 v[124:127], v13 offset:38912
  v_mfma_f32_32x32x16_bf16 a[96:111], v[88:91], v[68:71], a[96:111]
  ds_read_b64_tr_b16 v[100:101], v19 offset:40960
  v_mfma_f32_32x32x16_bf16 a[112:127], v[92:95], v[68:71], a[112:127]
  ds_read_b64_tr_b16 v[102:103], v19 offset:43008
  s_add_u32 m0, s24, 66560
  s_nop 0
  buffer_load_dwordx4 v3, s[4:7], s20 offen lds
  v_mfma_f32_32x32x16_bf16 a[128:143], v[80:83], v[72:75], a[128:143]
  ds_read_b64_tr_b16 v[104:105], v20 offset:40960
  v_mfma_f32_32x32x16_bf16 a[144:159], v[84:87], v[72:75], a[144:159]
  ds_read_b64_tr_b16 v[106:107], v20 offset:43008
  v_mfma_f32_32x32x16_bf16 a[160:175], v[88:91], v[72:75], a[160:175]
  ds_read_b64_tr_b16 v[108:109], v21 offset:40960
  v_mfma_f32_32x32x16_bf16 a[176:191], v[92:95], v[72:75], a[176:191]
  ds_read_b64_tr_b16 v[110:111], v21 offset:43008
  s_add_u32 m0, s24, 67584
  s_nop 0
  buffer_load_dwordx4 v4, s[4:7], s20 offen lds
  v_mfma_f32_32x32x16_bf16 a[192:207], v[80:83], v[76:79], a[192:207]
  v_mfma_f32_32x32x16_bf16 a[208:223], v[84:87], v[76:79], a[208:223]
  v_mfma_f32_32x32x16_bf16 a[224:239], v[88:91], v[76:79], a[224:239]
  v_mfma_f32_32x32x16_bf16 a[240:255], v[92:95], v[76:79], a[240:255]
  s_add_u32 m0, s24, 68608
  s_nop 0
  buffer_load_dwordx4 v5, s[4:7], s20 offen lds
  s_waitcnt vmcnt(12) lgkmcnt(0)
  s_barrier
  v_mfma_f32_32x32x16_bf16 a[0:15], v[112:115], v[96:99], a[0:15]
  ds_read_b64_tr_b16 v[64:65], v14 offset:0
  v_mfma_f32_32x32x16_bf16 a[16:31], v[116:119], v[96:99], a[16:31]
  ds_read_b64_tr_b16 v[66:67], v14 offset:2048
  v_mfma_f32_32x32x16_bf16 a[32:47], v[120:123], v[96:99], a[32:47]
  ds_read_b128 v[80:83], v10 offset:0
  v_mfma_f32_32x32x16_bf16 a[48:63], v[124:127], v[96:99], a[48:63]
  ds_read_b128 v[84:87], v10 offset:2048
  s_add_u32 m0, s25, 65536
  s_nop 0
  buffer_load_dwordx4 v6, s[8:11], s21 offen lds
  v_mfma_f32_32x32x16_bf16 a[64:79], v[112:115], v[100:103], a[64:79]
  ds_read_b128 v[88:91], v10 offset:4096
  v_mfma_f32_32x32x16_bf16 a[80:95], v[116:119], v[100:103], a[80:95]
  ds_read_b128 v[92:95], v10 offset:6144
  v_mfma_f32_32x32x16_bf16 a[96:111], v[120:123], v[100:103], a[96:111]
  ds_read_b64_tr_b16 v[68:69], v15 offset:0
  v_mfma_f32_32x32x16_bf16 a[112:127], v[124:127], v[100:103], a[112:127]
  ds_read_b64_tr_b16 v[70:71], v15 offset:2048
  s_add_u32 m0, s25, 66560
  s_nop 0
  buffer_load_dwordx4 v7, s[8:11], s21 offen lds
  v_mfma_f32_32x32x16_bf16 a[128:143], v[112:115], v[104:107], a[128:143]
  ds_read_b64_tr_b16 v[72:73], v16 offset:0
  v_mfma_f32_32x32x16_bf16 a[144:159], v[116:119], v[104:107], a[144:159]
  ds_read_b64_tr_b16 v[74:75], v16 offset:2048
  v_mfma_f32_32x32x16_bf16 a[160:175], v[120:123], v[104:107], a[160:175]
  ds_read_b64_tr_b16 v[76:77], v17 offset:0
  v_mfma_f32_32x32x16_bf16 a[176:191], v[124:127], v[104:107], a[176:191]
  ds_read_b64_tr_b16 v[78:79], v17 offset:2048
  s_add_u32 m0, s25, 67584
  s_nop 0
  buffer_load_dwordx4 v8, s[8:11], s21 offen lds
  v_mfma_f32_32x32x16_bf16 a[192:207], v[112:115], v[108:111], a[192:207]
  v_mfma_f32_32x32x16_bf16 a[208:223], v[116:119], v[108:111], a[208:223]
  v_mfma_f32_32x32x16_bf16 a[224:239], v[120:123], v[108:111], a[224:239]
  v_mfma_f32_32x32x16_bf16 a[240:255], v[124:127], v[108:111], a[240:255]
  s_add_u32 m0, s25, 68608
  s_nop 0
  buffer_load_dwordx4 v9, s[8:11], s21 offen lds
  s_add_u32 s20, s20, 64
  s_add_u32 s21, s21, s23
  s_waitcnt lgkmcnt(0)
  v_mfma_f32_32x32x16_bf16 a[0:15], v[80:83], v[64:67], a[0:15]
  ds_read_b64_tr_b16 v[96:97], v14 offset:8192
  v_mfma_f32_32x32x16_bf16 a[16:31], v[84:87], v[64:67], a[16:31]
  ds_read_b64_tr_b16 v[98:99], v14 offset:10240
  v_mfma_f32_32x32x16_bf16 a[32:47], v[88:91], v[64:67], a[32:47]
  ds_read_b128 v[112:115], v11 offset:0
  v_mfma_f32_32x32x16_bf16 a[48:63], v[92:95], v[64:67], a[48:63]
  ds_read_b128 v[116:119], v11 offset:2048
  s_add_u32 m0, s24, 98304
  s_nop 0
  buffer_load_dwordx4 v2, s[4:7], s20 offen lds
  v_mfma_f32_32x32x16_bf16 a[64:79], v[80:83], v[68:71], a[64:79]
  ds_read_b128 v[120:123], v11 offset:4096
  v_mfma_f32_32x32x16_bf16 a[80:95], v[84:87], v[68:71], a[80:95]
  ds_read_b128 v[124:127], v11 offset:6144
  v_mfma_f32_32x32x16_bf16 a[96:111], v[88:91], v[68:71], a[96:111]
  ds_read_b64_tr_b16 v[100:101], v15 offset:8192
  v_mfma_f32_32x32x16_bf16 a[112:127], v[92:95], v[68:71], a[112:127]
  ds_read_b64_tr_b16 v[102:103], v15 offset:10240
  s_add_u32 m0, s24, 99328
  s_nop 0
  buffer_load_dwordx4 v3, s[4:7], s20 offen lds
  v_mfma_f32_32x32x16_bf16 a[128:143], v[80:83], v[72:75], a[128:143]
  ds_read_b64_tr_b16 v[104:105], v16 offset:8192
  v_mfma_f32_32x32x16_bf16 a[144:159], v[84:87], v[72:75], a[144:159]
  ds_read_b64_tr_b16 v[106:107], v16 offset:10240
  v_mfma_f32_32x32x16_bf16 a[160:175], v[88:91], v[72:75], a[160:175]
  ds_read_b64_tr_b16 v[108:109], v17 offset:8192
  v_mfma_f32_32x32x16_bf16 a[176:191], v[92:95], v[72:75], a[176:191]
  ds_read_b64_tr_b16 v[110:111], v17 offset:10240
  s_add_u32 m0, s24, 100352
  s_nop 0
  buffer_load_dwordx4 v4, s[4:7], s20 offen lds
  v_mfma_f32_32x32x16_bf16 a[192:207], v[80:83], v[76:79], a[192:207]
  v_mfma_f32_32x32x16_bf16 a[208:223], v[84:87], v[76:79], a[208:223]
  v_mfma_f32_32x32x16_bf16 a[224:239], v[88:91], v[76:79], a[224:239]
  v_mfma_f32_32x32x16_bf16 a[240:255], v[92:95], v[76:79], a[240:255]
  s_add_u32 m0, s24, 101376
  s_nop 0
  buffer_load_dwordx4 v5, s[4:7], s20 offen lds
  s_waitcnt vmcnt(12) lgkmcnt(0)
  s_barrier
  v_mfma_f32_32x32x16_bf16 a[0:15], v[112:115], v[96:99], a[0:15]
  ds_read_b64_tr_b16 v[64:65], v14 offset:32768
  v_mfma_f32_32x32x16_bf16 a[16:31], v[116:119], v[96:99], a[16:31]
  ds_read_b64_tr_b16 v[66:67], v14 offset:34816
  v_mfma_f32_32x32x16_bf16 a[32:47], v[120:123], v[96:99], a[32:47]
  ds_read_b128 v[80:83], v10 offset:32768
  v_mfma_f32_32x32x16_bf16 a[48:63], v[124:127], v[96:99], a[48:63]
  ds_read_b128 v[84:87], v10 offset:34816
  s_add_u32 m0, s25, 98304
  s_nop 0
  buffer_load_dwordx4 v6, s[8:11], s21 offen lds
  v_mfma_f32_32x32x16_bf16 a[64:79], v[112:115], v[100:103], a[64:79]
  ds_read_b128 v[88:91], v10 offset:36864
  v_mfma_f32_32x32x16_bf16 a[80:95], v[116:119], v[100:103], a[80:95]
  ds_read_b128 v[92:95], v10 offset:38912
  v_mfma_f32_32x32x16_bf16 a[96:111], v[120:123], v[100:103], a[96:111]
  ds_read_b64_tr_b16 v[68:69], v15 offset:32768
  v_mfma_f32_32x32x16_bf16 a[112:127], v[124:127], v[100:103], a[112:127]
  ds_read_b64_tr_b16 v[70:71], v15 offset:34816
  s_add_u32 m0, s25, 99328
  s_nop 0
  buffer_load_dwordx4 v7, s[8:11], s21 offen lds
  v_mfma_f32_32x32x16_bf16 a[128:143], v[112:115], v[104:107], a[128:143]
  ds_read_b64_tr_b16 v[72:73], v16 offset:32768
  v_mfma_f32_32x32x16_bf16 a[144:159], v[116:119], v[104:107], a[144:159]
  ds_read_b64_tr_b16 v[74:75], v16 offset:34816
  v_mfma_f32_32x32x16_bf16 a[160:175], v[120:123], v[104:107], a[160:175]
  ds_read_b64_tr_b16 v[76:77], v17 offset:32768
  v_mfma_f32_32x32x16_bf16 a[176:191], v[124:127], v[104:107], a[176:191]
  ds_read_b64_tr_b16 v[78:79], v17 offset:34816
  s_add_u32 m0, s25, 100352
  s_nop 0
  buffer_load_dwordx4 v8, s[8:11], s21 offen lds
  v_mfma_f32_32x32x16_bf16 a[192:207], v[112:115], v[108:111], a[192:207]
  v_mfma_f32_32x32x16_bf16 a[208:223], v[116:119], v[108:111], a[208:223]
  v_mfma_f32_32x32x16_bf16 a[224:239], v[120:123], v[108:111], a[224:239]
  v_mfma_f32_32x32x16_bf16 a[240:255], v[124:127], v[108:111], a[240:255]
  s_add_u32 m0, s25, 101376
  s_nop 0
  buffer_load_dwordx4 v9, s[8:11], s21 offen lds
  s_add_u32 s20, s20, 64
  s_add_u32 s21, s21, s23
  s_waitcnt lgkmcnt(0)
  v_mfma_f32_32x32x16_bf16 a[0:15], v[80:83], v[64:67], a[0:15]
  ds_read_b64_tr_b16 v[96:97], v14 offset:40960
  v_mfma_f32_32x32x16_bf16 a[16:31], v[84:87], v[64:67], a[16:31]
  ds_read_b64_tr_b16 v[98:99], v14 offset:43008
  v_mfma_f32_32x32x16_bf16 a[32:47], v[88:91], v[64:67], a[32:47]
  ds_read_b128 v[112:115], v11 offset:32768
  v_mfma_f32_32x32x16_bf16 a[48:63], v[92:95], v[64:67], a[48:63]
  ds_read_b128 v[116:119], v11 offset:34816
  s_add_u32 m0, s24, 0
  s_nop 0
  buffer_load_dwordx4 v2, s[4:7], s20 offen lds
  v_mfma_f32_32x32x16_bf16 a[64:79], v[80:83], v[68:71], a[64:79]
  ds_read_b128 v[120:123], v11 offset:36864
  v_mfma_f32_32x32x16_bf16 a[80:95], v[84:87], v[68:71], a[80:95]
  ds_read_b128 v[124:127], v11 offset:38912
  v_mfma_f32_32x32x16_bf16 a[96:111], v[88:91], v[68:71], a[96:111]
  ds_read_b64_tr_b16 v[100:101], v15 offset:40960
  v_mfma_f32_32x32x16_bf16 a[112:127], v[92:95], v[68:71], a[112:127]
  ds_read_b64_tr_b16 v[102:103], v15 offset:43008
  s_add_u32 m0, s24, 1024
  s_nop 0
  buffer_load_dwordx4 v3, s[4:7], s20 offen lds
  v_mfma_f32_32x32x16_bf16 a[128:143], v[80:83], v[72:75], a[128:143]
  ds_read_b64_tr_b16 v[104:105], v16 offset:40960
  v_mfma_f32_32x32x16_bf16 a[144:159], v[84:87], v[72:75], a[144:159]
  ds_read_b64_tr_b16 v[106:107], v16 offset:43008
  v_mfma_f32_32x32x16_bf16 a[160:175], v[88:91], v[72:75], a[160:175]
  ds_read_b64_tr_b16 v[108:109], v17 offset:40960
  v_mfma_f32_32x32x16_bf16 a[176:191], v[92:95], v[72:75], a[176:191]
  ds_read_b64_tr_b16 v[110:111], v17 offset:43008
  s_add_u32 m0, s24, 2048
  s_nop 0
  buffer_load_dwordx4 v4, s[4:7], s20 offen lds
  v_mfma_f32_32x32x16_bf16 a[192:207], v[80:83], v[76:79], a[192:207]
  v_mfma_f32_32x32x16_bf16 a[208:223], v[84:87], v[76:79], a[208:223]
  v_mfma_f32_32x32x16_bf16 a[224:239], v[88:91], v[76:79], a[224:239]
  v_mfma_f32_32x32x16_bf16 a[240:255], v[92:95], v[76:79], a[240:255]
  s_add_u32 m0, s24, 3072
  s_nop 0
  buffer_load_dwordx4 v5, s[4:7], s20 offen lds
  s_waitcnt vmcnt(12) lgkmcnt(0)
  s_barrier
  v_mfma_f32_32x32x16_bf16 a[0:15], v[112:115], v[96:99], a[0:15]
  ds_read_b64_tr_b16 v[64:65], v18 offset:0
  v_mfma_f32_32x32x16_bf16 a[16:31], v[116:119], v[96:99], a[16:31]
  ds_read_b64_tr_b16 v[66:67], v18 offset:2048
  v_mfma_f32_32x32x16_bf16 a[32:47], v[120:123], v[96:99], a[32:47]
  ds_read_b128 v[80:83], v12 offset:0
  v_mfma_f32_32x32x16_bf16 a[48:63], v[124:127], v[96:99], a[48:63]
  ds_read_b128 v[84:87], v12 offset:2048
  s_add_u32 m0, s25, 0
  s_nop 0
  buffer_load_dwordx4 v6, s[8:11], s21 offen lds
  v_mfma_f32_32x32x16_bf16 a[64:79], v[112:115], v[100:103], a[64:79]
  ds_read_b128 v[88:91], v12 offset:4096
  v_mfma_f32_32x32x16_bf16 a[80:95], v[116:119], v[100:103], a[80:95]
  ds_read_b128 v[92:95], v12 offset:6144
  v_mfma_f32_32x32x16_bf16 a[96:111], v[120:123], v[100:103], a[96:111]
  ds_read_b64_tr_b16 v[68:69], v19 offset:0
  v_mfma_f32_32x32x16_bf16 a[112:127], v[124:127], v[100:103], a[112:127]
  ds_read_b64_tr_b16 v[70:71], v19 offset:2048
  s_add_u32 m0, s25, 1024
  s_nop 0
  buffer_load_dwordx4 v7, s[8:11], s21 offen lds
  v_mfma_f32_32x32x16_bf16 a[128:143], v[112:115], v[104:107], a[128:143]
  ds_read_b64_tr_b16 v[72:73], v20 offset:0
  v_mfma_f32_32x32x16_bf16 a[144:159], v[116:119], v[104:107], a[144:159]
  ds_read_b64_tr_b16 v[74:75], v20 offset:2048
  v_mfma_f32_32x32x16_bf16 a[160:175], v[120:123], v[104:107], a[160:175]
  ds_read_b64_tr_b16 v[76:77], v21 offset:0
  v_mfma_f32_32x32x16_bf16 a[176:191], v[124:127], v[104:107], a[176:191]
  ds_read_b64_tr_b16 v[78:79], v21 offset:2048
  s_add_u32 m0, s25, 2048
  s_nop 0
  buffer_load_dwordx4 v8, s[8:11], s21 offen lds
  v_mfma_f32_32x32x16_bf16 a[192:207], v[112:115], v[108:111], a[192:207]
  v_mfma_f32_32x32x16_bf16 a[208:223], v[116:119], v[108:111], a[208:223]
  v_mfma_f32_32x32x16_bf16 a[224:239], v[120:123], v[108:111], a[224:239]
  v_mfma_f32_32x32x16_bf16 a[240:255], v[124:127], v[108:111], a[240:255]
  s_add_u32 m0, s25, 3072
  s_nop 0
  buffer_load_dwordx4 v9, s[8:11], s21 offen lds
  s_add_u32 s20, s20, 64
  s_add_u32 s21, s21, s23
  s_waitcnt lgkmcnt(0)
  v_mfma_f32_32x32x16_bf16 a[0:15], v[80:83], v[64:67], a[0:15]
  ds_read_b64_tr_b16 v[96:97], v18 offset:8192
  v_mfma_f32_32x32x16_bf16 a[16:31], v[84:87], v[64:67], a[16:31]
  ds_read_b64_tr_b16 v[98:99], v18 offset:10240
  v_mfma_f32_32x32x16_bf16 a[32:47], v[88:91], v[64:67], a[32:47]
  ds_read_b128 v[112:115], v13 offset:0
  v_mfma_f32_32x32x16_bf16 a[48:63], v[92:95], v[64:67], a[48:63]
  ds_read_b128 v[116:119], v13 offset:2048
  s_add_u32 m0, s24, 32768
  s_nop 0
  buffer_load_dwordx4 v2, s[4:7], s20 offen lds
  v_mfma_f32_32x32x16_bf16 a[64:79], v[80:83], v[68:71], a[64:79]
  ds_read_b128 v[120:123], v13 offset:4096
  v_mfma_f32_32x32x16_bf16 a[80:95], v[84:87], v[68:71], a[80:95]
  ds_read_b128 v[124:127], v13 offset:6144
  v_mfma_f32_32x32x16_bf16 a[96:111], v[88:91], v[68:71], a[96:111]
  ds_read_b64_tr_b16 v[100:101], v19 offset:8192
  v_mfma_f32_32x32x16_bf16 a[112:127], v[92:95], v[68:71], a[112:127]
  ds_read_b64_tr_b16 v[102:103], v19 offset:10240
  s_add_u32 m0, s24, 33792
  s_nop 0
  buffer_load_dwordx4 v3, s[4:7], s20 offen lds
  v_mfma_f32_32x32x16_bf16 a[128:143], v[80:83], v[72:75], a[128:143]
  ds_read_b64_tr_b16 v[104:105], v20 offset:8192
  v_mfma_f32_32x32x16_bf16 a[144:159], v[84:87], v[72:75], a[144:159]
  ds_read_b64_tr_b16 v[106:107], v20 offset:10240
  v_mfma_f32_32x32x16_bf16 a[160:175], v[88:91], v[72:75], a[160:175]
  ds_read_b64_tr_b16 v[108:109], v21 offset:8192
  v_mfma_f32_32x32x16_bf16 a[176:191], v[92:95], v[72:75], a[176:191]
  ds_read_b64_tr_b16 v[110:111], v21 offset:10240
  s_add_u32 m0, s24, 34816
  s_nop 0
  buffer_load_dwordx4 v4, s[4:7], s20 offen lds
  v_mfma_f32_32x32x16_bf16 a[192:207], v[80:83], v[76:79], a[192:207]
  v_mfma_f32_32x32x16_bf16 a[208:223], v[84:87], v[76:79], a[208:223]
  v_mfma_f32_32x32x16_bf16 a[224:239], v[88:91], v[76:79], a[224:239]
  v_mfma_f32_32x32x16_bf16 a[240:255], v[92:95], v[76:79], a[240:255]
  s_add_u32 m0, s24, 35840
  s_nop 0
  buffer_load_dwordx4 v5, s[4:7], s20 offen lds
  s_waitcnt vmcnt(12) lgkmcnt(0)
  s_barrier
  v_mfma_f32_32x32x16_bf16 a[0:15], v[112:115], v[96:99], a[0:15]
  ds_read_b64_tr_b16 v[64:65], v18 offset:32768
  v_mfma_f32_32x32x16_bf16 a[16:31], v[116:119], v[96:99], a[16:31]
  ds_read_b64_tr_b16 v[66:67], v18 offset:34816
  v_mfma_f32_32x32x16_bf16 a[32:47], v[120:123], v[96:99], a[32:47]
  ds_read_b128 v[80:83], v12 offset:32768
  v_mfma_f32_32x32x16_bf16 a[48:63], v[124:127], v[96:99], a[48:63]
  ds_read_b128 v[84:87], v12 offset:34816
  s_add_u32 m0, s25, 32768
  s_nop 0
  buffer_load_dwordx4 v6, s[8:11], s21 offen lds
  v_mfma_f32_32x32x16_bf16 a[64:79], v[112:115], v[100:103], a[64:79]
  ds_read_b128 v[88:91], v12 offset:36864
  v_mfma_f32_32x32x16_bf16 a[80:95], v[116:119], v[100:103], a[80:95]
  ds_read_b128 v[92:95], v12 offset:38912
  v_mfma_f32_32x32x16_bf16 a[96:111], v[120:123], v[100:103], a[96:111]
  ds_read_b64_tr_b16 v[68:69], v19 offset:32768
  v_mfma_f32_32x32x16_bf16 a[112:127], v[124:127], v[100:103], a[112:127]
  ds_read_b64_tr_b16 v[70:71], v19 offset:34816
  s_add_u32 m0, s25, 33792
  s_nop 0
  buffer_load_dwordx4 v7, s[8:11], s21 offen lds
  v_mfma_f32_32x32x16_bf16 a[128:143], v[112:115], v[104:107], a[128:143]
  ds_read_b64_tr_b16 v[72:73], v20 offset:32768
  v_mfma_f32_32x32x16_bf16 a[144:159], v[116:119], v[104:107], a[144:159]
  ds_read_b64_tr_b16 v[74:75], v20 offset:34816
  v_mfma_f32_32x32x16_bf16 a[160:175], v[120:123], v[104:107], a[160:175]
  ds_read_b64_tr_b16 v[76:77], v21 offset:32768
  v_mfma_f32_32x32x16_bf16 a[176:191], v[124:127], v[104:107], a[176:191]
  ds_read_b64_tr_b16 v[78:79], v21 offset:34816
  s_add_u32 m0, s25, 34816
  s_nop 0
  buffer_load_dwordx4 v8, s[8:11], s21 offen lds
  v_mfma_f32_32x32x16_bf16 a[192:207], v[112:115], v[108:111], a[192:207]
  v_mfma_f32_32x32x16_bf16 a[208:223], v[116:119], v[108:111], a[208:223]
  v_mfma_f32_32x32x16_bf16 a[224:239], v[120:123], v[108:111], a[224:239]
  v_mfma_f32_32x32x16_bf16 a[240:255], v[124:127], v[108:111], a[240:255]
  s_add_u32 m0, s25, 35840
  s_nop 0
  buffer_load_dwordx4 v9, s[8:11], s21 offen lds
  s_add_u32 s20, s20, 64
  s_add_u32 s21, s21, s23
  s_waitcnt lgkmcnt(0)
  v_mfma_f32_32x32x16_bf16 a[0:15], v[80:83], v[64:67], a[0:15]
  ds_read_b64_tr_b16 v[96:97], v18 offset:40960
  v_mfma_f32_32x32x16_bf16 a[16:31], v[84:87], v[64:67], a[16:31]
  ds_read_b64_tr_b16 v[98:99], v18 offset:43008
  v_mfma_f32_32x32x16_bf16 a[32:47], v[88:91], v[64:67], a[32:47]
  ds_read_b128 v[112:115], v13 offset:32768
  v_mfma_f32_32x32x16_bf16 a[48:63], v[92:95], v[64:67], a[48:63]
  ds_read_b128 v[116:119], v13 offset:34816
  s_add_u32 m0, s24, 65536
  s_nop 0
  buffer_load_dwordx4 v2, s[4:7], s20 offen lds
  v_mfma_f32_32x32x16_bf16 a[64:79], v[80:83], v[68:71], a[64:79]
  ds_read_b128 v[120:123], v13 offset:36864
  v_mfma_f32_32x32x16_bf16 a[80:95], v[84:87], v[68:71], a[80:95]
  ds_read_b128 v[124:127], v13 offset:38912
  v_mfma_f32_32x32x16_bf16 a[96:111], v[88:91], v[68:71], a[96:111]
  ds_read_b64_tr_b16 v[100:101], v19 offset:40960
  v_mfma_f32_32x32x16_bf16 a[112:127], v[92:95], v[68:71], a[112:127]
  ds_read_b64_tr_b16 v[102:103], v19 offset:43008
  s_add_u32 m0, s24, 66560
  s_nop 0
  buffer_load_dwordx4 v3, s[4:7], s20 offen lds
  v_mfma_f32_32x32x16_bf16 a[128:143], v[80:83], v[72:75], a[128:143]
  ds_read_b64_tr_b16 v[104:105], v20 offset:40960
  v_mfma_f32_32x32x16_bf16 a[144:159], v[84:87], v[72:75], a[144:159]
  ds_read_b64_tr_b16 v[106:107], v20 offset:43008
  v_mfma_f32_32x32x16_bf16 a[160:175], v[88:91], v[72:75], a[160:175]
  ds_read_b64_tr_b16 v[108:109], v21 offset:40960
  v_mfma_f32_32x32x16_bf16 a[176:191], v[92:95], v[72:75], a[176:191]
  ds_read_b64_tr_b16 v[110:111], v21 offset:43008
  s_add_u32 m0, s24, 67584
  s_nop 0
  buffer_load_dwordx4 v4, s[4:7], s20 offen lds
  v_mfma_f32_32x32x16_bf16 a[192:207], v[80:83], v[76:79], a[192:207]
  v_mfma_f32_32x32x16_bf16 a[208:223], v[84:87], v[76:79], a[208:223]
  v_mfma_f32_32x32x16_bf16 a[224:239], v[88:91], v[76:79], a[224:239]
  v_mfma_f32_32x32x16_bf16 a[240:255], v[92:95], v[76:79], a[240:255]
  s_add_u32 m0, s24, 68608
  s_nop 0
  buffer_load_dwordx4 v5, s[4:7], s20 offen lds
  s_waitcnt vmcnt(12) lgkmcnt(0)
  s_barrier
  v_mfma_f32_32x32x16_bf16 a[0:15], v[112:115], v[96:99], a[0:15]
  ds_read_b64_tr_b16 v[64:65], v14 offset:0
  v_mfma_f32_32x32x16_bf16 a[16:31], v[116:119], v[96:99], a[16:31]
  ds_read_b64_tr_b16 v[66:67], v14 offset:2048
  v_mfma_f32_32x32x16_bf16 a[32:47], v[120:123], v[96:99], a[32:47]
  ds_read_b128 v[80:83], v10 offset:0
  v_mfma_f32_32x32x16_bf16 a[48:63], v[124:127], v[96:99], a[48:63]
  ds_read_b128 v[84:87], v10 offset:2048
  s_add_u32 m0, s25, 65536
  s_nop 0
  buffer_load_dwordx4 v6, s[8:11], s21 offen lds
  v_mfma_f32_32x32x16_bf16 a[64:79], v[112:115], v[100:103], a[64:79]
  ds_read_b128 v[88:91], v10 offset:4096
  v_mfma_f32_32x32x16_bf16 a[80:95], v[116:119], v[100:103], a[80:95]
  ds_read_b128 v[92:95], v10 offset:6144
  v_mfma_f32_32x32x16_bf16 a[96:111], v[120:123], v[100:103], a[96:111]
  ds_read_b64_tr_b16 v[68:69], v15 offset:0
  v_mfma_f32_32x32x16_bf16 a[112:127], v[124:127], v[100:103], a[112:127]
  ds_read_b64_tr_b16 v[70:71], v15 offset:2048
  s_add_u32 m0, s25, 66560
  s_nop 0
  buffer_load_dwordx4 v7, s[8:11], s21 offen lds
  v_mfma_f32_32x32x16_bf16 a[128:143], v[112:115], v[104:107], a[128:143]
  ds_read_b64_tr_b16 v[72:73], v16 offset:0
  v_mfma_f32_32x32x16_bf16 a[144:159], v[116:119], v[104:107], a[144:159]
  ds_read_b64_tr_b16 v[74:75], v16 offset:2048
  v_mfma_f32_32x32x16_bf16 a[160:175], v[120:123], v[104:107], a[160:175]
  ds_read_b64_tr_b16 v[76:77], v17 offset:0
  v_mfma_f32_32x32x16_bf16 a[176:191], v[124:127], v[104:107], a[176:191]
  ds_read_b64_tr_b16 v[78:79], v17 offset:2048
  s_add_u32 m0, s25, 67584
  s_nop 0
  buffer_load_dwordx4 v8, s[8:11], s21 offen lds
  v_mfma_f32_32x32x16_bf16 a[192:207], v[112:115], v[108:111], a[192:207]
  v_mfma_f32_32x32x16_bf16 a[208:223], v[116:119], v[108:111], a[208:223]
  v_mfma_f32_32x32x16_bf16 a[224:239], v[120:123], v[108:111], a[224:239]
  v_mfma_f32_32x32x16_bf16 a[240:255], v[124:127], v[108:111], a[240:255]
  s_add_u32 m0, s25, 68608
  s_nop 0
  buffer_load_dwordx4 v9, s[8:11], s21 offen lds
  s_add_u32 s20, s20, 64
  s_add_u32 s21, s21, s23
  s_waitcnt lgkmcnt(0)
  v_mfma_f32_32x32x16_bf16 a[0:15], v[80:83], v[64:67], a[0:15]
  ds_read_b64_tr_b16 v[96:97], v14 offset:8192
  v_mfma_f32_32x32x16_bf16 a[16:31], v[84:87], v[64:67], a[16:31]
  ds_read_b64_tr_b16 v[98:99], v14 offset:10240
  v_mfma_f32_32x32x16_bf16 a[32:47], v[88:91], v[64:67], a[32:47]
  ds_read_b128 v[112:115], v11 offset:0
  v_mfma_f32_32x32x16_bf16 a[48:63], v[92:95], v[64:67], a[48:63]
  ds_read_b128 v[116:119], v11 offset:2048
  s_add_u32 m0, s24, 98304
  s_nop 0
  buffer_load_dwordx4 v2, s[4:7], s20 offen lds
  v_mfma_f32_32x32x16_bf16 a[64:79], v[80:83], v[68:71], a[64:79]
  ds_read_b128 v[120:123], v11 offset:4096
  v_mfma_f32_32x32x16_bf16 a[80:95], v[84:87], v[68:71], a[80:95]
  ds_read_b128 v[124:127], v11 offset:6144
  v_mfma_f32_32x32x16_bf16 a[96:111], v[88:91], v[68:71], a[96:111]
  ds_read_b64_tr_b16 v[100:101], v15 offset:8192
  v_mfma_f32_32x32x16_bf16 a[112:127], v[92:95], v[68:71], a[112:127]
  ds_read_b64_tr_b16 v[102:103], v15 offset:10240
  s_add_u32 m0, s24, 99328
  s_nop 0
  buffer_load_dwordx4 v3, s[4:7], s20 offen lds
  v_mfma_f32_32x32x16_bf16 a[128:143], v[80:83], v[72:75], a[128:143]
  ds_read_b64_tr_b16 v[104:105], v16 offset:8192
  v_mfma_f32_32x32x16_bf16 a[144:159], v[84:87], v[72:75], a[144:159]
  ds_read_b64_tr_b16 v[106:107], v16 offset:10240
  v_mfma_f32_32x32x16_bf16 a[160:175], v[88:91], v[72:75], a[160:175]
  ds_read_b64_tr_b16 v[108:109], v17 offset:8192
  v_mfma_f32_32x32x16_bf16 a[176:191], v[92:95], v[72:75], a[176:191]
  ds_read_b64_tr_b16 v[110:111], v17 offset:10240
  s_add_u32 m0, s24, 100352
  s_nop 0
  buffer_load_dwordx4 v4, s[4:7], s20 offen lds
  v_mfma_f32_32x32x16_bf16 a[192:207], v[80:83], v[76:79], a[192:207]
  v_mfma_f32_32x32x16_bf16 a[208:223], v[84:87], v[76:79], a[208:223]
  v_mfma_f32_32x32x16_bf16 a[224:239], v[88:91], v[76:79], a[224:239]
  v_mfma_f32_32x32x16_bf16 a[240:255], v[92:95], v[76:79], a[240:255]
  s_add_u32 m0, s24, 101376
  s_nop 0
  buffer_load_dwordx4 v5, s[4:7], s20 offen lds
  s_waitcnt vmcnt(12) lgkmcnt(0)
  s_barrier
  v_mfma_f32_32x32x16_bf16 a[0:15], v[112:115], v[96:99], a[0:15]
  ds_read_b64_tr_b16 v[64:65], v14 offset:32768
  v_mfma_f32_32x32x16_bf16 a[16:31], v[116:119], v[96:99], a[16:31]
  ds_read_b64_tr_b16 v[66:67], v14 offset:34816
  v_mfma_f32_32x32x16_bf16 a[32:47], v[120:123], v[96:99], a[32:47]
  ds_read_b128 v[80:83], v10 offset:32768
  v_mfma_f32_32x32x16_bf16 a[48:63], v[124:127], v[96:99], a[48:63]
  ds_read_b128 v[84:87], v10 offset:34816
  s_add_u32 m0, s25, 98304
  s_nop 0
  buffer_load_dwordx4 v6, s[8:11], s21 offen lds
  v_mfma_f32_32x32x16_bf16 a[64:79], v[112:115], v[100:103], a[64:79]
  ds_read_b128 v[88:91], v10 offset:36864
  v_mfma_f32_32x32x16_bf16 a[80:95], v[116:119], v[100:103], a[80:95]
  ds_read_b128 v[92:95], v10 offset:38912
  v_mfma_f32_32x32x16_bf16 a[96:111], v[120:123], v[100:103], a[96:111]
  ds_read_b64_tr_b16 v[68:69], v15 offset:32768
  v_mfma_f32_32x32x16_bf16 a[112:127], v[124:127], v[100:103], a[112:127]
  ds_read_b64_tr_b16 v[70:71], v15 offset:34816
  s_add_u32 m0, s25, 99328
  s_nop 0
  buffer_load_dwordx4 v7, s[8:11], s21 offen lds
  v_mfma_f32_32x32x16_bf16 a[128:143], v[112:115], v[104:107], a[128:143]
  ds_read_b64_tr_b16 v[72:73], v16 offset:32768
  v_mfma_f32_32x32x16_bf16 a[144:159], v[116:119], v[104:107], a[144:159]
  ds_read_b64_tr_b16 v[74:75], v16 offset:34816
  v_mfma_f32_32x32x16_bf16 a[160:175], v[120:123], v[104:107], a[160:175]
  ds_read_b64_tr_b16 v[76:77], v17 offset:32768
  v_mfma_f32_32x32x16_bf16 a[176:191], v[124:127], v[104:107], a[176:191]
  ds_read_b64_tr_b16 v[78:79], v17 offset:34816
  s_add_u32 m0, s25, 100352
  s_nop 0
  buffer_load_dwordx4 v8, s[8:11], s21 offen lds
  v_mfma_f32_32x32x16_bf16 a[192:207], v[112:115], v[108:111], a[192:207]
  v_mfma_f32_32x32x16_bf16 a[208:223], v[116:119], v[108:111], a[208:223]
  v_mfma_f32_32x32x16_bf16 a[224:239], v[120:123], v[108:111], a[224:239]
  v_mfma_f32_32x32x16_bf16 a[240:255], v[124:127], v[108:111], a[240:255]
  s_add_u32 m0, s25, 101376
  s_nop 0
  buffer_load_dwordx4 v9, s[8:11], s21 offen lds
  s_add_u32 s20, s20, 64
  s_add_u32 s21, s21, s23
  s_waitcnt lgkmcnt(0)
  v_mfma_f32_32x32x16_bf16 a[0:15], v[80:83], v[64:67], a[0:15]
  ds_read_b64_tr_b16 v[96:97], v14 offset:40960
  v_mfma_f32_32x32x16_bf16 a[16:31], v[84:87], v[64:67], a[16:31]
  ds_read_b64_tr_b16 v[98:99], v14 offset:43008
  v_mfma_f32_32x32x16_bf16 a[32:47], v[88:91], v[64:67], a[32:47]
  ds_read_b128 v[112:115], v11 offset:32768
  v_mfma_f32_32x32x16_bf16 a[48:63], v[92:95], v[64:67], a[48:63]
  ds_read_b128 v[116:119], v11 offset:34816
  v_mfma_f32_32x32x16_bf16 a[64:79], v[80:83], v[68:71], a[64:79]
  ds_read_b128 v[120:123], v11 offset:36864
  v_mfma_f32_32x32x16_bf16 a[80:95], v[84:87], v[68:71], a[80:95]
  ds_read_b128 v[124:127], v11 offset:38912
  v_mfma_f32_32x32x16_bf16 a[96:111], v[88:91], v[68:71], a[96:111]
  ds_read_b64_tr_b16 v[100:101], v15 offset:40960
  v_mfma_f32_32x32x16_bf16 a[112:127], v[92:95], v[68:71], a[112:127]
  ds_read_b64_tr_b16 v[102:103], v15 offset:43008
  v_mfma_f32_32x32x16_bf16 a[128:143], v[80:83], v[72:75], a[128:143]
  ds_read_b64_tr_b16 v[104:105], v16 offset:40960
  v_mfma_f32_32x32x16_bf16 a[144:159], v[84:87], v[72:75], a[144:159]
  ds_read_b64_tr_b16 v[106:107], v16 offset:43008
  v_mfma_f32_32x32x16_bf16 a[160:175], v[88:91], v[72:75], a[160:175]
  ds_read_b64_tr_b16 v[108:109], v17 offset:40960
  v_mfma_f32_32x32x16_bf16 a[176:191], v[92:95], v[72:75], a[176:191]
  ds_read_b64_tr_b16 v[110:111], v17 offset:43008
  v_mfma_f32_32x32x16_bf16 a[192:207], v[80:83], v[76:79], a[192:207]
  v_mfma_f32_32x32x16_bf16 a[208:223], v[84:87], v[76:79], a[208:223]
  v_mfma_f32_32x32x16_bf16 a[224:239], v[88:91], v[76:79], a[224:239]
  v_mfma_f32_32x32x16_bf16 a[240:255], v[92:95], v[76:79], a[240:255]
  s_waitcnt vmcnt(8) lgkmcnt(0)
  s_barrier
  v_mfma_f32_32x32x16_bf16 a[0:15], v[112:115], v[96:99], a[0:15]
  ds_read_b64_tr_b16 v[64:65], v18 offset:0
  v_mfma_f32_32x32x16_bf16 a[16:31], v[116:119], v[96:99], a[16:31]
  ds_read_b64_tr_b16 v[66:67], v18 offset:2048
  v_mfma_f32_32x32x16_bf16 a[32:47], v[120:123], v[96:99], a[32:47]
  ds_read_b128 v[80:83], v12 offset:0
  v_mfma_f32_32x32x16_bf16 a[48:63], v[124:127], v[96:99], a[48:63]
  ds_read_b128 v[84:87], v12 offset:2048
  v_mfma_f32_32x32x16_bf16 a[64:79], v[112:115], v[100:103], a[64:79]
  ds_read_b128 v[88:91], v12 offset:4096
  v_mfma_f32_32x32x16_bf16 a[80:95], v[116:119], v[100:103], a[80:95]
  ds_read_b128 v[92:95], v12 offset:6144
  v_mfma_f32_32x32x16_bf16 a[96:111], v[120:123], v[100:103], a[96:111]
  ds_read_b64_tr_b16 v[68:69], v19 offset:0
  v_mfma_f32_32x32x16_bf16 a[112:127], v[124:127], v[100:103], a[112:127]
  ds_read_b64_tr_b16 v[70:71], v19 offset:2048
  v_mfma_f32_32x32x16_bf16 a[128:143], v[112:115], v[104:107], a[128:143]
  ds_read_b64_tr_b16 v[72:73], v20 offset:0
  v_mfma_f32_32x32x16_bf16 a[144:159], v[116:119], v[104:107], a[144:159]
  ds_read_b64_tr_b16 v[74:75], v20 offset:2048
  v_mfma_f32_32x32x16_bf16 a[160:175], v[120:123], v[104:107], a[160:175]
  ds_read_b64_tr_b16 v[76:77], v21 offset:0
  v_mfma_f32_32x32x16_bf16 a[176:191], v[124:127], v[104:107], a[176:191]
  ds_read_b64_tr_b16 v[78:79], v21 offset:2048
  v_mfma_f32_32x32x16_bf16 a[192:207], v[112:115], v[108:111], a[192:207]
  v_mfma_f32_32x32x16_bf16 a[208:223], v[116:119], v[108:111], a[208:223]
  v_mfma_f32_32x32x16_bf16 a[224:239], v[120:123], v[108:111], a[224:239]
  v_mfma_f32_32x32x16_bf16 a[240:255], v[124:127], v[108:111], a[240:255]
  s_waitcnt lgkmcnt(0)
  v_mfma_f32_32x32x16_bf16 a[0:15], v[80:83], v[64:67], a[0:15]
  ds_read_b64_tr_b16 v[96:97], v18 offset:8192
  v_mfma_f32_32x32x16_bf16 a[16:31], v[84:87], v[64:67], a[16:31]
  ds_read_b64_tr_b16 v[98:99], v18 offset:10240
  v_mfma_f32_32x32x16_bf16 a[32:47], v[88:91], v[64:67], a[32:47]
  ds_read_b128 v[112:115], v13 offset:0
  v_mfma_f32_32x32x16_bf16 a[48:63], v[92:95], v[64:67], a[48:63]
  ds_read_b128 v[116:119], v13 offset:2048
  v_mfma_f32_32x32x16_bf16 a[64:79], v[80:83], v[68:71], a[64:79]
  ds_read_b128 v[120:123], v13 offset:4096
  v_mfma_f32_32x32x16_bf16 a[80:95], v[84:87], v[68:71], a[80:95]
  ds_read_b128 v[124:127], v13 offset:6144
  v_mfma_f32_32x32x16_bf16 a[96:111], v[88:91], v[68:71], a[96:111]
  ds_read_b64_tr_b16 v[100:101], v19 offset:8192
  v_mfma_f32_32x32x16_bf16 a[112:127], v[92:95], v[68:71], a[112:127]
  ds_read_b64_tr_b16 v[102:103], v19 offset:10240
  v_mfma_f32_32x32x16_bf16 a[128:143], v[80:83], v[72:75], a[128:143]
  ds_read_b64_tr_b16 v[104:105], v20 offset:8192
  v_mfma_f32_32x32x16_bf16 a[144:159], v[84:87], v[72:75], a[144:159]
  ds_read_b64_tr_b16 v[106:107], v20 offset:10240
  v_mfma_f32_32x32x16_bf16 a[160:175], v[88:91], v[72:75], a[160:175]
  ds_read_b64_tr_b16 v[108:109], v21 offset:8192
  v_mfma_f32_32x32x16_bf16 a[176:191], v[92:95], v[72:75], a[176:191]
  ds_read_b64_tr_b16 v[110:111], v21 offset:10240
  v_mfma_f32_32x32x16_bf16 a[192:207], v[80:83], v[76:79], a[192:207]
  v_mfma_f32_32x32x16_bf16 a[208:223], v[84:87], v[76:79], a[208:223]
  v_mfma_f32_32x32x16_bf16 a[224:239], v[88:91], v[76:79], a[224:239]
  v_mfma_f32_32x32x16_bf16 a[240:255], v[92:95], v[76:79], a[240:255]
  s_waitcnt vmcnt(0) lgkmcnt(0)
  s_barrier
  v_mfma_f32_32x32x16_bf16 a[0:15], v[112:115], v[96:99], a[0:15]
  ds_read_b64_tr_b16 v[64:65], v18 offset:32768
  v_mfma_f32_32x32x16_bf16 a[16:31], v[116:119], v[96:99], a[16:31]
  ds_read_b64_tr_b16 v[66:67], v18 offset:34816
  v_mfma_f32_32x32x16_bf16 a[32:47], v[120:123], v[96:99], a[32:47]
  ds_read_b128 v[80:83], v12 offset:32768
  v_mfma_f32_32x32x16_bf16 a[48:63], v[124:127], v[96:99], a[48:63]
  ds_read_b128 v[84:87], v12 offset:34816
  v_mfma_f32_32x32x16_bf16 a[64:79], v[112:115], v[100:103], a[64:79]
  ds_read_b128 v[88:91], v12 offset:36864
  v_mfma_f32_32x32x16_bf16 a[80:95], v[116:119], v[100:103], a[80:95]
  ds_read_b128 v[92:95], v12 offset:38912
  v_mfma_f32_32x32x16_bf16 a[96:111], v[120:123], v[100:103], a[96:111]
  ds_read_b64_tr_b16 v[68:69], v19 offset:32768
  v_mfma_f32_32x32x16_bf16 a[112:127], v[124:127], v[100:103], a[112:127]
  ds_read_b64_tr_b16 v[70:71], v19 offset:34816
  v_mfma_f32_32x32x16_bf16 a[128:143], v[112:115], v[104:107], a[128:143]
  ds_read_b64_tr_b16 v[72:73], v20 offset:32768
  v_mfma_f32_32x32x16_bf16 a[144:159], v[116:119], v[104:107], a[144:159]
  ds_read_b64_tr_b16 v[74:75], v20 offset:34816
  v_mfma_f32_32x32x16_bf16 a[160:175], v[120:123], v[104:107], a[160:175]
  ds_read_b64_tr_b16 v[76:77], v21 offset:32768
  v_mfma_f32_32x32x16_bf16 a[176:191], v[124:127], v[104:107], a[176:191]
  ds_read_b64_tr_b16 v[78:79], v21 offset:34816
  v_mfma_f32_32x32x16_bf16 a[192:207], v[112:115], v[108:111], a[192:207]
  v_mfma_f32_32x32x16_bf16 a[208:223], v[116:119], v[108:111], a[208:223]
  v_mfma_f32_32x32x16_bf16 a[224:239], v[120:123], v[108:111], a[224:239]
  v_mfma_f32_32x32x16_bf16 a[240:255], v[124:127], v[108:111], a[240:255]
  s_waitcnt lgkmcnt(0)
  v_mfma_f32_32x32x16_bf16 a[0:15], v[80:83], v[64:67], a[0:15]
  ds_read_b64_tr_b16 v[96:97], v18 offset:40960
  v_mfma_f32_32x32x16_bf16 a[16:31], v[84:87], v[64:67], a[16:31]
  ds_read_b64_tr_b16 v[98:99], v18 offset:43008
  v_mfma_f32_32x32x16_bf16 a[32:47], v[88:91], v[64:67], a[32:47]
  ds_read_b128 v[112:115], v13 offset:32768
  v_mfma_f32_32x32x16_bf16 a[48:63], v[92:95], v[64:67], a[48:63]
  ds_read_b128 v[116:119], v13 offset:34816
  v_mfma_f32_32x32x16_bf16 a[64:79], v[80:83], v[68:71], a[64:79]
  ds_read_b128 v[120:123], v13 offset:36864
  v_mfma_f32_32x32x16_bf16 a[80:95], v[84:87], v[68:71], a[80:95]
  ds_read_b128 v[124:127], v13 offset:38912
  v_mfma_f32_32x32x16_bf16 a[96:111], v[88:91], v[68:71], a[96:111]
  ds_read_b64_tr_b16 v[100:101], v19 offset:40960
  v_mfma_f32_32x32x16_bf16 a[112:127], v[92:95], v[68:71], a[112:127]
  ds_read_b64_tr_b16 v[102:103], v19 offset:43008
  v_mfma_f32_32x32x16_bf16 a[128:143], v[80:83], v[72:75], a[128:143]
  ds_read_b64_tr_b16 v[104:105], v20 offset:40960
  v_mfma_f32_32x32x16_bf16 a[144:159], v[84:87], v[72:75], a[144:159]
  ds_read_b64_tr_b16 v[106:107], v20 offset:43008
  v_mfma_f32_32x32x16_bf16 a[160:175], v[88:91], v[72:75], a[160:175]
  ds_read_b64_tr_b16 v[108:109], v21 offset:40960
  v_mfma_f32_32x32x16_bf16 a[176:191], v[92:95], v[72:75], a[176:191]
  ds_read_b64_tr_b16 v[110:111], v21 offset:43008
  v_mfma_f32_32x32x16_bf16 a[192:207], v[80:83], v[76:79], a[192:207]
  v_mfma_f32_32x32x16_bf16 a[208:223], v[84:87], v[76:79], a[208:223]
  v_mfma_f32_32x32x16_bf16 a[224:239], v[88:91], v[76:79], a[224:239]
  v_mfma_f32_32x32x16_bf16 a[240:255], v[92:95], v[76:79], a[240:255]
  s_waitcnt lgkmcnt(0)
  v_mfma_f32_32x32x16_bf16 a[0:15], v[112:115], v[96:99], a[0:15]
  v_mfma_f32_32x32x16_bf16 a[16:31], v[116:119], v[96:99], a[16:31]
  v_mfma_f32_32x32x16_bf16 a[32:47], v[120:123], v[96:99], a[32:47]
  v_mfma_f32_32x32x16_bf16 a[48:63], v[124:127], v[96:99], a[48:63]
  v_mfma_f32_32x32x16_bf16 a[64:79], v[112:115], v[100:103], a[64:79]
  v_mfma_f32_32x32x16_bf16 a[80:95], v[116:119], v[100:103], a[80:95]
  v_mfma_f32_32x32x16_bf16 a[96:111], v[120:123], v[100:103], a[96:111]
  v_mfma_f32_32x32x16_bf16 a[112:127], v[124:127], v[100:103], a[112:127]
  v_mfma_f32_32x32x16_bf16 a[128:143], v[112:115], v[104:107], a[128:143]
  v_mfma_f32_32x32x16_bf16 a[144:159], v[116:119], v[104:107], a[144:159]
  v_mfma_f32_32x32x16_bf16 a[160:175], v[120:123], v[104:107], a[160:175]
  v_mfma_f32_32x32x16_bf16 a[176:191], v[124:127], v[104:107], a[176:191]
  v_mfma_f32_32x32x16_bf16 a[192:207], v[112:115], v[108:111], a[192:207]
  v_mfma_f32_32x32x16_bf16 a[208:223], v[116:119], v[108:111], a[208:223]
  v_mfma_f32_32x32x16_bf16 a[224:239], v[120:123], v[108:111], a[224:239]
  v_mfma_f32_32x32x16_bf16 a[240:255], v[124:127], v[108:111], a[240:255]
  s_cmp_eq_u32 s31, 1
  s_cbranch_scc1 BGG_EFRAG
  s_cmp_ge_u32 s35, 640
  s_cbranch_scc1 BGG_NEXT
  s_nop 7
  s_nop 7
  v_lshrrev_b32 v22, 5, v1
  v_mul_u32_u24 v22, 320, v22
  v_and_b32 v23, 31, v1
  s_mov_b32 s36, 52429
  s_mov_b32 s37, 81920
  s_add_u32 s34, s35, 0
  v_add_u32 v26, s34, v23
  v_mul_u32_u24 v27, s36, v26
  v_lshrrev_b32 v27, 20, v27
  v_mul_u32_u24 v28, 20, v27
  v_sub_u32 v28, v26, v28
  v_lshlrev_b32 v28, 4, v28
  v_mul_u32_u24 v27, s37, v27
  v_add3_u32 v32, v27, v28, v22
  v_accvgpr_read_b32 v40, a0
  v_accvgpr_read_b32 v41, a1
  v_accvgpr_read_b32 v42, a2
  v_accvgpr_read_b32 v43, a3
  v_accvgpr_read_b32 v44, a4
  v_accvgpr_read_b32 v45, a5
  v_accvgpr_read_b32 v46, a6
  v_accvgpr_read_b32 v47, a7
  v_accvgpr_read_b32 v48, a8
  v_accvgpr_read_b32 v49, a9
  v_accvgpr_read_b32 v50, a10
  v_accvgpr_read_b32 v51, a11
  v_accvgpr_read_b32 v52, a12
  v_accvgpr_read_b32 v53, a13
  v_accvgpr_read_b32 v54, a14
  v_accvgpr_read_b32 v55, a15
  v_cvt_pk_bf16_f32 v128, v40, v41
  v_cvt_pk_bf16_f32 v129, v42, v43
  v_cvt_pk_bf16_f32 v130, v44, v45
  v_cvt_pk_bf16_f32 v131, v46, v47
  v_cvt_pk_bf16_f32 v132, v48, v49
  v_cvt_pk_bf16_f32 v133, v50, v51
  v_cvt_pk_bf16_f32 v134, v52, v53
  v_cvt_pk_bf16_f32 v135, v54, v55
  s_add_u32 s34, s30, 0
  buffer_store_dwordx4 v[128:131], v32, s[12:15], s34 offen sc1
  buffer_store_dwordx4 v[132:135], v32, s[12:15], s34 offen offset:640 sc1
  v_accvgpr_read_b32 v40, a16
  v_accvgpr_read_b32 v41, a17
  v_accvgpr_read_b32 v42, a18
  v_accvgpr_read_b32 v43, a19
  v_accvgpr_read_b32 v44, a20
  v_accvgpr_read_b32 v45, a21
  v_accvgpr_read_b32 v46, a22
  v_accvgpr_read_b32 v47, a23
  v_accvgpr_read_b32 v48, a24
  v_accvgpr_read_b32 v49, a25
  v_accvgpr_read_b32 v50, a26
  v_accvgpr_read_b32 v51, a27
  v_accvgpr_read_b32 v52, a28
  v_accvgpr_read_b32 v53, a29
  v_accvgpr_read_b32 v54, a30
  v_accvgpr_read_b32 v55, a31
  v_cvt_pk_bf16_f32 v136, v40, v41
  v_cvt_pk_bf16_f32 v137, v42, v43
  v_cvt_pk_bf16_f32 v138, v44, v45
  v_cvt_pk_bf16_f32 v139, v46, v47
  v_cvt_pk_bf16_f32 v140, v48, v49
  v_cvt_pk_bf16_f32 v141, v50, v51
  v_cvt_pk_bf16_f32 v142, v52, v53
  v_cvt_pk_bf16_f32 v143, v54, v55
  s_add_u32 s34, s30, 1280
  buffer_store_dwordx4 v[136:139], v32, s[12:15], s34 offen sc1
  buffer_store_dwordx4 v[140:143], v32, s[12:15], s34 offen offset:640 sc1
  v_accvgpr_read_b32 v40, a32
  v_accvgpr_read_b32 v41, a33
  v_accvgpr_read_b32 v42, a34
  v_accvgpr_read_b32 v43, a35
  v_accvgpr_read_b32 v44, a36
  v_accvgpr_read_b32 v45, a37
  v_accvgpr_read_b32 v46, a38
  v_accvgpr_read_b32 v47, a39
  v_accvgpr_read_b32 v48, a40
  v_accvgpr_read_b32 v49, a41
  v_accvgpr_read_b32 v50, a42
  v_accvgpr_read_b32 v51, a43
  v_accvgpr_read_b32 v52, a44
  v_accvgpr_read_b32 v53, a45
  v_accvgpr_read_b32 v54, a46
  v_accvgpr_read_b32 v55, a47
  v_cvt_pk_bf16_f32 v144, v40, v41
  v_cvt_pk_bf16_f32 v145, v42, v43
  v_cvt_pk_bf16_f32 v146, v44, v45
  v_cvt_pk_bf16_f32 v147, v46, v47
  v_cvt_pk_bf16_f32 v148, v48, v49
  v_cvt_pk_bf16_f32 v149, v50, v51
  v_cvt_pk_bf16_f32 v150, v52, v53
  v_cvt_pk_bf16_f32 v151, v54, v55
  s_add_u32 s34, s30, 2560
  buffer_store_dwordx4 v[144:147], v32, s[12:15], s34 offen sc1
  buffer_store_dwordx4 v[148:151], v32, s[12:15], s34 offen offset:640 sc1
  v_accvgpr_read_b32 v40, a48
  v_accvgpr_read_b32 v41, a49
  v_accvgpr_read_b32 v42, a50
  v_accvgpr_read_b32 v43, a51
  v_accvgpr_read_b32 v44, a52
  v_accvgpr_read_b32 v45, a53
  v_accvgpr_read_b32 v46, a54
  v_accvgpr_read_b32 v47, a55
  v_accvgpr_read_b32 v48, a56
  v_accvgpr_read_b32 v49, a57
  v_accvgpr_read_b32 v50, a58
  v_accvgpr_read_b32 v51, a59
  v_accvgpr_read_b32 v52, a60
  v_accvgpr_read_b32 v53, a61
  v_accvgpr_read_b32 v54, a62
  v_accvgpr_read_b32 v55, a63
  v_cvt_pk_bf16_f32 v152, v40, v41
  v_cvt_pk_bf16_f32 v153, v42, v43
  v_cvt_pk_bf16_f32 v154, v44, v45
  v_cvt_pk_bf16_f32 v155, v46, v47
  v_cvt_pk_bf16_f32 v156, v48, v49
  v_cvt_pk_bf16_f32 v157, v50, v51
  v_cvt_pk_bf16_f32 v158, v52, v53
  v_cvt_pk_bf16_f32 v159, v54, v55
  s_add_u32 s34, s30, 3840
  buffer_store_dwordx4 v[152:155], v32, s[12:15], s34 offen sc1
  buffer_store_dwordx4 v[156:159], v32, s[12:15], s34 offen offset:640 sc1
  s_add_u32 s34, s35, 32
  v_add_u32 v26, s34, v23
  v_mul_u32_u24 v27, s36, v26
  v_lshrrev_b32 v27, 20, v27
  v_mul_u32_u24 v28, 20, v27
  v_sub_u32 v28, v26, v28
  v_lshlrev_b32 v28, 4, v28
  v_mul_u32_u24 v27, s37, v27
  v_add3_u32 v32, v27, v28, v22
  v_accvgpr_read_b32 v40, a64
  v_accvgpr_read_b32 v41, a65
  v_accvgpr_read_b32 v42, a66
  v_accvgpr_read_b32 v43, a67
  v_accvgpr_read_b32 v44, a68
  v_accvgpr_read_b32 v45, a69
  v_accvgpr_read_b32 v46, a70
  v_accvgpr_read_b32 v47, a71
  v_accvgpr_read_b32 v48, a72
  v_accvgpr_read_b32 v49, a73
  v_accvgpr_read_b32 v50, a74
  v_accvgpr_read_b32 v51, a75
  v_accvgpr_read_b32 v52, a76
  v_accvgpr_read_b32 v53, a77
  v_accvgpr_read_b32 v54, a78
  v_accvgpr_read_b32 v55, a79
  v_cvt_pk_bf16_f32 v128, v40, v41
  v_cvt_pk_bf16_f32 v129, v42, v43
  v_cvt_pk_bf16_f32 v130, v44, v45
  v_cvt_pk_bf16_f32 v131, v46, v47
  v_cvt_pk_bf16_f32 v132, v48, v49
  v_cvt_pk_bf16_f32 v133, v50, v51
  v_cvt_pk_bf16_f32 v134, v52, v53
  v_cvt_pk_bf16_f32 v135, v54, v55
  s_add_u32 s34, s30, 0
  buffer_store_dwordx4 v[128:131], v32, s[12:15], s34 offen sc1
  buffer_store_dwordx4 v[132:135], v32, s[12:15], s34 offen offset:640 sc1
  v_accvgpr_read_b32 v40, a80
  v_accvgpr_read_b32 v41, a81
  v_accvgpr_read_b32 v42, a82
  v_accvgpr_read_b32 v43, a83
  v_accvgpr_read_b32 v44, a84
  v_accvgpr_read_b32 v45, a85
  v_accvgpr_read_b32 v46, a86
  v_accvgpr_read_b32 v47, a87
  v_accvgpr_read_b32 v48, a88
  v_accvgpr_read_b32 v49, a89
  v_accvgpr_read_b32 v50, a90
  v_accvgpr_read_b32 v51, a91
  v_accvgpr_read_b32 v52, a92
  v_accvgpr_read_b32 v53, a93
  v_accvgpr_read_b32 v54, a94
  v_accvgpr_read_b32 v55, a95
  v_cvt_pk_bf16_f32 v136, v40, v41
  v_cvt_pk_bf16_f32 v137, v42, v43
  v_cvt_pk_bf16_f32 v138, v44, v45
  v_cvt_pk_bf16_f32 v139, v46, v47
  v_cvt_pk_bf16_f32 v140, v48, v49
  v_cvt_pk_bf16_f32 v141, v50, v51
  v_cvt_pk_bf16_f32 v142, v52, v53
  v_cvt_pk_bf16_f32 v143, v54, v55
  s_add_u32 s34, s30, 1280
  buffer_store_dwordx4 v[136:139], v32, s[12:15], s34 offen sc1
  buffer_store_dwordx4 v[140:143], v32, s[12:15], s34 offen offset:640 sc1
  v_accvgpr_read_b32 v40, a96
  v_accvgpr_read_b32 v41, a97
  v_accvgpr_read_b32 v42, a98
  v_accvgpr_read_b32 v43, a99
  v_accvgpr_read_b32 v44, a100
  v_accvgpr_read_b32 v45, a101
  v_accvgpr_read_b32 v46, a102
  v_accvgpr_read_b32 v47, a103
  v_accvgpr_read_b32 v48, a104
  v_accvgpr_read_b32 v49, a105
  v_accvgpr_read_b32 v50, a106
  v_accvgpr_read_b32 v51, a107
  v_accvgpr_read_b32 v52, a108
  v_accvgpr_read_b32 v53, a109
  v_accvgpr_read_b32 v54, a110
  v_accvgpr_read_b32 v55, a111
  v_cvt_pk_bf16_f32 v144, v40, v41
  v_cvt_pk_bf16_f32 v145, v42, v43
  v_cvt_pk_bf16_f32 v146, v44, v45
  v_cvt_pk_bf16_f32 v147, v46, v47
  v_cvt_pk_bf16_f32 v148, v48, v49
  v_cvt_pk_bf16_f32 v149, v50, v51
  v_cvt_pk_bf16_f32 v150, v52, v53
  v_cvt_pk_bf16_f32 v151, v54, v55
  s_add_u32 s34, s30, 2560
  buffer_store_dwordx4 v[144:147], v32, s[12:15], s34 offen sc1
  buffer_store_dwordx4 v[148:151], v32, s[12:15], s34 offen offset:640 sc1
  v_accvgpr_read_b32 v40, a112
  v_accvgpr_read_b32 v41, a113
  v_accvgpr_read_b32 v42, a114
  v_accvgpr_read_b32 v43, a115
  v_accvgpr_read_b32 v44, a116
  v_accvgpr_read_b32 v45, a117
  v_accvgpr_read_b32 v46, a118
  v_accvgpr_read_b32 v47, a119
  v_accvgpr_read_b32 v48, a120
  v_accvgpr_read_b32 v49, a121
  v_accvgpr_read_b32 v50, a122
  v_accvgpr_read_b32 v51, a123
  v_accvgpr_read_b32 v52, a124
  v_accvgpr_read_b32 v53, a125
  v_accvgpr_read_b32 v54, a126
  v_accvgpr_read_b32 v55, a127
  v_cvt_pk_bf16_f32 v152, v40, v41
  v_cvt_pk_bf16_f32 v153, v42, v43
  v_cvt_pk_bf16_f32 v154, v44, v45
  v_cvt_pk_bf16_f32 v155, v46, v47
  v_cvt_pk_bf16_f32 v156, v48, v49
  v_cvt_pk_bf16_f32 v157, v50, v51
  v_cvt_pk_bf16_f32 v158, v52, v53
  v_cvt_pk_bf16_f32 v159, v54, v55
  s_add_u32 s34, s30, 3840
  buffer_store_dwordx4 v[152:155], v32, s[12:15], s34 offen sc1
  buffer_store_dwordx4 v[156:159], v32, s[12:15], s34 offen offset:640 sc1
  s_add_u32 s34, s35, 64
  v_add_u32 v26, s34, v23
  v_mul_u32_u24 v27, s36, v26
  v_lshrrev_b32 v27, 20, v27
  v_mul_u32_u24 v28, 20, v27
  v_sub_u32 v28, v26, v28
  v_lshlrev_b32 v28, 4, v28
  v_mul_u32_u24 v27, s37, v27
  v_add3_u32 v32, v27, v28, v22
  v_accvgpr_read_b32 v40, a128
  v_accvgpr_read_b32 v41, a129
  v_accvgpr_read_b32 v42, a130
  v_accvgpr_read_b32 v43, a131
  v_accvgpr_read_b32 v44, a132
  v_accvgpr_read_b32 v45, a133
  v_accvgpr_read_b32 v46, a134
  v_accvgpr_read_b32 v47, a135
  v_accvgpr_read_b32 v48, a136
  v_accvgpr_read_b32 v49, a137
  v_accvgpr_read_b32 v50, a138
  v_accvgpr_read_b32 v51, a139
  v_accvgpr_read_b32 v52, a140
  v_accvgpr_read_b32 v53, a141
  v_accvgpr_read_b32 v54, a142
  v_accvgpr_read_b32 v55, a143
  v_cvt_pk_bf16_f32 v128, v40, v41
  v_cvt_pk_bf16_f32 v129, v42, v43
  v_cvt_pk_bf16_f32 v130, v44, v45
  v_cvt_pk_bf16_f32 v131, v46, v47
  v_cvt_pk_bf16_f32 v132, v48, v49
  v_cvt_pk_bf16_f32 v133, v50, v51
  v_cvt_pk_bf16_f32 v134, v52, v53
  v_cvt_pk_bf16_f32 v135, v54, v55
  s_add_u32 s34, s30, 0
  buffer_store_dwordx4 v[128:131], v32, s[12:15], s34 offen sc1
  buffer_store_dwordx4 v[132:135], v32, s[12:15], s34 offen offset:640 sc1
  v_accvgpr_read_b32 v40, a144
  v_accvgpr_read_b32 v41, a145
  v_accvgpr_read_b32 v42, a146
  v_accvgpr_read_b32 v43, a147
  v_accvgpr_read_b32 v44, a148
  v_accvgpr_read_b32 v45, a149
  v_accvgpr_read_b32 v46, a150
  v_accvgpr_read_b32 v47, a151
  v_accvgpr_read_b32 v48, a152
  v_accvgpr_read_b32 v49, a153
  v_accvgpr_read_b32 v50, a154
  v_accvgpr_read_b32 v51, a155
  v_accvgpr_read_b32 v52, a156
  v_accvgpr_read_b32 v53, a157
  v_accvgpr_read_b32 v54, a158
  v_accvgpr_read_b32 v55, a159
  v_cvt_pk_bf16_f32 v136, v40, v41
  v_cvt_pk_bf16_f32 v137, v42, v43
  v_cvt_pk_bf16_f32 v138, v44, v45
  v_cvt_pk_bf16_f32 v139, v46, v47
  v_cvt_pk_bf16_f32 v140, v48, v49
  v_cvt_pk_bf16_f32 v141, v50, v51
  v_cvt_pk_bf16_f32 v142, v52, v53
  v_cvt_pk_bf16_f32 v143, v54, v55
  s_add_u32 s34, s30, 1280
  buffer_store_dwordx4 v[136:139], v32, s[12:15], s34 offen sc1
  buffer_store_dwordx4 v[140:143], v32, s[12:15], s34 offen offset:640 sc1
  v_accvgpr_read_b32 v40, a160
  v_accvgpr_read_b32 v41, a161
  v_accvgpr_read_b32 v42, a162
  v_accvgpr_read_b32 v43, a163
  v_accvgpr_read_b32 v44, a164
  v_accvgpr_read_b32 v45, a165
  v_accvgpr_read_b32 v46, a166
  v_accvgpr_read_b32 v47, a167
  v_accvgpr_read_b32 v48, a168
  v_accvgpr_read_b32 v49, a169
  v_accvgpr_read_b32 v50, a170
  v_accvgpr_read_b32 v51, a171
  v_accvgpr_read_b32 v52, a172
  v_accvgpr_read_b32 v53, a173
  v_accvgpr_read_b32 v54, a174
  v_accvgpr_read_b32 v55, a175
  v_cvt_pk_bf16_f32 v144, v40, v41
  v_cvt_pk_bf16_f32 v145, v42, v43
  v_cvt_pk_bf16_f32 v146, v44, v45
  v_cvt_pk_bf16_f32 v147, v46, v47
  v_cvt_pk_bf16_f32 v148, v48, v49
  v_cvt_pk_bf16_f32 v149, v50, v51
  v_cvt_pk_bf16_f32 v150, v52, v53
  v_cvt_pk_bf16_f32 v151, v54, v55
  s_add_u32 s34, s30, 2560
  buffer_store_dwordx4 v[144:147], v32, s[12:15], s34 offen sc1
  buffer_store_dwordx4 v[148:151], v32, s[12:15], s34 offen offset:640 sc1
  v_accvgpr_read_b32 v40, a176
  v_accvgpr_read_b32 v41, a177
  v_accvgpr_read_b32 v42, a178
  v_accvgpr_read_b32 v43, a179
  v_accvgpr_read_b32 v44, a180
  v_accvgpr_read_b32 v45, a181
  v_accvgpr_read_b32 v46, a182
  v_accvgpr_read_b32 v47, a183
  v_accvgpr_read_b32 v48, a184
  v_accvgpr_read_b32 v49, a185
  v_accvgpr_read_b32 v50, a186
  v_accvgpr_read_b32 v51, a187
  v_accvgpr_read_b32 v52, a188
  v_accvgpr_read_b32 v53, a189
  v_accvgpr_read_b32 v54, a190
  v_accvgpr_read_b32 v55, a191
  v_cvt_pk_bf16_f32 v152, v40, v41
  v_cvt_pk_bf16_f32 v153, v42, v43
  v_cvt_pk_bf16_f32 v154, v44, v45
  v_cvt_pk_bf16_f32 v155, v46, v47
  v_cvt_pk_bf16_f32 v156, v48, v49
  v_cvt_pk_bf16_f32 v157, v50, v51
  v_cvt_pk_bf16_f32 v158, v52, v53
  v_cvt_pk_bf16_f32 v159, v54, v55
  s_add_u32 s34, s30, 3840
  buffer_store_dwordx4 v[152:155], v32, s[12:15], s34 offen sc1
  buffer_store_dwordx4 v[156:159], v32, s[12:15], s34 offen offset:640 sc1
  s_add_u32 s34, s35, 96
  v_add_u32 v26, s34, v23
  v_mul_u32_u24 v27, s36, v26
  v_lshrrev_b32 v27, 20, v27
  v_mul_u32_u24 v28, 20, v27
  v_sub_u32 v28, v26, v28
  v_lshlrev_b32 v28, 4, v28
  v_mul_u32_u24 v27, s37, v27
  v_add3_u32 v32, v27, v28, v22
  v_accvgpr_read_b32 v40, a192
  v_accvgpr_read_b32 v41, a193
  v_accvgpr_read_b32 v42, a194
  v_accvgpr_read_b32 v43, a195
  v_accvgpr_read_b32 v44, a196
  v_accvgpr_read_b32 v45, a197
  v_accvgpr_read_b32 v46, a198
  v_accvgpr_read_b32 v47, a199
  v_accvgpr_read_b32 v48, a200
  v_accvgpr_read_b32 v49, a201
  v_accvgpr_read_b32 v50, a202
  v_accvgpr_read_b32 v51, a203
  v_accvgpr_read_b32 v52, a204
  v_accvgpr_read_b32 v53, a205
  v_accvgpr_read_b32 v54, a206
  v_accvgpr_read_b32 v55, a207
  v_cvt_pk_bf16_f32 v128, v40, v41
  v_cvt_pk_bf16_f32 v129, v42, v43
  v_cvt_pk_bf16_f32 v130, v44, v45
  v_cvt_pk_bf16_f32 v131, v46, v47
  v_cvt_pk_bf16_f32 v132, v48, v49
  v_cvt_pk_bf16_f32 v133, v50, v51
  v_cvt_pk_bf16_f32 v134, v52, v53
  v_cvt_pk_bf16_f32 v135, v54, v55
  s_add_u32 s34, s30, 0
  buffer_store_dwordx4 v[128:131], v32, s[12:15], s34 offen sc1
  buffer_store_dwordx4 v[132:135], v32, s[12:15], s34 offen offset:640 sc1
  v_accvgpr_read_b32 v40, a208
  v_accvgpr_read_b32 v41, a209
  v_accvgpr_read_b32 v42, a210
  v_accvgpr_read_b32 v43, a211
  v_accvgpr_read_b32 v44, a212
  v_accvgpr_read_b32 v45, a213
  v_accvgpr_read_b32 v46, a214
  v_accvgpr_read_b32 v47, a215
  v_accvgpr_read_b32 v48, a216
  v_accvgpr_read_b32 v49, a217
  v_accvgpr_read_b32 v50, a218
  v_accvgpr_read_b32 v51, a219
  v_accvgpr_read_b32 v52, a220
  v_accvgpr_read_b32 v53, a221
  v_accvgpr_read_b32 v54, a222
  v_accvgpr_read_b32 v55, a223
  v_cvt_pk_bf16_f32 v136, v40, v41
  v_cvt_pk_bf16_f32 v137, v42, v43
  v_cvt_pk_bf16_f32 v138, v44, v45
  v_cvt_pk_bf16_f32 v139, v46, v47
  v_cvt_pk_bf16_f32 v140, v48, v49
  v_cvt_pk_bf16_f32 v141, v50, v51
  v_cvt_pk_bf16_f32 v142, v52, v53
  v_cvt_pk_bf16_f32 v143, v54, v55
  s_add_u32 s34, s30, 1280
  buffer_store_dwordx4 v[136:139], v32, s[12:15], s34 offen sc1
  buffer_store_dwordx4 v[140:143], v32, s[12:15], s34 offen offset:640 sc1
  v_accvgpr_read_b32 v40, a224
  v_accvgpr_read_b32 v41, a225
  v_accvgpr_read_b32 v42, a226
  v_accvgpr_read_b32 v43, a227
  v_accvgpr_read_b32 v44, a228
  v_accvgpr_read_b32 v45, a229
  v_accvgpr_read_b32 v46, a230
  v_accvgpr_read_b32 v47, a231
  v_accvgpr_read_b32 v48, a232
  v_accvgpr_read_b32 v49, a233
  v_accvgpr_read_b32 v50, a234
  v_accvgpr_read_b32 v51, a235
  v_accvgpr_read_b32 v52, a236
  v_accvgpr_read_b32 v53, a237
  v_accvgpr_read_b32 v54, a238
  v_accvgpr_read_b32 v55, a239
  v_cvt_pk_bf16_f32 v144, v40, v41
  v_cvt_pk_bf16_f32 v145, v42, v43
  v_cvt_pk_bf16_f32 v146, v44, v45
  v_cvt_pk_bf16_f32 v147, v46, v47
  v_cvt_pk_bf16_f32 v148, v48, v49
  v_cvt_pk_bf16_f32 v149, v50, v51
  v_cvt_pk_bf16_f32 v150, v52, v53
  v_cvt_pk_bf16_f32 v151, v54, v55
  s_add_u32 s34, s30, 2560
  buffer_store_dwordx4 v[144:147], v32, s[12:15], s34 offen sc1
  buffer_store_dwordx4 v[148:151], v32, s[12:15], s34 offen offset:640 sc1
  v_accvgpr_read_b32 v40, a240
  v_accvgpr_read_b32 v41, a241
  v_accvgpr_read_b32 v42, a242
  v_accvgpr_read_b32 v43, a243
  v_accvgpr_read_b32 v44, a244
  v_accvgpr_read_b32 v45, a245
  v_accvgpr_read_b32 v46, a246
  v_accvgpr_read_b32 v47, a247
  v_accvgpr_read_b32 v48, a248
  v_accvgpr_read_b32 v49, a249
  v_accvgpr_read_b32 v50, a250
  v_accvgpr_read_b32 v51, a251
  v_accvgpr_read_b32 v52, a252
  v_accvgpr_read_b32 v53, a253
  v_accvgpr_read_b32 v54, a254
  v_accvgpr_read_b32 v55, a255
  v_cvt_pk_bf16_f32 v152, v40, v41
  v_cvt_pk_bf16_f32 v153, v42, v43
  v_cvt_pk_bf16_f32 v154, v44, v45
  v_cvt_pk_bf16_f32 v155, v46, v47
  v_cvt_pk_bf16_f32 v156, v48, v49
  v_cvt_pk_bf16_f32 v157, v50, v51
  v_cvt_pk_bf16_f32 v158, v52, v53
  v_cvt_pk_bf16_f32 v159, v54, v55
  s_add_u32 s34, s30, 3840
  buffer_store_dwordx4 v[152:155], v32, s[12:15], s34 offen sc1
  buffer_store_dwordx4 v[156:159], v32, s[12:15], s34 offen offset:640 sc1
  s_branch BGG_NEXT
BGG_HALF:
  s_lshl_b32 s24, s26, 11
  s_mul_i32 s34, s26, 40960
  v_subrev_u32 v2, s34, v2
  v_add_u32 v3, 20480, v2
  s_lshl_b32 s34, s28, 12
  v_subrev_u32 v10, s34, v10
  v_subrev_u32 v11, s34, v11
  v_subrev_u32 v12, s34, v12
  v_subrev_u32 v13, s34, v13
  s_sub_u32 s34, s98, 1
  s_mul_i32 s36, s34, 163840
  s_add_u32 s20, s20, s36
  s_sub_u32 s34, s34, s28
  s_lshl_b32 s34, s34, 2
  s_lshl_b32 s36, s28, 1
  s_add_u32 s34, s34, s36
  s_mul_i32 s34, s34, 393216
  s_add_u32 s30, s30, s34
  s_cmp_eq_u32 s31, 1
  s_cbranch_scc1 BGG_HSWAP
  s_add_u32 m0, s24, 0
  s_nop 0
  buffer_load_dwordx4 v2, s[4:7], s20 offen lds
  s_add_u32 m0, s24, 1024
  s_nop 0
  buffer_load_dwordx4 v3, s[4:7], s20 offen lds
  s_add_u32 m0, s25, 0
  s_nop 0
  buffer_load_dwordx4 v6, s[8:11], s21 offen lds
  s_add_u32 m0, s25, 1024
  s_nop 0
  buffer_load_dwordx4 v7, s[8:11], s21 offen lds
  s_add_u32 m0, s25, 2048
  s_nop 0
  buffer_load_dwordx4 v8, s[8:11], s21 offen lds
  s_add_u32 m0, s25, 3072
  s_nop 0
  buffer_load_dwordx4 v9, s[8:11], s21 offen lds
  s_add_u32 s20, s20, 64
  s_add_u32 s21, s21, s23
  s_add_u32 m0, s24, 32768
  s_nop 0
  buffer_load_dwordx4 v2, s[4:7], s20 offen lds
  s_add_u32 m0, s24, 33792
  s_nop 0
  buffer_load_dwordx4 v3, s[4:7], s20 offen lds
  s_add_u32 m0, s25, 32768
  s_nop 0
  buffer_load_dwordx4 v6, s[8:11], s21 offen lds
  s_add_u32 m0, s25, 33792
  s_nop 0
  buffer_load_dwordx4 v7, s[8:11], s21 offen lds
  s_add_u32 m0, s25, 34816
  s_nop 0
  buffer_load_dwordx4 v8, s[8:11], s21 offen lds
  s_add_u32 m0, s25, 35840
  s_nop 0
  buffer_load_dwordx4 v9, s[8:11], s21 offen lds
  s_add_u32 s20, s20, 64
  s_add_u32 s21, s21, s23
  s_add_u32 m0, s24, 65536
  s_nop 0
  buffer_load_dwordx4 v2, s[4:7], s20 offen lds
  s_add_u32 m0, s24, 66560
  s_nop 0
  buffer_load_dwordx4 v3, s[4:7], s20 offen lds
  s_add_u32 m0, s25, 65536
  s_nop 0
  buffer_load_dwordx4 v6, s[8:11], s21 offen lds
  s_add_u32 m0, s25, 66560
  s_nop 0
  buffer_load_dwordx4 v7, s[8:11], s21 offen lds
  s_add_u32 m0, s25, 67584
  s_nop 0
  buffer_load_dwordx4 v8, s[8:11], s21 offen lds
  s_add_u32 m0, s25, 68608
  s_nop 0
  buffer_load_dwordx4 v9, s[8:11], s21 offen lds
  s_add_u32 s20, s20, 64
  s_add_u32 s21, s21, s23
  s_waitcnt vmcnt(12)
  s_barrier
  ds_read_b64_tr_b16 v[64:65], v14 offset:0
  ds_read_b64_tr_b16 v[66:67], v14 offset:2048
  ds_read_b128 v[80:83], v10 offset:0
  ds_read_b128 v[84:87], v10 offset:2048
  ds_read_b64_tr_b16 v[68:69], v15 offset:0
  ds_read_b64_tr_b16 v[70:71], v15 offset:2048
  ds_read_b64_tr_b16 v[72:73], v16 offset:0
  ds_read_b64_tr_b16 v[74:75], v16 offset:2048
  ds_read_b64_tr_b16 v[76:77], v17 offset:0
  ds_read_b64_tr_b16 v[78:79], v17 offset:2048
  s_waitcnt lgkmcnt(0)
  v_mfma_f32_32x32x16_bf16 a[0:15], v[64:67], v[80:83], 0
  ds_read_b64_tr_b16 v[96:97], v14 offset:8192
  ds_read_b64_tr_b16 v[98:99], v14 offset:10240
  v_mfma_f32_32x32x16_bf16 a[16:31], v[64:67], v[84:87], 0
  ds_read_b128 v[112:115], v11 offset:0
  ds_read_b128 v[116:119], v11 offset:2048
  v_mfma_f32_32x32x16_bf16 a[64:79], v[68:71], v[80:83], 0
  ds_read_b64_tr_b16 v[100:101], v15 offset:8192
  s_add_u32 m0, s24, 98304
  s_nop 0
  buffer_load_dwordx4 v2, s[4:7], s20 offen lds
  v_mfma_f32_32x32x16_bf16 a[80:95], v[68:71], v[84:87], 0
  ds_read_b64_tr_b16 v[102:103], v15 offset:10240
  v_mfma_f32_32x32x16_bf16 a[128:143], v[72:75], v[80:83], 0
  ds_read_b64_tr_b16 v[104:105], v16 offset:8192
  s_add_u32 m0, s24, 99328
  s_nop 0
  buffer_load_dwordx4 v3, s[4:7], s20 offen lds
  v_mfma_f32_32x32x16_bf16 a[144:159], v[72:75], v[84:87], 0
  ds_read_b64_tr_b16 v[106:107], v16 offset:10240
  v_mfma_f32_32x32x16_bf16 a[192:207], v[76:79], v[80:83], 0
  ds_read_b64_tr_b16 v[108:109], v17 offset:8192
  s_add_u32 m0, s25, 98304
  s_nop 0
  buffer_load_dwordx4 v6, s[8:11], s21 offen lds
  v_mfma_f32_32x32x16_bf16 a[208:223], v[76:79], v[84:87], 0
  ds_read_b64_tr_b16 v[110:111], v17 offset:10240
  s_waitcnt vmcnt(9) lgkmcnt(0)
  s_barrier
  v_mfma_f32_32x32x16_bf16 a[0:15], v[96:99], v[112:115], a[0:15]
  ds_read_b64_tr_b16 v[64:65], v14 offset:32768
  ds_read_b64_tr_b16 v[66:67], v14 offset:34816
  v_mfma_f32_32x32x16_bf16 a[16:31], v[96:99], v[116:119], a[16:31]
  ds_read_b128 v[80:83], v10 offset:32768
  ds_read_b128 v[84:87], v10 offset:34816
  v_mfma_f32_32x32x16_bf16 a[64:79], v[100:103], v[112:115], a[64:79]
  ds_read_b64_tr_b16 v[68:69], v15 offset:32768
  s_add_u32 m0, s25, 99328
  s_nop 0
  buffer_load_dwordx4 v7, s[8:11], s21 offen lds
  v_mfma_f32_32x32x16_bf16 a[80:95], v[100:103], v[116:119], a[80:95]
  ds_read_b64_tr_b16 v[70:71], v15 offset:34816
  v_mfma_f32_32x32x16_bf16 a[128:143], v[104:107], v[112:115], a[128:143]
  ds_read_b64_tr_b16 v[72:73], v16 offset:32768
  s_add_u32 m0, s25, 100352
  s_nop 0
  buffer_load_dwordx4 v8, s[8:11], s21 offen lds
  v_mfma_f32_32x32x16_bf16 a[144:159], v[104:107], v[116:119], a[144:159]
  ds_read_b64_tr_b16 v[74:75], v16 offset:34816
  v_mfma_f32_32x32x16_bf16 a[192:207], v[108:111], v[112:115], a[192:207]
  ds_read_b64_tr_b16 v[76:77], v17 offset:32768
  s_add_u32 m0, s25, 101376
  s_nop 0
  buffer_load_dwordx4 v9, s[8:11], s21 offen lds
  s_add_u32 s20, s20, 64
  s_add_u32 s21, s21, s23
  v_mfma_f32_32x32x16_bf16 a[208:223], v[108:111], v[116:119], a[208:223]
  ds_read_b64_tr_b16 v[78:79], v17 offset:34816
  s_waitcnt lgkmcnt(0)
  v_mfma_f32_32x32x16_bf16 a[0:15], v[64:67], v[80:83], a[0:15]
  ds_read_b64_tr_b16 v[96:97], v14 offset:40960
  ds_read_b64_tr_b16 v[98:99], v14 offset:43008
  v_mfma_f32_32x32x16_bf16 a[16:31], v[64:67], v[84:87], a[16:31]
  ds_read_b128 v[112:115], v11 offset:32768
  ds_read_b128 v[116:119], v11 offset:34816
  v_mfma_f32_32x32x16_bf16 a[64:79], v[68:71], v[80:83], a[64:79]
  ds_read_b64_tr_b16 v[100:101], v15 offset:40960
  s_add_u32 m0, s24, 0
  s_nop 0
  buffer_load_dwordx4 v2, s[4:7], s20 offen lds
  v_mfma_f32_32x32x16_bf16 a[80:95], v[68:71], v[84:87], a[80:95]
  ds_read_b64_tr_b16 v[102:103], v15 offset:43008
  v_mfma_f32_32x32x16_bf16 a[128:143], v[72:75], v[80:83], a[128:143]
  ds_read_b64_tr_b16 v[104:105], v16 offset:40960
  s_add_u32 m0, s24, 1024
  s_nop 0
  buffer_load_dwordx4 v3, s[4:7], s20 offen lds
  v_mfma_f32_32x32x16_bf16 a[144:159], v[72:75], v[84:87], a[144:159]
  ds_read_b64_tr_b16 v[106:107], v16 offset:43008
  v_mfma_f32_32x32x16_bf16 a[192:207], v[76:79], v[80:83], a[192:207]
  ds_read_b64_tr_b16 v[108:109], v17 offset:40960
  s_add_u32 m0, s25, 0
  s_nop 0
  buffer_load_dwordx4 v6, s[8:11], s21 offen lds
  v_mfma_f32_32x32x16_bf16 a[208:223], v[76:79], v[84:87], a[208:223]
  ds_read_b64_tr_b16 v[110:111], v17 offset:43008
  s_waitcnt vmcnt(9) lgkmcnt(0)
  s_barrier
  v_mfma_f32_32x32x16_bf16 a[0:15], v[96:99], v[112:115], a[0:15]
  ds_read_b64_tr_b16 v[64:65], v18 offset:0
  ds_read_b64_tr_b16 v[66:67], v18 offset:2048
  v_mfma_f32_32x32x16_bf16 a[16:31], v[96:99], v[116:119], a[16:31]
  ds_read_b128 v[80:83], v12 offset:0
  ds_read_b128 v[84:87], v12 offset:2048
  v_mfma_f32_32x32x16_bf16 a[64:79], v[100:103], v[112:115], a[64:79]
  ds_read_b64_tr_b16 v[68:69], v19 offset:0
  s_add_u32 m0, s25, 1024
  s_nop 0
  buffer_load_dwordx4 v7, s[8:11], s21 offen lds
  v_mfma_f32_32x32x16_bf16 a[80:95], v[100:103], v[116:119], a[80:95]
  ds_read_b64_tr_b16 v[70:71], v19 offset:2048
  v_mfma_f32_32x32x16_bf16 a[128:143], v[104:107], v[112:115], a[128:143]
  ds_read_b64_tr_b16 v[72:73], v20 offset:0
  s_add_u32 m0, s25, 2048
  s_nop 0
  buffer_load_dwordx4 v8, s[8:11], s21 offen lds
  v_mfma_f32_32x32x16_bf16 a[144:159], v[104:107], v[116:119], a[144:159]
  ds_read_b64_tr_b16 v[74:75], v20 offset:2048
  v_mfma_f32_32x32x16_bf16 a[192:207], v[108:111], v[112:115], a[192:207]
  ds_read_b64_tr_b16 v[76:77], v21 offset:0
  s_add_u32 m0, s25, 3072
  s_nop 0
  buffer_load_dwordx4 v9, s[8:11], s21 offen lds
  s_add_u32 s20, s20, 64
  s_add_u32 s21, s21, s23
  v_mfma_f32_32x32x16_bf16 a[208:223], v[108:111], v[116:119], a[208:223]
  ds_read_b64_tr_b16 v[78:79], v21 offset:2048
  s_waitcnt lgkmcnt(0)
  v_mfma_f32_32x32x16_bf16 a[0:15], v[64:67], v[80:83], a[0:15]
  ds_read_b64_tr_b16 v[96:97], v18 offset:8192
  ds_read_b64_tr_b16 v[98:99], v18 offset:10240
  v_mfma_f32_32x32x16_bf16 a[16:31], v[64:67], v[84:87], a[16:31]
  ds_read_b128 v[112:115], v13 offset:0
  ds_read_b128 v[116:119], v13 offset:2048
  v_mfma_f32_32x32x16_bf16 a[64:79], v[68:71], v[80:83], a[64:79]
  ds_read_b64_tr_b16 v[100:101], v19 offset:8192
  s_add_u32 m0, s24, 32768
  s_nop 0
  buffer_load_dwordx4 v2, s[4:7], s20 offen lds
  v_mfma_f32_32x32x16_bf16 a[80:95], v[68:71], v[84:87], a[80:95]
  ds_read_b64_tr_b16 v[102:103], v19 offset:10240
  v_mfma_f32_32x32x16_bf16 a[128:143], v[72:75], v[80:83], a[128:143]
  ds_read_b64_tr_b16 v[104:105], v20 offset:8192
  s_add_u32 m0, s24, 33792
  s_nop 0
  buffer_load_dwordx4 v3, s[4:7], s20 offen lds
  v_mfma_f32_32x32x16_bf16 a[144:159], v[72:75], v[84:87], a[144:159]
  ds_read_b64_tr_b16 v[106:107], v20 offset:10240
  v_mfma_f32_32x32x16_bf16 a[192:207], v[76:79], v[80:83], a[192:207]
  ds_read_b64_tr_b16 v[108:109], v21 offset:8192
  s_add_u32 m0, s25, 32768
  s_nop 0
  buffer_load_dwordx4 v6, s[8:11], s21 offen lds
  v_mfma_f32_32x32x16_bf16 a[208:223], v[76:79], v[84:87], a[208:223]
  ds_read_b64_tr_b16 v[110:111], v21 offset:10240
  s_waitcnt vmcnt(9) lgkmcnt(0)
  s_barrier
  v_mfma_f32_32x32x16_bf16 a[0:15], v[96:99], v[112:115], a[0:15]
  ds_read_b64_tr_b16 v[64:65], v18 offset:32768
  ds_read_b64_tr_b16 v[66:67], v18 offset:34816
  v_mfma_f32_32x32x16_bf16 a[16:31], v[96:99], v[116:119], a[16:31]
  ds_read_b128 v[80:83], v12 offset:32768
  ds_read_b128 v[84:87], v12 offset:34816
  v_mfma_f32_32x32x16_bf16 a[64:79], v[100:103], v[112:115], a[64:79]
  ds_read_b64_tr_b16 v[68:69], v19 offset:32768
  s_add_u32 m0, s25, 33792
  s_nop 0
  buffer_load_dwordx4 v7, s[8:11], s21 offen lds
  v_mfma_f32_32x32x16_bf16 a[80:95], v[100:103], v[116:119], a[80:95]
  ds_read_b64_tr_b16 v[70:71], v19 offset:34816
  v_mfma_f32_32x32x16_bf16 a[128:143], v[104:107], v[112:115], a[128:143]
  ds_read_b64_tr_b16 v[72:73], v20 offset:32768
  s_add_u32 m0, s25, 34816
  s_nop 0
  buffer_load_dwordx4 v8, s[8:11], s21 offen lds
  v_mfma_f32_32x32x16_bf16 a[144:159], v[104:107], v[116:119], a[144:159]
  ds_read_b64_tr_b16 v[74:75], v20 offset:34816
  v_mfma_f32_32x32x16_bf16 a[192:207], v[108:111], v[112:115], a[192:207]
  ds_read_b64_tr_b16 v[76:77], v21 offset:32768
  s_add_u32 m0, s25, 35840
  s_nop 0
  buffer_load_dwordx4 v9, s[8:11], s21 offen lds
  s_add_u32 s20, s20, 64
  s_add_u32 s21, s21, s23
  v_mfma_f32_32x32x16_bf16 a[208:223], v[108:111], v[116:119], a[208:223]
  ds_read_b64_tr_b16 v[78:79], v21 offset:34816
  s_waitcnt lgkmcnt(0)
  v_mfma_f32_32x32x16_bf16 a[0:15], v[64:67], v[80:83], a[0:15]
  ds_read_b64_tr_b16 v[96:97], v18 offset:40960
  ds_read_b64_tr_b16 v[98:99], v18 offset:43008
  v_mfma_f32_32x32x16_bf16 a[16:31], v[64:67], v[84:87], a[16:31]
  ds_read_b128 v[112:115], v13 offset:32768
  ds_read_b128 v[116:119], v13 offset:34816
  v_mfma_f32_32x32x16_bf16 a[64:79], v[68:71], v[80:83], a[64:79]
  ds_read_b64_tr_b16 v[100:101], v19 offset:40960
  s_add_u32 m0, s24, 65536
  s_nop 0
  buffer_load_dwordx4 v2, s[4:7], s20 offen lds
  v_mfma_f32_32x32x16_bf16 a[80:95], v[68:71], v[84:87], a[80:95]
  ds_read_b64_tr_b16 v[102:103], v19 offset:43008
  v_mfma_f32_32x32x16_bf16 a[128:143], v[72:75], v[80:83], a[128:143]
  ds_read_b64_tr_b16 v[104:105], v20 offset:40960
  s_add_u32 m0, s24, 66560
  s_nop 0
  buffer_load_dwordx4 v3, s[4:7], s20 offen lds
  v_mfma_f32_32x32x16_bf16 a[144:159], v[72:75], v[84:87], a[144:159]
  ds_read_b64_tr_b16 v[106:107], v20 offset:43008
  v_mfma_f32_32x32x16_bf16 a[192:207], v[76:79], v[80:83], a[192:207]
  ds_read_b64_tr_b16 v[108:109], v21 offset:40960
  s_add_u32 m0, s25, 65536
  s_nop 0
  buffer_load_dwordx4 v6, s[8:11], s21 offen lds
  v_mfma_f32_32x32x16_bf16 a[208:223], v[76:79], v[84:87], a[208:223]
  ds_read_b64_tr_b16 v[110:111], v21 offset:43008
  s_waitcnt vmcnt(9) lgkmcnt(0)
  s_barrier
  v_mfma_f32_32x32x16_bf16 a[0:15], v[96:99], v[112:115], a[0:15]
  ds_read_b64_tr_b16 v[64:65], v14 offset:0
  ds_read_b64_tr_b16 v[66:67], v14 offset:2048
  v_mfma_f32_32x32x16_bf16 a[16:31], v[96:99], v[116:119], a[16:31]
  ds_read_b128 v[80:83], v10 offset:0
  ds_read_b128 v[84:87], v10 offset:2048
  v_mfma_f32_32x32x16_bf16 a[64:79], v[100:103], v[112:115], a[64:79]
  ds_read_b64_tr_b16 v[68:69], v15 offset:0
  s_add_u32 m0, s25, 66560
  s_nop 0
  buffer_load_dwordx4 v7, s[8:11], s21 offen lds
  v_mfma_f32_32x32x16_bf16 a[80:95], v[100:103], v[116:119], a[80:95]
  ds_read_b64_tr_b16 v[70:71], v15 offset:2048
  v_mfma_f32_32x32x16_bf16 a[128:143], v[104:107], v[112:115], a[128:143]
  ds_read_b64_tr_b16 v[72:73], v16 offset:0
  s_add_u32 m0, s25, 67584
  s_nop 0
  buffer_load_dwordx4 v8, s[8:11], s21 offen lds
  v_mfma_f32_32x32x16_bf16 a[144:159], v[104:107], v[116:119], a[144:159]
  ds_read_b64_tr_b16 v[74:75], v16 offset:2048
  v_mfma_f32_32x32x16_bf16 a[192:207], v[108:111], v[112:115], a[192:207]
  ds_read_b64_tr_b16 v[76:77], v17 offset:0
  s_add_u32 m0, s25, 68608
  s_nop 0
  buffer_load_dwordx4 v9, s[8:11], s21 offen lds
  s_add_u32 s20, s20, 64
  s_add_u32 s21, s21, s23
  v_mfma_f32_32x32x16_bf16 a[208:223], v[108:111], v[116:119], a[208:223]
  ds_read_b64_tr_b16 v[78:79], v17 offset:2048
  s_waitcnt lgkmcnt(0)
  v_mfma_f32_32x32x16_bf16 a[0:15], v[64:67], v[80:83], a[0:15]
  ds_read_b64_tr_b16 v[96:97], v14 offset:8192
  ds_read_b64_tr_b16 v[98:99], v14 offset:10240
  v_mfma_f32_32x32x16_bf16 a[16:31], v[64:67], v[84:87], a[16:31]
  ds_read_b128 v[112:115], v11 offset:0
  ds_read_b128 v[116:119], v11 offset:2048
  v_mfma_f32_32x32x16_bf16 a[64:79], v[68:71], v[80:83], a[64:79]
  ds_read_b64_tr_b16 v[100:101], v15 offset:8192
  s_add_u32 m0, s24, 98304
  s_nop 0
  buffer_load_dwordx4 v2, s[4:7], s20 offen lds
  v_mfma_f32_32x32x16_bf16 a[80:95], v[68:71], v[84:87], a[80:95]
  ds_read_b64_tr_b16 v[102:103], v15 offset:10240
  v_mfma_f32_32x32x16_bf16 a[128:143], v[72:75], v[80:83], a[128:143]
  ds_read_b64_tr_b16 v[104:105], v16 offset:8192
  s_add_u32 m0, s24, 99328
  s_nop 0
  buffer_load_dwordx4 v3, s[4:7], s20 offen lds
  v_mfma_f32_32x32x16_bf16 a[144:159], v[72:75], v[84:87], a[144:159]
  ds_read_b64_tr_b16 v[106:107], v16 offset:10240
  v_mfma_f32_32x32x16_bf16 a[192:207], v[76:79], v[80:83], a[192:207]
  ds_read_b64_tr_b16 v[108:109], v17 offset:8192
  s_add_u32 m0, s25, 98304
  s_nop 0
  buffer_load_dwordx4 v6, s[8:11], s21 offen lds
  v_mfma_f32_32x32x16_bf16 a[208:223], v[76:79], v[84:87], a[208:223]
  ds_read_b64_tr_b16 v[110:111], v17 offset:10240
  s_waitcnt vmcnt(9) lgkmcnt(0)
  s_barrier
  v_mfma_f32_32x32x16_bf16 a[0:15], v[96:99], v[112:115], a[0:15]
  ds_read_b64_tr_b16 v[64:65], v14 offset:32768
  ds_read_b64_tr_b16 v[66:67], v14 offset:34816
  v_mfma_f32_32x32x16_bf16 a[16:31], v[96:99], v[116:119], a[16:31]
  ds_read_b128 v[80:83], v10 offset:32768
  ds_read_b128 v[84:87], v10 offset:34816
  v_mfma_f32_32x32x16_bf16 a[64:79], v[100:103], v[112:115], a[64:79]
  ds_read_b64_tr_b16 v[68:69], v15 offset:32768
  s_add_u32 m0, s25, 99328
  s_nop 0
  buffer_load_dwordx4 v7, s[8:11], s21 offen lds
  v_mfma_f32_32x32x16_bf16 a[80:95], v[100:103], v[116:119], a[80:95]
  ds_read_b64_tr_b16 v[70:71], v15 offset:34816
  v_mfma_f32_32x32x16_bf16 a[128:143], v[104:107], v[112:115], a[128:143]
  ds_read_b64_tr_b16 v[72:73], v16 offset:32768
  s_add_u32 m0, s25, 100352
  s_nop 0
  buffer_load_dwordx4 v8, s[8:11], s21 offen lds
  v_mfma_f32_32x32x16_bf16 a[144:159], v[104:107], v[116:119], a[144:159]
  ds_read_b64_tr_b16 v[74:75], v16 offset:34816
  v_mfma_f32_32x32x16_bf16 a[192:207], v[108:111], v[112:115], a[192:207]
  ds_read_b64_tr_b16 v[76:77], v17 offset:32768
  s_add_u32 m0, s25, 101376
  s_nop 0
  buffer_load_dwordx4 v9, s[8:11], s21 offen lds
  s_add_u32 s20, s20, 64
  s_add_u32 s21, s21, s23
  v_mfma_f32_32x32x16_bf16 a[208:223], v[108:111], v[116:119], a[208:223]
  ds_read_b64_tr_b16 v[78:79], v17 offset:34816
  s_waitcnt lgkmcnt(0)
  v_mfma_f32_32x32x16_bf16 a[0:15], v[64:67], v[80:83], a[0:15]
  ds_read_b64_tr_b16 v[96:97], v14 offset:40960
  ds_read_b64_tr_b16 v[98:99], v14 offset:43008
  v_mfma_f32_32x32x16_bf16 a[16:31], v[64:67], v[84:87], a[16:31]
  ds_read_b128 v[112:115], v11 offset:32768
  ds_read_b128 v[116:119], v11 offset:34816
  v_mfma_f32_32x32x16_bf16 a[64:79], v[68:71], v[80:83], a[64:79]
  ds_read_b64_tr_b16 v[100:101], v15 offset:40960
  s_add_u32 m0, s24, 0
  s_nop 0
  buffer_load_dwordx4 v2, s[4:7], s20 offen lds
  v_mfma_f32_32x32x16_bf16 a[80:95], v[68:71], v[84:87], a[80:95]
  ds_read_b64_tr_b16 v[102:103], v15 offset:43008
  v_mfma_f32_32x32x16_bf16 a[128:143], v[72:75], v[80:83], a[128:143]
  ds_read_b64_tr_b16 v[104:105], v16 offset:40960
  s_add_u32 m0, s24, 1024
  s_nop 0
  buffer_load_dwordx4 v3, s[4:7], s20 offen lds
  v_mfma_f32_32x32x16_bf16 a[144:159], v[72:75], v[84:87], a[144:159]
  ds_read_b64_tr_b16 v[106:107], v16 offset:43008
  v_mfma_f32_32x32x16_bf16 a[192:207], v[76:79], v[80:83], a[192:207]
  ds_read_b64_tr_b16 v[108:109], v17 offset:40960
  s_add_u32 m0, s25, 0
  s_nop 0
  buffer_load_dwordx4 v6, s[8:11], s21 offen lds
  v_mfma_f32_32x32x16_bf16 a[208:223], v[76:79], v[84:87], a[208:223]
  ds_read_b64_tr_b16 v[110:111], v17 offset:43008
  s_waitcnt vmcnt(9) lgkmcnt(0)
  s_barrier
  v_mfma_f32_32x32x16_bf16 a[0:15], v[96:99], v[112:115], a[0:15]
  ds_read_b64_tr_b16 v[64:65], v18 offset:0
  ds_read_b64_tr_b16 v[66:67], v18 offset:2048
  v_mfma_f32_32x32x16_bf16 a[16:31], v[96:99], v[116:119], a[16:31]
  ds_read_b128 v[80:83], v12 offset:0
  ds_read_b128 v[84:87], v12 offset:2048
  v_mfma_f32_32x32x16_bf16 a[64:79], v[100:103], v[112:115], a[64:79]
  ds_read_b64_tr_b16 v[68:69], v19 offset:0
  s_add_u32 m0, s25, 1024
  s_nop 0
  buffer_load_dwordx4 v7, s[8:11], s21 offen lds
  v_mfma_f32_32x32x16_bf16 a[80:95], v[100:103], v[116:119], a[80:95]
  ds_read_b64_tr_b16 v[70:71], v19 offset:2048
  v_mfma_f32_32x32x16_bf16 a[128:143], v[104:107], v[112:115], a[128:143]
  ds_read_b64_tr_b16 v[72:73], v20 offset:0
  s_add_u32 m0, s25, 2048
  s_nop 0
  buffer_load_dwordx4 v8, s[8:11], s21 offen lds
  v_mfma_f32_32x32x16_bf16 a[144:159], v[104:107], v[116:119], a[144:159]
  ds_read_b64_tr_b16 v[74:75], v20 offset:2048
  v_mfma_f32_32x32x16_bf16 a[192:207], v[108:111], v[112:115], a[192:207]
  ds_read_b64_tr_b16 v[76:77], v21 offset:0
  s_add_u32 m0, s25, 3072
  s_nop 0
  buffer_load_dwordx4 v9, s[8:11], s21 offen lds
  s_add_u32 s20, s20, 64
  s_add_u32 s21, s21, s23
  v_mfma_f32_32x32x16_bf16 a[208:223], v[108:111], v[116:119], a[208:223]
  ds_read_b64_tr_b16 v[78:79], v21 offset:2048
  s_waitcnt lgkmcnt(0)
  v_mfma_f32_32x32x16_bf16 a[0:15], v[64:67], v[80:83], a[0:15]
  ds_read_b64_tr_b16 v[96:97], v18 offset:8192
  ds_read_b64_tr_b16 v[98:99], v18 offset:10240
  v_mfma_f32_32x32x16_bf16 a[16:31], v[64:67], v[84:87], a[16:31]
  ds_read_b128 v[112:115], v13 offset:0
  ds_read_b128 v[116:119], v13 offset:2048
  v_mfma_f32_32x32x16_bf16 a[64:79], v[68:71], v[80:83], a[64:79]
  ds_read_b64_tr_b16 v[100:101], v19 offset:8192
  s_add_u32 m0, s24, 32768
  s_nop 0
  buffer_load_dwordx4 v2, s[4:7], s20 offen lds
  v_mfma_f32_32x32x16_bf16 a[80:95], v[68:71], v[84:87], a[80:95]
  ds_read_b64_tr_b16 v[102:103], v19 offset:10240
  v_mfma_f32_32x32x16_bf16 a[128:143], v[72:75], v[80:83], a[128:143]
  ds_read_b64_tr_b16 v[104:105], v20 offset:8192
  s_add_u32 m0, s24, 33792
  s_nop 0
  buffer_load_dwordx4 v3, s[4:7], s20 offen lds
  v_mfma_f32_32x32x16_bf16 a[144:159], v[72:75], v[84:87], a[144:159]
  ds_read_b64_tr_b16 v[106:107], v20 offset:10240
  v_mfma_f32_32x32x16_bf16 a[192:207], v[76:79], v[80:83], a[192:207]
  ds_read_b64_tr_b16 v[108:109], v21 offset:8192
  s_add_u32 m0, s25, 32768
  s_nop 0
  buffer_load_dwordx4 v6, s[8:11], s21 offen lds
  v_mfma_f32_32x32x16_bf16 a[208:223], v[76:79], v[84:87], a[208:223]
  ds_read_b64_tr_b16 v[110:111], v21 offset:10240
  s_waitcnt vmcnt(9) lgkmcnt(0)
  s_barrier
  v_mfma_f32_32x32x16_bf16 a[0:15], v[96:99], v[112:115], a[0:15]
  ds_read_b64_tr_b16 v[64:65], v18 offset:32768
  ds_read_b64_tr_b16 v[66:67], v18 offset:34816
  v_mfma_f32_32x32x16_bf16 a[16:31], v[96:99], v[116:119], a[16:31]
  ds_read_b128 v[80:83], v12 offset:32768
  ds_read_b128 v[84:87], v12 offset:34816
  v_mfma_f32_32x32x16_bf16 a[64:79], v[100:103], v[112:115], a[64:79]
  ds_read_b64_tr_b16 v[68:69], v19 offset:32768
  s_add_u32 m0, s25, 33792
  s_nop 0
  buffer_load_dwordx4 v7, s[8:11], s21 offen lds
  v_mfma_f32_32x32x16_bf16 a[80:95], v[100:103], v[116:119], a[80:95]
  ds_read_b64_tr_b16 v[70:71], v19 offset:34816
  v_mfma_f32_32x32x16_bf16 a[128:143], v[104:107], v[112:115], a[128:143]
  ds_read_b64_tr_b16 v[72:73], v20 offset:32768
  s_add_u32 m0, s25, 34816
  s_nop 0
  buffer_load_dwordx4 v8, s[8:11], s21 offen lds
  v_mfma_f32_32x32x16_bf16 a[144:159], v[104:107], v[116:119], a[144:159]
  ds_read_b64_tr_b16 v[74:75], v20 offset:34816
  v_mfma_f32_32x32x16_bf16 a[192:207], v[108:111], v[112:115], a[192:207]
  ds_read_b64_tr_b16 v[76:77], v21 offset:32768
  s_add_u32 m0, s25, 35840
  s_nop 0
  buffer_load_dwordx4 v9, s[8:11], s21 offen lds
  s_add_u32 s20, s20, 64
  s_add_u32 s21, s21, s23
  v_mfma_f32_32x32x16_bf16 a[208:223], v[108:111], v[116:119], a[208:223]
  ds_read_b64_tr_b16 v[78:79], v21 offset:34816
  s_waitcnt lgkmcnt(0)
  v_mfma_f32_32x32x16_bf16 a[0:15], v[64:67], v[80:83], a[0:15]
  ds_read_b64_tr_b16 v[96:97], v18 offset:40960
  ds_read_b64_tr_b16 v[98:99], v18 offset:43008
  v_mfma_f32_32x32x16_bf16 a[16:31], v[64:67], v[84:87], a[16:31]
  ds_read_b128 v[112:115], v13 offset:32768
  ds_read_b128 v[116:119], v13 offset:34816
  v_mfma_f32_32x32x16_bf16 a[64:79], v[68:71], v[80:83], a[64:79]
  ds_read_b64_tr_b16 v[100:101], v19 offset:40960
  s_add_u32 m0, s24, 65536
  s_nop 0
  buffer_load_dwordx4 v2, s[4:7], s20 offen lds
  v_mfma_f32_32x32x16_bf16 a[80:95], v[68:71], v[84:87], a[80:95]
  ds_read_b64_tr_b16 v[102:103], v19 offset:43008
  v_mfma_f32_32x32x16_bf16 a[128:143], v[72:75], v[80:83], a[128:143]
  ds_read_b64_tr_b16 v[104:105], v20 offset:40960
  s_add_u32 m0, s24, 66560
  s_nop 0
  buffer_load_dwordx4 v3, s[4:7], s20 offen lds
  v_mfma_f32_32x32x16_bf16 a[144:159], v[72:75], v[84:87], a[144:159]
  ds_read_b64_tr_b16 v[106:107], v20 offset:43008
  v_mfma_f32_32x32x16_bf16 a[192:207], v[76:79], v[80:83], a[192:207]
  ds_read_b64_tr_b16 v[108:109], v21 offset:40960
  s_add_u32 m0, s25, 65536
  s_nop 0
  buffer_load_dwordx4 v6, s[8:11], s21 offen lds
  v_mfma_f32_32x32x16_bf16 a[208:223], v[76:79], v[84:87], a[208:223]
  ds_read_b64_tr_b16 v[110:111], v21 offset:43008
  s_waitcnt vmcnt(9) lgkmcnt(0)
  s_barrier
  v_mfma_f32_32x32x16_bf16 a[0:15], v[96:99], v[112:115], a[0:15]
  ds_read_b64_tr_b16 v[64:65], v14 offset:0
  ds_read_b64_tr_b16 v[66:67], v14 offset:2048
  v_mfma_f32_32x32x16_bf16 a[16:31], v[96:99], v[116:119], a[16:31]
  ds_read_b128 v[80:83], v10 offset:0
  ds_read_b128 v[84:87], v10 offset:2048
  v_mfma_f32_32x32x16_bf16 a[64:79], v[100:103], v[112:115], a[64:79]
  ds_read_b64_tr_b16 v[68:69], v15 offset:0
  s_add_u32 m0, s25, 66560
  s_nop 0
  buffer_load_dwordx4 v7, s[8:11], s21 offen lds
  v_mfma_f32_32x32x16_bf16 a[80:95], v[100:103], v[116:119], a[80:95]
  ds_read_b64_tr_b16 v[70:71], v15 offset:2048
  v_mfma_f32_32x32x16_bf16 a[128:143], v[104:107], v[112:115], a[128:143]
  ds_read_b64_tr_b16 v[72:73], v16 offset:0
  s_add_u32 m0, s25, 67584
  s_nop 0
  buffer_load_dwordx4 v8, s[8:11], s21 offen lds
  v_mfma_f32_32x32x16_bf16 a[144:159], v[104:107], v[116:119], a[144:159]
  ds_read_b64_tr_b16 v[74:75], v16 offset:2048
  v_mfma_f32_32x32x16_bf16 a[192:207], v[108:111], v[112:115], a[192:207]
  ds_read_b64_tr_b16 v[76:77], v17 offset:0
  s_add_u32 m0, s25, 68608
  s_nop 0
  buffer_load_dwordx4 v9, s[8:11], s21 offen lds
  s_add_u32 s20, s20, 64
  s_add_u32 s21, s21, s23
  v_mfma_f32_32x32x16_bf16 a[208:223], v[108:111], v[116:119], a[208:223]
  ds_read_b64_tr_b16 v[78:79], v17 offset:2048
  s_waitcnt lgkmcnt(0)
  v_mfma_f32_32x32x16_bf16 a[0:15], v[64:67], v[80:83], a[0:15]
  ds_read_b64_tr_b16 v[96:97], v14 offset:8192
  ds_read_b64_tr_b16 v[98:99], v14 offset:10240
  v_mfma_f32_32x32x16_bf16 a[16:31], v[64:67], v[84:87], a[16:31]
  ds_read_b128 v[112:115], v11 offset:0
  ds_read_b128 v[116:119], v11 offset:2048
  v_mfma_f32_32x32x16_bf16 a[64:79], v[68:71], v[80:83], a[64:79]
  ds_read_b64_tr_b16 v[100:101], v15 offset:8192
  s_add_u32 m0, s24, 98304
  s_nop 0
  buffer_load_dwordx4 v2, s[4:7], s20 offen lds
  v_mfma_f32_32x32x16_bf16 a[80:95], v[68:71], v[84:87], a[80:95]
  ds_read_b64_tr_b16 v[102:103], v15 offset:10240
  v_mfma_f32_32x32x16_bf16 a[128:143], v[72:75], v[80:83], a[128:143]
  ds_read_b64_tr_b16 v[104:105], v16 offset:8192
  s_add_u32 m0, s24, 99328
  s_nop 0
  buffer_load_dwordx4 v3, s[4:7], s20 offen lds
  v_mfma_f32_32x32x16_bf16 a[144:159], v[72:75], v[84:87], a[144:159]
  ds_read_b64_tr_b16 v[106:107], v16 offset:10240
  v_mfma_f32_32x32x16_bf16 a[192:207], v[76:79], v[80:83], a[192:207]
  ds_read_b64_tr_b16 v[108:109], v17 offset:8192
  s_add_u32 m0, s25, 98304
  s_nop 0
  buffer_load_dwordx4 v6, s[8:11], s21 offen lds
  v_mfma_f32_32x32x16_bf16 a[208:223], v[76:79], v[84:87], a[208:223]
  ds_read_b64_tr_b16 v[110:111], v17 offset:10240
  s_waitcnt vmcnt(9) lgkmcnt(0)
  s_barrier
  v_mfma_f32_32x32x16_bf16 a[0:15], v[96:99], v[112:115], a[0:15]
  ds_read_b64_tr_b16 v[64:65], v14 offset:32768
  ds_read_b64_tr_b16 v[66:67], v14 offset:34816
  v_mfma_f32_32x32x16_bf16 a[16:31], v[96:99], v[116:119], a[16:31]
  ds_read_b128 v[80:83], v10 offset:32768
  ds_read_b128 v[84:87], v10 offset:34816
  v_mfma_f32_32x32x16_bf16 a[64:79], v[100:103], v[112:115], a[64:79]
  ds_read_b64_tr_b16 v[68:69], v15 offset:32768
  s_add_u32 m0, s25, 99328
  s_nop 0
  buffer_load_dwordx4 v7, s[8:11], s21 offen lds
  v_mfma_f32_32x32x16_bf16 a[80:95], v[100:103], v[116:119], a[80:95]
  ds_read_b64_tr_b16 v[70:71], v15 offset:34816
  v_mfma_f32_32x32x16_bf16 a[128:143], v[104:107], v[112:115], a[128:143]
  ds_read_b64_tr_b16 v[72:73], v16 offset:32768
  s_add_u32 m0, s25, 100352
  s_nop 0
  buffer_load_dwordx4 v8, s[8:11], s21 offen lds
  v_mfma_f32_32x32x16_bf16 a[144:159], v[104:107], v[116:119], a[144:159]
  ds_read_b64_tr_b16 v[74:75], v16 offset:34816
  v_mfma_f32_32x32x16_bf16 a[192:207], v[108:111], v[112:115], a[192:207]
  ds_read_b64_tr_b16 v[76:77], v17 offset:32768
  s_add_u32 m0, s25, 101376
  s_nop 0
  buffer_load_dwordx4 v9, s[8:11], s21 offen lds
  s_add_u32 s20, s20, 64
  s_add_u32 s21, s21, s23
  v_mfma_f32_32x32x16_bf16 a[208:223], v[108:111], v[116:119], a[208:223]
  ds_read_b64_tr_b16 v[78:79], v17 offset:34816
  s_waitcnt lgkmcnt(0)
  v_mfma_f32_32x32x16_bf16 a[0:15], v[64:67], v[80:83], a[0:15]
  ds_read_b64_tr_b16 v[96:97], v14 offset:40960
  ds_read_b64_tr_b16 v[98:99], v14 offset:43008
  v_mfma_f32_32x32x16_bf16 a[16:31], v[64:67], v[84:87], a[16:31]
  ds_read_b128 v[112:115], v11 offset:32768
  ds_read_b128 v[116:119], v11 offset:34816
  v_mfma_f32_32x32x16_bf16 a[64:79], v[68:71], v[80:83], a[64:79]
  ds_read_b64_tr_b16 v[100:101], v15 offset:40960
  s_add_u32 m0, s24, 0
  s_nop 0
  buffer_load_dwordx4 v2, s[4:7], s20 offen lds
  v_mfma_f32_32x32x16_bf16 a[80:95], v[68:71], v[84:87], a[80:95]
  ds_read_b64_tr_b16 v[102:103], v15 offset:43008
  v_mfma_f32_32x32x16_bf16 a[128:143], v[72:75], v[80:83], a[128:143]
  ds_read_b64_tr_b16 v[104:105], v16 offset:40960
  s_add_u32 m0, s24, 1024
  s_nop 0
  buffer_load_dwordx4 v3, s[4:7], s20 offen lds
  v_mfma_f32_32x32x16_bf16 a[144:159], v[72:75], v[84:87], a[144:159]
  ds_read_b64_tr_b16 v[106:107], v16 offset:43008
  v_mfma_f32_32x32x16_bf16 a[192:207], v[76:79], v[80:83], a[192:207]
  ds_read_b64_tr_b16 v[108:109], v17 offset:40960
  s_add_u32 m0, s25, 0
  s_nop 0
  buffer_load_dwordx4 v6, s[8:11], s21 offen lds
  v_mfma_f32_32x32x16_bf16 a[208:223], v[76:79], v[84:87], a[208:223]
  ds_read_b64_tr_b16 v[110:111], v17 offset:43008
  s_waitcnt vmcnt(9) lgkmcnt(0)
  s_barrier
  v_mfma_f32_32x32x16_bf16 a[0:15], v[96:99], v[112:115], a[0:15]
  ds_read_b64_tr_b16 v[64:65], v18 offset:0
  ds_read_b64_tr_b16 v[66:67], v18 offset:2048
  v_mfma_f32_32x32x16_bf16 a[16:31], v[96:99], v[116:119], a[16:31]
  ds_read_b128 v[80:83], v12 offset:0
  ds_read_b128 v[84:87], v12 offset:2048
  v_mfma_f32_32x32x16_bf16 a[64:79], v[100:103], v[112:115], a[64:79]
  ds_read_b64_tr_b16 v[68:69], v19 offset:0
  s_add_u32 m0, s25, 1024
  s_nop 0
  buffer_load_dwordx4 v7, s[8:11], s21 offen lds
  v_mfma_f32_32x32x16_bf16 a[80:95], v[100:103], v[116:119], a[80:95]
  ds_read_b64_tr_b16 v[70:71], v19 offset:2048
  v_mfma_f32_32x32x16_bf16 a[128:143], v[104:107], v[112:115], a[128:143]
  ds_read_b64_tr_b16 v[72:73], v20 offset:0
  s_add_u32 m0, s25, 2048
  s_nop 0
  buffer_load_dwordx4 v8, s[8:11], s21 offen lds
  v_mfma_f32_32x32x16_bf16 a[144:159], v[104:107], v[116:119], a[144:159]
  ds_read_b64_tr_b16 v[74:75], v20 offset:2048
  v_mfma_f32_32x32x16_bf16 a[192:207], v[108:111], v[112:115], a[192:207]
  ds_read_b64_tr_b16 v[76:77], v21 offset:0
  s_add_u32 m0, s25, 3072
  s_nop 0
  buffer_load_dwordx4 v9, s[8:11], s21 offen lds
  s_add_u32 s20, s20, 64
  s_add_u32 s21, s21, s23
  v_mfma_f32_32x32x16_bf16 a[208:223], v[108:111], v[116:119], a[208:223]
  ds_read_b64_tr_b16 v[78:79], v21 offset:2048
  s_waitcnt lgkmcnt(0)
  v_mfma_f32_32x32x16_bf16 a[0:15], v[64:67], v[80:83], a[0:15]
  ds_read_b64_tr_b16 v[96:97], v18 offset:8192
  ds_read_b64_tr_b16 v[98:99], v18 offset:10240
  v_mfma_f32_32x32x16_bf16 a[16:31], v[64:67], v[84:87], a[16:31]
  ds_read_b128 v[112:115], v13 offset:0
  ds_read_b128 v[116:119], v13 offset:2048
  v_mfma_f32_32x32x16_bf16 a[64:79], v[68:71], v[80:83], a[64:79]
  ds_read_b64_tr_b16 v[100:101], v19 offset:8192
  s_add_u32 m0, s24, 32768
  s_nop 0
  buffer_load_dwordx4 v2, s[4:7], s20 offen lds
  v_mfma_f32_32x32x16_bf16 a[80:95], v[68:71], v[84:87], a[80:95]
  ds_read_b64_tr_b16 v[102:103], v19 offset:10240
  v_mfma_f32_32x32x16_bf16 a[128:143], v[72:75], v[80:83], a[128:143]
  ds_read_b64_tr_b16 v[104:105], v20 offset:8192
  s_add_u32 m0, s24, 33792
  s_nop 0
  buffer_load_dwordx4 v3, s[4:7], s20 offen lds
  v_mfma_f32_32x32x16_bf16 a[144:159], v[72:75], v[84:87], a[144:159]
  ds_read_b64_tr_b16 v[106:107], v20 offset:10240
  v_mfma_f32_32x32x16_bf16 a[192:207], v[76:79], v[80:83], a[192:207]
  ds_read_b64_tr_b16 v[108:109], v21 offset:8192
  s_add_u32 m0, s25, 32768
  s_nop 0
  buffer_load_dwordx4 v6, s[8:11], s21 offen lds
  v_mfma_f32_32x32x16_bf16 a[208:223], v[76:79], v[84:87], a[208:223]
  ds_read_b64_tr_b16 v[110:111], v21 offset:10240
  s_waitcnt vmcnt(9) lgkmcnt(0)
  s_barrier
  v_mfma_f32_32x32x16_bf16 a[0:15], v[96:99], v[112:115], a[0:15]
  ds_read_b64_tr_b16 v[64:65], v18 offset:32768
  ds_read_b64_tr_b16 v[66:67], v18 offset:34816
  v_mfma_f32_32x32x16_bf16 a[16:31], v[96:99], v[116:119], a[16:31]
  ds_read_b128 v[80:83], v12 offset:32768
  ds_read_b128 v[84:87], v12 offset:34816
  v_mfma_f32_32x32x16_bf16 a[64:79], v[100:103], v[112:115], a[64:79]
  ds_read_b64_tr_b16 v[68:69], v19 offset:32768
  s_add_u32 m0, s25, 33792
  s_nop 0
  buffer_load_dwordx4 v7, s[8:11], s21 offen lds
  v_mfma_f32_32x32x16_bf16 a[80:95], v[100:103], v[116:119], a[80:95]
  ds_read_b64_tr_b16 v[70:71], v19 offset:34816
  v_mfma_f32_32x32x16_bf16 a[128:143], v[104:107], v[112:115], a[128:143]
  ds_read_b64_tr_b16 v[72:73], v20 offset:32768
  s_add_u32 m0, s25, 34816
  s_nop 0
  buffer_load_dwordx4 v8, s[8:11], s21 offen lds
  v_mfma_f32_32x32x16_bf16 a[144:159], v[104:107], v[116:119], a[144:159]
  ds_read_b64_tr_b16 v[74:75], v20 offset:34816
  v_mfma_f32_32x32x16_bf16 a[192:207], v[108:111], v[112:115], a[192:207]
  ds_read_b64_tr_b16 v[76:77], v21 offset:32768
  s_add_u32 m0, s25, 35840
  s_nop 0
  buffer_load_dwordx4 v9, s[8:11], s21 offen lds
  s_add_u32 s20, s20, 64
  s_add_u32 s21, s21, s23
  v_mfma_f32_32x32x16_bf16 a[208:223], v[108:111], v[116:119], a[208:223]
  ds_read_b64_tr_b16 v[78:79], v21 offset:34816
  s_waitcnt lgkmcnt(0)
  v_mfma_f32_32x32x16_bf16 a[0:15], v[64:67], v[80:83], a[0:15]
  ds_read_b64_tr_b16 v[96:97], v18 offset:40960
  ds_read_b64_tr_b16 v[98:99], v18 offset:43008
  v_mfma_f32_32x32x16_bf16 a[16:31], v[64:67], v[84:87], a[16:31]
  ds_read_b128 v[112:115], v13 offset:32768
  ds_read_b128 v[116:119], v13 offset:34816
  v_mfma_f32_32x32x16_bf16 a[64:79], v[68:71], v[80:83], a[64:79]
  ds_read_b64_tr_b16 v[100:101], v19 offset:40960
  s_add_u32 m0, s24, 65536
  s_nop 0
  buffer_load_dwordx4 v2, s[4:7], s20 offen lds
  v_mfma_f32_32x32x16_bf16 a[80:95], v[68:71], v[84:87], a[80:95]
  ds_read_b64_tr_b16 v[102:103], v19 offset:43008
  v_mfma_f32_32x32x16_bf16 a[128:143], v[72:75], v[80:83], a[128:143]
  ds_read_b64_tr_b16 v[104:105], v20 offset:40960
  s_add_u32 m0, s24, 66560
  s_nop 0
  buffer_load_dwordx4 v3, s[4:7], s20 offen lds
  v_mfma_f32_32x32x16_bf16 a[144:159], v[72:75], v[84:87], a[144:159]
  ds_read_b64_tr_b16 v[106:107], v20 offset:43008
  v_mfma_f32_32x32x16_bf16 a[192:207], v[76:79], v[80:83], a[192:207]
  ds_read_b64_tr_b16 v[108:109], v21 offset:40960
  s_add_u32 m0, s25, 65536
  s_nop 0
  buffer_load_dwordx4 v6, s[8:11], s21 offen lds
  v_mfma_f32_32x32x16_bf16 a[208:223], v[76:79], v[84:87], a[208:223]
  ds_read_b64_tr_b16 v[110:111], v21 offset:43008
  s_waitcnt vmcnt(9) lgkmcnt(0)
  s_barrier
  v_mfma_f32_32x32x16_bf16 a[0:15], v[96:99], v[112:115], a[0:15]
  ds_read_b64_tr_b16 v[64:65], v14 offset:0
  ds_read_b64_tr_b16 v[66:67], v14 offset:2048
  v_mfma_f32_32x32x16_bf16 a[16:31], v[96:99], v[116:119], a[16:31]
  ds_read_b128 v[80:83], v10 offset:0
  ds_read_b128 v[84:87], v10 offset:2048
  v_mfma_f32_32x32x16_bf16 a[64:79], v[100:103], v[112:115], a[64:79]
  ds_read_b64_tr_b16 v[68:69], v15 offset:0
  s_add_u32 m0, s25, 66560
  s_nop 0
  buffer_load_dwordx4 v7, s[8:11], s21 offen lds
  v_mfma_f32_32x32x16_bf16 a[80:95], v[100:103], v[116:119], a[80:95]
  ds_read_b64_tr_b16 v[70:71], v15 offset:2048
  v_mfma_f32_32x32x16_bf16 a[128:143], v[104:107], v[112:115], a[128:143]
  ds_read_b64_tr_b16 v[72:73], v16 offset:0
  s_add_u32 m0, s25, 67584
  s_nop 0
  buffer_load_dwordx4 v8, s[8:11], s21 offen lds
  v_mfma_f32_32x32x16_bf16 a[144:159], v[104:107], v[116:119], a[144:159]
  ds_read_b64_tr_b16 v[74:75], v16 offset:2048
  v_mfma_f32_32x32x16_bf16 a[192:207], v[108:111], v[112:115], a[192:207]
  ds_read_b64_tr_b16 v[76:77], v17 offset:0
  s_add_u32 m0, s25, 68608
  s_nop 0
  buffer_load_dwordx4 v9, s[8:11], s21 offen lds
  s_add_u32 s20, s20, 64
  s_add_u32 s21, s21, s23
  v_mfma_f32_32x32x16_bf16 a[208:223], v[108:111], v[116:119], a[208:223]
  ds_read_b64_tr_b16 v[78:79], v17 offset:2048
  s_waitcnt lgkmcnt(0)
  v_mfma_f32_32x32x16_bf16 a[0:15], v[64:67], v[80:83], a[0:15]
  ds_read_b64_tr_b16 v[96:97], v14 offset:8192
  ds_read_b64_tr_b16 v[98:99], v14 offset:10240
  v_mfma_f32_32x32x16_bf16 a[16:31], v[64:67], v[84:87], a[16:31]
  ds_read_b128 v[112:115], v11 offset:0
  ds_read_b128 v[116:119], v11 offset:2048
  v_mfma_f32_32x32x16_bf16 a[64:79], v[68:71], v[80:83], a[64:79]
  ds_read_b64_tr_b16 v[100:101], v15 offset:8192
  s_add_u32 m0, s24, 98304
  s_nop 0
  buffer_load_dwordx4 v2, s[4:7], s20 offen lds
  v_mfma_f32_32x32x16_bf16 a[80:95], v[68:71], v[84:87], a[80:95]
  ds_read_b64_tr_b16 v[102:103], v15 offset:10240
  v_mfma_f32_32x32x16_bf16 a[128:143], v[72:75], v[80:83], a[128:143]
  ds_read_b64_tr_b16 v[104:105], v16 offset:8192
  s_add_u32 m0, s24, 99328
  s_nop 0
  buffer_load_dwordx4 v3, s[4:7], s20 offen lds
  v_mfma_f32_32x32x16_bf16 a[144:159], v[72:75], v[84:87], a[144:159]
  ds_read_b64_tr_b16 v[106:107], v16 offset:10240
  v_mfma_f32_32x32x16_bf16 a[192:207], v[76:79], v[80:83], a[192:207]
  ds_read_b64_tr_b16 v[108:109], v17 offset:8192
  s_add_u32 m0, s25, 98304
  s_nop 0
  buffer_load_dwordx4 v6, s[8:11], s21 offen lds
  v_mfma_f32_32x32x16_bf16 a[208:223], v[76:79], v[84:87], a[208:223]
  ds_read_b64_tr_b16 v[110:111], v17 offset:10240
  s_waitcnt vmcnt(9) lgkmcnt(0)
  s_barrier
  v_mfma_f32_32x32x16_bf16 a[0:15], v[96:99], v[112:115], a[0:15]
  ds_read_b64_tr_b16 v[64:65], v14 offset:32768
  ds_read_b64_tr_b16 v[66:67], v14 offset:34816
  v_mfma_f32_32x32x16_bf16 a[16:31], v[96:99], v[116:119], a[16:31]
  ds_read_b128 v[80:83], v10 offset:32768
  ds_read_b128 v[84:87], v10 offset:34816
  v_mfma_f32_32x32x16_bf16 a[64:79], v[100:103], v[112:115], a[64:79]
  ds_read_b64_tr_b16 v[68:69], v15 offset:32768
  s_add_u32 m0, s25, 99328
  s_nop 0
  buffer_load_dwordx4 v7, s[8:11], s21 offen lds
  v_mfma_f32_32x32x16_bf16 a[80:95], v[100:103], v[116:119], a[80:95]
  ds_read_b64_tr_b16 v[70:71], v15 offset:34816
  v_mfma_f32_32x32x16_bf16 a[128:143], v[104:107], v[112:115], a[128:143]
  ds_read_b64_tr_b16 v[72:73], v16 offset:32768
  s_add_u32 m0, s25, 100352
  s_nop 0
  buffer_load_dwordx4 v8, s[8:11], s21 offen lds
  v_mfma_f32_32x32x16_bf16 a[144:159], v[104:107], v[116:119], a[144:159]
  ds_read_b64_tr_b16 v[74:75], v16 offset:34816
  v_mfma_f32_32x32x16_bf16 a[192:207], v[108:111], v[112:115], a[192:207]
  ds_read_b64_tr_b16 v[76:77], v17 offset:32768
  s_add_u32 m0, s25, 101376
  s_nop 0
  buffer_load_dwordx4 v9, s[8:11], s21 offen lds
  s_add_u32 s20, s20, 64
  s_add_u32 s21, s21, s23
  v_mfma_f32_32x32x16_bf16 a[208:223], v[108:111], v[116:119], a[208:223]
  ds_read_b64_tr_b16 v[78:79], v17 offset:34816
  s_waitcnt lgkmcnt(0)
  v_mfma_f32_32x32x16_bf16 a[0:15], v[64:67], v[80:83], a[0:15]
  ds_read_b64_tr_b16 v[96:97], v14 offset:40960
  ds_read_b64_tr_b16 v[98:99], v14 offset:43008
  v_mfma_f32_32x32x16_bf16 a[16:31], v[64:67], v[84:87], a[16:31]
  ds_read_b128 v[112:115], v11 offset:32768
  ds_read_b128 v[116:119], v11 offset:34816
  v_mfma_f32_32x32x16_bf16 a[64:79], v[68:71], v[80:83], a[64:79]
  ds_read_b64_tr_b16 v[100:101], v15 offset:40960
  s_add_u32 m0, s24, 0
  s_nop 0
  buffer_load_dwordx4 v2, s[4:7], s20 offen lds
  v_mfma_f32_32x32x16_bf16 a[80:95], v[68:71], v[84:87], a[80:95]
  ds_read_b64_tr_b16 v[102:103], v15 offset:43008
  v_mfma_f32_32x32x16_bf16 a[128:143], v[72:75], v[80:83], a[128:143]
  ds_read_b64_tr_b16 v[104:105], v16 offset:40960
  s_add_u32 m0, s24, 1024
  s_nop 0
  buffer_load_dwordx4 v3, s[4:7], s20 offen lds
  v_mfma_f32_32x32x16_bf16 a[144:159], v[72:75], v[84:87], a[144:159]
  ds_read_b64_tr_b16 v[106:107], v16 offset:43008
  v_mfma_f32_32x32x16_bf16 a[192:207], v[76:79], v[80:83], a[192:207]
  ds_read_b64_tr_b16 v[108:109], v17 offset:40960
  s_add_u32 m0, s25, 0
  s_nop 0
  buffer_load_dwordx4 v6, s[8:11], s21 offen lds
  v_mfma_f32_32x32x16_bf16 a[208:223], v[76:79], v[84:87], a[208:223]
  ds_read_b64_tr_b16 v[110:111], v17 offset:43008
  s_waitcnt vmcnt(9) lgkmcnt(0)
  s_barrier
  v_mfma_f32_32x32x16_bf16 a[0:15], v[96:99], v[112:115], a[0:15]
  ds_read_b64_tr_b16 v[64:65], v18 offset:0
  ds_read_b64_tr_b16 v[66:67], v18 offset:2048
  v_mfma_f32_32x32x16_bf16 a[16:31], v[96:99], v[116:119], a[16:31]
  ds_read_b128 v[80:83], v12 offset:0
  ds_read_b128 v[84:87], v12 offset:2048
  v_mfma_f32_32x32x16_bf16 a[64:79], v[100:103], v[112:115], a[64:79]
  ds_read_b64_tr_b16 v[68:69], v19 offset:0
  s_add_u32 m0, s25, 1024
  s_nop 0
  buffer_load_dwordx4 v7, s[8:11], s21 offen lds
  v_mfma_f32_32x32x16_bf16 a[80:95], v[100:103], v[116:119], a[80:95]
  ds_read_b64_tr_b16 v[70:71], v19 offset:2048
  v_mfma_f32_32x32x16_bf16 a[128:143], v[104:107], v[112:115], a[128:143]
  ds_read_b64_tr_b16 v[72:73], v20 offset:0
  s_add_u32 m0, s25, 2048
  s_nop 0
  buffer_load_dwordx4 v8, s[8:11], s21 offen lds
  v_mfma_f32_32x32x16_bf16 a[144:159], v[104:107], v[116:119], a[144:159]
  ds_read_b64_tr_b16 v[74:75], v20 offset:2048
  v_mfma_f32_32x32x16_bf16 a[192:207], v[108:111], v[112:115], a[192:207]
  ds_read_b64_tr_b16 v[76:77], v21 offset:0
  s_add_u32 m0, s25, 3072
  s_nop 0
  buffer_load_dwordx4 v9, s[8:11], s21 offen lds
  s_add_u32 s20, s20, 64
  s_add_u32 s21, s21, s23
  v_mfma_f32_32x32x16_bf16 a[208:223], v[108:111], v[116:119], a[208:223]
  ds_read_b64_tr_b16 v[78:79], v21 offset:2048
  s_waitcnt lgkmcnt(0)
  v_mfma_f32_32x32x16_bf16 a[0:15], v[64:67], v[80:83], a[0:15]
  ds_read_b64_tr_b16 v[96:97], v18 offset:8192
  ds_read_b64_tr_b16 v[98:99], v18 offset:10240
  v_mfma_f32_32x32x16_bf16 a[16:31], v[64:67], v[84:87], a[16:31]
  ds_read_b128 v[112:115], v13 offset:0
  ds_read_b128 v[116:119], v13 offset:2048
  v_mfma_f32_32x32x16_bf16 a[64:79], v[68:71], v[80:83], a[64:79]
  ds_read_b64_tr_b16 v[100:101], v19 offset:8192
  s_add_u32 m0, s24, 32768
  s_nop 0
  buffer_load_dwordx4 v2, s[4:7], s20 offen lds
  v_mfma_f32_32x32x16_bf16 a[80:95], v[68:71], v[84:87], a[80:95]
  ds_read_b64_tr_b16 v[102:103], v19 offset:10240
  v_mfma_f32_32x32x16_bf16 a[128:143], v[72:75], v[80:83], a[128:143]
  ds_read_b64_tr_b16 v[104:105], v20 offset:8192
  s_add_u32 m0, s24, 33792
  s_nop 0
  buffer_load_dwordx4 v3, s[4:7], s20 offen lds
  v_mfma_f32_32x32x16_bf16 a[144:159], v[72:75], v[84:87], a[144:159]
  ds_read_b64_tr_b16 v[106:107], v20 offset:10240
  v_mfma_f32_32x32x16_bf16 a[192:207], v[76:79], v[80:83], a[192:207]
  ds_read_b64_tr_b16 v[108:109], v21 offset:8192
  s_add_u32 m0, s25, 32768
  s_nop 0
  buffer_load_dwordx4 v6, s[8:11], s21 offen lds
  v_mfma_f32_32x32x16_bf16 a[208:223], v[76:79], v[84:87], a[208:223]
  ds_read_b64_tr_b16 v[110:111], v21 offset:10240
  s_waitcnt vmcnt(9) lgkmcnt(0)
  s_barrier
  v_mfma_f32_32x32x16_bf16 a[0:15], v[96:99], v[112:115], a[0:15]
  ds_read_b64_tr_b16 v[64:65], v18 offset:32768
  ds_read_b64_tr_b16 v[66:67], v18 offset:34816
  v_mfma_f32_32x32x16_bf16 a[16:31], v[96:99], v[116:119], a[16:31]
  ds_read_b128 v[80:83], v12 offset:32768
  ds_read_b128 v[84:87], v12 offset:34816
  v_mfma_f32_32x32x16_bf16 a[64:79], v[100:103], v[112:115], a[64:79]
  ds_read_b64_tr_b16 v[68:69], v19 offset:32768
  s_add_u32 m0, s25, 33792
  s_nop 0
  buffer_load_dwordx4 v7, s[8:11], s21 offen lds
  v_mfma_f32_32x32x16_bf16 a[80:95], v[100:103], v[116:119], a[80:95]
  ds_read_b64_tr_b16 v[70:71], v19 offset:34816
  v_mfma_f32_32x32x16_bf16 a[128:143], v[104:107], v[112:115], a[128:143]
  ds_read_b64_tr_b16 v[72:73], v20 offset:32768
  s_add_u32 m0, s25, 34816
  s_nop 0
  buffer_load_dwordx4 v8, s[8:11], s21 offen lds
  v_mfma_f32_32x32x16_bf16 a[144:159], v[104:107], v[116:119], a[144:159]
  ds_read_b64_tr_b16 v[74:75], v20 offset:34816
  v_mfma_f32_32x32x16_bf16 a[192:207], v[108:111], v[112:115], a[192:207]
  ds_read_b64_tr_b16 v[76:77], v21 offset:32768
  s_add_u32 m0, s25, 35840
  s_nop 0
  buffer_load_dwordx4 v9, s[8:11], s21 offen lds
  s_add_u32 s20, s20, 64
  s_add_u32 s21, s21, s23
  v_mfma_f32_32x32x16_bf16 a[208:223], v[108:111], v[116:119], a[208:223]
  ds_read_b64_tr_b16 v[78:79], v21 offset:34816
  s_waitcnt lgkmcnt(0)
  v_mfma_f32_32x32x16_bf16 a[0:15], v[64:67], v[80:83], a[0:15]
  ds_read_b64_tr_b16 v[96:97], v18 offset:40960
  ds_read_b64_tr_b16 v[98:99], v18 offset:43008
  v_mfma_f32_32x32x16_bf16 a[16:31], v[64:67], v[84:87], a[16:31]
  ds_read_b128 v[112:115], v13 offset:32768
  ds_read_b128 v[116:119], v13 offset:34816
  v_mfma_f32_32x32x16_bf16 a[64:79], v[68:71], v[80:83], a[64:79]
  ds_read_b64_tr_b16 v[100:101], v19 offset:40960
  s_add_u32 m0, s24, 65536
  s_nop 0
  buffer_load_dwordx4 v2, s[4:7], s20 offen lds
  v_mfma_f32_32x32x16_bf16 a[80:95], v[68:71], v[84:87], a[80:95]
  ds_read_b64_tr_b16 v[102:103], v19 offset:43008
  v_mfma_f32_32x32x16_bf16 a[128:143], v[72:75], v[80:83], a[128:143]
  ds_read_b64_tr_b16 v[104:105], v20 offset:40960
  s_add_u32 m0, s24, 66560
  s_nop 0
  buffer_load_dwordx4 v3, s[4:7], s20 offen lds
  v_mfma_f32_32x32x16_bf16 a[144:159], v[72:75], v[84:87], a[144:159]
  ds_read_b64_tr_b16 v[106:107], v20 offset:43008
  v_mfma_f32_32x32x16_bf16 a[192:207], v[76:79], v[80:83], a[192:207]
  ds_read_b64_tr_b16 v[108:109], v21 offset:40960
  s_add_u32 m0, s25, 65536
  s_nop 0
  buffer_load_dwordx4 v6, s[8:11], s21 offen lds
  v_mfma_f32_32x32x16_bf16 a[208:223], v[76:79], v[84:87], a[208:223]
  ds_read_b64_tr_b16 v[110:111], v21 offset:43008
  s_waitcnt vmcnt(9) lgkmcnt(0)
  s_barrier
  v_mfma_f32_32x32x16_bf16 a[0:15], v[96:99], v[112:115], a[0:15]
  ds_read_b64_tr_b16 v[64:65], v14 offset:0
  ds_read_b64_tr_b16 v[66:67], v14 offset:2048
  v_mfma_f32_32x32x16_bf16 a[16:31], v[96:99], v[116:119], a[16:31]
  ds_read_b128 v[80:83], v10 offset:0
  ds_read_b128 v[84:87], v10 offset:2048
  v_mfma_f32_32x32x16_bf16 a[64:79], v[100:103], v[112:115], a[64:79]
  ds_read_b64_tr_b16 v[68:69], v15 offset:0
  s_add_u32 m0, s25, 66560
  s_nop 0
  buffer_load_dwordx4 v7, s[8:11], s21 offen lds
  v_mfma_f32_32x32x16_bf16 a[80:95], v[100:103], v[116:119], a[80:95]
  ds_read_b64_tr_b16 v[70:71], v15 offset:2048
  v_mfma_f32_32x32x16_bf16 a[128:143], v[104:107], v[112:115], a[128:143]
  ds_read_b64_tr_b16 v[72:73], v16 offset:0
  s_add_u32 m0, s25, 67584
  s_nop 0
  buffer_load_dwordx4 v8, s[8:11], s21 offen lds
  v_mfma_f32_32x32x16_bf16 a[144:159], v[104:107], v[116:119], a[144:159]
  ds_read_b64_tr_b16 v[74:75], v16 offset:2048
  v_mfma_f32_32x32x16_bf16 a[192:207], v[108:111], v[112:115], a[192:207]
  ds_read_b64_tr_b16 v[76:77], v17 offset:0
  s_add_u32 m0, s25, 68608
  s_nop 0
  buffer_load_dwordx4 v9, s[8:11], s21 offen lds
  s_add_u32 s20, s20, 64
  s_add_u32 s21, s21, s23
  v_mfma_f32_32x32x16_bf16 a[208:223], v[108:111], v[116:119], a[208:223]
  ds_read_b64_tr_b16 v[78:79], v17 offset:2048
  s_waitcnt lgkmcnt(0)
  v_mfma_f32_32x32x16_bf16 a[0:15], v[64:67], v[80:83], a[0:15]
  ds_read_b64_tr_b16 v[96:97], v14 offset:8192
  ds_read_b64_tr_b16 v[98:99], v14 offset:10240
  v_mfma_f32_32x32x16_bf16 a[16:31], v[64:67], v[84:87], a[16:31]
  ds_read_b128 v[112:115], v11 offset:0
  ds_read_b128 v[116:119], v11 offset:2048
  v_mfma_f32_32x32x16_bf16 a[64:79], v[68:71], v[80:83], a[64:79]
  ds_read_b64_tr_b16 v[100:101], v15 offset:8192
  s_add_u32 m0, s24, 98304
  s_nop 0
  buffer_load_dwordx4 v2, s[4:7], s20 offen lds
  v_mfma_f32_32x32x16_bf16 a[80:95], v[68:71], v[84:87], a[80:95]
  ds_read_b64_tr_b16 v[102:103], v15 offset:10240
  v_mfma_f32_32x32x16_bf16 a[128:143], v[72:75], v[80:83], a[128:143]
  ds_read_b64_tr_b16 v[104:105], v16 offset:8192
  s_add_u32 m0, s24, 99328
  s_nop 0
  buffer_load_dwordx4 v3, s[4:7], s20 offen lds
  v_mfma_f32_32x32x16_bf16 a[144:159], v[72:75], v[84:87], a[144:159]
  ds_read_b64_tr_b16 v[106:107], v16 offset:10240
  v_mfma_f32_32x32x16_bf16 a[192:207], v[76:79], v[80:83], a[192:207]
  ds_read_b64_tr_b16 v[108:109], v17 offset:8192
  s_add_u32 m0, s25, 98304
  s_nop 0
  buffer_load_dwordx4 v6, s[8:11], s21 offen lds
  v_mfma_f32_32x32x16_bf16 a[208:223], v[76:79], v[84:87], a[208:223]
  ds_read_b64_tr_b16 v[110:111], v17 offset:10240
  s_waitcnt vmcnt(9) lgkmcnt(0)
  s_barrier
  v_mfma_f32_32x32x16_bf16 a[0:15], v[96:99], v[112:115], a[0:15]
  ds_read_b64_tr_b16 v[64:65], v14 offset:32768
  ds_read_b64_tr_b16 v[66:67], v14 offset:34816
  v_mfma_f32_32x32x16_bf16 a[16:31], v[96:99], v[116:119], a[16:31]
  ds_read_b128 v[80:83], v10 offset:32768
  ds_read_b128 v[84:87], v10 offset:34816
  v_mfma_f32_32x32x16_bf16 a[64:79], v[100:103], v[112:115], a[64:79]
  ds_read_b64_tr_b16 v[68:69], v15 offset:32768
  s_add_u32 m0, s25, 99328
  s_nop 0
  buffer_load_dwordx4 v7, s[8:11], s21 offen lds
  v_mfma_f32_32x32x16_bf16 a[80:95], v[100:103], v[116:119], a[80:95]
  ds_read_b64_tr_b16 v[70:71], v15 offset:34816
  v_mfma_f32_32x32x16_bf16 a[128:143], v[104:107], v[112:115], a[128:143]
  ds_read_b64_tr_b16 v[72:73], v16 offset:32768
  s_add_u32 m0, s25, 100352
  s_nop 0
  buffer_load_dwordx4 v8, s[8:11], s21 offen lds
  v_mfma_f32_32x32x16_bf16 a[144:159], v[104:107], v[116:119], a[144:159]
  ds_read_b64_tr_b16 v[74:75], v16 offset:34816
  v_mfma_f32_32x32x16_bf16 a[192:207], v[108:111], v[112:115], a[192:207]
  ds_read_b64_tr_b16 v[76:77], v17 offset:32768
  s_add_u32 m0, s25, 101376
  s_nop 0
  buffer_load_dwordx4 v9, s[8:11], s21 offen lds
  s_add_u32 s20, s20, 64
  s_add_u32 s21, s21, s23
  v_mfma_f32_32x32x16_bf16 a[208:223], v[108:111], v[116:119], a[208:223]
  ds_read_b64_tr_b16 v[78:79], v17 offset:34816
  s_waitcnt lgkmcnt(0)
  v_mfma_f32_32x32x16_bf16 a[0:15], v[64:67], v[80:83], a[0:15]
  ds_read_b64_tr_b16 v[96:97], v14 offset:40960
  ds_read_b64_tr_b16 v[98:99], v14 offset:43008
  v_mfma_f32_32x32x16_bf16 a[16:31], v[64:67], v[84:87], a[16:31]
  ds_read_b128 v[112:115], v11 offset:32768
  ds_read_b128 v[116:119], v11 offset:34816
  v_mfma_f32_32x32x16_bf16 a[64:79], v[68:71], v[80:83], a[64:79]
  ds_read_b64_tr_b16 v[100:101], v15 offset:40960
  v_mfma_f32_32x32x16_bf16 a[80:95], v[68:71], v[84:87], a[80:95]
  ds_read_b64_tr_b16 v[102:103], v15 offset:43008
  v_mfma_f32_32x32x16_bf16 a[128:143], v[72:75], v[80:83], a[128:143]
  ds_read_b64_tr_b16 v[104:105], v16 offset:40960
  v_mfma_f32_32x32x16_bf16 a[144:159], v[72:75], v[84:87], a[144:159]
  ds_read_b64_tr_b16 v[106:107], v16 offset:43008
  v_mfma_f32_32x32x16_bf16 a[192:207], v[76:79], v[80:83], a[192:207]
  ds_read_b64_tr_b16 v[108:109], v17 offset:40960
  v_mfma_f32_32x32x16_bf16 a[208:223], v[76:79], v[84:87], a[208:223]
  ds_read_b64_tr_b16 v[110:111], v17 offset:43008
  s_waitcnt vmcnt(6) lgkmcnt(0)
  s_barrier
  v_mfma_f32_32x32x16_bf16 a[0:15], v[96:99], v[112:115], a[0:15]
  ds_read_b64_tr_b16 v[64:65], v18 offset:0
  ds_read_b64_tr_b16 v[66:67], v18 offset:2048
  v_mfma_f32_32x32x16_bf16 a[16:31], v[96:99], v[116:119], a[16:31]
  ds_read_b128 v[80:83], v12 offset:0
  ds_read_b128 v[84:87], v12 offset:2048
  v_mfma_f32_32x32x16_bf16 a[64:79], v[100:103], v[112:115], a[64:79]
  ds_read_b64_tr_b16 v[68:69], v19 offset:0
  v_mfma_f32_32x32x16_bf16 a[80:95], v[100:103], v[116:119], a[80:95]
  ds_read_b64_tr_b16 v[70:71], v19 offset:2048
  v_mfma_f32_32x32x16_bf16 a[128:143], v[104:107], v[112:115], a[128:143]
  ds_read_b64_tr_b16 v[72:73], v20 offset:0
  v_mfma_f32_32x32x16_bf16 a[144:159], v[104:107], v[116:119], a[144:159]
  ds_read_b64_tr_b16 v[74:75], v20 offset:2048
  v_mfma_f32_32x32x16_bf16 a[192:207], v[108:111], v[112:115], a[192:207]
  ds_read_b64_tr_b16 v[76:77], v21 offset:0
  v_mfma_f32_32x32x16_bf16 a[208:223], v[108:111], v[116:119], a[208:223]
  ds_read_b64_tr_b16 v[78:79], v21 offset:2048
  s_waitcnt lgkmcnt(0)
  v_mfma_f32_32x32x16_bf16 a[0:15], v[64:67], v[80:83], a[0:15]
  ds_read_b64_tr_b16 v[96:97], v18 offset:8192
  ds_read_b64_tr_b16 v[98:99], v18 offset:10240
  v_mfma_f32_32x32x16_bf16 a[16:31], v[64:67], v[84:87], a[16:31]
  ds_read_b128 v[112:115], v13 offset:0
  ds_read_b128 v[116:119], v13 offset:2048
  v_mfma_f32_32x32x16_bf16 a[64:79], v[68:71], v[80:83], a[64:79]
  ds_read_b64_tr_b16 v[100:101], v19 offset:8192
  v_mfma_f32_32x32x16_bf16 a[80:95], v[68:71], v[84:87], a[80:95]
  ds_read_b64_tr_b16 v[102:103], v19 offset:10240
  v_mfma_f32_32x32x16_bf16 a[128:143], v[72:75], v[80:83], a[128:143]
  ds_read_b64_tr_b16 v[104:105], v20 offset:8192
  v_mfma_f32_32x32x16_bf16 a[144:159], v[72:75], v[84:87], a[144:159]
  ds_read_b64_tr_b16 v[106:107], v20 offset:10240
  v_mfma_f32_32x32x16_bf16 a[192:207], v[76:79], v[80:83], a[192:207]
  ds_read_b64_tr_b16 v[108:109], v21 offset:8192
  v_mfma_f32_32x32x16_bf16 a[208:223], v[76:79], v[84:87], a[208:223]
  ds_read_b64_tr_b16 v[110:111], v21 offset:10240
  s_waitcnt vmcnt(0) lgkmcnt(0)
  s_barrier
  v_mfma_f32_32x32x16_bf16 a[0:15], v[96:99], v[112:115], a[0:15]
  ds_read_b64_tr_b16 v[64:65], v18 offset:32768
  ds_read_b64_tr_b16 v[66:67], v18 offset:34816
  v_mfma_f32_32x32x16_bf16 a[16:31], v[96:99], v[116:119], a[16:31]
  ds_read_b128 v[80:83], v12 offset:32768
  ds_read_b128 v[84:87], v12 offset:34816
  v_mfma_f32_32x32x16_bf16 a[64:79], v[100:103], v[112:115], a[64:79]
  ds_read_b64_tr_b16 v[68:69], v19 offset:32768
  v_mfma_f32_32x32x16_bf16 a[80:95], v[100:103], v[116:119], a[80:95]
  ds_read_b64_tr_b16 v[70:71], v19 offset:34816
  v_mfma_f32_32x32x16_bf16 a[128:143], v[104:107], v[112:115], a[128:143]
  ds_read_b64_tr_b16 v[72:73], v20 offset:32768
  v_mfma_f32_32x32x16_bf16 a[144:159], v[104:107], v[116:119], a[144:159]
  ds_read_b64_tr_b16 v[74:75], v20 offset:34816
  v_mfma_f32_32x32x16_bf16 a[192:207], v[108:111], v[112:115], a[192:207]
  ds_read_b64_tr_b16 v[76:77], v21 offset:32768
  v_mfma_f32_32x32x16_bf16 a[208:223], v[108:111], v[116:119], a[208:223]
  ds_read_b64_tr_b16 v[78:79], v21 offset:34816
  s_waitcnt lgkmcnt(0)
  v_mfma_f32_32x32x16_bf16 a[0:15], v[64:67], v[80:83], a[0:15]
  ds_read_b64_tr_b16 v[96:97], v18 offset:40960
  ds_read_b64_tr_b16 v[98:99], v18 offset:43008
  v_mfma_f32_32x32x16_bf16 a[16:31], v[64:67], v[84:87], a[16:31]
  ds_read_b128 v[112:115], v13 offset:32768
  ds_read_b128 v[116:119], v13 offset:34816
  v_mfma_f32_32x32x16_bf16 a[64:79], v[68:71], v[80:83], a[64:79]
  ds_read_b64_tr_b16 v[100:101], v19 offset:40960
  v_mfma_f32_32x32x16_bf16 a[80:95], v[68:71], v[84:87], a[80:95]
  ds_read_b64_tr_b16 v[102:103], v19 offset:43008
  v_mfma_f32_32x32x16_bf16 a[128:143], v[72:75], v[80:83], a[128:143]
  ds_read_b64_tr_b16 v[104:105], v20 offset:40960
  v_mfma_f32_32x32x16_bf16 a[144:159], v[72:75], v[84:87], a[144:159]
  ds_read_b64_tr_b16 v[106:107], v20 offset:43008
  v_mfma_f32_32x32x16_bf16 a[192:207], v[76:79], v[80:83], a[192:207]
  ds_read_b64_tr_b16 v[108:109], v21 offset:40960
  v_mfma_f32_32x32x16_bf16 a[208:223], v[76:79], v[84:87], a[208:223]
  ds_read_b64_tr_b16 v[110:111], v21 offset:43008
  s_waitcnt lgkmcnt(0)
  v_mfma_f32_32x32x16_bf16 a[0:15], v[96:99], v[112:115], a[0:15]
  v_mfma_f32_32x32x16_bf16 a[16:31], v[96:99], v[116:119], a[16:31]
  v_mfma_f32_32x32x16_bf16 a[64:79], v[100:103], v[112:115], a[64:79]
  v_mfma_f32_32x32x16_bf16 a[80:95], v[100:103], v[116:119], a[80:95]
  v_mfma_f32_32x32x16_bf16 a[128:143], v[104:107], v[112:115], a[128:143]
  v_mfma_f32_32x32x16_bf16 a[144:159], v[104:107], v[116:119], a[144:159]
  v_mfma_f32_32x32x16_bf16 a[192:207], v[108:111], v[112:115], a[192:207]
  v_mfma_f32_32x32x16_bf16 a[208:223], v[108:111], v[116:119], a[208:223]
  s_branch BGG_HEPI
BGG_HSWAP:
  s_add_u32 m0, s24, 0
  s_nop 0
  buffer_load_dwordx4 v2, s[4:7], s20 offen lds
  s_add_u32 m0, s24, 1024
  s_nop 0
  buffer_load_dwordx4 v3, s[4:7], s20 offen lds
  s_add_u32 m0, s25, 0
  s_nop 0
  buffer_load_dwordx4 v6, s[8:11], s21 offen lds
  s_add_u32 m0, s25, 1024
  s_nop 0
  buffer_load_dwordx4 v7, s[8:11], s21 offen lds
  s_add_u32 m0, s25, 2048
  s_nop 0
  buffer_load_dwordx4 v8, s[8:11], s21 offen lds
  s_add_u32 m0, s25, 3072
  s_nop 0
  buffer_load_dwordx4 v9, s[8:11], s21 offen lds
  s_add_u32 s20, s20, 64
  s_add_u32 s21, s21, s23
  s_add_u32 m0, s24, 32768
  s_nop 0
  buffer_load_dwordx4 v2, s[4:7], s20 offen lds
  s_add_u32 m0, s24, 33792
  s_nop 0
  buffer_load_dwordx4 v3, s[4:7], s20 offen lds
  s_add_u32 m0, s25, 32768
  s_nop 0
  buffer_load_dwordx4 v6, s[8:11], s21 offen lds
  s_add_u32 m0, s25, 33792
  s_nop 0
  buffer_load_dwordx4 v7, s[8:11], s21 offen lds
  s_add_u32 m0, s25, 34816
  s_nop 0
  buffer_load_dwordx4 v8, s[8:11], s21 offen lds
  s_add_u32 m0, s25, 35840
  s_nop 0
  buffer_load_dwordx4 v9, s[8:11], s21 offen lds
  s_add_u32 s20, s20, 64
  s_add_u32 s21, s21, s23
  s_add_u32 m0, s24, 65536
  s_nop 0
  buffer_load_dwordx4 v2, s[4:7], s20 offen lds
  s_add_u32 m0, s24, 66560
  s_nop 0
  buffer_load_dwordx4 v3, s[4:7], s20 offen lds
  s_add_u32 m0, s25, 65536
  s_nop 0
  buffer_load_dwordx4 v6, s[8:11], s21 offen lds
  s_add_u32 m0, s25, 66560
  s_nop 0
  buffer_load_dwordx4 v7, s[8:11], s21 offen lds
  s_add_u32 m0, s25, 67584
  s_nop 0
  buffer_load_dwordx4 v8, s[8:11], s21 offen lds
  s_add_u32 m0, s25, 68608
  s_nop 0
  buffer_load_dwordx4 v9, s[8:11], s21 offen lds
  s_add_u32 s20, s20, 64
  s_add_u32 s21, s21, s23
  s_waitcnt vmcnt(12)
  s_barrier
  ds_read_b64_tr_b16 v[64:65], v14 offset:0
  ds_read_b64_tr_b16 v[66:67], v14 offset:2048
  ds_read_b128 v[80:83], v10 offset:0
  ds_read_b128 v[84:87], v10 offset:2048
  ds_read_b64_tr_b16 v[68:69], v15 offset:0
  ds_read_b64_tr_b16 v[70:71], v15 offset:2048
  ds_read_b64_tr_b16 v[72:73], v16 offset:0
  ds_read_b64_tr_b16 v[74:75], v16 offset:2048
  ds_read_b64_tr_b16 v[76:77], v17 offset:0
  ds_read_b64_tr_b16 v[78:79], v17 offset:2048
  s_waitcnt lgkmcnt(0)
  v_mfma_f32_32x32x16_bf16 a[0:15], v[80:83], v[64:67], 0
  ds_read_b64_tr_b16 v[96:97], v14 offset:8192
  ds_read_b64_tr_b16 v[98:99], v14 offset:10240
  v_mfma_f32_32x32x16_bf16 a[16:31], v[84:87], v[64:67], 0
  ds_read_b128 v[112:115], v11 offset:0
  ds_read_b128 v[116:119], v11 offset:2048
  v_mfma_f32_32x32x16_bf16 a[64:79], v[80:83], v[68:71], 0
  ds_read_b64_tr_b16 v[100:101], v15 offset:8192
  s_add_u32 m0, s24, 98304
  s_nop 0
  buffer_load_dwordx4 v2, s[4:7], s20 offen lds
  v_mfma_f32_32x32x16_bf16 a[80:95], v[84:87], v[68:71], 0
  ds_read_b64_tr_b16 v[102:103], v15 offset:10240
  v_mfma_f32_32x32x16_bf16 a[128:143], v[80:83], v[72:75], 0
  ds_read_b64_tr_b16 v[104:105], v16 offset:8192
  s_add_u32 m0, s24, 99328
  s_nop 0
  buffer_load_dwordx4 v3, s[4:7], s20 offen lds
  v_mfma_f32_32x32x16_bf16 a[144:159], v[84:87], v[72:75], 0
  ds_read_b64_tr_b16 v[106:107], v16 offset:10240
  v_mfma_f32_32x32x16_bf16 a[192:207], v[80:83], v[76:79], 0
  ds_read_b64_tr_b16 v[108:109], v17 offset:8192
  s_add_u32 m0, s25, 98304
  s_nop 0
  buffer_load_dwordx4 v6, s[8:11], s21 offen lds
  v_mfma_f32_32x32x16_bf16 a[208:223], v[84:87], v[76:79], 0
  ds_read_b64_tr_b16 v[110:111], v17 offset:10240
  s_waitcnt vmcnt(9) lgkmcnt(0)
  s_barrier
  v_mfma_f32_32x32x16_bf16 a[0:15], v[112:115], v[96:99], a[0:15]
  ds_read_b64_tr_b16 v[64:65], v14 offset:32768
  ds_read_b64_tr_b16 v[66:67], v14 offset:34816
  v_mfma_f32_32x32x16_bf16 a[16:31], v[116:119], v[96:99], a[16:31]
  ds_read_b128 v[80:83], v10 offset:32768
  ds_read_b128 v[84:87], v10 offset:34816
  v_mfma_f32_32x32x16_bf16 a[64:79], v[112:115], v[100:103], a[64:79]
  ds_read_b64_tr_b16 v[68:69], v15 offset:32768
  s_add_u32 m0, s25, 99328
  s_nop 0
  buffer_load_dwordx4 v7, s[8:11], s21 offen lds
  v_mfma_f32_32x32x16_bf16 a[80:95], v[116:119], v[100:103], a[80:95]
  ds_read_b64_tr_b16 v[70:71], v15 offset:34816
  v_mfma_f32_32x32x16_bf16 a[128:143], v[112:115], v[104:107], a[128:143]
  ds_read_b64_tr_b16 v[72:73], v16 offset:32768
  s_add_u32 m0, s25, 100352
  s_nop 0
  buffer_load_dwordx4 v8, s[8:11], s21 offen lds
  v_mfma_f32_32x32x16_bf16 a[144:159], v[116:119], v[104:107], a[144:159]
  ds_read_b64_tr_b16 v[74:75], v16 offset:34816
  v_mfma_f32_32x32x16_bf16 a[192:207], v[112:115], v[108:111], a[192:207]
  ds_read_b64_tr_b16 v[76:77], v17 offset:32768
  s_add_u32 m0, s25, 101376
  s_nop 0
  buffer_load_dwordx4 v9, s[8:11], s21 offen lds
  s_add_u32 s20, s20, 64
  s_add_u32 s21, s21, s23
  v_mfma_f32_32x32x16_bf16 a[208:223], v[116:119], v[108:111], a[208:223]
  ds_read_b64_tr_b16 v[78:79], v17 offset:34816
  s_waitcnt lgkmcnt(0)
  v_mfma_f32_32x32x16_bf16 a[0:15], v[80:83], v[64:67], a[0:15]
  ds_read_b64_tr_b16 v[96:97], v14 offset:40960
  ds_read_b64_tr_b16 v[98:99], v14 offset:43008
  v_mfma_f32_32x32x16_bf16 a[16:31], v[84:87], v[64:67], a[16:31]
  ds_read_b128 v[112:115], v11 offset:32768
  ds_read_b128 v[116:119], v11 offset:34816
  v_mfma_f32_32x32x16_bf16 a[64:79], v[80:83], v[68:71], a[64:79]
  ds_read_b64_tr_b16 v[100:101], v15 offset:40960
  s_add_u32 m0, s24, 0
  s_nop 0
  buffer_load_dwordx4 v2, s[4:7], s20 offen lds
  v_mfma_f32_32x32x16_bf16 a[80:95], v[84:87], v[68:71], a[80:95]
  ds_read_b64_tr_b16 v[102:103], v15 offset:43008
  v_mfma_f32_32x32x16_bf16 a[128:143], v[80:83], v[72:75], a[128:143]
  ds_read_b64_tr_b16 v[104:105], v16 offset:40960
  s_add_u32 m0, s24, 1024
  s_nop 0
  buffer_load_dwordx4 v3, s[4:7], s20 offen lds
  v_mfma_f32_32x32x16_bf16 a[144:159], v[84:87], v[72:75], a[144:159]
  ds_read_b64_tr_b16 v[106:107], v16 offset:43008
  v_mfma_f32_32x32x16_bf16 a[192:207], v[80:83], v[76:79], a[192:207]
  ds_read_b64_tr_b16 v[108:109], v17 offset:40960
  s_add_u32 m0, s25, 0
  s_nop 0
  buffer_load_dwordx4 v6, s[8:11], s21 offen lds
  v_mfma_f32_32x32x16_bf16 a[208:223], v[84:87], v[76:79], a[208:223]
  ds_read_b64_tr_b16 v[110:111], v17 offset:43008
  s_waitcnt vmcnt(9) lgkmcnt(0)
  s_barrier
  v_mfma_f32_32x32x16_bf16 a[0:15], v[112:115], v[96:99], a[0:15]
  ds_read_b64_tr_b16 v[64:65], v18 offset:0
  ds_read_b64_tr_b16 v[66:67], v18 offset:2048
  v_mfma_f32_32x32x16_bf16 a[16:31], v[116:119], v[96:99], a[16:31]
  ds_read_b128 v[80:83], v12 offset:0
  ds_read_b128 v[84:87], v12 offset:2048
  v_mfma_f32_32x32x16_bf16 a[64:79], v[112:115], v[100:103], a[64:79]
  ds_read_b64_tr_b16 v[68:69], v19 offset:0
  s_add_u32 m0, s25, 1024
  s_nop 0
  buffer_load_dwordx4 v7, s[8:11], s21 offen lds
  v_mfma_f32_32x32x16_bf16 a[80:95], v[116:119], v[100:103], a[80:95]
  ds_read_b64_tr_b16 v[70:71], v19 offset:2048
  v_mfma_f32_32x32x16_bf16 a[128:143], v[112:115], v[104:107], a[128:143]
  ds_read_b64_tr_b16 v[72:73], v20 offset:0
  s_add_u32 m0, s25, 2048
  s_nop 0
  buffer_load_dwordx4 v8, s[8:11], s21 offen lds
  v_mfma_f32_32x32x16_bf16 a[144:159], v[116:119], v[104:107], a[144:159]
  ds_read_b64_tr_b16 v[74:75], v20 offset:2048
  v_mfma_f32_32x32x16_bf16 a[192:207], v[112:115], v[108:111], a[192:207]
  ds_read_b64_tr_b16 v[76:77], v21 offset:0
  s_add_u32 m0, s25, 3072
  s_nop 0
  buffer_load_dwordx4 v9, s[8:11], s21 offen lds
  s_add_u32 s20, s20, 64
  s_add_u32 s21, s21, s23
  v_mfma_f32_32x32x16_bf16 a[208:223], v[116:119], v[108:111], a[208:223]
  ds_read_b64_tr_b16 v[78:79], v21 offset:2048
  s_waitcnt lgkmcnt(0)
  v_mfma_f32_32x32x16_bf16 a[0:15], v[80:83], v[64:67], a[0:15]
  ds_read_b64_tr_b16 v[96:97], v18 offset:8192
  ds_read_b64_tr_b16 v[98:99], v18 offset:10240
  v_mfma_f32_32x32x16_bf16 a[16:31], v[84:87], v[64:67], a[16:31]
  ds_read_b128 v[112:115], v13 offset:0
  ds_read_b128 v[116:119], v13 offset:2048
  v_mfma_f32_32x32x16_bf16 a[64:79], v[80:83], v[68:71], a[64:79]
  ds_read_b64_tr_b16 v[100:101], v19 offset:8192
  s_add_u32 m0, s24, 32768
  s_nop 0
  buffer_load_dwordx4 v2, s[4:7], s20 offen lds
  v_mfma_f32_32x32x16_bf16 a[80:95], v[84:87], v[68:71], a[80:95]
  ds_read_b64_tr_b16 v[102:103], v19 offset:10240
  v_mfma_f32_32x32x16_bf16 a[128:143], v[80:83], v[72:75], a[128:143]
  ds_read_b64_tr_b16 v[104:105], v20 offset:8192
  s_add_u32 m0, s24, 33792
  s_nop 0
  buffer_load_dwordx4 v3, s[4:7], s20 offen lds
  v_mfma_f32_32x32x16_bf16 a[144:159], v[84:87], v[72:75], a[144:159]
  ds_read_b64_tr_b16 v[106:107], v20 offset:10240
  v_mfma_f32_32x32x16_bf16 a[192:207], v[80:83], v[76:79], a[192:207]
  ds_read_b64_tr_b16 v[108:109], v21 offset:8192
  s_add_u32 m0, s25, 32768
  s_nop 0
  buffer_load_dwordx4 v6, s[8:11], s21 offen lds
  v_mfma_f32_32x32x16_bf16 a[208:223], v[84:87], v[76:79], a[208:223]
  ds_read_b64_tr_b16 v[110:111], v21 offset:10240
  s_waitcnt vmcnt(9) lgkmcnt(0)
  s_barrier
  v_mfma_f32_32x32x16_bf16 a[0:15], v[112:115], v[96:99], a[0:15]
  ds_read_b64_tr_b16 v[64:65], v18 offset:32768
  ds_read_b64_tr_b16 v[66:67], v18 offset:34816
  v_mfma_f32_32x32x16_bf16 a[16:31], v[116:119], v[96:99], a[16:31]
  ds_read_b128 v[80:83], v12 offset:32768
  ds_read_b128 v[84:87], v12 offset:34816
  v_mfma_f32_32x32x16_bf16 a[64:79], v[112:115], v[100:103], a[64:79]
  ds_read_b64_tr_b16 v[68:69], v19 offset:32768
  s_add_u32 m0, s25, 33792
  s_nop 0
  buffer_load_dwordx4 v7, s[8:11], s21 offen lds
  v_mfma_f32_32x32x16_bf16 a[80:95], v[116:119], v[100:103], a[80:95]
  ds_read_b64_tr_b16 v[70:71], v19 offset:34816
  v_mfma_f32_32x32x16_bf16 a[128:143], v[112:115], v[104:107], a[128:143]
  ds_read_b64_tr_b16 v[72:73], v20 offset:32768
  s_add_u32 m0, s25, 34816
  s_nop 0
  buffer_load_dwordx4 v8, s[8:11], s21 offen lds
  v_mfma_f32_32x32x16_bf16 a[144:159], v[116:119], v[104:107], a[144:159]
  ds_read_b64_tr_b16 v[74:75], v20 offset:34816
  v_mfma_f32_32x32x16_bf16 a[192:207], v[112:115], v[108:111], a[192:207]
  ds_read_b64_tr_b16 v[76:77], v21 offset:32768
  s_add_u32 m0, s25, 35840
  s_nop 0
  buffer_load_dwordx4 v9, s[8:11], s21 offen lds
  s_add_u32 s20, s20, 64
  s_add_u32 s21, s21, s23
  v_mfma_f32_32x32x16_bf16 a[208:223], v[116:119], v[108:111], a[208:223]
  ds_read_b64_tr_b16 v[78:79], v21 offset:34816
  s_waitcnt lgkmcnt(0)
  v_mfma_f32_32x32x16_bf16 a[0:15], v[80:83], v[64:67], a[0:15]
  ds_read_b64_tr_b16 v[96:97], v18 offset:40960
  ds_read_b64_tr_b16 v[98:99], v18 offset:43008
  v_mfma_f32_32x32x16_bf16 a[16:31], v[84:87], v[64:67], a[16:31]
  ds_read_b128 v[112:115], v13 offset:32768
  ds_read_b128 v[116:119], v13 offset:34816
  v_mfma_f32_32x32x16_bf16 a[64:79], v[80:83], v[68:71], a[64:79]
  ds_read_b64_tr_b16 v[100:101], v19 offset:40960
  s_add_u32 m0, s24, 65536
  s_nop 0
  buffer_load_dwordx4 v2, s[4:7], s20 offen lds
  v_mfma_f32_32x32x16_bf16 a[80:95], v[84:87], v[68:71], a[80:95]
  ds_read_b64_tr_b16 v[102:103], v19 offset:43008
  v_mfma_f32_32x32x16_bf16 a[128:143], v[80:83], v[72:75], a[128:143]
  ds_read_b64_tr_b16 v[104:105], v20 offset:40960
  s_add_u32 m0, s24, 66560
  s_nop 0
  buffer_load_dwordx4 v3, s[4:7], s20 offen lds
  v_mfma_f32_32x32x16_bf16 a[144:159], v[84:87], v[72:75], a[144:159]
  ds_read_b64_tr_b16 v[106:107], v20 offset:43008
  v_mfma_f32_32x32x16_bf16 a[192:207], v[80:83], v[76:79], a[192:207]
  ds_read_b64_tr_b16 v[108:109], v21 offset:40960
  s_add_u32 m0, s25, 65536
  s_nop 0
  buffer_load_dwordx4 v6, s[8:11], s21 offen lds
  v_mfma_f32_32x32x16_bf16 a[208:223], v[84:87], v[76:79], a[208:223]
  ds_read_b64_tr_b16 v[110:111], v21 offset:43008
  s_waitcnt vmcnt(9) lgkmcnt(0)
  s_barrier
  v_mfma_f32_32x32x16_bf16 a[0:15], v[112:115], v[96:99], a[0:15]
  ds_read_b64_tr_b16 v[64:65], v14 offset:0
  ds_read_b64_tr_b16 v[66:67], v14 offset:2048
  v_mfma_f32_32x32x16_bf16 a[16:31], v[116:119], v[96:99], a[16:31]
  ds_read_b128 v[80:83], v10 offset:0
  ds_read_b128 v[84:87], v10 offset:2048
  v_mfma_f32_32x32x16_bf16 a[64:79], v[112:115], v[100:103], a[64:79]
  ds_read_b64_tr_b16 v[68:69], v15 offset:0
  s_add_u32 m0, s25, 66560
  s_nop 0
  buffer_load_dwordx4 v7, s[8:11], s21 offen lds
  v_mfma_f32_32x32x16_bf16 a[80:95], v[116:119], v[100:103], a[80:95]
  ds_read_b64_tr_b16 v[70:71], v15 offset:2048
  v_mfma_f32_32x32x16_bf16 a[128:143], v[112:115], v[104:107], a[128:143]
  ds_read_b64_tr_b16 v[72:73], v16 offset:0
  s_add_u32 m0, s25, 67584
  s_nop 0
  buffer_load_dwordx4 v8, s[8:11], s21 offen lds
  v_mfma_f32_32x32x16_bf16 a[144:159], v[116:119], v[104:107], a[144:159]
  ds_read_b64_tr_b16 v[74:75], v16 offset:2048
  v_mfma_f32_32x32x16_bf16 a[192:207], v[112:115], v[108:111], a[192:207]
  ds_read_b64_tr_b16 v[76:77], v17 offset:0
  s_add_u32 m0, s25, 68608
  s_nop 0
  buffer_load_dwordx4 v9, s[8:11], s21 offen lds
  s_add_u32 s20, s20, 64
  s_add_u32 s21, s21, s23
  v_mfma_f32_32x32x16_bf16 a[208:223], v[116:119], v[108:111], a[208:223]
  ds_read_b64_tr_b16 v[78:79], v17 offset:2048
  s_waitcnt lgkmcnt(0)
  v_mfma_f32_32x32x16_bf16 a[0:15], v[80:83], v[64:67], a[0:15]
  ds_read_b64_tr_b16 v[96:97], v14 offset:8192
  ds_read_b64_tr_b16 v[98:99], v14 offset:10240
  v_mfma_f32_32x32x16_bf16 a[16:31], v[84:87], v[64:67], a[16:31]
  ds_read_b128 v[112:115], v11 offset:0
  ds_read_b128 v[116:119], v11 offset:2048
  v_mfma_f32_32x32x16_bf16 a[64:79], v[80:83], v[68:71], a[64:79]
  ds_read_b64_tr_b16 v[100:101], v15 offset:8192
  s_add_u32 m0, s24, 98304
  s_nop 0
  buffer_load_dwordx4 v2, s[4:7], s20 offen lds
  v_mfma_f32_32x32x16_bf16 a[80:95], v[84:87], v[68:71], a[80:95]
  ds_read_b64_tr_b16 v[102:103], v15 offset:10240
  v_mfma_f32_32x32x16_bf16 a[128:143], v[80:83], v[72:75], a[128:143]
  ds_read_b64_tr_b16 v[104:105], v16 offset:8192
  s_add_u32 m0, s24, 99328
  s_nop 0
  buffer_load_dwordx4 v3, s[4:7], s20 offen lds
  v_mfma_f32_32x32x16_bf16 a[144:159], v[84:87], v[72:75], a[144:159]
  ds_read_b64_tr_b16 v[106:107], v16 offset:10240
  v_mfma_f32_32x32x16_bf16 a[192:207], v[80:83], v[76:79], a[192:207]
  ds_read_b64_tr_b16 v[108:109], v17 offset:8192
  s_add_u32 m0, s25, 98304
  s_nop 0
  buffer_load_dwordx4 v6, s[8:11], s21 offen lds
  v_mfma_f32_32x32x16_bf16 a[208:223], v[84:87], v[76:79], a[208:223]
  ds_read_b64_tr_b16 v[110:111], v17 offset:10240
  s_waitcnt vmcnt(9) lgkmcnt(0)
  s_barrier
  v_mfma_f32_32x32x16_bf16 a[0:15], v[112:115], v[96:99], a[0:15]
  ds_read_b64_tr_b16 v[64:65], v14 offset:32768
  ds_read_b64_tr_b16 v[66:67], v14 offset:34816
  v_mfma_f32_32x32x16_bf16 a[16:31], v[116:119], v[96:99], a[16:31]
  ds_read_b128 v[80:83], v10 offset:32768
  ds_read_b128 v[84:87], v10 offset:34816
  v_mfma_f32_32x32x16_bf16 a[64:79], v[112:115], v[100:103], a[64:79]
  ds_read_b64_tr_b16 v[68:69], v15 offset:32768
  s_add_u32 m0, s25, 99328
  s_nop 0
  buffer_load_dwordx4 v7, s[8:11], s21 offen lds
  v_mfma_f32_32x32x16_bf16 a[80:95], v[116:119], v[100:103], a[80:95]
  ds_read_b64_tr_b16 v[70:71], v15 offset:34816
  v_mfma_f32_32x32x16_bf16 a[128:143], v[112:115], v[104:107], a[128:143]
  ds_read_b64_tr_b16 v[72:73], v16 offset:32768
  s_add_u32 m0, s25, 100352
  s_nop 0
  buffer_load_dwordx4 v8, s[8:11], s21 offen lds
  v_mfma_f32_32x32x16_bf16 a[144:159], v[116:119], v[104:107], a[144:159]
  ds_read_b64_tr_b16 v[74:75], v16 offset:34816
  v_mfma_f32_32x32x16_bf16 a[192:207], v[112:115], v[108:111], a[192:207]
  ds_read_b64_tr_b16 v[76:77], v17 offset:32768
  s_add_u32 m0, s25, 101376
  s_nop 0
  buffer_load_dwordx4 v9, s[8:11], s21 offen lds
  s_add_u32 s20, s20, 64
  s_add_u32 s21, s21, s23
  v_mfma_f32_32x32x16_bf16 a[208:223], v[116:119], v[108:111], a[208:223]
  ds_read_b64_tr_b16 v[78:79], v17 offset:34816
  s_waitcnt lgkmcnt(0)
  v_mfma_f32_32x32x16_bf16 a[0:15], v[80:83], v[64:67], a[0:15]
  ds_read_b64_tr_b16 v[96:97], v14 offset:40960
  ds_read_b64_tr_b16 v[98:99], v14 offset:43008
  v_mfma_f32_32x32x16_bf16 a[16:31], v[84:87], v[64:67], a[16:31]
  ds_read_b128 v[112:115], v11 offset:32768
  ds_read_b128 v[116:119], v11 offset:34816
  v_mfma_f32_32x32x16_bf16 a[64:79], v[80:83], v[68:71], a[64:79]
  ds_read_b64_tr_b16 v[100:101], v15 offset:40960
  s_add_u32 m0, s24, 0
  s_nop 0
  buffer_load_dwordx4 v2, s[4:7], s20 offen lds
  v_mfma_f32_32x32x16_bf16 a[80:95], v[84:87], v[68:71], a[80:95]
  ds_read_b64_tr_b16 v[102:103], v15 offset:43008
  v_mfma_f32_32x32x16_bf16 a[128:143], v[80:83], v[72:75], a[128:143]
  ds_read_b64_tr_b16 v[104:105], v16 offset:40960
  s_add_u32 m0, s24, 1024
  s_nop 0
  buffer_load_dwordx4 v3, s[4:7], s20 offen lds
  v_mfma_f32_32x32x16_bf16 a[144:159], v[84:87], v[72:75], a[144:159]
  ds_read_b64_tr_b16 v[106:107], v16 offset:43008
  v_mfma_f32_32x32x16_bf16 a[192:207], v[80:83], v[76:79], a[192:207]
  ds_read_b64_tr_b16 v[108:109], v17 offset:40960
  s_add_u32 m0, s25, 0
  s_nop 0
  buffer_load_dwordx4 v6, s[8:11], s21 offen lds
  v_mfma_f32_32x32x16_bf16 a[208:223], v[84:87], v[76:79], a[208:223]
  ds_read_b64_tr_b16 v[110:111], v17 offset:43008
  s_waitcnt vmcnt(9) lgkmcnt(0)
  s_barrier
  v_mfma_f32_32x32x16_bf16 a[0:15], v[112:115], v[96:99], a[0:15]
  ds_read_b64_tr_b16 v[64:65], v18 offset:0
  ds_read_b64_tr_b16 v[66:67], v18 offset:2048
  v_mfma_f32_32x32x16_bf16 a[16:31], v[116:119], v[96:99], a[16:31]
  ds_read_b128 v[80:83], v12 offset:0
  ds_read_b128 v[84:87], v12 offset:2048
  v_mfma_f32_32x32x16_bf16 a[64:79], v[112:115], v[100:103], a[64:79]
  ds_read_b64_tr_b16 v[68:69], v19 offset:0
  s_add_u32 m0, s25, 1024
  s_nop 0
  buffer_load_dwordx4 v7, s[8:11], s21 offen lds
  v_mfma_f32_32x32x16_bf16 a[80:95], v[116:119], v[100:103], a[80:95]
  ds_read_b64_tr_b16 v[70:71], v19 offset:2048
  v_mfma_f32_32x32x16_bf16 a[128:143], v[112:115], v[104:107], a[128:143]
  ds_read_b64_tr_b16 v[72:73], v20 offset:0
  s_add_u32 m0, s25, 2048
  s_nop 0
  buffer_load_dwordx4 v8, s[8:11], s21 offen lds
  v_mfma_f32_32x32x16_bf16 a[144:159], v[116:119], v[104:107], a[144:159]
  ds_read_b64_tr_b16 v[74:75], v20 offset:2048
  v_mfma_f32_32x32x16_bf16 a[192:207], v[112:115], v[108:111], a[192:207]
  ds_read_b64_tr_b16 v[76:77], v21 offset:0
  s_add_u32 m0, s25, 3072
  s_nop 0
  buffer_load_dwordx4 v9, s[8:11], s21 offen lds
  s_add_u32 s20, s20, 64
  s_add_u32 s21, s21, s23
  v_mfma_f32_32x32x16_bf16 a[208:223], v[116:119], v[108:111], a[208:223]
  ds_read_b64_tr_b16 v[78:79], v21 offset:2048
  s_waitcnt lgkmcnt(0)
  v_mfma_f32_32x32x16_bf16 a[0:15], v[80:83], v[64:67], a[0:15]
  ds_read_b64_tr_b16 v[96:97], v18 offset:8192
  ds_read_b64_tr_b16 v[98:99], v18 offset:10240
  v_mfma_f32_32x32x16_bf16 a[16:31], v[84:87], v[64:67], a[16:31]
  ds_read_b128 v[112:115], v13 offset:0
  ds_read_b128 v[116:119], v13 offset:2048
  v_mfma_f32_32x32x16_bf16 a[64:79], v[80:83], v[68:71], a[64:79]
  ds_read_b64_tr_b16 v[100:101], v19 offset:8192
  s_add_u32 m0, s24, 32768
  s_nop 0
  buffer_load_dwordx4 v2, s[4:7], s20 offen lds
  v_mfma_f32_32x32x16_bf16 a[80:95], v[84:87], v[68:71], a[80:95]
  ds_read_b64_tr_b16 v[102:103], v19 offset:10240
  v_mfma_f32_32x32x16_bf16 a[128:143], v[80:83], v[72:75], a[128:143]
  ds_read_b64_tr_b16 v[104:105], v20 offset:8192
  s_add_u32 m0, s24, 33792
  s_nop 0
  buffer_load_dwordx4 v3, s[4:7], s20 offen lds
  v_mfma_f32_32x32x16_bf16 a[144:159], v[84:87], v[72:75], a[144:159]
  ds_read_b64_tr_b16 v[106:107], v20 offset:10240
  v_mfma_f32_32x32x16_bf16 a[192:207], v[80:83], v[76:79], a[192:207]
  ds_read_b64_tr_b16 v[108:109], v21 offset:8192
  s_add_u32 m0, s25, 32768
  s_nop 0
  buffer_load_dwordx4 v6, s[8:11], s21 offen lds
  v_mfma_f32_32x32x16_bf16 a[208:223], v[84:87], v[76:79], a[208:223]
  ds_read_b64_tr_b16 v[110:111], v21 offset:10240
  s_waitcnt vmcnt(9) lgkmcnt(0)
  s_barrier
  v_mfma_f32_32x32x16_bf16 a[0:15], v[112:115], v[96:99], a[0:15]
  ds_read_b64_tr_b16 v[64:65], v18 offset:32768
  ds_read_b64_tr_b16 v[66:67], v18 offset:34816
  v_mfma_f32_32x32x16_bf16 a[16:31], v[116:119], v[96:99], a[16:31]
  ds_read_b128 v[80:83], v12 offset:32768
  ds_read_b128 v[84:87], v12 offset:34816
  v_mfma_f32_32x32x16_bf16 a[64:79], v[112:115], v[100:103], a[64:79]
  ds_read_b64_tr_b16 v[68:69], v19 offset:32768
  s_add_u32 m0, s25, 33792
  s_nop 0
  buffer_load_dwordx4 v7, s[8:11], s21 offen lds
  v_mfma_f32_32x32x16_bf16 a[80:95], v[116:119], v[100:103], a[80:95]
  ds_read_b64_tr_b16 v[70:71], v19 offset:34816
  v_mfma_f32_32x32x16_bf16 a[128:143], v[112:115], v[104:107], a[128:143]
  ds_read_b64_tr_b16 v[72:73], v20 offset:32768
  s_add_u32 m0, s25, 34816
  s_nop 0
  buffer_load_dwordx4 v8, s[8:11], s21 offen lds
  v_mfma_f32_32x32x16_bf16 a[144:159], v[116:119], v[104:107], a[144:159]
  ds_read_b64_tr_b16 v[74:75], v20 offset:34816
  v_mfma_f32_32x32x16_bf16 a[192:207], v[112:115], v[108:111], a[192:207]
  ds_read_b64_tr_b16 v[76:77], v21 offset:32768
  s_add_u32 m0, s25, 35840
  s_nop 0
  buffer_load_dwordx4 v9, s[8:11], s21 offen lds
  s_add_u32 s20, s20, 64
  s_add_u32 s21, s21, s23
  v_mfma_f32_32x32x16_bf16 a[208:223], v[116:119], v[108:111], a[208:223]
  ds_read_b64_tr_b16 v[78:79], v21 offset:34816
  s_waitcnt lgkmcnt(0)
  v_mfma_f32_32x32x16_bf16 a[0:15], v[80:83], v[64:67], a[0:15]
  ds_read_b64_tr_b16 v[96:97], v18 offset:40960
  ds_read_b64_tr_b16 v[98:99], v18 offset:43008
  v_mfma_f32_32x32x16_bf16 a[16:31], v[84:87], v[64:67], a[16:31]
  ds_read_b128 v[112:115], v13 offset:32768
  ds_read_b128 v[116:119], v13 offset:34816
  v_mfma_f32_32x32x16_bf16 a[64:79], v[80:83], v[68:71], a[64:79]
  ds_read_b64_tr_b16 v[100:101], v19 offset:40960
  s_add_u32 m0, s24, 65536
  s_nop 0
  buffer_load_dwordx4 v2, s[4:7], s20 offen lds
  v_mfma_f32_32x32x16_bf16 a[80:95], v[84:87], v[68:71], a[80:95]
  ds_read_b64_tr_b16 v[102:103], v19 offset:43008
  v_mfma_f32_32x32x16_bf16 a[128:143], v[80:83], v[72:75], a[128:143]
  ds_read_b64_tr_b16 v[104:105], v20 offset:40960
  s_add_u32 m0, s24, 66560
  s_nop 0
  buffer_load_dwordx4 v3, s[4:7], s20 offen lds
  v_mfma_f32_32x32x16_bf16 a[144:159], v[84:87], v[72:75], a[144:159]
  ds_read_b64_tr_b16 v[106:107], v20 offset:43008
  v_mfma_f32_32x32x16_bf16 a[192:207], v[80:83], v[76:79], a[192:207]
  ds_read_b64_tr_b16 v[108:109], v21 offset:40960
  s_add_u32 m0, s25, 65536
  s_nop 0
  buffer_load_dwordx4 v6, s[8:11], s21 offen lds
  v_mfma_f32_32x32x16_bf16 a[208:223], v[84:87], v[76:79], a[208:223]
  ds_read_b64_tr_b16 v[110:111], v21 offset:43008
  s_waitcnt vmcnt(9) lgkmcnt(0)
  s_barrier
  v_mfma_f32_32x32x16_bf16 a[0:15], v[112:115], v[96:99], a[0:15]
  ds_read_b64_tr_b16 v[64:65], v14 offset:0
  ds_read_b64_tr_b16 v[66:67], v14 offset:2048
  v_mfma_f32_32x32x16_bf16 a[16:31], v[116:119], v[96:99], a[16:31]
  ds_read_b128 v[80:83], v10 offset:0
  ds_read_b128 v[84:87], v10 offset:2048
  v_mfma_f32_32x32x16_bf16 a[64:79], v[112:115], v[100:103], a[64:79]
  ds_read_b64_tr_b16 v[68:69], v15 offset:0
  s_add_u32 m0, s25, 66560
  s_nop 0
  buffer_load_dwordx4 v7, s[8:11], s21 offen lds
  v_mfma_f32_32x32x16_bf16 a[80:95], v[116:119], v[100:103], a[80:95]
  ds_read_b64_tr_b16 v[70:71], v15 offset:2048
  v_mfma_f32_32x32x16_bf16 a[128:143], v[112:115], v[104:107], a[128:143]
  ds_read_b64_tr_b16 v[72:73], v16 offset:0
  s_add_u32 m0, s25, 67584
  s_nop 0
  buffer_load_dwordx4 v8, s[8:11], s21 offen lds
  v_mfma_f32_32x32x16_bf16 a[144:159], v[116:119], v[104:107], a[144:159]
  ds_read_b64_tr_b16 v[74:75], v16 offset:2048
  v_mfma_f32_32x32x16_bf16 a[192:207], v[112:115], v[108:111], a[192:207]
  ds_read_b64_tr_b16 v[76:77], v17 offset:0
  s_add_u32 m0, s25, 68608
  s_nop 0
  buffer_load_dwordx4 v9, s[8:11], s21 offen lds
  s_add_u32 s20, s20, 64
  s_add_u32 s21, s21, s23
  v_mfma_f32_32x32x16_bf16 a[208:223], v[116:119], v[108:111], a[208:223]
  ds_read_b64_tr_b16 v[78:79], v17 offset:2048
  s_waitcnt lgkmcnt(0)
  v_mfma_f32_32x32x16_bf16 a[0:15], v[80:83], v[64:67], a[0:15]
  ds_read_b64_tr_b16 v[96:97], v14 offset:8192
  ds_read_b64_tr_b16 v[98:99], v14 offset:10240
  v_mfma_f32_32x32x16_bf16 a[16:31], v[84:87], v[64:67], a[16:31]
  ds_read_b128 v[112:115], v11 offset:0
  ds_read_b128 v[116:119], v11 offset:2048
  v_mfma_f32_32x32x16_bf16 a[64:79], v[80:83], v[68:71], a[64:79]
  ds_read_b64_tr_b16 v[100:101], v15 offset:8192
  s_add_u32 m0, s24, 98304
  s_nop 0
  buffer_load_dwordx4 v2, s[4:7], s20 offen lds
  v_mfma_f32_32x32x16_bf16 a[80:95], v[84:87], v[68:71], a[80:95]
  ds_read_b64_tr_b16 v[102:103], v15 offset:10240
  v_mfma_f32_32x32x16_bf16 a[128:143], v[80:83], v[72:75], a[128:143]
  ds_read_b64_tr_b16 v[104:105], v16 offset:8192
  s_add_u32 m0, s24, 99328
  s_nop 0
  buffer_load_dwordx4 v3, s[4:7], s20 offen lds
  v_mfma_f32_32x32x16_bf16 a[144:159], v[84:87], v[72:75], a[144:159]
  ds_read_b64_tr_b16 v[106:107], v16 offset:10240
  v_mfma_f32_32x32x16_bf16 a[192:207], v[80:83], v[76:79], a[192:207]
  ds_read_b64_tr_b16 v[108:109], v17 offset:8192
  s_add_u32 m0, s25, 98304
  s_nop 0
  buffer_load_dwordx4 v6, s[8:11], s21 offen lds
  v_mfma_f32_32x32x16_bf16 a[208:223], v[84:87], v[76:79], a[208:223]
  ds_read_b64_tr_b16 v[110:111], v17 offset:10240
  s_waitcnt vmcnt(9) lgkmcnt(0)
  s_barrier
  v_mfma_f32_32x32x16_bf16 a[0:15], v[112:115], v[96:99], a[0:15]
  ds_read_b64_tr_b16 v[64:65], v14 offset:32768
  ds_read_b64_tr_b16 v[66:67], v14 offset:34816
  v_mfma_f32_32x32x16_bf16 a[16:31], v[116:119], v[96:99], a[16:31]
  ds_read_b128 v[80:83], v10 offset:32768
  ds_read_b128 v[84:87], v10 offset:34816
  v_mfma_f32_32x32x16_bf16 a[64:79], v[112:115], v[100:103], a[64:79]
  ds_read_b64_tr_b16 v[68:69], v15 offset:32768
  s_add_u32 m0, s25, 99328
  s_nop 0
  buffer_load_dwordx4 v7, s[8:11], s21 offen lds
  v_mfma_f32_32x32x16_bf16 a[80:95], v[116:119], v[100:103], a[80:95]
  ds_read_b64_tr_b16 v[70:71], v15 offset:34816
  v_mfma_f32_32x32x16_bf16 a[128:143], v[112:115], v[104:107], a[128:143]
  ds_read_b64_tr_b16 v[72:73], v16 offset:32768
  s_add_u32 m0, s25, 100352
  s_nop 0
  buffer_load_dwordx4 v8, s[8:11], s21 offen lds
  v_mfma_f32_32x32x16_bf16 a[144:159], v[116:119], v[104:107], a[144:159]
  ds_read_b64_tr_b16 v[74:75], v16 offset:34816
  v_mfma_f32_32x32x16_bf16 a[192:207], v[112:115], v[108:111], a[192:207]
  ds_read_b64_tr_b16 v[76:77], v17 offset:32768
  s_add_u32 m0, s25, 101376
  s_nop 0
  buffer_load_dwordx4 v9, s[8:11], s21 offen lds
  s_add_u32 s20, s20, 64
  s_add_u32 s21, s21, s23
  v_mfma_f32_32x32x16_bf16 a[208:223], v[116:119], v[108:111], a[208:223]
  ds_read_b64_tr_b16 v[78:79], v17 offset:34816
  s_waitcnt lgkmcnt(0)
  v_mfma_f32_32x32x16_bf16 a[0:15], v[80:83], v[64:67], a[0:15]
  ds_read_b64_tr_b16 v[96:97], v14 offset:40960
  ds_read_b64_tr_b16 v[98:99], v14 offset:43008
  v_mfma_f32_32x32x16_bf16 a[16:31], v[84:87], v[64:67], a[16:31]
  ds_read_b128 v[112:115], v11 offset:32768
  ds_read_b128 v[116:119], v11 offset:34816
  v_mfma_f32_32x32x16_bf16 a[64:79], v[80:83], v[68:71], a[64:79]
  ds_read_b64_tr_b16 v[100:101], v15 offset:40960
  s_add_u32 m0, s24, 0
  s_nop 0
  buffer_load_dwordx4 v2, s[4:7], s20 offen lds
  v_mfma_f32_32x32x16_bf16 a[80:95], v[84:87], v[68:71], a[80:95]
  ds_read_b64_tr_b16 v[102:103], v15 offset:43008
  v_mfma_f32_32x32x16_bf16 a[128:143], v[80:83], v[72:75], a[128:143]
  ds_read_b64_tr_b16 v[104:105], v16 offset:40960
  s_add_u32 m0, s24, 1024
  s_nop 0
  buffer_load_dwordx4 v3, s[4:7], s20 offen lds
  v_mfma_f32_32x32x16_bf16 a[144:159], v[84:87], v[72:75], a[144:159]
  ds_read_b64_tr_b16 v[106:107], v16 offset:43008
  v_mfma_f32_32x32x16_bf16 a[192:207], v[80:83], v[76:79], a[192:207]
  ds_read_b64_tr_b16 v[108:109], v17 offset:40960
  s_add_u32 m0, s25, 0
  s_nop 0
  buffer_load_dwordx4 v6, s[8:11], s21 offen lds
  v_mfma_f32_32x32x16_bf16 a[208:223], v[84:87], v[76:79], a[208:223]
  ds_read_b64_tr_b16 v[110:111], v17 offset:43008
  s_waitcnt vmcnt(9) lgkmcnt(0)
  s_barrier
  v_mfma_f32_32x32x16_bf16 a[0:15], v[112:115], v[96:99], a[0:15]
  ds_read_b64_tr_b16 v[64:65], v18 offset:0
  ds_read_b64_tr_b16 v[66:67], v18 offset:2048
  v_mfma_f32_32x32x16_bf16 a[16:31], v[116:119], v[96:99], a[16:31]
  ds_read_b128 v[80:83], v12 offset:0
  ds_read_b128 v[84:87], v12 offset:2048
  v_mfma_f32_32x32x16_bf16 a[64:79], v[112:115], v[100:103], a[64:79]
  ds_read_b64_tr_b16 v[68:69], v19 offset:0
  s_add_u32 m0, s25, 1024
  s_nop 0
  buffer_load_dwordx4 v7, s[8:11], s21 offen lds
  v_mfma_f32_32x32x16_bf16 a[80:95], v[116:119], v[100:103], a[80:95]
  ds_read_b64_tr_b16 v[70:71], v19 offset:2048
  v_mfma_f32_32x32x16_bf16 a[128:143], v[112:115], v[104:107], a[128:143]
  ds_read_b64_tr_b16 v[72:73], v20 offset:0
  s_add_u32 m0, s25, 2048
  s_nop 0
  buffer_load_dwordx4 v8, s[8:11], s21 offen lds
  v_mfma_f32_32x32x16_bf16 a[144:159], v[116:119], v[104:107], a[144:159]
  ds_read_b64_tr_b16 v[74:75], v20 offset:2048
  v_mfma_f32_32x32x16_bf16 a[192:207], v[112:115], v[108:111], a[192:207]
  ds_read_b64_tr_b16 v[76:77], v21 offset:0
  s_add_u32 m0, s25, 3072
  s_nop 0
  buffer_load_dwordx4 v9, s[8:11], s21 offen lds
  s_add_u32 s20, s20, 64
  s_add_u32 s21, s21, s23
  v_mfma_f32_32x32x16_bf16 a[208:223], v[116:119], v[108:111], a[208:223]
  ds_read_b64_tr_b16 v[78:79], v21 offset:2048
  s_waitcnt lgkmcnt(0)
  v_mfma_f32_32x32x16_bf16 a[0:15], v[80:83], v[64:67], a[0:15]
  ds_read_b64_tr_b16 v[96:97], v18 offset:8192
  ds_read_b64_tr_b16 v[98:99], v18 offset:10240
  v_mfma_f32_32x32x16_bf16 a[16:31], v[84:87], v[64:67], a[16:31]
  ds_read_b128 v[112:115], v13 offset:0
  ds_read_b128 v[116:119], v13 offset:2048
  v_mfma_f32_32x32x16_bf16 a[64:79], v[80:83], v[68:71], a[64:79]
  ds_read_b64_tr_b16 v[100:101], v19 offset:8192
  s_add_u32 m0, s24, 32768
  s_nop 0
  buffer_load_dwordx4 v2, s[4:7], s20 offen lds
  v_mfma_f32_32x32x16_bf16 a[80:95], v[84:87], v[68:71], a[80:95]
  ds_read_b64_tr_b16 v[102:103], v19 offset:10240
  v_mfma_f32_32x32x16_bf16 a[128:143], v[80:83], v[72:75], a[128:143]
  ds_read_b64_tr_b16 v[104:105], v20 offset:8192
  s_add_u32 m0, s24, 33792
  s_nop 0
  buffer_load_dwordx4 v3, s[4:7], s20 offen lds
  v_mfma_f32_32x32x16_bf16 a[144:159], v[84:87], v[72:75], a[144:159]
  ds_read_b64_tr_b16 v[106:107], v20 offset:10240
  v_mfma_f32_32x32x16_bf16 a[192:207], v[80:83], v[76:79], a[192:207]
  ds_read_b64_tr_b16 v[108:109], v21 offset:8192
  s_add_u32 m0, s25, 32768
  s_nop 0
  buffer_load_dwordx4 v6, s[8:11], s21 offen lds
  v_mfma_f32_32x32x16_bf16 a[208:223], v[84:87], v[76:79], a[208:223]
  ds_read_b64_tr_b16 v[110:111], v21 offset:10240
  s_waitcnt vmcnt(9) lgkmcnt(0)
  s_barrier
  v_mfma_f32_32x32x16_bf16 a[0:15], v[112:115], v[96:99], a[0:15]
  ds_read_b64_tr_b16 v[64:65], v18 offset:32768
  ds_read_b64_tr_b16 v[66:67], v18 offset:34816
  v_mfma_f32_32x32x16_bf16 a[16:31], v[116:119], v[96:99], a[16:31]
  ds_read_b128 v[80:83], v12 offset:32768
  ds_read_b128 v[84:87], v12 offset:34816
  v_mfma_f32_32x32x16_bf16 a[64:79], v[112:115], v[100:103], a[64:79]
  ds_read_b64_tr_b16 v[68:69], v19 offset:32768
  s_add_u32 m0, s25, 33792
  s_nop 0
  buffer_load_dwordx4 v7, s[8:11], s21 offen lds
  v_mfma_f32_32x32x16_bf16 a[80:95], v[116:119], v[100:103], a[80:95]
  ds_read_b64_tr_b16 v[70:71], v19 offset:34816
  v_mfma_f32_32x32x16_bf16 a[128:143], v[112:115], v[104:107], a[128:143]
  ds_read_b64_tr_b16 v[72:73], v20 offset:32768
  s_add_u32 m0, s25, 34816
  s_nop 0
  buffer_load_dwordx4 v8, s[8:11], s21 offen lds
  v_mfma_f32_32x32x16_bf16 a[144:159], v[116:119], v[104:107], a[144:159]
  ds_read_b64_tr_b16 v[74:75], v20 offset:34816
  v_mfma_f32_32x32x16_bf16 a[192:207], v[112:115], v[108:111], a[192:207]
  ds_read_b64_tr_b16 v[76:77], v21 offset:32768
  s_add_u32 m0, s25, 35840
  s_nop 0
  buffer_load_dwordx4 v9, s[8:11], s21 offen lds
  s_add_u32 s20, s20, 64
  s_add_u32 s21, s21, s23
  v_mfma_f32_32x32x16_bf16 a[208:223], v[116:119], v[108:111], a[208:223]
  ds_read_b64_tr_b16 v[78:79], v21 offset:34816
  s_waitcnt lgkmcnt(0)
  v_mfma_f32_32x32x16_bf16 a[0:15], v[80:83], v[64:67], a[0:15]
  ds_read_b64_tr_b16 v[96:97], v18 offset:40960
  ds_read_b64_tr_b16 v[98:99], v18 offset:43008
  v_mfma_f32_32x32x16_bf16 a[16:31], v[84:87], v[64:67], a[16:31]
  ds_read_b128 v[112:115], v13 offset:32768
  ds_read_b128 v[116:119], v13 offset:34816
  v_mfma_f32_32x32x16_bf16 a[64:79], v[80:83], v[68:71], a[64:79]
  ds_read_b64_tr_b16 v[100:101], v19 offset:40960
  s_add_u32 m0, s24, 65536
  s_nop 0
  buffer_load_dwordx4 v2, s[4:7], s20 offen lds
  v_mfma_f32_32x32x16_bf16 a[80:95], v[84:87], v[68:71], a[80:95]
  ds_read_b64_tr_b16 v[102:103], v19 offset:43008
  v_mfma_f32_32x32x16_bf16 a[128:143], v[80:83], v[72:75], a[128:143]
  ds_read_b64_tr_b16 v[104:105], v20 offset:40960
  s_add_u32 m0, s24, 66560
  s_nop 0
  buffer_load_dwordx4 v3, s[4:7], s20 offen lds
  v_mfma_f32_32x32x16_bf16 a[144:159], v[84:87], v[72:75], a[144:159]
  ds_read_b64_tr_b16 v[106:107], v20 offset:43008
  v_mfma_f32_32x32x16_bf16 a[192:207], v[80:83], v[76:79], a[192:207]
  ds_read_b64_tr_b16 v[108:109], v21 offset:40960
  s_add_u32 m0, s25, 65536
  s_nop 0
  buffer_load_dwordx4 v6, s[8:11], s21 offen lds
  v_mfma_f32_32x32x16_bf16 a[208:223], v[84:87], v[76:79], a[208:223]
  ds_read_b64_tr_b16 v[110:111], v21 offset:43008
  s_waitcnt vmcnt(9) lgkmcnt(0)
  s_barrier
  v_mfma_f32_32x32x16_bf16 a[0:15], v[112:115], v[96:99], a[0:15]
  ds_read_b64_tr_b16 v[64:65], v14 offset:0
  ds_read_b64_tr_b16 v[66:67], v14 offset:2048
  v_mfma_f32_32x32x16_bf16 a[16:31], v[116:119], v[96:99], a[16:31]
  ds_read_b128 v[80:83], v10 offset:0
  ds_read_b128 v[84:87], v10 offset:2048
  v_mfma_f32_32x32x16_bf16 a[64:79], v[112:115], v[100:103], a[64:79]
  ds_read_b64_tr_b16 v[68:69], v15 offset:0
  s_add_u32 m0, s25, 66560
  s_nop 0
  buffer_load_dwordx4 v7, s[8:11], s21 offen lds
  v_mfma_f32_32x32x16_bf16 a[80:95], v[116:119], v[100:103], a[80:95]
  ds_read_b64_tr_b16 v[70:71], v15 offset:2048
  v_mfma_f32_32x32x16_bf16 a[128:143], v[112:115], v[104:107], a[128:143]
  ds_read_b64_tr_b16 v[72:73], v16 offset:0
  s_add_u32 m0, s25, 67584
  s_nop 0
  buffer_load_dwordx4 v8, s[8:11], s21 offen lds
  v_mfma_f32_32x32x16_bf16 a[144:159], v[116:119], v[104:107], a[144:159]
  ds_read_b64_tr_b16 v[74:75], v16 offset:2048
  v_mfma_f32_32x32x16_bf16 a[192:207], v[112:115], v[108:111], a[192:207]
  ds_read_b64_tr_b16 v[76:77], v17 offset:0
  s_add_u32 m0, s25, 68608
  s_nop 0
  buffer_load_dwordx4 v9, s[8:11], s21 offen lds
  s_add_u32 s20, s20, 64
  s_add_u32 s21, s21, s23
  v_mfma_f32_32x32x16_bf16 a[208:223], v[116:119], v[108:111], a[208:223]
  ds_read_b64_tr_b16 v[78:79], v17 offset:2048
  s_waitcnt lgkmcnt(0)
  v_mfma_f32_32x32x16_bf16 a[0:15], v[80:83], v[64:67], a[0:15]
  ds_read_b64_tr_b16 v[96:97], v14 offset:8192
  ds_read_b64_tr_b16 v[98:99], v14 offset:10240
  v_mfma_f32_32x32x16_bf16 a[16:31], v[84:87], v[64:67], a[16:31]
  ds_read_b128 v[112:115], v11 offset:0
  ds_read_b128 v[116:119], v11 offset:2048
  v_mfma_f32_32x32x16_bf16 a[64:79], v[80:83], v[68:71], a[64:79]
  ds_read_b64_tr_b16 v[100:101], v15 offset:8192
  s_add_u32 m0, s24, 98304
  s_nop 0
  buffer_load_dwordx4 v2, s[4:7], s20 offen lds
  v_mfma_f32_32x32x16_bf16 a[80:95], v[84:87], v[68:71], a[80:95]
  ds_read_b64_tr_b16 v[102:103], v15 offset:10240
  v_mfma_f32_32x32x16_bf16 a[128:143], v[80:83], v[72:75], a[128:143]
  ds_read_b64_tr_b16 v[104:105], v16 offset:8192
  s_add_u32 m0, s24, 99328
  s_nop 0
  buffer_load_dwordx4 v3, s[4:7], s20 offen lds
  v_mfma_f32_32x32x16_bf16 a[144:159], v[84:87], v[72:75], a[144:159]
  ds_read_b64_tr_b16 v[106:107], v16 offset:10240
  v_mfma_f32_32x32x16_bf16 a[192:207], v[80:83], v[76:79], a[192:207]
  ds_read_b64_tr_b16 v[108:109], v17 offset:8192
  s_add_u32 m0, s25, 98304
  s_nop 0
  buffer_load_dwordx4 v6, s[8:11], s21 offen lds
  v_mfma_f32_32x32x16_bf16 a[208:223], v[84:87], v[76:79], a[208:223]
  ds_read_b64_tr_b16 v[110:111], v17 offset:10240
  s_waitcnt vmcnt(9) lgkmcnt(0)
  s_barrier
  v_mfma_f32_32x32x16_bf16 a[0:15], v[112:115], v[96:99], a[0:15]
  ds_read_b64_tr_b16 v[64:65], v14 offset:32768
  ds_read_b64_tr_b16 v[66:67], v14 offset:34816
  v_mfma_f32_32x32x16_bf16 a[16:31], v[116:119], v[96:99], a[16:31]
  ds_read_b128 v[80:83], v10 offset:32768
  ds_read_b128 v[84:87], v10 offset:34816
  v_mfma_f32_32x32x16_bf16 a[64:79], v[112:115], v[100:103], a[64:79]
  ds_read_b64_tr_b16 v[68:69], v15 offset:32768
  s_add_u32 m0, s25, 99328
  s_nop 0
  buffer_load_dwordx4 v7, s[8:11], s21 offen lds
  v_mfma_f32_32x32x16_bf16 a[80:95], v[116:119], v[100:103], a[80:95]
  ds_read_b64_tr_b16 v[70:71], v15 offset:34816
  v_mfma_f32_32x32x16_bf16 a[128:143], v[112:115], v[104:107], a[128:143]
  ds_read_b64_tr_b16 v[72:73], v16 offset:32768
  s_add_u32 m0, s25, 100352
  s_nop 0
  buffer_load_dwordx4 v8, s[8:11], s21 offen lds
  v_mfma_f32_32x32x16_bf16 a[144:159], v[116:119], v[104:107], a[144:159]
  ds_read_b64_tr_b16 v[74:75], v16 offset:34816
  v_mfma_f32_32x32x16_bf16 a[192:207], v[112:115], v[108:111], a[192:207]
  ds_read_b64_tr_b16 v[76:77], v17 offset:32768
  s_add_u32 m0, s25, 101376
  s_nop 0
  buffer_load_dwordx4 v9, s[8:11], s21 offen lds
  s_add_u32 s20, s20, 64
  s_add_u32 s21, s21, s23
  v_mfma_f32_32x32x16_bf16 a[208:223], v[116:119], v[108:111], a[208:223]
  ds_read_b64_tr_b16 v[78:79], v17 offset:34816
  s_waitcnt lgkmcnt(0)
  v_mfma_f32_32x32x16_bf16 a[0:15], v[80:83], v[64:67], a[0:15]
  ds_read_b64_tr_b16 v[96:97], v14 offset:40960
  ds_read_b64_tr_b16 v[98:99], v14 offset:43008
  v_mfma_f32_32x32x16_bf16 a[16:31], v[84:87], v[64:67], a[16:31]
  ds_read_b128 v[112:115], v11 offset:32768
  ds_read_b128 v[116:119], v11 offset:34816
  v_mfma_f32_32x32x16_bf16 a[64:79], v[80:83], v[68:71], a[64:79]
  ds_read_b64_tr_b16 v[100:101], v15 offset:40960
  s_add_u32 m0, s24, 0
  s_nop 0
  buffer_load_dwordx4 v2, s[4:7], s20 offen lds
  v_mfma_f32_32x32x16_bf16 a[80:95], v[84:87], v[68:71], a[80:95]
  ds_read_b64_tr_b16 v[102:103], v15 offset:43008
  v_mfma_f32_32x32x16_bf16 a[128:143], v[80:83], v[72:75], a[128:143]
  ds_read_b64_tr_b16 v[104:105], v16 offset:40960
  s_add_u32 m0, s24, 1024
  s_nop 0
  buffer_load_dwordx4 v3, s[4:7], s20 offen lds
  v_mfma_f32_32x32x16_bf16 a[144:159], v[84:87], v[72:75], a[144:159]
  ds_read_b64_tr_b16 v[106:107], v16 offset:43008
  v_mfma_f32_32x32x16_bf16 a[192:207], v[80:83], v[76:79], a[192:207]
  ds_read_b64_tr_b16 v[108:109], v17 offset:40960
  s_add_u32 m0, s25, 0
  s_nop 0
  buffer_load_dwordx4 v6, s[8:11], s21 offen lds
  v_mfma_f32_32x32x16_bf16 a[208:223], v[84:87], v[76:79], a[208:223]
  ds_read_b64_tr_b16 v[110:111], v17 offset:43008
  s_waitcnt vmcnt(9) lgkmcnt(0)
  s_barrier
  v_mfma_f32_32x32x16_bf16 a[0:15], v[112:115], v[96:99], a[0:15]
  ds_read_b64_tr_b16 v[64:65], v18 offset:0
  ds_read_b64_tr_b16 v[66:67], v18 offset:2048
  v_mfma_f32_32x32x16_bf16 a[16:31], v[116:119], v[96:99], a[16:31]
  ds_read_b128 v[80:83], v12 offset:0
  ds_read_b128 v[84:87], v12 offset:2048
  v_mfma_f32_32x32x16_bf16 a[64:79], v[112:115], v[100:103], a[64:79]
  ds_read_b64_tr_b16 v[68:69], v19 offset:0
  s_add_u32 m0, s25, 1024
  s_nop 0
  buffer_load_dwordx4 v7, s[8:11], s21 offen lds
  v_mfma_f32_32x32x16_bf16 a[80:95], v[116:119], v[100:103], a[80:95]
  ds_read_b64_tr_b16 v[70:71], v19 offset:2048
  v_mfma_f32_32x32x16_bf16 a[128:143], v[112:115], v[104:107], a[128:143]
  ds_read_b64_tr_b16 v[72:73], v20 offset:0
  s_add_u32 m0, s25, 2048
  s_nop 0
  buffer_load_dwordx4 v8, s[8:11], s21 offen lds
  v_mfma_f32_32x32x16_bf16 a[144:159], v[116:119], v[104:107], a[144:159]
  ds_read_b64_tr_b16 v[74:75], v20 offset:2048
  v_mfma_f32_32x32x16_bf16 a[192:207], v[112:115], v[108:111], a[192:207]
  ds_read_b64_tr_b16 v[76:77], v21 offset:0
  s_add_u32 m0, s25, 3072
  s_nop 0
  buffer_load_dwordx4 v9, s[8:11], s21 offen lds
  s_add_u32 s20, s20, 64
  s_add_u32 s21, s21, s23
  v_mfma_f32_32x32x16_bf16 a[208:223], v[116:119], v[108:111], a[208:223]
  ds_read_b64_tr_b16 v[78:79], v21 offset:2048
  s_waitcnt lgkmcnt(0)
  v_mfma_f32_32x32x16_bf16 a[0:15], v[80:83], v[64:67], a[0:15]
  ds_read_b64_tr_b16 v[96:97], v18 offset:8192
  ds_read_b64_tr_b16 v[98:99], v18 offset:10240
  v_mfma_f32_32x32x16_bf16 a[16:31], v[84:87], v[64:67], a[16:31]
  ds_read_b128 v[112:115], v13 offset:0
  ds_read_b128 v[116:119], v13 offset:2048
  v_mfma_f32_32x32x16_bf16 a[64:79], v[80:83], v[68:71], a[64:79]
  ds_read_b64_tr_b16 v[100:101], v19 offset:8192
  s_add_u32 m0, s24, 32768
  s_nop 0
  buffer_load_dwordx4 v2, s[4:7], s20 offen lds
  v_mfma_f32_32x32x16_bf16 a[80:95], v[84:87], v[68:71], a[80:95]
  ds_read_b64_tr_b16 v[102:103], v19 offset:10240
  v_mfma_f32_32x32x16_bf16 a[128:143], v[80:83], v[72:75], a[128:143]
  ds_read_b64_tr_b16 v[104:105], v20 offset:8192
  s_add_u32 m0, s24, 33792
  s_nop 0
  buffer_load_dwordx4 v3, s[4:7], s20 offen lds
  v_mfma_f32_32x32x16_bf16 a[144:159], v[84:87], v[72:75], a[144:159]
  ds_read_b64_tr_b16 v[106:107], v20 offset:10240
  v_mfma_f32_32x32x16_bf16 a[192:207], v[80:83], v[76:79], a[192:207]
  ds_read_b64_tr_b16 v[108:109], v21 offset:8192
  s_add_u32 m0, s25, 32768
  s_nop 0
  buffer_load_dwordx4 v6, s[8:11], s21 offen lds
  v_mfma_f32_32x32x16_bf16 a[208:223], v[84:87], v[76:79], a[208:223]
  ds_read_b64_tr_b16 v[110:111], v21 offset:10240
  s_waitcnt vmcnt(9) lgkmcnt(0)
  s_barrier
  v_mfma_f32_32x32x16_bf16 a[0:15], v[112:115], v[96:99], a[0:15]
  ds_read_b64_tr_b16 v[64:65], v18 offset:32768
  ds_read_b64_tr_b16 v[66:67], v18 offset:34816
  v_mfma_f32_32x32x16_bf16 a[16:31], v[116:119], v[96:99], a[16:31]
  ds_read_b128 v[80:83], v12 offset:32768
  ds_read_b128 v[84:87], v12 offset:34816
  v_mfma_f32_32x32x16_bf16 a[64:79], v[112:115], v[100:103], a[64:79]
  ds_read_b64_tr_b16 v[68:69], v19 offset:32768
  s_add_u32 m0, s25, 33792
  s_nop 0
  buffer_load_dwordx4 v7, s[8:11], s21 offen lds
  v_mfma_f32_32x32x16_bf16 a[80:95], v[116:119], v[100:103], a[80:95]
  ds_read_b64_tr_b16 v[70:71], v19 offset:34816
  v_mfma_f32_32x32x16_bf16 a[128:143], v[112:115], v[104:107], a[128:143]
  ds_read_b64_tr_b16 v[72:73], v20 offset:32768
  s_add_u32 m0, s25, 34816
  s_nop 0
  buffer_load_dwordx4 v8, s[8:11], s21 offen lds
  v_mfma_f32_32x32x16_bf16 a[144:159], v[116:119], v[104:107], a[144:159]
  ds_read_b64_tr_b16 v[74:75], v20 offset:34816
  v_mfma_f32_32x32x16_bf16 a[192:207], v[112:115], v[108:111], a[192:207]
  ds_read_b64_tr_b16 v[76:77], v21 offset:32768
  s_add_u32 m0, s25, 35840
  s_nop 0
  buffer_load_dwordx4 v9, s[8:11], s21 offen lds
  s_add_u32 s20, s20, 64
  s_add_u32 s21, s21, s23
  v_mfma_f32_32x32x16_bf16 a[208:223], v[116:119], v[108:111], a[208:223]
  ds_read_b64_tr_b16 v[78:79], v21 offset:34816
  s_waitcnt lgkmcnt(0)
  v_mfma_f32_32x32x16_bf16 a[0:15], v[80:83], v[64:67], a[0:15]
  ds_read_b64_tr_b16 v[96:97], v18 offset:40960
  ds_read_b64_tr_b16 v[98:99], v18 offset:43008
  v_mfma_f32_32x32x16_bf16 a[16:31], v[84:87], v[64:67], a[16:31]
  ds_read_b128 v[112:115], v13 offset:32768
  ds_read_b128 v[116:119], v13 offset:34816
  v_mfma_f32_32x32x16_bf16 a[64:79], v[80:83], v[68:71], a[64:79]
  ds_read_b64_tr_b16 v[100:101], v19 offset:40960
  s_add_u32 m0, s24, 65536
  s_nop 0
  buffer_load_dwordx4 v2, s[4:7], s20 offen lds
  v_mfma_f32_32x32x16_bf16 a[80:95], v[84:87], v[68:71], a[80:95]
  ds_read_b64_tr_b16 v[102:103], v19 offset:43008
  v_mfma_f32_32x32x16_bf16 a[128:143], v[80:83], v[72:75], a[128:143]
  ds_read_b64_tr_b16 v[104:105], v20 offset:40960
  s_add_u32 m0, s24, 66560
  s_nop 0
  buffer_load_dwordx4 v3, s[4:7], s20 offen lds
  v_mfma_f32_32x32x16_bf16 a[144:159], v[84:87], v[72:75], a[144:159]
  ds_read_b64_tr_b16 v[106:107], v20 offset:43008
  v_mfma_f32_32x32x16_bf16 a[192:207], v[80:83], v[76:79], a[192:207]
  ds_read_b64_tr_b16 v[108:109], v21 offset:40960
  s_add_u32 m0, s25, 65536
  s_nop 0
  buffer_load_dwordx4 v6, s[8:11], s21 offen lds
  v_mfma_f32_32x32x16_bf16 a[208:223], v[84:87], v[76:79], a[208:223]
  ds_read_b64_tr_b16 v[110:111], v21 offset:43008
  s_waitcnt vmcnt(9) lgkmcnt(0)
  s_barrier
  v_mfma_f32_32x32x16_bf16 a[0:15], v[112:115], v[96:99], a[0:15]
  ds_read_b64_tr_b16 v[64:65], v14 offset:0
  ds_read_b64_tr_b16 v[66:67], v14 offset:2048
  v_mfma_f32_32x32x16_bf16 a[16:31], v[116:119], v[96:99], a[16:31]
  ds_read_b128 v[80:83], v10 offset:0
  ds_read_b128 v[84:87], v10 offset:2048
  v_mfma_f32_32x32x16_bf16 a[64:79], v[112:115], v[100:103], a[64:79]
  ds_read_b64_tr_b16 v[68:69], v15 offset:0
  s_add_u32 m0, s25, 66560
  s_nop 0
  buffer_load_dwordx4 v7, s[8:11], s21 offen lds
  v_mfma_f32_32x32x16_bf16 a[80:95], v[116:119], v[100:103], a[80:95]
  ds_read_b64_tr_b16 v[70:71], v15 offset:2048
  v_mfma_f32_32x32x16_bf16 a[128:143], v[112:115], v[104:107], a[128:143]
  ds_read_b64_tr_b16 v[72:73], v16 offset:0
  s_add_u32 m0, s25, 67584
  s_nop 0
  buffer_load_dwordx4 v8, s[8:11], s21 offen lds
  v_mfma_f32_32x32x16_bf16 a[144:159], v[116:119], v[104:107], a[144:159]
  ds_read_b64_tr_b16 v[74:75], v16 offset:2048
  v_mfma_f32_32x32x16_bf16 a[192:207], v[112:115], v[108:111], a[192:207]
  ds_read_b64_tr_b16 v[76:77], v17 offset:0
  s_add_u32 m0, s25, 68608
  s_nop 0
  buffer_load_dwordx4 v9, s[8:11], s21 offen lds
  s_add_u32 s20, s20, 64
  s_add_u32 s21, s21, s23
  v_mfma_f32_32x32x16_bf16 a[208:223], v[116:119], v[108:111], a[208:223]
  ds_read_b64_tr_b16 v[78:79], v17 offset:2048
  s_waitcnt lgkmcnt(0)
  v_mfma_f32_32x32x16_bf16 a[0:15], v[80:83], v[64:67], a[0:15]
  ds_read_b64_tr_b16 v[96:97], v14 offset:8192
  ds_read_b64_tr_b16 v[98:99], v14 offset:10240
  v_mfma_f32_32x32x16_bf16 a[16:31], v[84:87], v[64:67], a[16:31]
  ds_read_b128 v[112:115], v11 offset:0
  ds_read_b128 v[116:119], v11 offset:2048
  v_mfma_f32_32x32x16_bf16 a[64:79], v[80:83], v[68:71], a[64:79]
  ds_read_b64_tr_b16 v[100:101], v15 offset:8192
  s_add_u32 m0, s24, 98304
  s_nop 0
  buffer_load_dwordx4 v2, s[4:7], s20 offen lds
  v_mfma_f32_32x32x16_bf16 a[80:95], v[84:87], v[68:71], a[80:95]
  ds_read_b64_tr_b16 v[102:103], v15 offset:10240
  v_mfma_f32_32x32x16_bf16 a[128:143], v[80:83], v[72:75], a[128:143]
  ds_read_b64_tr_b16 v[104:105], v16 offset:8192
  s_add_u32 m0, s24, 99328
  s_nop 0
  buffer_load_dwordx4 v3, s[4:7], s20 offen lds
  v_mfma_f32_32x32x16_bf16 a[144:159], v[84:87], v[72:75], a[144:159]
  ds_read_b64_tr_b16 v[106:107], v16 offset:10240
  v_mfma_f32_32x32x16_bf16 a[192:207], v[80:83], v[76:79], a[192:207]
  ds_read_b64_tr_b16 v[108:109], v17 offset:8192
  s_add_u32 m0, s25, 98304
  s_nop 0
  buffer_load_dwordx4 v6, s[8:11], s21 offen lds
  v_mfma_f32_32x32x16_bf16 a[208:223], v[84:87], v[76:79], a[208:223]
  ds_read_b64_tr_b16 v[110:111], v17 offset:10240
  s_waitcnt vmcnt(9) lgkmcnt(0)
  s_barrier
  v_mfma_f32_32x32x16_bf16 a[0:15], v[112:115], v[96:99], a[0:15]
  ds_read_b64_tr_b16 v[64:65], v14 offset:32768
  ds_read_b64_tr_b16 v[66:67], v14 offset:34816
  v_mfma_f32_32x32x16_bf16 a[16:31], v[116:119], v[96:99], a[16:31]
  ds_read_b128 v[80:83], v10 offset:32768
  ds_read_b128 v[84:87], v10 offset:34816
  v_mfma_f32_32x32x16_bf16 a[64:79], v[112:115], v[100:103], a[64:79]
  ds_read_b64_tr_b16 v[68:69], v15 offset:32768
  s_add_u32 m0, s25, 99328
  s_nop 0
  buffer_load_dwordx4 v7, s[8:11], s21 offen lds
  v_mfma_f32_32x32x16_bf16 a[80:95], v[116:119], v[100:103], a[80:95]
  ds_read_b64_tr_b16 v[70:71], v15 offset:34816
  v_mfma_f32_32x32x16_bf16 a[128:143], v[112:115], v[104:107], a[128:143]
  ds_read_b64_tr_b16 v[72:73], v16 offset:32768
  s_add_u32 m0, s25, 100352
  s_nop 0
  buffer_load_dwordx4 v8, s[8:11], s21 offen lds
  v_mfma_f32_32x32x16_bf16 a[144:159], v[116:119], v[104:107], a[144:159]
  ds_read_b64_tr_b16 v[74:75], v16 offset:34816
  v_mfma_f32_32x32x16_bf16 a[192:207], v[112:115], v[108:111], a[192:207]
  ds_read_b64_tr_b16 v[76:77], v17 offset:32768
  s_add_u32 m0, s25, 101376
  s_nop 0
  buffer_load_dwordx4 v9, s[8:11], s21 offen lds
  s_add_u32 s20, s20, 64
  s_add_u32 s21, s21, s23
  v_mfma_f32_32x32x16_bf16 a[208:223], v[116:119], v[108:111], a[208:223]
  ds_read_b64_tr_b16 v[78:79], v17 offset:34816
  s_waitcnt lgkmcnt(0)
  v_mfma_f32_32x32x16_bf16 a[0:15], v[80:83], v[64:67], a[0:15]
  ds_read_b64_tr_b16 v[96:97], v14 offset:40960
  ds_read_b64_tr_b16 v[98:99], v14 offset:43008
  v_mfma_f32_32x32x16_bf16 a[16:31], v[84:87], v[64:67], a[16:31]
  ds_read_b128 v[112:115], v11 offset:32768
  ds_read_b128 v[116:119], v11 offset:34816
  v_mfma_f32_32x32x16_bf16 a[64:79], v[80:83], v[68:71], a[64:79]
  ds_read_b64_tr_b16 v[100:101], v15 offset:40960
  v_mfma_f32_32x32x16_bf16 a[80:95], v[84:87], v[68:71], a[80:95]
  ds_read_b64_tr_b16 v[102:103], v15 offset:43008
  v_mfma_f32_32x32x16_bf16 a[128:143], v[80:83], v[72:75], a[128:143]
  ds_read_b64_tr_b16 v[104:105], v16 offset:40960
  v_mfma_f32_32x32x16_bf16 a[144:159], v[84:87], v[72:75], a[144:159]
  ds_read_b64_tr_b16 v[106:107], v16 offset:43008
  v_mfma_f32_32x32x16_bf16 a[192:207], v[80:83], v[76:79], a[192:207]
  ds_read_b64_tr_b16 v[108:109], v17 offset:40960
  v_mfma_f32_32x32x16_bf16 a[208:223], v[84:87], v[76:79], a[208:223]
  ds_read_b64_tr_b16 v[110:111], v17 offset:43008
  s_waitcnt vmcnt(6) lgkmcnt(0)
  s_barrier
  v_mfma_f32_32x32x16_bf16 a[0:15], v[112:115], v[96:99], a[0:15]
  ds_read_b64_tr_b16 v[64:65], v18 offset:0
  ds_read_b64_tr_b16 v[66:67], v18 offset:2048
  v_mfma_f32_32x32x16_bf16 a[16:31], v[116:119], v[96:99], a[16:31]
  ds_read_b128 v[80:83], v12 offset:0
  ds_read_b128 v[84:87], v12 offset:2048
  v_mfma_f32_32x32x16_bf16 a[64:79], v[112:115], v[100:103], a[64:79]
  ds_read_b64_tr_b16 v[68:69], v19 offset:0
  v_mfma_f32_32x32x16_bf16 a[80:95], v[116:119], v[100:103], a[80:95]
  ds_read_b64_tr_b16 v[70:71], v19 offset:2048
  v_mfma_f32_32x32x16_bf16 a[128:143], v[112:115], v[104:107], a[128:143]
  ds_read_b64_tr_b16 v[72:73], v20 offset:0
  v_mfma_f32_32x32x16_bf16 a[144:159], v[116:119], v[104:107], a[144:159]
  ds_read_b64_tr_b16 v[74:75], v20 offset:2048
  v_mfma_f32_32x32x16_bf16 a[192:207], v[112:115], v[108:111], a[192:207]
  ds_read_b64_tr_b16 v[76:77], v21 offset:0
  v_mfma_f32_32x32x16_bf16 a[208:223], v[116:119], v[108:111], a[208:223]
  ds_read_b64_tr_b16 v[78:79], v21 offset:2048
  s_waitcnt lgkmcnt(0)
  v_mfma_f32_32x32x16_bf16 a[0:15], v[80:83], v[64:67], a[0:15]
  ds_read_b64_tr_b16 v[96:97], v18 offset:8192
  ds_read_b64_tr_b16 v[98:99], v18 offset:10240
  v_mfma_f32_32x32x16_bf16 a[16:31], v[84:87], v[64:67], a[16:31]
  ds_read_b128 v[112:115], v13 offset:0
  ds_read_b128 v[116:119], v13 offset:2048
  v_mfma_f32_32x32x16_bf16 a[64:79], v[80:83], v[68:71], a[64:79]
  ds_read_b64_tr_b16 v[100:101], v19 offset:8192
  v_mfma_f32_32x32x16_bf16 a[80:95], v[84:87], v[68:71], a[80:95]
  ds_read_b64_tr_b16 v[102:103], v19 offset:10240
  v_mfma_f32_32x32x16_bf16 a[128:143], v[80:83], v[72:75], a[128:143]
  ds_read_b64_tr_b16 v[104:105], v20 offset:8192
  v_mfma_f32_32x32x16_bf16 a[144:159], v[84:87], v[72:75], a[144:159]
  ds_read_b64_tr_b16 v[106:107], v20 offset:10240
  v_mfma_f32_32x32x16_bf16 a[192:207], v[80:83], v[76:79], a[192:207]
  ds_read_b64_tr_b16 v[108:109], v21 offset:8192
  v_mfma_f32_32x32x16_bf16 a[208:223], v[84:87], v[76:79], a[208:223]
  ds_read_b64_tr_b16 v[110:111], v21 offset:10240
  s_waitcnt vmcnt(0) lgkmcnt(0)
  s_barrier
  v_mfma_f32_32x32x16_bf16 a[0:15], v[112:115], v[96:99], a[0:15]
  ds_read_b64_tr_b16 v[64:65], v18 offset:32768
  ds_read_b64_tr_b16 v[66:67], v18 offset:34816
  v_mfma_f32_32x32x16_bf16 a[16:31], v[116:119], v[96:99], a[16:31]
  ds_read_b128 v[80:83], v12 offset:32768
  ds_read_b128 v[84:87], v12 offset:34816
  v_mfma_f32_32x32x16_bf16 a[64:79], v[112:115], v[100:103], a[64:79]
  ds_read_b64_tr_b16 v[68:69], v19 offset:32768
  v_mfma_f32_32x32x16_bf16 a[80:95], v[116:119], v[100:103], a[80:95]
  ds_read_b64_tr_b16 v[70:71], v19 offset:34816
  v_mfma_f32_32x32x16_bf16 a[128:143], v[112:115], v[104:107], a[128:143]
  ds_read_b64_tr_b16 v[72:73], v20 offset:32768
  v_mfma_f32_32x32x16_bf16 a[144:159], v[116:119], v[104:107], a[144:159]
  ds_read_b64_tr_b16 v[74:75], v20 offset:34816
  v_mfma_f32_32x32x16_bf16 a[192:207], v[112:115], v[108:111], a[192:207]
  ds_read_b64_tr_b16 v[76:77], v21 offset:32768
  v_mfma_f32_32x32x16_bf16 a[208:223], v[116:119], v[108:111], a[208:223]
  ds_read_b64_tr_b16 v[78:79], v21 offset:34816
  s_waitcnt lgkmcnt(0)
  v_mfma_f32_32x32x16_bf16 a[0:15], v[80:83], v[64:67], a[0:15]
  ds_read_b64_tr_b16 v[96:97], v18 offset:40960
  ds_read_b64_tr_b16 v[98:99], v18 offset:43008
  v_mfma_f32_32x32x16_bf16 a[16:31], v[84:87], v[64:67], a[16:31]
  ds_read_b128 v[112:115], v13 offset:32768
  ds_read_b128 v[116:119], v13 offset:34816
  v_mfma_f32_32x32x16_bf16 a[64:79], v[80:83], v[68:71], a[64:79]
  ds_read_b64_tr_b16 v[100:101], v19 offset:40960
  v_mfma_f32_32x32x16_bf16 a[80:95], v[84:87], v[68:71], a[80:95]
  ds_read_b64_tr_b16 v[102:103], v19 offset:43008
  v_mfma_f32_32x32x16_bf16 a[128:143], v[80:83], v[72:75], a[128:143]
  ds_read_b64_tr_b16 v[104:105], v20 offset:40960
  v_mfma_f32_32x32x16_bf16 a[144:159], v[84:87], v[72:75], a[144:159]
  ds_read_b64_tr_b16 v[106:107], v20 offset:43008
  v_mfma_f32_32x32x16_bf16 a[192:207], v[80:83], v[76:79], a[192:207]
  ds_read_b64_tr_b16 v[108:109], v21 offset:40960
  v_mfma_f32_32x32x16_bf16 a[208:223], v[84:87], v[76:79], a[208:223]
  ds_read_b64_tr_b16 v[110:111], v21 offset:43008
  s_waitcnt lgkmcnt(0)
  v_mfma_f32_32x32x16_bf16 a[0:15], v[112:115], v[96:99], a[0:15]
  v_mfma_f32_32x32x16_bf16 a[16:31], v[116:119], v[96:99], a[16:31]
  v_mfma_f32_32x32x16_bf16 a[64:79], v[112:115], v[100:103], a[64:79]
  v_mfma_f32_32x32x16_bf16 a[80:95], v[116:119], v[100:103], a[80:95]
  v_mfma_f32_32x32x16_bf16 a[128:143], v[112:115], v[104:107], a[128:143]
  v_mfma_f32_32x32x16_bf16 a[144:159], v[116:119], v[104:107], a[144:159]
  v_mfma_f32_32x32x16_bf16 a[192:207], v[112:115], v[108:111], a[192:207]
  v_mfma_f32_32x32x16_bf16 a[208:223], v[116:119], v[108:111], a[208:223]
BGG_HEPI:
  s_nop 7
  s_nop 7
  v_lshlrev_b32 v22, 4, v1
  v_accvgpr_read_b32 v40, a0
  v_accvgpr_read_b32 v41, a1
  v_accvgpr_read_b32 v42, a2
  v_accvgpr_read_b32 v43, a3
  v_accvgpr_read_b32 v44, a4
  v_accvgpr_read_b32 v45, a5
  v_accvgpr_read_b32 v46, a6
  v_accvgpr_read_b32 v47, a7
  v_accvgpr_read_b32 v48, a8
  v_accvgpr_read_b32 v49, a9
  v_accvgpr_read_b32 v50, a10
  v_accvgpr_read_b32 v51, a11
  v_accvgpr_read_b32 v52, a12
  v_accvgpr_read_b32 v53, a13
  v_accvgpr_read_b32 v54, a14
  v_accvgpr_read_b32 v55, a15
  v_cvt_pk_bf16_f32 v128, v40, v41
  v_cvt_pk_bf16_f32 v129, v42, v43
  v_cvt_pk_bf16_f32 v130, v44, v45
  v_cvt_pk_bf16_f32 v131, v46, v47
  v_cvt_pk_bf16_f32 v132, v48, v49
  v_cvt_pk_bf16_f32 v133, v50, v51
  v_cvt_pk_bf16_f32 v134, v52, v53
  v_cvt_pk_bf16_f32 v135, v54, v55
  s_add_u32 s34, s30, 0
  buffer_store_dwordx4 v[128:131], v22, s[12:15], s34 offen sc1
  buffer_store_dwordx4 v[132:135], v22, s[12:15], s34 offen offset:1024 sc1
  v_accvgpr_read_b32 v40, a16
  v_accvgpr_read_b32 v41, a17
  v_accvgpr_read_b32 v42, a18
  v_accvgpr_read_b32 v43, a19
  v_accvgpr_read_b32 v44, a20
  v_accvgpr_read_b32 v45, a21
  v_accvgpr_read_b32 v46, a22
  v_accvgpr_read_b32 v47, a23
  v_accvgpr_read_b32 v48, a24
  v_accvgpr_read_b32 v49, a25
  v_accvgpr_read_b32 v50, a26
  v_accvgpr_read_b32 v51, a27
  v_accvgpr_read_b32 v52, a28
  v_accvgpr_read_b32 v53, a29
  v_accvgpr_read_b32 v54, a30
  v_accvgpr_read_b32 v55, a31
  v_cvt_pk_bf16_f32 v136, v40, v41
  v_cvt_pk_bf16_f32 v137, v42, v43
  v_cvt_pk_bf16_f32 v138, v44, v45
  v_cvt_pk_bf16_f32 v139, v46, v47
  v_cvt_pk_bf16_f32 v140, v48, v49
  v_cvt_pk_bf16_f32 v141, v50, v51
  v_cvt_pk_bf16_f32 v142, v52, v53
  v_cvt_pk_bf16_f32 v143, v54, v55
  s_add_u32 s34, s30, 393216
  buffer_store_dwordx4 v[136:139], v22, s[12:15], s34 offen sc1
  buffer_store_dwordx4 v[140:143], v22, s[12:15], s34 offen offset:1024 sc1
  v_accvgpr_read_b32 v40, a64
  v_accvgpr_read_b32 v41, a65
  v_accvgpr_read_b32 v42, a66
  v_accvgpr_read_b32 v43, a67
  v_accvgpr_read_b32 v44, a68
  v_accvgpr_read_b32 v45, a69
  v_accvgpr_read_b32 v46, a70
  v_accvgpr_read_b32 v47, a71
  v_accvgpr_read_b32 v48, a72
  v_accvgpr_read_b32 v49, a73
  v_accvgpr_read_b32 v50, a74
  v_accvgpr_read_b32 v51, a75
  v_accvgpr_read_b32 v52, a76
  v_accvgpr_read_b32 v53, a77
  v_accvgpr_read_b32 v54, a78
  v_accvgpr_read_b32 v55, a79
  v_cvt_pk_bf16_f32 v144, v40, v41
  v_cvt_pk_bf16_f32 v145, v42, v43
  v_cvt_pk_bf16_f32 v146, v44, v45
  v_cvt_pk_bf16_f32 v147, v46, v47
  v_cvt_pk_bf16_f32 v148, v48, v49
  v_cvt_pk_bf16_f32 v149, v50, v51
  v_cvt_pk_bf16_f32 v150, v52, v53
  v_cvt_pk_bf16_f32 v151, v54, v55
  s_add_u32 s34, s30, 2048
  buffer_store_dwordx4 v[144:147], v22, s[12:15], s34 offen sc1
  buffer_store_dwordx4 v[148:151], v22, s[12:15], s34 offen offset:1024 sc1
  v_accvgpr_read_b32 v40, a80
  v_accvgpr_read_b32 v41, a81
  v_accvgpr_read_b32 v42, a82
  v_accvgpr_read_b32 v43, a83
  v_accvgpr_read_b32 v44, a84
  v_accvgpr_read_b32 v45, a85
  v_accvgpr_read_b32 v46, a86
  v_accvgpr_read_b32 v47, a87
  v_accvgpr_read_b32 v48, a88
  v_accvgpr_read_b32 v49, a89
  v_accvgpr_read_b32 v50, a90
  v_accvgpr_read_b32 v51, a91
  v_accvgpr_read_b32 v52, a92
  v_accvgpr_read_b32 v53, a93
  v_accvgpr_read_b32 v54, a94
  v_accvgpr_read_b32 v55, a95
  v_cvt_pk_bf16_f32 v152, v40, v41
  v_cvt_pk_bf16_f32 v153, v42, v43
  v_cvt_pk_bf16_f32 v154, v44, v45
  v_cvt_pk_bf16_f32 v155, v46, v47
  v_cvt_pk_bf16_f32 v156, v48, v49
  v_cvt_pk_bf16_f32 v157, v50, v51
  v_cvt_pk_bf16_f32 v158, v52, v53
  v_cvt_pk_bf16_f32 v159, v54, v55
  s_add_u32 s34, s30, 395264
  buffer_store_dwordx4 v[152:155], v22, s[12:15], s34 offen sc1
  buffer_store_dwordx4 v[156:159], v22, s[12:15], s34 offen offset:1024 sc1
  v_accvgpr_read_b32 v40, a128
  v_accvgpr_read_b32 v41, a129
  v_accvgpr_read_b32 v42, a130
  v_accvgpr_read_b32 v43, a131
  v_accvgpr_read_b32 v44, a132
  v_accvgpr_read_b32 v45, a133
  v_accvgpr_read_b32 v46, a134
  v_accvgpr_read_b32 v47, a135
  v_accvgpr_read_b32 v48, a136
  v_accvgpr_read_b32 v49, a137
  v_accvgpr_read_b32 v50, a138
  v_accvgpr_read_b32 v51, a139
  v_accvgpr_read_b32 v52, a140
  v_accvgpr_read_b32 v53, a141
  v_accvgpr_read_b32 v54, a142
  v_accvgpr_read_b32 v55, a143
  v_cvt_pk_bf16_f32 v128, v40, v41
  v_cvt_pk_bf16_f32 v129, v42, v43
  v_cvt_pk_bf16_f32 v130, v44, v45
  v_cvt_pk_bf16_f32 v131, v46, v47
  v_cvt_pk_bf16_f32 v132, v48, v49
  v_cvt_pk_bf16_f32 v133, v50, v51
  v_cvt_pk_bf16_f32 v134, v52, v53
  v_cvt_pk_bf16_f32 v135, v54, v55
  s_add_u32 s34, s30, 4096
  buffer_store_dwordx4 v[128:131], v22, s[12:15], s34 offen sc1
  buffer_store_dwordx4 v[132:135], v22, s[12:15], s34 offen offset:1024 sc1
  v_accvgpr_read_b32 v40, a144
  v_accvgpr_read_b32 v41, a145
  v_accvgpr_read_b32 v42, a146
  v_accvgpr_read_b32 v43, a147
  v_accvgpr_read_b32 v44, a148
  v_accvgpr_read_b32 v45, a149
  v_accvgpr_read_b32 v46, a150
  v_accvgpr_read_b32 v47, a151
  v_accvgpr_read_b32 v48, a152
  v_accvgpr_read_b32 v49, a153
  v_accvgpr_read_b32 v50, a154
  v_accvgpr_read_b32 v51, a155
  v_accvgpr_read_b32 v52, a156
  v_accvgpr_read_b32 v53, a157
  v_accvgpr_read_b32 v54, a158
  v_accvgpr_read_b32 v55, a159
  v_cvt_pk_bf16_f32 v136, v40, v41
  v_cvt_pk_bf16_f32 v137, v42, v43
  v_cvt_pk_bf16_f32 v138, v44, v45
  v_cvt_pk_bf16_f32 v139, v46, v47
  v_cvt_pk_bf16_f32 v140, v48, v49
  v_cvt_pk_bf16_f32 v141, v50, v51
  v_cvt_pk_bf16_f32 v142, v52, v53
  v_cvt_pk_bf16_f32 v143, v54, v55
  s_add_u32 s34, s30, 397312
  buffer_store_dwordx4 v[136:139], v22, s[12:15], s34 offen sc1
  buffer_store_dwordx4 v[140:143], v22, s[12:15], s34 offen offset:1024 sc1
  v_accvgpr_read_b32 v40, a192
  v_accvgpr_read_b32 v41, a193
  v_accvgpr_read_b32 v42, a194
  v_accvgpr_read_b32 v43, a195
  v_accvgpr_read_b32 v44, a196
  v_accvgpr_read_b32 v45, a197
  v_accvgpr_read_b32 v46, a198
  v_accvgpr_read_b32 v47, a199
  v_accvgpr_read_b32 v48, a200
  v_accvgpr_read_b32 v49, a201
  v_accvgpr_read_b32 v50, a202
  v_accvgpr_read_b32 v51, a203
  v_accvgpr_read_b32 v52, a204
  v_accvgpr_read_b32 v53, a205
  v_accvgpr_read_b32 v54, a206
  v_accvgpr_read_b32 v55, a207
  v_cvt_pk_bf16_f32 v144, v40, v41
  v_cvt_pk_bf16_f32 v145, v42, v43
  v_cvt_pk_bf16_f32 v146, v44, v45
  v_cvt_pk_bf16_f32 v147, v46, v47
  v_cvt_pk_bf16_f32 v148, v48, v49
  v_cvt_pk_bf16_f32 v149, v50, v51
  v_cvt_pk_bf16_f32 v150, v52, v53
  v_cvt_pk_bf16_f32 v151, v54, v55
  s_add_u32 s34, s30, 6144
  buffer_store_dwordx4 v[144:147], v22, s[12:15], s34 offen sc1
  buffer_store_dwordx4 v[148:151], v22, s[12:15], s34 offen offset:1024 sc1
  v_accvgpr_read_b32 v40, a208
  v_accvgpr_read_b32 v41, a209
  v_accvgpr_read_b32 v42, a210
  v_accvgpr_read_b32 v43, a211
  v_accvgpr_read_b32 v44, a212
  v_accvgpr_read_b32 v45, a213
  v_accvgpr_read_b32 v46, a214
  v_accvgpr_read_b32 v47, a215
  v_accvgpr_read_b32 v48, a216
  v_accvgpr_read_b32 v49, a217
  v_accvgpr_read_b32 v50, a218
  v_accvgpr_read_b32 v51, a219
  v_accvgpr_read_b32 v52, a220
  v_accvgpr_read_b32 v53, a221
  v_accvgpr_read_b32 v54, a222
  v_accvgpr_read_b32 v55, a223
  v_cvt_pk_bf16_f32 v152, v40, v41
  v_cvt_pk_bf16_f32 v153, v42, v43
  v_cvt_pk_bf16_f32 v154, v44, v45
  v_cvt_pk_bf16_f32 v155, v46, v47
  v_cvt_pk_bf16_f32 v156, v48, v49
  v_cvt_pk_bf16_f32 v157, v50, v51
  v_cvt_pk_bf16_f32 v158, v52, v53
  v_cvt_pk_bf16_f32 v159, v54, v55
  s_add_u32 s34, s30, 399360
  buffer_store_dwordx4 v[152:155], v22, s[12:15], s34 offen sc1
  buffer_store_dwordx4 v[156:159], v22, s[12:15], s34 offen offset:1024 sc1
BGG_NEXT:
  s_cmp_eq_u32 s90, 0
  s_cbranch_scc0 BG_SIG
  s_cmp_eq_u32 s80, 0
  s_cbranch_scc0 TI_7
  v_mov_b32 v255, 1
  s_mov_b64 exec, 1
  buffer_atomic_add v255, off, s[84:87], s97 sc0 sc1
  s_mov_b64 exec, -1
TI_7:
  s_waitcnt vmcnt(0)
  v_readfirstlane_b32 s96, v255
  s_barrier
  s_branch BG_FIN
BG_BA:
  s_mov_b32 s91, 1836032
  s_cmp_eq_u32 s80, 0
  s_cbranch_scc0 W_8_d
  v_lshlrev_b32 v2, 2, v0
  s_mov_b32 s93, 0
  s_mov_b64 exec, 0x1
W_8_l:
  buffer_load_dword v3, v2, s[84:87], s91 offen sc1
  s_add_u32 s93, s93, 1
  s_waitcnt vmcnt(0)
  v_cmp_gt_u32 vcc, 64, v3
  s_cbranch_vccz W_8_k
  s_sleep 4
  s_cmp_lt_u32 s93, 200000
  s_cbranch_scc1 W_8_l
W_8_k:
  s_mov_b64 exec, -1
W_8_d:
  s_barrier
  s_mov_b32 s4, s84
  s_mov_b32 s5, s85
  s_mov_b32 s6, s86
  s_mov_b32 s7, s87
  s_lshr_b32 s58, s82, 2
  s_lshl_b32 s59, s79, 3
  s_add_u32 s58, s58, s59
  s_and_b32 s59, s82, 3
  s_lshl_b32 s90, s59, 6
  s_add_u32 s90, s90, 1836096
  v_lshlrev_b32 v2, 4, v1
  v_and_b32 v6, 31, v1
  v_lshrrev_b32 v7, 5, v1
  v_lshlrev_b32 v3, 3, v6
  v_add_u32 v3, 1024, v3
  v_mul_u32_u24 v4, 320, v7
  v_lshlrev_b32 v5, 4, v6
  v_add_u32 v4, v4, v5
  v_mul_u32_u24 v5, 1280, v6
  v_lshlrev_b32 v7, 3, v7
  v_add_u32 v5, v5, v7
  s_mov_b32 s40, 0x3ea52b5c
  s_mov_b32 s41, 0x3ea52b5c
  s_mov_b32 s44, 0x000fffff
  s_mov_b32 s45, 0x000fffff
  s_mul_i32 s46, s58, 81920
  s_add_u32 s42, s46, 118489088
  s_add_u32 s43, s46, 121634816
  s_lshl_b32 s47, s59, 4
  s_lshl_b32 s48, s80, 2
  s_add_u32 s47, s47, s48
  s_mul_i32 s48, s47, 1280
  s_add_u32 s48, s48, s46
  s_add_u32 s48, s48, 115343360
  s_add_u32 s49, s48, 0
  buffer_load_dwordx4 v[8:11], v2, s[4:7], s49 offen
  buffer_load_dwordx2 v[12:13], v3, s[4:7], s49 offen
  s_add_u32 s49, s48, 1280
  buffer_load_dwordx4 v[14:17], v2, s[4:7], s49 offen
  buffer_load_dwordx2 v[18:19], v3, s[4:7], s49 offen
  s_add_u32 s49, s48, 2560
  buffer_load_dwordx4 v[20:23], v2, s[4:7], s49 offen
  buffer_load_dwordx2 v[24:25], v3, s[4:7], s49 offen
  s_add_u32 s49, s48, 3840
  buffer_load_dwordx4 v[26:29], v2, s[4:7], s49 offen
  buffer_load_dwordx2 v[30:31], v3, s[4:7], s49 offen
  v_mov_b32 v166, 0x3f803f80
  v_mov_b32 v167, 0x3f803f80
  v_mov_b32 v168, 0x3f803f80
  v_mov_b32 v169, 0x3f803f80
  v_mov_b32 v170, 0x3f803f80
  v_mov_b32 v171, 0x3f803f80
  v_mov_b32 v172, 0x3f803f80
  v_mov_b32 v173, 0x3f803f80
  v_mov_b32 v180, 0x3f803f80
  v_mov_b32 v181, 0x3f803f80
  v_mov_b32 v182, 0x3f803f80
  v_mov_b32 v183, 0x3f803f80
  v_mov_b32 v184, 0x3f803f80
  v_mov_b32 v185, 0x3f803f80
  v_mov_b32 v186, 0x3f803f80
  v_mov_b32 v187, 0x3f803f80
  v_mov_b32 v194, 0x3f803f80
  v_mov_b32 v195, 0x3f803f80
  v_mov_b32 v196, 0x3f803f80
  v_mov_b32 v197, 0x3f803f80
  v_mov_b32 v198, 0x3f803f80
  v_mov_b32 v199, 0x3f803f80
  v_mov_b32 v200, 0x3f803f80
  v_mov_b32 v201, 0x3f803f80
  v_mov_b32 v208, 0x3f803f80
  v_mov_b32 v209, 0x3f803f80
  v_mov_b32 v210, 0x3f803f80
  v_mov_b32 v211, 0x3f803f80
  v_mov_b32 v212, 0x3f803f80
  v_mov_b32 v213, 0x3f803f80
  v_mov_b32 v214, 0x3f803f80
  v_mov_b32 v215, 0x3f803f80
  v_mov_b32 v32, 0xff800000
  v_mov_b32 v36, 0
  v_mov_b32 v37, 0xff800000
  v_mov_b32 v33, 0xff800000
  v_mov_b32 v38, 0
  v_mov_b32 v39, 0xff800000
  v_mov_b32 v34, 0xff800000
  v_mov_b32 v40, 0
  v_mov_b32 v41, 0xff800000
  v_mov_b32 v35, 0xff800000
  v_mov_b32 v42, 0
  v_mov_b32 v43, 0xff800000
  v_mov_b32 v48, 0
  v_mov_b32 v49, 0
  v_mov_b32 v50, 0
  v_mov_b32 v51, 0
  v_mov_b32 v52, 0
  v_mov_b32 v53, 0
  v_mov_b32 v54, 0
  v_mov_b32 v55, 0
  v_mov_b32 v56, 0
  v_mov_b32 v57, 0
  v_mov_b32 v58, 0
  v_mov_b32 v59, 0
  v_mov_b32 v60, 0
  v_mov_b32 v61, 0
  v_mov_b32 v62, 0
  v_mov_b32 v63, 0
  v_mov_b32 v64, 0
  v_mov_b32 v65, 0
  v_mov_b32 v66, 0
  v_mov_b32 v67, 0
  v_mov_b32 v68, 0
  v_mov_b32 v69, 0
  v_mov_b32 v70, 0
  v_mov_b32 v71, 0
  v_mov_b32 v72, 0
  v_mov_b32 v73, 0
  v_mov_b32 v74, 0
  v_mov_b32 v75, 0
  v_mov_b32 v76, 0
  v_mov_b32 v77, 0
  v_mov_b32 v78, 0
  v_mov_b32 v79, 0
  v_mov_b32 v80, 0
  v_mov_b32 v81, 0
  v_mov_b32 v82, 0
  v_mov_b32 v83, 0
  v_mov_b32 v84, 0
  v_mov_b32 v85, 0
  v_mov_b32 v86, 0
  v_mov_b32 v87, 0
  v_mov_b32 v88, 0
  v_mov_b32 v89, 0
  v_mov_b32 v90, 0
  v_mov_b32 v91, 0
  v_mov_b32 v92, 0
  v_mov_b32 v93, 0
  v_mov_b32 v94, 0
  v_mov_b32 v95, 0
  v_mov_b32 v96, 0
  v_mov_b32 v97, 0
  v_mov_b32 v98, 0
  v_mov_b32 v99, 0
  v_mov_b32 v100, 0
  v_mov_b32 v101, 0
  v_mov_b32 v102, 0
  v_mov_b32 v103, 0
  v_mov_b32 v104, 0
  v_mov_b32 v105, 0
  v_mov_b32 v106, 0
  v_mov_b32 v107, 0
  v_mov_b32 v108, 0
  v_mov_b32 v109, 0
  v_mov_b32 v110, 0
  v_mov_b32 v111, 0
  buffer_load_dwordx4 v[160:163], v2, s[4:7], s42 offen
  buffer_load_dwordx2 v[164:165], v3, s[4:7], s42 offen
  s_mov_b64 exec, s[44:45]
  buffer_load_dwordx4 v[166:169], v4, s[4:7], s43 offen
  buffer_load_dwordx4 v[170:173], v4, s[4:7], s43 offen offset:640
  s_mov_b64 exec, -1
  s_add_u32 s42, s42, 1280
  s_add_u32 s43, s43, 1280
  buffer_load_dwordx4 v[174:177], v2, s[4:7], s42 offen
  buffer_load_dwordx2 v[178:179], v3, s[4:7], s42 offen
  s_mov_b64 exec, s[44:45]
  buffer_load_dwordx4 v[180:183], v4, s[4:7], s43 offen
  buffer_load_dwordx4 v[184:187], v4, s[4:7], s43 offen offset:640
  s_mov_b64 exec, -1
  s_add_u32 s42, s42, 1280
  s_add_u32 s43, s43, 1280
  buffer_load_dwordx4 v[188:191], v2, s[4:7], s42 offen
  buffer_load_dwordx2 v[192:193], v3, s[4:7], s42 offen
  s_mov_b64 exec, s[44:45]
  buffer_load_dwordx4 v[194:197], v4, s[4:7], s43 offen
  buffer_load_dwordx4 v[198:201], v4, s[4:7], s43 offen offset:640
  s_mov_b64 exec, -1
  s_add_u32 s42, s42, 1280
  s_add_u32 s43, s43, 1280
  s_waitcnt vmcnt(8)
  v_cmp_gt_u32 vcc, 32, v1
  v_cndmask_b32 v12, 0, v12, vcc
  v_cndmask_b32 v13, 0, v13, vcc
  v_cndmask_b32 v18, 0, v18, vcc
  v_cndmask_b32 v19, 0, v19, vcc
  v_cndmask_b32 v24, 0, v24, vcc
  v_cndmask_b32 v25, 0, v25, vcc
  v_cndmask_b32 v30, 0, v30, vcc
  v_cndmask_b32 v31, 0, v31, vcc
  s_nop 1
  v_mfma_f32_32x32x16_bf16 v[112:127], v[160:163], v[8:11], 0
  v_mfma_f32_32x32x8_bf16 v[112:127], v[164:165], v[12:13], v[112:127]
  v_mov_b32 v152, 0
  v_mov_b32 v153, 0
  v_mov_b32 v154, 0
  v_mov_b32 v155, 0
  v_mov_b32 v156, 0
  v_mov_b32 v157, 0
  v_mov_b32 v158, 0
  v_mov_b32 v159, 0
  s_nop 7
  s_nop 7
  s_mov_b32 s50, 16
BA_9_loop:
  v_mfma_f32_32x32x16_bf16 v[96:111], v[208:211], v[152:155], v[96:111]
  v_max3_f32 v216, v112, v113, v114
  v_max3_f32 v217, v115, v116, v117
  v_max3_f32 v216, v216, v118, v119
  v_max3_f32 v217, v217, v120, v121
  v_max3_f32 v216, v216, v122, v123
  v_max3_f32 v217, v217, v124, v125
  v_max3_f32 v216, v216, v126, v127
  v_max3_f32 v216, v216, v217, v32
  v_mfma_f32_32x32x16_bf16 v[96:111], v[212:215], v[156:159], v[96:111]
  v_mov_b32 v217, v216
  s_nop 1
  v_permlane32_swap_b32 v216, v217
  v_max_f32 v216, v216, v217
  v_cmp_gt_f32 vcc, v216, v37
  s_cbranch_vccz BK_10
  v_sub_f32 v217, v32, v216
  v_mul_f32 v217, s40, v217
  v_exp_f32 v218, v217
  v_mov_b32 v32, v216
  v_mul_f32 v36, s40, v216
  v_add_f32 v37, 0x41c663eb, v216
  v_pk_mul_f32 v[48:49], v[48:49], v[218:219] op_sel_hi:[1,0]
  v_pk_mul_f32 v[50:51], v[50:51], v[218:219] op_sel_hi:[1,0]
  v_pk_mul_f32 v[52:53], v[52:53], v[218:219] op_sel_hi:[1,0]
  v_pk_mul_f32 v[54:55], v[54:55], v[218:219] op_sel_hi:[1,0]
  v_pk_mul_f32 v[56:57], v[56:57], v[218:219] op_sel_hi:[1,0]
  v_pk_mul_f32 v[58:59], v[58:59], v[218:219] op_sel_hi:[1,0]
  v_pk_mul_f32 v[60:61], v[60:61], v[218:219] op_sel_hi:[1,0]
  v_pk_mul_f32 v[62:63], v[62:63], v[218:219] op_sel_hi:[1,0]
BK_10:
  v_mfma_f32_32x32x16_bf16 v[128:143], v[160:163], v[14:17], 0
  v_pk_fma_f32 v[112:113], v[112:113], s[40:41], v[36:37] op_sel_hi:[1,1,0] neg_lo:[0,0,1] neg_hi:[0,0,1]
  v_pk_fma_f32 v[114:115], v[114:115], s[40:41], v[36:37] op_sel_hi:[1,1,0] neg_lo:[0,0,1] neg_hi:[0,0,1]
  v_pk_fma_f32 v[116:117], v[116:117], s[40:41], v[36:37] op_sel_hi:[1,1,0] neg_lo:[0,0,1] neg_hi:[0,0,1]
  v_pk_fma_f32 v[118:119], v[118:119], s[40:41], v[36:37] op_sel_hi:[1,1,0] neg_lo:[0,0,1] neg_hi:[0,0,1]
  v_pk_fma_f32 v[120:121], v[120:121], s[40:41], v[36:37] op_sel_hi:[1,1,0] neg_lo:[0,0,1] neg_hi:[0,0,1]
  v_pk_fma_f32 v[122:123], v[122:123], s[40:41], v[36:37] op_sel_hi:[1,1,0] neg_lo:[0,0,1] neg_hi:[0,0,1]
  v_pk_fma_f32 v[124:125], v[124:125], s[40:41], v[36:37] op_sel_hi:[1,1,0] neg_lo:[0,0,1] neg_hi:[0,0,1]
  v_pk_fma_f32 v[126:127], v[126:127], s[40:41], v[36:37] op_sel_hi:[1,1,0] neg_lo:[0,0,1] neg_hi:[0,0,1]
  v_mfma_f32_32x32x8_bf16 v[128:143], v[164:165], v[18:19], v[128:143]
  v_exp_f32 v112, v112
  v_exp_f32 v113, v113
  v_exp_f32 v114, v114
  v_exp_f32 v115, v115
  v_exp_f32 v116, v116
  v_exp_f32 v117, v117
  v_exp_f32 v118, v118
  v_exp_f32 v119, v119
  v_exp_f32 v120, v120
  v_exp_f32 v121, v121
  v_exp_f32 v122, v122
  v_exp_f32 v123, v123
  v_exp_f32 v124, v124
  v_exp_f32 v125, v125
  v_exp_f32 v126, v126
  v_exp_f32 v127, v127
  v_cvt_pk_bf16_f32 v144, v112, v113
  v_cvt_pk_bf16_f32 v145, v114, v115
  v_cvt_pk_bf16_f32 v146, v116, v117
  v_cvt_pk_bf16_f32 v147, v118, v119
  v_cvt_pk_bf16_f32 v148, v120, v121
  v_cvt_pk_bf16_f32 v149, v122, v123
  v_cvt_pk_bf16_f32 v150, v124, v125
  v_cvt_pk_bf16_f32 v151, v126, v127
  v_mfma_f32_32x32x16_bf16 v[48:63], v[166:169], v[144:147], v[48:63]
  v_max3_f32 v216, v128, v129, v130
  v_max3_f32 v217, v131, v132, v133
  v_max3_f32 v216, v216, v134, v135
  v_max3_f32 v217, v217, v136, v137
  v_max3_f32 v216, v216, v138, v139
  v_max3_f32 v217, v217, v140, v141
  v_max3_f32 v216, v216, v142, v143
  v_max3_f32 v216, v216, v217, v33
  v_mfma_f32_32x32x16_bf16 v[48:63], v[170:173], v[148:151], v[48:63]
  v_mov_b32 v217, v216
  s_nop 1
  v_permlane32_swap_b32 v216, v217
  v_max_f32 v216, v216, v217
  v_cmp_gt_f32 vcc, v216, v39
  s_cbranch_vccz BK_11
  v_sub_f32 v217, v33, v216
  v_mul_f32 v217, s40, v217
  v_exp_f32 v218, v217
  v_mov_b32 v33, v216
  v_mul_f32 v38, s40, v216
  v_add_f32 v39, 0x41c663eb, v216
  v_pk_mul_f32 v[64:65], v[64:65], v[218:219] op_sel_hi:[1,0]
  v_pk_mul_f32 v[66:67], v[66:67], v[218:219] op_sel_hi:[1,0]
  v_pk_mul_f32 v[68:69], v[68:69], v[218:219] op_sel_hi:[1,0]
  v_pk_mul_f32 v[70:71], v[70:71], v[218:219] op_sel_hi:[1,0]
  v_pk_mul_f32 v[72:73], v[72:73], v[218:219] op_sel_hi:[1,0]
  v_pk_mul_f32 v[74:75], v[74:75], v[218:219] op_sel_hi:[1,0]
  v_pk_mul_f32 v[76:77], v[76:77], v[218:219] op_sel_hi:[1,0]
  v_pk_mul_f32 v[78:79], v[78:79], v[218:219] op_sel_hi:[1,0]
BK_11:
  v_mfma_f32_32x32x16_bf16 v[112:127], v[160:163], v[20:23], 0
  v_pk_fma_f32 v[128:129], v[128:129], s[40:41], v[38:39] op_sel_hi:[1,1,0] neg_lo:[0,0,1] neg_hi:[0,0,1]
  v_pk_fma_f32 v[130:131], v[130:131], s[40:41], v[38:39] op_sel_hi:[1,1,0] neg_lo:[0,0,1] neg_hi:[0,0,1]
  v_pk_fma_f32 v[132:133], v[132:133], s[40:41], v[38:39] op_sel_hi:[1,1,0] neg_lo:[0,0,1] neg_hi:[0,0,1]
  v_pk_fma_f32 v[134:135], v[134:135], s[40:41], v[38:39] op_sel_hi:[1,1,0] neg_lo:[0,0,1] neg_hi:[0,0,1]
  v_pk_fma_f32 v[136:137], v[136:137], s[40:41], v[38:39] op_sel_hi:[1,1,0] neg_lo:[0,0,1] neg_hi:[0,0,1]
  v_pk_fma_f32 v[138:139], v[138:139], s[40:41], v[38:39] op_sel_hi:[1,1,0] neg_lo:[0,0,1] neg_hi:[0,0,1]
  v_pk_fma_f32 v[140:141], v[140:141], s[40:41], v[38:39] op_sel_hi:[1,1,0] neg_lo:[0,0,1] neg_hi:[0,0,1]
  v_pk_fma_f32 v[142:143], v[142:143], s[40:41], v[38:39] op_sel_hi:[1,1,0] neg_lo:[0,0,1] neg_hi:[0,0,1]
  v_mfma_f32_32x32x8_bf16 v[112:127], v[164:165], v[24:25], v[112:127]
  buffer_load_dwordx4 v[202:205], v2, s[4:7], s42 offen
  buffer_load_dwordx2 v[206:207], v3, s[4:7], s42 offen
  s_mov_b64 exec, s[44:45]
  buffer_load_dwordx4 v[208:211], v4, s[4:7], s43 offen
  buffer_load_dwordx4 v[212:215], v4, s[4:7], s43 offen offset:640
  s_mov_b64 exec, -1
  s_add_u32 s42, s42, 1280
  s_add_u32 s43, s43, 1280
  v_exp_f32 v128, v128
  v_exp_f32 v129, v129
  v_exp_f32 v130, v130
  v_exp_f32 v131, v131
  v_exp_f32 v132, v132
  v_exp_f32 v133, v133
  v_exp_f32 v134, v134
  v_exp_f32 v135, v135
  v_exp_f32 v136, v136
  v_exp_f32 v137, v137
  v_exp_f32 v138, v138
  v_exp_f32 v139, v139
  v_exp_f32 v140, v140
  v_exp_f32 v141, v141
  v_exp_f32 v142, v142
  v_exp_f32 v143, v143
  v_cvt_pk_bf16_f32 v152, v128, v129
  v_cvt_pk_bf16_f32 v153, v130, v131
  v_cvt_pk_bf16_f32 v154, v132, v133
  v_cvt_pk_bf16_f32 v155, v134, v135
  v_cvt_pk_bf16_f32 v156, v136, v137
  v_cvt_pk_bf16_f32 v157, v138, v139
  v_cvt_pk_bf16_f32 v158, v140, v141
  v_cvt_pk_bf16_f32 v159, v142, v143
  v_mfma_f32_32x32x16_bf16 v[64:79], v[166:169], v[152:155], v[64:79]
  v_max3_f32 v216, v112, v113, v114
  v_max3_f32 v217, v115, v116, v117
  v_max3_f32 v216, v216, v118, v119
  v_max3_f32 v217, v217, v120, v121
  v_max3_f32 v216, v216, v122, v123
  v_max3_f32 v217, v217, v124, v125
  v_max3_f32 v216, v216, v126, v127
  v_max3_f32 v216, v216, v217, v34
  v_mfma_f32_32x32x16_bf16 v[64:79], v[170:173], v[156:159], v[64:79]
  v_mov_b32 v217, v216
  s_nop 1
  v_permlane32_swap_b32 v216, v217
  v_max_f32 v216, v216, v217
  v_cmp_gt_f32 vcc, v216, v41
  s_cbranch_vccz BK_12
  v_sub_f32 v217, v34, v216
  v_mul_f32 v217, s40, v217
  v_exp_f32 v218, v217
  v_mov_b32 v34, v216
  v_mul_f32 v40, s40, v216
  v_add_f32 v41, 0x41c663eb, v216
  v_pk_mul_f32 v[80:81], v[80:81], v[218:219] op_sel_hi:[1,0]
  v_pk_mul_f32 v[82:83], v[82:83], v[218:219] op_sel_hi:[1,0]
  v_pk_mul_f32 v[84:85], v[84:85], v[218:219] op_sel_hi:[1,0]
  v_pk_mul_f32 v[86:87], v[86:87], v[218:219] op_sel_hi:[1,0]
  v_pk_mul_f32 v[88:89], v[88:89], v[218:219] op_sel_hi:[1,0]
  v_pk_mul_f32 v[90:91], v[90:91], v[218:219] op_sel_hi:[1,0]
  v_pk_mul_f32 v[92:93], v[92:93], v[218:219] op_sel_hi:[1,0]
  v_pk_mul_f32 v[94:95], v[94:95], v[218:219] op_sel_hi:[1,0]
BK_12:
  v_mfma_f32_32x32x16_bf16 v[128:143], v[160:163], v[26:29], 0
  v_pk_fma_f32 v[112:113], v[112:113], s[40:41], v[40:41] op_sel_hi:[1,1,0] neg_lo:[0,0,1] neg_hi:[0,0,1]
  v_pk_fma_f32 v[114:115], v[114:115], s[40:41], v[40:41] op_sel_hi:[1,1,0] neg_lo:[0,0,1] neg_hi:[0,0,1]
  v_pk_fma_f32 v[116:117], v[116:117], s[40:41], v[40:41] op_sel_hi:[1,1,0] neg_lo:[0,0,1] neg_hi:[0,0,1]
  v_pk_fma_f32 v[118:119], v[118:119], s[40:41], v[40:41] op_sel_hi:[1,1,0] neg_lo:[0,0,1] neg_hi:[0,0,1]
  v_pk_fma_f32 v[120:121], v[120:121], s[40:41], v[40:41] op_sel_hi:[1,1,0] neg_lo:[0,0,1] neg_hi:[0,0,1]
  v_pk_fma_f32 v[122:123], v[122:123], s[40:41], v[40:41] op_sel_hi:[1,1,0] neg_lo:[0,0,1] neg_hi:[0,0,1]
  v_pk_fma_f32 v[124:125], v[124:125], s[40:41], v[40:41] op_sel_hi:[1,1,0] neg_lo:[0,0,1] neg_hi:[0,0,1]
  v_pk_fma_f32 v[126:127], v[126:127], s[40:41], v[40:41] op_sel_hi:[1,1,0] neg_lo:[0,0,1] neg_hi:[0,0,1]
  v_mfma_f32_32x32x8_bf16 v[128:143], v[164:165], v[30:31], v[128:143]
  v_exp_f32 v112, v112
  v_exp_f32 v113, v113
  v_exp_f32 v114, v114
  v_exp_f32 v115, v115
  v_exp_f32 v116, v116
  v_exp_f32 v117, v117
  v_exp_f32 v118, v118
  v_exp_f32 v119, v119
  v_exp_f32 v120, v120
  v_exp_f32 v121, v121
  v_exp_f32 v122, v122
  v_exp_f32 v123, v123
  v_exp_f32 v124, v124
  v_exp_f32 v125, v125
  v_exp_f32 v126, v126
  v_exp_f32 v127, v127
  v_cvt_pk_bf16_f32 v144, v112, v113
  v_cvt_pk_bf16_f32 v145, v114, v115
  v_cvt_pk_bf16_f32 v146, v116, v117
  v_cvt_pk_bf16_f32 v147, v118, v119
  v_cvt_pk_bf16_f32 v148, v120, v121
  v_cvt_pk_bf16_f32 v149, v122, v123
  v_cvt_pk_bf16_f32 v150, v124, v125
  v_cvt_pk_bf16_f32 v151, v126, v127
  s_waitcnt vmcnt(8)
  v_mfma_f32_32x32x16_bf16 v[80:95], v[166:169], v[144:147], v[80:95]
  v_max3_f32 v216, v128, v129, v130
  v_max3_f32 v217, v131, v132, v133
  v_max3_f32 v216, v216, v134, v135
  v_max3_f32 v217, v217, v136, v137
  v_max3_f32 v216, v216, v138, v139
  v_max3_f32 v217, v217, v140, v141
  v_max3_f32 v216, v216, v142, v143
  v_max3_f32 v216, v216, v217, v35
  v_mfma_f32_32x32x16_bf16 v[80:95], v[170:173], v[148:151], v[80:95]
  v_mov_b32 v217, v216
  s_nop 1
  v_permlane32_swap_b32 v216, v217
  v_max_f32 v216, v216, v217
  v_cmp_gt_f32 vcc, v216, v43
  s_cbranch_vccz BK_13
  v_sub_f32 v217, v35, v216
  v_mul_f32 v217, s40, v217
  v_exp_f32 v218, v217
  v_mov_b32 v35, v216
  v_mul_f32 v42, s40, v216
  v_add_f32 v43, 0x41c663eb, v216
  v_pk_mul_f32 v[96:97], v[96:97], v[218:219] op_sel_hi:[1,0]
  v_pk_mul_f32 v[98:99], v[98:99], v[218:219] op_sel_hi:[1,0]
  v_pk_mul_f32 v[100:101], v[100:101], v[218:219] op_sel_hi:[1,0]
  v_pk_mul_f32 v[102:103], v[102:103], v[218:219] op_sel_hi:[1,0]
  v_pk_mul_f32 v[104:105], v[104:105], v[218:219] op_sel_hi:[1,0]
  v_pk_mul_f32 v[106:107], v[106:107], v[218:219] op_sel_hi:[1,0]
  v_pk_mul_f32 v[108:109], v[108:109], v[218:219] op_sel_hi:[1,0]
  v_pk_mul_f32 v[110:111], v[110:111], v[218:219] op_sel_hi:[1,0]
BK_13:
  v_mfma_f32_32x32x16_bf16 v[112:127], v[174:177], v[8:11], 0
  v_pk_fma_f32 v[128:129], v[128:129], s[40:41], v[42:43] op_sel_hi:[1,1,0] neg_lo:[0,0,1] neg_hi:[0,0,1]
  v_pk_fma_f32 v[130:131], v[130:131], s[40:41], v[42:43] op_sel_hi:[1,1,0] neg_lo:[0,0,1] neg_hi:[0,0,1]
  v_pk_fma_f32 v[132:133], v[132:133], s[40:41], v[42:43] op_sel_hi:[1,1,0] neg_lo:[0,0,1] neg_hi:[0,0,1]
  v_pk_fma_f32 v[134:135], v[134:135], s[40:41], v[42:43] op_sel_hi:[1,1,0] neg_lo:[0,0,1] neg_hi:[0,0,1]
  v_pk_fma_f32 v[136:137], v[136:137], s[40:41], v[42:43] op_sel_hi:[1,1,0] neg_lo:[0,0,1] neg_hi:[0,0,1]
  v_pk_fma_f32 v[138:139], v[138:139], s[40:41], v[42:43] op_sel_hi:[1,1,0] neg_lo:[0,0,1] neg_hi:[0,0,1]
  v_pk_fma_f32 v[140:141], v[140:141], s[40:41], v[42:43] op_sel_hi:[1,1,0] neg_lo:[0,0,1] neg_hi:[0,0,1]
  v_pk_fma_f32 v[142:143], v[142:143], s[40:41], v[42:43] op_sel_hi:[1,1,0] neg_lo:[0,0,1] neg_hi:[0,0,1]
  v_mfma_f32_32x32x8_bf16 v[112:127], v[178:179], v[12:13], v[112:127]
  v_exp_f32 v128, v128
  v_exp_f32 v129, v129
  v_exp_f32 v130, v130
  v_exp_f32 v131, v131
  v_exp_f32 v132, v132
  v_exp_f32 v133, v133
  v_exp_f32 v134, v134
  v_exp_f32 v135, v135
  v_exp_f32 v136, v136
  v_exp_f32 v137, v137
  v_exp_f32 v138, v138
  v_exp_f32 v139, v139
  v_exp_f32 v140, v140
  v_exp_f32 v141, v141
  v_exp_f32 v142, v142
  v_exp_f32 v143, v143
  v_cvt_pk_bf16_f32 v152, v128, v129
  v_cvt_pk_bf16_f32 v153, v130, v131
  v_cvt_pk_bf16_f32 v154, v132, v133
  v_cvt_pk_bf16_f32 v155, v134, v135
  v_cvt_pk_bf16_f32 v156, v136, v137
  v_cvt_pk_bf16_f32 v157, v138, v139
  v_cvt_pk_bf16_f32 v158, v140, v141
  v_cvt_pk_bf16_f32 v159, v142, v143
  v_mfma_f32_32x32x16_bf16 v[96:111], v[166:169], v[152:155], v[96:111]
  v_max3_f32 v216, v112, v113, v114
  v_max3_f32 v217, v115, v116, v117
  v_max3_f32 v216, v216, v118, v119
  v_max3_f32 v217, v217, v120, v121
  v_max3_f32 v216, v216, v122, v123
  v_max3_f32 v217, v217, v124, v125
  v_max3_f32 v216, v216, v126, v127
  v_max3_f32 v216, v216, v217, v32
  v_mfma_f32_32x32x16_bf16 v[96:111], v[170:173], v[156:159], v[96:111]
  v_mov_b32 v217, v216
  s_nop 1
  v_permlane32_swap_b32 v216, v217
  v_max_f32 v216, v216, v217
  v_cmp_gt_f32 vcc, v216, v37
  s_cbranch_vccz BK_14
  v_sub_f32 v217, v32, v216
  v_mul_f32 v217, s40, v217
  v_exp_f32 v218, v217
  v_mov_b32 v32, v216
  v_mul_f32 v36, s40, v216
  v_add_f32 v37, 0x41c663eb, v216
  v_pk_mul_f32 v[48:49], v[48:49], v[218:219] op_sel_hi:[1,0]
  v_pk_mul_f32 v[50:51], v[50:51], v[218:219] op_sel_hi:[1,0]
  v_pk_mul_f32 v[52:53], v[52:53], v[218:219] op_sel_hi:[1,0]
  v_pk_mul_f32 v[54:55], v[54:55], v[218:219] op_sel_hi:[1,0]
  v_pk_mul_f32 v[56:57], v[56:57], v[218:219] op_sel_hi:[1,0]
  v_pk_mul_f32 v[58:59], v[58:59], v[218:219] op_sel_hi:[1,0]
  v_pk_mul_f32 v[60:61], v[60:61], v[218:219] op_sel_hi:[1,0]
  v_pk_mul_f32 v[62:63], v[62:63], v[218:219] op_sel_hi:[1,0]
BK_14:
  v_mfma_f32_32x32x16_bf16 v[128:143], v[174:177], v[14:17], 0
  v_pk_fma_f32 v[112:113], v[112:113], s[40:41], v[36:37] op_sel_hi:[1,1,0] neg_lo:[0,0,1] neg_hi:[0,0,1]
  v_pk_fma_f32 v[114:115], v[114:115], s[40:41], v[36:37] op_sel_hi:[1,1,0] neg_lo:[0,0,1] neg_hi:[0,0,1]
  v_pk_fma_f32 v[116:117], v[116:117], s[40:41], v[36:37] op_sel_hi:[1,1,0] neg_lo:[0,0,1] neg_hi:[0,0,1]
  v_pk_fma_f32 v[118:119], v[118:119], s[40:41], v[36:37] op_sel_hi:[1,1,0] neg_lo:[0,0,1] neg_hi:[0,0,1]
  v_pk_fma_f32 v[120:121], v[120:121], s[40:41], v[36:37] op_sel_hi:[1,1,0] neg_lo:[0,0,1] neg_hi:[0,0,1]
  v_pk_fma_f32 v[122:123], v[122:123], s[40:41], v[36:37] op_sel_hi:[1,1,0] neg_lo:[0,0,1] neg_hi:[0,0,1]
  v_pk_fma_f32 v[124:125], v[124:125], s[40:41], v[36:37] op_sel_hi:[1,1,0] neg_lo:[0,0,1] neg_hi:[0,0,1]
  v_pk_fma_f32 v[126:127], v[126:127], s[40:41], v[36:37] op_sel_hi:[1,1,0] neg_lo:[0,0,1] neg_hi:[0,0,1]
  v_mfma_f32_32x32x8_bf16 v[128:143], v[178:179], v[18:19], v[128:143]
  v_exp_f32 v112, v112
  v_exp_f32 v113, v113
  v_exp_f32 v114, v114
  v_exp_f32 v115, v115
  v_exp_f32 v116, v116
  v_exp_f32 v117, v117
  v_exp_f32 v118, v118
  v_exp_f32 v119, v119
  v_exp_f32 v120, v120
  v_exp_f32 v121, v121
  v_exp_f32 v122, v122
  v_exp_f32 v123, v123
  v_exp_f32 v124, v124
  v_exp_f32 v125, v125
  v_exp_f32 v126, v126
  v_exp_f32 v127, v127
  v_cvt_pk_bf16_f32 v144, v112, v113
  v_cvt_pk_bf16_f32 v145, v114, v115
  v_cvt_pk_bf16_f32 v146, v116, v117
  v_cvt_pk_bf16_f32 v147, v118, v119
  v_cvt_pk_bf16_f32 v148, v120, v121
  v_cvt_pk_bf16_f32 v149, v122, v123
  v_cvt_pk_bf16_f32 v150, v124, v125
  v_cvt_pk_bf16_f32 v151, v126, v127
  v_mfma_f32_32x32x16_bf16 v[48:63], v[180:183], v[144:147], v[48:63]
  v_max3_f32 v216, v128, v129, v130
  v_max3_f32 v217, v131, v132, v133
  v_max3_f32 v216, v216, v134, v135
  v_max3_f32 v217, v217, v136, v137
  v_max3_f32 v216, v216, v138, v139
  v_max3_f32 v217, v217, v140, v141
  v_max3_f32 v216, v216, v142, v143
  v_max3_f32 v216, v216, v217, v33
  v_mfma_f32_32x32x16_bf16 v[48:63], v[184:187], v[148:151], v[48:63]
  v_mov_b32 v217, v216
  s_nop 1
  v_permlane32_swap_b32 v216, v217
  v_max_f32 v216, v216, v217
  v_cmp_gt_f32 vcc, v216, v39
  s_cbranch_vccz BK_15
  v_sub_f32 v217, v33, v216
  v_mul_f32 v217, s40, v217
  v_exp_f32 v218, v217
  v_mov_b32 v33, v216
  v_mul_f32 v38, s40, v216
  v_add_f32 v39, 0x41c663eb, v216
  v_pk_mul_f32 v[64:65], v[64:65], v[218:219] op_sel_hi:[1,0]
  v_pk_mul_f32 v[66:67], v[66:67], v[218:219] op_sel_hi:[1,0]
  v_pk_mul_f32 v[68:69], v[68:69], v[218:219] op_sel_hi:[1,0]
  v_pk_mul_f32 v[70:71], v[70:71], v[218:219] op_sel_hi:[1,0]
  v_pk_mul_f32 v[72:73], v[72:73], v[218:219] op_sel_hi:[1,0]
  v_pk_mul_f32 v[74:75], v[74:75], v[218:219] op_sel_hi:[1,0]
  v_pk_mul_f32 v[76:77], v[76:77], v[218:219] op_sel_hi:[1,0]
  v_pk_mul_f32 v[78:79], v[78:79], v[218:219] op_sel_hi:[1,0]
BK_15:
  v_mfma_f32_32x32x16_bf16 v[112:127], v[174:177], v[20:23], 0
  v_pk_fma_f32 v[128:129], v[128:129], s[40:41], v[38:39] op_sel_hi:[1,1,0] neg_lo:[0,0,1] neg_hi:[0,0,1]
  v_pk_fma_f32 v[130:131], v[130:131], s[40:41], v[38:39] op_sel_hi:[1,1,0] neg_lo:[0,0,1] neg_hi:[0,0,1]
  v_pk_fma_f32 v[132:133], v[132:133], s[40:41], v[38:39] op_sel_hi:[1,1,0] neg_lo:[0,0,1] neg_hi:[0,0,1]
  v_pk_fma_f32 v[134:135], v[134:135], s[40:41], v[38:39] op_sel_hi:[1,1,0] neg_lo:[0,0,1] neg_hi:[0,0,1]
  v_pk_fma_f32 v[136:137], v[136:137], s[40:41], v[38:39] op_sel_hi:[1,1,0] neg_lo:[0,0,1] neg_hi:[0,0,1]
  v_pk_fma_f32 v[138:139], v[138:139], s[40:41], v[38:39] op_sel_hi:[1,1,0] neg_lo:[0,0,1] neg_hi:[0,0,1]
  v_pk_fma_f32 v[140:141], v[140:141], s[40:41], v[38:39] op_sel_hi:[1,1,0] neg_lo:[0,0,1] neg_hi:[0,0,1]
  v_pk_fma_f32 v[142:143], v[142:143], s[40:41], v[38:39] op_sel_hi:[1,1,0] neg_lo:[0,0,1] neg_hi:[0,0,1]
  v_mfma_f32_32x32x8_bf16 v[112:127], v[178:179], v[24:25], v[112:127]
  buffer_load_dwordx4 v[160:163], v2, s[4:7], s42 offen
  buffer_load_dwordx2 v[164:165], v3, s[4:7], s42 offen
  s_mov_b64 exec, s[44:45]
  buffer_load_dwordx4 v[166:169], v4, s[4:7], s43 offen
  buffer_load_dwordx4 v[170:173], v4, s[4:7], s43 offen offset:640
  s_mov_b64 exec, -1
  s_add_u32 s42, s42, 1280
  s_add_u32 s43, s43, 1280
  v_exp_f32 v128, v128
  v_exp_f32 v129, v129
  v_exp_f32 v130, v130
  v_exp_f32 v131, v131
  v_exp_f32 v132, v132
  v_exp_f32 v133, v133
  v_exp_f32 v134, v134
  v_exp_f32 v135, v135
  v_exp_f32 v136, v136
  v_exp_f32 v137, v137
  v_exp_f32 v138, v138
  v_exp_f32 v139, v139
  v_exp_f32 v140, v140
  v_exp_f32 v141, v141
  v_exp_f32 v142, v142
  v_exp_f32 v143, v143
  v_cvt_pk_bf16_f32 v152, v128, v129
  v_cvt_pk_bf16_f32 v153, v130, v131
  v_cvt_pk_bf16_f32 v154, v132, v133
  v_cvt_pk_bf16_f32 v155, v134, v135
  v_cvt_pk_bf16_f32 v156, v136, v137
  v_cvt_pk_bf16_f32 v157, v138, v139
  v_cvt_pk_bf16_f32 v158, v140, v141
  v_cvt_pk_bf16_f32 v159, v142, v143
  v_mfma_f32_32x32x16_bf16 v[64:79], v[180:183], v[152:155], v[64:79]
  v_max3_f32 v216, v112, v113, v114
  v_max3_f32 v217, v115, v116, v117
  v_max3_f32 v216, v216, v118, v119
  v_max3_f32 v217, v217, v120, v121
  v_max3_f32 v216, v216, v122, v123
  v_max3_f32 v217, v217, v124, v125
  v_max3_f32 v216, v216, v126, v127
  v_max3_f32 v216, v216, v217, v34
  v_mfma_f32_32x32x16_bf16 v[64:79], v[184:187], v[156:159], v[64:79]
  v_mov_b32 v217, v216
  s_nop 1
  v_permlane32_swap_b32 v216, v217
  v_max_f32 v216, v216, v217
  v_cmp_gt_f32 vcc, v216, v41
  s_cbranch_vccz BK_16
  v_sub_f32 v217, v34, v216
  v_mul_f32 v217, s40, v217
  v_exp_f32 v218, v217
  v_mov_b32 v34, v216
  v_mul_f32 v40, s40, v216
  v_add_f32 v41, 0x41c663eb, v216
  v_pk_mul_f32 v[80:81], v[80:81], v[218:219] op_sel_hi:[1,0]
  v_pk_mul_f32 v[82:83], v[82:83], v[218:219] op_sel_hi:[1,0]
  v_pk_mul_f32 v[84:85], v[84:85], v[218:219] op_sel_hi:[1,0]
  v_pk_mul_f32 v[86:87], v[86:87], v[218:219] op_sel_hi:[1,0]
  v_pk_mul_f32 v[88:89], v[88:89], v[218:219] op_sel_hi:[1,0]
  v_pk_mul_f32 v[90:91], v[90:91], v[218:219] op_sel_hi:[1,0]
  v_pk_mul_f32 v[92:93], v[92:93], v[218:219] op_sel_hi:[1,0]
  v_pk_mul_f32 v[94:95], v[94:95], v[218:219] op_sel_hi:[1,0]
BK_16:
  v_mfma_f32_32x32x16_bf16 v[128:143], v[174:177], v[26:29], 0
  v_pk_fma_f32 v[112:113], v[112:113], s[40:41], v[40:41] op_sel_hi:[1,1,0] neg_lo:[0,0,1] neg_hi:[0,0,1]
  v_pk_fma_f32 v[114:115], v[114:115], s[40:41], v[40:41] op_sel_hi:[1,1,0] neg_lo:[0,0,1] neg_hi:[0,0,1]
  v_pk_fma_f32 v[116:117], v[116:117], s[40:41], v[40:41] op_sel_hi:[1,1,0] neg_lo:[0,0,1] neg_hi:[0,0,1]
  v_pk_fma_f32 v[118:119], v[118:119], s[40:41], v[40:41] op_sel_hi:[1,1,0] neg_lo:[0,0,1] neg_hi:[0,0,1]
  v_pk_fma_f32 v[120:121], v[120:121], s[40:41], v[40:41] op_sel_hi:[1,1,0] neg_lo:[0,0,1] neg_hi:[0,0,1]
  v_pk_fma_f32 v[122:123], v[122:123], s[40:41], v[40:41] op_sel_hi:[1,1,0] neg_lo:[0,0,1] neg_hi:[0,0,1]
  v_pk_fma_f32 v[124:125], v[124:125], s[40:41], v[40:41] op_sel_hi:[1,1,0] neg_lo:[0,0,1] neg_hi:[0,0,1]
  v_pk_fma_f32 v[126:127], v[126:127], s[40:41], v[40:41] op_sel_hi:[1,1,0] neg_lo:[0,0,1] neg_hi:[0,0,1]
  v_mfma_f32_32x32x8_bf16 v[128:143], v[178:179], v[30:31], v[128:143]
  v_exp_f32 v112, v112
  v_exp_f32 v113, v113
  v_exp_f32 v114, v114
  v_exp_f32 v115, v115
  v_exp_f32 v116, v116
  v_exp_f32 v117, v117
  v_exp_f32 v118, v118
  v_exp_f32 v119, v119
  v_exp_f32 v120, v120
  v_exp_f32 v121, v121
  v_exp_f32 v122, v122
  v_exp_f32 v123, v123
  v_exp_f32 v124, v124
  v_exp_f32 v125, v125
  v_exp_f32 v126, v126
  v_exp_f32 v127, v127
  v_cvt_pk_bf16_f32 v144, v112, v113
  v_cvt_pk_bf16_f32 v145, v114, v115
  v_cvt_pk_bf16_f32 v146, v116, v117
  v_cvt_pk_bf16_f32 v147, v118, v119
  v_cvt_pk_bf16_f32 v148, v120, v121
  v_cvt_pk_bf16_f32 v149, v122, v123
  v_cvt_pk_bf16_f32 v150, v124, v125
  v_cvt_pk_bf16_f32 v151, v126, v127
  s_waitcnt vmcnt(8)
  v_mfma_f32_32x32x16_bf16 v[80:95], v[180:183], v[144:147], v[80:95]
  v_max3_f32 v216, v128, v129, v130
  v_max3_f32 v217, v131, v132, v133
  v_max3_f32 v216, v216, v134, v135
  v_max3_f32 v217, v217, v136, v137
  v_max3_f32 v216, v216, v138, v139
  v_max3_f32 v217, v217, v140, v141
  v_max3_f32 v216, v216, v142, v143
  v_max3_f32 v216, v216, v217, v35
  v_mfma_f32_32x32x16_bf16 v[80:95], v[184:187], v[148:151], v[80:95]
  v_mov_b32 v217, v216
  s_nop 1
  v_permlane32_swap_b32 v216, v217
  v_max_f32 v216, v216, v217
  v_cmp_gt_f32 vcc, v216, v43
  s_cbranch_vccz BK_17
  v_sub_f32 v217, v35, v216
  v_mul_f32 v217, s40, v217
  v_exp_f32 v218, v217
  v_mov_b32 v35, v216
  v_mul_f32 v42, s40, v216
  v_add_f32 v43, 0x41c663eb, v216
  v_pk_mul_f32 v[96:97], v[96:97], v[218:219] op_sel_hi:[1,0]
  v_pk_mul_f32 v[98:99], v[98:99], v[218:219] op_sel_hi:[1,0]
  v_pk_mul_f32 v[100:101], v[100:101], v[218:219] op_sel_hi:[1,0]
  v_pk_mul_f32 v[102:103], v[102:103], v[218:219] op_sel_hi:[1,0]
  v_pk_mul_f32 v[104:105], v[104:105], v[218:219] op_sel_hi:[1,0]
  v_pk_mul_f32 v[106:107], v[106:107], v[218:219] op_sel_hi:[1,0]
  v_pk_mul_f32 v[108:109], v[108:109], v[218:219] op_sel_hi:[1,0]
  v_pk_mul_f32 v[110:111], v[110:111], v[218:219] op_sel_hi:[1,0]
BK_17:
  v_mfma_f32_32x32x16_bf16 v[112:127], v[188:191], v[8:11], 0
  v_pk_fma_f32 v[128:129], v[128:129], s[40:41], v[42:43] op_sel_hi:[1,1,0] neg_lo:[0,0,1] neg_hi:[0,0,1]
  v_pk_fma_f32 v[130:131], v[130:131], s[40:41], v[42:43] op_sel_hi:[1,1,0] neg_lo:[0,0,1] neg_hi:[0,0,1]
  v_pk_fma_f32 v[132:133], v[132:133], s[40:41], v[42:43] op_sel_hi:[1,1,0] neg_lo:[0,0,1] neg_hi:[0,0,1]
  v_pk_fma_f32 v[134:135], v[134:135], s[40:41], v[42:43] op_sel_hi:[1,1,0] neg_lo:[0,0,1] neg_hi:[0,0,1]
  v_pk_fma_f32 v[136:137], v[136:137], s[40:41], v[42:43] op_sel_hi:[1,1,0] neg_lo:[0,0,1] neg_hi:[0,0,1]
  v_pk_fma_f32 v[138:139], v[138:139], s[40:41], v[42:43] op_sel_hi:[1,1,0] neg_lo:[0,0,1] neg_hi:[0,0,1]
  v_pk_fma_f32 v[140:141], v[140:141], s[40:41], v[42:43] op_sel_hi:[1,1,0] neg_lo:[0,0,1] neg_hi:[0,0,1]
  v_pk_fma_f32 v[142:143], v[142:143], s[40:41], v[42:43] op_sel_hi:[1,1,0] neg_lo:[0,0,1] neg_hi:[0,0,1]
  v_mfma_f32_32x32x8_bf16 v[112:127], v[192:193], v[12:13], v[112:127]
  v_exp_f32 v128, v128
  v_exp_f32 v129, v129
  v_exp_f32 v130, v130
  v_exp_f32 v131, v131
  v_exp_f32 v132, v132
  v_exp_f32 v133, v133
  v_exp_f32 v134, v134
  v_exp_f32 v135, v135
  v_exp_f32 v136, v136
  v_exp_f32 v137, v137
  v_exp_f32 v138, v138
  v_exp_f32 v139, v139
  v_exp_f32 v140, v140
  v_exp_f32 v141, v141
  v_exp_f32 v142, v142
  v_exp_f32 v143, v143
  v_cvt_pk_bf16_f32 v152, v128, v129
  v_cvt_pk_bf16_f32 v153, v130, v131
  v_cvt_pk_bf16_f32 v154, v132, v133
  v_cvt_pk_bf16_f32 v155, v134, v135
  v_cvt_pk_bf16_f32 v156, v136, v137
  v_cvt_pk_bf16_f32 v157, v138, v139
  v_cvt_pk_bf16_f32 v158, v140, v141
  v_cvt_pk_bf16_f32 v159, v142, v143
  v_mfma_f32_32x32x16_bf16 v[96:111], v[180:183], v[152:155], v[96:111]
  v_max3_f32 v216, v112, v113, v114
  v_max3_f32 v217, v115, v116, v117
  v_max3_f32 v216, v216, v118, v119
  v_max3_f32 v217, v217, v120, v121
  v_max3_f32 v216, v216, v122, v123
  v_max3_f32 v217, v217, v124, v125
  v_max3_f32 v216, v216, v126, v127
  v_max3_f32 v216, v216, v217, v32
  v_mfma_f32_32x32x16_bf16 v[96:111], v[184:187], v[156:159], v[96:111]
  v_mov_b32 v217, v216
  s_nop 1
  v_permlane32_swap_b32 v216, v217
  v_max_f32 v216, v216, v217
  v_cmp_gt_f32 vcc, v216, v37
  s_cbranch_vccz BK_18
  v_sub_f32 v217, v32, v216
  v_mul_f32 v217, s40, v217
  v_exp_f32 v218, v217
  v_mov_b32 v32, v216
  v_mul_f32 v36, s40, v216
  v_add_f32 v37, 0x41c663eb, v216
  v_pk_mul_f32 v[48:49], v[48:49], v[218:219] op_sel_hi:[1,0]
  v_pk_mul_f32 v[50:51], v[50:51], v[218:219] op_sel_hi:[1,0]
  v_pk_mul_f32 v[52:53], v[52:53], v[218:219] op_sel_hi:[1,0]
  v_pk_mul_f32 v[54:55], v[54:55], v[218:219] op_sel_hi:[1,0]
  v_pk_mul_f32 v[56:57], v[56:57], v[218:219] op_sel_hi:[1,0]
  v_pk_mul_f32 v[58:59], v[58:59], v[218:219] op_sel_hi:[1,0]
  v_pk_mul_f32 v[60:61], v[60:61], v[218:219] op_sel_hi:[1,0]
  v_pk_mul_f32 v[62:63], v[62:63], v[218:219] op_sel_hi:[1,0]
BK_18:
  v_mfma_f32_32x32x16_bf16 v[128:143], v[188:191], v[14:17], 0
  v_pk_fma_f32 v[112:113], v[112:113], s[40:41], v[36:37] op_sel_hi:[1,1,0] neg_lo:[0,0,1] neg_hi:[0,0,1]
  v_pk_fma_f32 v[114:115], v[114:115], s[40:41], v[36:37] op_sel_hi:[1,1,0] neg_lo:[0,0,1] neg_hi:[0,0,1]
  v_pk_fma_f32 v[116:117], v[116:117], s[40:41], v[36:37] op_sel_hi:[1,1,0] neg_lo:[0,0,1] neg_hi:[0,0,1]
  v_pk_fma_f32 v[118:119], v[118:119], s[40:41], v[36:37] op_sel_hi:[1,1,0] neg_lo:[0,0,1] neg_hi:[0,0,1]
  v_pk_fma_f32 v[120:121], v[120:121], s[40:41], v[36:37] op_sel_hi:[1,1,0] neg_lo:[0,0,1] neg_hi:[0,0,1]
  v_pk_fma_f32 v[122:123], v[122:123], s[40:41], v[36:37] op_sel_hi:[1,1,0] neg_lo:[0,0,1] neg_hi:[0,0,1]
  v_pk_fma_f32 v[124:125], v[124:125], s[40:41], v[36:37] op_sel_hi:[1,1,0] neg_lo:[0,0,1] neg_hi:[0,0,1]
  v_pk_fma_f32 v[126:127], v[126:127], s[40:41], v[36:37] op_sel_hi:[1,1,0] neg_lo:[0,0,1] neg_hi:[0,0,1]
  v_mfma_f32_32x32x8_bf16 v[128:143], v[192:193], v[18:19], v[128:143]
  v_exp_f32 v112, v112
  v_exp_f32 v113, v113
  v_exp_f32 v114, v114
  v_exp_f32 v115, v115
  v_exp_f32 v116, v116
  v_exp_f32 v117, v117
  v_exp_f32 v118, v118
  v_exp_f32 v119, v119
  v_exp_f32 v120, v120
  v_exp_f32 v121, v121
  v_exp_f32 v122, v122
  v_exp_f32 v123, v123
  v_exp_f32 v124, v124
  v_exp_f32 v125, v125
  v_exp_f32 v126, v126
  v_exp_f32 v127, v127
  v_cvt_pk_bf16_f32 v144, v112, v113
  v_cvt_pk_bf16_f32 v145, v114, v115
  v_cvt_pk_bf16_f32 v146, v116, v117
  v_cvt_pk_bf16_f32 v147, v118, v119
  v_cvt_pk_bf16_f32 v148, v120, v121
  v_cvt_pk_bf16_f32 v149, v122, v123
  v_cvt_pk_bf16_f32 v150, v124, v125
  v_cvt_pk_bf16_f32 v151, v126, v127
  v_mfma_f32_32x32x16_bf16 v[48:63], v[194:197], v[144:147], v[48:63]
  v_max3_f32 v216, v128, v129, v130
  v_max3_f32 v217, v131, v132, v133
  v_max3_f32 v216, v216, v134, v135
  v_max3_f32 v217, v217, v136, v137
  v_max3_f32 v216, v216, v138, v139
  v_max3_f32 v217, v217, v140, v141
  v_max3_f32 v216, v216, v142, v143
  v_max3_f32 v216, v216, v217, v33
  v_mfma_f32_32x32x16_bf16 v[48:63], v[198:201], v[148:151], v[48:63]
  v_mov_b32 v217, v216
  s_nop 1
  v_permlane32_swap_b32 v216, v217
  v_max_f32 v216, v216, v217
  v_cmp_gt_f32 vcc, v216, v39
  s_cbranch_vccz BK_19
  v_sub_f32 v217, v33, v216
  v_mul_f32 v217, s40, v217
  v_exp_f32 v218, v217
  v_mov_b32 v33, v216
  v_mul_f32 v38, s40, v216
  v_add_f32 v39, 0x41c663eb, v216
  v_pk_mul_f32 v[64:65], v[64:65], v[218:219] op_sel_hi:[1,0]
  v_pk_mul_f32 v[66:67], v[66:67], v[218:219] op_sel_hi:[1,0]
  v_pk_mul_f32 v[68:69], v[68:69], v[218:219] op_sel_hi:[1,0]
  v_pk_mul_f32 v[70:71], v[70:71], v[218:219] op_sel_hi:[1,0]
  v_pk_mul_f32 v[72:73], v[72:73], v[218:219] op_sel_hi:[1,0]
  v_pk_mul_f32 v[74:75], v[74:75], v[218:219] op_sel_hi:[1,0]
  v_pk_mul_f32 v[76:77], v[76:77], v[218:219] op_sel_hi:[1,0]
  v_pk_mul_f32 v[78:79], v[78:79], v[218:219] op_sel_hi:[1,0]
BK_19:
  v_mfma_f32_32x32x16_bf16 v[112:127], v[188:191], v[20:23], 0
  v_pk_fma_f32 v[128:129], v[128:129], s[40:41], v[38:39] op_sel_hi:[1,1,0] neg_lo:[0,0,1] neg_hi:[0,0,1]
  v_pk_fma_f32 v[130:131], v[130:131], s[40:41], v[38:39] op_sel_hi:[1,1,0] neg_lo:[0,0,1] neg_hi:[0,0,1]
  v_pk_fma_f32 v[132:133], v[132:133], s[40:41], v[38:39] op_sel_hi:[1,1,0] neg_lo:[0,0,1] neg_hi:[0,0,1]
  v_pk_fma_f32 v[134:135], v[134:135], s[40:41], v[38:39] op_sel_hi:[1,1,0] neg_lo:[0,0,1] neg_hi:[0,0,1]
  v_pk_fma_f32 v[136:137], v[136:137], s[40:41], v[38:39] op_sel_hi:[1,1,0] neg_lo:[0,0,1] neg_hi:[0,0,1]
  v_pk_fma_f32 v[138:139], v[138:139], s[40:41], v[38:39] op_sel_hi:[1,1,0] neg_lo:[0,0,1] neg_hi:[0,0,1]
  v_pk_fma_f32 v[140:141], v[140:141], s[40:41], v[38:39] op_sel_hi:[1,1,0] neg_lo:[0,0,1] neg_hi:[0,0,1]
  v_pk_fma_f32 v[142:143], v[142:143], s[40:41], v[38:39] op_sel_hi:[1,1,0] neg_lo:[0,0,1] neg_hi:[0,0,1]
  v_mfma_f32_32x32x8_bf16 v[112:127], v[192:193], v[24:25], v[112:127]
  buffer_load_dwordx4 v[174:177], v2, s[4:7], s42 offen
  buffer_load_dwordx2 v[178:179], v3, s[4:7], s42 offen
  s_mov_b64 exec, s[44:45]
  buffer_load_dwordx4 v[180:183], v4, s[4:7], s43 offen
  buffer_load_dwordx4 v[184:187], v4, s[4:7], s43 offen offset:640
  s_mov_b64 exec, -1
  s_add_u32 s42, s42, 1280
  s_add_u32 s43, s43, 1280
  v_exp_f32 v128, v128
  v_exp_f32 v129, v129
  v_exp_f32 v130, v130
  v_exp_f32 v131, v131
  v_exp_f32 v132, v132
  v_exp_f32 v133, v133
  v_exp_f32 v134, v134
  v_exp_f32 v135, v135
  v_exp_f32 v136, v136
  v_exp_f32 v137, v137
  v_exp_f32 v138, v138
  v_exp_f32 v139, v139
  v_exp_f32 v140, v140
  v_exp_f32 v141, v141
  v_exp_f32 v142, v142
  v_exp_f32 v143, v143
  v_cvt_pk_bf16_f32 v152, v128, v129
  v_cvt_pk_bf16_f32 v153, v130, v131
  v_cvt_pk_bf16_f32 v154, v132, v133
  v_cvt_pk_bf16_f32 v155, v134, v135
  v_cvt_pk_bf16_f32 v156, v136, v137
  v_cvt_pk_bf16_f32 v157, v138, v139
  v_cvt_pk_bf16_f32 v158, v140, v141
  v_cvt_pk_bf16_f32 v159, v142, v143
  v_mfma_f32_32x32x16_bf16 v[64:79], v[194:197], v[152:155], v[64:79]
  v_max3_f32 v216, v112, v113, v114
  v_max3_f32 v217, v115, v116, v117
  v_max3_f32 v216, v216, v118, v119
  v_max3_f32 v217, v217, v120, v121
  v_max3_f32 v216, v216, v122, v123
  v_max3_f32 v217, v217, v124, v125
  v_max3_f32 v216, v216, v126, v127
  v_max3_f32 v216, v216, v217, v34
  v_mfma_f32_32x32x16_bf16 v[64:79], v[198:201], v[156:159], v[64:79]
  v_mov_b32 v217, v216
  s_nop 1
  v_permlane32_swap_b32 v216, v217
  v_max_f32 v216, v216, v217
  v_cmp_gt_f32 vcc, v216, v41
  s_cbranch_vccz BK_20
  v_sub_f32 v217, v34, v216
  v_mul_f32 v217, s40, v217
  v_exp_f32 v218, v217
  v_mov_b32 v34, v216
  v_mul_f32 v40, s40, v216
  v_add_f32 v41, 0x41c663eb, v216
  v_pk_mul_f32 v[80:81], v[80:81], v[218:219] op_sel_hi:[1,0]
  v_pk_mul_f32 v[82:83], v[82:83], v[218:219] op_sel_hi:[1,0]
  v_pk_mul_f32 v[84:85], v[84:85], v[218:219] op_sel_hi:[1,0]
  v_pk_mul_f32 v[86:87], v[86:87], v[218:219] op_sel_hi:[1,0]
  v_pk_mul_f32 v[88:89], v[88:89], v[218:219] op_sel_hi:[1,0]
  v_pk_mul_f32 v[90:91], v[90:91], v[218:219] op_sel_hi:[1,0]
  v_pk_mul_f32 v[92:93], v[92:93], v[218:219] op_sel_hi:[1,0]
  v_pk_mul_f32 v[94:95], v[94:95], v[218:219] op_sel_hi:[1,0]
BK_20:
  v_mfma_f32_32x32x16_bf16 v[128:143], v[188:191], v[26:29], 0
  v_pk_fma_f32 v[112:113], v[112:113], s[40:41], v[40:41] op_sel_hi:[1,1,0] neg_lo:[0,0,1] neg_hi:[0,0,1]
  v_pk_fma_f32 v[114:115], v[114:115], s[40:41], v[40:41] op_sel_hi:[1,1,0] neg_lo:[0,0,1] neg_hi:[0,0,1]
  v_pk_fma_f32 v[116:117], v[116:117], s[40:41], v[40:41] op_sel_hi:[1,1,0] neg_lo:[0,0,1] neg_hi:[0,0,1]
  v_pk_fma_f32 v[118:119], v[118:119], s[40:41], v[40:41] op_sel_hi:[1,1,0] neg_lo:[0,0,1] neg_hi:[0,0,1]
  v_pk_fma_f32 v[120:121], v[120:121], s[40:41], v[40:41] op_sel_hi:[1,1,0] neg_lo:[0,0,1] neg_hi:[0,0,1]
  v_pk_fma_f32 v[122:123], v[122:123], s[40:41], v[40:41] op_sel_hi:[1,1,0] neg_lo:[0,0,1] neg_hi:[0,0,1]
  v_pk_fma_f32 v[124:125], v[124:125], s[40:41], v[40:41] op_sel_hi:[1,1,0] neg_lo:[0,0,1] neg_hi:[0,0,1]
  v_pk_fma_f32 v[126:127], v[126:127], s[40:41], v[40:41] op_sel_hi:[1,1,0] neg_lo:[0,0,1] neg_hi:[0,0,1]
  v_mfma_f32_32x32x8_bf16 v[128:143], v[192:193], v[30:31], v[128:143]
  v_exp_f32 v112, v112
  v_exp_f32 v113, v113
  v_exp_f32 v114, v114
  v_exp_f32 v115, v115
  v_exp_f32 v116, v116
  v_exp_f32 v117, v117
  v_exp_f32 v118, v118
  v_exp_f32 v119, v119
  v_exp_f32 v120, v120
  v_exp_f32 v121, v121
  v_exp_f32 v122, v122
  v_exp_f32 v123, v123
  v_exp_f32 v124, v124
  v_exp_f32 v125, v125
  v_exp_f32 v126, v126
  v_exp_f32 v127, v127
  v_cvt_pk_bf16_f32 v144, v112, v113
  v_cvt_pk_bf16_f32 v145, v114, v115
  v_cvt_pk_bf16_f32 v146, v116, v117
  v_cvt_pk_bf16_f32 v147, v118, v119
  v_cvt_pk_bf16_f32 v148, v120, v121
  v_cvt_pk_bf16_f32 v149, v122, v123
  v_cvt_pk_bf16_f32 v150, v124, v125
  v_cvt_pk_bf16_f32 v151, v126, v127
  s_waitcnt vmcnt(8)
  v_mfma_f32_32x32x16_bf16 v[80:95], v[194:197], v[144:147], v[80:95]
  v_max3_f32 v216, v128, v129, v130
  v_max3_f32 v217, v131, v132, v133
  v_max3_f32 v216, v216, v134, v135
  v_max3_f32 v217, v217, v136, v137
  v_max3_f32 v216, v216, v138, v139
  v_max3_f32 v217, v217, v140, v141
  v_max3_f32 v216, v216, v142, v143
  v_max3_f32 v216, v216, v217, v35
  v_mfma_f32_32x32x16_bf16 v[80:95], v[198:201], v[148:151], v[80:95]
  v_mov_b32 v217, v216
  s_nop 1
  v_permlane32_swap_b32 v216, v217
  v_max_f32 v216, v216, v217
  v_cmp_gt_f32 vcc, v216, v43
  s_cbranch_vccz BK_21
  v_sub_f32 v217, v35, v216
  v_mul_f32 v217, s40, v217
  v_exp_f32 v218, v217
  v_mov_b32 v35, v216
  v_mul_f32 v42, s40, v216
  v_add_f32 v43, 0x41c663eb, v216
  v_pk_mul_f32 v[96:97], v[96:97], v[218:219] op_sel_hi:[1,0]
  v_pk_mul_f32 v[98:99], v[98:99], v[218:219] op_sel_hi:[1,0]
  v_pk_mul_f32 v[100:101], v[100:101], v[218:219] op_sel_hi:[1,0]
  v_pk_mul_f32 v[102:103], v[102:103], v[218:219] op_sel_hi:[1,0]
  v_pk_mul_f32 v[104:105], v[104:105], v[218:219] op_sel_hi:[1,0]
  v_pk_mul_f32 v[106:107], v[106:107], v[218:219] op_sel_hi:[1,0]
  v_pk_mul_f32 v[108:109], v[108:109], v[218:219] op_sel_hi:[1,0]
  v_pk_mul_f32 v[110:111], v[110:111], v[218:219] op_sel_hi:[1,0]
BK_21:
  v_mfma_f32_32x32x16_bf16 v[112:127], v[202:205], v[8:11], 0
  v_pk_fma_f32 v[128:129], v[128:129], s[40:41], v[42:43] op_sel_hi:[1,1,0] neg_lo:[0,0,1] neg_hi:[0,0,1]
  v_pk_fma_f32 v[130:131], v[130:131], s[40:41], v[42:43] op_sel_hi:[1,1,0] neg_lo:[0,0,1] neg_hi:[0,0,1]
  v_pk_fma_f32 v[132:133], v[132:133], s[40:41], v[42:43] op_sel_hi:[1,1,0] neg_lo:[0,0,1] neg_hi:[0,0,1]
  v_pk_fma_f32 v[134:135], v[134:135], s[40:41], v[42:43] op_sel_hi:[1,1,0] neg_lo:[0,0,1] neg_hi:[0,0,1]
  v_pk_fma_f32 v[136:137], v[136:137], s[40:41], v[42:43] op_sel_hi:[1,1,0] neg_lo:[0,0,1] neg_hi:[0,0,1]
  v_pk_fma_f32 v[138:139], v[138:139], s[40:41], v[42:43] op_sel_hi:[1,1,0] neg_lo:[0,0,1] neg_hi:[0,0,1]
  v_pk_fma_f32 v[140:141], v[140:141], s[40:41], v[42:43] op_sel_hi:[1,1,0] neg_lo:[0,0,1] neg_hi:[0,0,1]
  v_pk_fma_f32 v[142:143], v[142:143], s[40:41], v[42:43] op_sel_hi:[1,1,0] neg_lo:[0,0,1] neg_hi:[0,0,1]
  v_mfma_f32_32x32x8_bf16 v[112:127], v[206:207], v[12:13], v[112:127]
  v_exp_f32 v128, v128
  v_exp_f32 v129, v129
  v_exp_f32 v130, v130
  v_exp_f32 v131, v131
  v_exp_f32 v132, v132
  v_exp_f32 v133, v133
  v_exp_f32 v134, v134
  v_exp_f32 v135, v135
  v_exp_f32 v136, v136
  v_exp_f32 v137, v137
  v_exp_f32 v138, v138
  v_exp_f32 v139, v139
  v_exp_f32 v140, v140
  v_exp_f32 v141, v141
  v_exp_f32 v142, v142
  v_exp_f32 v143, v143
  v_cvt_pk_bf16_f32 v152, v128, v129
  v_cvt_pk_bf16_f32 v153, v130, v131
  v_cvt_pk_bf16_f32 v154, v132, v133
  v_cvt_pk_bf16_f32 v155, v134, v135
  v_cvt_pk_bf16_f32 v156, v136, v137
  v_cvt_pk_bf16_f32 v157, v138, v139
  v_cvt_pk_bf16_f32 v158, v140, v141
  v_cvt_pk_bf16_f32 v159, v142, v143
  v_mfma_f32_32x32x16_bf16 v[96:111], v[194:197], v[152:155], v[96:111]
  v_max3_f32 v216, v112, v113, v114
  v_max3_f32 v217, v115, v116, v117
  v_max3_f32 v216, v216, v118, v119
  v_max3_f32 v217, v217, v120, v121
  v_max3_f32 v216, v216, v122, v123
  v_max3_f32 v217, v217, v124, v125
  v_max3_f32 v216, v216, v126, v127
  v_max3_f32 v216, v216, v217, v32
  v_mfma_f32_32x32x16_bf16 v[96:111], v[198:201], v[156:159], v[96:111]
  v_mov_b32 v217, v216
  s_nop 1
  v_permlane32_swap_b32 v216, v217
  v_max_f32 v216, v216, v217
  v_cmp_gt_f32 vcc, v216, v37
  s_cbranch_vccz BK_22
  v_sub_f32 v217, v32, v216
  v_mul_f32 v217, s40, v217
  v_exp_f32 v218, v217
  v_mov_b32 v32, v216
  v_mul_f32 v36, s40, v216
  v_add_f32 v37, 0x41c663eb, v216
  v_pk_mul_f32 v[48:49], v[48:49], v[218:219] op_sel_hi:[1,0]
  v_pk_mul_f32 v[50:51], v[50:51], v[218:219] op_sel_hi:[1,0]
  v_pk_mul_f32 v[52:53], v[52:53], v[218:219] op_sel_hi:[1,0]
  v_pk_mul_f32 v[54:55], v[54:55], v[218:219] op_sel_hi:[1,0]
  v_pk_mul_f32 v[56:57], v[56:57], v[218:219] op_sel_hi:[1,0]
  v_pk_mul_f32 v[58:59], v[58:59], v[218:219] op_sel_hi:[1,0]
  v_pk_mul_f32 v[60:61], v[60:61], v[218:219] op_sel_hi:[1,0]
  v_pk_mul_f32 v[62:63], v[62:63], v[218:219] op_sel_hi:[1,0]
BK_22:
  v_mfma_f32_32x32x16_bf16 v[128:143], v[202:205], v[14:17], 0
  v_pk_fma_f32 v[112:113], v[112:113], s[40:41], v[36:37] op_sel_hi:[1,1,0] neg_lo:[0,0,1] neg_hi:[0,0,1]
  v_pk_fma_f32 v[114:115], v[114:115], s[40:41], v[36:37] op_sel_hi:[1,1,0] neg_lo:[0,0,1] neg_hi:[0,0,1]
  v_pk_fma_f32 v[116:117], v[116:117], s[40:41], v[36:37] op_sel_hi:[1,1,0] neg_lo:[0,0,1] neg_hi:[0,0,1]
  v_pk_fma_f32 v[118:119], v[118:119], s[40:41], v[36:37] op_sel_hi:[1,1,0] neg_lo:[0,0,1] neg_hi:[0,0,1]
  v_pk_fma_f32 v[120:121], v[120:121], s[40:41], v[36:37] op_sel_hi:[1,1,0] neg_lo:[0,0,1] neg_hi:[0,0,1]
  v_pk_fma_f32 v[122:123], v[122:123], s[40:41], v[36:37] op_sel_hi:[1,1,0] neg_lo:[0,0,1] neg_hi:[0,0,1]
  v_pk_fma_f32 v[124:125], v[124:125], s[40:41], v[36:37] op_sel_hi:[1,1,0] neg_lo:[0,0,1] neg_hi:[0,0,1]
  v_pk_fma_f32 v[126:127], v[126:127], s[40:41], v[36:37] op_sel_hi:[1,1,0] neg_lo:[0,0,1] neg_hi:[0,0,1]
  v_mfma_f32_32x32x8_bf16 v[128:143], v[206:207], v[18:19], v[128:143]
  v_exp_f32 v112, v112
  v_exp_f32 v113, v113
  v_exp_f32 v114, v114
  v_exp_f32 v115, v115
  v_exp_f32 v116, v116
  v_exp_f32 v117, v117
  v_exp_f32 v118, v118
  v_exp_f32 v119, v119
  v_exp_f32 v120, v120
  v_exp_f32 v121, v121
  v_exp_f32 v122, v122
  v_exp_f32 v123, v123
  v_exp_f32 v124, v124
  v_exp_f32 v125, v125
  v_exp_f32 v126, v126
  v_exp_f32 v127, v127
  v_cvt_pk_bf16_f32 v144, v112, v113
  v_cvt_pk_bf16_f32 v145, v114, v115
  v_cvt_pk_bf16_f32 v146, v116, v117
  v_cvt_pk_bf16_f32 v147, v118, v119
  v_cvt_pk_bf16_f32 v148, v120, v121
  v_cvt_pk_bf16_f32 v149, v122, v123
  v_cvt_pk_bf16_f32 v150, v124, v125
  v_cvt_pk_bf16_f32 v151, v126, v127
  v_mfma_f32_32x32x16_bf16 v[48:63], v[208:211], v[144:147], v[48:63]
  v_max3_f32 v216, v128, v129, v130
  v_max3_f32 v217, v131, v132, v133
  v_max3_f32 v216, v216, v134, v135
  v_max3_f32 v217, v217, v136, v137
  v_max3_f32 v216, v216, v138, v139
  v_max3_f32 v217, v217, v140, v141
  v_max3_f32 v216, v216, v142, v143
  v_max3_f32 v216, v216, v217, v33
  v_mfma_f32_32x32x16_bf16 v[48:63], v[212:215], v[148:151], v[48:63]
  v_mov_b32 v217, v216
  s_nop 1
  v_permlane32_swap_b32 v216, v217
  v_max_f32 v216, v216, v217
  v_cmp_gt_f32 vcc, v216, v39
  s_cbranch_vccz BK_23
  v_sub_f32 v217, v33, v216
  v_mul_f32 v217, s40, v217
  v_exp_f32 v218, v217
  v_mov_b32 v33, v216
  v_mul_f32 v38, s40, v216
  v_add_f32 v39, 0x41c663eb, v216
  v_pk_mul_f32 v[64:65], v[64:65], v[218:219] op_sel_hi:[1,0]
  v_pk_mul_f32 v[66:67], v[66:67], v[218:219] op_sel_hi:[1,0]
  v_pk_mul_f32 v[68:69], v[68:69], v[218:219] op_sel_hi:[1,0]
  v_pk_mul_f32 v[70:71], v[70:71], v[218:219] op_sel_hi:[1,0]
  v_pk_mul_f32 v[72:73], v[72:73], v[218:219] op_sel_hi:[1,0]
  v_pk_mul_f32 v[74:75], v[74:75], v[218:219] op_sel_hi:[1,0]
  v_pk_mul_f32 v[76:77], v[76:77], v[218:219] op_sel_hi:[1,0]
  v_pk_mul_f32 v[78:79], v[78:79], v[218:219] op_sel_hi:[1,0]
BK_23:
  v_mfma_f32_32x32x16_bf16 v[112:127], v[202:205], v[20:23], 0
  v_pk_fma_f32 v[128:129], v[128:129], s[40:41], v[38:39] op_sel_hi:[1,1,0] neg_lo:[0,0,1] neg_hi:[0,0,1]
  v_pk_fma_f32 v[130:131], v[130:131], s[40:41], v[38:39] op_sel_hi:[1,1,0] neg_lo:[0,0,1] neg_hi:[0,0,1]
  v_pk_fma_f32 v[132:133], v[132:133], s[40:41], v[38:39] op_sel_hi:[1,1,0] neg_lo:[0,0,1] neg_hi:[0,0,1]
  v_pk_fma_f32 v[134:135], v[134:135], s[40:41], v[38:39] op_sel_hi:[1,1,0] neg_lo:[0,0,1] neg_hi:[0,0,1]
  v_pk_fma_f32 v[136:137], v[136:137], s[40:41], v[38:39] op_sel_hi:[1,1,0] neg_lo:[0,0,1] neg_hi:[0,0,1]
  v_pk_fma_f32 v[138:139], v[138:139], s[40:41], v[38:39] op_sel_hi:[1,1,0] neg_lo:[0,0,1] neg_hi:[0,0,1]
  v_pk_fma_f32 v[140:141], v[140:141], s[40:41], v[38:39] op_sel_hi:[1,1,0] neg_lo:[0,0,1] neg_hi:[0,0,1]
  v_pk_fma_f32 v[142:143], v[142:143], s[40:41], v[38:39] op_sel_hi:[1,1,0] neg_lo:[0,0,1] neg_hi:[0,0,1]
  v_mfma_f32_32x32x8_bf16 v[112:127], v[206:207], v[24:25], v[112:127]
  buffer_load_dwordx4 v[188:191], v2, s[4:7], s42 offen
  buffer_load_dwordx2 v[192:193], v3, s[4:7], s42 offen
  s_mov_b64 exec, s[44:45]
  buffer_load_dwordx4 v[194:197], v4, s[4:7], s43 offen
  buffer_load_dwordx4 v[198:201], v4, s[4:7], s43 offen offset:640
  s_mov_b64 exec, -1
  s_add_u32 s42, s42, 1280
  s_add_u32 s43, s43, 1280
  v_exp_f32 v128, v128
  v_exp_f32 v129, v129
  v_exp_f32 v130, v130
  v_exp_f32 v131, v131
  v_exp_f32 v132, v132
  v_exp_f32 v133, v133
  v_exp_f32 v134, v134
  v_exp_f32 v135, v135
  v_exp_f32 v136, v136
  v_exp_f32 v137, v137
  v_exp_f32 v138, v138
  v_exp_f32 v139, v139
  v_exp_f32 v140, v140
  v_exp_f32 v141, v141
  v_exp_f32 v142, v142
  v_exp_f32 v143, v143
  v_cvt_pk_bf16_f32 v152, v128, v129
  v_cvt_pk_bf16_f32 v153, v130, v131
  v_cvt_pk_bf16_f32 v154, v132, v133
  v_cvt_pk_bf16_f32 v155, v134, v135
  v_cvt_pk_bf16_f32 v156, v136, v137
  v_cvt_pk_bf16_f32 v157, v138, v139
  v_cvt_pk_bf16_f32 v158, v140, v141
  v_cvt_pk_bf16_f32 v159, v142, v143
  v_mfma_f32_32x32x16_bf16 v[64:79], v[208:211], v[152:155], v[64:79]
  v_max3_f32 v216, v112, v113, v114
  v_max3_f32 v217, v115, v116, v117
  v_max3_f32 v216, v216, v118, v119
  v_max3_f32 v217, v217, v120, v121
  v_max3_f32 v216, v216, v122, v123
  v_max3_f32 v217, v217, v124, v125
  v_max3_f32 v216, v216, v126, v127
  v_max3_f32 v216, v216, v217, v34
  v_mfma_f32_32x32x16_bf16 v[64:79], v[212:215], v[156:159], v[64:79]
  v_mov_b32 v217, v216
  s_nop 1
  v_permlane32_swap_b32 v216, v217
  v_max_f32 v216, v216, v217
  v_cmp_gt_f32 vcc, v216, v41
  s_cbranch_vccz BK_24
  v_sub_f32 v217, v34, v216
  v_mul_f32 v217, s40, v217
  v_exp_f32 v218, v217
  v_mov_b32 v34, v216
  v_mul_f32 v40, s40, v216
  v_add_f32 v41, 0x41c663eb, v216
  v_pk_mul_f32 v[80:81], v[80:81], v[218:219] op_sel_hi:[1,0]
  v_pk_mul_f32 v[82:83], v[82:83], v[218:219] op_sel_hi:[1,0]
  v_pk_mul_f32 v[84:85], v[84:85], v[218:219] op_sel_hi:[1,0]
  v_pk_mul_f32 v[86:87], v[86:87], v[218:219] op_sel_hi:[1,0]
  v_pk_mul_f32 v[88:89], v[88:89], v[218:219] op_sel_hi:[1,0]
  v_pk_mul_f32 v[90:91], v[90:91], v[218:219] op_sel_hi:[1,0]
  v_pk_mul_f32 v[92:93], v[92:93], v[218:219] op_sel_hi:[1,0]
  v_pk_mul_f32 v[94:95], v[94:95], v[218:219] op_sel_hi:[1,0]
BK_24:
  v_mfma_f32_32x32x16_bf16 v[128:143], v[202:205], v[26:29], 0
  v_pk_fma_f32 v[112:113], v[112:113], s[40:41], v[40:41] op_sel_hi:[1,1,0] neg_lo:[0,0,1] neg_hi:[0,0,1]
  v_pk_fma_f32 v[114:115], v[114:115], s[40:41], v[40:41] op_sel_hi:[1,1,0] neg_lo:[0,0,1] neg_hi:[0,0,1]
  v_pk_fma_f32 v[116:117], v[116:117], s[40:41], v[40:41] op_sel_hi:[1,1,0] neg_lo:[0,0,1] neg_hi:[0,0,1]
  v_pk_fma_f32 v[118:119], v[118:119], s[40:41], v[40:41] op_sel_hi:[1,1,0] neg_lo:[0,0,1] neg_hi:[0,0,1]
  v_pk_fma_f32 v[120:121], v[120:121], s[40:41], v[40:41] op_sel_hi:[1,1,0] neg_lo:[0,0,1] neg_hi:[0,0,1]
  v_pk_fma_f32 v[122:123], v[122:123], s[40:41], v[40:41] op_sel_hi:[1,1,0] neg_lo:[0,0,1] neg_hi:[0,0,1]
  v_pk_fma_f32 v[124:125], v[124:125], s[40:41], v[40:41] op_sel_hi:[1,1,0] neg_lo:[0,0,1] neg_hi:[0,0,1]
  v_pk_fma_f32 v[126:127], v[126:127], s[40:41], v[40:41] op_sel_hi:[1,1,0] neg_lo:[0,0,1] neg_hi:[0,0,1]
  v_mfma_f32_32x32x8_bf16 v[128:143], v[206:207], v[30:31], v[128:143]
  v_exp_f32 v112, v112
  v_exp_f32 v113, v113
  v_exp_f32 v114, v114
  v_exp_f32 v115, v115
  v_exp_f32 v116, v116
  v_exp_f32 v117, v117
  v_exp_f32 v118, v118
  v_exp_f32 v119, v119
  v_exp_f32 v120, v120
  v_exp_f32 v121, v121
  v_exp_f32 v122, v122
  v_exp_f32 v123, v123
  v_exp_f32 v124, v124
  v_exp_f32 v125, v125
  v_exp_f32 v126, v126
  v_exp_f32 v127, v127
  v_cvt_pk_bf16_f32 v144, v112, v113
  v_cvt_pk_bf16_f32 v145, v114, v115
  v_cvt_pk_bf16_f32 v146, v116, v117
  v_cvt_pk_bf16_f32 v147, v118, v119
  v_cvt_pk_bf16_f32 v148, v120, v121
  v_cvt_pk_bf16_f32 v149, v122, v123
  v_cvt_pk_bf16_f32 v150, v124, v125
  v_cvt_pk_bf16_f32 v151, v126, v127
  s_waitcnt vmcnt(8)
  v_mfma_f32_32x32x16_bf16 v[80:95], v[208:211], v[144:147], v[80:95]
  v_max3_f32 v216, v128, v129, v130
  v_max3_f32 v217, v131, v132, v133
  v_max3_f32 v216, v216, v134, v135
  v_max3_f32 v217, v217, v136, v137
  v_max3_f32 v216, v216, v138, v139
  v_max3_f32 v217, v217, v140, v141
  v_max3_f32 v216, v216, v142, v143
  v_max3_f32 v216, v216, v217, v35
  v_mfma_f32_32x32x16_bf16 v[80:95], v[212:215], v[148:151], v[80:95]
  v_mov_b32 v217, v216
  s_nop 1
  v_permlane32_swap_b32 v216, v217
  v_max_f32 v216, v216, v217
  v_cmp_gt_f32 vcc, v216, v43
  s_cbranch_vccz BK_25
  v_sub_f32 v217, v35, v216
  v_mul_f32 v217, s40, v217
  v_exp_f32 v218, v217
  v_mov_b32 v35, v216
  v_mul_f32 v42, s40, v216
  v_add_f32 v43, 0x41c663eb, v216
  v_pk_mul_f32 v[96:97], v[96:97], v[218:219] op_sel_hi:[1,0]
  v_pk_mul_f32 v[98:99], v[98:99], v[218:219] op_sel_hi:[1,0]
  v_pk_mul_f32 v[100:101], v[100:101], v[218:219] op_sel_hi:[1,0]
  v_pk_mul_f32 v[102:103], v[102:103], v[218:219] op_sel_hi:[1,0]
  v_pk_mul_f32 v[104:105], v[104:105], v[218:219] op_sel_hi:[1,0]
  v_pk_mul_f32 v[106:107], v[106:107], v[218:219] op_sel_hi:[1,0]
  v_pk_mul_f32 v[108:109], v[108:109], v[218:219] op_sel_hi:[1,0]
  v_pk_mul_f32 v[110:111], v[110:111], v[218:219] op_sel_hi:[1,0]
BK_25:
  v_mfma_f32_32x32x16_bf16 v[112:127], v[160:163], v[8:11], 0
  v_pk_fma_f32 v[128:129], v[128:129], s[40:41], v[42:43] op_sel_hi:[1,1,0] neg_lo:[0,0,1] neg_hi:[0,0,1]
  v_pk_fma_f32 v[130:131], v[130:131], s[40:41], v[42:43] op_sel_hi:[1,1,0] neg_lo:[0,0,1] neg_hi:[0,0,1]
  v_pk_fma_f32 v[132:133], v[132:133], s[40:41], v[42:43] op_sel_hi:[1,1,0] neg_lo:[0,0,1] neg_hi:[0,0,1]
  v_pk_fma_f32 v[134:135], v[134:135], s[40:41], v[42:43] op_sel_hi:[1,1,0] neg_lo:[0,0,1] neg_hi:[0,0,1]
  v_pk_fma_f32 v[136:137], v[136:137], s[40:41], v[42:43] op_sel_hi:[1,1,0] neg_lo:[0,0,1] neg_hi:[0,0,1]
  v_pk_fma_f32 v[138:139], v[138:139], s[40:41], v[42:43] op_sel_hi:[1,1,0] neg_lo:[0,0,1] neg_hi:[0,0,1]
  v_pk_fma_f32 v[140:141], v[140:141], s[40:41], v[42:43] op_sel_hi:[1,1,0] neg_lo:[0,0,1] neg_hi:[0,0,1]
  v_pk_fma_f32 v[142:143], v[142:143], s[40:41], v[42:43] op_sel_hi:[1,1,0] neg_lo:[0,0,1] neg_hi:[0,0,1]
  v_mfma_f32_32x32x8_bf16 v[112:127], v[164:165], v[12:13], v[112:127]
  v_exp_f32 v128, v128
  v_exp_f32 v129, v129
  v_exp_f32 v130, v130
  v_exp_f32 v131, v131
  v_exp_f32 v132, v132
  v_exp_f32 v133, v133
  v_exp_f32 v134, v134
  v_exp_f32 v135, v135
  v_exp_f32 v136, v136
  v_exp_f32 v137, v137
  v_exp_f32 v138, v138
  v_exp_f32 v139, v139
  v_exp_f32 v140, v140
  v_exp_f32 v141, v141
  v_exp_f32 v142, v142
  v_exp_f32 v143, v143
  v_cvt_pk_bf16_f32 v152, v128, v129
  v_cvt_pk_bf16_f32 v153, v130, v131
  v_cvt_pk_bf16_f32 v154, v132, v133
  v_cvt_pk_bf16_f32 v155, v134, v135
  v_cvt_pk_bf16_f32 v156, v136, v137
  v_cvt_pk_bf16_f32 v157, v138, v139
  v_cvt_pk_bf16_f32 v158, v140, v141
  v_cvt_pk_bf16_f32 v159, v142, v143
  s_sub_u32 s50, s50, 1
  s_cmp_lg_u32 s50, 0
  s_cbranch_scc1 BA_9_loop
  s_nop 1
  v_mfma_f32_32x32x16_bf16 v[96:111], v[208:211], v[152:155], v[96:111]
  v_mfma_f32_32x32x16_bf16 v[96:111], v[212:215], v[156:159], v[96:111]
  s_waitcnt vmcnt(0)
  s_nop 7
  s_nop 7
  s_mul_i32 s48, s47, 40960
  s_mul_i32 s49, s58, 40
  s_add_u32 s48, s48, s49
  s_add_u32 s48, s48, 124780544
  v_rcp_f32 v216, v60
  s_nop 0
  v_pk_mul_f32 v[48:49], v[48:49], v[216:217] op_sel_hi:[1,0]
  v_pk_mul_f32 v[50:51], v[50:51], v[216:217] op_sel_hi:[1,0]
  v_pk_mul_f32 v[52:53], v[52:53], v[216:217] op_sel_hi:[1,0]
  v_pk_mul_f32 v[54:55], v[54:55], v[216:217] op_sel_hi:[1,0]
  v_pk_mul_f32 v[56:57], v[56:57], v[216:217] op_sel_hi:[1,0]
  v_pk_mul_f32 v[58:59], v[58:59], v[216:217] op_sel_hi:[1,0]
  v_cvt_pk_bf16_f32 v220, v48, v49
  v_cvt_pk_bf16_f32 v221, v50, v51
  v_cvt_pk_bf16_f32 v222, v52, v53
  v_cvt_pk_bf16_f32 v223, v54, v55
  v_cvt_pk_bf16_f32 v224, v56, v57
  v_cvt_pk_bf16_f32 v225, v58, v59
  s_add_u32 s49, s48, 0
  buffer_store_dwordx2 v[220:221], v5, s[4:7], s49 offen sc1
  buffer_store_dwordx2 v[222:223], v5, s[4:7], s49 offen offset:16 sc1
  s_mov_b32 exec_hi, 0
  buffer_store_dwordx2 v[224:225], v5, s[4:7], s49 offen offset:32 sc1
  s_mov_b32 exec_hi, -1
  v_rcp_f32 v216, v76
  s_nop 0
  v_pk_mul_f32 v[64:65], v[64:65], v[216:217] op_sel_hi:[1,0]
  v_pk_mul_f32 v[66:67], v[66:67], v[216:217] op_sel_hi:[1,0]
  v_pk_mul_f32 v[68:69], v[68:69], v[216:217] op_sel_hi:[1,0]
  v_pk_mul_f32 v[70:71], v[70:71], v[216:217] op_sel_hi:[1,0]
  v_pk_mul_f32 v[72:73], v[72:73], v[216:217] op_sel_hi:[1,0]
  v_pk_mul_f32 v[74:75], v[74:75], v[216:217] op_sel_hi:[1,0]
  v_cvt_pk_bf16_f32 v220, v64, v65
  v_cvt_pk_bf16_f32 v221, v66, v67
  v_cvt_pk_bf16_f32 v222, v68, v69
  v_cvt_pk_bf16_f32 v223, v70, v71
  v_cvt_pk_bf16_f32 v224, v72, v73
  v_cvt_pk_bf16_f32 v225, v74, v75
  s_add_u32 s49, s48, 40960
  buffer_store_dwordx2 v[220:221], v5, s[4:7], s49 offen sc1
  buffer_store_dwordx2 v[222:223], v5, s[4:7], s49 offen offset:16 sc1
  s_mov_b32 exec_hi, 0
  buffer_store_dwordx2 v[224:225], v5, s[4:7], s49 offen offset:32 sc1
  s_mov_b32 exec_hi, -1
  v_rcp_f32 v216, v92
  s_nop 0
  v_pk_mul_f32 v[80:81], v[80:81], v[216:217] op_sel_hi:[1,0]
  v_pk_mul_f32 v[82:83], v[82:83], v[216:217] op_sel_hi:[1,0]
  v_pk_mul_f32 v[84:85], v[84:85], v[216:217] op_sel_hi:[1,0]
  v_pk_mul_f32 v[86:87], v[86:87], v[216:217] op_sel_hi:[1,0]
  v_pk_mul_f32 v[88:89], v[88:89], v[216:217] op_sel_hi:[1,0]
  v_pk_mul_f32 v[90:91], v[90:91], v[216:217] op_sel_hi:[1,0]
  v_cvt_pk_bf16_f32 v220, v80, v81
  v_cvt_pk_bf16_f32 v221, v82, v83
  v_cvt_pk_bf16_f32 v222, v84, v85
  v_cvt_pk_bf16_f32 v223, v86, v87
  v_cvt_pk_bf16_f32 v224, v88, v89
  v_cvt_pk_bf16_f32 v225, v90, v91
  s_add_u32 s49, s48, 81920
  buffer_store_dwordx2 v[220:221], v5, s[4:7], s49 offen sc1
  buffer_store_dwordx2 v[222:223], v5, s[4:7], s49 offen offset:16 sc1
  s_mov_b32 exec_hi, 0
  buffer_store_dwordx2 v[224:225], v5, s[4:7], s49 offen offset:32 sc1
  s_mov_b32 exec_hi, -1
  v_rcp_f32 v216, v108
  s_nop 0
  v_pk_mul_f32 v[96:97], v[96:97], v[216:217] op_sel_hi:[1,0]
  v_pk_mul_f32 v[98:99], v[98:99], v[216:217] op_sel_hi:[1,0]
  v_pk_mul_f32 v[100:101], v[100:101], v[216:217] op_sel_hi:[1,0]
  v_pk_mul_f32 v[102:103], v[102:103], v[216:217] op_sel_hi:[1,0]
  v_pk_mul_f32 v[104:105], v[104:105], v[216:217] op_sel_hi:[1,0]
  v_pk_mul_f32 v[106:107], v[106:107], v[216:217] op_sel_hi:[1,0]
  v_cvt_pk_bf16_f32 v220, v96, v97
  v_cvt_pk_bf16_f32 v221, v98, v99
  v_cvt_pk_bf16_f32 v222, v100, v101
  v_cvt_pk_bf16_f32 v223, v102, v103
  v_cvt_pk_bf16_f32 v224, v104, v105
  v_cvt_pk_bf16_f32 v225, v106, v107
  s_add_u32 s49, s48, 122880
  buffer_store_dwordx2 v[220:221], v5, s[4:7], s49 offen sc1
  buffer_store_dwordx2 v[222:223], v5, s[4:7], s49 offen offset:16 sc1
  s_mov_b32 exec_hi, 0
  buffer_store_dwordx2 v[224:225], v5, s[4:7], s49 offen offset:32 sc1
  s_mov_b32 exec_hi, -1
  s_branch BG_SIG
BG_X:
  s_lshr_b32 s57, s82, 1
  s_add_u32 s57, s57, s83
  s_and_b32 s58, s82, 1
  s_lshl_b32 s59, s79, 1
  s_add_u32 s58, s58, s59
  s_lshr_b32 s59, s57, 3
  s_lshl_b32 s59, s59, 6
  s_cmp_eq_u32 s80, 0
  s_cbranch_scc0 XW_26_d
  s_lshl_b32 s91, s58, 6
  s_add_u32 s91, s91, 1843200
  s_add_u32 s60, s57, 1
  v_lshlrev_b32 v2, 2, v0
  v_add_u32 v2, s91, v2
  v_mov_b32 v4, s60
  s_add_u32 s61, s59, 1835520
  s_add_u32 s62, s59, 1835008
  v_cmp_eq_u32 vcc, 16, v0
  v_mov_b32 v5, s61
  v_cndmask_b32 v2, v2, v5, vcc
  v_cndmask_b32 v4, v4, 24, vcc
  v_cmp_eq_u32 vcc, 17, v0
  v_mov_b32 v5, s62
  v_cndmask_b32 v2, v2, v5, vcc
  v_mov_b32 v5, 96
  v_cndmask_b32 v4, v4, v5, vcc
  v_cmp_gt_u32 vcc, 16, v0
  v_mov_b32 v5, s57
  v_cndmask_b32 v5, 0, v5, vcc
  s_mov_b32 s93, 0
  s_mov_b64 exec, 0x3ffff
XW_26_l:
  buffer_load_dword v3, v2, s[84:87], 0 offen sc1
  s_add_u32 s93, s93, 1
  s_waitcnt vmcnt(0)
  v_cmp_gt_u32 vcc, v4, v3
  s_cbranch_vccz XW_26_k
  v_cmp_gt_u32 vcc, v5, v3
  s_cbranch_vccz XW_26_n
  s_sleep 120
XW_26_n:
  s_sleep 24
  s_cmp_lt_u32 s93, 200000
  s_cbranch_scc1 XW_26_l
XW_26_k:
  s_mov_b64 exec, -1
XW_26_d:
  s_barrier
  s_mov_b32 s4, s84
  s_mov_b32 s5, s85
  s_mov_b32 s6, s86
  s_mov_b32 s7, s87
  s_lshl_b32 s17, s57, 5
  s_lshl_b32 s58, s58, 2
  s_add_u32 s17, s17, s58
  s_add_u32 s17, s17, s80
  s_lshl_b32 s90, s57, 6
  s_add_u32 s90, s90, 1839104
  v_lshlrev_b32 v2, 4, v1
  v_lshrrev_b32 v7, 5, v1
  v_lshlrev_b32 v3, 7, v7
  v_and_b32 v5, 7, v1
  v_lshlrev_b32 v5, 4, v5
  v_add_u32 v3, v3, v5
  v_and_b32 v5, 31, v1
  v_lshlrev_b32 v4, 4, v5
  v_lshlrev_b32 v6, 3, v7
  v_add_u32 v4, v4, v6
  v_lshlrev_b32 v7, 2, v7
  v_sub_u32 v6, v5, v7
  s_mul_i32 s18, s17, 12288
  s_add_u32 s19, s18, 27262976
  buffer_load_dwordx4 v[56:59], v2, s[4:7], s19 offen offset:0
  buffer_load_dwordx4 v[60:63], v2, s[4:7], s19 offen offset:1024
  buffer_load_dwordx4 v[64:67], v2, s[4:7], s19 offen offset:2048
  buffer_load_dwordx4 v[68:71], v2, s[4:7], s19 offen offset:3072
  s_add_u32 s19, s18, 27267072
  buffer_load_dwordx4 v[72:75], v2, s[4:7], s19 offen offset:0
  buffer_load_dwordx4 v[76:79], v2, s[4:7], s19 offen offset:1024
  buffer_load_dwordx4 v[80:83], v2, s[4:7], s19 offen offset:2048
  buffer_load_dwordx4 v[84:87], v2, s[4:7], s19 offen offset:3072
  s_add_u32 s19, s18, 27271168
  buffer_load_dwordx4 v[88:91], v2, s[4:7], s19 offen offset:0
  buffer_load_dwordx4 v[92:95], v2, s[4:7], s19 offen offset:1024
  buffer_load_dwordx4 v[96:99], v2, s[4:7], s19 offen offset:2048
  buffer_load_dwordx4 v[100:103], v2, s[4:7], s19 offen offset:3072
  s_add_u32 s19, s18, 2097152
  buffer_load_dwordx4 v[8:11], v2, s[4:7], s19 offen offset:0
  buffer_load_dwordx4 v[12:15], v2, s[4:7], s19 offen offset:1024
  buffer_load_dwordx4 v[16:19], v2, s[4:7], s19 offen offset:2048
  buffer_load_dwordx4 v[20:23], v2, s[4:7], s19 offen offset:3072
  s_add_u32 s19, s18, 2101248
  buffer_load_dwordx4 v[24:27], v2, s[4:7], s19 offen offset:0
  buffer_load_dwordx4 v[28:31], v2, s[4:7], s19 offen offset:1024
  buffer_load_dwordx4 v[32:35], v2, s[4:7], s19 offen offset:2048
  buffer_load_dwordx4 v[36:39], v2, s[4:7], s19 offen offset:3072
  s_add_u32 s19, s18, 2105344
  buffer_load_dwordx4 v[40:43], v2, s[4:7], s19 offen offset:0
  buffer_load_dwordx4 v[44:47], v2, s[4:7], s19 offen offset:1024
  buffer_load_dwordx4 v[48:51], v2, s[4:7], s19 offen offset:2048
  buffer_load_dwordx4 v[52:55], v2, s[4:7], s19 offen offset:3072
  s_mul_i32 s19, s17, 3072
  s_add_u32 s19, s19, 102760448
  buffer_load_dwordx4 v[104:107], v3, s[4:7], s19 offen offset:0
  buffer_load_dwordx4 v[108:111], v3, s[4:7], s19 offen offset:256
  buffer_load_dwordx4 v[112:115], v3, s[4:7], s19 offen offset:512
  buffer_load_dwordx4 v[116:119], v3, s[4:7], s19 offen offset:768
  buffer_load_dwordx4 v[120:123], v3, s[4:7], s19 offen offset:1024
  buffer_load_dwordx4 v[124:127], v3, s[4:7], s19 offen offset:1280
  buffer_load_dwordx4 v[128:131], v3, s[4:7], s19 offen offset:1536
  buffer_load_dwordx4 v[132:135], v3, s[4:7], s19 offen offset:1792
  buffer_load_dwordx4 v[136:139], v3, s[4:7], s19 offen offset:2048
  buffer_load_dwordx4 v[140:143], v3, s[4:7], s19 offen offset:2304
  buffer_load_dwordx4 v[144:147], v3, s[4:7], s19 offen offset:2560
  buffer_load_dwordx4 v[148:151], v3, s[4:7], s19 offen offset:2816
  s_add_u32 s19, s18, 52428800
  buffer_load_dwordx4 v[152:155], v2, s[4:7], s19 offen offset:0
  buffer_load_dwordx4 v[156:159], v2, s[4:7], s19 offen offset:1024
  buffer_load_dwordx4 v[160:163], v2, s[4:7], s19 offen offset:2048
  buffer_load_dwordx4 v[164:167], v2, s[4:7], s19 offen offset:3072
  s_add_u32 s19, s18, 52432896
  buffer_load_dwordx4 v[168:171], v2, s[4:7], s19 offen offset:0
  buffer_load_dwordx4 v[172:175], v2, s[4:7], s19 offen offset:1024
  buffer_load_dwordx4 v[176:179], v2, s[4:7], s19 offen offset:2048
  buffer_load_dwordx4 v[180:183], v2, s[4:7], s19 offen offset:3072
  s_add_u32 s19, s18, 52436992
  buffer_load_dwordx4 v[184:187], v2, s[4:7], s19 offen offset:0
  buffer_load_dwordx4 v[188:191], v2, s[4:7], s19 offen offset:1024
  buffer_load_dwordx4 v[192:195], v2, s[4:7], s19 offen offset:2048
  buffer_load_dwordx4 v[196:199], v2, s[4:7], s19 offen offset:3072
  s_mul_i32 s19, s17, 3072
  s_add_u32 s19, s19, 109051904
  buffer_load_dwordx2 v[200:201], v4, s[4:7], s19 offen offset:0
  buffer_load_dwordx2 v[202:203], v4, s[4:7], s19 offen offset:512
  buffer_load_dwordx2 v[204:205], v4, s[4:7], s19 offen offset:1024
  buffer_load_dwordx2 v[206:207], v4, s[4:7], s19 offen offset:1536
  buffer_load_dwordx2 v[208:209], v4, s[4:7], s19 offen offset:2048
  buffer_load_dwordx2 v[210:211], v4, s[4:7], s19 offen offset:2560
  s_waitcnt vmcnt(30)
  v_mfma_f32_32x32x16_bf16 v[212:227], v[56:59], v[8:11], 0
  v_mfma_f32_32x32x16_bf16 v[212:227], v[60:63], v[12:15], v[212:227]
  v_mfma_f32_32x32x16_bf16 v[212:227], v[64:67], v[16:19], v[212:227]
  v_mfma_f32_32x32x16_bf16 v[212:227], v[68:71], v[20:23], v[212:227]
  v_mfma_f32_32x32x16_bf16 v[212:227], v[72:75], v[24:27], v[212:227]
  v_mfma_f32_32x32x16_bf16 v[212:227], v[76:79], v[28:31], v[212:227]
  v_mfma_f32_32x32x16_bf16 v[212:227], v[80:83], v[32:35], v[212:227]
  v_mfma_f32_32x32x16_bf16 v[212:227], v[84:87], v[36:39], v[212:227]
  v_mfma_f32_32x32x16_bf16 v[212:227], v[88:91], v[40:43], v[212:227]
  v_mfma_f32_32x32x16_bf16 v[212:227], v[92:95], v[44:47], v[212:227]
  v_mfma_f32_32x32x16_bf16 v[212:227], v[96:99], v[48:51], v[212:227]
  v_mfma_f32_32x32x16_bf16 v[212:227], v[100:103], v[52:55], v[212:227]
  s_waitcnt vmcnt(18)
  v_mfma_f32_32x32x16_bf16 v[228:243], v[104:107], v[8:11], 0
  v_mfma_f32_32x32x16_bf16 v[228:243], v[108:111], v[12:15], v[228:243]
  v_mfma_f32_32x32x16_bf16 v[228:243], v[112:115], v[16:19], v[228:243]
  v_mfma_f32_32x32x16_bf16 v[228:243], v[116:119], v[20:23], v[228:243]
  v_mfma_f32_32x32x16_bf16 v[228:243], v[120:123], v[24:27], v[228:243]
  v_mfma_f32_32x32x16_bf16 v[228:243], v[124:127], v[28:31], v[228:243]
  v_mfma_f32_32x32x16_bf16 v[228:243], v[128:131], v[32:35], v[228:243]
  v_mfma_f32_32x32x16_bf16 v[228:243], v[132:135], v[36:39], v[228:243]
  v_mfma_f32_32x32x16_bf16 v[228:243], v[136:139], v[40:43], v[228:243]
  v_mfma_f32_32x32x16_bf16 v[228:243], v[140:143], v[44:47], v[228:243]
  v_mfma_f32_32x32x16_bf16 v[228:243], v[144:147], v[48:51], v[228:243]
  v_mfma_f32_32x32x16_bf16 v[228:243], v[148:151], v[52:55], v[228:243]
  v_mov_b32 v42, 0xff800000
  v_cmp_le_i32 vcc, 0, v6
  v_cndmask_b32 v212, v42, v212, vcc
  v_cmp_le_i32 vcc, 1, v6
  v_cndmask_b32 v213, v42, v213, vcc
  v_cmp_le_i32 vcc, 2, v6
  v_cndmask_b32 v214, v42, v214, vcc
  v_cmp_le_i32 vcc, 3, v6
  v_cndmask_b32 v215, v42, v215, vcc
  v_cmp_le_i32 vcc, 8, v6
  v_cndmask_b32 v216, v42, v216, vcc
  v_cmp_le_i32 vcc, 9, v6
  v_cndmask_b32 v217, v42, v217, vcc
  v_cmp_le_i32 vcc, 10, v6
  v_cndmask_b32 v218, v42, v218, vcc
  v_cmp_le_i32 vcc, 11, v6
  v_cndmask_b32 v219, v42, v219, vcc
  v_cmp_le_i32 vcc, 16, v6
  v_cndmask_b32 v220, v42, v220, vcc
  v_cmp_le_i32 vcc, 17, v6
  v_cndmask_b32 v221, v42, v221, vcc
  v_cmp_le_i32 vcc, 18, v6
  v_cndmask_b32 v222, v42, v222, vcc
  v_cmp_le_i32 vcc, 19, v6
  v_cndmask_b32 v223, v42, v223, vcc
  v_cmp_le_i32 vcc, 24, v6
  v_cndmask_b32 v224, v42, v224, vcc
  v_cmp_le_i32 vcc, 25, v6
  v_cndmask_b32 v225, v42, v225, vcc
  v_cmp_le_i32 vcc, 26, v6
  v_cndmask_b32 v226, v42, v226, vcc
  v_cmp_le_i32 vcc, 27, v6
  v_cndmask_b32 v227, v42, v227, vcc
  s_nop 7
  s_nop 3
  v_max3_f32 v40, v212, v213, v214
  v_max3_f32 v40, v40, v215, v216
  v_max3_f32 v40, v40, v217, v218
  v_max3_f32 v40, v40, v219, v220
  v_max3_f32 v40, v40, v221, v222
  v_max3_f32 v40, v40, v223, v224
  v_max3_f32 v40, v40, v225, v226
  v_max3_f32 v40, v40, v227, v228
  v_max3_f32 v40, v40, v229, v230
  v_max_f32 v40, v40, v231
  v_mov_b32 v41, v40
  s_mov_b32 s19, 0x3dd53b95
  s_nop 0
  v_permlane32_swap_b32 v40, v41
  v_max_f32 v40, v40, v41
  v_mul_f32 v40, s19, v40
  v_fma_f32 v212, v212, s19, -v40
  v_fma_f32 v213, v213, s19, -v40
  v_fma_f32 v214, v214, s19, -v40
  v_fma_f32 v215, v215, s19, -v40
  v_fma_f32 v216, v216, s19, -v40
  v_fma_f32 v217, v217, s19, -v40
  v_fma_f32 v218, v218, s19, -v40
  v_fma_f32 v219, v219, s19, -v40
  v_fma_f32 v220, v220, s19, -v40
  v_fma_f32 v221, v221, s19, -v40
  v_fma_f32 v222, v222, s19, -v40
  v_fma_f32 v223, v223, s19, -v40
  v_fma_f32 v224, v224, s19, -v40
  v_fma_f32 v225, v225, s19, -v40
  v_fma_f32 v226, v226, s19, -v40
  v_fma_f32 v227, v227, s19, -v40
  v_fma_f32 v228, v228, s19, -v40
  v_fma_f32 v229, v229, s19, -v40
  v_fma_f32 v230, v230, s19, -v40
  v_fma_f32 v231, v231, s19, -v40
  v_exp_f32 v212, v212
  v_exp_f32 v213, v213
  v_exp_f32 v214, v214
  v_exp_f32 v215, v215
  v_exp_f32 v216, v216
  v_exp_f32 v217, v217
  v_exp_f32 v218, v218
  v_exp_f32 v219, v219
  v_exp_f32 v220, v220
  v_exp_f32 v221, v221
  v_exp_f32 v222, v222
  v_exp_f32 v223, v223
  v_exp_f32 v224, v224
  v_exp_f32 v225, v225
  v_exp_f32 v226, v226
  v_exp_f32 v227, v227
  v_exp_f32 v228, v228
  v_exp_f32 v229, v229
  v_exp_f32 v230, v230
  v_exp_f32 v231, v231
  s_nop 0
  v_add_f32 v42, v212, v213
  v_add_f32 v43, v214, v215
  v_add_f32 v42, v42, v216
  v_add_f32 v43, v43, v217
  v_add_f32 v42, v42, v218
  v_add_f32 v43, v43, v219
  v_add_f32 v42, v42, v220
  v_add_f32 v43, v43, v221
  v_add_f32 v42, v42, v222
  v_add_f32 v43, v43, v223
  v_add_f32 v42, v42, v224
  v_add_f32 v43, v43, v225
  v_add_f32 v42, v42, v226
  v_add_f32 v43, v43, v227
  v_add_f32 v42, v42, v228
  v_add_f32 v43, v43, v229
  v_add_f32 v42, v42, v230
  v_add_f32 v43, v43, v231
  v_add_f32 v42, v42, v43
  v_mov_b32 v41, v42
  s_nop 1
  v_permlane32_swap_b32 v42, v41
  v_add_f32 v42, v42, v41
  v_rcp_f32 v42, v42
  s_nop 0
  v_mul_f32 v212, v212, v42
  v_mul_f32 v213, v213, v42
  v_mul_f32 v214, v214, v42
  v_mul_f32 v215, v215, v42
  v_mul_f32 v216, v216, v42
  v_mul_f32 v217, v217, v42
  v_mul_f32 v218, v218, v42
  v_mul_f32 v219, v219, v42
  v_mul_f32 v220, v220, v42
  v_mul_f32 v221, v221, v42
  v_mul_f32 v222, v222, v42
  v_mul_f32 v223, v223, v42
  v_mul_f32 v224, v224, v42
  v_mul_f32 v225, v225, v42
  v_mul_f32 v226, v226, v42
  v_mul_f32 v227, v227, v42
  v_mul_f32 v228, v228, v42
  v_mul_f32 v229, v229, v42
  v_mul_f32 v230, v230, v42
  v_mul_f32 v231, v231, v42
  v_cvt_pk_bf16_f32 v244, v212, v213
  v_cvt_pk_bf16_f32 v245, v214, v215
  v_cvt_pk_bf16_f32 v246, v216, v217
  v_cvt_pk_bf16_f32 v247, v218, v219
  v_cvt_pk_bf16_f32 v248, v220, v221
  v_cvt_pk_bf16_f32 v249, v222, v223
  v_cvt_pk_bf16_f32 v250, v224, v225
  v_cvt_pk_bf16_f32 v251, v226, v227
  v_cvt_pk_bf16_f32 v252, v228, v229
  v_cvt_pk_bf16_f32 v253, v230, v231
  s_mul_i32 s18, s17, 12288
  s_add_u32 s18, s18, 77594624
  s_waitcnt vmcnt(0)
  s_nop 0
  v_mfma_f32_32x32x16_bf16 v[8:23], v[152:155], v[244:247], 0
  v_mfma_f32_32x32x16_bf16 v[8:23], v[156:159], v[248:251], v[8:23]
  v_mfma_f32_32x32x8_bf16 v[8:23], v[200:201], v[252:253], v[8:23]
  v_mfma_f32_32x32x16_bf16 v[24:39], v[160:163], v[244:247], 0
  v_mfma_f32_32x32x16_bf16 v[24:39], v[164:167], v[248:251], v[24:39]
  v_mfma_f32_32x32x8_bf16 v[24:39], v[202:203], v[252:253], v[24:39]
  v_cvt_pk_bf16_f32 v40, v8, v9
  v_cvt_pk_bf16_f32 v41, v10, v11
  v_cvt_pk_bf16_f32 v42, v12, v13
  v_cvt_pk_bf16_f32 v43, v14, v15
  v_cvt_pk_bf16_f32 v44, v16, v17
  v_cvt_pk_bf16_f32 v45, v18, v19
  v_cvt_pk_bf16_f32 v46, v20, v21
  v_cvt_pk_bf16_f32 v47, v22, v23
  s_add_u32 s19, s18, 0
  buffer_store_dwordx4 v[40:43], v2, s[4:7], s19 offen sc1
  buffer_store_dwordx4 v[44:47], v2, s[4:7], s19 offen offset:1024 sc1
  v_mfma_f32_32x32x16_bf16 v[8:23], v[168:171], v[244:247], 0
  v_mfma_f32_32x32x16_bf16 v[8:23], v[172:175], v[248:251], v[8:23]
  v_mfma_f32_32x32x8_bf16 v[8:23], v[204:205], v[252:253], v[8:23]
  v_cvt_pk_bf16_f32 v40, v24, v25
  v_cvt_pk_bf16_f32 v41, v26, v27
  v_cvt_pk_bf16_f32 v42, v28, v29
  v_cvt_pk_bf16_f32 v43, v30, v31
  v_cvt_pk_bf16_f32 v44, v32, v33
  v_cvt_pk_bf16_f32 v45, v34, v35
  v_cvt_pk_bf16_f32 v46, v36, v37
  v_cvt_pk_bf16_f32 v47, v38, v39
  s_add_u32 s19, s18, 2048
  buffer_store_dwordx4 v[40:43], v2, s[4:7], s19 offen sc1
  buffer_store_dwordx4 v[44:47], v2, s[4:7], s19 offen offset:1024 sc1
  v_mfma_f32_32x32x16_bf16 v[24:39], v[176:179], v[244:247], 0
  v_mfma_f32_32x32x16_bf16 v[24:39], v[180:183], v[248:251], v[24:39]
  v_mfma_f32_32x32x8_bf16 v[24:39], v[206:207], v[252:253], v[24:39]
  v_cvt_pk_bf16_f32 v40, v8, v9
  v_cvt_pk_bf16_f32 v41, v10, v11
  v_cvt_pk_bf16_f32 v42, v12, v13
  v_cvt_pk_bf16_f32 v43, v14, v15
  v_cvt_pk_bf16_f32 v44, v16, v17
  v_cvt_pk_bf16_f32 v45, v18, v19
  v_cvt_pk_bf16_f32 v46, v20, v21
  v_cvt_pk_bf16_f32 v47, v22, v23
  s_add_u32 s19, s18, 4096
  buffer_store_dwordx4 v[40:43], v2, s[4:7], s19 offen sc1
  buffer_store_dwordx4 v[44:47], v2, s[4:7], s19 offen offset:1024 sc1
  v_mfma_f32_32x32x16_bf16 v[8:23], v[184:187], v[244:247], 0
  v_mfma_f32_32x32x16_bf16 v[8:23], v[188:191], v[248:251], v[8:23]
  v_mfma_f32_32x32x8_bf16 v[8:23], v[208:209], v[252:253], v[8:23]
  v_cvt_pk_bf16_f32 v40, v24, v25
  v_cvt_pk_bf16_f32 v41, v26, v27
  v_cvt_pk_bf16_f32 v42, v28, v29
  v_cvt_pk_bf16_f32 v43, v30, v31
  v_cvt_pk_bf16_f32 v44, v32, v33
  v_cvt_pk_bf16_f32 v45, v34, v35
  v_cvt_pk_bf16_f32 v46, v36, v37
  v_cvt_pk_bf16_f32 v47, v38, v39
  s_add_u32 s19, s18, 6144
  buffer_store_dwordx4 v[40:43], v2, s[4:7], s19 offen sc1
  buffer_store_dwordx4 v[44:47], v2, s[4:7], s19 offen offset:1024 sc1
  v_mfma_f32_32x32x16_bf16 v[24:39], v[192:195], v[244:247], 0
  v_mfma_f32_32x32x16_bf16 v[24:39], v[196:199], v[248:251], v[24:39]
  v_mfma_f32_32x32x8_bf16 v[24:39], v[210:211], v[252:253], v[24:39]
  v_cvt_pk_bf16_f32 v40, v8, v9
  v_cvt_pk_bf16_f32 v41, v10, v11
  v_cvt_pk_bf16_f32 v42, v12, v13
  v_cvt_pk_bf16_f32 v43, v14, v15
  v_cvt_pk_bf16_f32 v44, v16, v17
  v_cvt_pk_bf16_f32 v45, v18, v19
  v_cvt_pk_bf16_f32 v46, v20, v21
  v_cvt_pk_bf16_f32 v47, v22, v23
  s_add_u32 s19, s18, 8192
  buffer_store_dwordx4 v[40:43], v2, s[4:7], s19 offen sc1
  buffer_store_dwordx4 v[44:47], v2, s[4:7], s19 offen offset:1024 sc1
  s_nop 7
  s_nop 3
  v_cvt_pk_bf16_f32 v40, v24, v25
  v_cvt_pk_bf16_f32 v41, v26, v27
  v_cvt_pk_bf16_f32 v42, v28, v29
  v_cvt_pk_bf16_f32 v43, v30, v31
  v_cvt_pk_bf16_f32 v44, v32, v33
  v_cvt_pk_bf16_f32 v45, v34, v35
  v_cvt_pk_bf16_f32 v46, v36, v37
  v_cvt_pk_bf16_f32 v47, v38, v39
  s_add_u32 s19, s18, 10240
  buffer_store_dwordx4 v[40:43], v2, s[4:7], s19 offen sc1
  buffer_store_dwordx4 v[44:47], v2, s[4:7], s19 offen offset:1024 sc1
  s_branch BG_SIG
BG_O5:
  s_mov_b32 s37, s82
  s_mul_i32 s39, s37, 1
  s_sub_u32 s39, s82, s39
  s_mul_i32 s39, s39, 160
  s_mul_i32 s34, s79, 160
  s_add_u32 s39, s39, s34
  s_add_u32 s37, s37, s83
  s_lshl_b32 s91, s37, 7
  s_add_u32 s91, s91, 1839104
  s_cmp_eq_u32 s80, 0
  s_cbranch_scc0 W_27_d
  v_lshlrev_b32 v2, 6, v0
  s_mov_b32 s93, 0
  s_mov_b64 exec, 0x3
W_27_l:
  buffer_load_dword v3, v2, s[84:87], s91 offen sc1
  s_add_u32 s93, s93, 1
  s_waitcnt vmcnt(0)
  v_cmp_gt_u32 vcc, 8, v3
  s_cbranch_vccz W_27_k
  s_sleep 48
  s_cmp_lt_u32 s93, 200000
  s_cbranch_scc1 W_27_l
W_27_k:
  s_mov_b64 exec, -1
W_27_d:
  s_barrier
  s_load_dwordx2 s[8:9], s[0:1], 40
  s_mov_b32 s10, 0x780000
  s_mov_b32 s11, 0x00020000
  s_load_dwordx2 s[16:17], s[0:1], 80
  s_mov_b32 s18, 0x500000
  s_mov_b32 s19, 0x00020000
  s_mov_b32 s4, s84
  s_mov_b32 s5, s85
  s_mov_b32 s6, s86
  s_mov_b32 s7, s87
  v_lshlrev_b32 v2, 4, v1
  v_add_u32 v5, 0, v1
  v_mul_u32_u24 v6, 3277, v5
  v_lshrrev_b32 v6, 16, v6
  v_mul_u32_u24 v7, 20, v6
  v_sub_u32 v7, v5, v7
  v_mul_u32_u24 v6, 1280, v6
  v_lshlrev_b32 v7, 4, v7
  v_add_u32 v8, v6, v7
  v_add_u32 v5, 64, v1
  v_mul_u32_u24 v6, 3277, v5
  v_lshrrev_b32 v6, 16, v6
  v_mul_u32_u24 v7, 20, v6
  v_sub_u32 v7, v5, v7
  v_mul_u32_u24 v6, 1280, v6
  v_lshlrev_b32 v7, 4, v7
  v_add_u32 v9, v6, v7
  v_add_u32 v5, 128, v1
  v_mul_u32_u24 v6, 3277, v5
  v_lshrrev_b32 v6, 16, v6
  v_mul_u32_u24 v7, 20, v6
  v_sub_u32 v7, v5, v7
  v_mul_u32_u24 v6, 1280, v6
  v_lshlrev_b32 v7, 4, v7
  v_add_u32 v10, v6, v7
  v_add_u32 v5, 192, v1
  v_mul_u32_u24 v6, 3277, v5
  v_lshrrev_b32 v6, 16, v6
  v_mul_u32_u24 v7, 20, v6
  v_sub_u32 v7, v5, v7
  v_mul_u32_u24 v6, 1280, v6
  v_lshlrev_b32 v7, 4, v7
  v_add_u32 v11, v6, v7
  v_add_u32 v5, 256, v1
  v_mul_u32_u24 v6, 3277, v5
  v_lshrrev_b32 v6, 16, v6
  v_mul_u32_u24 v7, 20, v6
  v_sub_u32 v7, v5, v7
  v_mul_u32_u24 v6, 1280, v6
  v_lshlrev_b32 v7, 4, v7
  v_add_u32 v12, v6, v7
  v_lshrrev_b32 v5, 5, v1
  v_lshlrev_b32 v5, 2, v5
  v_bfe_u32 v6, v1, 2, 2
  v_add_u32 v5, v5, v6
  v_mul_u32_u24 v5, 320, v5
  v_bfe_u32 v6, v1, 4, 1
  v_lshlrev_b32 v6, 5, v6
  v_and_b32 v7, 3, v1
  v_lshlrev_b32 v7, 3, v7
  v_add3_u32 v5, v5, v6, v7
  s_mul_i32 s34, s80, 32768
  v_add_u32 v3, s34, v5
  v_and_b32 v5, 31, v1
  v_mul_u32_u24 v5, 2560, v5
  v_lshrrev_b32 v6, 5, v1
  v_lshlrev_b32 v6, 4, v6
  v_add_u32 v4, v5, v6
  s_waitcnt lgkmcnt(0)
  s_mul_i32 s20, s37, 786432
  s_mul_i32 s34, s80, 98304
  s_add_u32 s20, s20, s34
  s_add_u32 s20, s20, 77594624
  s_add_u32 s21, s20, 393216
  s_mul_i32 s22, s80, 1966080
  s_lshl_b32 s34, s39, 1
  s_add_u32 s22, s22, s34
  s_mul_i32 s23, s80, 32768
  s_add_u32 m0, s23, 0
  s_nop 0
  buffer_load_dwordx4 v8, s[8:11], s22 offen lds
  s_add_u32 m0, s23, 1024
  s_nop 0
  buffer_load_dwordx4 v9, s[8:11], s22 offen lds
  s_add_u32 m0, s23, 2048
  s_nop 0
  buffer_load_dwordx4 v10, s[8:11], s22 offen lds
  s_add_u32 m0, s23, 3072
  s_nop 0
  buffer_load_dwordx4 v11, s[8:11], s22 offen lds
  s_add_u32 m0, s23, 4096
  s_nop 0
  buffer_load_dwordx4 v12, s[8:11], s22 offen lds
  buffer_load_dwordx4 v[16:19], v2, s[4:7], s20 offen
  buffer_load_dwordx4 v[20:23], v2, s[4:7], s21 offen
  s_add_u32 s20, s20, 1024
  s_add_u32 s21, s21, 1024
  s_add_u32 s22, s22, 20480
  s_add_u32 m0, s23, 5120
  s_nop 0
  buffer_load_dwordx4 v8, s[8:11], s22 offen lds
  s_add_u32 m0, s23, 6144
  s_nop 0
  buffer_load_dwordx4 v9, s[8:11], s22 offen lds
  s_add_u32 m0, s23, 7168
  s_nop 0
  buffer_load_dwordx4 v10, s[8:11], s22 offen lds
  s_add_u32 m0, s23, 8192
  s_nop 0
  buffer_load_dwordx4 v11, s[8:11], s22 offen lds
  s_add_u32 m0, s23, 9216
  s_nop 0
  buffer_load_dwordx4 v12, s[8:11], s22 offen lds
  buffer_load_dwordx4 v[24:27], v2, s[4:7], s20 offen
  buffer_load_dwordx4 v[28:31], v2, s[4:7], s21 offen
  s_add_u32 s20, s20, 1024
  s_add_u32 s21, s21, 1024
  s_add_u32 s22, s22, 20480
  s_add_u32 m0, s23, 10240
  s_nop 0
  buffer_load_dwordx4 v8, s[8:11], s22 offen lds
  s_add_u32 m0, s23, 11264
  s_nop 0
  buffer_load_dwordx4 v9, s[8:11], s22 offen lds
  s_add_u32 m0, s23, 12288
  s_nop 0
  buffer_load_dwordx4 v10, s[8:11], s22 offen lds
  s_add_u32 m0, s23, 13312
  s_nop 0
  buffer_load_dwordx4 v11, s[8:11], s22 offen lds
  s_add_u32 m0, s23, 14336
  s_nop 0
  buffer_load_dwordx4 v12, s[8:11], s22 offen lds
  buffer_load_dwordx4 v[32:35], v2, s[4:7], s20 offen
  buffer_load_dwordx4 v[36:39], v2, s[4:7], s21 offen
  s_add_u32 s20, s20, 1024
  s_add_u32 s21, s21, 1024
  s_add_u32 s22, s22, 20480
  s_add_u32 m0, s23, 15360
  s_nop 0
  buffer_load_dwordx4 v8, s[8:11], s22 offen lds
  s_add_u32 m0, s23, 16384
  s_nop 0
  buffer_load_dwordx4 v9, s[8:11], s22 offen lds
  s_add_u32 m0, s23, 17408
  s_nop 0
  buffer_load_dwordx4 v10, s[8:11], s22 offen lds
  s_add_u32 m0, s23, 18432
  s_nop 0
  buffer_load_dwordx4 v11, s[8:11], s22 offen lds
  s_add_u32 m0, s23, 19456
  s_nop 0
  buffer_load_dwordx4 v12, s[8:11], s22 offen lds
  buffer_load_dwordx4 v[40:43], v2, s[4:7], s20 offen
  buffer_load_dwordx4 v[44:47], v2, s[4:7], s21 offen
  s_add_u32 s20, s20, 1024
  s_add_u32 s21, s21, 1024
  s_add_u32 s22, s22, 20480
  s_add_u32 m0, s23, 20480
  s_nop 0
  buffer_load_dwordx4 v8, s[8:11], s22 offen lds
  s_add_u32 m0, s23, 21504
  s_nop 0
  buffer_load_dwordx4 v9, s[8:11], s22 offen lds
  s_add_u32 m0, s23, 22528
  s_nop 0
  buffer_load_dwordx4 v10, s[8:11], s22 offen lds
  s_add_u32 m0, s23, 23552
  s_nop 0
  buffer_load_dwordx4 v11, s[8:11], s22 offen lds
  s_add_u32 m0, s23, 24576
  s_nop 0
  buffer_load_dwordx4 v12, s[8:11], s22 offen lds
  buffer_load_dwordx4 v[48:51], v2, s[4:7], s20 offen
  buffer_load_dwordx4 v[52:55], v2, s[4:7], s21 offen
  s_add_u32 s20, s20, 1024
  s_add_u32 s21, s21, 1024
  s_add_u32 s22, s22, 20480
  s_add_u32 m0, s23, 25600
  s_nop 0
  buffer_load_dwordx4 v8, s[8:11], s22 offen lds
  s_add_u32 m0, s23, 26624
  s_nop 0
  buffer_load_dwordx4 v9, s[8:11], s22 offen lds
  s_add_u32 m0, s23, 27648
  s_nop 0
  buffer_load_dwordx4 v10, s[8:11], s22 offen lds
  s_add_u32 m0, s23, 28672
  s_nop 0
  buffer_load_dwordx4 v11, s[8:11], s22 offen lds
  s_add_u32 m0, s23, 29696
  s_nop 0
  buffer_load_dwordx4 v12, s[8:11], s22 offen lds
  buffer_load_dwordx4 v[56:59], v2, s[4:7], s20 offen
  buffer_load_dwordx4 v[60:63], v2, s[4:7], s21 offen
  s_add_u32 s20, s20, 1024
  s_add_u32 s21, s21, 1024
  s_add_u32 s22, s22, 20480
  s_waitcnt vmcnt(35)
  ds_read_b64_tr_b16 v[80:81], v3 offset:0
  ds_read_b64_tr_b16 v[82:83], v3 offset:2560
  ds_read_b64_tr_b16 v[84:85], v3 offset:64
  ds_read_b64_tr_b16 v[86:87], v3 offset:2624
  ds_read_b64_tr_b16 v[88:89], v3 offset:128
  ds_read_b64_tr_b16 v[90:91], v3 offset:2688
  ds_read_b64_tr_b16 v[92:93], v3 offset:192
  ds_read_b64_tr_b16 v[94:95], v3 offset:2752
  ds_read_b64_tr_b16 v[96:97], v3 offset:256
  ds_read_b64_tr_b16 v[98:99], v3 offset:2816
  s_waitcnt vmcnt(28) lgkmcnt(0)
  v_mfma_f32_32x32x16_bf16 a[0:15], v[80:83], v[16:19], 0
  ds_read_b64_tr_b16 v[120:121], v3 offset:5120
  v_mfma_f32_32x32x16_bf16 a[16:31], v[80:83], v[20:23], 0
  ds_read_b64_tr_b16 v[122:123], v3 offset:7680
  v_mfma_f32_32x32x16_bf16 a[32:47], v[84:87], v[16:19], 0
  ds_read_b64_tr_b16 v[124:125], v3 offset:5184
  v_mfma_f32_32x32x16_bf16 a[48:63], v[84:87], v[20:23], 0
  ds_read_b64_tr_b16 v[126:127], v3 offset:7744
  v_mfma_f32_32x32x16_bf16 a[64:79], v[88:91], v[16:19], 0
  ds_read_b64_tr_b16 v[128:129], v3 offset:5248
  v_mfma_f32_32x32x16_bf16 a[80:95], v[88:91], v[20:23], 0
  ds_read_b64_tr_b16 v[130:131], v3 offset:7808
  v_mfma_f32_32x32x16_bf16 a[96:111], v[92:95], v[16:19], 0
  ds_read_b64_tr_b16 v[132:133], v3 offset:5312
  v_mfma_f32_32x32x16_bf16 a[112:127], v[92:95], v[20:23], 0
  ds_read_b64_tr_b16 v[134:135], v3 offset:7872
  v_mfma_f32_32x32x16_bf16 a[128:143], v[96:99], v[16:19], 0
  ds_read_b64_tr_b16 v[136:137], v3 offset:5376
  v_mfma_f32_32x32x16_bf16 a[144:159], v[96:99], v[20:23], 0
  ds_read_b64_tr_b16 v[138:139], v3 offset:7936
  s_add_u32 m0, s23, 0
  s_nop 0
  buffer_load_dwordx4 v8, s[8:11], s22 offen lds
  s_add_u32 m0, s23, 1024
  s_nop 0
  buffer_load_dwordx4 v9, s[8:11], s22 offen lds
  s_add_u32 m0, s23, 2048
  s_nop 0
  buffer_load_dwordx4 v10, s[8:11], s22 offen lds
  s_add_u32 m0, s23, 3072
  s_nop 0
  buffer_load_dwordx4 v11, s[8:11], s22 offen lds
  s_add_u32 m0, s23, 4096
  s_nop 0
  buffer_load_dwordx4 v12, s[8:11], s22 offen lds
  buffer_load_dwordx4 v[16:19], v2, s[4:7], s20 offen
  buffer_load_dwordx4 v[20:23], v2, s[4:7], s21 offen
  s_add_u32 s20, s20, 1024
  s_add_u32 s21, s21, 1024
  s_add_u32 s22, s22, 20480
  s_waitcnt vmcnt(28) lgkmcnt(0)
  v_mfma_f32_32x32x16_bf16 a[0:15], v[120:123], v[24:27], a[0:15]
  ds_read_b64_tr_b16 v[80:81], v3 offset:10240
  v_mfma_f32_32x32x16_bf16 a[16:31], v[120:123], v[28:31], a[16:31]
  ds_read_b64_tr_b16 v[82:83], v3 offset:12800
  v_mfma_f32_32x32x16_bf16 a[32:47], v[124:127], v[24:27], a[32:47]
  ds_read_b64_tr_b16 v[84:85], v3 offset:10304
  v_mfma_f32_32x32x16_bf16 a[48:63], v[124:127], v[28:31], a[48:63]
  ds_read_b64_tr_b16 v[86:87], v3 offset:12864
  v_mfma_f32_32x32x16_bf16 a[64:79], v[128:131], v[24:27], a[64:79]
  ds_read_b64_tr_b16 v[88:89], v3 offset:10368
  v_mfma_f32_32x32x16_bf16 a[80:95], v[128:131], v[28:31], a[80:95]
  ds_read_b64_tr_b16 v[90:91], v3 offset:12928
  v_mfma_f32_32x32x16_bf16 a[96:111], v[132:135], v[24:27], a[96:111]
  ds_read_b64_tr_b16 v[92:93], v3 offset:10432
  v_mfma_f32_32x32x16_bf16 a[112:127], v[132:135], v[28:31], a[112:127]
  ds_read_b64_tr_b16 v[94:95], v3 offset:12992
  v_mfma_f32_32x32x16_bf16 a[128:143], v[136:139], v[24:27], a[128:143]
  ds_read_b64_tr_b16 v[96:97], v3 offset:10496
  v_mfma_f32_32x32x16_bf16 a[144:159], v[136:139], v[28:31], a[144:159]
  ds_read_b64_tr_b16 v[98:99], v3 offset:13056
  s_add_u32 m0, s23, 5120
  s_nop 0
  buffer_load_dwordx4 v8, s[8:11], s22 offen lds
  s_add_u32 m0, s23, 6144
  s_nop 0
  buffer_load_dwordx4 v9, s[8:11], s22 offen lds
  s_add_u32 m0, s23, 7168
  s_nop 0
  buffer_load_dwordx4 v10, s[8:11], s22 offen lds
  s_add_u32 m0, s23, 8192
  s_nop 0
  buffer_load_dwordx4 v11, s[8:11], s22 offen lds
  s_add_u32 m0, s23, 9216
  s_nop 0
  buffer_load_dwordx4 v12, s[8:11], s22 offen lds
  buffer_load_dwordx4 v[24:27], v2, s[4:7], s20 offen
  buffer_load_dwordx4 v[28:31], v2, s[4:7], s21 offen
  s_add_u32 s20, s20, 1024
  s_add_u32 s21, s21, 1024
  s_add_u32 s22, s22, 20480
  s_waitcnt vmcnt(28) lgkmcnt(0)
  v_mfma_f32_32x32x16_bf16 a[0:15], v[80:83], v[32:35], a[0:15]
  ds_read_b64_tr_b16 v[120:121], v3 offset:15360
  v_mfma_f32_32x32x16_bf16 a[16:31], v[80:83], v[36:39], a[16:31]
  ds_read_b64_tr_b16 v[122:123], v3 offset:17920
  v_mfma_f32_32x32x16_bf16 a[32:47], v[84:87], v[32:35], a[32:47]
  ds_read_b64_tr_b16 v[124:125], v3 offset:15424
  v_mfma_f32_32x32x16_bf16 a[48:63], v[84:87], v[36:39], a[48:63]
  ds_read_b64_tr_b16 v[126:127], v3 offset:17984
  v_mfma_f32_32x32x16_bf16 a[64:79], v[88:91], v[32:35], a[64:79]
  ds_read_b64_tr_b16 v[128:129], v3 offset:15488
  v_mfma_f32_32x32x16_bf16 a[80:95], v[88:91], v[36:39], a[80:95]
  ds_read_b64_tr_b16 v[130:131], v3 offset:18048
  v_mfma_f32_32x32x16_bf16 a[96:111], v[92:95], v[32:35], a[96:111]
  ds_read_b64_tr_b16 v[132:133], v3 offset:15552
  v_mfma_f32_32x32x16_bf16 a[112:127], v[92:95], v[36:39], a[112:127]
  ds_read_b64_tr_b16 v[134:135], v3 offset:18112
  v_mfma_f32_32x32x16_bf16 a[128:143], v[96:99], v[32:35], a[128:143]
  ds_read_b64_tr_b16 v[136:137], v3 offset:15616
  v_mfma_f32_32x32x16_bf16 a[144:159], v[96:99], v[36:39], a[144:159]
  ds_read_b64_tr_b16 v[138:139], v3 offset:18176
  s_add_u32 m0, s23, 10240
  s_nop 0
  buffer_load_dwordx4 v8, s[8:11], s22 offen lds
  s_add_u32 m0, s23, 11264
  s_nop 0
  buffer_load_dwordx4 v9, s[8:11], s22 offen lds
  s_add_u32 m0, s23, 12288
  s_nop 0
  buffer_load_dwordx4 v10, s[8:11], s22 offen lds
  s_add_u32 m0, s23, 13312
  s_nop 0
  buffer_load_dwordx4 v11, s[8:11], s22 offen lds
  s_add_u32 m0, s23, 14336
  s_nop 0
  buffer_load_dwordx4 v12, s[8:11], s22 offen lds
  buffer_load_dwordx4 v[32:35], v2, s[4:7], s20 offen
  buffer_load_dwordx4 v[36:39], v2, s[4:7], s21 offen
  s_add_u32 s20, s20, 1024
  s_add_u32 s21, s21, 1024
  s_add_u32 s22, s22, 20480
  s_waitcnt vmcnt(28) lgkmcnt(0)
  v_mfma_f32_32x32x16_bf16 a[0:15], v[120:123], v[40:43], a[0:15]
  ds_read_b64_tr_b16 v[80:81], v3 offset:20480
  v_mfma_f32_32x32x16_bf16 a[16:31], v[120:123], v[44:47], a[16:31]
  ds_read_b64_tr_b16 v[82:83], v3 offset:23040
  v_mfma_f32_32x32x16_bf16 a[32:47], v[124:127], v[40:43], a[32:47]
  ds_read_b64_tr_b16 v[84:85], v3 offset:20544
  v_mfma_f32_32x32x16_bf16 a[48:63], v[124:127], v[44:47], a[48:63]
  ds_read_b64_tr_b16 v[86:87], v3 offset:23104
  v_mfma_f32_32x32x16_bf16 a[64:79], v[128:131], v[40:43], a[64:79]
  ds_read_b64_tr_b16 v[88:89], v3 offset:20608
  v_mfma_f32_32x32x16_bf16 a[80:95], v[128:131], v[44:47], a[80:95]
  ds_read_b64_tr_b16 v[90:91], v3 offset:23168
  v_mfma_f32_32x32x16_bf16 a[96:111], v[132:135], v[40:43], a[96:111]
  ds_read_b64_tr_b16 v[92:93], v3 offset:20672
  v_mfma_f32_32x32x16_bf16 a[112:127], v[132:135], v[44:47], a[112:127]
  ds_read_b64_tr_b16 v[94:95], v3 offset:23232
  v_mfma_f32_32x32x16_bf16 a[128:143], v[136:139], v[40:43], a[128:143]
  ds_read_b64_tr_b16 v[96:97], v3 offset:20736
  v_mfma_f32_32x32x16_bf16 a[144:159], v[136:139], v[44:47], a[144:159]
  ds_read_b64_tr_b16 v[98:99], v3 offset:23296
  s_add_u32 m0, s23, 15360
  s_nop 0
  buffer_load_dwordx4 v8, s[8:11], s22 offen lds
  s_add_u32 m0, s23, 16384
  s_nop 0
  buffer_load_dwordx4 v9, s[8:11], s22 offen lds
  s_add_u32 m0, s23, 17408
  s_nop 0
  buffer_load_dwordx4 v10, s[8:11], s22 offen lds
  s_add_u32 m0, s23, 18432
  s_nop 0
  buffer_load_dwordx4 v11, s[8:11], s22 offen lds
  s_add_u32 m0, s23, 19456
  s_nop 0
  buffer_load_dwordx4 v12, s[8:11], s22 offen lds
  buffer_load_dwordx4 v[40:43], v2, s[4:7], s20 offen
  buffer_load_dwordx4 v[44:47], v2, s[4:7], s21 offen
  s_add_u32 s20, s20, 1024
  s_add_u32 s21, s21, 1024
  s_add_u32 s22, s22, 20480
  s_waitcnt vmcnt(28) lgkmcnt(0)
  v_mfma_f32_32x32x16_bf16 a[0:15], v[80:83], v[48:51], a[0:15]
  ds_read_b64_tr_b16 v[120:121], v3 offset:25600
  v_mfma_f32_32x32x16_bf16 a[16:31], v[80:83], v[52:55], a[16:31]
  ds_read_b64_tr_b16 v[122:123], v3 offset:28160
  v_mfma_f32_32x32x16_bf16 a[32:47], v[84:87], v[48:51], a[32:47]
  ds_read_b64_tr_b16 v[124:125], v3 offset:25664
  v_mfma_f32_32x32x16_bf16 a[48:63], v[84:87], v[52:55], a[48:63]
  ds_read_b64_tr_b16 v[126:127], v3 offset:28224
  v_mfma_f32_32x32x16_bf16 a[64:79], v[88:91], v[48:51], a[64:79]
  ds_read_b64_tr_b16 v[128:129], v3 offset:25728
  v_mfma_f32_32x32x16_bf16 a[80:95], v[88:91], v[52:55], a[80:95]
  ds_read_b64_tr_b16 v[130:131], v3 offset:28288
  v_mfma_f32_32x32x16_bf16 a[96:111], v[92:95], v[48:51], a[96:111]
  ds_read_b64_tr_b16 v[132:133], v3 offset:25792
  v_mfma_f32_32x32x16_bf16 a[112:127], v[92:95], v[52:55], a[112:127]
  ds_read_b64_tr_b16 v[134:135], v3 offset:28352
  v_mfma_f32_32x32x16_bf16 a[128:143], v[96:99], v[48:51], a[128:143]
  ds_read_b64_tr_b16 v[136:137], v3 offset:25856
  v_mfma_f32_32x32x16_bf16 a[144:159], v[96:99], v[52:55], a[144:159]
  ds_read_b64_tr_b16 v[138:139], v3 offset:28416
  s_add_u32 m0, s23, 20480
  s_nop 0
  buffer_load_dwordx4 v8, s[8:11], s22 offen lds
  s_add_u32 m0, s23, 21504
  s_nop 0
  buffer_load_dwordx4 v9, s[8:11], s22 offen lds
  s_add_u32 m0, s23, 22528
  s_nop 0
  buffer_load_dwordx4 v10, s[8:11], s22 offen lds
  s_add_u32 m0, s23, 23552
  s_nop 0
  buffer_load_dwordx4 v11, s[8:11], s22 offen lds
  s_add_u32 m0, s23, 24576
  s_nop 0
  buffer_load_dwordx4 v12, s[8:11], s22 offen lds
  buffer_load_dwordx4 v[48:51], v2, s[4:7], s20 offen
  buffer_load_dwordx4 v[52:55], v2, s[4:7], s21 offen
  s_add_u32 s20, s20, 1024
  s_add_u32 s21, s21, 1024
  s_add_u32 s22, s22, 20480
  s_waitcnt vmcnt(28) lgkmcnt(0)
  v_mfma_f32_32x32x16_bf16 a[0:15], v[120:123], v[56:59], a[0:15]
  ds_read_b64_tr_b16 v[80:81], v3 offset:0
  v_mfma_f32_32x32x16_bf16 a[16:31], v[120:123], v[60:63], a[16:31]
  ds_read_b64_tr_b16 v[82:83], v3 offset:2560
  v_mfma_f32_32x32x16_bf16 a[32:47], v[124:127], v[56:59], a[32:47]
  ds_read_b64_tr_b16 v[84:85], v3 offset:64
  v_mfma_f32_32x32x16_bf16 a[48:63], v[124:127], v[60:63], a[48:63]
  ds_read_b64_tr_b16 v[86:87], v3 offset:2624
  v_mfma_f32_32x32x16_bf16 a[64:79], v[128:131], v[56:59], a[64:79]
  ds_read_b64_tr_b16 v[88:89], v3 offset:128
  v_mfma_f32_32x32x16_bf16 a[80:95], v[128:131], v[60:63], a[80:95]
  ds_read_b64_tr_b16 v[90:91], v3 offset:2688
  v_mfma_f32_32x32x16_bf16 a[96:111], v[132:135], v[56:59], a[96:111]
  ds_read_b64_tr_b16 v[92:93], v3 offset:192
  v_mfma_f32_32x32x16_bf16 a[112:127], v[132:135], v[60:63], a[112:127]
  ds_read_b64_tr_b16 v[94:95], v3 offset:2752
  v_mfma_f32_32x32x16_bf16 a[128:143], v[136:139], v[56:59], a[128:143]
  ds_read_b64_tr_b16 v[96:97], v3 offset:256
  v_mfma_f32_32x32x16_bf16 a[144:159], v[136:139], v[60:63], a[144:159]
  ds_read_b64_tr_b16 v[98:99], v3 offset:2816
  s_add_u32 m0, s23, 25600
  s_nop 0
  buffer_load_dwordx4 v8, s[8:11], s22 offen lds
  s_add_u32 m0, s23, 26624
  s_nop 0
  buffer_load_dwordx4 v9, s[8:11], s22 offen lds
  s_add_u32 m0, s23, 27648
  s_nop 0
  buffer_load_dwordx4 v10, s[8:11], s22 offen lds
  s_add_u32 m0, s23, 28672
  s_nop 0
  buffer_load_dwordx4 v11, s[8:11], s22 offen lds
  s_add_u32 m0, s23, 29696
  s_nop 0
  buffer_load_dwordx4 v12, s[8:11], s22 offen lds
  buffer_load_dwordx4 v[56:59], v2, s[4:7], s20 offen
  buffer_load_dwordx4 v[60:63], v2, s[4:7], s21 offen
  s_add_u32 s20, s20, 1024
  s_add_u32 s21, s21, 1024
  s_add_u32 s22, s22, 20480
  s_mov_b32 s24, 14
OP_28_loop:
  s_waitcnt vmcnt(28) lgkmcnt(0)
  v_mfma_f32_32x32x16_bf16 a[0:15], v[80:83], v[16:19], a[0:15]
  ds_read_b64_tr_b16 v[120:121], v3 offset:5120
  v_mfma_f32_32x32x16_bf16 a[16:31], v[80:83], v[20:23], a[16:31]
  ds_read_b64_tr_b16 v[122:123], v3 offset:7680
  v_mfma_f32_32x32x16_bf16 a[32:47], v[84:87], v[16:19], a[32:47]
  ds_read_b64_tr_b16 v[124:125], v3 offset:5184
  v_mfma_f32_32x32x16_bf16 a[48:63], v[84:87], v[20:23], a[48:63]
  ds_read_b64_tr_b16 v[126:127], v3 offset:7744
  v_mfma_f32_32x32x16_bf16 a[64:79], v[88:91], v[16:19], a[64:79]
  ds_read_b64_tr_b16 v[128:129], v3 offset:5248
  v_mfma_f32_32x32x16_bf16 a[80:95], v[88:91], v[20:23], a[80:95]
  ds_read_b64_tr_b16 v[130:131], v3 offset:7808
  v_mfma_f32_32x32x16_bf16 a[96:111], v[92:95], v[16:19], a[96:111]
  ds_read_b64_tr_b16 v[132:133], v3 offset:5312
  v_mfma_f32_32x32x16_bf16 a[112:127], v[92:95], v[20:23], a[112:127]
  ds_read_b64_tr_b16 v[134:135], v3 offset:7872
  v_mfma_f32_32x32x16_bf16 a[128:143], v[96:99], v[16:19], a[128:143]
  ds_read_b64_tr_b16 v[136:137], v3 offset:5376
  v_mfma_f32_32x32x16_bf16 a[144:159], v[96:99], v[20:23], a[144:159]
  ds_read_b64_tr_b16 v[138:139], v3 offset:7936
  s_add_u32 m0, s23, 0
  s_nop 0
  buffer_load_dwordx4 v8, s[8:11], s22 offen lds
  s_add_u32 m0, s23, 1024
  s_nop 0
  buffer_load_dwordx4 v9, s[8:11], s22 offen lds
  s_add_u32 m0, s23, 2048
  s_nop 0
  buffer_load_dwordx4 v10, s[8:11], s22 offen lds
  s_add_u32 m0, s23, 3072
  s_nop 0
  buffer_load_dwordx4 v11, s[8:11], s22 offen lds
  s_add_u32 m0, s23, 4096
  s_nop 0
  buffer_load_dwordx4 v12, s[8:11], s22 offen lds
  buffer_load_dwordx4 v[16:19], v2, s[4:7], s20 offen
  buffer_load_dwordx4 v[20:23], v2, s[4:7], s21 offen
  s_add_u32 s20, s20, 1024
  s_add_u32 s21, s21, 1024
  s_add_u32 s22, s22, 20480
  s_waitcnt vmcnt(28) lgkmcnt(0)
  v_mfma_f32_32x32x16_bf16 a[0:15], v[120:123], v[24:27], a[0:15]
  ds_read_b64_tr_b16 v[80:81], v3 offset:10240
  v_mfma_f32_32x32x16_bf16 a[16:31], v[120:123], v[28:31], a[16:31]
  ds_read_b64_tr_b16 v[82:83], v3 offset:12800
  v_mfma_f32_32x32x16_bf16 a[32:47], v[124:127], v[24:27], a[32:47]
  ds_read_b64_tr_b16 v[84:85], v3 offset:10304
  v_mfma_f32_32x32x16_bf16 a[48:63], v[124:127], v[28:31], a[48:63]
  ds_read_b64_tr_b16 v[86:87], v3 offset:12864
  v_mfma_f32_32x32x16_bf16 a[64:79], v[128:131], v[24:27], a[64:79]
  ds_read_b64_tr_b16 v[88:89], v3 offset:10368
  v_mfma_f32_32x32x16_bf16 a[80:95], v[128:131], v[28:31], a[80:95]
  ds_read_b64_tr_b16 v[90:91], v3 offset:12928
  v_mfma_f32_32x32x16_bf16 a[96:111], v[132:135], v[24:27], a[96:111]
  ds_read_b64_tr_b16 v[92:93], v3 offset:10432
  v_mfma_f32_32x32x16_bf16 a[112:127], v[132:135], v[28:31], a[112:127]
  ds_read_b64_tr_b16 v[94:95], v3 offset:12992
  v_mfma_f32_32x32x16_bf16 a[128:143], v[136:139], v[24:27], a[128:143]
  ds_read_b64_tr_b16 v[96:97], v3 offset:10496
  v_mfma_f32_32x32x16_bf16 a[144:159], v[136:139], v[28:31], a[144:159]
  ds_read_b64_tr_b16 v[98:99], v3 offset:13056
  s_add_u32 m0, s23, 5120
  s_nop 0
  buffer_load_dwordx4 v8, s[8:11], s22 offen lds
  s_add_u32 m0, s23, 6144
  s_nop 0
  buffer_load_dwordx4 v9, s[8:11], s22 offen lds
  s_add_u32 m0, s23, 7168
  s_nop 0
  buffer_load_dwordx4 v10, s[8:11], s22 offen lds
  s_add_u32 m0, s23, 8192
  s_nop 0
  buffer_load_dwordx4 v11, s[8:11], s22 offen lds
  s_add_u32 m0, s23, 9216
  s_nop 0
  buffer_load_dwordx4 v12, s[8:11], s22 offen lds
  buffer_load_dwordx4 v[24:27], v2, s[4:7], s20 offen
  buffer_load_dwordx4 v[28:31], v2, s[4:7], s21 offen
  s_add_u32 s20, s20, 1024
  s_add_u32 s21, s21, 1024
  s_add_u32 s22, s22, 20480
  s_waitcnt vmcnt(28) lgkmcnt(0)
  v_mfma_f32_32x32x16_bf16 a[0:15], v[80:83], v[32:35], a[0:15]
  ds_read_b64_tr_b16 v[120:121], v3 offset:15360
  v_mfma_f32_32x32x16_bf16 a[16:31], v[80:83], v[36:39], a[16:31]
  ds_read_b64_tr_b16 v[122:123], v3 offset:17920
  v_mfma_f32_32x32x16_bf16 a[32:47], v[84:87], v[32:35], a[32:47]
  ds_read_b64_tr_b16 v[124:125], v3 offset:15424
  v_mfma_f32_32x32x16_bf16 a[48:63], v[84:87], v[36:39], a[48:63]
  ds_read_b64_tr_b16 v[126:127], v3 offset:17984
  v_mfma_f32_32x32x16_bf16 a[64:79], v[88:91], v[32:35], a[64:79]
  ds_read_b64_tr_b16 v[128:129], v3 offset:15488
  v_mfma_f32_32x32x16_bf16 a[80:95], v[88:91], v[36:39], a[80:95]
  ds_read_b64_tr_b16 v[130:131], v3 offset:18048
  v_mfma_f32_32x32x16_bf16 a[96:111], v[92:95], v[32:35], a[96:111]
  ds_read_b64_tr_b16 v[132:133], v3 offset:15552
  v_mfma_f32_32x32x16_bf16 a[112:127], v[92:95], v[36:39], a[112:127]
  ds_read_b64_tr_b16 v[134:135], v3 offset:18112
  v_mfma_f32_32x32x16_bf16 a[128:143], v[96:99], v[32:35], a[128:143]
  ds_read_b64_tr_b16 v[136:137], v3 offset:15616
  v_mfma_f32_32x32x16_bf16 a[144:159], v[96:99], v[36:39], a[144:159]
  ds_read_b64_tr_b16 v[138:139], v3 offset:18176
  s_add_u32 m0, s23, 10240
  s_nop 0
  buffer_load_dwordx4 v8, s[8:11], s22 offen lds
  s_add_u32 m0, s23, 11264
  s_nop 0
  buffer_load_dwordx4 v9, s[8:11], s22 offen lds
  s_add_u32 m0, s23, 12288
  s_nop 0
  buffer_load_dwordx4 v10, s[8:11], s22 offen lds
  s_add_u32 m0, s23, 13312
  s_nop 0
  buffer_load_dwordx4 v11, s[8:11], s22 offen lds
  s_add_u32 m0, s23, 14336
  s_nop 0
  buffer_load_dwordx4 v12, s[8:11], s22 offen lds
  buffer_load_dwordx4 v[32:35], v2, s[4:7], s20 offen
  buffer_load_dwordx4 v[36:39], v2, s[4:7], s21 offen
  s_add_u32 s20, s20, 1024
  s_add_u32 s21, s21, 1024
  s_add_u32 s22, s22, 20480
  s_waitcnt vmcnt(28) lgkmcnt(0)
  v_mfma_f32_32x32x16_bf16 a[0:15], v[120:123], v[40:43], a[0:15]
  ds_read_b64_tr_b16 v[80:81], v3 offset:20480
  v_mfma_f32_32x32x16_bf16 a[16:31], v[120:123], v[44:47], a[16:31]
  ds_read_b64_tr_b16 v[82:83], v3 offset:23040
  v_mfma_f32_32x32x16_bf16 a[32:47], v[124:127], v[40:43], a[32:47]
  ds_read_b64_tr_b16 v[84:85], v3 offset:20544
  v_mfma_f32_32x32x16_bf16 a[48:63], v[124:127], v[44:47], a[48:63]
  ds_read_b64_tr_b16 v[86:87], v3 offset:23104
  v_mfma_f32_32x32x16_bf16 a[64:79], v[128:131], v[40:43], a[64:79]
  ds_read_b64_tr_b16 v[88:89], v3 offset:20608
  v_mfma_f32_32x32x16_bf16 a[80:95], v[128:131], v[44:47], a[80:95]
  ds_read_b64_tr_b16 v[90:91], v3 offset:23168
  v_mfma_f32_32x32x16_bf16 a[96:111], v[132:135], v[40:43], a[96:111]
  ds_read_b64_tr_b16 v[92:93], v3 offset:20672
  v_mfma_f32_32x32x16_bf16 a[112:127], v[132:135], v[44:47], a[112:127]
  ds_read_b64_tr_b16 v[94:95], v3 offset:23232
  v_mfma_f32_32x32x16_bf16 a[128:143], v[136:139], v[40:43], a[128:143]
  ds_read_b64_tr_b16 v[96:97], v3 offset:20736
  v_mfma_f32_32x32x16_bf16 a[144:159], v[136:139], v[44:47], a[144:159]
  ds_read_b64_tr_b16 v[98:99], v3 offset:23296
  s_add_u32 m0, s23, 15360
  s_nop 0
  buffer_load_dwordx4 v8, s[8:11], s22 offen lds
  s_add_u32 m0, s23, 16384
  s_nop 0
  buffer_load_dwordx4 v9, s[8:11], s22 offen lds
  s_add_u32 m0, s23, 17408
  s_nop 0
  buffer_load_dwordx4 v10, s[8:11], s22 offen lds
  s_add_u32 m0, s23, 18432
  s_nop 0
  buffer_load_dwordx4 v11, s[8:11], s22 offen lds
  s_add_u32 m0, s23, 19456
  s_nop 0
  buffer_load_dwordx4 v12, s[8:11], s22 offen lds
  buffer_load_dwordx4 v[40:43], v2, s[4:7], s20 offen
  buffer_load_dwordx4 v[44:47], v2, s[4:7], s21 offen
  s_add_u32 s20, s20, 1024
  s_add_u32 s21, s21, 1024
  s_add_u32 s22, s22, 20480
  s_waitcnt vmcnt(28) lgkmcnt(0)
  v_mfma_f32_32x32x16_bf16 a[0:15], v[80:83], v[48:51], a[0:15]
  ds_read_b64_tr_b16 v[120:121], v3 offset:25600
  v_mfma_f32_32x32x16_bf16 a[16:31], v[80:83], v[52:55], a[16:31]
  ds_read_b64_tr_b16 v[122:123], v3 offset:28160
  v_mfma_f32_32x32x16_bf16 a[32:47], v[84:87], v[48:51], a[32:47]
  ds_read_b64_tr_b16 v[124:125], v3 offset:25664
  v_mfma_f32_32x32x16_bf16 a[48:63], v[84:87], v[52:55], a[48:63]
  ds_read_b64_tr_b16 v[126:127], v3 offset:28224
  v_mfma_f32_32x32x16_bf16 a[64:79], v[88:91], v[48:51], a[64:79]
  ds_read_b64_tr_b16 v[128:129], v3 offset:25728
  v_mfma_f32_32x32x16_bf16 a[80:95], v[88:91], v[52:55], a[80:95]
  ds_read_b64_tr_b16 v[130:131], v3 offset:28288
  v_mfma_f32_32x32x16_bf16 a[96:111], v[92:95], v[48:51], a[96:111]
  ds_read_b64_tr_b16 v[132:133], v3 offset:25792
  v_mfma_f32_32x32x16_bf16 a[112:127], v[92:95], v[52:55], a[112:127]
  ds_read_b64_tr_b16 v[134:135], v3 offset:28352
  v_mfma_f32_32x32x16_bf16 a[128:143], v[96:99], v[48:51], a[128:143]
  ds_read_b64_tr_b16 v[136:137], v3 offset:25856
  v_mfma_f32_32x32x16_bf16 a[144:159], v[96:99], v[52:55], a[144:159]
  ds_read_b64_tr_b16 v[138:139], v3 offset:28416
  s_add_u32 m0, s23, 20480
  s_nop 0
  buffer_load_dwordx4 v8, s[8:11], s22 offen lds
  s_add_u32 m0, s23, 21504
  s_nop 0
  buffer_load_dwordx4 v9, s[8:11], s22 offen lds
  s_add_u32 m0, s23, 22528
  s_nop 0
  buffer_load_dwordx4 v10, s[8:11], s22 offen lds
  s_add_u32 m0, s23, 23552
  s_nop 0
  buffer_load_dwordx4 v11, s[8:11], s22 offen lds
  s_add_u32 m0, s23, 24576
  s_nop 0
  buffer_load_dwordx4 v12, s[8:11], s22 offen lds
  buffer_load_dwordx4 v[48:51], v2, s[4:7], s20 offen
  buffer_load_dwordx4 v[52:55], v2, s[4:7], s21 offen
  s_add_u32 s20, s20, 1024
  s_add_u32 s21, s21, 1024
  s_add_u32 s22, s22, 20480
  s_waitcnt vmcnt(28) lgkmcnt(0)
  v_mfma_f32_32x32x16_bf16 a[0:15], v[120:123], v[56:59], a[0:15]
  ds_read_b64_tr_b16 v[80:81], v3 offset:0
  v_mfma_f32_32x32x16_bf16 a[16:31], v[120:123], v[60:63], a[16:31]
  ds_read_b64_tr_b16 v[82:83], v3 offset:2560
  v_mfma_f32_32x32x16_bf16 a[32:47], v[124:127], v[56:59], a[32:47]
  ds_read_b64_tr_b16 v[84:85], v3 offset:64
  v_mfma_f32_32x32x16_bf16 a[48:63], v[124:127], v[60:63], a[48:63]
  ds_read_b64_tr_b16 v[86:87], v3 offset:2624
  v_mfma_f32_32x32x16_bf16 a[64:79], v[128:131], v[56:59], a[64:79]
  ds_read_b64_tr_b16 v[88:89], v3 offset:128
  v_mfma_f32_32x32x16_bf16 a[80:95], v[128:131], v[60:63], a[80:95]
  ds_read_b64_tr_b16 v[90:91], v3 offset:2688
  v_mfma_f32_32x32x16_bf16 a[96:111], v[132:135], v[56:59], a[96:111]
  ds_read_b64_tr_b16 v[92:93], v3 offset:192
  v_mfma_f32_32x32x16_bf16 a[112:127], v[132:135], v[60:63], a[112:127]
  ds_read_b64_tr_b16 v[94:95], v3 offset:2752
  v_mfma_f32_32x32x16_bf16 a[128:143], v[136:139], v[56:59], a[128:143]
  ds_read_b64_tr_b16 v[96:97], v3 offset:256
  v_mfma_f32_32x32x16_bf16 a[144:159], v[136:139], v[60:63], a[144:159]
  ds_read_b64_tr_b16 v[98:99], v3 offset:2816
  s_add_u32 m0, s23, 25600
  s_nop 0
  buffer_load_dwordx4 v8, s[8:11], s22 offen lds
  s_add_u32 m0, s23, 26624
  s_nop 0
  buffer_load_dwordx4 v9, s[8:11], s22 offen lds
  s_add_u32 m0, s23, 27648
  s_nop 0
  buffer_load_dwordx4 v10, s[8:11], s22 offen lds
  s_add_u32 m0, s23, 28672
  s_nop 0
  buffer_load_dwordx4 v11, s[8:11], s22 offen lds
  s_add_u32 m0, s23, 29696
  s_nop 0
  buffer_load_dwordx4 v12, s[8:11], s22 offen lds
  buffer_load_dwordx4 v[56:59], v2, s[4:7], s20 offen
  buffer_load_dwordx4 v[60:63], v2, s[4:7], s21 offen
  s_add_u32 s20, s20, 1024
  s_add_u32 s21, s21, 1024
  s_add_u32 s22, s22, 20480
  s_sub_u32 s24, s24, 1
  s_cmp_lg_u32 s24, 0
  s_cbranch_scc1 OP_28_loop
  s_cmp_eq_u32 s80, 0
  s_cbranch_scc0 TI_29
  v_mov_b32 v255, 1
  s_mov_b64 exec, 1
  buffer_atomic_add v255, off, s[84:87], s97 sc0 sc1
  s_mov_b64 exec, -1
TI_29:
  s_waitcnt vmcnt(28) lgkmcnt(0)
  v_mfma_f32_32x32x16_bf16 a[0:15], v[80:83], v[16:19], a[0:15]
  ds_read_b64_tr_b16 v[120:121], v3 offset:5120
  v_mfma_f32_32x32x16_bf16 a[16:31], v[80:83], v[20:23], a[16:31]
  ds_read_b64_tr_b16 v[122:123], v3 offset:7680
  v_mfma_f32_32x32x16_bf16 a[32:47], v[84:87], v[16:19], a[32:47]
  ds_read_b64_tr_b16 v[124:125], v3 offset:5184
  v_mfma_f32_32x32x16_bf16 a[48:63], v[84:87], v[20:23], a[48:63]
  ds_read_b64_tr_b16 v[126:127], v3 offset:7744
  v_mfma_f32_32x32x16_bf16 a[64:79], v[88:91], v[16:19], a[64:79]
  ds_read_b64_tr_b16 v[128:129], v3 offset:5248
  v_mfma_f32_32x32x16_bf16 a[80:95], v[88:91], v[20:23], a[80:95]
  ds_read_b64_tr_b16 v[130:131], v3 offset:7808
  v_mfma_f32_32x32x16_bf16 a[96:111], v[92:95], v[16:19], a[96:111]
  ds_read_b64_tr_b16 v[132:133], v3 offset:5312
  v_mfma_f32_32x32x16_bf16 a[112:127], v[92:95], v[20:23], a[112:127]
  ds_read_b64_tr_b16 v[134:135], v3 offset:7872
  v_mfma_f32_32x32x16_bf16 a[128:143], v[96:99], v[16:19], a[128:143]
  ds_read_b64_tr_b16 v[136:137], v3 offset:5376
  v_mfma_f32_32x32x16_bf16 a[144:159], v[96:99], v[20:23], a[144:159]
  ds_read_b64_tr_b16 v[138:139], v3 offset:7936
  s_waitcnt vmcnt(21) lgkmcnt(0)
  v_mfma_f32_32x32x16_bf16 a[0:15], v[120:123], v[24:27], a[0:15]
  ds_read_b64_tr_b16 v[80:81], v3 offset:10240
  v_mfma_f32_32x32x16_bf16 a[16:31], v[120:123], v[28:31], a[16:31]
  ds_read_b64_tr_b16 v[82:83], v3 offset:12800
  v_mfma_f32_32x32x16_bf16 a[32:47], v[124:127], v[24:27], a[32:47]
  ds_read_b64_tr_b16 v[84:85], v3 offset:10304
  v_mfma_f32_32x32x16_bf16 a[48:63], v[124:127], v[28:31], a[48:63]
  ds_read_b64_tr_b16 v[86:87], v3 offset:12864
  v_mfma_f32_32x32x16_bf16 a[64:79], v[128:131], v[24:27], a[64:79]
  ds_read_b64_tr_b16 v[88:89], v3 offset:10368
  v_mfma_f32_32x32x16_bf16 a[80:95], v[128:131], v[28:31], a[80:95]
  ds_read_b64_tr_b16 v[90:91], v3 offset:12928
  v_mfma_f32_32x32x16_bf16 a[96:111], v[132:135], v[24:27], a[96:111]
  ds_read_b64_tr_b16 v[92:93], v3 offset:10432
  v_mfma_f32_32x32x16_bf16 a[112:127], v[132:135], v[28:31], a[112:127]
  ds_read_b64_tr_b16 v[94:95], v3 offset:12992
  v_mfma_f32_32x32x16_bf16 a[128:143], v[136:139], v[24:27], a[128:143]
  ds_read_b64_tr_b16 v[96:97], v3 offset:10496
  v_mfma_f32_32x32x16_bf16 a[144:159], v[136:139], v[28:31], a[144:159]
  ds_read_b64_tr_b16 v[98:99], v3 offset:13056
  s_waitcnt vmcnt(14) lgkmcnt(0)
  v_mfma_f32_32x32x16_bf16 a[0:15], v[80:83], v[32:35], a[0:15]
  ds_read_b64_tr_b16 v[120:121], v3 offset:15360
  v_mfma_f32_32x32x16_bf16 a[16:31], v[80:83], v[36:39], a[16:31]
  ds_read_b64_tr_b16 v[122:123], v3 offset:17920
  v_mfma_f32_32x32x16_bf16 a[32:47], v[84:87], v[32:35], a[32:47]
  ds_read_b64_tr_b16 v[124:125], v3 offset:15424
  v_mfma_f32_32x32x16_bf16 a[48:63], v[84:87], v[36:39], a[48:63]
  ds_read_b64_tr_b16 v[126:127], v3 offset:17984
  v_mfma_f32_32x32x16_bf16 a[64:79], v[88:91], v[32:35], a[64:79]
  ds_read_b64_tr_b16 v[128:129], v3 offset:15488
  v_mfma_f32_32x32x16_bf16 a[80:95], v[88:91], v[36:39], a[80:95]
  ds_read_b64_tr_b16 v[130:131], v3 offset:18048
  v_mfma_f32_32x32x16_bf16 a[96:111], v[92:95], v[32:35], a[96:111]
  ds_read_b64_tr_b16 v[132:133], v3 offset:15552
  v_mfma_f32_32x32x16_bf16 a[112:127], v[92:95], v[36:39], a[112:127]
  ds_read_b64_tr_b16 v[134:135], v3 offset:18112
  v_mfma_f32_32x32x16_bf16 a[128:143], v[96:99], v[32:35], a[128:143]
  ds_read_b64_tr_b16 v[136:137], v3 offset:15616
  v_mfma_f32_32x32x16_bf16 a[144:159], v[96:99], v[36:39], a[144:159]
  ds_read_b64_tr_b16 v[138:139], v3 offset:18176
  s_waitcnt vmcnt(7) lgkmcnt(0)
  v_mfma_f32_32x32x16_bf16 a[0:15], v[120:123], v[40:43], a[0:15]
  ds_read_b64_tr_b16 v[80:81], v3 offset:20480
  v_mfma_f32_32x32x16_bf16 a[16:31], v[120:123], v[44:47], a[16:31]
  ds_read_b64_tr_b16 v[82:83], v3 offset:23040
  v_mfma_f32_32x32x16_bf16 a[32:47], v[124:127], v[40:43], a[32:47]
  ds_read_b64_tr_b16 v[84:85], v3 offset:20544
  v_mfma_f32_32x32x16_bf16 a[48:63], v[124:127], v[44:47], a[48:63]
  ds_read_b64_tr_b16 v[86:87], v3 offset:23104
  v_mfma_f32_32x32x16_bf16 a[64:79], v[128:131], v[40:43], a[64:79]
  ds_read_b64_tr_b16 v[88:89], v3 offset:20608
  v_mfma_f32_32x32x16_bf16 a[80:95], v[128:131], v[44:47], a[80:95]
  ds_read_b64_tr_b16 v[90:91], v3 offset:23168
  v_mfma_f32_32x32x16_bf16 a[96:111], v[132:135], v[40:43], a[96:111]
  ds_read_b64_tr_b16 v[92:93], v3 offset:20672
  v_mfma_f32_32x32x16_bf16 a[112:127], v[132:135], v[44:47], a[112:127]
  ds_read_b64_tr_b16 v[94:95], v3 offset:23232
  v_mfma_f32_32x32x16_bf16 a[128:143], v[136:139], v[40:43], a[128:143]
  ds_read_b64_tr_b16 v[96:97], v3 offset:20736
  v_mfma_f32_32x32x16_bf16 a[144:159], v[136:139], v[44:47], a[144:159]
  ds_read_b64_tr_b16 v[98:99], v3 offset:23296
  s_waitcnt vmcnt(0) lgkmcnt(0)
  v_mfma_f32_32x32x16_bf16 a[0:15], v[80:83], v[48:51], a[0:15]
  ds_read_b64_tr_b16 v[120:121], v3 offset:25600
  v_mfma_f32_32x32x16_bf16 a[16:31], v[80:83], v[52:55], a[16:31]
  ds_read_b64_tr_b16 v[122:123], v3 offset:28160
  v_mfma_f32_32x32x16_bf16 a[32:47], v[84:87], v[48:51], a[32:47]
  ds_read_b64_tr_b16 v[124:125], v3 offset:25664
  v_mfma_f32_32x32x16_bf16 a[48:63], v[84:87], v[52:55], a[48:63]
  ds_read_b64_tr_b16 v[126:127], v3 offset:28224
  v_mfma_f32_32x32x16_bf16 a[64:79], v[88:91], v[48:51], a[64:79]
  ds_read_b64_tr_b16 v[128:129], v3 offset:25728
  v_mfma_f32_32x32x16_bf16 a[80:95], v[88:91], v[52:55], a[80:95]
  ds_read_b64_tr_b16 v[130:131], v3 offset:28288
  v_mfma_f32_32x32x16_bf16 a[96:111], v[92:95], v[48:51], a[96:111]
  ds_read_b64_tr_b16 v[132:133], v3 offset:25792
  v_mfma_f32_32x32x16_bf16 a[112:127], v[92:95], v[52:55], a[112:127]
  ds_read_b64_tr_b16 v[134:135], v3 offset:28352
  v_mfma_f32_32x32x16_bf16 a[128:143], v[96:99], v[48:51], a[128:143]
  ds_read_b64_tr_b16 v[136:137], v3 offset:25856
  v_mfma_f32_32x32x16_bf16 a[144:159], v[96:99], v[52:55], a[144:159]
  ds_read_b64_tr_b16 v[138:139], v3 offset:28416
  s_waitcnt lgkmcnt(0)
  v_mfma_f32_32x32x16_bf16 a[0:15], v[120:123], v[56:59], a[0:15]
  v_mfma_f32_32x32x16_bf16 a[16:31], v[120:123], v[60:63], a[16:31]
  v_mfma_f32_32x32x16_bf16 a[32:47], v[124:127], v[56:59], a[32:47]
  v_mfma_f32_32x32x16_bf16 a[48:63], v[124:127], v[60:63], a[48:63]
  v_mfma_f32_32x32x16_bf16 a[64:79], v[128:131], v[56:59], a[64:79]
  v_mfma_f32_32x32x16_bf16 a[80:95], v[128:131], v[60:63], a[80:95]
  v_mfma_f32_32x32x16_bf16 a[96:111], v[132:135], v[56:59], a[96:111]
  v_mfma_f32_32x32x16_bf16 a[112:127], v[132:135], v[60:63], a[112:127]
  v_mfma_f32_32x32x16_bf16 a[128:143], v[136:139], v[56:59], a[128:143]
  v_mfma_f32_32x32x16_bf16 a[144:159], v[136:139], v[60:63], a[144:159]
  s_waitcnt vmcnt(0)
  v_readfirstlane_b32 s96, v255
  s_nop 7
  s_nop 7
  v_add_u32 v5, s23, v2
  s_cmp_eq_u32 s80, 0
  s_cbranch_scc0 OP_28_w0
  ds_write_b128 v5, a[16:19] offset:0
  ds_write_b128 v5, a[20:23] offset:1024
  ds_write_b128 v5, a[24:27] offset:2048
  ds_write_b128 v5, a[28:31] offset:3072
  ds_write_b128 v5, a[32:35] offset:4096
  ds_write_b128 v5, a[36:39] offset:5120
  ds_write_b128 v5, a[40:43] offset:6144
  ds_write_b128 v5, a[44:47] offset:7168
  ds_write_b128 v5, a[48:51] offset:8192
  ds_write_b128 v5, a[52:55] offset:9216
  ds_write_b128 v5, a[56:59] offset:10240
  ds_write_b128 v5, a[60:63] offset:11264
  ds_write_b128 v5, a[80:83] offset:12288
  ds_write_b128 v5, a[84:87] offset:13312
  ds_write_b128 v5, a[88:91] offset:14336
  ds_write_b128 v5, a[92:95] offset:15360
  ds_write_b128 v5, a[96:99] offset:16384
  ds_write_b128 v5, a[100:103] offset:17408
  ds_write_b128 v5, a[104:107] offset:18432
  ds_write_b128 v5, a[108:111] offset:19456
  ds_write_b128 v5, a[112:115] offset:20480
  ds_write_b128 v5, a[116:119] offset:21504
  ds_write_b128 v5, a[120:123] offset:22528
  ds_write_b128 v5, a[124:127] offset:23552
  ds_write_b128 v5, a[144:147] offset:24576
  ds_write_b128 v5, a[148:151] offset:25600
  ds_write_b128 v5, a[152:155] offset:26624
  ds_write_b128 v5, a[156:159] offset:27648
OP_28_w0:
  s_cmp_eq_u32 s80, 1
  s_cbranch_scc0 OP_28_w1
  ds_write_b128 v5, a[0:3] offset:0
  ds_write_b128 v5, a[4:7] offset:1024
  ds_write_b128 v5, a[8:11] offset:2048
  ds_write_b128 v5, a[12:15] offset:3072
  ds_write_b128 v5, a[32:35] offset:4096
  ds_write_b128 v5, a[36:39] offset:5120
  ds_write_b128 v5, a[40:43] offset:6144
  ds_write_b128 v5, a[44:47] offset:7168
  ds_write_b128 v5, a[48:51] offset:8192
  ds_write_b128 v5, a[52:55] offset:9216
  ds_write_b128 v5, a[56:59] offset:10240
  ds_write_b128 v5, a[60:63] offset:11264
  ds_write_b128 v5, a[64:67] offset:12288
  ds_write_b128 v5, a[68:71] offset:13312
  ds_write_b128 v5, a[72:75] offset:14336
  ds_write_b128 v5, a[76:79] offset:15360
  ds_write_b128 v5, a[96:99] offset:16384
  ds_write_b128 v5, a[100:103] offset:17408
  ds_write_b128 v5, a[104:107] offset:18432
  ds_write_b128 v5, a[108:111] offset:19456
  ds_write_b128 v5, a[112:115] offset:20480
  ds_write_b128 v5, a[116:119] offset:21504
  ds_write_b128 v5, a[120:123] offset:22528
  ds_write_b128 v5, a[124:127] offset:23552
  ds_write_b128 v5, a[128:131] offset:24576
  ds_write_b128 v5, a[132:135] offset:25600
  ds_write_b128 v5, a[136:139] offset:26624
  ds_write_b128 v5, a[140:143] offset:27648
OP_28_w1:
  s_cmp_eq_u32 s80, 2
  s_cbranch_scc0 OP_28_w2
  ds_write_b128 v5, a[0:3] offset:0
  ds_write_b128 v5, a[4:7] offset:1024
  ds_write_b128 v5, a[8:11] offset:2048
  ds_write_b128 v5, a[12:15] offset:3072
  ds_write_b128 v5, a[16:19] offset:4096
  ds_write_b128 v5, a[20:23] offset:5120
  ds_write_b128 v5, a[24:27] offset:6144
  ds_write_b128 v5, a[28:31] offset:7168
  ds_write_b128 v5, a[48:51] offset:8192
  ds_write_b128 v5, a[52:55] offset:9216
  ds_write_b128 v5, a[56:59] offset:10240
  ds_write_b128 v5, a[60:63] offset:11264
  ds_write_b128 v5, a[64:67] offset:12288
  ds_write_b128 v5, a[68:71] offset:13312
  ds_write_b128 v5, a[72:75] offset:14336
  ds_write_b128 v5, a[76:79] offset:15360
  ds_write_b128 v5, a[80:83] offset:16384
  ds_write_b128 v5, a[84:87] offset:17408
  ds_write_b128 v5, a[88:91] offset:18432
  ds_write_b128 v5, a[92:95] offset:19456
  ds_write_b128 v5, a[112:115] offset:20480
  ds_write_b128 v5, a[116:119] offset:21504
  ds_write_b128 v5, a[120:123] offset:22528
  ds_write_b128 v5, a[124:127] offset:23552
  ds_write_b128 v5, a[128:131] offset:24576
  ds_write_b128 v5, a[132:135] offset:25600
  ds_write_b128 v5, a[136:139] offset:26624
  ds_write_b128 v5, a[140:143] offset:27648
  ds_write_b128 v5, a[144:147] offset:28672
  ds_write_b128 v5, a[148:151] offset:29696
  ds_write_b128 v5, a[152:155] offset:30720
  ds_write_b128 v5, a[156:159] offset:31744
OP_28_w2:
  s_cmp_eq_u32 s80, 3
  s_cbranch_scc0 OP_28_w3
  ds_write_b128 v5, a[0:3] offset:0
  ds_write_b128 v5, a[4:7] offset:1024
  ds_write_b128 v5, a[8:11] offset:2048
  ds_write_b128 v5, a[12:15] offset:3072
  ds_write_b128 v5, a[16:19] offset:4096
  ds_write_b128 v5, a[20:23] offset:5120
  ds_write_b128 v5, a[24:27] offset:6144
  ds_write_b128 v5, a[28:31] offset:7168
  ds_write_b128 v5, a[32:35] offset:8192
  ds_write_b128 v5, a[36:39] offset:9216
  ds_write_b128 v5, a[40:43] offset:10240
  ds_write_b128 v5, a[44:47] offset:11264
  ds_write_b128 v5, a[64:67] offset:12288
  ds_write_b128 v5, a[68:71] offset:13312
  ds_write_b128 v5, a[72:75] offset:14336
  ds_write_b128 v5, a[76:79] offset:15360
  ds_write_b128 v5, a[80:83] offset:16384
  ds_write_b128 v5, a[84:87] offset:17408
  ds_write_b128 v5, a[88:91] offset:18432
  ds_write_b128 v5, a[92:95] offset:19456
  ds_write_b128 v5, a[96:99] offset:20480
  ds_write_b128 v5, a[100:103] offset:21504
  ds_write_b128 v5, a[104:107] offset:22528
  ds_write_b128 v5, a[108:111] offset:23552
  ds_write_b128 v5, a[128:131] offset:24576
  ds_write_b128 v5, a[132:135] offset:25600
  ds_write_b128 v5, a[136:139] offset:26624
  ds_write_b128 v5, a[140:143] offset:27648
  ds_write_b128 v5, a[144:147] offset:28672
  ds_write_b128 v5, a[148:151] offset:29696
  ds_write_b128 v5, a[152:155] offset:30720
  ds_write_b128 v5, a[156:159] offset:31744
OP_28_w3:
  s_waitcnt lgkmcnt(0)
  s_barrier
  s_mul_i32 s25, s37, 163840
  s_lshl_b32 s34, s39, 1
  s_add_u32 s25, s25, s34
  s_cmp_eq_u32 s80, 0
  s_cbranch_scc0 OP_28_r0
  v_add_u32 v6, 32768, v2
  ds_read_b128 v[160:163], v6 offset:0
  ds_read_b128 v[164:167], v6 offset:1024
  ds_read_b128 v[168:171], v6 offset:2048
  ds_read_b128 v[172:175], v6 offset:3072
  v_add_u32 v6, 65536, v2
  ds_read_b128 v[176:179], v6 offset:0
  ds_read_b128 v[180:183], v6 offset:1024
  ds_read_b128 v[184:187], v6 offset:2048
  ds_read_b128 v[188:191], v6 offset:3072
  v_add_u32 v6, 98304, v2
  ds_read_b128 v[192:195], v6 offset:0
  ds_read_b128 v[196:199], v6 offset:1024
  ds_read_b128 v[200:203], v6 offset:2048
  ds_read_b128 v[204:207], v6 offset:3072
  v_accvgpr_read_b32 v208, a0
  v_accvgpr_read_b32 v209, a1
  v_accvgpr_read_b32 v210, a2
  v_accvgpr_read_b32 v211, a3
  v_accvgpr_read_b32 v212, a4
  v_accvgpr_read_b32 v213, a5
  v_accvgpr_read_b32 v214, a6
  v_accvgpr_read_b32 v215, a7
  v_accvgpr_read_b32 v216, a8
  v_accvgpr_read_b32 v217, a9
  v_accvgpr_read_b32 v218, a10
  v_accvgpr_read_b32 v219, a11
  v_accvgpr_read_b32 v220, a12
  v_accvgpr_read_b32 v221, a13
  v_accvgpr_read_b32 v222, a14
  v_accvgpr_read_b32 v223, a15
  s_waitcnt lgkmcnt(0)
  v_pk_add_f32 v[160:161], v[160:161], v[176:177]
  v_pk_add_f32 v[192:193], v[192:193], v[208:209]
  v_pk_add_f32 v[162:163], v[162:163], v[178:179]
  v_pk_add_f32 v[194:195], v[194:195], v[210:211]
  v_pk_add_f32 v[164:165], v[164:165], v[180:181]
  v_pk_add_f32 v[196:197], v[196:197], v[212:213]
  v_pk_add_f32 v[166:167], v[166:167], v[182:183]
  v_pk_add_f32 v[198:199], v[198:199], v[214:215]
  v_pk_add_f32 v[168:169], v[168:169], v[184:185]
  v_pk_add_f32 v[200:201], v[200:201], v[216:217]
  v_pk_add_f32 v[170:171], v[170:171], v[186:187]
  v_pk_add_f32 v[202:203], v[202:203], v[218:219]
  v_pk_add_f32 v[172:173], v[172:173], v[188:189]
  v_pk_add_f32 v[204:205], v[204:205], v[220:221]
  v_pk_add_f32 v[174:175], v[174:175], v[190:191]
  v_pk_add_f32 v[206:207], v[206:207], v[222:223]
  v_pk_add_f32 v[160:161], v[160:161], v[192:193]
  v_pk_add_f32 v[162:163], v[162:163], v[194:195]
  v_pk_add_f32 v[164:165], v[164:165], v[196:197]
  v_pk_add_f32 v[166:167], v[166:167], v[198:199]
  v_pk_add_f32 v[168:169], v[168:169], v[200:201]
  v_pk_add_f32 v[170:171], v[170:171], v[202:203]
  v_pk_add_f32 v[172:173], v[172:173], v[204:205]
  v_pk_add_f32 v[174:175], v[174:175], v[206:207]
  v_cvt_pk_bf16_f32 v224, v160, v161
  v_cvt_pk_bf16_f32 v225, v162, v163
  v_cvt_pk_bf16_f32 v226, v164, v165
  v_cvt_pk_bf16_f32 v227, v166, v167
  v_cvt_pk_bf16_f32 v228, v168, v169
  v_cvt_pk_bf16_f32 v229, v170, v171
  v_cvt_pk_bf16_f32 v230, v172, v173
  v_cvt_pk_bf16_f32 v231, v174, v175
  s_add_u32 s34, s25, 0
  s_nop 0
  v_permlane32_swap_b32 v224, v226
  v_permlane32_swap_b32 v225, v227
  v_permlane32_swap_b32 v228, v230
  v_permlane32_swap_b32 v229, v231
  buffer_store_dwordx4 v[224:227], v4, s[16:19], s34 offen offset:0
  buffer_store_dwordx4 v[228:231], v4, s[16:19], s34 offen offset:32
  v_add_u32 v6, 45056, v2
  ds_read_b128 v[160:163], v6 offset:0
  ds_read_b128 v[164:167], v6 offset:1024
  ds_read_b128 v[168:171], v6 offset:2048
  ds_read_b128 v[172:175], v6 offset:3072
  v_add_u32 v6, 77824, v2
  ds_read_b128 v[176:179], v6 offset:0
  ds_read_b128 v[180:183], v6 offset:1024
  ds_read_b128 v[184:187], v6 offset:2048
  ds_read_b128 v[188:191], v6 offset:3072
  v_add_u32 v6, 110592, v2
  ds_read_b128 v[192:195], v6 offset:0
  ds_read_b128 v[196:199], v6 offset:1024
  ds_read_b128 v[200:203], v6 offset:2048
  ds_read_b128 v[204:207], v6 offset:3072
  v_accvgpr_read_b32 v208, a64
  v_accvgpr_read_b32 v209, a65
  v_accvgpr_read_b32 v210, a66
  v_accvgpr_read_b32 v211, a67
  v_accvgpr_read_b32 v212, a68
  v_accvgpr_read_b32 v213, a69
  v_accvgpr_read_b32 v214, a70
  v_accvgpr_read_b32 v215, a71
  v_accvgpr_read_b32 v216, a72
  v_accvgpr_read_b32 v217, a73
  v_accvgpr_read_b32 v218, a74
  v_accvgpr_read_b32 v219, a75
  v_accvgpr_read_b32 v220, a76
  v_accvgpr_read_b32 v221, a77
  v_accvgpr_read_b32 v222, a78
  v_accvgpr_read_b32 v223, a79
  s_waitcnt lgkmcnt(0)
  v_pk_add_f32 v[160:161], v[160:161], v[176:177]
  v_pk_add_f32 v[192:193], v[192:193], v[208:209]
  v_pk_add_f32 v[162:163], v[162:163], v[178:179]
  v_pk_add_f32 v[194:195], v[194:195], v[210:211]
  v_pk_add_f32 v[164:165], v[164:165], v[180:181]
  v_pk_add_f32 v[196:197], v[196:197], v[212:213]
  v_pk_add_f32 v[166:167], v[166:167], v[182:183]
  v_pk_add_f32 v[198:199], v[198:199], v[214:215]
  v_pk_add_f32 v[168:169], v[168:169], v[184:185]
  v_pk_add_f32 v[200:201], v[200:201], v[216:217]
  v_pk_add_f32 v[170:171], v[170:171], v[186:187]
  v_pk_add_f32 v[202:203], v[202:203], v[218:219]
  v_pk_add_f32 v[172:173], v[172:173], v[188:189]
  v_pk_add_f32 v[204:205], v[204:205], v[220:221]
  v_pk_add_f32 v[174:175], v[174:175], v[190:191]
  v_pk_add_f32 v[206:207], v[206:207], v[222:223]
  v_pk_add_f32 v[160:161], v[160:161], v[192:193]
  v_pk_add_f32 v[162:163], v[162:163], v[194:195]
  v_pk_add_f32 v[164:165], v[164:165], v[196:197]
  v_pk_add_f32 v[166:167], v[166:167], v[198:199]
  v_pk_add_f32 v[168:169], v[168:169], v[200:201]
  v_pk_add_f32 v[170:171], v[170:171], v[202:203]
  v_pk_add_f32 v[172:173], v[172:173], v[204:205]
  v_pk_add_f32 v[174:175], v[174:175], v[206:207]
  v_cvt_pk_bf16_f32 v224, v160, v161
  v_cvt_pk_bf16_f32 v225, v162, v163
  v_cvt_pk_bf16_f32 v226, v164, v165
  v_cvt_pk_bf16_f32 v227, v166, v167
  v_cvt_pk_bf16_f32 v228, v168, v169
  v_cvt_pk_bf16_f32 v229, v170, v171
  v_cvt_pk_bf16_f32 v230, v172, v173
  v_cvt_pk_bf16_f32 v231, v174, v175
  s_add_u32 s34, s25, 128
  s_nop 0
  v_permlane32_swap_b32 v224, v226
  v_permlane32_swap_b32 v225, v227
  v_permlane32_swap_b32 v228, v230
  v_permlane32_swap_b32 v229, v231
  buffer_store_dwordx4 v[224:227], v4, s[16:19], s34 offen offset:0
  buffer_store_dwordx4 v[228:231], v4, s[16:19], s34 offen offset:32
  v_add_u32 v6, 57344, v2
  ds_read_b128 v[160:163], v6 offset:0
  ds_read_b128 v[164:167], v6 offset:1024
  ds_read_b128 v[168:171], v6 offset:2048
  ds_read_b128 v[172:175], v6 offset:3072
  v_add_u32 v6, 90112, v2
  ds_read_b128 v[176:179], v6 offset:0
  ds_read_b128 v[180:183], v6 offset:1024
  ds_read_b128 v[184:187], v6 offset:2048
  ds_read_b128 v[188:191], v6 offset:3072
  v_add_u32 v6, 122880, v2
  ds_read_b128 v[192:195], v6 offset:0
  ds_read_b128 v[196:199], v6 offset:1024
  ds_read_b128 v[200:203], v6 offset:2048
  ds_read_b128 v[204:207], v6 offset:3072
  v_accvgpr_read_b32 v208, a128
  v_accvgpr_read_b32 v209, a129
  v_accvgpr_read_b32 v210, a130
  v_accvgpr_read_b32 v211, a131
  v_accvgpr_read_b32 v212, a132
  v_accvgpr_read_b32 v213, a133
  v_accvgpr_read_b32 v214, a134
  v_accvgpr_read_b32 v215, a135
  v_accvgpr_read_b32 v216, a136
  v_accvgpr_read_b32 v217, a137
  v_accvgpr_read_b32 v218, a138
  v_accvgpr_read_b32 v219, a139
  v_accvgpr_read_b32 v220, a140
  v_accvgpr_read_b32 v221, a141
  v_accvgpr_read_b32 v222, a142
  v_accvgpr_read_b32 v223, a143
  s_waitcnt lgkmcnt(0)
  v_pk_add_f32 v[160:161], v[160:161], v[176:177]
  v_pk_add_f32 v[192:193], v[192:193], v[208:209]
  v_pk_add_f32 v[162:163], v[162:163], v[178:179]
  v_pk_add_f32 v[194:195], v[194:195], v[210:211]
  v_pk_add_f32 v[164:165], v[164:165], v[180:181]
  v_pk_add_f32 v[196:197], v[196:197], v[212:213]
  v_pk_add_f32 v[166:167], v[166:167], v[182:183]
  v_pk_add_f32 v[198:199], v[198:199], v[214:215]
  v_pk_add_f32 v[168:169], v[168:169], v[184:185]
  v_pk_add_f32 v[200:201], v[200:201], v[216:217]
  v_pk_add_f32 v[170:171], v[170:171], v[186:187]
  v_pk_add_f32 v[202:203], v[202:203], v[218:219]
  v_pk_add_f32 v[172:173], v[172:173], v[188:189]
  v_pk_add_f32 v[204:205], v[204:205], v[220:221]
  v_pk_add_f32 v[174:175], v[174:175], v[190:191]
  v_pk_add_f32 v[206:207], v[206:207], v[222:223]
  v_pk_add_f32 v[160:161], v[160:161], v[192:193]
  v_pk_add_f32 v[162:163], v[162:163], v[194:195]
  v_pk_add_f32 v[164:165], v[164:165], v[196:197]
  v_pk_add_f32 v[166:167], v[166:167], v[198:199]
  v_pk_add_f32 v[168:169], v[168:169], v[200:201]
  v_pk_add_f32 v[170:171], v[170:171], v[202:203]
  v_pk_add_f32 v[172:173], v[172:173], v[204:205]
  v_pk_add_f32 v[174:175], v[174:175], v[206:207]
  v_cvt_pk_bf16_f32 v224, v160, v161
  v_cvt_pk_bf16_f32 v225, v162, v163
  v_cvt_pk_bf16_f32 v226, v164, v165
  v_cvt_pk_bf16_f32 v227, v166, v167
  v_cvt_pk_bf16_f32 v228, v168, v169
  v_cvt_pk_bf16_f32 v229, v170, v171
  v_cvt_pk_bf16_f32 v230, v172, v173
  v_cvt_pk_bf16_f32 v231, v174, v175
  s_add_u32 s34, s25, 256
  s_nop 0
  v_permlane32_swap_b32 v224, v226
  v_permlane32_swap_b32 v225, v227
  v_permlane32_swap_b32 v228, v230
  v_permlane32_swap_b32 v229, v231
  buffer_store_dwordx4 v[224:227], v4, s[16:19], s34 offen offset:0
  buffer_store_dwordx4 v[228:231], v4, s[16:19], s34 offen offset:32
OP_28_r0:
  s_cmp_eq_u32 s80, 1
  s_cbranch_scc0 OP_28_r1
  v_add_u32 v6, 0, v2
  ds_read_b128 v[160:163], v6 offset:0
  ds_read_b128 v[164:167], v6 offset:1024
  ds_read_b128 v[168:171], v6 offset:2048
  ds_read_b128 v[172:175], v6 offset:3072
  v_add_u32 v6, 69632, v2
  ds_read_b128 v[176:179], v6 offset:0
  ds_read_b128 v[180:183], v6 offset:1024
  ds_read_b128 v[184:187], v6 offset:2048
  ds_read_b128 v[188:191], v6 offset:3072
  v_add_u32 v6, 102400, v2
  ds_read_b128 v[192:195], v6 offset:0
  ds_read_b128 v[196:199], v6 offset:1024
  ds_read_b128 v[200:203], v6 offset:2048
  ds_read_b128 v[204:207], v6 offset:3072
  v_accvgpr_read_b32 v208, a16
  v_accvgpr_read_b32 v209, a17
  v_accvgpr_read_b32 v210, a18
  v_accvgpr_read_b32 v211, a19
  v_accvgpr_read_b32 v212, a20
  v_accvgpr_read_b32 v213, a21
  v_accvgpr_read_b32 v214, a22
  v_accvgpr_read_b32 v215, a23
  v_accvgpr_read_b32 v216, a24
  v_accvgpr_read_b32 v217, a25
  v_accvgpr_read_b32 v218, a26
  v_accvgpr_read_b32 v219, a27
  v_accvgpr_read_b32 v220, a28
  v_accvgpr_read_b32 v221, a29
  v_accvgpr_read_b32 v222, a30
  v_accvgpr_read_b32 v223, a31
  s_waitcnt lgkmcnt(0)
  v_pk_add_f32 v[160:161], v[160:161], v[176:177]
  v_pk_add_f32 v[192:193], v[192:193], v[208:209]
  v_pk_add_f32 v[162:163], v[162:163], v[178:179]
  v_pk_add_f32 v[194:195], v[194:195], v[210:211]
  v_pk_add_f32 v[164:165], v[164:165], v[180:181]
  v_pk_add_f32 v[196:197], v[196:197], v[212:213]
  v_pk_add_f32 v[166:167], v[166:167], v[182:183]
  v_pk_add_f32 v[198:199], v[198:199], v[214:215]
  v_pk_add_f32 v[168:169], v[168:169], v[184:185]
  v_pk_add_f32 v[200:201], v[200:201], v[216:217]
  v_pk_add_f32 v[170:171], v[170:171], v[186:187]
  v_pk_add_f32 v[202:203], v[202:203], v[218:219]
  v_pk_add_f32 v[172:173], v[172:173], v[188:189]
  v_pk_add_f32 v[204:205], v[204:205], v[220:221]
  v_pk_add_f32 v[174:175], v[174:175], v[190:191]
  v_pk_add_f32 v[206:207], v[206:207], v[222:223]
  v_pk_add_f32 v[160:161], v[160:161], v[192:193]
  v_pk_add_f32 v[162:163], v[162:163], v[194:195]
  v_pk_add_f32 v[164:165], v[164:165], v[196:197]
  v_pk_add_f32 v[166:167], v[166:167], v[198:199]
  v_pk_add_f32 v[168:169], v[168:169], v[200:201]
  v_pk_add_f32 v[170:171], v[170:171], v[202:203]
  v_pk_add_f32 v[172:173], v[172:173], v[204:205]
  v_pk_add_f32 v[174:175], v[174:175], v[206:207]
  v_cvt_pk_bf16_f32 v224, v160, v161
  v_cvt_pk_bf16_f32 v225, v162, v163
  v_cvt_pk_bf16_f32 v226, v164, v165
  v_cvt_pk_bf16_f32 v227, v166, v167
  v_cvt_pk_bf16_f32 v228, v168, v169
  v_cvt_pk_bf16_f32 v229, v170, v171
  v_cvt_pk_bf16_f32 v230, v172, v173
  v_cvt_pk_bf16_f32 v231, v174, v175
  s_add_u32 s34, s25, 81920
  s_nop 0
  v_permlane32_swap_b32 v224, v226
  v_permlane32_swap_b32 v225, v227
  v_permlane32_swap_b32 v228, v230
  v_permlane32_swap_b32 v229, v231
  buffer_store_dwordx4 v[224:227], v4, s[16:19], s34 offen offset:0
  buffer_store_dwordx4 v[228:231], v4, s[16:19], s34 offen offset:32
  v_add_u32 v6, 12288, v2
  ds_read_b128 v[160:163], v6 offset:0
  ds_read_b128 v[164:167], v6 offset:1024
  ds_read_b128 v[168:171], v6 offset:2048
  ds_read_b128 v[172:175], v6 offset:3072
  v_add_u32 v6, 81920, v2
  ds_read_b128 v[176:179], v6 offset:0
  ds_read_b128 v[180:183], v6 offset:1024
  ds_read_b128 v[184:187], v6 offset:2048
  ds_read_b128 v[188:191], v6 offset:3072
  v_add_u32 v6, 114688, v2
  ds_read_b128 v[192:195], v6 offset:0
  ds_read_b128 v[196:199], v6 offset:1024
  ds_read_b128 v[200:203], v6 offset:2048
  ds_read_b128 v[204:207], v6 offset:3072
  v_accvgpr_read_b32 v208, a80
  v_accvgpr_read_b32 v209, a81
  v_accvgpr_read_b32 v210, a82
  v_accvgpr_read_b32 v211, a83
  v_accvgpr_read_b32 v212, a84
  v_accvgpr_read_b32 v213, a85
  v_accvgpr_read_b32 v214, a86
  v_accvgpr_read_b32 v215, a87
  v_accvgpr_read_b32 v216, a88
  v_accvgpr_read_b32 v217, a89
  v_accvgpr_read_b32 v218, a90
  v_accvgpr_read_b32 v219, a91
  v_accvgpr_read_b32 v220, a92
  v_accvgpr_read_b32 v221, a93
  v_accvgpr_read_b32 v222, a94
  v_accvgpr_read_b32 v223, a95
  s_waitcnt lgkmcnt(0)
  v_pk_add_f32 v[160:161], v[160:161], v[176:177]
  v_pk_add_f32 v[192:193], v[192:193], v[208:209]
  v_pk_add_f32 v[162:163], v[162:163], v[178:179]
  v_pk_add_f32 v[194:195], v[194:195], v[210:211]
  v_pk_add_f32 v[164:165], v[164:165], v[180:181]
  v_pk_add_f32 v[196:197], v[196:197], v[212:213]
  v_pk_add_f32 v[166:167], v[166:167], v[182:183]
  v_pk_add_f32 v[198:199], v[198:199], v[214:215]
  v_pk_add_f32 v[168:169], v[168:169], v[184:185]
  v_pk_add_f32 v[200:201], v[200:201], v[216:217]
  v_pk_add_f32 v[170:171], v[170:171], v[186:187]
  v_pk_add_f32 v[202:203], v[202:203], v[218:219]
  v_pk_add_f32 v[172:173], v[172:173], v[188:189]
  v_pk_add_f32 v[204:205], v[204:205], v[220:221]
  v_pk_add_f32 v[174:175], v[174:175], v[190:191]
  v_pk_add_f32 v[206:207], v[206:207], v[222:223]
  v_pk_add_f32 v[160:161], v[160:161], v[192:193]
  v_pk_add_f32 v[162:163], v[162:163], v[194:195]
  v_pk_add_f32 v[164:165], v[164:165], v[196:197]
  v_pk_add_f32 v[166:167], v[166:167], v[198:199]
  v_pk_add_f32 v[168:169], v[168:169], v[200:201]
  v_pk_add_f32 v[170:171], v[170:171], v[202:203]
  v_pk_add_f32 v[172:173], v[172:173], v[204:205]
  v_pk_add_f32 v[174:175], v[174:175], v[206:207]
  v_cvt_pk_bf16_f32 v224, v160, v161
  v_cvt_pk_bf16_f32 v225, v162, v163
  v_cvt_pk_bf16_f32 v226, v164, v165
  v_cvt_pk_bf16_f32 v227, v166, v167
  v_cvt_pk_bf16_f32 v228, v168, v169
  v_cvt_pk_bf16_f32 v229, v170, v171
  v_cvt_pk_bf16_f32 v230, v172, v173
  v_cvt_pk_bf16_f32 v231, v174, v175
  s_add_u32 s34, s25, 82048
  s_nop 0
  v_permlane32_swap_b32 v224, v226
  v_permlane32_swap_b32 v225, v227
  v_permlane32_swap_b32 v228, v230
  v_permlane32_swap_b32 v229, v231
  buffer_store_dwordx4 v[224:227], v4, s[16:19], s34 offen offset:0
  buffer_store_dwordx4 v[228:231], v4, s[16:19], s34 offen offset:32
  v_add_u32 v6, 24576, v2
  ds_read_b128 v[160:163], v6 offset:0
  ds_read_b128 v[164:167], v6 offset:1024
  ds_read_b128 v[168:171], v6 offset:2048
  ds_read_b128 v[172:175], v6 offset:3072
  v_add_u32 v6, 94208, v2
  ds_read_b128 v[176:179], v6 offset:0
  ds_read_b128 v[180:183], v6 offset:1024
  ds_read_b128 v[184:187], v6 offset:2048
  ds_read_b128 v[188:191], v6 offset:3072
  v_add_u32 v6, 126976, v2
  ds_read_b128 v[192:195], v6 offset:0
  ds_read_b128 v[196:199], v6 offset:1024
  ds_read_b128 v[200:203], v6 offset:2048
  ds_read_b128 v[204:207], v6 offset:3072
  v_accvgpr_read_b32 v208, a144
  v_accvgpr_read_b32 v209, a145
  v_accvgpr_read_b32 v210, a146
  v_accvgpr_read_b32 v211, a147
  v_accvgpr_read_b32 v212, a148
  v_accvgpr_read_b32 v213, a149
  v_accvgpr_read_b32 v214, a150
  v_accvgpr_read_b32 v215, a151
  v_accvgpr_read_b32 v216, a152
  v_accvgpr_read_b32 v217, a153
  v_accvgpr_read_b32 v218, a154
  v_accvgpr_read_b32 v219, a155
  v_accvgpr_read_b32 v220, a156
  v_accvgpr_read_b32 v221, a157
  v_accvgpr_read_b32 v222, a158
  v_accvgpr_read_b32 v223, a159
  s_waitcnt lgkmcnt(0)
  v_pk_add_f32 v[160:161], v[160:161], v[176:177]
  v_pk_add_f32 v[192:193], v[192:193], v[208:209]
  v_pk_add_f32 v[162:163], v[162:163], v[178:179]
  v_pk_add_f32 v[194:195], v[194:195], v[210:211]
  v_pk_add_f32 v[164:165], v[164:165], v[180:181]
  v_pk_add_f32 v[196:197], v[196:197], v[212:213]
  v_pk_add_f32 v[166:167], v[166:167], v[182:183]
  v_pk_add_f32 v[198:199], v[198:199], v[214:215]
  v_pk_add_f32 v[168:169], v[168:169], v[184:185]
  v_pk_add_f32 v[200:201], v[200:201], v[216:217]
  v_pk_add_f32 v[170:171], v[170:171], v[186:187]
  v_pk_add_f32 v[202:203], v[202:203], v[218:219]
  v_pk_add_f32 v[172:173], v[172:173], v[188:189]
  v_pk_add_f32 v[204:205], v[204:205], v[220:221]
  v_pk_add_f32 v[174:175], v[174:175], v[190:191]
  v_pk_add_f32 v[206:207], v[206:207], v[222:223]
  v_pk_add_f32 v[160:161], v[160:161], v[192:193]
  v_pk_add_f32 v[162:163], v[162:163], v[194:195]
  v_pk_add_f32 v[164:165], v[164:165], v[196:197]
  v_pk_add_f32 v[166:167], v[166:167], v[198:199]
  v_pk_add_f32 v[168:169], v[168:169], v[200:201]
  v_pk_add_f32 v[170:171], v[170:171], v[202:203]
  v_pk_add_f32 v[172:173], v[172:173], v[204:205]
  v_pk_add_f32 v[174:175], v[174:175], v[206:207]
  v_cvt_pk_bf16_f32 v224, v160, v161
  v_cvt_pk_bf16_f32 v225, v162, v163
  v_cvt_pk_bf16_f32 v226, v164, v165
  v_cvt_pk_bf16_f32 v227, v166, v167
  v_cvt_pk_bf16_f32 v228, v168, v169
  v_cvt_pk_bf16_f32 v229, v170, v171
  v_cvt_pk_bf16_f32 v230, v172, v173
  v_cvt_pk_bf16_f32 v231, v174, v175
  s_add_u32 s34, s25, 82176
  s_nop 0
  v_permlane32_swap_b32 v224, v226
  v_permlane32_swap_b32 v225, v227
  v_permlane32_swap_b32 v228, v230
  v_permlane32_swap_b32 v229, v231
  buffer_store_dwordx4 v[224:227], v4, s[16:19], s34 offen offset:0
  buffer_store_dwordx4 v[228:231], v4, s[16:19], s34 offen offset:32
OP_28_r1:
  s_cmp_eq_u32 s80, 2
  s_cbranch_scc0 OP_28_r2
  v_add_u32 v6, 4096, v2
  ds_read_b128 v[160:163], v6 offset:0
  ds_read_b128 v[164:167], v6 offset:1024
  ds_read_b128 v[168:171], v6 offset:2048
  ds_read_b128 v[172:175], v6 offset:3072
  v_add_u32 v6, 36864, v2
  ds_read_b128 v[176:179], v6 offset:0
  ds_read_b128 v[180:183], v6 offset:1024
  ds_read_b128 v[184:187], v6 offset:2048
  ds_read_b128 v[188:191], v6 offset:3072
  v_add_u32 v6, 106496, v2
  ds_read_b128 v[192:195], v6 offset:0
  ds_read_b128 v[196:199], v6 offset:1024
  ds_read_b128 v[200:203], v6 offset:2048
  ds_read_b128 v[204:207], v6 offset:3072
  v_accvgpr_read_b32 v208, a32
  v_accvgpr_read_b32 v209, a33
  v_accvgpr_read_b32 v210, a34
  v_accvgpr_read_b32 v211, a35
  v_accvgpr_read_b32 v212, a36
  v_accvgpr_read_b32 v213, a37
  v_accvgpr_read_b32 v214, a38
  v_accvgpr_read_b32 v215, a39
  v_accvgpr_read_b32 v216, a40
  v_accvgpr_read_b32 v217, a41
  v_accvgpr_read_b32 v218, a42
  v_accvgpr_read_b32 v219, a43
  v_accvgpr_read_b32 v220, a44
  v_accvgpr_read_b32 v221, a45
  v_accvgpr_read_b32 v222, a46
  v_accvgpr_read_b32 v223, a47
  s_waitcnt lgkmcnt(0)
  v_pk_add_f32 v[160:161], v[160:161], v[176:177]
  v_pk_add_f32 v[192:193], v[192:193], v[208:209]
  v_pk_add_f32 v[162:163], v[162:163], v[178:179]
  v_pk_add_f32 v[194:195], v[194:195], v[210:211]
  v_pk_add_f32 v[164:165], v[164:165], v[180:181]
  v_pk_add_f32 v[196:197], v[196:197], v[212:213]
  v_pk_add_f32 v[166:167], v[166:167], v[182:183]
  v_pk_add_f32 v[198:199], v[198:199], v[214:215]
  v_pk_add_f32 v[168:169], v[168:169], v[184:185]
  v_pk_add_f32 v[200:201], v[200:201], v[216:217]
  v_pk_add_f32 v[170:171], v[170:171], v[186:187]
  v_pk_add_f32 v[202:203], v[202:203], v[218:219]
  v_pk_add_f32 v[172:173], v[172:173], v[188:189]
  v_pk_add_f32 v[204:205], v[204:205], v[220:221]
  v_pk_add_f32 v[174:175], v[174:175], v[190:191]
  v_pk_add_f32 v[206:207], v[206:207], v[222:223]
  v_pk_add_f32 v[160:161], v[160:161], v[192:193]
  v_pk_add_f32 v[162:163], v[162:163], v[194:195]
  v_pk_add_f32 v[164:165], v[164:165], v[196:197]
  v_pk_add_f32 v[166:167], v[166:167], v[198:199]
  v_pk_add_f32 v[168:169], v[168:169], v[200:201]
  v_pk_add_f32 v[170:171], v[170:171], v[202:203]
  v_pk_add_f32 v[172:173], v[172:173], v[204:205]
  v_pk_add_f32 v[174:175], v[174:175], v[206:207]
  v_cvt_pk_bf16_f32 v224, v160, v161
  v_cvt_pk_bf16_f32 v225, v162, v163
  v_cvt_pk_bf16_f32 v226, v164, v165
  v_cvt_pk_bf16_f32 v227, v166, v167
  v_cvt_pk_bf16_f32 v228, v168, v169
  v_cvt_pk_bf16_f32 v229, v170, v171
  v_cvt_pk_bf16_f32 v230, v172, v173
  v_cvt_pk_bf16_f32 v231, v174, v175
  s_add_u32 s34, s25, 64
  s_nop 0
  v_permlane32_swap_b32 v224, v226
  v_permlane32_swap_b32 v225, v227
  v_permlane32_swap_b32 v228, v230
  v_permlane32_swap_b32 v229, v231
  buffer_store_dwordx4 v[224:227], v4, s[16:19], s34 offen offset:0
  buffer_store_dwordx4 v[228:231], v4, s[16:19], s34 offen offset:32
  v_add_u32 v6, 16384, v2
  ds_read_b128 v[160:163], v6 offset:0
  ds_read_b128 v[164:167], v6 offset:1024
  ds_read_b128 v[168:171], v6 offset:2048
  ds_read_b128 v[172:175], v6 offset:3072
  v_add_u32 v6, 49152, v2
  ds_read_b128 v[176:179], v6 offset:0
  ds_read_b128 v[180:183], v6 offset:1024
  ds_read_b128 v[184:187], v6 offset:2048
  ds_read_b128 v[188:191], v6 offset:3072
  v_add_u32 v6, 118784, v2
  ds_read_b128 v[192:195], v6 offset:0
  ds_read_b128 v[196:199], v6 offset:1024
  ds_read_b128 v[200:203], v6 offset:2048
  ds_read_b128 v[204:207], v6 offset:3072
  v_accvgpr_read_b32 v208, a96
  v_accvgpr_read_b32 v209, a97
  v_accvgpr_read_b32 v210, a98
  v_accvgpr_read_b32 v211, a99
  v_accvgpr_read_b32 v212, a100
  v_accvgpr_read_b32 v213, a101
  v_accvgpr_read_b32 v214, a102
  v_accvgpr_read_b32 v215, a103
  v_accvgpr_read_b32 v216, a104
  v_accvgpr_read_b32 v217, a105
  v_accvgpr_read_b32 v218, a106
  v_accvgpr_read_b32 v219, a107
  v_accvgpr_read_b32 v220, a108
  v_accvgpr_read_b32 v221, a109
  v_accvgpr_read_b32 v222, a110
  v_accvgpr_read_b32 v223, a111
  s_waitcnt lgkmcnt(0)
  v_pk_add_f32 v[160:161], v[160:161], v[176:177]
  v_pk_add_f32 v[192:193], v[192:193], v[208:209]
  v_pk_add_f32 v[162:163], v[162:163], v[178:179]
  v_pk_add_f32 v[194:195], v[194:195], v[210:211]
  v_pk_add_f32 v[164:165], v[164:165], v[180:181]
  v_pk_add_f32 v[196:197], v[196:197], v[212:213]
  v_pk_add_f32 v[166:167], v[166:167], v[182:183]
  v_pk_add_f32 v[198:199], v[198:199], v[214:215]
  v_pk_add_f32 v[168:169], v[168:169], v[184:185]
  v_pk_add_f32 v[200:201], v[200:201], v[216:217]
  v_pk_add_f32 v[170:171], v[170:171], v[186:187]
  v_pk_add_f32 v[202:203], v[202:203], v[218:219]
  v_pk_add_f32 v[172:173], v[172:173], v[188:189]
  v_pk_add_f32 v[204:205], v[204:205], v[220:221]
  v_pk_add_f32 v[174:175], v[174:175], v[190:191]
  v_pk_add_f32 v[206:207], v[206:207], v[222:223]
  v_pk_add_f32 v[160:161], v[160:161], v[192:193]
  v_pk_add_f32 v[162:163], v[162:163], v[194:195]
  v_pk_add_f32 v[164:165], v[164:165], v[196:197]
  v_pk_add_f32 v[166:167], v[166:167], v[198:199]
  v_pk_add_f32 v[168:169], v[168:169], v[200:201]
  v_pk_add_f32 v[170:171], v[170:171], v[202:203]
  v_pk_add_f32 v[172:173], v[172:173], v[204:205]
  v_pk_add_f32 v[174:175], v[174:175], v[206:207]
  v_cvt_pk_bf16_f32 v224, v160, v161
  v_cvt_pk_bf16_f32 v225, v162, v163
  v_cvt_pk_bf16_f32 v226, v164, v165
  v_cvt_pk_bf16_f32 v227, v166, v167
  v_cvt_pk_bf16_f32 v228, v168, v169
  v_cvt_pk_bf16_f32 v229, v170, v171
  v_cvt_pk_bf16_f32 v230, v172, v173
  v_cvt_pk_bf16_f32 v231, v174, v175
  s_add_u32 s34, s25, 192
  s_nop 0
  v_permlane32_swap_b32 v224, v226
  v_permlane32_swap_b32 v225, v227
  v_permlane32_swap_b32 v228, v230
  v_permlane32_swap_b32 v229, v231
  buffer_store_dwordx4 v[224:227], v4, s[16:19], s34 offen offset:0
  buffer_store_dwordx4 v[228:231], v4, s[16:19], s34 offen offset:32
OP_28_r2:
  s_cmp_eq_u32 s80, 3
  s_cbranch_scc0 OP_28_r3
  v_add_u32 v6, 8192, v2
  ds_read_b128 v[160:163], v6 offset:0
  ds_read_b128 v[164:167], v6 offset:1024
  ds_read_b128 v[168:171], v6 offset:2048
  ds_read_b128 v[172:175], v6 offset:3072
  v_add_u32 v6, 40960, v2
  ds_read_b128 v[176:179], v6 offset:0
  ds_read_b128 v[180:183], v6 offset:1024
  ds_read_b128 v[184:187], v6 offset:2048
  ds_read_b128 v[188:191], v6 offset:3072
  v_add_u32 v6, 73728, v2
  ds_read_b128 v[192:195], v6 offset:0
  ds_read_b128 v[196:199], v6 offset:1024
  ds_read_b128 v[200:203], v6 offset:2048
  ds_read_b128 v[204:207], v6 offset:3072
  v_accvgpr_read_b32 v208, a48
  v_accvgpr_read_b32 v209, a49
  v_accvgpr_read_b32 v210, a50
  v_accvgpr_read_b32 v211, a51
  v_accvgpr_read_b32 v212, a52
  v_accvgpr_read_b32 v213, a53
  v_accvgpr_read_b32 v214, a54
  v_accvgpr_read_b32 v215, a55
  v_accvgpr_read_b32 v216, a56
  v_accvgpr_read_b32 v217, a57
  v_accvgpr_read_b32 v218, a58
  v_accvgpr_read_b32 v219, a59
  v_accvgpr_read_b32 v220, a60
  v_accvgpr_read_b32 v221, a61
  v_accvgpr_read_b32 v222, a62
  v_accvgpr_read_b32 v223, a63
  s_waitcnt lgkmcnt(0)
  v_pk_add_f32 v[160:161], v[160:161], v[176:177]
  v_pk_add_f32 v[192:193], v[192:193], v[208:209]
  v_pk_add_f32 v[162:163], v[162:163], v[178:179]
  v_pk_add_f32 v[194:195], v[194:195], v[210:211]
  v_pk_add_f32 v[164:165], v[164:165], v[180:181]
  v_pk_add_f32 v[196:197], v[196:197], v[212:213]
  v_pk_add_f32 v[166:167], v[166:167], v[182:183]
  v_pk_add_f32 v[198:199], v[198:199], v[214:215]
  v_pk_add_f32 v[168:169], v[168:169], v[184:185]
  v_pk_add_f32 v[200:201], v[200:201], v[216:217]
  v_pk_add_f32 v[170:171], v[170:171], v[186:187]
  v_pk_add_f32 v[202:203], v[202:203], v[218:219]
  v_pk_add_f32 v[172:173], v[172:173], v[188:189]
  v_pk_add_f32 v[204:205], v[204:205], v[220:221]
  v_pk_add_f32 v[174:175], v[174:175], v[190:191]
  v_pk_add_f32 v[206:207], v[206:207], v[222:223]
  v_pk_add_f32 v[160:161], v[160:161], v[192:193]
  v_pk_add_f32 v[162:163], v[162:163], v[194:195]
  v_pk_add_f32 v[164:165], v[164:165], v[196:197]
  v_pk_add_f32 v[166:167], v[166:167], v[198:199]
  v_pk_add_f32 v[168:169], v[168:169], v[200:201]
  v_pk_add_f32 v[170:171], v[170:171], v[202:203]
  v_pk_add_f32 v[172:173], v[172:173], v[204:205]
  v_pk_add_f32 v[174:175], v[174:175], v[206:207]
  v_cvt_pk_bf16_f32 v224, v160, v161
  v_cvt_pk_bf16_f32 v225, v162, v163
  v_cvt_pk_bf16_f32 v226, v164, v165
  v_cvt_pk_bf16_f32 v227, v166, v167
  v_cvt_pk_bf16_f32 v228, v168, v169
  v_cvt_pk_bf16_f32 v229, v170, v171
  v_cvt_pk_bf16_f32 v230, v172, v173
  v_cvt_pk_bf16_f32 v231, v174, v175
  s_add_u32 s34, s25, 81984
  s_nop 0
  v_permlane32_swap_b32 v224, v226
  v_permlane32_swap_b32 v225, v227
  v_permlane32_swap_b32 v228, v230
  v_permlane32_swap_b32 v229, v231
  buffer_store_dwordx4 v[224:227], v4, s[16:19], s34 offen offset:0
  buffer_store_dwordx4 v[228:231], v4, s[16:19], s34 offen offset:32
  v_add_u32 v6, 20480, v2
  ds_read_b128 v[160:163], v6 offset:0
  ds_read_b128 v[164:167], v6 offset:1024
  ds_read_b128 v[168:171], v6 offset:2048
  ds_read_b128 v[172:175], v6 offset:3072
  v_add_u32 v6, 53248, v2
  ds_read_b128 v[176:179], v6 offset:0
  ds_read_b128 v[180:183], v6 offset:1024
  ds_read_b128 v[184:187], v6 offset:2048
  ds_read_b128 v[188:191], v6 offset:3072
  v_add_u32 v6, 86016, v2
  ds_read_b128 v[192:195], v6 offset:0
  ds_read_b128 v[196:199], v6 offset:1024
  ds_read_b128 v[200:203], v6 offset:2048
  ds_read_b128 v[204:207], v6 offset:3072
  v_accvgpr_read_b32 v208, a112
  v_accvgpr_read_b32 v209, a113
  v_accvgpr_read_b32 v210, a114
  v_accvgpr_read_b32 v211, a115
  v_accvgpr_read_b32 v212, a116
  v_accvgpr_read_b32 v213, a117
  v_accvgpr_read_b32 v214, a118
  v_accvgpr_read_b32 v215, a119
  v_accvgpr_read_b32 v216, a120
  v_accvgpr_read_b32 v217, a121
  v_accvgpr_read_b32 v218, a122
  v_accvgpr_read_b32 v219, a123
  v_accvgpr_read_b32 v220, a124
  v_accvgpr_read_b32 v221, a125
  v_accvgpr_read_b32 v222, a126
  v_accvgpr_read_b32 v223, a127
  s_waitcnt lgkmcnt(0)
  v_pk_add_f32 v[160:161], v[160:161], v[176:177]
  v_pk_add_f32 v[192:193], v[192:193], v[208:209]
  v_pk_add_f32 v[162:163], v[162:163], v[178:179]
  v_pk_add_f32 v[194:195], v[194:195], v[210:211]
  v_pk_add_f32 v[164:165], v[164:165], v[180:181]
  v_pk_add_f32 v[196:197], v[196:197], v[212:213]
  v_pk_add_f32 v[166:167], v[166:167], v[182:183]
  v_pk_add_f32 v[198:199], v[198:199], v[214:215]
  v_pk_add_f32 v[168:169], v[168:169], v[184:185]
  v_pk_add_f32 v[200:201], v[200:201], v[216:217]
  v_pk_add_f32 v[170:171], v[170:171], v[186:187]
  v_pk_add_f32 v[202:203], v[202:203], v[218:219]
  v_pk_add_f32 v[172:173], v[172:173], v[188:189]
  v_pk_add_f32 v[204:205], v[204:205], v[220:221]
  v_pk_add_f32 v[174:175], v[174:175], v[190:191]
  v_pk_add_f32 v[206:207], v[206:207], v[222:223]
  v_pk_add_f32 v[160:161], v[160:161], v[192:193]
  v_pk_add_f32 v[162:163], v[162:163], v[194:195]
  v_pk_add_f32 v[164:165], v[164:165], v[196:197]
  v_pk_add_f32 v[166:167], v[166:167], v[198:199]
  v_pk_add_f32 v[168:169], v[168:169], v[200:201]
  v_pk_add_f32 v[170:171], v[170:171], v[202:203]
  v_pk_add_f32 v[172:173], v[172:173], v[204:205]
  v_pk_add_f32 v[174:175], v[174:175], v[206:207]
  v_cvt_pk_bf16_f32 v224, v160, v161
  v_cvt_pk_bf16_f32 v225, v162, v163
  v_cvt_pk_bf16_f32 v226, v164, v165
  v_cvt_pk_bf16_f32 v227, v166, v167
  v_cvt_pk_bf16_f32 v228, v168, v169
  v_cvt_pk_bf16_f32 v229, v170, v171
  v_cvt_pk_bf16_f32 v230, v172, v173
  v_cvt_pk_bf16_f32 v231, v174, v175
  s_add_u32 s34, s25, 82112
  s_nop 0
  v_permlane32_swap_b32 v224, v226
  v_permlane32_swap_b32 v225, v227
  v_permlane32_swap_b32 v228, v230
  v_permlane32_swap_b32 v229, v231
  buffer_store_dwordx4 v[224:227], v4, s[16:19], s34 offen offset:0
  buffer_store_dwordx4 v[228:231], v4, s[16:19], s34 offen offset:32
OP_28_r3:
  s_barrier
  s_branch BG_FIN
BG_O1:
  s_mul_i32 s37, s82, 13108
  s_lshr_b32 s37, s37, 16
  s_mul_i32 s39, s37, 5
  s_sub_u32 s39, s82, s39
  s_mul_i32 s39, s39, 32
  s_mul_i32 s34, s79, 160
  s_add_u32 s39, s39, s34
  s_add_u32 s37, s37, s83
  s_lshl_b32 s91, s37, 6
  s_add_u32 s91, s91, 1839104
  s_cmp_eq_u32 s80, 0
  s_cbranch_scc0 W_30_d
  v_lshlrev_b32 v2, 6, v0
  s_mov_b32 s93, 0
  s_mov_b64 exec, 0x1
W_30_l:
  buffer_load_dword v3, v2, s[84:87], s91 offen sc1
  s_add_u32 s93, s93, 1
  s_waitcnt vmcnt(0)
  v_cmp_gt_u32 vcc, 8, v3
  s_cbranch_vccz W_30_k
  s_sleep 48
  s_cmp_lt_u32 s93, 200000
  s_cbranch_scc1 W_30_l
W_30_k:
  s_mov_b64 exec, -1
W_30_d:
  s_barrier
  s_load_dwordx2 s[8:9], s[0:1], 40
  s_mov_b32 s10, 0x780000
  s_mov_b32 s11, 0x00020000
  s_load_dwordx2 s[16:17], s[0:1], 80
  s_mov_b32 s18, 0x500000
  s_mov_b32 s19, 0x00020000
  s_mov_b32 s4, s84
  s_mov_b32 s5, s85
  s_mov_b32 s6, s86
  s_mov_b32 s7, s87
  v_lshlrev_b32 v2, 4, v1
  v_add_u32 v5, 0, v1
  v_mul_u32_u24 v6, 16385, v5
  v_lshrrev_b32 v6, 16, v6
  v_mul_u32_u24 v7, 4, v6
  v_sub_u32 v7, v5, v7
  v_mul_u32_u24 v6, 1280, v6
  v_lshlrev_b32 v7, 4, v7
  v_add_u32 v8, v6, v7
  v_lshrrev_b32 v5, 5, v1
  v_lshlrev_b32 v5, 2, v5
  v_bfe_u32 v6, v1, 2, 2
  v_add_u32 v5, v5, v6
  v_mul_u32_u24 v5, 64, v5
  v_bfe_u32 v6, v1, 4, 1
  v_lshlrev_b32 v6, 5, v6
  v_and_b32 v7, 3, v1
  v_lshlrev_b32 v7, 3, v7
  v_add3_u32 v5, v5, v6, v7
  s_mul_i32 s34, s80, 32768
  v_add_u32 v3, s34, v5
  v_and_b32 v5, 31, v1
  v_mul_u32_u24 v5, 2560, v5
  v_lshrrev_b32 v6, 5, v1
  v_lshlrev_b32 v6, 4, v6
  v_add_u32 v4, v5, v6
  s_waitcnt lgkmcnt(0)
  s_mul_i32 s20, s37, 393216
  s_mul_i32 s34, s80, 98304
  s_add_u32 s20, s20, s34
  s_add_u32 s20, s20, 77594624
  s_add_u32 s21, s20, 393216
  s_mul_i32 s22, s80, 1966080
  s_lshl_b32 s34, s39, 1
  s_add_u32 s22, s22, s34
  s_mul_i32 s23, s80, 32768
  s_add_u32 m0, s23, 0
  s_nop 0
  buffer_load_dwordx4 v8, s[8:11], s22 offen lds
  buffer_load_dwordx4 v[16:19], v2, s[4:7], s20 offen
  s_add_u32 s20, s20, 1024
  s_add_u32 s22, s22, 20480
  s_add_u32 m0, s23, 1024
  s_nop 0
  buffer_load_dwordx4 v8, s[8:11], s22 offen lds
  buffer_load_dwordx4 v[20:23], v2, s[4:7], s20 offen
  s_add_u32 s20, s20, 1024
  s_add_u32 s22, s22, 20480
  s_add_u32 m0, s23, 2048
  s_nop 0
  buffer_load_dwordx4 v8, s[8:11], s22 offen lds
  buffer_load_dwordx4 v[24:27], v2, s[4:7], s20 offen
  s_add_u32 s20, s20, 1024
  s_add_u32 s22, s22, 20480
  s_add_u32 m0, s23, 3072
  s_nop 0
  buffer_load_dwordx4 v8, s[8:11], s22 offen lds
  buffer_load_dwordx4 v[28:31], v2, s[4:7], s20 offen
  s_add_u32 s20, s20, 1024
  s_add_u32 s22, s22, 20480
  s_add_u32 m0, s23, 4096
  s_nop 0
  buffer_load_dwordx4 v8, s[8:11], s22 offen lds
  buffer_load_dwordx4 v[32:35], v2, s[4:7], s20 offen
  s_add_u32 s20, s20, 1024
  s_add_u32 s22, s22, 20480
  s_add_u32 m0, s23, 5120
  s_nop 0
  buffer_load_dwordx4 v8, s[8:11], s22 offen lds
  buffer_load_dwordx4 v[36:39], v2, s[4:7], s20 offen
  s_add_u32 s20, s20, 1024
  s_add_u32 s22, s22, 20480
  s_add_u32 m0, s23, 6144
  s_nop 0
  buffer_load_dwordx4 v8, s[8:11], s22 offen lds
  buffer_load_dwordx4 v[40:43], v2, s[4:7], s20 offen
  s_add_u32 s20, s20, 1024
  s_add_u32 s22, s22, 20480
  s_add_u32 m0, s23, 7168
  s_nop 0
  buffer_load_dwordx4 v8, s[8:11], s22 offen lds
  buffer_load_dwordx4 v[44:47], v2, s[4:7], s20 offen
  s_add_u32 s20, s20, 1024
  s_add_u32 s22, s22, 20480
  s_add_u32 m0, s23, 8192
  s_nop 0
  buffer_load_dwordx4 v8, s[8:11], s22 offen lds
  buffer_load_dwordx4 v[48:51], v2, s[4:7], s20 offen
  s_add_u32 s20, s20, 1024
  s_add_u32 s22, s22, 20480
  s_add_u32 m0, s23, 9216
  s_nop 0
  buffer_load_dwordx4 v8, s[8:11], s22 offen lds
  buffer_load_dwordx4 v[52:55], v2, s[4:7], s20 offen
  s_add_u32 s20, s20, 1024
  s_add_u32 s22, s22, 20480
  s_add_u32 m0, s23, 10240
  s_nop 0
  buffer_load_dwordx4 v8, s[8:11], s22 offen lds
  buffer_load_dwordx4 v[56:59], v2, s[4:7], s20 offen
  s_add_u32 s20, s20, 1024
  s_add_u32 s22, s22, 20480
  s_add_u32 m0, s23, 11264
  s_nop 0
  buffer_load_dwordx4 v8, s[8:11], s22 offen lds
  buffer_load_dwordx4 v[60:63], v2, s[4:7], s20 offen
  s_add_u32 s20, s20, 1024
  s_add_u32 s22, s22, 20480
  s_add_u32 m0, s23, 12288
  s_nop 0
  buffer_load_dwordx4 v8, s[8:11], s22 offen lds
  buffer_load_dwordx4 v[64:67], v2, s[4:7], s20 offen
  s_add_u32 s20, s20, 1024
  s_add_u32 s22, s22, 20480
  s_add_u32 m0, s23, 13312
  s_nop 0
  buffer_load_dwordx4 v8, s[8:11], s22 offen lds
  buffer_load_dwordx4 v[68:71], v2, s[4:7], s20 offen
  s_add_u32 s20, s20, 1024
  s_add_u32 s22, s22, 20480
  s_add_u32 m0, s23, 14336
  s_nop 0
  buffer_load_dwordx4 v8, s[8:11], s22 offen lds
  buffer_load_dwordx4 v[72:75], v2, s[4:7], s20 offen
  s_add_u32 s20, s20, 1024
  s_add_u32 s22, s22, 20480
  s_add_u32 m0, s23, 15360
  s_nop 0
  buffer_load_dwordx4 v8, s[8:11], s22 offen lds
  buffer_load_dwordx4 v[76:79], v2, s[4:7], s20 offen
  s_add_u32 s20, s20, 1024
  s_add_u32 s22, s22, 20480
  s_add_u32 m0, s23, 16384
  s_nop 0
  buffer_load_dwordx4 v8, s[8:11], s22 offen lds
  buffer_load_dwordx4 v[80:83], v2, s[4:7], s20 offen
  s_add_u32 s20, s20, 1024
  s_add_u32 s22, s22, 20480
  s_add_u32 m0, s23, 17408
  s_nop 0
  buffer_load_dwordx4 v8, s[8:11], s22 offen lds
  buffer_load_dwordx4 v[84:87], v2, s[4:7], s20 offen
  s_add_u32 s20, s20, 1024
  s_add_u32 s22, s22, 20480
  s_add_u32 m0, s23, 18432
  s_nop 0
  buffer_load_dwordx4 v8, s[8:11], s22 offen lds
  buffer_load_dwordx4 v[88:91], v2, s[4:7], s20 offen
  s_add_u32 s20, s20, 1024
  s_add_u32 s22, s22, 20480
  s_add_u32 m0, s23, 19456
  s_nop 0
  buffer_load_dwordx4 v8, s[8:11], s22 offen lds
  buffer_load_dwordx4 v[92:95], v2, s[4:7], s20 offen
  s_add_u32 s20, s20, 1024
  s_add_u32 s22, s22, 20480
  s_add_u32 m0, s23, 20480
  s_nop 0
  buffer_load_dwordx4 v8, s[8:11], s22 offen lds
  buffer_load_dwordx4 v[96:99], v2, s[4:7], s20 offen
  s_add_u32 s20, s20, 1024
  s_add_u32 s22, s22, 20480
  s_add_u32 m0, s23, 21504
  s_nop 0
  buffer_load_dwordx4 v8, s[8:11], s22 offen lds
  buffer_load_dwordx4 v[100:103], v2, s[4:7], s20 offen
  s_add_u32 s20, s20, 1024
  s_add_u32 s22, s22, 20480
  s_add_u32 m0, s23, 22528
  s_nop 0
  buffer_load_dwordx4 v8, s[8:11], s22 offen lds
  buffer_load_dwordx4 v[104:107], v2, s[4:7], s20 offen
  s_add_u32 s20, s20, 1024
  s_add_u32 s22, s22, 20480
  s_add_u32 m0, s23, 23552
  s_nop 0
  buffer_load_dwordx4 v8, s[8:11], s22 offen lds
  buffer_load_dwordx4 v[108:111], v2, s[4:7], s20 offen
  s_add_u32 s20, s20, 1024
  s_add_u32 s22, s22, 20480
  s_waitcnt vmcnt(40)
  ds_read_b64_tr_b16 v[112:113], v3 offset:0
  ds_read_b64_tr_b16 v[114:115], v3 offset:512
  ds_read_b64_tr_b16 v[116:117], v3 offset:1024
  ds_read_b64_tr_b16 v[118:119], v3 offset:1536
  ds_read_b64_tr_b16 v[120:121], v3 offset:2048
  ds_read_b64_tr_b16 v[122:123], v3 offset:2560
  ds_read_b64_tr_b16 v[124:125], v3 offset:3072
  ds_read_b64_tr_b16 v[126:127], v3 offset:3584
  s_waitcnt vmcnt(32) lgkmcnt(0)
  ds_read_b64_tr_b16 v[128:129], v3 offset:4096
  ds_read_b64_tr_b16 v[130:131], v3 offset:4608
  ds_read_b64_tr_b16 v[132:133], v3 offset:5120
  ds_read_b64_tr_b16 v[134:135], v3 offset:5632
  ds_read_b64_tr_b16 v[136:137], v3 offset:6144
  ds_read_b64_tr_b16 v[138:139], v3 offset:6656
  ds_read_b64_tr_b16 v[140:141], v3 offset:7168
  ds_read_b64_tr_b16 v[142:143], v3 offset:7680
  v_mfma_f32_32x32x16_bf16 a[0:15], v[112:115], v[16:19], 0
  v_mfma_f32_32x32x16_bf16 a[0:15], v[116:119], v[20:23], a[0:15]
  v_mfma_f32_32x32x16_bf16 a[0:15], v[120:123], v[24:27], a[0:15]
  v_mfma_f32_32x32x16_bf16 a[0:15], v[124:127], v[28:31], a[0:15]
  s_add_u32 m0, s23, 0
  s_nop 0
  buffer_load_dwordx4 v8, s[8:11], s22 offen lds
  buffer_load_dwordx4 v[16:19], v2, s[4:7], s20 offen
  s_add_u32 s20, s20, 1024
  s_add_u32 s22, s22, 20480
  s_add_u32 m0, s23, 1024
  s_nop 0
  buffer_load_dwordx4 v8, s[8:11], s22 offen lds
  buffer_load_dwordx4 v[20:23], v2, s[4:7], s20 offen
  s_add_u32 s20, s20, 1024
  s_add_u32 s22, s22, 20480
  s_add_u32 m0, s23, 2048
  s_nop 0
  buffer_load_dwordx4 v8, s[8:11], s22 offen lds
  buffer_load_dwordx4 v[24:27], v2, s[4:7], s20 offen
  s_add_u32 s20, s20, 1024
  s_add_u32 s22, s22, 20480
  s_add_u32 m0, s23, 3072
  s_nop 0
  buffer_load_dwordx4 v8, s[8:11], s22 offen lds
  buffer_load_dwordx4 v[28:31], v2, s[4:7], s20 offen
  s_add_u32 s20, s20, 1024
  s_add_u32 s22, s22, 20480
  s_waitcnt vmcnt(32) lgkmcnt(0)
  ds_read_b64_tr_b16 v[112:113], v3 offset:8192
  ds_read_b64_tr_b16 v[114:115], v3 offset:8704
  ds_read_b64_tr_b16 v[116:117], v3 offset:9216
  ds_read_b64_tr_b16 v[118:119], v3 offset:9728
  ds_read_b64_tr_b16 v[120:121], v3 offset:10240
  ds_read_b64_tr_b16 v[122:123], v3 offset:10752
  ds_read_b64_tr_b16 v[124:125], v3 offset:11264
  ds_read_b64_tr_b16 v[126:127], v3 offset:11776
  v_mfma_f32_32x32x16_bf16 a[0:15], v[128:131], v[32:35], a[0:15]
  v_mfma_f32_32x32x16_bf16 a[0:15], v[132:135], v[36:39], a[0:15]
  v_mfma_f32_32x32x16_bf16 a[0:15], v[136:139], v[40:43], a[0:15]
  v_mfma_f32_32x32x16_bf16 a[0:15], v[140:143], v[44:47], a[0:15]
  s_add_u32 m0, s23, 4096
  s_nop 0
  buffer_load_dwordx4 v8, s[8:11], s22 offen lds
  buffer_load_dwordx4 v[32:35], v2, s[4:7], s20 offen
  s_add_u32 s20, s20, 1024
  s_add_u32 s22, s22, 20480
  s_add_u32 m0, s23, 5120
  s_nop 0
  buffer_load_dwordx4 v8, s[8:11], s22 offen lds
  buffer_load_dwordx4 v[36:39], v2, s[4:7], s20 offen
  s_add_u32 s20, s20, 1024
  s_add_u32 s22, s22, 20480
  s_add_u32 m0, s23, 6144
  s_nop 0
  buffer_load_dwordx4 v8, s[8:11], s22 offen lds
  buffer_load_dwordx4 v[40:43], v2, s[4:7], s20 offen
  s_add_u32 s20, s20, 1024
  s_add_u32 s22, s22, 20480
  s_add_u32 m0, s23, 7168
  s_nop 0
  buffer_load_dwordx4 v8, s[8:11], s22 offen lds
  buffer_load_dwordx4 v[44:47], v2, s[4:7], s20 offen
  s_add_u32 s20, s20, 1024
  s_add_u32 s22, s22, 20480
  s_waitcnt vmcnt(32) lgkmcnt(0)
  ds_read_b64_tr_b16 v[128:129], v3 offset:12288
  ds_read_b64_tr_b16 v[130:131], v3 offset:12800
  ds_read_b64_tr_b16 v[132:133], v3 offset:13312
  ds_read_b64_tr_b16 v[134:135], v3 offset:13824
  ds_read_b64_tr_b16 v[136:137], v3 offset:14336
  ds_read_b64_tr_b16 v[138:139], v3 offset:14848
  ds_read_b64_tr_b16 v[140:141], v3 offset:15360
  ds_read_b64_tr_b16 v[142:143], v3 offset:15872
  v_mfma_f32_32x32x16_bf16 a[0:15], v[112:115], v[48:51], a[0:15]
  v_mfma_f32_32x32x16_bf16 a[0:15], v[116:119], v[52:55], a[0:15]
  v_mfma_f32_32x32x16_bf16 a[0:15], v[120:123], v[56:59], a[0:15]
  v_mfma_f32_32x32x16_bf16 a[0:15], v[124:127], v[60:63], a[0:15]
  s_add_u32 m0, s23, 8192
  s_nop 0
  buffer_load_dwordx4 v8, s[8:11], s22 offen lds
  buffer_load_dwordx4 v[48:51], v2, s[4:7], s20 offen
  s_add_u32 s20, s20, 1024
  s_add_u32 s22, s22, 20480
  s_add_u32 m0, s23, 9216
  s_nop 0
  buffer_load_dwordx4 v8, s[8:11], s22 offen lds
  buffer_load_dwordx4 v[52:55], v2, s[4:7], s20 offen
  s_add_u32 s20, s20, 1024
  s_add_u32 s22, s22, 20480
  s_add_u32 m0, s23, 10240
  s_nop 0
  buffer_load_dwordx4 v8, s[8:11], s22 offen lds
  buffer_load_dwordx4 v[56:59], v2, s[4:7], s20 offen
  s_add_u32 s20, s20, 1024
  s_add_u32 s22, s22, 20480
  s_add_u32 m0, s23, 11264
  s_nop 0
  buffer_load_dwordx4 v8, s[8:11], s22 offen lds
  buffer_load_dwordx4 v[60:63], v2, s[4:7], s20 offen
  s_add_u32 s20, s20, 1024
  s_add_u32 s22, s22, 20480
  s_waitcnt vmcnt(32) lgkmcnt(0)
  ds_read_b64_tr_b16 v[112:113], v3 offset:16384
  ds_read_b64_tr_b16 v[114:115], v3 offset:16896
  ds_read_b64_tr_b16 v[116:117], v3 offset:17408
  ds_read_b64_tr_b16 v[118:119], v3 offset:17920
  ds_read_b64_tr_b16 v[120:121], v3 offset:18432
  ds_read_b64_tr_b16 v[122:123], v3 offset:18944
  ds_read_b64_tr_b16 v[124:125], v3 offset:19456
  ds_read_b64_tr_b16 v[126:127], v3 offset:19968
  v_mfma_f32_32x32x16_bf16 a[0:15], v[128:131], v[64:67], a[0:15]
  v_mfma_f32_32x32x16_bf16 a[0:15], v[132:135], v[68:71], a[0:15]
  v_mfma_f32_32x32x16_bf16 a[0:15], v[136:139], v[72:75], a[0:15]
  v_mfma_f32_32x32x16_bf16 a[0:15], v[140:143], v[76:79], a[0:15]
  s_add_u32 m0, s23, 12288
  s_nop 0
  buffer_load_dwordx4 v8, s[8:11], s22 offen lds
  buffer_load_dwordx4 v[64:67], v2, s[4:7], s20 offen
  s_add_u32 s20, s20, 1024
  s_add_u32 s22, s22, 20480
  s_add_u32 m0, s23, 13312
  s_nop 0
  buffer_load_dwordx4 v8, s[8:11], s22 offen lds
  buffer_load_dwordx4 v[68:71], v2, s[4:7], s20 offen
  s_add_u32 s20, s20, 1024
  s_add_u32 s22, s22, 20480
  s_add_u32 m0, s23, 14336
  s_nop 0
  buffer_load_dwordx4 v8, s[8:11], s22 offen lds
  buffer_load_dwordx4 v[72:75], v2, s[4:7], s20 offen
  s_add_u32 s20, s20, 1024
  s_add_u32 s22, s22, 20480
  s_add_u32 m0, s23, 15360
  s_nop 0
  buffer_load_dwordx4 v8, s[8:11], s22 offen lds
  buffer_load_dwordx4 v[76:79], v2, s[4:7], s20 offen
  s_add_u32 s20, s20, 1024
  s_add_u32 s22, s22, 20480
  s_waitcnt vmcnt(32) lgkmcnt(0)
  ds_read_b64_tr_b16 v[128:129], v3 offset:20480
  ds_read_b64_tr_b16 v[130:131], v3 offset:20992
  ds_read_b64_tr_b16 v[132:133], v3 offset:21504
  ds_read_b64_tr_b16 v[134:135], v3 offset:22016
  ds_read_b64_tr_b16 v[136:137], v3 offset:22528
  ds_read_b64_tr_b16 v[138:139], v3 offset:23040
  ds_read_b64_tr_b16 v[140:141], v3 offset:23552
  ds_read_b64_tr_b16 v[142:143], v3 offset:24064
  v_mfma_f32_32x32x16_bf16 a[0:15], v[112:115], v[80:83], a[0:15]
  v_mfma_f32_32x32x16_bf16 a[0:15], v[116:119], v[84:87], a[0:15]
  v_mfma_f32_32x32x16_bf16 a[0:15], v[120:123], v[88:91], a[0:15]
  v_mfma_f32_32x32x16_bf16 a[0:15], v[124:127], v[92:95], a[0:15]
  s_add_u32 m0, s23, 16384
  s_nop 0
  buffer_load_dwordx4 v8, s[8:11], s22 offen lds
  buffer_load_dwordx4 v[80:83], v2, s[4:7], s20 offen
  s_add_u32 s20, s20, 1024
  s_add_u32 s22, s22, 20480
  s_add_u32 m0, s23, 17408
  s_nop 0
  buffer_load_dwordx4 v8, s[8:11], s22 offen lds
  buffer_load_dwordx4 v[84:87], v2, s[4:7], s20 offen
  s_add_u32 s20, s20, 1024
  s_add_u32 s22, s22, 20480
  s_add_u32 m0, s23, 18432
  s_nop 0
  buffer_load_dwordx4 v8, s[8:11], s22 offen lds
  buffer_load_dwordx4 v[88:91], v2, s[4:7], s20 offen
  s_add_u32 s20, s20, 1024
  s_add_u32 s22, s22, 20480
  s_add_u32 m0, s23, 19456
  s_nop 0
  buffer_load_dwordx4 v8, s[8:11], s22 offen lds
  buffer_load_dwordx4 v[92:95], v2, s[4:7], s20 offen
  s_add_u32 s20, s20, 1024
  s_add_u32 s22, s22, 20480
  s_waitcnt vmcnt(32) lgkmcnt(0)
  ds_read_b64_tr_b16 v[112:113], v3 offset:0
  ds_read_b64_tr_b16 v[114:115], v3 offset:512
  ds_read_b64_tr_b16 v[116:117], v3 offset:1024
  ds_read_b64_tr_b16 v[118:119], v3 offset:1536
  ds_read_b64_tr_b16 v[120:121], v3 offset:2048
  ds_read_b64_tr_b16 v[122:123], v3 offset:2560
  ds_read_b64_tr_b16 v[124:125], v3 offset:3072
  ds_read_b64_tr_b16 v[126:127], v3 offset:3584
  v_mfma_f32_32x32x16_bf16 a[0:15], v[128:131], v[96:99], a[0:15]
  v_mfma_f32_32x32x16_bf16 a[0:15], v[132:135], v[100:103], a[0:15]
  v_mfma_f32_32x32x16_bf16 a[0:15], v[136:139], v[104:107], a[0:15]
  v_mfma_f32_32x32x16_bf16 a[0:15], v[140:143], v[108:111], a[0:15]
  s_add_u32 m0, s23, 20480
  s_nop 0
  buffer_load_dwordx4 v8, s[8:11], s22 offen lds
  buffer_load_dwordx4 v[96:99], v2, s[4:7], s20 offen
  s_add_u32 s20, s20, 1024
  s_add_u32 s22, s22, 20480
  s_add_u32 m0, s23, 21504
  s_nop 0
  buffer_load_dwordx4 v8, s[8:11], s22 offen lds
  buffer_load_dwordx4 v[100:103], v2, s[4:7], s20 offen
  s_add_u32 s20, s20, 1024
  s_add_u32 s22, s22, 20480
  s_add_u32 m0, s23, 22528
  s_nop 0
  buffer_load_dwordx4 v8, s[8:11], s22 offen lds
  buffer_load_dwordx4 v[104:107], v2, s[4:7], s20 offen
  s_add_u32 s20, s20, 1024
  s_add_u32 s22, s22, 20480
  s_add_u32 m0, s23, 23552
  s_nop 0
  buffer_load_dwordx4 v8, s[8:11], s22 offen lds
  buffer_load_dwordx4 v[108:111], v2, s[4:7], s20 offen
  s_add_u32 s20, s20, 1024
  s_add_u32 s22, s22, 20480
  s_mov_b32 s24, 2
OP_31_loop:
  s_waitcnt vmcnt(32) lgkmcnt(0)
  ds_read_b64_tr_b16 v[128:129], v3 offset:4096
  ds_read_b64_tr_b16 v[130:131], v3 offset:4608
  ds_read_b64_tr_b16 v[132:133], v3 offset:5120
  ds_read_b64_tr_b16 v[134:135], v3 offset:5632
  ds_read_b64_tr_b16 v[136:137], v3 offset:6144
  ds_read_b64_tr_b16 v[138:139], v3 offset:6656
  ds_read_b64_tr_b16 v[140:141], v3 offset:7168
  ds_read_b64_tr_b16 v[142:143], v3 offset:7680
  v_mfma_f32_32x32x16_bf16 a[0:15], v[112:115], v[16:19], a[0:15]
  v_mfma_f32_32x32x16_bf16 a[0:15], v[116:119], v[20:23], a[0:15]
  v_mfma_f32_32x32x16_bf16 a[0:15], v[120:123], v[24:27], a[0:15]
  v_mfma_f32_32x32x16_bf16 a[0:15], v[124:127], v[28:31], a[0:15]
  s_add_u32 m0, s23, 0
  s_nop 0
  buffer_load_dwordx4 v8, s[8:11], s22 offen lds
  buffer_load_dwordx4 v[16:19], v2, s[4:7], s20 offen
  s_add_u32 s20, s20, 1024
  s_add_u32 s22, s22, 20480
  s_add_u32 m0, s23, 1024
  s_nop 0
  buffer_load_dwordx4 v8, s[8:11], s22 offen lds
  buffer_load_dwordx4 v[20:23], v2, s[4:7], s20 offen
  s_add_u32 s20, s20, 1024
  s_add_u32 s22, s22, 20480
  s_add_u32 m0, s23, 2048
  s_nop 0
  buffer_load_dwordx4 v8, s[8:11], s22 offen lds
  buffer_load_dwordx4 v[24:27], v2, s[4:7], s20 offen
  s_add_u32 s20, s20, 1024
  s_add_u32 s22, s22, 20480
  s_add_u32 m0, s23, 3072
  s_nop 0
  buffer_load_dwordx4 v8, s[8:11], s22 offen lds
  buffer_load_dwordx4 v[28:31], v2, s[4:7], s20 offen
  s_add_u32 s20, s20, 1024
  s_add_u32 s22, s22, 20480
  s_waitcnt vmcnt(32) lgkmcnt(0)
  ds_read_b64_tr_b16 v[112:113], v3 offset:8192
  ds_read_b64_tr_b16 v[114:115], v3 offset:8704
  ds_read_b64_tr_b16 v[116:117], v3 offset:9216
  ds_read_b64_tr_b16 v[118:119], v3 offset:9728
  ds_read_b64_tr_b16 v[120:121], v3 offset:10240
  ds_read_b64_tr_b16 v[122:123], v3 offset:10752
  ds_read_b64_tr_b16 v[124:125], v3 offset:11264
  ds_read_b64_tr_b16 v[126:127], v3 offset:11776
  v_mfma_f32_32x32x16_bf16 a[0:15], v[128:131], v[32:35], a[0:15]
  v_mfma_f32_32x32x16_bf16 a[0:15], v[132:135], v[36:39], a[0:15]
  v_mfma_f32_32x32x16_bf16 a[0:15], v[136:139], v[40:43], a[0:15]
  v_mfma_f32_32x32x16_bf16 a[0:15], v[140:143], v[44:47], a[0:15]
  s_add_u32 m0, s23, 4096
  s_nop 0
  buffer_load_dwordx4 v8, s[8:11], s22 offen lds
  buffer_load_dwordx4 v[32:35], v2, s[4:7], s20 offen
  s_add_u32 s20, s20, 1024
  s_add_u32 s22, s22, 20480
  s_add_u32 m0, s23, 5120
  s_nop 0
  buffer_load_dwordx4 v8, s[8:11], s22 offen lds
  buffer_load_dwordx4 v[36:39], v2, s[4:7], s20 offen
  s_add_u32 s20, s20, 1024
  s_add_u32 s22, s22, 20480
  s_add_u32 m0, s23, 6144
  s_nop 0
  buffer_load_dwordx4 v8, s[8:11], s22 offen lds
  buffer_load_dwordx4 v[40:43], v2, s[4:7], s20 offen
  s_add_u32 s20, s20, 1024
  s_add_u32 s22, s22, 20480
  s_add_u32 m0, s23, 7168
  s_nop 0
  buffer_load_dwordx4 v8, s[8:11], s22 offen lds
  buffer_load_dwordx4 v[44:47], v2, s[4:7], s20 offen
  s_add_u32 s20, s20, 1024
  s_add_u32 s22, s22, 20480
  s_waitcnt vmcnt(32) lgkmcnt(0)
  ds_read_b64_tr_b16 v[128:129], v3 offset:12288
  ds_read_b64_tr_b16 v[130:131], v3 offset:12800
  ds_read_b64_tr_b16 v[132:133], v3 offset:13312
  ds_read_b64_tr_b16 v[134:135], v3 offset:13824
  ds_read_b64_tr_b16 v[136:137], v3 offset:14336
  ds_read_b64_tr_b16 v[138:139], v3 offset:14848
  ds_read_b64_tr_b16 v[140:141], v3 offset:15360
  ds_read_b64_tr_b16 v[142:143], v3 offset:15872
  v_mfma_f32_32x32x16_bf16 a[0:15], v[112:115], v[48:51], a[0:15]
  v_mfma_f32_32x32x16_bf16 a[0:15], v[116:119], v[52:55], a[0:15]
  v_mfma_f32_32x32x16_bf16 a[0:15], v[120:123], v[56:59], a[0:15]
  v_mfma_f32_32x32x16_bf16 a[0:15], v[124:127], v[60:63], a[0:15]
  s_add_u32 m0, s23, 8192
  s_nop 0
  buffer_load_dwordx4 v8, s[8:11], s22 offen lds
  buffer_load_dwordx4 v[48:51], v2, s[4:7], s20 offen
  s_add_u32 s20, s20, 1024
  s_add_u32 s22, s22, 20480
  s_add_u32 m0, s23, 9216
  s_nop 0
  buffer_load_dwordx4 v8, s[8:11], s22 offen lds
  buffer_load_dwordx4 v[52:55], v2, s[4:7], s20 offen
  s_add_u32 s20, s20, 1024
  s_add_u32 s22, s22, 20480
  s_add_u32 m0, s23, 10240
  s_nop 0
  buffer_load_dwordx4 v8, s[8:11], s22 offen lds
  buffer_load_dwordx4 v[56:59], v2, s[4:7], s20 offen
  s_add_u32 s20, s20, 1024
  s_add_u32 s22, s22, 20480
  s_add_u32 m0, s23, 11264
  s_nop 0
  buffer_load_dwordx4 v8, s[8:11], s22 offen lds
  buffer_load_dwordx4 v[60:63], v2, s[4:7], s20 offen
  s_add_u32 s20, s20, 1024
  s_add_u32 s22, s22, 20480
  s_waitcnt vmcnt(32) lgkmcnt(0)
  ds_read_b64_tr_b16 v[112:113], v3 offset:16384
  ds_read_b64_tr_b16 v[114:115], v3 offset:16896
  ds_read_b64_tr_b16 v[116:117], v3 offset:17408
  ds_read_b64_tr_b16 v[118:119], v3 offset:17920
  ds_read_b64_tr_b16 v[120:121], v3 offset:18432
  ds_read_b64_tr_b16 v[122:123], v3 offset:18944
  ds_read_b64_tr_b16 v[124:125], v3 offset:19456
  ds_read_b64_tr_b16 v[126:127], v3 offset:19968
  v_mfma_f32_32x32x16_bf16 a[0:15], v[128:131], v[64:67], a[0:15]
  v_mfma_f32_32x32x16_bf16 a[0:15], v[132:135], v[68:71], a[0:15]
  v_mfma_f32_32x32x16_bf16 a[0:15], v[136:139], v[72:75], a[0:15]
  v_mfma_f32_32x32x16_bf16 a[0:15], v[140:143], v[76:79], a[0:15]
  s_add_u32 m0, s23, 12288
  s_nop 0
  buffer_load_dwordx4 v8, s[8:11], s22 offen lds
  buffer_load_dwordx4 v[64:67], v2, s[4:7], s20 offen
  s_add_u32 s20, s20, 1024
  s_add_u32 s22, s22, 20480
  s_add_u32 m0, s23, 13312
  s_nop 0
  buffer_load_dwordx4 v8, s[8:11], s22 offen lds
  buffer_load_dwordx4 v[68:71], v2, s[4:7], s20 offen
  s_add_u32 s20, s20, 1024
  s_add_u32 s22, s22, 20480
  s_add_u32 m0, s23, 14336
  s_nop 0
  buffer_load_dwordx4 v8, s[8:11], s22 offen lds
  buffer_load_dwordx4 v[72:75], v2, s[4:7], s20 offen
  s_add_u32 s20, s20, 1024
  s_add_u32 s22, s22, 20480
  s_add_u32 m0, s23, 15360
  s_nop 0
  buffer_load_dwordx4 v8, s[8:11], s22 offen lds
  buffer_load_dwordx4 v[76:79], v2, s[4:7], s20 offen
  s_add_u32 s20, s20, 1024
  s_add_u32 s22, s22, 20480
  s_waitcnt vmcnt(32) lgkmcnt(0)
  ds_read_b64_tr_b16 v[128:129], v3 offset:20480
  ds_read_b64_tr_b16 v[130:131], v3 offset:20992
  ds_read_b64_tr_b16 v[132:133], v3 offset:21504
  ds_read_b64_tr_b16 v[134:135], v3 offset:22016
  ds_read_b64_tr_b16 v[136:137], v3 offset:22528
  ds_read_b64_tr_b16 v[138:139], v3 offset:23040
  ds_read_b64_tr_b16 v[140:141], v3 offset:23552
  ds_read_b64_tr_b16 v[142:143], v3 offset:24064
  v_mfma_f32_32x32x16_bf16 a[0:15], v[112:115], v[80:83], a[0:15]
  v_mfma_f32_32x32x16_bf16 a[0:15], v[116:119], v[84:87], a[0:15]
  v_mfma_f32_32x32x16_bf16 a[0:15], v[120:123], v[88:91], a[0:15]
  v_mfma_f32_32x32x16_bf16 a[0:15], v[124:127], v[92:95], a[0:15]
  s_add_u32 m0, s23, 16384
  s_nop 0
  buffer_load_dwordx4 v8, s[8:11], s22 offen lds
  buffer_load_dwordx4 v[80:83], v2, s[4:7], s20 offen
  s_add_u32 s20, s20, 1024
  s_add_u32 s22, s22, 20480
  s_add_u32 m0, s23, 17408
  s_nop 0
  buffer_load_dwordx4 v8, s[8:11], s22 offen lds
  buffer_load_dwordx4 v[84:87], v2, s[4:7], s20 offen
  s_add_u32 s20, s20, 1024
  s_add_u32 s22, s22, 20480
  s_add_u32 m0, s23, 18432
  s_nop 0
  buffer_load_dwordx4 v8, s[8:11], s22 offen lds
  buffer_load_dwordx4 v[88:91], v2, s[4:7], s20 offen
  s_add_u32 s20, s20, 1024
  s_add_u32 s22, s22, 20480
  s_add_u32 m0, s23, 19456
  s_nop 0
  buffer_load_dwordx4 v8, s[8:11], s22 offen lds
  buffer_load_dwordx4 v[92:95], v2, s[4:7], s20 offen
  s_add_u32 s20, s20, 1024
  s_add_u32 s22, s22, 20480
  s_waitcnt vmcnt(32) lgkmcnt(0)
  ds_read_b64_tr_b16 v[112:113], v3 offset:0
  ds_read_b64_tr_b16 v[114:115], v3 offset:512
  ds_read_b64_tr_b16 v[116:117], v3 offset:1024
  ds_read_b64_tr_b16 v[118:119], v3 offset:1536
  ds_read_b64_tr_b16 v[120:121], v3 offset:2048
  ds_read_b64_tr_b16 v[122:123], v3 offset:2560
  ds_read_b64_tr_b16 v[124:125], v3 offset:3072
  ds_read_b64_tr_b16 v[126:127], v3 offset:3584
  v_mfma_f32_32x32x16_bf16 a[0:15], v[128:131], v[96:99], a[0:15]
  v_mfma_f32_32x32x16_bf16 a[0:15], v[132:135], v[100:103], a[0:15]
  v_mfma_f32_32x32x16_bf16 a[0:15], v[136:139], v[104:107], a[0:15]
  v_mfma_f32_32x32x16_bf16 a[0:15], v[140:143], v[108:111], a[0:15]
  s_add_u32 m0, s23, 20480
  s_nop 0
  buffer_load_dwordx4 v8, s[8:11], s22 offen lds
  buffer_load_dwordx4 v[96:99], v2, s[4:7], s20 offen
  s_add_u32 s20, s20, 1024
  s_add_u32 s22, s22, 20480
  s_add_u32 m0, s23, 21504
  s_nop 0
  buffer_load_dwordx4 v8, s[8:11], s22 offen lds
  buffer_load_dwordx4 v[100:103], v2, s[4:7], s20 offen
  s_add_u32 s20, s20, 1024
  s_add_u32 s22, s22, 20480
  s_add_u32 m0, s23, 22528
  s_nop 0
  buffer_load_dwordx4 v8, s[8:11], s22 offen lds
  buffer_load_dwordx4 v[104:107], v2, s[4:7], s20 offen
  s_add_u32 s20, s20, 1024
  s_add_u32 s22, s22, 20480
  s_add_u32 m0, s23, 23552
  s_nop 0
  buffer_load_dwordx4 v8, s[8:11], s22 offen lds
  buffer_load_dwordx4 v[108:111], v2, s[4:7], s20 offen
  s_add_u32 s20, s20, 1024
  s_add_u32 s22, s22, 20480
  s_sub_u32 s24, s24, 1
  s_cmp_lg_u32 s24, 0
  s_cbranch_scc1 OP_31_loop
  s_cmp_eq_u32 s80, 0
  s_cbranch_scc0 TI_32
  v_mov_b32 v255, 1
  s_mov_b64 exec, 1
  buffer_atomic_add v255, off, s[84:87], s97 sc0 sc1
  s_mov_b64 exec, -1
TI_32:
  s_waitcnt vmcnt(32) lgkmcnt(0)
  ds_read_b64_tr_b16 v[128:129], v3 offset:4096
  ds_read_b64_tr_b16 v[130:131], v3 offset:4608
  ds_read_b64_tr_b16 v[132:133], v3 offset:5120
  ds_read_b64_tr_b16 v[134:135], v3 offset:5632
  ds_read_b64_tr_b16 v[136:137], v3 offset:6144
  ds_read_b64_tr_b16 v[138:139], v3 offset:6656
  ds_read_b64_tr_b16 v[140:141], v3 offset:7168
  ds_read_b64_tr_b16 v[142:143], v3 offset:7680
  v_mfma_f32_32x32x16_bf16 a[0:15], v[112:115], v[16:19], a[0:15]
  v_mfma_f32_32x32x16_bf16 a[0:15], v[116:119], v[20:23], a[0:15]
  v_mfma_f32_32x32x16_bf16 a[0:15], v[120:123], v[24:27], a[0:15]
  v_mfma_f32_32x32x16_bf16 a[0:15], v[124:127], v[28:31], a[0:15]
  s_waitcnt vmcnt(24) lgkmcnt(0)
  ds_read_b64_tr_b16 v[112:113], v3 offset:8192
  ds_read_b64_tr_b16 v[114:115], v3 offset:8704
  ds_read_b64_tr_b16 v[116:117], v3 offset:9216
  ds_read_b64_tr_b16 v[118:119], v3 offset:9728
  ds_read_b64_tr_b16 v[120:121], v3 offset:10240
  ds_read_b64_tr_b16 v[122:123], v3 offset:10752
  ds_read_b64_tr_b16 v[124:125], v3 offset:11264
  ds_read_b64_tr_b16 v[126:127], v3 offset:11776
  v_mfma_f32_32x32x16_bf16 a[0:15], v[128:131], v[32:35], a[0:15]
  v_mfma_f32_32x32x16_bf16 a[0:15], v[132:135], v[36:39], a[0:15]
  v_mfma_f32_32x32x16_bf16 a[0:15], v[136:139], v[40:43], a[0:15]
  v_mfma_f32_32x32x16_bf16 a[0:15], v[140:143], v[44:47], a[0:15]
  s_waitcnt vmcnt(16) lgkmcnt(0)
  ds_read_b64_tr_b16 v[128:129], v3 offset:12288
  ds_read_b64_tr_b16 v[130:131], v3 offset:12800
  ds_read_b64_tr_b16 v[132:133], v3 offset:13312
  ds_read_b64_tr_b16 v[134:135], v3 offset:13824
  ds_read_b64_tr_b16 v[136:137], v3 offset:14336
  ds_read_b64_tr_b16 v[138:139], v3 offset:14848
  ds_read_b64_tr_b16 v[140:141], v3 offset:15360
  ds_read_b64_tr_b16 v[142:143], v3 offset:15872
  v_mfma_f32_32x32x16_bf16 a[0:15], v[112:115], v[48:51], a[0:15]
  v_mfma_f32_32x32x16_bf16 a[0:15], v[116:119], v[52:55], a[0:15]
  v_mfma_f32_32x32x16_bf16 a[0:15], v[120:123], v[56:59], a[0:15]
  v_mfma_f32_32x32x16_bf16 a[0:15], v[124:127], v[60:63], a[0:15]
  s_waitcnt vmcnt(8) lgkmcnt(0)
  ds_read_b64_tr_b16 v[112:113], v3 offset:16384
  ds_read_b64_tr_b16 v[114:115], v3 offset:16896
  ds_read_b64_tr_b16 v[116:117], v3 offset:17408
  ds_read_b64_tr_b16 v[118:119], v3 offset:17920
  ds_read_b64_tr_b16 v[120:121], v3 offset:18432
  ds_read_b64_tr_b16 v[122:123], v3 offset:18944
  ds_read_b64_tr_b16 v[124:125], v3 offset:19456
  ds_read_b64_tr_b16 v[126:127], v3 offset:19968
  v_mfma_f32_32x32x16_bf16 a[0:15], v[128:131], v[64:67], a[0:15]
  v_mfma_f32_32x32x16_bf16 a[0:15], v[132:135], v[68:71], a[0:15]
  v_mfma_f32_32x32x16_bf16 a[0:15], v[136:139], v[72:75], a[0:15]
  v_mfma_f32_32x32x16_bf16 a[0:15], v[140:143], v[76:79], a[0:15]
  s_waitcnt vmcnt(0) lgkmcnt(0)
  ds_read_b64_tr_b16 v[128:129], v3 offset:20480
  ds_read_b64_tr_b16 v[130:131], v3 offset:20992
  ds_read_b64_tr_b16 v[132:133], v3 offset:21504
  ds_read_b64_tr_b16 v[134:135], v3 offset:22016
  ds_read_b64_tr_b16 v[136:137], v3 offset:22528
  ds_read_b64_tr_b16 v[138:139], v3 offset:23040
  ds_read_b64_tr_b16 v[140:141], v3 offset:23552
  ds_read_b64_tr_b16 v[142:143], v3 offset:24064
  v_mfma_f32_32x32x16_bf16 a[0:15], v[112:115], v[80:83], a[0:15]
  v_mfma_f32_32x32x16_bf16 a[0:15], v[116:119], v[84:87], a[0:15]
  v_mfma_f32_32x32x16_bf16 a[0:15], v[120:123], v[88:91], a[0:15]
  v_mfma_f32_32x32x16_bf16 a[0:15], v[124:127], v[92:95], a[0:15]
  s_waitcnt lgkmcnt(0)
  v_mfma_f32_32x32x16_bf16 a[0:15], v[128:131], v[96:99], a[0:15]
  v_mfma_f32_32x32x16_bf16 a[0:15], v[132:135], v[100:103], a[0:15]
  v_mfma_f32_32x32x16_bf16 a[0:15], v[136:139], v[104:107], a[0:15]
  v_mfma_f32_32x32x16_bf16 a[0:15], v[140:143], v[108:111], a[0:15]
  s_waitcnt vmcnt(0)
  v_readfirstlane_b32 s96, v255
  s_nop 7
  s_nop 7
  v_add_u32 v5, s23, v2
  s_cmp_eq_u32 s80, 0
  s_cbranch_scc0 OP_31_w0
OP_31_w0:
  s_cmp_eq_u32 s80, 1
  s_cbranch_scc0 OP_31_w1
  ds_write_b128 v5, a[0:3] offset:0
  ds_write_b128 v5, a[4:7] offset:1024
  ds_write_b128 v5, a[8:11] offset:2048
  ds_write_b128 v5, a[12:15] offset:3072
OP_31_w1:
  s_cmp_eq_u32 s80, 2
  s_cbranch_scc0 OP_31_w2
  ds_write_b128 v5, a[0:3] offset:0
  ds_write_b128 v5, a[4:7] offset:1024
  ds_write_b128 v5, a[8:11] offset:2048
  ds_write_b128 v5, a[12:15] offset:3072
OP_31_w2:
  s_cmp_eq_u32 s80, 3
  s_cbranch_scc0 OP_31_w3
  ds_write_b128 v5, a[0:3] offset:0
  ds_write_b128 v5, a[4:7] offset:1024
  ds_write_b128 v5, a[8:11] offset:2048
  ds_write_b128 v5, a[12:15] offset:3072
OP_31_w3:
  s_waitcnt lgkmcnt(0)
  s_barrier
  s_mul_i32 s25, s37, 81920
  s_lshl_b32 s34, s39, 1
  s_add_u32 s25, s25, s34
  s_cmp_eq_u32 s80, 0
  s_cbranch_scc0 OP_31_r0
  v_add_u32 v6, 32768, v2
  ds_read_b128 v[160:163], v6 offset:0
  ds_read_b128 v[164:167], v6 offset:1024
  ds_read_b128 v[168:171], v6 offset:2048
  ds_read_b128 v[172:175], v6 offset:3072
  v_add_u32 v6, 65536, v2
  ds_read_b128 v[176:179], v6 offset:0
  ds_read_b128 v[180:183], v6 offset:1024
  ds_read_b128 v[184:187], v6 offset:2048
  ds_read_b128 v[188:191], v6 offset:3072
  v_add_u32 v6, 98304, v2
  ds_read_b128 v[192:195], v6 offset:0
  ds_read_b128 v[196:199], v6 offset:1024
  ds_read_b128 v[200:203], v6 offset:2048
  ds_read_b128 v[204:207], v6 offset:3072
  v_accvgpr_read_b32 v208, a0
  v_accvgpr_read_b32 v209, a1
  v_accvgpr_read_b32 v210, a2
  v_accvgpr_read_b32 v211, a3
  v_accvgpr_read_b32 v212, a4
  v_accvgpr_read_b32 v213, a5
  v_accvgpr_read_b32 v214, a6
  v_accvgpr_read_b32 v215, a7
  v_accvgpr_read_b32 v216, a8
  v_accvgpr_read_b32 v217, a9
  v_accvgpr_read_b32 v218, a10
  v_accvgpr_read_b32 v219, a11
  v_accvgpr_read_b32 v220, a12
  v_accvgpr_read_b32 v221, a13
  v_accvgpr_read_b32 v222, a14
  v_accvgpr_read_b32 v223, a15
  s_waitcnt lgkmcnt(0)
  v_pk_add_f32 v[160:161], v[160:161], v[176:177]
  v_pk_add_f32 v[192:193], v[192:193], v[208:209]
  v_pk_add_f32 v[162:163], v[162:163], v[178:179]
  v_pk_add_f32 v[194:195], v[194:195], v[210:211]
  v_pk_add_f32 v[164:165], v[164:165], v[180:181]
  v_pk_add_f32 v[196:197], v[196:197], v[212:213]
  v_pk_add_f32 v[166:167], v[166:167], v[182:183]
  v_pk_add_f32 v[198:199], v[198:199], v[214:215]
  v_pk_add_f32 v[168:169], v[168:169], v[184:185]
  v_pk_add_f32 v[200:201], v[200:201], v[216:217]
  v_pk_add_f32 v[170:171], v[170:171], v[186:187]
  v_pk_add_f32 v[202:203], v[202:203], v[218:219]
  v_pk_add_f32 v[172:173], v[172:173], v[188:189]
  v_pk_add_f32 v[204:205], v[204:205], v[220:221]
  v_pk_add_f32 v[174:175], v[174:175], v[190:191]
  v_pk_add_f32 v[206:207], v[206:207], v[222:223]
  v_pk_add_f32 v[160:161], v[160:161], v[192:193]
  v_pk_add_f32 v[162:163], v[162:163], v[194:195]
  v_pk_add_f32 v[164:165], v[164:165], v[196:197]
  v_pk_add_f32 v[166:167], v[166:167], v[198:199]
  v_pk_add_f32 v[168:169], v[168:169], v[200:201]
  v_pk_add_f32 v[170:171], v[170:171], v[202:203]
  v_pk_add_f32 v[172:173], v[172:173], v[204:205]
  v_pk_add_f32 v[174:175], v[174:175], v[206:207]
  v_cvt_pk_bf16_f32 v224, v160, v161
  v_cvt_pk_bf16_f32 v225, v162, v163
  v_cvt_pk_bf16_f32 v226, v164, v165
  v_cvt_pk_bf16_f32 v227, v166, v167
  v_cvt_pk_bf16_f32 v228, v168, v169
  v_cvt_pk_bf16_f32 v229, v170, v171
  v_cvt_pk_bf16_f32 v230, v172, v173
  v_cvt_pk_bf16_f32 v231, v174, v175
  s_add_u32 s34, s25, 0
  s_nop 0
  v_permlane32_swap_b32 v224, v226
  v_permlane32_swap_b32 v225, v227
  v_permlane32_swap_b32 v228, v230
  v_permlane32_swap_b32 v229, v231
  buffer_store_dwordx4 v[224:227], v4, s[16:19], s34 offen offset:0
  buffer_store_dwordx4 v[228:231], v4, s[16:19], s34 offen offset:32
OP_31_r0:
  s_cmp_eq_u32 s80, 1
  s_cbranch_scc0 OP_31_r1
OP_31_r1:
  s_cmp_eq_u32 s80, 2
  s_cbranch_scc0 OP_31_r2
OP_31_r2:
  s_cmp_eq_u32 s80, 3
  s_cbranch_scc0 OP_31_r3
OP_31_r3:
  s_barrier
  s_branch BG_FIN
BG_OM:
  s_lshr_b32 s37, s82, 1
  s_add_u32 s37, s37, s83
  s_and_b32 s38, s82, 1
  s_mul_i32 s39, s38, 96
  s_mul_i32 s34, s79, 160
  s_add_u32 s39, s39, s34
  s_lshl_b32 s91, s37, 7
  s_add_u32 s91, s91, 1839104
  s_cmp_eq_u32 s80, 0
  s_cbranch_scc0 W_33_d
  v_lshlrev_b32 v2, 6, v0
  s_mov_b32 s93, 0
  s_mov_b64 exec, 0x3
W_33_l:
  buffer_load_dword v3, v2, s[84:87], s91 offen sc1
  s_add_u32 s93, s93, 1
  s_waitcnt vmcnt(0)
  v_cmp_gt_u32 vcc, 8, v3
  s_cbranch_vccz W_33_k
  s_sleep 48
  s_cmp_lt_u32 s93, 200000
  s_cbranch_scc1 W_33_l
W_33_k:
  s_mov_b64 exec, -1
W_33_d:
  s_barrier
  s_load_dwordx2 s[8:9], s[0:1], 40
  s_mov_b32 s10, 0x780000
  s_mov_b32 s11, 0x00020000
  s_load_dwordx2 s[16:17], s[0:1], 80
  s_mov_b32 s18, 0x500000
  s_mov_b32 s19, 0x00020000
  s_mov_b32 s4, s84
  s_mov_b32 s5, s85
  s_mov_b32 s6, s86
  s_mov_b32 s7, s87
  s_cmp_eq_u32 s38, 0
  s_cbranch_scc0 BG_OMB
  v_lshlrev_b32 v2, 4, v1
  v_add_u32 v5, 0, v1
  v_mul_u32_u24 v6, 5462, v5
  v_lshrrev_b32 v6, 16, v6
  v_mul_u32_u24 v7, 12, v6
  v_sub_u32 v7, v5, v7
  v_mul_u32_u24 v6, 1280, v6
  v_lshlrev_b32 v7, 4, v7
  v_add_u32 v8, v6, v7
  v_add_u32 v5, 64, v1
  v_mul_u32_u24 v6, 5462, v5
  v_lshrrev_b32 v6, 16, v6
  v_mul_u32_u24 v7, 12, v6
  v_sub_u32 v7, v5, v7
  v_mul_u32_u24 v6, 1280, v6
  v_lshlrev_b32 v7, 4, v7
  v_add_u32 v9, v6, v7
  v_add_u32 v5, 128, v1
  v_mul_u32_u24 v6, 5462, v5
  v_lshrrev_b32 v6, 16, v6
  v_mul_u32_u24 v7, 12, v6
  v_sub_u32 v7, v5, v7
  v_mul_u32_u24 v6, 1280, v6
  v_lshlrev_b32 v7, 4, v7
  v_add_u32 v10, v6, v7
  v_lshrrev_b32 v5, 5, v1
  v_lshlrev_b32 v5, 2, v5
  v_bfe_u32 v6, v1, 2, 2
  v_add_u32 v5, v5, v6
  v_mul_u32_u24 v5, 192, v5
  v_bfe_u32 v6, v1, 4, 1
  v_lshlrev_b32 v6, 5, v6
  v_and_b32 v7, 3, v1
  v_lshlrev_b32 v7, 3, v7
  v_add3_u32 v5, v5, v6, v7
  s_mul_i32 s34, s80, 32768
  v_add_u32 v3, s34, v5
  v_and_b32 v5, 31, v1
  v_mul_u32_u24 v5, 2560, v5
  v_lshrrev_b32 v6, 5, v1
  v_lshlrev_b32 v6, 4, v6
  v_add_u32 v4, v5, v6
  s_waitcnt lgkmcnt(0)
  s_mul_i32 s20, s37, 786432
  s_mul_i32 s34, s80, 98304
  s_add_u32 s20, s20, s34
  s_add_u32 s20, s20, 77594624
  s_add_u32 s21, s20, 393216
  s_mul_i32 s22, s80, 1966080
  s_lshl_b32 s34, s39, 1
  s_add_u32 s22, s22, s34
  s_mul_i32 s23, s80, 32768
  s_add_u32 m0, s23, 0
  s_nop 0
  buffer_load_dwordx4 v8, s[8:11], s22 offen lds
  s_add_u32 m0, s23, 1024
  s_nop 0
  buffer_load_dwordx4 v9, s[8:11], s22 offen lds
  s_add_u32 m0, s23, 2048
  s_nop 0
  buffer_load_dwordx4 v10, s[8:11], s22 offen lds
  buffer_load_dwordx4 v[16:19], v2, s[4:7], s20 offen
  buffer_load_dwordx4 v[20:23], v2, s[4:7], s21 offen
  s_add_u32 s20, s20, 1024
  s_add_u32 s21, s21, 1024
  s_add_u32 s22, s22, 20480
  s_add_u32 m0, s23, 3072
  s_nop 0
  buffer_load_dwordx4 v8, s[8:11], s22 offen lds
  s_add_u32 m0, s23, 4096
  s_nop 0
  buffer_load_dwordx4 v9, s[8:11], s22 offen lds
  s_add_u32 m0, s23, 5120
  s_nop 0
  buffer_load_dwordx4 v10, s[8:11], s22 offen lds
  buffer_load_dwordx4 v[24:27], v2, s[4:7], s20 offen
  buffer_load_dwordx4 v[28:31], v2, s[4:7], s21 offen
  s_add_u32 s20, s20, 1024
  s_add_u32 s21, s21, 1024
  s_add_u32 s22, s22, 20480
  s_add_u32 m0, s23, 6144
  s_nop 0
  buffer_load_dwordx4 v8, s[8:11], s22 offen lds
  s_add_u32 m0, s23, 7168
  s_nop 0
  buffer_load_dwordx4 v9, s[8:11], s22 offen lds
  s_add_u32 m0, s23, 8192
  s_nop 0
  buffer_load_dwordx4 v10, s[8:11], s22 offen lds
  buffer_load_dwordx4 v[32:35], v2, s[4:7], s20 offen
  buffer_load_dwordx4 v[36:39], v2, s[4:7], s21 offen
  s_add_u32 s20, s20, 1024
  s_add_u32 s21, s21, 1024
  s_add_u32 s22, s22, 20480
  s_add_u32 m0, s23, 9216
  s_nop 0
  buffer_load_dwordx4 v8, s[8:11], s22 offen lds
  s_add_u32 m0, s23, 10240
  s_nop 0
  buffer_load_dwordx4 v9, s[8:11], s22 offen lds
  s_add_u32 m0, s23, 11264
  s_nop 0
  buffer_load_dwordx4 v10, s[8:11], s22 offen lds
  buffer_load_dwordx4 v[40:43], v2, s[4:7], s20 offen
  buffer_load_dwordx4 v[44:47], v2, s[4:7], s21 offen
  s_add_u32 s20, s20, 1024
  s_add_u32 s21, s21, 1024
  s_add_u32 s22, s22, 20480
  s_add_u32 m0, s23, 12288
  s_nop 0
  buffer_load_dwordx4 v8, s[8:11], s22 offen lds
  s_add_u32 m0, s23, 13312
  s_nop 0
  buffer_load_dwordx4 v9, s[8:11], s22 offen lds
  s_add_u32 m0, s23, 14336
  s_nop 0
  buffer_load_dwordx4 v10, s[8:11], s22 offen lds
  buffer_load_dwordx4 v[48:51], v2, s[4:7], s20 offen
  buffer_load_dwordx4 v[52:55], v2, s[4:7], s21 offen
  s_add_u32 s20, s20, 1024
  s_add_u32 s21, s21, 1024
  s_add_u32 s22, s22, 20480
  s_add_u32 m0, s23, 15360
  s_nop 0
  buffer_load_dwordx4 v8, s[8:11], s22 offen lds
  s_add_u32 m0, s23, 16384
  s_nop 0
  buffer_load_dwordx4 v9, s[8:11], s22 offen lds
  s_add_u32 m0, s23, 17408
  s_nop 0
  buffer_load_dwordx4 v10, s[8:11], s22 offen lds
  buffer_load_dwordx4 v[56:59], v2, s[4:7], s20 offen
  buffer_load_dwordx4 v[60:63], v2, s[4:7], s21 offen
  s_add_u32 s20, s20, 1024
  s_add_u32 s21, s21, 1024
  s_add_u32 s22, s22, 20480
  s_add_u32 m0, s23, 18432
  s_nop 0
  buffer_load_dwordx4 v8, s[8:11], s22 offen lds
  s_add_u32 m0, s23, 19456
  s_nop 0
  buffer_load_dwordx4 v9, s[8:11], s22 offen lds
  s_add_u32 m0, s23, 20480
  s_nop 0
  buffer_load_dwordx4 v10, s[8:11], s22 offen lds
  buffer_load_dwordx4 v[64:67], v2, s[4:7], s20 offen
  buffer_load_dwordx4 v[68:71], v2, s[4:7], s21 offen
  s_add_u32 s20, s20, 1024
  s_add_u32 s21, s21, 1024
  s_add_u32 s22, s22, 20480
  s_add_u32 m0, s23, 21504
  s_nop 0
  buffer_load_dwordx4 v8, s[8:11], s22 offen lds
  s_add_u32 m0, s23, 22528
  s_nop 0
  buffer_load_dwordx4 v9, s[8:11], s22 offen lds
  s_add_u32 m0, s23, 23552
  s_nop 0
  buffer_load_dwordx4 v10, s[8:11], s22 offen lds
  buffer_load_dwordx4 v[72:75], v2, s[4:7], s20 offen
  buffer_load_dwordx4 v[76:79], v2, s[4:7], s21 offen
  s_add_u32 s20, s20, 1024
  s_add_u32 s21, s21, 1024
  s_add_u32 s22, s22, 20480
  s_waitcnt vmcnt(35)
  ds_read_b64_tr_b16 v[80:81], v3 offset:0
  ds_read_b64_tr_b16 v[82:83], v3 offset:1536
  ds_read_b64_tr_b16 v[84:85], v3 offset:64
  ds_read_b64_tr_b16 v[86:87], v3 offset:1600
  ds_read_b64_tr_b16 v[88:89], v3 offset:128
  ds_read_b64_tr_b16 v[90:91], v3 offset:1664
  s_waitcnt vmcnt(30) lgkmcnt(0)
  v_mfma_f32_32x32x16_bf16 a[0:15], v[80:83], v[16:19], 0
  ds_read_b64_tr_b16 v[120:121], v3 offset:3072
  v_mfma_f32_32x32x16_bf16 a[16:31], v[80:83], v[20:23], 0
  ds_read_b64_tr_b16 v[122:123], v3 offset:4608
  v_mfma_f32_32x32x16_bf16 a[32:47], v[84:87], v[16:19], 0
  ds_read_b64_tr_b16 v[124:125], v3 offset:3136
  v_mfma_f32_32x32x16_bf16 a[48:63], v[84:87], v[20:23], 0
  ds_read_b64_tr_b16 v[126:127], v3 offset:4672
  v_mfma_f32_32x32x16_bf16 a[64:79], v[88:91], v[16:19], 0
  ds_read_b64_tr_b16 v[128:129], v3 offset:3200
  v_mfma_f32_32x32x16_bf16 a[80:95], v[88:91], v[20:23], 0
  ds_read_b64_tr_b16 v[130:131], v3 offset:4736
  s_add_u32 m0, s23, 0
  s_nop 0
  buffer_load_dwordx4 v8, s[8:11], s22 offen lds
  s_add_u32 m0, s23, 1024
  s_nop 0
  buffer_load_dwordx4 v9, s[8:11], s22 offen lds
  s_add_u32 m0, s23, 2048
  s_nop 0
  buffer_load_dwordx4 v10, s[8:11], s22 offen lds
  buffer_load_dwordx4 v[16:19], v2, s[4:7], s20 offen
  buffer_load_dwordx4 v[20:23], v2, s[4:7], s21 offen
  s_add_u32 s20, s20, 1024
  s_add_u32 s21, s21, 1024
  s_add_u32 s22, s22, 20480
  s_waitcnt vmcnt(30) lgkmcnt(0)
  v_mfma_f32_32x32x16_bf16 a[0:15], v[120:123], v[24:27], a[0:15]
  ds_read_b64_tr_b16 v[80:81], v3 offset:6144
  v_mfma_f32_32x32x16_bf16 a[16:31], v[120:123], v[28:31], a[16:31]
  ds_read_b64_tr_b16 v[82:83], v3 offset:7680
  v_mfma_f32_32x32x16_bf16 a[32:47], v[124:127], v[24:27], a[32:47]
  ds_read_b64_tr_b16 v[84:85], v3 offset:6208
  v_mfma_f32_32x32x16_bf16 a[48:63], v[124:127], v[28:31], a[48:63]
  ds_read_b64_tr_b16 v[86:87], v3 offset:7744
  v_mfma_f32_32x32x16_bf16 a[64:79], v[128:131], v[24:27], a[64:79]
  ds_read_b64_tr_b16 v[88:89], v3 offset:6272
  v_mfma_f32_32x32x16_bf16 a[80:95], v[128:131], v[28:31], a[80:95]
  ds_read_b64_tr_b16 v[90:91], v3 offset:7808
  s_add_u32 m0, s23, 3072
  s_nop 0
  buffer_load_dwordx4 v8, s[8:11], s22 offen lds
  s_add_u32 m0, s23, 4096
  s_nop 0
  buffer_load_dwordx4 v9, s[8:11], s22 offen lds
  s_add_u32 m0, s23, 5120
  s_nop 0
  buffer_load_dwordx4 v10, s[8:11], s22 offen lds
  buffer_load_dwordx4 v[24:27], v2, s[4:7], s20 offen
  buffer_load_dwordx4 v[28:31], v2, s[4:7], s21 offen
  s_add_u32 s20, s20, 1024
  s_add_u32 s21, s21, 1024
  s_add_u32 s22, s22, 20480
  s_waitcnt vmcnt(30) lgkmcnt(0)
  v_mfma_f32_32x32x16_bf16 a[0:15], v[80:83], v[32:35], a[0:15]
  ds_read_b64_tr_b16 v[120:121], v3 offset:9216
  v_mfma_f32_32x32x16_bf16 a[16:31], v[80:83], v[36:39], a[16:31]
  ds_read_b64_tr_b16 v[122:123], v3 offset:10752
  v_mfma_f32_32x32x16_bf16 a[32:47], v[84:87], v[32:35], a[32:47]
  ds_read_b64_tr_b16 v[124:125], v3 offset:9280
  v_mfma_f32_32x32x16_bf16 a[48:63], v[84:87], v[36:39], a[48:63]
  ds_read_b64_tr_b16 v[126:127], v3 offset:10816
  v_mfma_f32_32x32x16_bf16 a[64:79], v[88:91], v[32:35], a[64:79]
  ds_read_b64_tr_b16 v[128:129], v3 offset:9344
  v_mfma_f32_32x32x16_bf16 a[80:95], v[88:91], v[36:39], a[80:95]
  ds_read_b64_tr_b16 v[130:131], v3 offset:10880
  s_add_u32 m0, s23, 6144
  s_nop 0
  buffer_load_dwordx4 v8, s[8:11], s22 offen lds
  s_add_u32 m0, s23, 7168
  s_nop 0
  buffer_load_dwordx4 v9, s[8:11], s22 offen lds
  s_add_u32 m0, s23, 8192
  s_nop 0
  buffer_load_dwordx4 v10, s[8:11], s22 offen lds
  buffer_load_dwordx4 v[32:35], v2, s[4:7], s20 offen
  buffer_load_dwordx4 v[36:39], v2, s[4:7], s21 offen
  s_add_u32 s20, s20, 1024
  s_add_u32 s21, s21, 1024
  s_add_u32 s22, s22, 20480
  s_waitcnt vmcnt(30) lgkmcnt(0)
  v_mfma_f32_32x32x16_bf16 a[0:15], v[120:123], v[40:43], a[0:15]
  ds_read_b64_tr_b16 v[80:81], v3 offset:12288
  v_mfma_f32_32x32x16_bf16 a[16:31], v[120:123], v[44:47], a[16:31]
  ds_read_b64_tr_b16 v[82:83], v3 offset:13824
  v_mfma_f32_32x32x16_bf16 a[32:47], v[124:127], v[40:43], a[32:47]
  ds_read_b64_tr_b16 v[84:85], v3 offset:12352
  v_mfma_f32_32x32x16_bf16 a[48:63], v[124:127], v[44:47], a[48:63]
  ds_read_b64_tr_b16 v[86:87], v3 offset:13888
  v_mfma_f32_32x32x16_bf16 a[64:79], v[128:131], v[40:43], a[64:79]
  ds_read_b64_tr_b16 v[88:89], v3 offset:12416
  v_mfma_f32_32x32x16_bf16 a[80:95], v[128:131], v[44:47], a[80:95]
  ds_read_b64_tr_b16 v[90:91], v3 offset:13952
  s_add_u32 m0, s23, 9216
  s_nop 0
  buffer_load_dwordx4 v8, s[8:11], s22 offen lds
  s_add_u32 m0, s23, 10240
  s_nop 0
  buffer_load_dwordx4 v9, s[8:11], s22 offen lds
  s_add_u32 m0, s23, 11264
  s_nop 0
  buffer_load_dwordx4 v10, s[8:11], s22 offen lds
  buffer_load_dwordx4 v[40:43], v2, s[4:7], s20 offen
  buffer_load_dwordx4 v[44:47], v2, s[4:7], s21 offen
  s_add_u32 s20, s20, 1024
  s_add_u32 s21, s21, 1024
  s_add_u32 s22, s22, 20480
  s_waitcnt vmcnt(30) lgkmcnt(0)
  v_mfma_f32_32x32x16_bf16 a[0:15], v[80:83], v[48:51], a[0:15]
  ds_read_b64_tr_b16 v[120:121], v3 offset:15360
  v_mfma_f32_32x32x16_bf16 a[16:31], v[80:83], v[52:55], a[16:31]
  ds_read_b64_tr_b16 v[122:123], v3 offset:16896
  v_mfma_f32_32x32x16_bf16 a[32:47], v[84:87], v[48:51], a[32:47]
  ds_read_b64_tr_b16 v[124:125], v3 offset:15424
  v_mfma_f32_32x32x16_bf16 a[48:63], v[84:87], v[52:55], a[48:63]
  ds_read_b64_tr_b16 v[126:127], v3 offset:16960
  v_mfma_f32_32x32x16_bf16 a[64:79], v[88:91], v[48:51], a[64:79]
  ds_read_b64_tr_b16 v[128:129], v3 offset:15488
  v_mfma_f32_32x32x16_bf16 a[80:95], v[88:91], v[52:55], a[80:95]
  ds_read_b64_tr_b16 v[130:131], v3 offset:17024
  s_add_u32 m0, s23, 12288
  s_nop 0
  buffer_load_dwordx4 v8, s[8:11], s22 offen lds
  s_add_u32 m0, s23, 13312
  s_nop 0
  buffer_load_dwordx4 v9, s[8:11], s22 offen lds
  s_add_u32 m0, s23, 14336
  s_nop 0
  buffer_load_dwordx4 v10, s[8:11], s22 offen lds
  buffer_load_dwordx4 v[48:51], v2, s[4:7], s20 offen
  buffer_load_dwordx4 v[52:55], v2, s[4:7], s21 offen
  s_add_u32 s20, s20, 1024
  s_add_u32 s21, s21, 1024
  s_add_u32 s22, s22, 20480
  s_waitcnt vmcnt(30) lgkmcnt(0)
  v_mfma_f32_32x32x16_bf16 a[0:15], v[120:123], v[56:59], a[0:15]
  ds_read_b64_tr_b16 v[80:81], v3 offset:18432
  v_mfma_f32_32x32x16_bf16 a[16:31], v[120:123], v[60:63], a[16:31]
  ds_read_b64_tr_b16 v[82:83], v3 offset:19968
  v_mfma_f32_32x32x16_bf16 a[32:47], v[124:127], v[56:59], a[32:47]
  ds_read_b64_tr_b16 v[84:85], v3 offset:18496
  v_mfma_f32_32x32x16_bf16 a[48:63], v[124:127], v[60:63], a[48:63]
  ds_read_b64_tr_b16 v[86:87], v3 offset:20032
  v_mfma_f32_32x32x16_bf16 a[64:79], v[128:131], v[56:59], a[64:79]
  ds_read_b64_tr_b16 v[88:89], v3 offset:18560
  v_mfma_f32_32x32x16_bf16 a[80:95], v[128:131], v[60:63], a[80:95]
  ds_read_b64_tr_b16 v[90:91], v3 offset:20096
  s_add_u32 m0, s23, 15360
  s_nop 0
  buffer_load_dwordx4 v8, s[8:11], s22 offen lds
  s_add_u32 m0, s23, 16384
  s_nop 0
  buffer_load_dwordx4 v9, s[8:11], s22 offen lds
  s_add_u32 m0, s23, 17408
  s_nop 0
  buffer_load_dwordx4 v10, s[8:11], s22 offen lds
  buffer_load_dwordx4 v[56:59], v2, s[4:7], s20 offen
  buffer_load_dwordx4 v[60:63], v2, s[4:7], s21 offen
  s_add_u32 s20, s20, 1024
  s_add_u32 s21, s21, 1024
  s_add_u32 s22, s22, 20480
  s_waitcnt vmcnt(30) lgkmcnt(0)
  v_mfma_f32_32x32x16_bf16 a[0:15], v[80:83], v[64:67], a[0:15]
  ds_read_b64_tr_b16 v[120:121], v3 offset:21504
  v_mfma_f32_32x32x16_bf16 a[16:31], v[80:83], v[68:71], a[16:31]
  ds_read_b64_tr_b16 v[122:123], v3 offset:23040
  v_mfma_f32_32x32x16_bf16 a[32:47], v[84:87], v[64:67], a[32:47]
  ds_read_b64_tr_b16 v[124:125], v3 offset:21568
  v_mfma_f32_32x32x16_bf16 a[48:63], v[84:87], v[68:71], a[48:63]
  ds_read_b64_tr_b16 v[126:127], v3 offset:23104
  v_mfma_f32_32x32x16_bf16 a[64:79], v[88:91], v[64:67], a[64:79]
  ds_read_b64_tr_b16 v[128:129], v3 offset:21632
  v_mfma_f32_32x32x16_bf16 a[80:95], v[88:91], v[68:71], a[80:95]
  ds_read_b64_tr_b16 v[130:131], v3 offset:23168
  s_add_u32 m0, s23, 18432
  s_nop 0
  buffer_load_dwordx4 v8, s[8:11], s22 offen lds
  s_add_u32 m0, s23, 19456
  s_nop 0
  buffer_load_dwordx4 v9, s[8:11], s22 offen lds
  s_add_u32 m0, s23, 20480
  s_nop 0
  buffer_load_dwordx4 v10, s[8:11], s22 offen lds
  buffer_load_dwordx4 v[64:67], v2, s[4:7], s20 offen
  buffer_load_dwordx4 v[68:71], v2, s[4:7], s21 offen
  s_add_u32 s20, s20, 1024
  s_add_u32 s21, s21, 1024
  s_add_u32 s22, s22, 20480
  s_waitcnt vmcnt(30) lgkmcnt(0)
  v_mfma_f32_32x32x16_bf16 a[0:15], v[120:123], v[72:75], a[0:15]
  ds_read_b64_tr_b16 v[80:81], v3 offset:0
  v_mfma_f32_32x32x16_bf16 a[16:31], v[120:123], v[76:79], a[16:31]
  ds_read_b64_tr_b16 v[82:83], v3 offset:1536
  v_mfma_f32_32x32x16_bf16 a[32:47], v[124:127], v[72:75], a[32:47]
  ds_read_b64_tr_b16 v[84:85], v3 offset:64
  v_mfma_f32_32x32x16_bf16 a[48:63], v[124:127], v[76:79], a[48:63]
  ds_read_b64_tr_b16 v[86:87], v3 offset:1600
  v_mfma_f32_32x32x16_bf16 a[64:79], v[128:131], v[72:75], a[64:79]
  ds_read_b64_tr_b16 v[88:89], v3 offset:128
  v_mfma_f32_32x32x16_bf16 a[80:95], v[128:131], v[76:79], a[80:95]
  ds_read_b64_tr_b16 v[90:91], v3 offset:1664
  s_add_u32 m0, s23, 21504
  s_nop 0
  buffer_load_dwordx4 v8, s[8:11], s22 offen lds
  s_add_u32 m0, s23, 22528
  s_nop 0
  buffer_load_dwordx4 v9, s[8:11], s22 offen lds
  s_add_u32 m0, s23, 23552
  s_nop 0
  buffer_load_dwordx4 v10, s[8:11], s22 offen lds
  buffer_load_dwordx4 v[72:75], v2, s[4:7], s20 offen
  buffer_load_dwordx4 v[76:79], v2, s[4:7], s21 offen
  s_add_u32 s20, s20, 1024
  s_add_u32 s21, s21, 1024
  s_add_u32 s22, s22, 20480
  s_mov_b32 s24, 10
OP_34_loop:
  s_waitcnt vmcnt(30) lgkmcnt(0)
  v_mfma_f32_32x32x16_bf16 a[0:15], v[80:83], v[16:19], a[0:15]
  ds_read_b64_tr_b16 v[120:121], v3 offset:3072
  v_mfma_f32_32x32x16_bf16 a[16:31], v[80:83], v[20:23], a[16:31]
  ds_read_b64_tr_b16 v[122:123], v3 offset:4608
  v_mfma_f32_32x32x16_bf16 a[32:47], v[84:87], v[16:19], a[32:47]
  ds_read_b64_tr_b16 v[124:125], v3 offset:3136
  v_mfma_f32_32x32x16_bf16 a[48:63], v[84:87], v[20:23], a[48:63]
  ds_read_b64_tr_b16 v[126:127], v3 offset:4672
  v_mfma_f32_32x32x16_bf16 a[64:79], v[88:91], v[16:19], a[64:79]
  ds_read_b64_tr_b16 v[128:129], v3 offset:3200
  v_mfma_f32_32x32x16_bf16 a[80:95], v[88:91], v[20:23], a[80:95]
  ds_read_b64_tr_b16 v[130:131], v3 offset:4736
  s_add_u32 m0, s23, 0
  s_nop 0
  buffer_load_dwordx4 v8, s[8:11], s22 offen lds
  s_add_u32 m0, s23, 1024
  s_nop 0
  buffer_load_dwordx4 v9, s[8:11], s22 offen lds
  s_add_u32 m0, s23, 2048
  s_nop 0
  buffer_load_dwordx4 v10, s[8:11], s22 offen lds
  buffer_load_dwordx4 v[16:19], v2, s[4:7], s20 offen
  buffer_load_dwordx4 v[20:23], v2, s[4:7], s21 offen
  s_add_u32 s20, s20, 1024
  s_add_u32 s21, s21, 1024
  s_add_u32 s22, s22, 20480
  s_waitcnt vmcnt(30) lgkmcnt(0)
  v_mfma_f32_32x32x16_bf16 a[0:15], v[120:123], v[24:27], a[0:15]
  ds_read_b64_tr_b16 v[80:81], v3 offset:6144
  v_mfma_f32_32x32x16_bf16 a[16:31], v[120:123], v[28:31], a[16:31]
  ds_read_b64_tr_b16 v[82:83], v3 offset:7680
  v_mfma_f32_32x32x16_bf16 a[32:47], v[124:127], v[24:27], a[32:47]
  ds_read_b64_tr_b16 v[84:85], v3 offset:6208
  v_mfma_f32_32x32x16_bf16 a[48:63], v[124:127], v[28:31], a[48:63]
  ds_read_b64_tr_b16 v[86:87], v3 offset:7744
  v_mfma_f32_32x32x16_bf16 a[64:79], v[128:131], v[24:27], a[64:79]
  ds_read_b64_tr_b16 v[88:89], v3 offset:6272
  v_mfma_f32_32x32x16_bf16 a[80:95], v[128:131], v[28:31], a[80:95]
  ds_read_b64_tr_b16 v[90:91], v3 offset:7808
  s_add_u32 m0, s23, 3072
  s_nop 0
  buffer_load_dwordx4 v8, s[8:11], s22 offen lds
  s_add_u32 m0, s23, 4096
  s_nop 0
  buffer_load_dwordx4 v9, s[8:11], s22 offen lds
  s_add_u32 m0, s23, 5120
  s_nop 0
  buffer_load_dwordx4 v10, s[8:11], s22 offen lds
  buffer_load_dwordx4 v[24:27], v2, s[4:7], s20 offen
  buffer_load_dwordx4 v[28:31], v2, s[4:7], s21 offen
  s_add_u32 s20, s20, 1024
  s_add_u32 s21, s21, 1024
  s_add_u32 s22, s22, 20480
  s_waitcnt vmcnt(30) lgkmcnt(0)
  v_mfma_f32_32x32x16_bf16 a[0:15], v[80:83], v[32:35], a[0:15]
  ds_read_b64_tr_b16 v[120:121], v3 offset:9216
  v_mfma_f32_32x32x16_bf16 a[16:31], v[80:83], v[36:39], a[16:31]
  ds_read_b64_tr_b16 v[122:123], v3 offset:10752
  v_mfma_f32_32x32x16_bf16 a[32:47], v[84:87], v[32:35], a[32:47]
  ds_read_b64_tr_b16 v[124:125], v3 offset:9280
  v_mfma_f32_32x32x16_bf16 a[48:63], v[84:87], v[36:39], a[48:63]
  ds_read_b64_tr_b16 v[126:127], v3 offset:10816
  v_mfma_f32_32x32x16_bf16 a[64:79], v[88:91], v[32:35], a[64:79]
  ds_read_b64_tr_b16 v[128:129], v3 offset:9344
  v_mfma_f32_32x32x16_bf16 a[80:95], v[88:91], v[36:39], a[80:95]
  ds_read_b64_tr_b16 v[130:131], v3 offset:10880
  s_add_u32 m0, s23, 6144
  s_nop 0
  buffer_load_dwordx4 v8, s[8:11], s22 offen lds
  s_add_u32 m0, s23, 7168
  s_nop 0
  buffer_load_dwordx4 v9, s[8:11], s22 offen lds
  s_add_u32 m0, s23, 8192
  s_nop 0
  buffer_load_dwordx4 v10, s[8:11], s22 offen lds
  buffer_load_dwordx4 v[32:35], v2, s[4:7], s20 offen
  buffer_load_dwordx4 v[36:39], v2, s[4:7], s21 offen
  s_add_u32 s20, s20, 1024
  s_add_u32 s21, s21, 1024
  s_add_u32 s22, s22, 20480
  s_waitcnt vmcnt(30) lgkmcnt(0)
  v_mfma_f32_32x32x16_bf16 a[0:15], v[120:123], v[40:43], a[0:15]
  ds_read_b64_tr_b16 v[80:81], v3 offset:12288
  v_mfma_f32_32x32x16_bf16 a[16:31], v[120:123], v[44:47], a[16:31]
  ds_read_b64_tr_b16 v[82:83], v3 offset:13824
  v_mfma_f32_32x32x16_bf16 a[32:47], v[124:127], v[40:43], a[32:47]
  ds_read_b64_tr_b16 v[84:85], v3 offset:12352
  v_mfma_f32_32x32x16_bf16 a[48:63], v[124:127], v[44:47], a[48:63]
  ds_read_b64_tr_b16 v[86:87], v3 offset:13888
  v_mfma_f32_32x32x16_bf16 a[64:79], v[128:131], v[40:43], a[64:79]
  ds_read_b64_tr_b16 v[88:89], v3 offset:12416
  v_mfma_f32_32x32x16_bf16 a[80:95], v[128:131], v[44:47], a[80:95]
  ds_read_b64_tr_b16 v[90:91], v3 offset:13952
  s_add_u32 m0, s23, 9216
  s_nop 0
  buffer_load_dwordx4 v8, s[8:11], s22 offen lds
  s_add_u32 m0, s23, 10240
  s_nop 0
  buffer_load_dwordx4 v9, s[8:11], s22 offen lds
  s_add_u32 m0, s23, 11264
  s_nop 0
  buffer_load_dwordx4 v10, s[8:11], s22 offen lds
  buffer_load_dwordx4 v[40:43], v2, s[4:7], s20 offen
  buffer_load_dwordx4 v[44:47], v2, s[4:7], s21 offen
  s_add_u32 s20, s20, 1024
  s_add_u32 s21, s21, 1024
  s_add_u32 s22, s22, 20480
  s_waitcnt vmcnt(30) lgkmcnt(0)
  v_mfma_f32_32x32x16_bf16 a[0:15], v[80:83], v[48:51], a[0:15]
  ds_read_b64_tr_b16 v[120:121], v3 offset:15360
  v_mfma_f32_32x32x16_bf16 a[16:31], v[80:83], v[52:55], a[16:31]
  ds_read_b64_tr_b16 v[122:123], v3 offset:16896
  v_mfma_f32_32x32x16_bf16 a[32:47], v[84:87], v[48:51], a[32:47]
  ds_read_b64_tr_b16 v[124:125], v3 offset:15424
  v_mfma_f32_32x32x16_bf16 a[48:63], v[84:87], v[52:55], a[48:63]
  ds_read_b64_tr_b16 v[126:127], v3 offset:16960
  v_mfma_f32_32x32x16_bf16 a[64:79], v[88:91], v[48:51], a[64:79]
  ds_read_b64_tr_b16 v[128:129], v3 offset:15488
  v_mfma_f32_32x32x16_bf16 a[80:95], v[88:91], v[52:55], a[80:95]
  ds_read_b64_tr_b16 v[130:131], v3 offset:17024
  s_add_u32 m0, s23, 12288
  s_nop 0
  buffer_load_dwordx4 v8, s[8:11], s22 offen lds
  s_add_u32 m0, s23, 13312
  s_nop 0
  buffer_load_dwordx4 v9, s[8:11], s22 offen lds
  s_add_u32 m0, s23, 14336
  s_nop 0
  buffer_load_dwordx4 v10, s[8:11], s22 offen lds
  buffer_load_dwordx4 v[48:51], v2, s[4:7], s20 offen
  buffer_load_dwordx4 v[52:55], v2, s[4:7], s21 offen
  s_add_u32 s20, s20, 1024
  s_add_u32 s21, s21, 1024
  s_add_u32 s22, s22, 20480
  s_waitcnt vmcnt(30) lgkmcnt(0)
  v_mfma_f32_32x32x16_bf16 a[0:15], v[120:123], v[56:59], a[0:15]
  ds_read_b64_tr_b16 v[80:81], v3 offset:18432
  v_mfma_f32_32x32x16_bf16 a[16:31], v[120:123], v[60:63], a[16:31]
  ds_read_b64_tr_b16 v[82:83], v3 offset:19968
  v_mfma_f32_32x32x16_bf16 a[32:47], v[124:127], v[56:59], a[32:47]
  ds_read_b64_tr_b16 v[84:85], v3 offset:18496
  v_mfma_f32_32x32x16_bf16 a[48:63], v[124:127], v[60:63], a[48:63]
  ds_read_b64_tr_b16 v[86:87], v3 offset:20032
  v_mfma_f32_32x32x16_bf16 a[64:79], v[128:131], v[56:59], a[64:79]
  ds_read_b64_tr_b16 v[88:89], v3 offset:18560
  v_mfma_f32_32x32x16_bf16 a[80:95], v[128:131], v[60:63], a[80:95]
  ds_read_b64_tr_b16 v[90:91], v3 offset:20096
  s_add_u32 m0, s23, 15360
  s_nop 0
  buffer_load_dwordx4 v8, s[8:11], s22 offen lds
  s_add_u32 m0, s23, 16384
  s_nop 0
  buffer_load_dwordx4 v9, s[8:11], s22 offen lds
  s_add_u32 m0, s23, 17408
  s_nop 0
  buffer_load_dwordx4 v10, s[8:11], s22 offen lds
  buffer_load_dwordx4 v[56:59], v2, s[4:7], s20 offen
  buffer_load_dwordx4 v[60:63], v2, s[4:7], s21 offen
  s_add_u32 s20, s20, 1024
  s_add_u32 s21, s21, 1024
  s_add_u32 s22, s22, 20480
  s_waitcnt vmcnt(30) lgkmcnt(0)
  v_mfma_f32_32x32x16_bf16 a[0:15], v[80:83], v[64:67], a[0:15]
  ds_read_b64_tr_b16 v[120:121], v3 offset:21504
  v_mfma_f32_32x32x16_bf16 a[16:31], v[80:83], v[68:71], a[16:31]
  ds_read_b64_tr_b16 v[122:123], v3 offset:23040
  v_mfma_f32_32x32x16_bf16 a[32:47], v[84:87], v[64:67], a[32:47]
  ds_read_b64_tr_b16 v[124:125], v3 offset:21568
  v_mfma_f32_32x32x16_bf16 a[48:63], v[84:87], v[68:71], a[48:63]
  ds_read_b64_tr_b16 v[126:127], v3 offset:23104
  v_mfma_f32_32x32x16_bf16 a[64:79], v[88:91], v[64:67], a[64:79]
  ds_read_b64_tr_b16 v[128:129], v3 offset:21632
  v_mfma_f32_32x32x16_bf16 a[80:95], v[88:91], v[68:71], a[80:95]
  ds_read_b64_tr_b16 v[130:131], v3 offset:23168
  s_add_u32 m0, s23, 18432
  s_nop 0
  buffer_load_dwordx4 v8, s[8:11], s22 offen lds
  s_add_u32 m0, s23, 19456
  s_nop 0
  buffer_load_dwordx4 v9, s[8:11], s22 offen lds
  s_add_u32 m0, s23, 20480
  s_nop 0
  buffer_load_dwordx4 v10, s[8:11], s22 offen lds
  buffer_load_dwordx4 v[64:67], v2, s[4:7], s20 offen
  buffer_load_dwordx4 v[68:71], v2, s[4:7], s21 offen
  s_add_u32 s20, s20, 1024
  s_add_u32 s21, s21, 1024
  s_add_u32 s22, s22, 20480
  s_waitcnt vmcnt(30) lgkmcnt(0)
  v_mfma_f32_32x32x16_bf16 a[0:15], v[120:123], v[72:75], a[0:15]
  ds_read_b64_tr_b16 v[80:81], v3 offset:0
  v_mfma_f32_32x32x16_bf16 a[16:31], v[120:123], v[76:79], a[16:31]
  ds_read_b64_tr_b16 v[82:83], v3 offset:1536
  v_mfma_f32_32x32x16_bf16 a[32:47], v[124:127], v[72:75], a[32:47]
  ds_read_b64_tr_b16 v[84:85], v3 offset:64
  v_mfma_f32_32x32x16_bf16 a[48:63], v[124:127], v[76:79], a[48:63]
  ds_read_b64_tr_b16 v[86:87], v3 offset:1600
  v_mfma_f32_32x32x16_bf16 a[64:79], v[128:131], v[72:75], a[64:79]
  ds_read_b64_tr_b16 v[88:89], v3 offset:128
  v_mfma_f32_32x32x16_bf16 a[80:95], v[128:131], v[76:79], a[80:95]
  ds_read_b64_tr_b16 v[90:91], v3 offset:1664
  s_add_u32 m0, s23, 21504
  s_nop 0
  buffer_load_dwordx4 v8, s[8:11], s22 offen lds
  s_add_u32 m0, s23, 22528
  s_nop 0
  buffer_load_dwordx4 v9, s[8:11], s22 offen lds
  s_add_u32 m0, s23, 23552
  s_nop 0
  buffer_load_dwordx4 v10, s[8:11], s22 offen lds
  buffer_load_dwordx4 v[72:75], v2, s[4:7], s20 offen
  buffer_load_dwordx4 v[76:79], v2, s[4:7], s21 offen
  s_add_u32 s20, s20, 1024
  s_add_u32 s21, s21, 1024
  s_add_u32 s22, s22, 20480
  s_sub_u32 s24, s24, 1
  s_cmp_lg_u32 s24, 0
  s_cbranch_scc1 OP_34_loop
  s_cmp_eq_u32 s80, 0
  s_cbranch_scc0 TI_35
  v_mov_b32 v255, 1
  s_mov_b64 exec, 1
  buffer_atomic_add v255, off, s[84:87], s97 sc0 sc1
  s_mov_b64 exec, -1
TI_35:
  s_waitcnt vmcnt(30) lgkmcnt(0)
  v_mfma_f32_32x32x16_bf16 a[0:15], v[80:83], v[16:19], a[0:15]
  ds_read_b64_tr_b16 v[120:121], v3 offset:3072
  v_mfma_f32_32x32x16_bf16 a[16:31], v[80:83], v[20:23], a[16:31]
  ds_read_b64_tr_b16 v[122:123], v3 offset:4608
  v_mfma_f32_32x32x16_bf16 a[32:47], v[84:87], v[16:19], a[32:47]
  ds_read_b64_tr_b16 v[124:125], v3 offset:3136
  v_mfma_f32_32x32x16_bf16 a[48:63], v[84:87], v[20:23], a[48:63]
  ds_read_b64_tr_b16 v[126:127], v3 offset:4672
  v_mfma_f32_32x32x16_bf16 a[64:79], v[88:91], v[16:19], a[64:79]
  ds_read_b64_tr_b16 v[128:129], v3 offset:3200
  v_mfma_f32_32x32x16_bf16 a[80:95], v[88:91], v[20:23], a[80:95]
  ds_read_b64_tr_b16 v[130:131], v3 offset:4736
  s_waitcnt vmcnt(25) lgkmcnt(0)
  v_mfma_f32_32x32x16_bf16 a[0:15], v[120:123], v[24:27], a[0:15]
  ds_read_b64_tr_b16 v[80:81], v3 offset:6144
  v_mfma_f32_32x32x16_bf16 a[16:31], v[120:123], v[28:31], a[16:31]
  ds_read_b64_tr_b16 v[82:83], v3 offset:7680
  v_mfma_f32_32x32x16_bf16 a[32:47], v[124:127], v[24:27], a[32:47]
  ds_read_b64_tr_b16 v[84:85], v3 offset:6208
  v_mfma_f32_32x32x16_bf16 a[48:63], v[124:127], v[28:31], a[48:63]
  ds_read_b64_tr_b16 v[86:87], v3 offset:7744
  v_mfma_f32_32x32x16_bf16 a[64:79], v[128:131], v[24:27], a[64:79]
  ds_read_b64_tr_b16 v[88:89], v3 offset:6272
  v_mfma_f32_32x32x16_bf16 a[80:95], v[128:131], v[28:31], a[80:95]
  ds_read_b64_tr_b16 v[90:91], v3 offset:7808
  s_waitcnt vmcnt(20) lgkmcnt(0)
  v_mfma_f32_32x32x16_bf16 a[0:15], v[80:83], v[32:35], a[0:15]
  ds_read_b64_tr_b16 v[120:121], v3 offset:9216
  v_mfma_f32_32x32x16_bf16 a[16:31], v[80:83], v[36:39], a[16:31]
  ds_read_b64_tr_b16 v[122:123], v3 offset:10752
  v_mfma_f32_32x32x16_bf16 a[32:47], v[84:87], v[32:35], a[32:47]
  ds_read_b64_tr_b16 v[124:125], v3 offset:9280
  v_mfma_f32_32x32x16_bf16 a[48:63], v[84:87], v[36:39], a[48:63]
  ds_read_b64_tr_b16 v[126:127], v3 offset:10816
  v_mfma_f32_32x32x16_bf16 a[64:79], v[88:91], v[32:35], a[64:79]
  ds_read_b64_tr_b16 v[128:129], v3 offset:9344
  v_mfma_f32_32x32x16_bf16 a[80:95], v[88:91], v[36:39], a[80:95]
  ds_read_b64_tr_b16 v[130:131], v3 offset:10880
  s_waitcnt vmcnt(15) lgkmcnt(0)
  v_mfma_f32_32x32x16_bf16 a[0:15], v[120:123], v[40:43], a[0:15]
  ds_read_b64_tr_b16 v[80:81], v3 offset:12288
  v_mfma_f32_32x32x16_bf16 a[16:31], v[120:123], v[44:47], a[16:31]
  ds_read_b64_tr_b16 v[82:83], v3 offset:13824
  v_mfma_f32_32x32x16_bf16 a[32:47], v[124:127], v[40:43], a[32:47]
  ds_read_b64_tr_b16 v[84:85], v3 offset:12352
  v_mfma_f32_32x32x16_bf16 a[48:63], v[124:127], v[44:47], a[48:63]
  ds_read_b64_tr_b16 v[86:87], v3 offset:13888
  v_mfma_f32_32x32x16_bf16 a[64:79], v[128:131], v[40:43], a[64:79]
  ds_read_b64_tr_b16 v[88:89], v3 offset:12416
  v_mfma_f32_32x32x16_bf16 a[80:95], v[128:131], v[44:47], a[80:95]
  ds_read_b64_tr_b16 v[90:91], v3 offset:13952
  s_waitcnt vmcnt(10) lgkmcnt(0)
  v_mfma_f32_32x32x16_bf16 a[0:15], v[80:83], v[48:51], a[0:15]
  ds_read_b64_tr_b16 v[120:121], v3 offset:15360
  v_mfma_f32_32x32x16_bf16 a[16:31], v[80:83], v[52:55], a[16:31]
  ds_read_b64_tr_b16 v[122:123], v3 offset:16896
  v_mfma_f32_32x32x16_bf16 a[32:47], v[84:87], v[48:51], a[32:47]
  ds_read_b64_tr_b16 v[124:125], v3 offset:15424
  v_mfma_f32_32x32x16_bf16 a[48:63], v[84:87], v[52:55], a[48:63]
  ds_read_b64_tr_b16 v[126:127], v3 offset:16960
  v_mfma_f32_32x32x16_bf16 a[64:79], v[88:91], v[48:51], a[64:79]
  ds_read_b64_tr_b16 v[128:129], v3 offset:15488
  v_mfma_f32_32x32x16_bf16 a[80:95], v[88:91], v[52:55], a[80:95]
  ds_read_b64_tr_b16 v[130:131], v3 offset:17024
  s_waitcnt vmcnt(5) lgkmcnt(0)
  v_mfma_f32_32x32x16_bf16 a[0:15], v[120:123], v[56:59], a[0:15]
  ds_read_b64_tr_b16 v[80:81], v3 offset:18432
  v_mfma_f32_32x32x16_bf16 a[16:31], v[120:123], v[60:63], a[16:31]
  ds_read_b64_tr_b16 v[82:83], v3 offset:19968
  v_mfma_f32_32x32x16_bf16 a[32:47], v[124:127], v[56:59], a[32:47]
  ds_read_b64_tr_b16 v[84:85], v3 offset:18496
  v_mfma_f32_32x32x16_bf16 a[48:63], v[124:127], v[60:63], a[48:63]
  ds_read_b64_tr_b16 v[86:87], v3 offset:20032
  v_mfma_f32_32x32x16_bf16 a[64:79], v[128:131], v[56:59], a[64:79]
  ds_read_b64_tr_b16 v[88:89], v3 offset:18560
  v_mfma_f32_32x32x16_bf16 a[80:95], v[128:131], v[60:63], a[80:95]
  ds_read_b64_tr_b16 v[90:91], v3 offset:20096
  s_waitcnt vmcnt(0) lgkmcnt(0)
  v_mfma_f32_32x32x16_bf16 a[0:15], v[80:83], v[64:67], a[0:15]
  ds_read_b64_tr_b16 v[120:121], v3 offset:21504
  v_mfma_f32_32x32x16_bf16 a[16:31], v[80:83], v[68:71], a[16:31]
  ds_read_b64_tr_b16 v[122:123], v3 offset:23040
  v_mfma_f32_32x32x16_bf16 a[32:47], v[84:87], v[64:67], a[32:47]
  ds_read_b64_tr_b16 v[124:125], v3 offset:21568
  v_mfma_f32_32x32x16_bf16 a[48:63], v[84:87], v[68:71], a[48:63]
  ds_read_b64_tr_b16 v[126:127], v3 offset:23104
  v_mfma_f32_32x32x16_bf16 a[64:79], v[88:91], v[64:67], a[64:79]
  ds_read_b64_tr_b16 v[128:129], v3 offset:21632
  v_mfma_f32_32x32x16_bf16 a[80:95], v[88:91], v[68:71], a[80:95]
  ds_read_b64_tr_b16 v[130:131], v3 offset:23168
  s_waitcnt lgkmcnt(0)
  v_mfma_f32_32x32x16_bf16 a[0:15], v[120:123], v[72:75], a[0:15]
  v_mfma_f32_32x32x16_bf16 a[16:31], v[120:123], v[76:79], a[16:31]
  v_mfma_f32_32x32x16_bf16 a[32:47], v[124:127], v[72:75], a[32:47]
  v_mfma_f32_32x32x16_bf16 a[48:63], v[124:127], v[76:79], a[48:63]
  v_mfma_f32_32x32x16_bf16 a[64:79], v[128:131], v[72:75], a[64:79]
  v_mfma_f32_32x32x16_bf16 a[80:95], v[128:131], v[76:79], a[80:95]
  s_waitcnt vmcnt(0)
  v_readfirstlane_b32 s96, v255
  s_nop 7
  s_nop 7
  v_add_u32 v5, s23, v2
  s_cmp_eq_u32 s80, 0
  s_cbranch_scc0 OP_34_w0
  ds_write_b128 v5, a[16:19] offset:0
  ds_write_b128 v5, a[20:23] offset:1024
  ds_write_b128 v5, a[24:27] offset:2048
  ds_write_b128 v5, a[28:31] offset:3072
  ds_write_b128 v5, a[32:35] offset:4096
  ds_write_b128 v5, a[36:39] offset:5120
  ds_write_b128 v5, a[40:43] offset:6144
  ds_write_b128 v5, a[44:47] offset:7168
  ds_write_b128 v5, a[48:51] offset:8192
  ds_write_b128 v5, a[52:55] offset:9216
  ds_write_b128 v5, a[56:59] offset:10240
  ds_write_b128 v5, a[60:63] offset:11264
  ds_write_b128 v5, a[80:83] offset:12288
  ds_write_b128 v5, a[84:87] offset:13312
  ds_write_b128 v5, a[88:91] offset:14336
  ds_write_b128 v5, a[92:95] offset:15360
OP_34_w0:
  s_cmp_eq_u32 s80, 1
  s_cbranch_scc0 OP_34_w1
  ds_write_b128 v5, a[0:3] offset:0
  ds_write_b128 v5, a[4:7] offset:1024
  ds_write_b128 v5, a[8:11] offset:2048
  ds_write_b128 v5, a[12:15] offset:3072
  ds_write_b128 v5, a[32:35] offset:4096
  ds_write_b128 v5, a[36:39] offset:5120
  ds_write_b128 v5, a[40:43] offset:6144
  ds_write_b128 v5, a[44:47] offset:7168
  ds_write_b128 v5, a[48:51] offset:8192
  ds_write_b128 v5, a[52:55] offset:9216
  ds_write_b128 v5, a[56:59] offset:10240
  ds_write_b128 v5, a[60:63] offset:11264
  ds_write_b128 v5, a[64:67] offset:12288
  ds_write_b128 v5, a[68:71] offset:13312
  ds_write_b128 v5, a[72:75] offset:14336
  ds_write_b128 v5, a[76:79] offset:15360
OP_34_w1:
  s_cmp_eq_u32 s80, 2
  s_cbranch_scc0 OP_34_w2
  ds_write_b128 v5, a[0:3] offset:0
  ds_write_b128 v5, a[4:7] offset:1024
  ds_write_b128 v5, a[8:11] offset:2048
  ds_write_b128 v5, a[12:15] offset:3072
  ds_write_b128 v5, a[16:19] offset:4096
  ds_write_b128 v5, a[20:23] offset:5120
  ds_write_b128 v5, a[24:27] offset:6144
  ds_write_b128 v5, a[28:31] offset:7168
  ds_write_b128 v5, a[48:51] offset:8192
  ds_write_b128 v5, a[52:55] offset:9216
  ds_write_b128 v5, a[56:59] offset:10240
  ds_write_b128 v5, a[60:63] offset:11264
  ds_write_b128 v5, a[64:67] offset:12288
  ds_write_b128 v5, a[68:71] offset:13312
  ds_write_b128 v5, a[72:75] offset:14336
  ds_write_b128 v5, a[76:79] offset:15360
  ds_write_b128 v5, a[80:83] offset:16384
  ds_write_b128 v5, a[84:87] offset:17408
  ds_write_b128 v5, a[88:91] offset:18432
  ds_write_b128 v5, a[92:95] offset:19456
OP_34_w2:
  s_cmp_eq_u32 s80, 3
  s_cbranch_scc0 OP_34_w3
  ds_write_b128 v5, a[0:3] offset:0
  ds_write_b128 v5, a[4:7] offset:1024
  ds_write_b128 v5, a[8:11] offset:2048
  ds_write_b128 v5, a[12:15] offset:3072
  ds_write_b128 v5, a[16:19] offset:4096
  ds_write_b128 v5, a[20:23] offset:5120
  ds_write_b128 v5, a[24:27] offset:6144
  ds_write_b128 v5, a[28:31] offset:7168
  ds_write_b128 v5, a[32:35] offset:8192
  ds_write_b128 v5, a[36:39] offset:9216
  ds_write_b128 v5, a[40:43] offset:10240
  ds_write_b128 v5, a[44:47] offset:11264
  ds_write_b128 v5, a[64:67] offset:12288
  ds_write_b128 v5, a[68:71] offset:13312
  ds_write_b128 v5, a[72:75] offset:14336
  ds_write_b128 v5, a[76:79] offset:15360
  ds_write_b128 v5, a[80:83] offset:16384
  ds_write_b128 v5, a[84:87] offset:17408
  ds_write_b128 v5, a[88:91] offset:18432
  ds_write_b128 v5, a[92:95] offset:19456
OP_34_w3:
  s_waitcnt lgkmcnt(0)
  s_barrier
  s_mul_i32 s25, s37, 163840
  s_lshl_b32 s34, s39, 1
  s_add_u32 s25, s25, s34
  s_cmp_eq_u32 s80, 0
  s_cbranch_scc0 OP_34_r0
  v_add_u32 v6, 32768, v2
  ds_read_b128 v[160:163], v6 offset:0
  ds_read_b128 v[164:167], v6 offset:1024
  ds_read_b128 v[168:171], v6 offset:2048
  ds_read_b128 v[172:175], v6 offset:3072
  v_add_u32 v6, 65536, v2
  ds_read_b128 v[176:179], v6 offset:0
  ds_read_b128 v[180:183], v6 offset:1024
  ds_read_b128 v[184:187], v6 offset:2048
  ds_read_b128 v[188:191], v6 offset:3072
  v_add_u32 v6, 98304, v2
  ds_read_b128 v[192:195], v6 offset:0
  ds_read_b128 v[196:199], v6 offset:1024
  ds_read_b128 v[200:203], v6 offset:2048
  ds_read_b128 v[204:207], v6 offset:3072
  v_accvgpr_read_b32 v208, a0
  v_accvgpr_read_b32 v209, a1
  v_accvgpr_read_b32 v210, a2
  v_accvgpr_read_b32 v211, a3
  v_accvgpr_read_b32 v212, a4
  v_accvgpr_read_b32 v213, a5
  v_accvgpr_read_b32 v214, a6
  v_accvgpr_read_b32 v215, a7
  v_accvgpr_read_b32 v216, a8
  v_accvgpr_read_b32 v217, a9
  v_accvgpr_read_b32 v218, a10
  v_accvgpr_read_b32 v219, a11
  v_accvgpr_read_b32 v220, a12
  v_accvgpr_read_b32 v221, a13
  v_accvgpr_read_b32 v222, a14
  v_accvgpr_read_b32 v223, a15
  s_waitcnt lgkmcnt(0)
  v_pk_add_f32 v[160:161], v[160:161], v[176:177]
  v_pk_add_f32 v[192:193], v[192:193], v[208:209]
  v_pk_add_f32 v[162:163], v[162:163], v[178:179]
  v_pk_add_f32 v[194:195], v[194:195], v[210:211]
  v_pk_add_f32 v[164:165], v[164:165], v[180:181]
  v_pk_add_f32 v[196:197], v[196:197], v[212:213]
  v_pk_add_f32 v[166:167], v[166:167], v[182:183]
  v_pk_add_f32 v[198:199], v[198:199], v[214:215]
  v_pk_add_f32 v[168:169], v[168:169], v[184:185]
  v_pk_add_f32 v[200:201], v[200:201], v[216:217]
  v_pk_add_f32 v[170:171], v[170:171], v[186:187]
  v_pk_add_f32 v[202:203], v[202:203], v[218:219]
  v_pk_add_f32 v[172:173], v[172:173], v[188:189]
  v_pk_add_f32 v[204:205], v[204:205], v[220:221]
  v_pk_add_f32 v[174:175], v[174:175], v[190:191]
  v_pk_add_f32 v[206:207], v[206:207], v[222:223]
  v_pk_add_f32 v[160:161], v[160:161], v[192:193]
  v_pk_add_f32 v[162:163], v[162:163], v[194:195]
  v_pk_add_f32 v[164:165], v[164:165], v[196:197]
  v_pk_add_f32 v[166:167], v[166:167], v[198:199]
  v_pk_add_f32 v[168:169], v[168:169], v[200:201]
  v_pk_add_f32 v[170:171], v[170:171], v[202:203]
  v_pk_add_f32 v[172:173], v[172:173], v[204:205]
  v_pk_add_f32 v[174:175], v[174:175], v[206:207]
  v_cvt_pk_bf16_f32 v224, v160, v161
  v_cvt_pk_bf16_f32 v225, v162, v163
  v_cvt_pk_bf16_f32 v226, v164, v165
  v_cvt_pk_bf16_f32 v227, v166, v167
  v_cvt_pk_bf16_f32 v228, v168, v169
  v_cvt_pk_bf16_f32 v229, v170, v171
  v_cvt_pk_bf16_f32 v230, v172, v173
  v_cvt_pk_bf16_f32 v231, v174, v175
  s_add_u32 s34, s25, 0
  s_nop 0
  v_permlane32_swap_b32 v224, v226
  v_permlane32_swap_b32 v225, v227
  v_permlane32_swap_b32 v228, v230
  v_permlane32_swap_b32 v229, v231
  buffer_store_dwordx4 v[224:227], v4, s[16:19], s34 offen offset:0
  buffer_store_dwordx4 v[228:231], v4, s[16:19], s34 offen offset:32
  v_add_u32 v6, 45056, v2
  ds_read_b128 v[160:163], v6 offset:0
  ds_read_b128 v[164:167], v6 offset:1024
  ds_read_b128 v[168:171], v6 offset:2048
  ds_read_b128 v[172:175], v6 offset:3072
  v_add_u32 v6, 77824, v2
  ds_read_b128 v[176:179], v6 offset:0
  ds_read_b128 v[180:183], v6 offset:1024
  ds_read_b128 v[184:187], v6 offset:2048
  ds_read_b128 v[188:191], v6 offset:3072
  v_add_u32 v6, 110592, v2
  ds_read_b128 v[192:195], v6 offset:0
  ds_read_b128 v[196:199], v6 offset:1024
  ds_read_b128 v[200:203], v6 offset:2048
  ds_read_b128 v[204:207], v6 offset:3072
  v_accvgpr_read_b32 v208, a64
  v_accvgpr_read_b32 v209, a65
  v_accvgpr_read_b32 v210, a66
  v_accvgpr_read_b32 v211, a67
  v_accvgpr_read_b32 v212, a68
  v_accvgpr_read_b32 v213, a69
  v_accvgpr_read_b32 v214, a70
  v_accvgpr_read_b32 v215, a71
  v_accvgpr_read_b32 v216, a72
  v_accvgpr_read_b32 v217, a73
  v_accvgpr_read_b32 v218, a74
  v_accvgpr_read_b32 v219, a75
  v_accvgpr_read_b32 v220, a76
  v_accvgpr_read_b32 v221, a77
  v_accvgpr_read_b32 v222, a78
  v_accvgpr_read_b32 v223, a79
  s_waitcnt lgkmcnt(0)
  v_pk_add_f32 v[160:161], v[160:161], v[176:177]
  v_pk_add_f32 v[192:193], v[192:193], v[208:209]
  v_pk_add_f32 v[162:163], v[162:163], v[178:179]
  v_pk_add_f32 v[194:195], v[194:195], v[210:211]
  v_pk_add_f32 v[164:165], v[164:165], v[180:181]
  v_pk_add_f32 v[196:197], v[196:197], v[212:213]
  v_pk_add_f32 v[166:167], v[166:167], v[182:183]
  v_pk_add_f32 v[198:199], v[198:199], v[214:215]
  v_pk_add_f32 v[168:169], v[168:169], v[184:185]
  v_pk_add_f32 v[200:201], v[200:201], v[216:217]
  v_pk_add_f32 v[170:171], v[170:171], v[186:187]
  v_pk_add_f32 v[202:203], v[202:203], v[218:219]
  v_pk_add_f32 v[172:173], v[172:173], v[188:189]
  v_pk_add_f32 v[204:205], v[204:205], v[220:221]
  v_pk_add_f32 v[174:175], v[174:175], v[190:191]
  v_pk_add_f32 v[206:207], v[206:207], v[222:223]
  v_pk_add_f32 v[160:161], v[160:161], v[192:193]
  v_pk_add_f32 v[162:163], v[162:163], v[194:195]
  v_pk_add_f32 v[164:165], v[164:165], v[196:197]
  v_pk_add_f32 v[166:167], v[166:167], v[198:199]
  v_pk_add_f32 v[168:169], v[168:169], v[200:201]
  v_pk_add_f32 v[170:171], v[170:171], v[202:203]
  v_pk_add_f32 v[172:173], v[172:173], v[204:205]
  v_pk_add_f32 v[174:175], v[174:175], v[206:207]
  v_cvt_pk_bf16_f32 v224, v160, v161
  v_cvt_pk_bf16_f32 v225, v162, v163
  v_cvt_pk_bf16_f32 v226, v164, v165
  v_cvt_pk_bf16_f32 v227, v166, v167
  v_cvt_pk_bf16_f32 v228, v168, v169
  v_cvt_pk_bf16_f32 v229, v170, v171
  v_cvt_pk_bf16_f32 v230, v172, v173
  v_cvt_pk_bf16_f32 v231, v174, v175
  s_add_u32 s34, s25, 128
  s_nop 0
  v_permlane32_swap_b32 v224, v226
  v_permlane32_swap_b32 v225, v227
  v_permlane32_swap_b32 v228, v230
  v_permlane32_swap_b32 v229, v231
  buffer_store_dwordx4 v[224:227], v4, s[16:19], s34 offen offset:0
  buffer_store_dwordx4 v[228:231], v4, s[16:19], s34 offen offset:32
OP_34_r0:
  s_cmp_eq_u32 s80, 1
  s_cbranch_scc0 OP_34_r1
  v_add_u32 v6, 0, v2
  ds_read_b128 v[160:163], v6 offset:0
  ds_read_b128 v[164:167], v6 offset:1024
  ds_read_b128 v[168:171], v6 offset:2048
  ds_read_b128 v[172:175], v6 offset:3072
  v_add_u32 v6, 69632, v2
  ds_read_b128 v[176:179], v6 offset:0
  ds_read_b128 v[180:183], v6 offset:1024
  ds_read_b128 v[184:187], v6 offset:2048
  ds_read_b128 v[188:191], v6 offset:3072
  v_add_u32 v6, 102400, v2
  ds_read_b128 v[192:195], v6 offset:0
  ds_read_b128 v[196:199], v6 offset:1024
  ds_read_b128 v[200:203], v6 offset:2048
  ds_read_b128 v[204:207], v6 offset:3072
  v_accvgpr_read_b32 v208, a16
  v_accvgpr_read_b32 v209, a17
  v_accvgpr_read_b32 v210, a18
  v_accvgpr_read_b32 v211, a19
  v_accvgpr_read_b32 v212, a20
  v_accvgpr_read_b32 v213, a21
  v_accvgpr_read_b32 v214, a22
  v_accvgpr_read_b32 v215, a23
  v_accvgpr_read_b32 v216, a24
  v_accvgpr_read_b32 v217, a25
  v_accvgpr_read_b32 v218, a26
  v_accvgpr_read_b32 v219, a27
  v_accvgpr_read_b32 v220, a28
  v_accvgpr_read_b32 v221, a29
  v_accvgpr_read_b32 v222, a30
  v_accvgpr_read_b32 v223, a31
  s_waitcnt lgkmcnt(0)
  v_pk_add_f32 v[160:161], v[160:161], v[176:177]
  v_pk_add_f32 v[192:193], v[192:193], v[208:209]
  v_pk_add_f32 v[162:163], v[162:163], v[178:179]
  v_pk_add_f32 v[194:195], v[194:195], v[210:211]
  v_pk_add_f32 v[164:165], v[164:165], v[180:181]
  v_pk_add_f32 v[196:197], v[196:197], v[212:213]
  v_pk_add_f32 v[166:167], v[166:167], v[182:183]
  v_pk_add_f32 v[198:199], v[198:199], v[214:215]
  v_pk_add_f32 v[168:169], v[168:169], v[184:185]
  v_pk_add_f32 v[200:201], v[200:201], v[216:217]
  v_pk_add_f32 v[170:171], v[170:171], v[186:187]
  v_pk_add_f32 v[202:203], v[202:203], v[218:219]
  v_pk_add_f32 v[172:173], v[172:173], v[188:189]
  v_pk_add_f32 v[204:205], v[204:205], v[220:221]
  v_pk_add_f32 v[174:175], v[174:175], v[190:191]
  v_pk_add_f32 v[206:207], v[206:207], v[222:223]
  v_pk_add_f32 v[160:161], v[160:161], v[192:193]
  v_pk_add_f32 v[162:163], v[162:163], v[194:195]
  v_pk_add_f32 v[164:165], v[164:165], v[196:197]
  v_pk_add_f32 v[166:167], v[166:167], v[198:199]
  v_pk_add_f32 v[168:169], v[168:169], v[200:201]
  v_pk_add_f32 v[170:171], v[170:171], v[202:203]
  v_pk_add_f32 v[172:173], v[172:173], v[204:205]
  v_pk_add_f32 v[174:175], v[174:175], v[206:207]
  v_cvt_pk_bf16_f32 v224, v160, v161
  v_cvt_pk_bf16_f32 v225, v162, v163
  v_cvt_pk_bf16_f32 v226, v164, v165
  v_cvt_pk_bf16_f32 v227, v166, v167
  v_cvt_pk_bf16_f32 v228, v168, v169
  v_cvt_pk_bf16_f32 v229, v170, v171
  v_cvt_pk_bf16_f32 v230, v172, v173
  v_cvt_pk_bf16_f32 v231, v174, v175
  s_add_u32 s34, s25, 81920
  s_nop 0
  v_permlane32_swap_b32 v224, v226
  v_permlane32_swap_b32 v225, v227
  v_permlane32_swap_b32 v228, v230
  v_permlane32_swap_b32 v229, v231
  buffer_store_dwordx4 v[224:227], v4, s[16:19], s34 offen offset:0
  buffer_store_dwordx4 v[228:231], v4, s[16:19], s34 offen offset:32
  v_add_u32 v6, 12288, v2
  ds_read_b128 v[160:163], v6 offset:0
  ds_read_b128 v[164:167], v6 offset:1024
  ds_read_b128 v[168:171], v6 offset:2048
  ds_read_b128 v[172:175], v6 offset:3072
  v_add_u32 v6, 81920, v2
  ds_read_b128 v[176:179], v6 offset:0
  ds_read_b128 v[180:183], v6 offset:1024
  ds_read_b128 v[184:187], v6 offset:2048
  ds_read_b128 v[188:191], v6 offset:3072
  v_add_u32 v6, 114688, v2
  ds_read_b128 v[192:195], v6 offset:0
  ds_read_b128 v[196:199], v6 offset:1024
  ds_read_b128 v[200:203], v6 offset:2048
  ds_read_b128 v[204:207], v6 offset:3072
  v_accvgpr_read_b32 v208, a80
  v_accvgpr_read_b32 v209, a81
  v_accvgpr_read_b32 v210, a82
  v_accvgpr_read_b32 v211, a83
  v_accvgpr_read_b32 v212, a84
  v_accvgpr_read_b32 v213, a85
  v_accvgpr_read_b32 v214, a86
  v_accvgpr_read_b32 v215, a87
  v_accvgpr_read_b32 v216, a88
  v_accvgpr_read_b32 v217, a89
  v_accvgpr_read_b32 v218, a90
  v_accvgpr_read_b32 v219, a91
  v_accvgpr_read_b32 v220, a92
  v_accvgpr_read_b32 v221, a93
  v_accvgpr_read_b32 v222, a94
  v_accvgpr_read_b32 v223, a95
  s_waitcnt lgkmcnt(0)
  v_pk_add_f32 v[160:161], v[160:161], v[176:177]
  v_pk_add_f32 v[192:193], v[192:193], v[208:209]
  v_pk_add_f32 v[162:163], v[162:163], v[178:179]
  v_pk_add_f32 v[194:195], v[194:195], v[210:211]
  v_pk_add_f32 v[164:165], v[164:165], v[180:181]
  v_pk_add_f32 v[196:197], v[196:197], v[212:213]
  v_pk_add_f32 v[166:167], v[166:167], v[182:183]
  v_pk_add_f32 v[198:199], v[198:199], v[214:215]
  v_pk_add_f32 v[168:169], v[168:169], v[184:185]
  v_pk_add_f32 v[200:201], v[200:201], v[216:217]
  v_pk_add_f32 v[170:171], v[170:171], v[186:187]
  v_pk_add_f32 v[202:203], v[202:203], v[218:219]
  v_pk_add_f32 v[172:173], v[172:173], v[188:189]
  v_pk_add_f32 v[204:205], v[204:205], v[220:221]
  v_pk_add_f32 v[174:175], v[174:175], v[190:191]
  v_pk_add_f32 v[206:207], v[206:207], v[222:223]
  v_pk_add_f32 v[160:161], v[160:161], v[192:193]
  v_pk_add_f32 v[162:163], v[162:163], v[194:195]
  v_pk_add_f32 v[164:165], v[164:165], v[196:197]
  v_pk_add_f32 v[166:167], v[166:167], v[198:199]
  v_pk_add_f32 v[168:169], v[168:169], v[200:201]
  v_pk_add_f32 v[170:171], v[170:171], v[202:203]
  v_pk_add_f32 v[172:173], v[172:173], v[204:205]
  v_pk_add_f32 v[174:175], v[174:175], v[206:207]
  v_cvt_pk_bf16_f32 v224, v160, v161
  v_cvt_pk_bf16_f32 v225, v162, v163
  v_cvt_pk_bf16_f32 v226, v164, v165
  v_cvt_pk_bf16_f32 v227, v166, v167
  v_cvt_pk_bf16_f32 v228, v168, v169
  v_cvt_pk_bf16_f32 v229, v170, v171
  v_cvt_pk_bf16_f32 v230, v172, v173
  v_cvt_pk_bf16_f32 v231, v174, v175
  s_add_u32 s34, s25, 82048
  s_nop 0
  v_permlane32_swap_b32 v224, v226
  v_permlane32_swap_b32 v225, v227
  v_permlane32_swap_b32 v228, v230
  v_permlane32_swap_b32 v229, v231
  buffer_store_dwordx4 v[224:227], v4, s[16:19], s34 offen offset:0
  buffer_store_dwordx4 v[228:231], v4, s[16:19], s34 offen offset:32
OP_34_r1:
  s_cmp_eq_u32 s80, 2
  s_cbranch_scc0 OP_34_r2
  v_add_u32 v6, 4096, v2
  ds_read_b128 v[160:163], v6 offset:0
  ds_read_b128 v[164:167], v6 offset:1024
  ds_read_b128 v[168:171], v6 offset:2048
  ds_read_b128 v[172:175], v6 offset:3072
  v_add_u32 v6, 36864, v2
  ds_read_b128 v[176:179], v6 offset:0
  ds_read_b128 v[180:183], v6 offset:1024
  ds_read_b128 v[184:187], v6 offset:2048
  ds_read_b128 v[188:191], v6 offset:3072
  v_add_u32 v6, 106496, v2
  ds_read_b128 v[192:195], v6 offset:0
  ds_read_b128 v[196:199], v6 offset:1024
  ds_read_b128 v[200:203], v6 offset:2048
  ds_read_b128 v[204:207], v6 offset:3072
  v_accvgpr_read_b32 v208, a32
  v_accvgpr_read_b32 v209, a33
  v_accvgpr_read_b32 v210, a34
  v_accvgpr_read_b32 v211, a35
  v_accvgpr_read_b32 v212, a36
  v_accvgpr_read_b32 v213, a37
  v_accvgpr_read_b32 v214, a38
  v_accvgpr_read_b32 v215, a39
  v_accvgpr_read_b32 v216, a40
  v_accvgpr_read_b32 v217, a41
  v_accvgpr_read_b32 v218, a42
  v_accvgpr_read_b32 v219, a43
  v_accvgpr_read_b32 v220, a44
  v_accvgpr_read_b32 v221, a45
  v_accvgpr_read_b32 v222, a46
  v_accvgpr_read_b32 v223, a47
  s_waitcnt lgkmcnt(0)
  v_pk_add_f32 v[160:161], v[160:161], v[176:177]
  v_pk_add_f32 v[192:193], v[192:193], v[208:209]
  v_pk_add_f32 v[162:163], v[162:163], v[178:179]
  v_pk_add_f32 v[194:195], v[194:195], v[210:211]
  v_pk_add_f32 v[164:165], v[164:165], v[180:181]
  v_pk_add_f32 v[196:197], v[196:197], v[212:213]
  v_pk_add_f32 v[166:167], v[166:167], v[182:183]
  v_pk_add_f32 v[198:199], v[198:199], v[214:215]
  v_pk_add_f32 v[168:169], v[168:169], v[184:185]
  v_pk_add_f32 v[200:201], v[200:201], v[216:217]
  v_pk_add_f32 v[170:171], v[170:171], v[186:187]
  v_pk_add_f32 v[202:203], v[202:203], v[218:219]
  v_pk_add_f32 v[172:173], v[172:173], v[188:189]
  v_pk_add_f32 v[204:205], v[204:205], v[220:221]
  v_pk_add_f32 v[174:175], v[174:175], v[190:191]
  v_pk_add_f32 v[206:207], v[206:207], v[222:223]
  v_pk_add_f32 v[160:161], v[160:161], v[192:193]
  v_pk_add_f32 v[162:163], v[162:163], v[194:195]
  v_pk_add_f32 v[164:165], v[164:165], v[196:197]
  v_pk_add_f32 v[166:167], v[166:167], v[198:199]
  v_pk_add_f32 v[168:169], v[168:169], v[200:201]
  v_pk_add_f32 v[170:171], v[170:171], v[202:203]
  v_pk_add_f32 v[172:173], v[172:173], v[204:205]
  v_pk_add_f32 v[174:175], v[174:175], v[206:207]
  v_cvt_pk_bf16_f32 v224, v160, v161
  v_cvt_pk_bf16_f32 v225, v162, v163
  v_cvt_pk_bf16_f32 v226, v164, v165
  v_cvt_pk_bf16_f32 v227, v166, v167
  v_cvt_pk_bf16_f32 v228, v168, v169
  v_cvt_pk_bf16_f32 v229, v170, v171
  v_cvt_pk_bf16_f32 v230, v172, v173
  v_cvt_pk_bf16_f32 v231, v174, v175
  s_add_u32 s34, s25, 64
  s_nop 0
  v_permlane32_swap_b32 v224, v226
  v_permlane32_swap_b32 v225, v227
  v_permlane32_swap_b32 v228, v230
  v_permlane32_swap_b32 v229, v231
  buffer_store_dwordx4 v[224:227], v4, s[16:19], s34 offen offset:0
  buffer_store_dwordx4 v[228:231], v4, s[16:19], s34 offen offset:32
OP_34_r2:
  s_cmp_eq_u32 s80, 3
  s_cbranch_scc0 OP_34_r3
  v_add_u32 v6, 8192, v2
  ds_read_b128 v[160:163], v6 offset:0
  ds_read_b128 v[164:167], v6 offset:1024
  ds_read_b128 v[168:171], v6 offset:2048
  ds_read_b128 v[172:175], v6 offset:3072
  v_add_u32 v6, 40960, v2
  ds_read_b128 v[176:179], v6 offset:0
  ds_read_b128 v[180:183], v6 offset:1024
  ds_read_b128 v[184:187], v6 offset:2048
  ds_read_b128 v[188:191], v6 offset:3072
  v_add_u32 v6, 73728, v2
  ds_read_b128 v[192:195], v6 offset:0
  ds_read_b128 v[196:199], v6 offset:1024
  ds_read_b128 v[200:203], v6 offset:2048
  ds_read_b128 v[204:207], v6 offset:3072
  v_accvgpr_read_b32 v208, a48
  v_accvgpr_read_b32 v209, a49
  v_accvgpr_read_b32 v210, a50
  v_accvgpr_read_b32 v211, a51
  v_accvgpr_read_b32 v212, a52
  v_accvgpr_read_b32 v213, a53
  v_accvgpr_read_b32 v214, a54
  v_accvgpr_read_b32 v215, a55
  v_accvgpr_read_b32 v216, a56
  v_accvgpr_read_b32 v217, a57
  v_accvgpr_read_b32 v218, a58
  v_accvgpr_read_b32 v219, a59
  v_accvgpr_read_b32 v220, a60
  v_accvgpr_read_b32 v221, a61
  v_accvgpr_read_b32 v222, a62
  v_accvgpr_read_b32 v223, a63
  s_waitcnt lgkmcnt(0)
  v_pk_add_f32 v[160:161], v[160:161], v[176:177]
  v_pk_add_f32 v[192:193], v[192:193], v[208:209]
  v_pk_add_f32 v[162:163], v[162:163], v[178:179]
  v_pk_add_f32 v[194:195], v[194:195], v[210:211]
  v_pk_add_f32 v[164:165], v[164:165], v[180:181]
  v_pk_add_f32 v[196:197], v[196:197], v[212:213]
  v_pk_add_f32 v[166:167], v[166:167], v[182:183]
  v_pk_add_f32 v[198:199], v[198:199], v[214:215]
  v_pk_add_f32 v[168:169], v[168:169], v[184:185]
  v_pk_add_f32 v[200:201], v[200:201], v[216:217]
  v_pk_add_f32 v[170:171], v[170:171], v[186:187]
  v_pk_add_f32 v[202:203], v[202:203], v[218:219]
  v_pk_add_f32 v[172:173], v[172:173], v[188:189]
  v_pk_add_f32 v[204:205], v[204:205], v[220:221]
  v_pk_add_f32 v[174:175], v[174:175], v[190:191]
  v_pk_add_f32 v[206:207], v[206:207], v[222:223]
  v_pk_add_f32 v[160:161], v[160:161], v[192:193]
  v_pk_add_f32 v[162:163], v[162:163], v[194:195]
  v_pk_add_f32 v[164:165], v[164:165], v[196:197]
  v_pk_add_f32 v[166:167], v[166:167], v[198:199]
  v_pk_add_f32 v[168:169], v[168:169], v[200:201]
  v_pk_add_f32 v[170:171], v[170:171], v[202:203]
  v_pk_add_f32 v[172:173], v[172:173], v[204:205]
  v_pk_add_f32 v[174:175], v[174:175], v[206:207]
  v_cvt_pk_bf16_f32 v224, v160, v161
  v_cvt_pk_bf16_f32 v225, v162, v163
  v_cvt_pk_bf16_f32 v226, v164, v165
  v_cvt_pk_bf16_f32 v227, v166, v167
  v_cvt_pk_bf16_f32 v228, v168, v169
  v_cvt_pk_bf16_f32 v229, v170, v171
  v_cvt_pk_bf16_f32 v230, v172, v173
  v_cvt_pk_bf16_f32 v231, v174, v175
  s_add_u32 s34, s25, 81984
  s_nop 0
  v_permlane32_swap_b32 v224, v226
  v_permlane32_swap_b32 v225, v227
  v_permlane32_swap_b32 v228, v230
  v_permlane32_swap_b32 v229, v231
  buffer_store_dwordx4 v[224:227], v4, s[16:19], s34 offen offset:0
  buffer_store_dwordx4 v[228:231], v4, s[16:19], s34 offen offset:32
OP_34_r3:
  s_barrier
  s_branch BG_FIN
BG_OMB:
  v_lshlrev_b32 v2, 4, v1
  v_add_u32 v5, 0, v1
  v_mul_u32_u24 v6, 8193, v5
  v_lshrrev_b32 v6, 16, v6
  v_mul_u32_u24 v7, 8, v6
  v_sub_u32 v7, v5, v7
  v_mul_u32_u24 v6, 1280, v6
  v_lshlrev_b32 v7, 4, v7
  v_add_u32 v8, v6, v7
  v_add_u32 v5, 64, v1
  v_mul_u32_u24 v6, 8193, v5
  v_lshrrev_b32 v6, 16, v6
  v_mul_u32_u24 v7, 8, v6
  v_sub_u32 v7, v5, v7
  v_mul_u32_u24 v6, 1280, v6
  v_lshlrev_b32 v7, 4, v7
  v_add_u32 v9, v6, v7
  v_lshrrev_b32 v5, 5, v1
  v_lshlrev_b32 v5, 2, v5
  v_bfe_u32 v6, v1, 2, 2
  v_add_u32 v5, v5, v6
  v_mul_u32_u24 v5, 128, v5
  v_bfe_u32 v6, v1, 4, 1
  v_lshlrev_b32 v6, 5, v6
  v_and_b32 v7, 3, v1
  v_lshlrev_b32 v7, 3, v7
  v_add3_u32 v5, v5, v6, v7
  s_mul_i32 s34, s80, 32768
  v_add_u32 v3, s34, v5
  v_and_b32 v5, 31, v1
  v_mul_u32_u24 v5, 2560, v5
  v_lshrrev_b32 v6, 5, v1
  v_lshlrev_b32 v6, 4, v6
  v_add_u32 v4, v5, v6
  s_waitcnt lgkmcnt(0)
  s_mul_i32 s20, s37, 786432
  s_mul_i32 s34, s80, 98304
  s_add_u32 s20, s20, s34
  s_add_u32 s20, s20, 77594624
  s_add_u32 s21, s20, 393216
  s_mul_i32 s22, s80, 1966080
  s_lshl_b32 s34, s39, 1
  s_add_u32 s22, s22, s34
  s_mul_i32 s23, s80, 32768
  s_add_u32 m0, s23, 0
  s_nop 0
  buffer_load_dwordx4 v8, s[8:11], s22 offen lds
  s_add_u32 m0, s23, 1024
  s_nop 0
  buffer_load_dwordx4 v9, s[8:11], s22 offen lds
  buffer_load_dwordx4 v[16:19], v2, s[4:7], s20 offen
  buffer_load_dwordx4 v[20:23], v2, s[4:7], s21 offen
  s_add_u32 s20, s20, 1024
  s_add_u32 s21, s21, 1024
  s_add_u32 s22, s22, 20480
  s_add_u32 m0, s23, 2048
  s_nop 0
  buffer_load_dwordx4 v8, s[8:11], s22 offen lds
  s_add_u32 m0, s23, 3072
  s_nop 0
  buffer_load_dwordx4 v9, s[8:11], s22 offen lds
  buffer_load_dwordx4 v[24:27], v2, s[4:7], s20 offen
  buffer_load_dwordx4 v[28:31], v2, s[4:7], s21 offen
  s_add_u32 s20, s20, 1024
  s_add_u32 s21, s21, 1024
  s_add_u32 s22, s22, 20480
  s_add_u32 m0, s23, 4096
  s_nop 0
  buffer_load_dwordx4 v8, s[8:11], s22 offen lds
  s_add_u32 m0, s23, 5120
  s_nop 0
  buffer_load_dwordx4 v9, s[8:11], s22 offen lds
  buffer_load_dwordx4 v[32:35], v2, s[4:7], s20 offen
  buffer_load_dwordx4 v[36:39], v2, s[4:7], s21 offen
  s_add_u32 s20, s20, 1024
  s_add_u32 s21, s21, 1024
  s_add_u32 s22, s22, 20480
  s_add_u32 m0, s23, 6144
  s_nop 0
  buffer_load_dwordx4 v8, s[8:11], s22 offen lds
  s_add_u32 m0, s23, 7168
  s_nop 0
  buffer_load_dwordx4 v9, s[8:11], s22 offen lds
  buffer_load_dwordx4 v[40:43], v2, s[4:7], s20 offen
  buffer_load_dwordx4 v[44:47], v2, s[4:7], s21 offen
  s_add_u32 s20, s20, 1024
  s_add_u32 s21, s21, 1024
  s_add_u32 s22, s22, 20480
  s_add_u32 m0, s23, 8192
  s_nop 0
  buffer_load_dwordx4 v8, s[8:11], s22 offen lds
  s_add_u32 m0, s23, 9216
  s_nop 0
  buffer_load_dwordx4 v9, s[8:11], s22 offen lds
  buffer_load_dwordx4 v[48:51], v2, s[4:7], s20 offen
  buffer_load_dwordx4 v[52:55], v2, s[4:7], s21 offen
  s_add_u32 s20, s20, 1024
  s_add_u32 s21, s21, 1024
  s_add_u32 s22, s22, 20480
  s_add_u32 m0, s23, 10240
  s_nop 0
  buffer_load_dwordx4 v8, s[8:11], s22 offen lds
  s_add_u32 m0, s23, 11264
  s_nop 0
  buffer_load_dwordx4 v9, s[8:11], s22 offen lds
  buffer_load_dwordx4 v[56:59], v2, s[4:7], s20 offen
  buffer_load_dwordx4 v[60:63], v2, s[4:7], s21 offen
  s_add_u32 s20, s20, 1024
  s_add_u32 s21, s21, 1024
  s_add_u32 s22, s22, 20480
  s_add_u32 m0, s23, 12288
  s_nop 0
  buffer_load_dwordx4 v8, s[8:11], s22 offen lds
  s_add_u32 m0, s23, 13312
  s_nop 0
  buffer_load_dwordx4 v9, s[8:11], s22 offen lds
  buffer_load_dwordx4 v[64:67], v2, s[4:7], s20 offen
  buffer_load_dwordx4 v[68:71], v2, s[4:7], s21 offen
  s_add_u32 s20, s20, 1024
  s_add_u32 s21, s21, 1024
  s_add_u32 s22, s22, 20480
  s_add_u32 m0, s23, 14336
  s_nop 0
  buffer_load_dwordx4 v8, s[8:11], s22 offen lds
  s_add_u32 m0, s23, 15360
  s_nop 0
  buffer_load_dwordx4 v9, s[8:11], s22 offen lds
  buffer_load_dwordx4 v[72:75], v2, s[4:7], s20 offen
  buffer_load_dwordx4 v[76:79], v2, s[4:7], s21 offen
  s_add_u32 s20, s20, 1024
  s_add_u32 s21, s21, 1024
  s_add_u32 s22, s22, 20480
  s_waitcnt vmcnt(28)
  ds_read_b64_tr_b16 v[80:81], v3 offset:0
  ds_read_b64_tr_b16 v[82:83], v3 offset:1024
  ds_read_b64_tr_b16 v[84:85], v3 offset:64
  ds_read_b64_tr_b16 v[86:87], v3 offset:1088
  s_waitcnt vmcnt(24) lgkmcnt(0)
  v_mfma_f32_32x32x16_bf16 a[0:15], v[80:83], v[16:19], 0
  ds_read_b64_tr_b16 v[120:121], v3 offset:2048
  v_mfma_f32_32x32x16_bf16 a[16:31], v[80:83], v[20:23], 0
  ds_read_b64_tr_b16 v[122:123], v3 offset:3072
  v_mfma_f32_32x32x16_bf16 a[32:47], v[84:87], v[16:19], 0
  ds_read_b64_tr_b16 v[124:125], v3 offset:2112
  v_mfma_f32_32x32x16_bf16 a[48:63], v[84:87], v[20:23], 0
  ds_read_b64_tr_b16 v[126:127], v3 offset:3136
  s_add_u32 m0, s23, 0
  s_nop 0
  buffer_load_dwordx4 v8, s[8:11], s22 offen lds
  s_add_u32 m0, s23, 1024
  s_nop 0
  buffer_load_dwordx4 v9, s[8:11], s22 offen lds
  buffer_load_dwordx4 v[16:19], v2, s[4:7], s20 offen
  buffer_load_dwordx4 v[20:23], v2, s[4:7], s21 offen
  s_add_u32 s20, s20, 1024
  s_add_u32 s21, s21, 1024
  s_add_u32 s22, s22, 20480
  s_waitcnt vmcnt(24) lgkmcnt(0)
  v_mfma_f32_32x32x16_bf16 a[0:15], v[120:123], v[24:27], a[0:15]
  ds_read_b64_tr_b16 v[80:81], v3 offset:4096
  v_mfma_f32_32x32x16_bf16 a[16:31], v[120:123], v[28:31], a[16:31]
  ds_read_b64_tr_b16 v[82:83], v3 offset:5120
  v_mfma_f32_32x32x16_bf16 a[32:47], v[124:127], v[24:27], a[32:47]
  ds_read_b64_tr_b16 v[84:85], v3 offset:4160
  v_mfma_f32_32x32x16_bf16 a[48:63], v[124:127], v[28:31], a[48:63]
  ds_read_b64_tr_b16 v[86:87], v3 offset:5184
  s_add_u32 m0, s23, 2048
  s_nop 0
  buffer_load_dwordx4 v8, s[8:11], s22 offen lds
  s_add_u32 m0, s23, 3072
  s_nop 0
  buffer_load_dwordx4 v9, s[8:11], s22 offen lds
  buffer_load_dwordx4 v[24:27], v2, s[4:7], s20 offen
  buffer_load_dwordx4 v[28:31], v2, s[4:7], s21 offen
  s_add_u32 s20, s20, 1024
  s_add_u32 s21, s21, 1024
  s_add_u32 s22, s22, 20480
  s_waitcnt vmcnt(24) lgkmcnt(0)
  v_mfma_f32_32x32x16_bf16 a[0:15], v[80:83], v[32:35], a[0:15]
  ds_read_b64_tr_b16 v[120:121], v3 offset:6144
  v_mfma_f32_32x32x16_bf16 a[16:31], v[80:83], v[36:39], a[16:31]
  ds_read_b64_tr_b16 v[122:123], v3 offset:7168
  v_mfma_f32_32x32x16_bf16 a[32:47], v[84:87], v[32:35], a[32:47]
  ds_read_b64_tr_b16 v[124:125], v3 offset:6208
  v_mfma_f32_32x32x16_bf16 a[48:63], v[84:87], v[36:39], a[48:63]
  ds_read_b64_tr_b16 v[126:127], v3 offset:7232
  s_add_u32 m0, s23, 4096
  s_nop 0
  buffer_load_dwordx4 v8, s[8:11], s22 offen lds
  s_add_u32 m0, s23, 5120
  s_nop 0
  buffer_load_dwordx4 v9, s[8:11], s22 offen lds
  buffer_load_dwordx4 v[32:35], v2, s[4:7], s20 offen
  buffer_load_dwordx4 v[36:39], v2, s[4:7], s21 offen
  s_add_u32 s20, s20, 1024
  s_add_u32 s21, s21, 1024
  s_add_u32 s22, s22, 20480
  s_waitcnt vmcnt(24) lgkmcnt(0)
  v_mfma_f32_32x32x16_bf16 a[0:15], v[120:123], v[40:43], a[0:15]
  ds_read_b64_tr_b16 v[80:81], v3 offset:8192
  v_mfma_f32_32x32x16_bf16 a[16:31], v[120:123], v[44:47], a[16:31]
  ds_read_b64_tr_b16 v[82:83], v3 offset:9216
  v_mfma_f32_32x32x16_bf16 a[32:47], v[124:127], v[40:43], a[32:47]
  ds_read_b64_tr_b16 v[84:85], v3 offset:8256
  v_mfma_f32_32x32x16_bf16 a[48:63], v[124:127], v[44:47], a[48:63]
  ds_read_b64_tr_b16 v[86:87], v3 offset:9280
  s_add_u32 m0, s23, 6144
  s_nop 0
  buffer_load_dwordx4 v8, s[8:11], s22 offen lds
  s_add_u32 m0, s23, 7168
  s_nop 0
  buffer_load_dwordx4 v9, s[8:11], s22 offen lds
  buffer_load_dwordx4 v[40:43], v2, s[4:7], s20 offen
  buffer_load_dwordx4 v[44:47], v2, s[4:7], s21 offen
  s_add_u32 s20, s20, 1024
  s_add_u32 s21, s21, 1024
  s_add_u32 s22, s22, 20480
  s_waitcnt vmcnt(24) lgkmcnt(0)
  v_mfma_f32_32x32x16_bf16 a[0:15], v[80:83], v[48:51], a[0:15]
  ds_read_b64_tr_b16 v[120:121], v3 offset:10240
  v_mfma_f32_32x32x16_bf16 a[16:31], v[80:83], v[52:55], a[16:31]
  ds_read_b64_tr_b16 v[122:123], v3 offset:11264
  v_mfma_f32_32x32x16_bf16 a[32:47], v[84:87], v[48:51], a[32:47]
  ds_read_b64_tr_b16 v[124:125], v3 offset:10304
  v_mfma_f32_32x32x16_bf16 a[48:63], v[84:87], v[52:55], a[48:63]
  ds_read_b64_tr_b16 v[126:127], v3 offset:11328
  s_add_u32 m0, s23, 8192
  s_nop 0
  buffer_load_dwordx4 v8, s[8:11], s22 offen lds
  s_add_u32 m0, s23, 9216
  s_nop 0
  buffer_load_dwordx4 v9, s[8:11], s22 offen lds
  buffer_load_dwordx4 v[48:51], v2, s[4:7], s20 offen
  buffer_load_dwordx4 v[52:55], v2, s[4:7], s21 offen
  s_add_u32 s20, s20, 1024
  s_add_u32 s21, s21, 1024
  s_add_u32 s22, s22, 20480
  s_waitcnt vmcnt(24) lgkmcnt(0)
  v_mfma_f32_32x32x16_bf16 a[0:15], v[120:123], v[56:59], a[0:15]
  ds_read_b64_tr_b16 v[80:81], v3 offset:12288
  v_mfma_f32_32x32x16_bf16 a[16:31], v[120:123], v[60:63], a[16:31]
  ds_read_b64_tr_b16 v[82:83], v3 offset:13312
  v_mfma_f32_32x32x16_bf16 a[32:47], v[124:127], v[56:59], a[32:47]
  ds_read_b64_tr_b16 v[84:85], v3 offset:12352
  v_mfma_f32_32x32x16_bf16 a[48:63], v[124:127], v[60:63], a[48:63]
  ds_read_b64_tr_b16 v[86:87], v3 offset:13376
  s_add_u32 m0, s23, 10240
  s_nop 0
  buffer_load_dwordx4 v8, s[8:11], s22 offen lds
  s_add_u32 m0, s23, 11264
  s_nop 0
  buffer_load_dwordx4 v9, s[8:11], s22 offen lds
  buffer_load_dwordx4 v[56:59], v2, s[4:7], s20 offen
  buffer_load_dwordx4 v[60:63], v2, s[4:7], s21 offen
  s_add_u32 s20, s20, 1024
  s_add_u32 s21, s21, 1024
  s_add_u32 s22, s22, 20480
  s_waitcnt vmcnt(24) lgkmcnt(0)
  v_mfma_f32_32x32x16_bf16 a[0:15], v[80:83], v[64:67], a[0:15]
  ds_read_b64_tr_b16 v[120:121], v3 offset:14336
  v_mfma_f32_32x32x16_bf16 a[16:31], v[80:83], v[68:71], a[16:31]
  ds_read_b64_tr_b16 v[122:123], v3 offset:15360
  v_mfma_f32_32x32x16_bf16 a[32:47], v[84:87], v[64:67], a[32:47]
  ds_read_b64_tr_b16 v[124:125], v3 offset:14400
  v_mfma_f32_32x32x16_bf16 a[48:63], v[84:87], v[68:71], a[48:63]
  ds_read_b64_tr_b16 v[126:127], v3 offset:15424
  s_add_u32 m0, s23, 12288
  s_nop 0
  buffer_load_dwordx4 v8, s[8:11], s22 offen lds
  s_add_u32 m0, s23, 13312
  s_nop 0
  buffer_load_dwordx4 v9, s[8:11], s22 offen lds
  buffer_load_dwordx4 v[64:67], v2, s[4:7], s20 offen
  buffer_load_dwordx4 v[68:71], v2, s[4:7], s21 offen
  s_add_u32 s20, s20, 1024
  s_add_u32 s21, s21, 1024
  s_add_u32 s22, s22, 20480
  s_waitcnt vmcnt(24) lgkmcnt(0)
  v_mfma_f32_32x32x16_bf16 a[0:15], v[120:123], v[72:75], a[0:15]
  ds_read_b64_tr_b16 v[80:81], v3 offset:0
  v_mfma_f32_32x32x16_bf16 a[16:31], v[120:123], v[76:79], a[16:31]
  ds_read_b64_tr_b16 v[82:83], v3 offset:1024
  v_mfma_f32_32x32x16_bf16 a[32:47], v[124:127], v[72:75], a[32:47]
  ds_read_b64_tr_b16 v[84:85], v3 offset:64
  v_mfma_f32_32x32x16_bf16 a[48:63], v[124:127], v[76:79], a[48:63]
  ds_read_b64_tr_b16 v[86:87], v3 offset:1088
  s_add_u32 m0, s23, 14336
  s_nop 0
  buffer_load_dwordx4 v8, s[8:11], s22 offen lds
  s_add_u32 m0, s23, 15360
  s_nop 0
  buffer_load_dwordx4 v9, s[8:11], s22 offen lds
  buffer_load_dwordx4 v[72:75], v2, s[4:7], s20 offen
  buffer_load_dwordx4 v[76:79], v2, s[4:7], s21 offen
  s_add_u32 s20, s20, 1024
  s_add_u32 s21, s21, 1024
  s_add_u32 s22, s22, 20480
  s_mov_b32 s24, 10
OP_36_loop:
  s_waitcnt vmcnt(24) lgkmcnt(0)
  v_mfma_f32_32x32x16_bf16 a[0:15], v[80:83], v[16:19], a[0:15]
  ds_read_b64_tr_b16 v[120:121], v3 offset:2048
  v_mfma_f32_32x32x16_bf16 a[16:31], v[80:83], v[20:23], a[16:31]
  ds_read_b64_tr_b16 v[122:123], v3 offset:3072
  v_mfma_f32_32x32x16_bf16 a[32:47], v[84:87], v[16:19], a[32:47]
  ds_read_b64_tr_b16 v[124:125], v3 offset:2112
  v_mfma_f32_32x32x16_bf16 a[48:63], v[84:87], v[20:23], a[48:63]
  ds_read_b64_tr_b16 v[126:127], v3 offset:3136
  s_add_u32 m0, s23, 0
  s_nop 0
  buffer_load_dwordx4 v8, s[8:11], s22 offen lds
  s_add_u32 m0, s23, 1024
  s_nop 0
  buffer_load_dwordx4 v9, s[8:11], s22 offen lds
  buffer_load_dwordx4 v[16:19], v2, s[4:7], s20 offen
  buffer_load_dwordx4 v[20:23], v2, s[4:7], s21 offen
  s_add_u32 s20, s20, 1024
  s_add_u32 s21, s21, 1024
  s_add_u32 s22, s22, 20480
  s_waitcnt vmcnt(24) lgkmcnt(0)
  v_mfma_f32_32x32x16_bf16 a[0:15], v[120:123], v[24:27], a[0:15]
  ds_read_b64_tr_b16 v[80:81], v3 offset:4096
  v_mfma_f32_32x32x16_bf16 a[16:31], v[120:123], v[28:31], a[16:31]
  ds_read_b64_tr_b16 v[82:83], v3 offset:5120
  v_mfma_f32_32x32x16_bf16 a[32:47], v[124:127], v[24:27], a[32:47]
  ds_read_b64_tr_b16 v[84:85], v3 offset:4160
  v_mfma_f32_32x32x16_bf16 a[48:63], v[124:127], v[28:31], a[48:63]
  ds_read_b64_tr_b16 v[86:87], v3 offset:5184
  s_add_u32 m0, s23, 2048
  s_nop 0
  buffer_load_dwordx4 v8, s[8:11], s22 offen lds
  s_add_u32 m0, s23, 3072
  s_nop 0
  buffer_load_dwordx4 v9, s[8:11], s22 offen lds
  buffer_load_dwordx4 v[24:27], v2, s[4:7], s20 offen
  buffer_load_dwordx4 v[28:31], v2, s[4:7], s21 offen
  s_add_u32 s20, s20, 1024
  s_add_u32 s21, s21, 1024
  s_add_u32 s22, s22, 20480
  s_waitcnt vmcnt(24) lgkmcnt(0)
  v_mfma_f32_32x32x16_bf16 a[0:15], v[80:83], v[32:35], a[0:15]
  ds_read_b64_tr_b16 v[120:121], v3 offset:6144
  v_mfma_f32_32x32x16_bf16 a[16:31], v[80:83], v[36:39], a[16:31]
  ds_read_b64_tr_b16 v[122:123], v3 offset:7168
  v_mfma_f32_32x32x16_bf16 a[32:47], v[84:87], v[32:35], a[32:47]
  ds_read_b64_tr_b16 v[124:125], v3 offset:6208
  v_mfma_f32_32x32x16_bf16 a[48:63], v[84:87], v[36:39], a[48:63]
  ds_read_b64_tr_b16 v[126:127], v3 offset:7232
  s_add_u32 m0, s23, 4096
  s_nop 0
  buffer_load_dwordx4 v8, s[8:11], s22 offen lds
  s_add_u32 m0, s23, 5120
  s_nop 0
  buffer_load_dwordx4 v9, s[8:11], s22 offen lds
  buffer_load_dwordx4 v[32:35], v2, s[4:7], s20 offen
  buffer_load_dwordx4 v[36:39], v2, s[4:7], s21 offen
  s_add_u32 s20, s20, 1024
  s_add_u32 s21, s21, 1024
  s_add_u32 s22, s22, 20480
  s_waitcnt vmcnt(24) lgkmcnt(0)
  v_mfma_f32_32x32x16_bf16 a[0:15], v[120:123], v[40:43], a[0:15]
  ds_read_b64_tr_b16 v[80:81], v3 offset:8192
  v_mfma_f32_32x32x16_bf16 a[16:31], v[120:123], v[44:47], a[16:31]
  ds_read_b64_tr_b16 v[82:83], v3 offset:9216
  v_mfma_f32_32x32x16_bf16 a[32:47], v[124:127], v[40:43], a[32:47]
  ds_read_b64_tr_b16 v[84:85], v3 offset:8256
  v_mfma_f32_32x32x16_bf16 a[48:63], v[124:127], v[44:47], a[48:63]
  ds_read_b64_tr_b16 v[86:87], v3 offset:9280
  s_add_u32 m0, s23, 6144
  s_nop 0
  buffer_load_dwordx4 v8, s[8:11], s22 offen lds
  s_add_u32 m0, s23, 7168
  s_nop 0
  buffer_load_dwordx4 v9, s[8:11], s22 offen lds
  buffer_load_dwordx4 v[40:43], v2, s[4:7], s20 offen
  buffer_load_dwordx4 v[44:47], v2, s[4:7], s21 offen
  s_add_u32 s20, s20, 1024
  s_add_u32 s21, s21, 1024
  s_add_u32 s22, s22, 20480
  s_waitcnt vmcnt(24) lgkmcnt(0)
  v_mfma_f32_32x32x16_bf16 a[0:15], v[80:83], v[48:51], a[0:15]
  ds_read_b64_tr_b16 v[120:121], v3 offset:10240
  v_mfma_f32_32x32x16_bf16 a[16:31], v[80:83], v[52:55], a[16:31]
  ds_read_b64_tr_b16 v[122:123], v3 offset:11264
  v_mfma_f32_32x32x16_bf16 a[32:47], v[84:87], v[48:51], a[32:47]
  ds_read_b64_tr_b16 v[124:125], v3 offset:10304
  v_mfma_f32_32x32x16_bf16 a[48:63], v[84:87], v[52:55], a[48:63]
  ds_read_b64_tr_b16 v[126:127], v3 offset:11328
  s_add_u32 m0, s23, 8192
  s_nop 0
  buffer_load_dwordx4 v8, s[8:11], s22 offen lds
  s_add_u32 m0, s23, 9216
  s_nop 0
  buffer_load_dwordx4 v9, s[8:11], s22 offen lds
  buffer_load_dwordx4 v[48:51], v2, s[4:7], s20 offen
  buffer_load_dwordx4 v[52:55], v2, s[4:7], s21 offen
  s_add_u32 s20, s20, 1024
  s_add_u32 s21, s21, 1024
  s_add_u32 s22, s22, 20480
  s_waitcnt vmcnt(24) lgkmcnt(0)
  v_mfma_f32_32x32x16_bf16 a[0:15], v[120:123], v[56:59], a[0:15]
  ds_read_b64_tr_b16 v[80:81], v3 offset:12288
  v_mfma_f32_32x32x16_bf16 a[16:31], v[120:123], v[60:63], a[16:31]
  ds_read_b64_tr_b16 v[82:83], v3 offset:13312
  v_mfma_f32_32x32x16_bf16 a[32:47], v[124:127], v[56:59], a[32:47]
  ds_read_b64_tr_b16 v[84:85], v3 offset:12352
  v_mfma_f32_32x32x16_bf16 a[48:63], v[124:127], v[60:63], a[48:63]
  ds_read_b64_tr_b16 v[86:87], v3 offset:13376
  s_add_u32 m0, s23, 10240
  s_nop 0
  buffer_load_dwordx4 v8, s[8:11], s22 offen lds
  s_add_u32 m0, s23, 11264
  s_nop 0
  buffer_load_dwordx4 v9, s[8:11], s22 offen lds
  buffer_load_dwordx4 v[56:59], v2, s[4:7], s20 offen
  buffer_load_dwordx4 v[60:63], v2, s[4:7], s21 offen
  s_add_u32 s20, s20, 1024
  s_add_u32 s21, s21, 1024
  s_add_u32 s22, s22, 20480
  s_waitcnt vmcnt(24) lgkmcnt(0)
  v_mfma_f32_32x32x16_bf16 a[0:15], v[80:83], v[64:67], a[0:15]
  ds_read_b64_tr_b16 v[120:121], v3 offset:14336
  v_mfma_f32_32x32x16_bf16 a[16:31], v[80:83], v[68:71], a[16:31]
  ds_read_b64_tr_b16 v[122:123], v3 offset:15360
  v_mfma_f32_32x32x16_bf16 a[32:47], v[84:87], v[64:67], a[32:47]
  ds_read_b64_tr_b16 v[124:125], v3 offset:14400
  v_mfma_f32_32x32x16_bf16 a[48:63], v[84:87], v[68:71], a[48:63]
  ds_read_b64_tr_b16 v[126:127], v3 offset:15424
  s_add_u32 m0, s23, 12288
  s_nop 0
  buffer_load_dwordx4 v8, s[8:11], s22 offen lds
  s_add_u32 m0, s23, 13312
  s_nop 0
  buffer_load_dwordx4 v9, s[8:11], s22 offen lds
  buffer_load_dwordx4 v[64:67], v2, s[4:7], s20 offen
  buffer_load_dwordx4 v[68:71], v2, s[4:7], s21 offen
  s_add_u32 s20, s20, 1024
  s_add_u32 s21, s21, 1024
  s_add_u32 s22, s22, 20480
  s_waitcnt vmcnt(24) lgkmcnt(0)
  v_mfma_f32_32x32x16_bf16 a[0:15], v[120:123], v[72:75], a[0:15]
  ds_read_b64_tr_b16 v[80:81], v3 offset:0
  v_mfma_f32_32x32x16_bf16 a[16:31], v[120:123], v[76:79], a[16:31]
  ds_read_b64_tr_b16 v[82:83], v3 offset:1024
  v_mfma_f32_32x32x16_bf16 a[32:47], v[124:127], v[72:75], a[32:47]
  ds_read_b64_tr_b16 v[84:85], v3 offset:64
  v_mfma_f32_32x32x16_bf16 a[48:63], v[124:127], v[76:79], a[48:63]
  ds_read_b64_tr_b16 v[86:87], v3 offset:1088
  s_add_u32 m0, s23, 14336
  s_nop 0
  buffer_load_dwordx4 v8, s[8:11], s22 offen lds
  s_add_u32 m0, s23, 15360
  s_nop 0
  buffer_load_dwordx4 v9, s[8:11], s22 offen lds
  buffer_load_dwordx4 v[72:75], v2, s[4:7], s20 offen
  buffer_load_dwordx4 v[76:79], v2, s[4:7], s21 offen
  s_add_u32 s20, s20, 1024
  s_add_u32 s21, s21, 1024
  s_add_u32 s22, s22, 20480
  s_sub_u32 s24, s24, 1
  s_cmp_lg_u32 s24, 0
  s_cbranch_scc1 OP_36_loop
  s_cmp_eq_u32 s80, 0
  s_cbranch_scc0 TI_37
  v_mov_b32 v255, 1
  s_mov_b64 exec, 1
  buffer_atomic_add v255, off, s[84:87], s97 sc0 sc1
  s_mov_b64 exec, -1
TI_37:
  s_waitcnt vmcnt(24) lgkmcnt(0)
  v_mfma_f32_32x32x16_bf16 a[0:15], v[80:83], v[16:19], a[0:15]
  ds_read_b64_tr_b16 v[120:121], v3 offset:2048
  v_mfma_f32_32x32x16_bf16 a[16:31], v[80:83], v[20:23], a[16:31]
  ds_read_b64_tr_b16 v[122:123], v3 offset:3072
  v_mfma_f32_32x32x16_bf16 a[32:47], v[84:87], v[16:19], a[32:47]
  ds_read_b64_tr_b16 v[124:125], v3 offset:2112
  v_mfma_f32_32x32x16_bf16 a[48:63], v[84:87], v[20:23], a[48:63]
  ds_read_b64_tr_b16 v[126:127], v3 offset:3136
  s_waitcnt vmcnt(20) lgkmcnt(0)
  v_mfma_f32_32x32x16_bf16 a[0:15], v[120:123], v[24:27], a[0:15]
  ds_read_b64_tr_b16 v[80:81], v3 offset:4096
  v_mfma_f32_32x32x16_bf16 a[16:31], v[120:123], v[28:31], a[16:31]
  ds_read_b64_tr_b16 v[82:83], v3 offset:5120
  v_mfma_f32_32x32x16_bf16 a[32:47], v[124:127], v[24:27], a[32:47]
  ds_read_b64_tr_b16 v[84:85], v3 offset:4160
  v_mfma_f32_32x32x16_bf16 a[48:63], v[124:127], v[28:31], a[48:63]
  ds_read_b64_tr_b16 v[86:87], v3 offset:5184
  s_waitcnt vmcnt(16) lgkmcnt(0)
  v_mfma_f32_32x32x16_bf16 a[0:15], v[80:83], v[32:35], a[0:15]
  ds_read_b64_tr_b16 v[120:121], v3 offset:6144
  v_mfma_f32_32x32x16_bf16 a[16:31], v[80:83], v[36:39], a[16:31]
  ds_read_b64_tr_b16 v[122:123], v3 offset:7168
  v_mfma_f32_32x32x16_bf16 a[32:47], v[84:87], v[32:35], a[32:47]
  ds_read_b64_tr_b16 v[124:125], v3 offset:6208
  v_mfma_f32_32x32x16_bf16 a[48:63], v[84:87], v[36:39], a[48:63]
  ds_read_b64_tr_b16 v[126:127], v3 offset:7232
  s_waitcnt vmcnt(12) lgkmcnt(0)
  v_mfma_f32_32x32x16_bf16 a[0:15], v[120:123], v[40:43], a[0:15]
  ds_read_b64_tr_b16 v[80:81], v3 offset:8192
  v_mfma_f32_32x32x16_bf16 a[16:31], v[120:123], v[44:47], a[16:31]
  ds_read_b64_tr_b16 v[82:83], v3 offset:9216
  v_mfma_f32_32x32x16_bf16 a[32:47], v[124:127], v[40:43], a[32:47]
  ds_read_b64_tr_b16 v[84:85], v3 offset:8256
  v_mfma_f32_32x32x16_bf16 a[48:63], v[124:127], v[44:47], a[48:63]
  ds_read_b64_tr_b16 v[86:87], v3 offset:9280
  s_waitcnt vmcnt(8) lgkmcnt(0)
  v_mfma_f32_32x32x16_bf16 a[0:15], v[80:83], v[48:51], a[0:15]
  ds_read_b64_tr_b16 v[120:121], v3 offset:10240
  v_mfma_f32_32x32x16_bf16 a[16:31], v[80:83], v[52:55], a[16:31]
  ds_read_b64_tr_b16 v[122:123], v3 offset:11264
  v_mfma_f32_32x32x16_bf16 a[32:47], v[84:87], v[48:51], a[32:47]
  ds_read_b64_tr_b16 v[124:125], v3 offset:10304
  v_mfma_f32_32x32x16_bf16 a[48:63], v[84:87], v[52:55], a[48:63]
  ds_read_b64_tr_b16 v[126:127], v3 offset:11328
  s_waitcnt vmcnt(4) lgkmcnt(0)
  v_mfma_f32_32x32x16_bf16 a[0:15], v[120:123], v[56:59], a[0:15]
  ds_read_b64_tr_b16 v[80:81], v3 offset:12288
  v_mfma_f32_32x32x16_bf16 a[16:31], v[120:123], v[60:63], a[16:31]
  ds_read_b64_tr_b16 v[82:83], v3 offset:13312
  v_mfma_f32_32x32x16_bf16 a[32:47], v[124:127], v[56:59], a[32:47]
  ds_read_b64_tr_b16 v[84:85], v3 offset:12352
  v_mfma_f32_32x32x16_bf16 a[48:63], v[124:127], v[60:63], a[48:63]
  ds_read_b64_tr_b16 v[86:87], v3 offset:13376
  s_waitcnt vmcnt(0) lgkmcnt(0)
  v_mfma_f32_32x32x16_bf16 a[0:15], v[80:83], v[64:67], a[0:15]
  ds_read_b64_tr_b16 v[120:121], v3 offset:14336
  v_mfma_f32_32x32x16_bf16 a[16:31], v[80:83], v[68:71], a[16:31]
  ds_read_b64_tr_b16 v[122:123], v3 offset:15360
  v_mfma_f32_32x32x16_bf16 a[32:47], v[84:87], v[64:67], a[32:47]
  ds_read_b64_tr_b16 v[124:125], v3 offset:14400
  v_mfma_f32_32x32x16_bf16 a[48:63], v[84:87], v[68:71], a[48:63]
  ds_read_b64_tr_b16 v[126:127], v3 offset:15424
  s_waitcnt lgkmcnt(0)
  v_mfma_f32_32x32x16_bf16 a[0:15], v[120:123], v[72:75], a[0:15]
  v_mfma_f32_32x32x16_bf16 a[16:31], v[120:123], v[76:79], a[16:31]
  v_mfma_f32_32x32x16_bf16 a[32:47], v[124:127], v[72:75], a[32:47]
  v_mfma_f32_32x32x16_bf16 a[48:63], v[124:127], v[76:79], a[48:63]
  s_waitcnt vmcnt(0)
  v_readfirstlane_b32 s96, v255
  s_nop 7
  s_nop 7
  v_add_u32 v5, s23, v2
  s_cmp_eq_u32 s80, 0
  s_cbranch_scc0 OP_36_w0
  ds_write_b128 v5, a[16:19] offset:0
  ds_write_b128 v5, a[20:23] offset:1024
  ds_write_b128 v5, a[24:27] offset:2048
  ds_write_b128 v5, a[28:31] offset:3072
  ds_write_b128 v5, a[32:35] offset:4096
  ds_write_b128 v5, a[36:39] offset:5120
  ds_write_b128 v5, a[40:43] offset:6144
  ds_write_b128 v5, a[44:47] offset:7168
  ds_write_b128 v5, a[48:51] offset:8192
  ds_write_b128 v5, a[52:55] offset:9216
  ds_write_b128 v5, a[56:59] offset:10240
  ds_write_b128 v5, a[60:63] offset:11264
OP_36_w0:
  s_cmp_eq_u32 s80, 1
  s_cbranch_scc0 OP_36_w1
  ds_write_b128 v5, a[0:3] offset:0
  ds_write_b128 v5, a[4:7] offset:1024
  ds_write_b128 v5, a[8:11] offset:2048
  ds_write_b128 v5, a[12:15] offset:3072
  ds_write_b128 v5, a[32:35] offset:4096
  ds_write_b128 v5, a[36:39] offset:5120
  ds_write_b128 v5, a[40:43] offset:6144
  ds_write_b128 v5, a[44:47] offset:7168
  ds_write_b128 v5, a[48:51] offset:8192
  ds_write_b128 v5, a[52:55] offset:9216
  ds_write_b128 v5, a[56:59] offset:10240
  ds_write_b128 v5, a[60:63] offset:11264
OP_36_w1:
  s_cmp_eq_u32 s80, 2
  s_cbranch_scc0 OP_36_w2
  ds_write_b128 v5, a[0:3] offset:0
  ds_write_b128 v5, a[4:7] offset:1024
  ds_write_b128 v5, a[8:11] offset:2048
  ds_write_b128 v5, a[12:15] offset:3072
  ds_write_b128 v5, a[16:19] offset:4096
  ds_write_b128 v5, a[20:23] offset:5120
  ds_write_b128 v5, a[24:27] offset:6144
  ds_write_b128 v5, a[28:31] offset:7168
  ds_write_b128 v5, a[48:51] offset:8192
  ds_write_b128 v5, a[52:55] offset:9216
  ds_write_b128 v5, a[56:59] offset:10240
  ds_write_b128 v5, a[60:63] offset:11264
OP_36_w2:
  s_cmp_eq_u32 s80, 3
  s_cbranch_scc0 OP_36_w3
  ds_write_b128 v5, a[0:3] offset:0
  ds_write_b128 v5, a[4:7] offset:1024
  ds_write_b128 v5, a[8:11] offset:2048
  ds_write_b128 v5, a[12:15] offset:3072
  ds_write_b128 v5, a[16:19] offset:4096
  ds_write_b128 v5, a[20:23] offset:5120
  ds_write_b128 v5, a[24:27] offset:6144
  ds_write_b128 v5, a[28:31] offset:7168
  ds_write_b128 v5, a[32:35] offset:8192
  ds_write_b128 v5, a[36:39] offset:9216
  ds_write_b128 v5, a[40:43] offset:10240
  ds_write_b128 v5, a[44:47] offset:11264
OP_36_w3:
  s_waitcnt lgkmcnt(0)
  s_barrier
  s_mul_i32 s25, s37, 163840
  s_lshl_b32 s34, s39, 1
  s_add_u32 s25, s25, s34
  s_cmp_eq_u32 s80, 0
  s_cbranch_scc0 OP_36_r0
  v_add_u32 v6, 32768, v2
  ds_read_b128 v[160:163], v6 offset:0
  ds_read_b128 v[164:167], v6 offset:1024
  ds_read_b128 v[168:171], v6 offset:2048
  ds_read_b128 v[172:175], v6 offset:3072
  v_add_u32 v6, 65536, v2
  ds_read_b128 v[176:179], v6 offset:0
  ds_read_b128 v[180:183], v6 offset:1024
  ds_read_b128 v[184:187], v6 offset:2048
  ds_read_b128 v[188:191], v6 offset:3072
  v_add_u32 v6, 98304, v2
  ds_read_b128 v[192:195], v6 offset:0
  ds_read_b128 v[196:199], v6 offset:1024
  ds_read_b128 v[200:203], v6 offset:2048
  ds_read_b128 v[204:207], v6 offset:3072
  v_accvgpr_read_b32 v208, a0
  v_accvgpr_read_b32 v209, a1
  v_accvgpr_read_b32 v210, a2
  v_accvgpr_read_b32 v211, a3
  v_accvgpr_read_b32 v212, a4
  v_accvgpr_read_b32 v213, a5
  v_accvgpr_read_b32 v214, a6
  v_accvgpr_read_b32 v215, a7
  v_accvgpr_read_b32 v216, a8
  v_accvgpr_read_b32 v217, a9
  v_accvgpr_read_b32 v218, a10
  v_accvgpr_read_b32 v219, a11
  v_accvgpr_read_b32 v220, a12
  v_accvgpr_read_b32 v221, a13
  v_accvgpr_read_b32 v222, a14
  v_accvgpr_read_b32 v223, a15
  s_waitcnt lgkmcnt(0)
  v_pk_add_f32 v[160:161], v[160:161], v[176:177]
  v_pk_add_f32 v[192:193], v[192:193], v[208:209]
  v_pk_add_f32 v[162:163], v[162:163], v[178:179]
  v_pk_add_f32 v[194:195], v[194:195], v[210:211]
  v_pk_add_f32 v[164:165], v[164:165], v[180:181]
  v_pk_add_f32 v[196:197], v[196:197], v[212:213]
  v_pk_add_f32 v[166:167], v[166:167], v[182:183]
  v_pk_add_f32 v[198:199], v[198:199], v[214:215]
  v_pk_add_f32 v[168:169], v[168:169], v[184:185]
  v_pk_add_f32 v[200:201], v[200:201], v[216:217]
  v_pk_add_f32 v[170:171], v[170:171], v[186:187]
  v_pk_add_f32 v[202:203], v[202:203], v[218:219]
  v_pk_add_f32 v[172:173], v[172:173], v[188:189]
  v_pk_add_f32 v[204:205], v[204:205], v[220:221]
  v_pk_add_f32 v[174:175], v[174:175], v[190:191]
  v_pk_add_f32 v[206:207], v[206:207], v[222:223]
  v_pk_add_f32 v[160:161], v[160:161], v[192:193]
  v_pk_add_f32 v[162:163], v[162:163], v[194:195]
  v_pk_add_f32 v[164:165], v[164:165], v[196:197]
  v_pk_add_f32 v[166:167], v[166:167], v[198:199]
  v_pk_add_f32 v[168:169], v[168:169], v[200:201]
  v_pk_add_f32 v[170:171], v[170:171], v[202:203]
  v_pk_add_f32 v[172:173], v[172:173], v[204:205]
  v_pk_add_f32 v[174:175], v[174:175], v[206:207]
  v_cvt_pk_bf16_f32 v224, v160, v161
  v_cvt_pk_bf16_f32 v225, v162, v163
  v_cvt_pk_bf16_f32 v226, v164, v165
  v_cvt_pk_bf16_f32 v227, v166, v167
  v_cvt_pk_bf16_f32 v228, v168, v169
  v_cvt_pk_bf16_f32 v229, v170, v171
  v_cvt_pk_bf16_f32 v230, v172, v173
  v_cvt_pk_bf16_f32 v231, v174, v175
  s_add_u32 s34, s25, 0
  s_nop 0
  v_permlane32_swap_b32 v224, v226
  v_permlane32_swap_b32 v225, v227
  v_permlane32_swap_b32 v228, v230
  v_permlane32_swap_b32 v229, v231
  buffer_store_dwordx4 v[224:227], v4, s[16:19], s34 offen offset:0
  buffer_store_dwordx4 v[228:231], v4, s[16:19], s34 offen offset:32
OP_36_r0:
  s_cmp_eq_u32 s80, 1
  s_cbranch_scc0 OP_36_r1
  v_add_u32 v6, 0, v2
  ds_read_b128 v[160:163], v6 offset:0
  ds_read_b128 v[164:167], v6 offset:1024
  ds_read_b128 v[168:171], v6 offset:2048
  ds_read_b128 v[172:175], v6 offset:3072
  v_add_u32 v6, 69632, v2
  ds_read_b128 v[176:179], v6 offset:0
  ds_read_b128 v[180:183], v6 offset:1024
  ds_read_b128 v[184:187], v6 offset:2048
  ds_read_b128 v[188:191], v6 offset:3072
  v_add_u32 v6, 102400, v2
  ds_read_b128 v[192:195], v6 offset:0
  ds_read_b128 v[196:199], v6 offset:1024
  ds_read_b128 v[200:203], v6 offset:2048
  ds_read_b128 v[204:207], v6 offset:3072
  v_accvgpr_read_b32 v208, a16
  v_accvgpr_read_b32 v209, a17
  v_accvgpr_read_b32 v210, a18
  v_accvgpr_read_b32 v211, a19
  v_accvgpr_read_b32 v212, a20
  v_accvgpr_read_b32 v213, a21
  v_accvgpr_read_b32 v214, a22
  v_accvgpr_read_b32 v215, a23
  v_accvgpr_read_b32 v216, a24
  v_accvgpr_read_b32 v217, a25
  v_accvgpr_read_b32 v218, a26
  v_accvgpr_read_b32 v219, a27
  v_accvgpr_read_b32 v220, a28
  v_accvgpr_read_b32 v221, a29
  v_accvgpr_read_b32 v222, a30
  v_accvgpr_read_b32 v223, a31
  s_waitcnt lgkmcnt(0)
  v_pk_add_f32 v[160:161], v[160:161], v[176:177]
  v_pk_add_f32 v[192:193], v[192:193], v[208:209]
  v_pk_add_f32 v[162:163], v[162:163], v[178:179]
  v_pk_add_f32 v[194:195], v[194:195], v[210:211]
  v_pk_add_f32 v[164:165], v[164:165], v[180:181]
  v_pk_add_f32 v[196:197], v[196:197], v[212:213]
  v_pk_add_f32 v[166:167], v[166:167], v[182:183]
  v_pk_add_f32 v[198:199], v[198:199], v[214:215]
  v_pk_add_f32 v[168:169], v[168:169], v[184:185]
  v_pk_add_f32 v[200:201], v[200:201], v[216:217]
  v_pk_add_f32 v[170:171], v[170:171], v[186:187]
  v_pk_add_f32 v[202:203], v[202:203], v[218:219]
  v_pk_add_f32 v[172:173], v[172:173], v[188:189]
  v_pk_add_f32 v[204:205], v[204:205], v[220:221]
  v_pk_add_f32 v[174:175], v[174:175], v[190:191]
  v_pk_add_f32 v[206:207], v[206:207], v[222:223]
  v_pk_add_f32 v[160:161], v[160:161], v[192:193]
  v_pk_add_f32 v[162:163], v[162:163], v[194:195]
  v_pk_add_f32 v[164:165], v[164:165], v[196:197]
  v_pk_add_f32 v[166:167], v[166:167], v[198:199]
  v_pk_add_f32 v[168:169], v[168:169], v[200:201]
  v_pk_add_f32 v[170:171], v[170:171], v[202:203]
  v_pk_add_f32 v[172:173], v[172:173], v[204:205]
  v_pk_add_f32 v[174:175], v[174:175], v[206:207]
  v_cvt_pk_bf16_f32 v224, v160, v161
  v_cvt_pk_bf16_f32 v225, v162, v163
  v_cvt_pk_bf16_f32 v226, v164, v165
  v_cvt_pk_bf16_f32 v227, v166, v167
  v_cvt_pk_bf16_f32 v228, v168, v169
  v_cvt_pk_bf16_f32 v229, v170, v171
  v_cvt_pk_bf16_f32 v230, v172, v173
  v_cvt_pk_bf16_f32 v231, v174, v175
  s_add_u32 s34, s25, 81920
  s_nop 0
  v_permlane32_swap_b32 v224, v226
  v_permlane32_swap_b32 v225, v227
  v_permlane32_swap_b32 v228, v230
  v_permlane32_swap_b32 v229, v231
  buffer_store_dwordx4 v[224:227], v4, s[16:19], s34 offen offset:0
  buffer_store_dwordx4 v[228:231], v4, s[16:19], s34 offen offset:32
OP_36_r1:
  s_cmp_eq_u32 s80, 2
  s_cbranch_scc0 OP_36_r2
  v_add_u32 v6, 4096, v2
  ds_read_b128 v[160:163], v6 offset:0
  ds_read_b128 v[164:167], v6 offset:1024
  ds_read_b128 v[168:171], v6 offset:2048
  ds_read_b128 v[172:175], v6 offset:3072
  v_add_u32 v6, 36864, v2
  ds_read_b128 v[176:179], v6 offset:0
  ds_read_b128 v[180:183], v6 offset:1024
  ds_read_b128 v[184:187], v6 offset:2048
  ds_read_b128 v[188:191], v6 offset:3072
  v_add_u32 v6, 106496, v2
  ds_read_b128 v[192:195], v6 offset:0
  ds_read_b128 v[196:199], v6 offset:1024
  ds_read_b128 v[200:203], v6 offset:2048
  ds_read_b128 v[204:207], v6 offset:3072
  v_accvgpr_read_b32 v208, a32
  v_accvgpr_read_b32 v209, a33
  v_accvgpr_read_b32 v210, a34
  v_accvgpr_read_b32 v211, a35
  v_accvgpr_read_b32 v212, a36
  v_accvgpr_read_b32 v213, a37
  v_accvgpr_read_b32 v214, a38
  v_accvgpr_read_b32 v215, a39
  v_accvgpr_read_b32 v216, a40
  v_accvgpr_read_b32 v217, a41
  v_accvgpr_read_b32 v218, a42
  v_accvgpr_read_b32 v219, a43
  v_accvgpr_read_b32 v220, a44
  v_accvgpr_read_b32 v221, a45
  v_accvgpr_read_b32 v222, a46
  v_accvgpr_read_b32 v223, a47
  s_waitcnt lgkmcnt(0)
  v_pk_add_f32 v[160:161], v[160:161], v[176:177]
  v_pk_add_f32 v[192:193], v[192:193], v[208:209]
  v_pk_add_f32 v[162:163], v[162:163], v[178:179]
  v_pk_add_f32 v[194:195], v[194:195], v[210:211]
  v_pk_add_f32 v[164:165], v[164:165], v[180:181]
  v_pk_add_f32 v[196:197], v[196:197], v[212:213]
  v_pk_add_f32 v[166:167], v[166:167], v[182:183]
  v_pk_add_f32 v[198:199], v[198:199], v[214:215]
  v_pk_add_f32 v[168:169], v[168:169], v[184:185]
  v_pk_add_f32 v[200:201], v[200:201], v[216:217]
  v_pk_add_f32 v[170:171], v[170:171], v[186:187]
  v_pk_add_f32 v[202:203], v[202:203], v[218:219]
  v_pk_add_f32 v[172:173], v[172:173], v[188:189]
  v_pk_add_f32 v[204:205], v[204:205], v[220:221]
  v_pk_add_f32 v[174:175], v[174:175], v[190:191]
  v_pk_add_f32 v[206:207], v[206:207], v[222:223]
  v_pk_add_f32 v[160:161], v[160:161], v[192:193]
  v_pk_add_f32 v[162:163], v[162:163], v[194:195]
  v_pk_add_f32 v[164:165], v[164:165], v[196:197]
  v_pk_add_f32 v[166:167], v[166:167], v[198:199]
  v_pk_add_f32 v[168:169], v[168:169], v[200:201]
  v_pk_add_f32 v[170:171], v[170:171], v[202:203]
  v_pk_add_f32 v[172:173], v[172:173], v[204:205]
  v_pk_add_f32 v[174:175], v[174:175], v[206:207]
  v_cvt_pk_bf16_f32 v224, v160, v161
  v_cvt_pk_bf16_f32 v225, v162, v163
  v_cvt_pk_bf16_f32 v226, v164, v165
  v_cvt_pk_bf16_f32 v227, v166, v167
  v_cvt_pk_bf16_f32 v228, v168, v169
  v_cvt_pk_bf16_f32 v229, v170, v171
  v_cvt_pk_bf16_f32 v230, v172, v173
  v_cvt_pk_bf16_f32 v231, v174, v175
  s_add_u32 s34, s25, 64
  s_nop 0
  v_permlane32_swap_b32 v224, v226
  v_permlane32_swap_b32 v225, v227
  v_permlane32_swap_b32 v228, v230
  v_permlane32_swap_b32 v229, v231
  buffer_store_dwordx4 v[224:227], v4, s[16:19], s34 offen offset:0
  buffer_store_dwordx4 v[228:231], v4, s[16:19], s34 offen offset:32
OP_36_r2:
  s_cmp_eq_u32 s80, 3
  s_cbranch_scc0 OP_36_r3
  v_add_u32 v6, 8192, v2
  ds_read_b128 v[160:163], v6 offset:0
  ds_read_b128 v[164:167], v6 offset:1024
  ds_read_b128 v[168:171], v6 offset:2048
  ds_read_b128 v[172:175], v6 offset:3072
  v_add_u32 v6, 40960, v2
  ds_read_b128 v[176:179], v6 offset:0
  ds_read_b128 v[180:183], v6 offset:1024
  ds_read_b128 v[184:187], v6 offset:2048
  ds_read_b128 v[188:191], v6 offset:3072
  v_add_u32 v6, 73728, v2
  ds_read_b128 v[192:195], v6 offset:0
  ds_read_b128 v[196:199], v6 offset:1024
  ds_read_b128 v[200:203], v6 offset:2048
  ds_read_b128 v[204:207], v6 offset:3072
  v_accvgpr_read_b32 v208, a48
  v_accvgpr_read_b32 v209, a49
  v_accvgpr_read_b32 v210, a50
  v_accvgpr_read_b32 v211, a51
  v_accvgpr_read_b32 v212, a52
  v_accvgpr_read_b32 v213, a53
  v_accvgpr_read_b32 v214, a54
  v_accvgpr_read_b32 v215, a55
  v_accvgpr_read_b32 v216, a56
  v_accvgpr_read_b32 v217, a57
  v_accvgpr_read_b32 v218, a58
  v_accvgpr_read_b32 v219, a59
  v_accvgpr_read_b32 v220, a60
  v_accvgpr_read_b32 v221, a61
  v_accvgpr_read_b32 v222, a62
  v_accvgpr_read_b32 v223, a63
  s_waitcnt lgkmcnt(0)
  v_pk_add_f32 v[160:161], v[160:161], v[176:177]
  v_pk_add_f32 v[192:193], v[192:193], v[208:209]
  v_pk_add_f32 v[162:163], v[162:163], v[178:179]
  v_pk_add_f32 v[194:195], v[194:195], v[210:211]
  v_pk_add_f32 v[164:165], v[164:165], v[180:181]
  v_pk_add_f32 v[196:197], v[196:197], v[212:213]
  v_pk_add_f32 v[166:167], v[166:167], v[182:183]
  v_pk_add_f32 v[198:199], v[198:199], v[214:215]
  v_pk_add_f32 v[168:169], v[168:169], v[184:185]
  v_pk_add_f32 v[200:201], v[200:201], v[216:217]
  v_pk_add_f32 v[170:171], v[170:171], v[186:187]
  v_pk_add_f32 v[202:203], v[202:203], v[218:219]
  v_pk_add_f32 v[172:173], v[172:173], v[188:189]
  v_pk_add_f32 v[204:205], v[204:205], v[220:221]
  v_pk_add_f32 v[174:175], v[174:175], v[190:191]
  v_pk_add_f32 v[206:207], v[206:207], v[222:223]
  v_pk_add_f32 v[160:161], v[160:161], v[192:193]
  v_pk_add_f32 v[162:163], v[162:163], v[194:195]
  v_pk_add_f32 v[164:165], v[164:165], v[196:197]
  v_pk_add_f32 v[166:167], v[166:167], v[198:199]
  v_pk_add_f32 v[168:169], v[168:169], v[200:201]
  v_pk_add_f32 v[170:171], v[170:171], v[202:203]
  v_pk_add_f32 v[172:173], v[172:173], v[204:205]
  v_pk_add_f32 v[174:175], v[174:175], v[206:207]
  v_cvt_pk_bf16_f32 v224, v160, v161
  v_cvt_pk_bf16_f32 v225, v162, v163
  v_cvt_pk_bf16_f32 v226, v164, v165
  v_cvt_pk_bf16_f32 v227, v166, v167
  v_cvt_pk_bf16_f32 v228, v168, v169
  v_cvt_pk_bf16_f32 v229, v170, v171
  v_cvt_pk_bf16_f32 v230, v172, v173
  v_cvt_pk_bf16_f32 v231, v174, v175
  s_add_u32 s34, s25, 81984
  s_nop 0
  v_permlane32_swap_b32 v224, v226
  v_permlane32_swap_b32 v225, v227
  v_permlane32_swap_b32 v228, v230
  v_permlane32_swap_b32 v229, v231
  buffer_store_dwordx4 v[224:227], v4, s[16:19], s34 offen offset:0
  buffer_store_dwordx4 v[228:231], v4, s[16:19], s34 offen offset:32
OP_36_r3:
  s_barrier
  s_branch BG_FIN
BG_OK:
  s_mul_i32 s37, s82, 3277
  s_lshr_b32 s37, s37, 16
  s_mul_i32 s39, s37, 20
  s_sub_u32 s39, s82, s39
  s_and_b32 s38, s39, 3
  s_lshr_b32 s39, s39, 2
  s_add_u32 s37, s37, s83
  s_sub_u32 s63, s37, 56
  s_mul_i32 s63, s63, 20
  s_mul_i32 s34, s79, 5
  s_add_u32 s63, s63, s34
  s_add_u32 s63, s63, s39
  s_lshl_b32 s64, s63, 4
  s_add_u32 s64, s64, 1843712
  s_lshl_b32 s63, s63, 14
  s_add_u32 s63, s63, 130023424
  s_lshl_b32 s39, s39, 5
  s_mul_i32 s34, s79, 160
  s_add_u32 s39, s39, s34
  s_lshl_b32 s91, s37, 6
  s_add_u32 s91, s91, 1839104
  s_load_dwordx2 s[8:9], s[0:1], 40
  s_mov_b32 s10, 0x780000
  s_mov_b32 s11, 0x00020000
  s_load_dwordx2 s[16:17], s[0:1], 80
  s_mov_b32 s18, 0x500000
  s_mov_b32 s19, 0x00020000
  s_mov_b32 s4, s84
  s_mov_b32 s5, s85
  s_mov_b32 s6, s86
  s_mov_b32 s7, s87
  v_lshlrev_b32 v2, 4, v1
  v_add_u32 v5, 0, v1
  v_mul_u32_u24 v6, 16385, v5
  v_lshrrev_b32 v6, 16, v6
  v_mul_u32_u24 v7, 4, v6
  v_sub_u32 v7, v5, v7
  v_mul_u32_u24 v6, 1280, v6
  v_lshlrev_b32 v7, 4, v7
  v_add_u32 v8, v6, v7
  v_lshrrev_b32 v5, 5, v1
  v_lshlrev_b32 v5, 2, v5
  v_bfe_u32 v6, v1, 2, 2
  v_add_u32 v5, v5, v6
  v_mul_u32_u24 v5, 64, v5
  v_bfe_u32 v6, v1, 4, 1
  v_lshlrev_b32 v6, 5, v6
  v_and_b32 v7, 3, v1
  v_lshlrev_b32 v7, 3, v7
  v_add3_u32 v5, v5, v6, v7
  s_mul_i32 s34, s80, 32768
  v_add_u32 v3, s34, v5
  v_and_b32 v5, 31, v1
  v_mul_u32_u24 v5, 2560, v5
  v_lshrrev_b32 v6, 5, v1
  v_lshlrev_b32 v6, 4, v6
  v_add_u32 v4, v5, v6
  s_waitcnt lgkmcnt(0)
  s_lshl_b32 s34, s38, 2
  s_add_u32 s34, s34, s80
  s_mul_i32 s35, s34, 24576
  s_mul_i32 s20, s37, 393216
  s_add_u32 s20, s20, s35
  s_add_u32 s20, s20, 77594624
  s_mul_i32 s22, s34, 491520
  s_lshl_b32 s34, s39, 1
  s_add_u32 s22, s22, s34
  s_mul_i32 s23, s80, 32768
  s_add_u32 m0, s23, 0
  s_nop 0
  buffer_load_dwordx4 v8, s[8:11], s22 offen lds
  s_add_u32 s22, s22, 20480
  s_add_u32 m0, s23, 1024
  s_nop 0
  buffer_load_dwordx4 v8, s[8:11], s22 offen lds
  s_add_u32 s22, s22, 20480
  s_add_u32 m0, s23, 2048
  s_nop 0
  buffer_load_dwordx4 v8, s[8:11], s22 offen lds
  s_add_u32 s22, s22, 20480
  s_add_u32 m0, s23, 3072
  s_nop 0
  buffer_load_dwordx4 v8, s[8:11], s22 offen lds
  s_add_u32 s22, s22, 20480
  s_add_u32 m0, s23, 4096
  s_nop 0
  buffer_load_dwordx4 v8, s[8:11], s22 offen lds
  s_add_u32 s22, s22, 20480
  s_add_u32 m0, s23, 5120
  s_nop 0
  buffer_load_dwordx4 v8, s[8:11], s22 offen lds
  s_add_u32 s22, s22, 20480
  s_add_u32 m0, s23, 6144
  s_nop 0
  buffer_load_dwordx4 v8, s[8:11], s22 offen lds
  s_add_u32 s22, s22, 20480
  s_add_u32 m0, s23, 7168
  s_nop 0
  buffer_load_dwordx4 v8, s[8:11], s22 offen lds
  s_add_u32 s22, s22, 20480
  s_add_u32 m0, s23, 8192
  s_nop 0
  buffer_load_dwordx4 v8, s[8:11], s22 offen lds
  s_add_u32 s22, s22, 20480
  s_add_u32 m0, s23, 9216
  s_nop 0
  buffer_load_dwordx4 v8, s[8:11], s22 offen lds
  s_add_u32 s22, s22, 20480
  s_add_u32 m0, s23, 10240
  s_nop 0
  buffer_load_dwordx4 v8, s[8:11], s22 offen lds
  s_add_u32 s22, s22, 20480
  s_add_u32 m0, s23, 11264
  s_nop 0
  buffer_load_dwordx4 v8, s[8:11], s22 offen lds
  s_add_u32 s22, s22, 20480
  s_add_u32 m0, s23, 12288
  s_nop 0
  buffer_load_dwordx4 v8, s[8:11], s22 offen lds
  s_add_u32 s22, s22, 20480
  s_add_u32 m0, s23, 13312
  s_nop 0
  buffer_load_dwordx4 v8, s[8:11], s22 offen lds
  s_add_u32 s22, s22, 20480
  s_add_u32 m0, s23, 14336
  s_nop 0
  buffer_load_dwordx4 v8, s[8:11], s22 offen lds
  s_add_u32 s22, s22, 20480
  s_add_u32 m0, s23, 15360
  s_nop 0
  buffer_load_dwordx4 v8, s[8:11], s22 offen lds
  s_add_u32 s22, s22, 20480
  s_add_u32 m0, s23, 16384
  s_nop 0
  buffer_load_dwordx4 v8, s[8:11], s22 offen lds
  s_add_u32 s22, s22, 20480
  s_add_u32 m0, s23, 17408
  s_nop 0
  buffer_load_dwordx4 v8, s[8:11], s22 offen lds
  s_add_u32 s22, s22, 20480
  s_add_u32 m0, s23, 18432
  s_nop 0
  buffer_load_dwordx4 v8, s[8:11], s22 offen lds
  s_add_u32 s22, s22, 20480
  s_add_u32 m0, s23, 19456
  s_nop 0
  buffer_load_dwordx4 v8, s[8:11], s22 offen lds
  s_add_u32 s22, s22, 20480
  s_add_u32 m0, s23, 20480
  s_nop 0
  buffer_load_dwordx4 v8, s[8:11], s22 offen lds
  s_add_u32 s22, s22, 20480
  s_add_u32 m0, s23, 21504
  s_nop 0
  buffer_load_dwordx4 v8, s[8:11], s22 offen lds
  s_add_u32 s22, s22, 20480
  s_add_u32 m0, s23, 22528
  s_nop 0
  buffer_load_dwordx4 v8, s[8:11], s22 offen lds
  s_add_u32 s22, s22, 20480
  s_add_u32 m0, s23, 23552
  s_nop 0
  buffer_load_dwordx4 v8, s[8:11], s22 offen lds
  s_add_u32 s22, s22, 20480
  s_cmp_eq_u32 s80, 0
  s_cbranch_scc0 W_39_d
  v_lshlrev_b32 v5, 2, v0
  s_mov_b32 s93, 0
  s_mov_b64 exec, 0x1
W_39_l:
  buffer_load_dword v6, v5, s[84:87], s91 offen sc1
  s_add_u32 s93, s93, 1
  s_waitcnt vmcnt(0)
  v_cmp_gt_u32 vcc, 8, v6
  s_cbranch_vccz W_39_k
  s_sleep 32
  s_cmp_lt_u32 s93, 200000
  s_cbranch_scc1 W_39_l
W_39_k:
  s_mov_b64 exec, -1
W_39_d:
  s_barrier
  buffer_load_dwordx4 v[16:19], v2, s[4:7], s20 offen offset:0
  buffer_load_dwordx4 v[20:23], v2, s[4:7], s20 offen offset:1024
  buffer_load_dwordx4 v[24:27], v2, s[4:7], s20 offen offset:2048
  buffer_load_dwordx4 v[28:31], v2, s[4:7], s20 offen offset:3072
  s_add_u32 s20, s20, 4096
  buffer_load_dwordx4 v[32:35], v2, s[4:7], s20 offen offset:0
  buffer_load_dwordx4 v[36:39], v2, s[4:7], s20 offen offset:1024
  buffer_load_dwordx4 v[40:43], v2, s[4:7], s20 offen offset:2048
  buffer_load_dwordx4 v[44:47], v2, s[4:7], s20 offen offset:3072
  s_add_u32 s20, s20, 4096
  buffer_load_dwordx4 v[48:51], v2, s[4:7], s20 offen offset:0
  buffer_load_dwordx4 v[52:55], v2, s[4:7], s20 offen offset:1024
  buffer_load_dwordx4 v[56:59], v2, s[4:7], s20 offen offset:2048
  buffer_load_dwordx4 v[60:63], v2, s[4:7], s20 offen offset:3072
  s_add_u32 s20, s20, 4096
  buffer_load_dwordx4 v[64:67], v2, s[4:7], s20 offen offset:0
  buffer_load_dwordx4 v[68:71], v2, s[4:7], s20 offen offset:1024
  buffer_load_dwordx4 v[72:75], v2, s[4:7], s20 offen offset:2048
  buffer_load_dwordx4 v[76:79], v2, s[4:7], s20 offen offset:3072
  s_add_u32 s20, s20, 4096
  buffer_load_dwordx4 v[80:83], v2, s[4:7], s20 offen offset:0
  buffer_load_dwordx4 v[84:87], v2, s[4:7], s20 offen offset:1024
  buffer_load_dwordx4 v[88:91], v2, s[4:7], s20 offen offset:2048
  buffer_load_dwordx4 v[92:95], v2, s[4:7], s20 offen offset:3072
  s_add_u32 s20, s20, 4096
  buffer_load_dwordx4 v[96:99], v2, s[4:7], s20 offen offset:0
  buffer_load_dwordx4 v[100:103], v2, s[4:7], s20 offen offset:1024
  buffer_load_dwordx4 v[104:107], v2, s[4:7], s20 offen offset:2048
  buffer_load_dwordx4 v[108:111], v2, s[4:7], s20 offen offset:3072
  s_add_u32 s20, s20, 4096
  s_cmp_eq_u32 s80, 0
  s_cbranch_scc0 TI_40
  v_mov_b32 v255, 1
  s_mov_b64 exec, 1
  buffer_atomic_add v255, off, s[84:87], s97 sc0 sc1
  s_mov_b64 exec, -1
TI_40:
  s_waitcnt vmcnt(24)
  ds_read_b64_tr_b16 v[112:113], v3 offset:0
  ds_read_b64_tr_b16 v[114:115], v3 offset:512
  ds_read_b64_tr_b16 v[116:117], v3 offset:1024
  ds_read_b64_tr_b16 v[118:119], v3 offset:1536
  ds_read_b64_tr_b16 v[120:121], v3 offset:2048
  ds_read_b64_tr_b16 v[122:123], v3 offset:2560
  ds_read_b64_tr_b16 v[124:125], v3 offset:3072
  ds_read_b64_tr_b16 v[126:127], v3 offset:3584
  s_waitcnt vmcnt(20) lgkmcnt(0)
  ds_read_b64_tr_b16 v[128:129], v3 offset:4096
  ds_read_b64_tr_b16 v[130:131], v3 offset:4608
  ds_read_b64_tr_b16 v[132:133], v3 offset:5120
  ds_read_b64_tr_b16 v[134:135], v3 offset:5632
  ds_read_b64_tr_b16 v[136:137], v3 offset:6144
  ds_read_b64_tr_b16 v[138:139], v3 offset:6656
  ds_read_b64_tr_b16 v[140:141], v3 offset:7168
  ds_read_b64_tr_b16 v[142:143], v3 offset:7680
  v_mfma_f32_32x32x16_bf16 a[0:15], v[112:115], v[16:19], 0
  v_mfma_f32_32x32x16_bf16 a[0:15], v[116:119], v[20:23], a[0:15]
  v_mfma_f32_32x32x16_bf16 a[0:15], v[120:123], v[24:27], a[0:15]
  v_mfma_f32_32x32x16_bf16 a[0:15], v[124:127], v[28:31], a[0:15]
  s_waitcnt vmcnt(16) lgkmcnt(0)
  ds_read_b64_tr_b16 v[112:113], v3 offset:8192
  ds_read_b64_tr_b16 v[114:115], v3 offset:8704
  ds_read_b64_tr_b16 v[116:117], v3 offset:9216
  ds_read_b64_tr_b16 v[118:119], v3 offset:9728
  ds_read_b64_tr_b16 v[120:121], v3 offset:10240
  ds_read_b64_tr_b16 v[122:123], v3 offset:10752
  ds_read_b64_tr_b16 v[124:125], v3 offset:11264
  ds_read_b64_tr_b16 v[126:127], v3 offset:11776
  v_mfma_f32_32x32x16_bf16 a[0:15], v[128:131], v[32:35], a[0:15]
  v_mfma_f32_32x32x16_bf16 a[0:15], v[132:135], v[36:39], a[0:15]
  v_mfma_f32_32x32x16_bf16 a[0:15], v[136:139], v[40:43], a[0:15]
  v_mfma_f32_32x32x16_bf16 a[0:15], v[140:143], v[44:47], a[0:15]
  s_waitcnt vmcnt(12) lgkmcnt(0)
  ds_read_b64_tr_b16 v[128:129], v3 offset:12288
  ds_read_b64_tr_b16 v[130:131], v3 offset:12800
  ds_read_b64_tr_b16 v[132:133], v3 offset:13312
  ds_read_b64_tr_b16 v[134:135], v3 offset:13824
  ds_read_b64_tr_b16 v[136:137], v3 offset:14336
  ds_read_b64_tr_b16 v[138:139], v3 offset:14848
  ds_read_b64_tr_b16 v[140:141], v3 offset:15360
  ds_read_b64_tr_b16 v[142:143], v3 offset:15872
  v_mfma_f32_32x32x16_bf16 a[0:15], v[112:115], v[48:51], a[0:15]
  v_mfma_f32_32x32x16_bf16 a[0:15], v[116:119], v[52:55], a[0:15]
  v_mfma_f32_32x32x16_bf16 a[0:15], v[120:123], v[56:59], a[0:15]
  v_mfma_f32_32x32x16_bf16 a[0:15], v[124:127], v[60:63], a[0:15]
  s_waitcnt vmcnt(8) lgkmcnt(0)
  ds_read_b64_tr_b16 v[112:113], v3 offset:16384
  ds_read_b64_tr_b16 v[114:115], v3 offset:16896
  ds_read_b64_tr_b16 v[116:117], v3 offset:17408
  ds_read_b64_tr_b16 v[118:119], v3 offset:17920
  ds_read_b64_tr_b16 v[120:121], v3 offset:18432
  ds_read_b64_tr_b16 v[122:123], v3 offset:18944
  ds_read_b64_tr_b16 v[124:125], v3 offset:19456
  ds_read_b64_tr_b16 v[126:127], v3 offset:19968
  v_mfma_f32_32x32x16_bf16 a[0:15], v[128:131], v[64:67], a[0:15]
  v_mfma_f32_32x32x16_bf16 a[0:15], v[132:135], v[68:71], a[0:15]
  v_mfma_f32_32x32x16_bf16 a[0:15], v[136:139], v[72:75], a[0:15]
  v_mfma_f32_32x32x16_bf16 a[0:15], v[140:143], v[76:79], a[0:15]
  s_waitcnt vmcnt(4) lgkmcnt(0)
  ds_read_b64_tr_b16 v[128:129], v3 offset:20480
  ds_read_b64_tr_b16 v[130:131], v3 offset:20992
  ds_read_b64_tr_b16 v[132:133], v3 offset:21504
  ds_read_b64_tr_b16 v[134:135], v3 offset:22016
  ds_read_b64_tr_b16 v[136:137], v3 offset:22528
  ds_read_b64_tr_b16 v[138:139], v3 offset:23040
  ds_read_b64_tr_b16 v[140:141], v3 offset:23552
  ds_read_b64_tr_b16 v[142:143], v3 offset:24064
  v_mfma_f32_32x32x16_bf16 a[0:15], v[112:115], v[80:83], a[0:15]
  v_mfma_f32_32x32x16_bf16 a[0:15], v[116:119], v[84:87], a[0:15]
  v_mfma_f32_32x32x16_bf16 a[0:15], v[120:123], v[88:91], a[0:15]
  v_mfma_f32_32x32x16_bf16 a[0:15], v[124:127], v[92:95], a[0:15]
  s_waitcnt vmcnt(0) lgkmcnt(0)
  v_mfma_f32_32x32x16_bf16 a[0:15], v[128:131], v[96:99], a[0:15]
  v_mfma_f32_32x32x16_bf16 a[0:15], v[132:135], v[100:103], a[0:15]
  v_mfma_f32_32x32x16_bf16 a[0:15], v[136:139], v[104:107], a[0:15]
  v_mfma_f32_32x32x16_bf16 a[0:15], v[140:143], v[108:111], a[0:15]
  s_waitcnt vmcnt(0)
  v_readfirstlane_b32 s96, v255
  s_nop 7
  s_nop 7
  v_add_u32 v5, s23, v2
  s_cmp_eq_u32 s80, 0
  s_cbranch_scc1 OK_38_w0
  ds_write_b128 v5, a[0:3] offset:0
  ds_write_b128 v5, a[4:7] offset:1024
  ds_write_b128 v5, a[8:11] offset:2048
  ds_write_b128 v5, a[12:15] offset:3072
OK_38_w0:
  s_waitcnt lgkmcnt(0)
  s_barrier
  s_cmp_eq_u32 s80, 0
  s_cbranch_scc0 OK_38_end
  v_add_u32 v6, 32768, v2
  ds_read_b128 v[160:163], v6 offset:0
  ds_read_b128 v[164:167], v6 offset:1024
  ds_read_b128 v[168:171], v6 offset:2048
  ds_read_b128 v[172:175], v6 offset:3072
  v_add_u32 v6, 65536, v2
  ds_read_b128 v[176:179], v6 offset:0
  ds_read_b128 v[180:183], v6 offset:1024
  ds_read_b128 v[184:187], v6 offset:2048
  ds_read_b128 v[188:191], v6 offset:3072
  v_add_u32 v6, 98304, v2
  ds_read_b128 v[192:195], v6 offset:0
  ds_read_b128 v[196:199], v6 offset:1024
  ds_read_b128 v[200:203], v6 offset:2048
  ds_read_b128 v[204:207], v6 offset:3072
  v_accvgpr_read_b32 v208, a0
  v_accvgpr_read_b32 v209, a1
  v_accvgpr_read_b32 v210, a2
  v_accvgpr_read_b32 v211, a3
  v_accvgpr_read_b32 v212, a4
  v_accvgpr_read_b32 v213, a5
  v_accvgpr_read_b32 v214, a6
  v_accvgpr_read_b32 v215, a7
  v_accvgpr_read_b32 v216, a8
  v_accvgpr_read_b32 v217, a9
  v_accvgpr_read_b32 v218, a10
  v_accvgpr_read_b32 v219, a11
  v_accvgpr_read_b32 v220, a12
  v_accvgpr_read_b32 v221, a13
  v_accvgpr_read_b32 v222, a14
  v_accvgpr_read_b32 v223, a15
  s_waitcnt lgkmcnt(0)
  v_pk_add_f32 v[160:161], v[160:161], v[176:177]
  v_pk_add_f32 v[192:193], v[192:193], v[208:209]
  v_pk_add_f32 v[162:163], v[162:163], v[178:179]
  v_pk_add_f32 v[194:195], v[194:195], v[210:211]
  v_pk_add_f32 v[164:165], v[164:165], v[180:181]
  v_pk_add_f32 v[196:197], v[196:197], v[212:213]
  v_pk_add_f32 v[166:167], v[166:167], v[182:183]
  v_pk_add_f32 v[198:199], v[198:199], v[214:215]
  v_pk_add_f32 v[168:169], v[168:169], v[184:185]
  v_pk_add_f32 v[200:201], v[200:201], v[216:217]
  v_pk_add_f32 v[170:171], v[170:171], v[186:187]
  v_pk_add_f32 v[202:203], v[202:203], v[218:219]
  v_pk_add_f32 v[172:173], v[172:173], v[188:189]
  v_pk_add_f32 v[204:205], v[204:205], v[220:221]
  v_pk_add_f32 v[174:175], v[174:175], v[190:191]
  v_pk_add_f32 v[206:207], v[206:207], v[222:223]
  v_pk_add_f32 v[160:161], v[160:161], v[192:193]
  v_pk_add_f32 v[162:163], v[162:163], v[194:195]
  v_pk_add_f32 v[164:165], v[164:165], v[196:197]
  v_pk_add_f32 v[166:167], v[166:167], v[198:199]
  v_pk_add_f32 v[168:169], v[168:169], v[200:201]
  v_pk_add_f32 v[170:171], v[170:171], v[202:203]
  v_pk_add_f32 v[172:173], v[172:173], v[204:205]
  v_pk_add_f32 v[174:175], v[174:175], v[206:207]
  s_lshl_b32 s34, s38, 12
  s_add_u32 s34, s34, s63
  s_nop 0
  buffer_store_dwordx4 v[160:163], v2, s[4:7], s34 offen offset:0 sc1
  buffer_store_dwordx4 v[164:167], v2, s[4:7], s34 offen offset:1024 sc1
  buffer_store_dwordx4 v[168:171], v2, s[4:7], s34 offen offset:2048 sc1
  buffer_store_dwordx4 v[172:175], v2, s[4:7], s34 offen offset:3072 sc1
  s_waitcnt vmcnt(0)
  v_mov_b32 v7, 1
  s_mov_b64 exec, 1
  buffer_atomic_add v7, off, s[4:7], s64 sc0 sc1
  s_mov_b64 exec, -1
  s_waitcnt vmcnt(0)
  v_readfirstlane_b32 s34, v7
  s_cmp_eq_u32 s34, 3
  s_cbranch_scc0 OK_38_end
  s_mov_b32 s34, s63
  buffer_load_dwordx4 v[160:163], v2, s[4:7], s34 offen offset:0 sc1
  buffer_load_dwordx4 v[164:167], v2, s[4:7], s34 offen offset:1024 sc1
  buffer_load_dwordx4 v[168:171], v2, s[4:7], s34 offen offset:2048 sc1
  buffer_load_dwordx4 v[172:175], v2, s[4:7], s34 offen offset:3072 sc1
  s_add_u32 s34, s34, 4096
  buffer_load_dwordx4 v[176:179], v2, s[4:7], s34 offen offset:0 sc1
  buffer_load_dwordx4 v[180:183], v2, s[4:7], s34 offen offset:1024 sc1
  buffer_load_dwordx4 v[184:187], v2, s[4:7], s34 offen offset:2048 sc1
  buffer_load_dwordx4 v[188:191], v2, s[4:7], s34 offen offset:3072 sc1
  s_add_u32 s34, s34, 4096
  buffer_load_dwordx4 v[192:195], v2, s[4:7], s34 offen offset:0 sc1
  buffer_load_dwordx4 v[196:199], v2, s[4:7], s34 offen offset:1024 sc1
  buffer_load_dwordx4 v[200:203], v2, s[4:7], s34 offen offset:2048 sc1
  buffer_load_dwordx4 v[204:207], v2, s[4:7], s34 offen offset:3072 sc1
  s_add_u32 s34, s34, 4096
  buffer_load_dwordx4 v[208:211], v2, s[4:7], s34 offen offset:0 sc1
  buffer_load_dwordx4 v[212:215], v2, s[4:7], s34 offen offset:1024 sc1
  buffer_load_dwordx4 v[216:219], v2, s[4:7], s34 offen offset:2048 sc1
  buffer_load_dwordx4 v[220:223], v2, s[4:7], s34 offen offset:3072 sc1
  s_add_u32 s34, s34, 4096
  s_mul_i32 s25, s37, 81920
  s_lshl_b32 s34, s39, 1
  s_add_u32 s25, s25, s34
  s_waitcnt vmcnt(0)
  v_pk_add_f32 v[160:161], v[160:161], v[176:177]
  v_pk_add_f32 v[192:193], v[192:193], v[208:209]
  v_pk_add_f32 v[162:163], v[162:163], v[178:179]
  v_pk_add_f32 v[194:195], v[194:195], v[210:211]
  v_pk_add_f32 v[164:165], v[164:165], v[180:181]
  v_pk_add_f32 v[196:197], v[196:197], v[212:213]
  v_pk_add_f32 v[166:167], v[166:167], v[182:183]
  v_pk_add_f32 v[198:199], v[198:199], v[214:215]
  v_pk_add_f32 v[168:169], v[168:169], v[184:185]
  v_pk_add_f32 v[200:201], v[200:201], v[216:217]
  v_pk_add_f32 v[170:171], v[170:171], v[186:187]
  v_pk_add_f32 v[202:203], v[202:203], v[218:219]
  v_pk_add_f32 v[172:173], v[172:173], v[188:189]
  v_pk_add_f32 v[204:205], v[204:205], v[220:221]
  v_pk_add_f32 v[174:175], v[174:175], v[190:191]
  v_pk_add_f32 v[206:207], v[206:207], v[222:223]
  v_pk_add_f32 v[160:161], v[160:161], v[192:193]
  v_pk_add_f32 v[162:163], v[162:163], v[194:195]
  v_pk_add_f32 v[164:165], v[164:165], v[196:197]
  v_pk_add_f32 v[166:167], v[166:167], v[198:199]
  v_pk_add_f32 v[168:169], v[168:169], v[200:201]
  v_pk_add_f32 v[170:171], v[170:171], v[202:203]
  v_pk_add_f32 v[172:173], v[172:173], v[204:205]
  v_pk_add_f32 v[174:175], v[174:175], v[206:207]
  v_cvt_pk_bf16_f32 v224, v160, v161
  v_cvt_pk_bf16_f32 v225, v162, v163
  v_cvt_pk_bf16_f32 v226, v164, v165
  v_cvt_pk_bf16_f32 v227, v166, v167
  v_cvt_pk_bf16_f32 v228, v168, v169
  v_cvt_pk_bf16_f32 v229, v170, v171
  v_cvt_pk_bf16_f32 v230, v172, v173
  v_cvt_pk_bf16_f32 v231, v174, v175
  s_nop 0
  v_permlane32_swap_b32 v224, v226
  v_permlane32_swap_b32 v225, v227
  v_permlane32_swap_b32 v228, v230
  v_permlane32_swap_b32 v229, v231
  buffer_store_dwordx4 v[224:227], v4, s[16:19], s25 offen offset:0
  buffer_store_dwordx4 v[228:231], v4, s[16:19], s25 offen offset:32
OK_38_end:
  s_barrier
  s_branch BG_FIN
BG_SIG:
  s_cmp_eq_u32 s80, 0
  s_cbranch_scc0 TI_42
  v_mov_b32 v255, 1
  s_mov_b64 exec, 1
  buffer_atomic_add v255, off, s[84:87], s97 sc0 sc1
  s_mov_b64 exec, -1
TI_42:
  s_waitcnt vmcnt(0)
  v_readfirstlane_b32 s96, v255
  s_barrier
  s_cmp_eq_u32 s80, 0
  s_cbranch_scc0 S_41
  v_mov_b32 v2, 0
  v_mov_b32 v3, s99
  s_mov_b64 exec, 1
  buffer_atomic_add v3, v2, s[84:87], s90 offen sc1
  s_mov_b64 exec, -1
S_41:
BG_FIN:
  s_branch BG_LOOP
BG_END:
L1_END:
  s_endpgm
.section .rodata,"a"
.p2align 6
.amdhsa_kernel concat_heads__memory_aug_recurrent_mem_tr__mha_block__prompt_kernel
  .amdhsa_next_free_vgpr 512
  .amdhsa_next_free_sgpr 102
  .amdhsa_accum_offset 256
  .amdhsa_group_segment_fixed_size 0
  .amdhsa_kernarg_size 104
  .amdhsa_user_sgpr_count 2
  .amdhsa_user_sgpr_kernarg_segment_ptr 1
  .amdhsa_system_sgpr_workgroup_id_x 1
.end_amdhsa_kernel
```
